```python
import torch

def _softmax(x, axis=-1):
    return torch.softmax(x, dim=axis)
def _gelu(x):
    return torch.nn.functional.gelu(x, approximate="tanh")
def _silu(x):
    return torch.nn.functional.silu(x)
def _sigmoid(x):
    return torch.sigmoid(x)
def _layernorm(x, axis=-1, eps=1e-5):
    m = x.mean(dim=axis, keepdim=True)
    v = x.var(dim=axis, keepdim=True, unbiased=False)
    return (x - m) / torch.sqrt(v + eps)
def _scatter_add(tgt, idx, src, axis=0):
    return tgt.clone().index_add_(axis, idx, src)
def _segment_sum(src, seg, n):
    out = torch.zeros((n,) + src.shape[1:], dtype=src.dtype)
    return out.index_add_(0, seg, src)
def _pad(x, pw):
    flat = tuple(v for pair in reversed(pw) for v in pair)
    return torch.nn.functional.pad(x, flat)

kernel_name = 'concat_heads__gqa_block_cached__mha_block_cached__near_ridge'

def setup_inputs():

    _w = (lambda a: (lambda t: t.to(torch.bfloat16) if t.is_floating_point() else t)(torch.as_tensor(a)))
    def _A_setup():
        B, Sq, D = 8, 176, 448
        Hq, Hkv, Sk, Dh = 16, 8, 2048, 256
        assert Hq % Hkv == 0, (Hq, Hkv)
        return {
            "x": _w((lambda *s: torch.randn(*s, dtype=torch.bfloat16) * 0.8)(B, Sq, D)),
            "k_cache": _w((lambda *s: torch.randn(*s, dtype=torch.bfloat16) * 0.8)(B, Hkv, Sk, Dh)),
            "v_cache": _w((lambda *s: torch.randn(*s, dtype=torch.bfloat16) * 0.05)(B, Hkv, Sk, Dh)),
            "wq": _w((lambda *s: torch.randn(*s, dtype=torch.bfloat16) * 0.8)(D, Hq * Dh) * (D ** -0.5)),
            "wo": _w((lambda *s: torch.randn(*s, dtype=torch.bfloat16) * 0.05)(Hq * Dh, D) * ((Hq * Dh) ** -0.5)),
        }
    _A_in = _A_setup()

    def _B_setup():
        B, Sq, D = 8, 176, 448
        H, Sk, Dh = 16, 2048, 256
        return {
            "x": _w((lambda *s: torch.randn(*s, dtype=torch.bfloat16) * 0.8)(B, Sq, D)),
            "k_cache": _w((lambda *s: torch.randn(*s, dtype=torch.bfloat16) * 0.8)(B, H, Sk, Dh)),
            "v_cache": _w((lambda *s: torch.randn(*s, dtype=torch.bfloat16) * 0.05)(B, H, Sk, Dh)),
            "wq": _w((lambda *s: torch.randn(*s, dtype=torch.bfloat16) * 0.8)(D, H * Dh) * (D ** -0.5)),
            "wo": _w((lambda *s: torch.randn(*s, dtype=torch.bfloat16) * 0.05)(H * Dh, D) * ((H * Dh) ** -0.5)),
        }
    _B_in = _B_setup()

    return {
        "A_x": _A_in["x"],
        "A_k_cache": _A_in["k_cache"],
        "A_v_cache": _A_in["v_cache"],
        "A_wq": _A_in["wq"],
        "A_wo": _A_in["wo"],
        "B_x": _B_in["x"],
        "B_k_cache": _B_in["k_cache"],
        "B_v_cache": _B_in["v_cache"],
        "B_wq": _B_in["wq"],
        "B_wo": _B_in["wo"],
    }

def reference(A_x, A_k_cache, A_v_cache, A_wq, A_wo, B_x, B_k_cache, B_v_cache, B_wq, B_wo):
    def _A_ref(x, k_cache, v_cache, wq, wo):
        B, Sq, D = x.shape
        Hq, Dh = 16, 256
        Hkv = k_cache.shape[1]
        rep = Hq // Hkv
        q = (lambda x, *d: x.permute(*d))((x @ wq).reshape(B, Sq, Hq, Dh), 0, 2, 1, 3)
        k = (lambda x, n, axis: torch.repeat_interleave(x, n, dim=axis))(k_cache, rep, axis=1)
        v = (lambda x, n, axis: torch.repeat_interleave(x, n, dim=axis))(v_cache, rep, axis=1)
        scores = torch.einsum("bhqd,bhkd->bhqk", q, k) * (Dh ** -0.5)
        p = _softmax(scores, axis=-1)
        o = torch.einsum("bhqk,bhkd->bhqd", p, v)
        return (lambda x, *d: x.permute(*d))(o, 0, 2, 1, 3).reshape(B, Sq, Hq * Dh) @ wo

    def _B_ref(x, k_cache, v_cache, wq, wo):
        B, Sq, D = x.shape
        H, Dh = 16, 256
        q = (lambda x, *d: x.permute(*d))((x @ wq).reshape(B, Sq, H, Dh), 0, 2, 1, 3)
        scores = torch.einsum("bhqd,bhkd->bhqk", q, k_cache) * (Dh ** -0.5)
        p = _softmax(scores, axis=-1)
        o = torch.einsum("bhqk,bhkd->bhqd", p, v_cache)
        return (lambda x, *d: x.permute(*d))(o, 0, 2, 1, 3).reshape(B, Sq, H * Dh) @ wo

    a = _A_ref(A_x, A_k_cache, A_v_cache, A_wq, A_wo)
    b = _B_ref(B_x, B_k_cache, B_v_cache, B_wq, B_wo)
    return torch.concatenate([a, b], axis=-1)
```

```asm
; @launch kernel=concat_heads__gqa_block_cached__mha_block_cached__near_ridge_kernel grid=(256,1,1) block=(256,1,1) lds=163840
; @launch kernel=oproj_kernel grid=(247,1,1) block=(640,1,1) lds=0
.amdgcn_target "amdgcn-amd-amdhsa--gfx950"
.text
.globl concat_heads__gqa_block_cached__mha_block_cached__near_ridge_kernel
.p2align 8
.type concat_heads__gqa_block_cached__mha_block_cached__near_ridge_kernel,@function
concat_heads__gqa_block_cached__mha_block_cached__near_ridge_kernel:
s_cmp_ge_u32 s2,256
s_cbranch_scc1 K1_END
s_load_dwordx16 s[32:47],s[0:1],0
s_load_dwordx4 s[48:51],s[0:1],64
s_load_dwordx2 s[52:53],s[0:1],96
s_bitcmp0_b32 s2,0
s_cbranch_scc1 ALT
s_getpc_b64 s[54:55]
CW2:
s_lshr_b32 s56,s2,3
s_mul_i32 s56,s56,768
s_add_u32 s56,s56,PRE_A-CW2
s_cmp_ge_u32 s56,(PRE_A-CW2+(M29_A-PRE_A+767)/768*768)
s_cselect_b32 s57,PRE_B-CW2-(PRE_A-CW2+(M29_A-PRE_A+767)/768*768),0
s_add_u32 s56,s56,s57
v_min_u32 v58,5,v0
v_lshl_add_u32 v58,v58,7,s56
v_min_u32 v58,M29_B-CW2-4,v58
v_mov_b32 v59,0
v_lshl_add_u64 v[60:61],v[58:59],0,s[54:55]
global_load_dword v56,v[60:61],off
s_and_b32 s54,s2,7
s_lshr_b32 s55,s2,3
s_and_b32 s56,s54,3
s_lshl_b32 s56,s56,2
s_and_b32 s57,s55,3
s_add_u32 s56,s56,s57
s_and_b32 s57,s54,4
s_bfe_u32 s58,s55,0x20002
s_add_u32 s57,s57,s58
s_lshr_b32 s58,s55,4
v_lshrrev_b32 v30,6,v0
v_and_b32 v31,63,v0
v_readfirstlane_b32 s24,v30
v_lshrrev_b32 v32,4,v31
v_and_b32 v33,15,v31
v_lshrrev_b32 v34,5,v31
v_and_b32 v35,31,v31
v_add_u32 v36,0,v34
v_lshlrev_b32 v37,1,v36
v_xor_b32 v37,v37,v35
v_lshlrev_b32 v12,4,v37
v_lshl_add_u32 v20,v34,13,v12
v_add_u32 v36,2,v34
v_lshlrev_b32 v37,1,v36
v_xor_b32 v37,v37,v35
v_lshlrev_b32 v13,4,v37
v_lshl_add_u32 v21,v34,13,v13
v_add_u32 v21,15360,v21
v_add_u32 v36,4,v34
v_lshlrev_b32 v37,1,v36
v_xor_b32 v37,v37,v35
v_lshlrev_b32 v14,4,v37
v_lshl_add_u32 v22,v34,13,v14
v_add_u32 v22,63488,v22
v_add_u32 v36,6,v34
v_lshlrev_b32 v37,1,v36
v_xor_b32 v37,v37,v35
v_lshlrev_b32 v15,4,v37
v_lshl_add_u32 v23,v34,13,v15
v_add_u32 v23,78848,v23
v_lshrrev_b32 v36,3,v31
v_mad_u32_u24 v36,v30,48,v36
v_mul_u32_u24 v36,0x380,v36
v_and_b32 v37,7,v31
v_xor_b32 v37,v37,v32
v_lshl_add_u32 v24,v37,4,v36
v_xor_b32 v37,4,v37
v_lshl_add_u32 v36,v37,4,v36
v_add_u32 v25,6144,v36
v_add_u32 v26,12288,v24
v_add_u32 v27,18432,v36
v_add_u32 v28,28672,v24
v_add_u32 v29,34816,v36
s_lshl_b32 s25,s24,12
s_and_b32 s28,s24,1
s_lshl_b32 s29,s28,17
s_lshr_b32 s28,s24,1
s_lshl_b32 s28,s28,15
s_add_u32 s29,s29,s28
s_mul_i32 s69,s24,6144
s_add_u32 s69,s69,114688
s_lshl_b32 s54,s56,9
s_mul_i32 s55,s57,157696
s_sub_u32 s14,3670016,s54
s_mov_b32 s15,0x20000
s_mov_b32 s18,157696
s_mov_b32 s19,0x20000
s_cmp_eq_u32 s58,0
s_waitcnt lgkmcnt(0)
s_cselect_b64 s[12:13],s[38:39],s[48:49]
s_cselect_b64 s[16:17],s[32:33],s[42:43]
s_add_u32 s12,s12,s54
s_addc_u32 s13,s13,0
s_add_u32 s16,s16,s55
s_addc_u32 s17,s17,0
s_cmp_eq_u32 s24,3
s_cbranch_scc1 START_B
START_A:
s_add_u32 m0,s25,49152
s_add_u32 s28,s29,0
buffer_load_dwordx4 v20,s[12:15],s28 offen lds
buffer_load_dwordx4 v21,s[12:15],s28 offen offset:1024 lds
buffer_load_dwordx4 v22,s[12:15],s28 offen offset:2048 lds
buffer_load_dwordx4 v23,s[12:15],s28 offen offset:3072 lds
s_add_u32 m0,s69,0
s_mov_b32 s28,0
buffer_load_dwordx4 v24,s[16:19],s28 offen lds
buffer_load_dwordx4 v25,s[16:19],s28 offen offset:1024 lds
buffer_load_dwordx4 v26,s[16:19],s28 offen offset:2048 lds
buffer_load_dwordx4 v27,s[16:19],s28 offen offset:3072 lds
s_add_u32 m0,s69,4096
s_nop 0
buffer_load_dwordx4 v28,s[16:19],s28 offen lds
buffer_load_dwordx4 v29,s[16:19],s28 offen offset:1024 lds
s_add_u32 m0,s25,98304
s_add_u32 s28,s29,262144
buffer_load_dwordx4 v20,s[12:15],s28 offen lds
v_lshl_add_u32 v12,v34,9,v12
v_lshl_add_u32 v13,v34,9,v13
v_lshl_add_u32 v14,v34,9,v14
v_lshl_add_u32 v15,v34,9,v15
s_lshl_b32 s59,s57,4
s_add_u32 s59,s59,s56
s_sub_u32 s54,1,s58
s_lshr_b32 s59,s59,s54
buffer_load_dwordx4 v21,s[12:15],s28 offen offset:1024 lds
s_lshl_b32 s59,s59,20
s_cmp_eq_u32 s58,0
s_cselect_b64 s[4:5],s[34:35],s[44:45]
s_cselect_b64 s[8:9],s[36:37],s[46:47]
s_cselect_b64 s[96:97],s[40:41],s[50:51]
s_add_u32 s4,s4,s59
s_addc_u32 s5,s5,0
s_mov_b32 s6,0x100000
s_mov_b32 s7,0x20000
s_add_u32 s8,s8,s59
s_addc_u32 s9,s9,0
s_mov_b32 s10,0x100000
s_mov_b32 s11,0x20000
buffer_load_dwordx4 v22,s[12:15],s28 offen offset:2048 lds
v_lshrrev_b32 v36,2,v33
v_lshl_add_u32 v36,v32,2,v36
v_and_b32 v38,3,v33
v_and_b32 v39,7,v36
v_lshlrev_b32 v36,9,v36
v_xor_b32 v37,0,v39
v_lshlrev_b32 v37,5,v37
v_lshl_add_u32 v37,v38,3,v37
buffer_load_dwordx4 v23,s[12:15],s28 offen offset:3072 lds
v_add_u32 v37,v37,v36
v_add_u32 v4,65536,v37
v_xor_b32 v37,1,v39
v_lshlrev_b32 v37,5,v37
v_lshl_add_u32 v37,v38,3,v37
v_add_u32 v37,v37,v36
v_add_u32 v5,65536,v37
v_xor_b32 v37,2,v39
s_add_u32 m0,s25,16384
s_add_u32 s28,s29,524288
buffer_load_dwordx4 v20,s[12:15],s28 offen lds
v_lshlrev_b32 v37,5,v37
v_lshl_add_u32 v37,v38,3,v37
v_add_u32 v37,v37,v36
v_add_u32 v6,65536,v37
v_xor_b32 v37,3,v39
v_lshlrev_b32 v37,5,v37
v_lshl_add_u32 v37,v38,3,v37
v_add_u32 v37,v37,v36
buffer_load_dwordx4 v21,s[12:15],s28 offen offset:1024 lds
v_add_u32 v7,65536,v37
v_xor_b32 v37,4,v39
v_lshlrev_b32 v37,5,v37
v_lshl_add_u32 v37,v38,3,v37
v_add_u32 v37,v37,v36
v_add_u32 v8,65536,v37
v_xor_b32 v37,5,v39
v_lshlrev_b32 v37,5,v37
buffer_load_dwordx4 v22,s[12:15],s28 offen offset:2048 lds
v_lshl_add_u32 v37,v38,3,v37
v_add_u32 v37,v37,v36
v_add_u32 v9,65536,v37
v_xor_b32 v37,6,v39
v_lshlrev_b32 v37,5,v37
v_lshl_add_u32 v37,v38,3,v37
v_add_u32 v37,v37,v36
v_add_u32 v10,65536,v37
buffer_load_dwordx4 v23,s[12:15],s28 offen offset:3072 lds
v_xor_b32 v37,7,v39
v_lshlrev_b32 v37,5,v37
v_lshl_add_u32 v37,v38,3,v37
v_add_u32 v37,v37,v36
v_add_u32 v11,65536,v37
v_lshlrev_b32 v39,1,v39
v_add_u32 v36,49152,v36
v_add_u32 v37,0,v38
s_add_u32 m0,s69,24576
s_mov_b32 s28,128
buffer_load_dwordx4 v24,s[16:19],s28 offen lds
v_xor_b32 v37,v37,v39
v_lshl_add_u32 v16,v37,4,v36
v_add_u32 v37,4,v38
v_xor_b32 v37,v37,v39
v_lshl_add_u32 v17,v37,4,v36
v_add_u32 v37,8,v38
v_xor_b32 v37,v37,v39
v_lshl_add_u32 v18,v37,4,v36
buffer_load_dwordx4 v25,s[16:19],s28 offen offset:1024 lds
v_add_u32 v37,12,v38
v_xor_b32 v37,v37,v39
v_lshl_add_u32 v19,v37,4,v36
v_lshrrev_b32 v37,1,v33
v_xor_b32 v37,v37,v32
v_lshlrev_b32 v36,7,v33
v_add_u32 v36,s69,v36
v_lshl_add_u32 v44,v37,4,v36
buffer_load_dwordx4 v26,s[16:19],s28 offen offset:2048 lds
v_xor_b32 v37,4,v37
v_lshl_add_u32 v45,v37,4,v36
v_and_b32 v36,7,v33
v_lshlrev_b32 v36,1,v36
v_add_u32 v37,0,v32
v_xor_b32 v37,v37,v36
v_lshlrev_b32 v37,4,v37
v_lshl_add_u32 v0,v33,9,v37
buffer_load_dwordx4 v27,s[16:19],s28 offen offset:3072 lds
v_add_u32 v37,4,v32
v_xor_b32 v37,v37,v36
v_lshlrev_b32 v37,4,v37
v_lshl_add_u32 v1,v33,9,v37
v_add_u32 v37,8,v32
v_xor_b32 v37,v37,v36
v_lshlrev_b32 v37,4,v37
v_lshl_add_u32 v2,v33,9,v37
s_add_u32 m0,s69,28672
s_nop 0
buffer_load_dwordx4 v28,s[16:19],s28 offen lds
v_add_u32 v37,12,v32
v_xor_b32 v37,v37,v36
v_lshlrev_b32 v37,4,v37
v_lshl_add_u32 v3,v33,9,v37
s_mov_b32 s30,0
s_mov_b32 s60,0x3db8aa3b
s_mov_b32 s61,s60
s_mul_i32 s62,s24,688128
buffer_load_dwordx4 v29,s[16:19],s28 offen offset:1024 lds
s_add_u32 s63,s62,229376
s_add_u32 s64,s62,458752
s_mul_i32 s67,s24,28672
s_lshl_b32 s54,s58,3
s_add_u32 s54,s54,s57
s_lshl_b32 s68,s54,4
s_add_u32 s68,s68,s56
s_lshl_b32 s68,s68,10
s_add_u32 m0,s25,65536
s_add_u32 s28,s29,786432
buffer_load_dwordx4 v20,s[12:15],s28 offen lds
s_add_u32 s68,50331648,s68
s_mul_i32 s55,s24,192
s_add_u32 s68,s68,s55
s_mul_i32 s54,s54,2523136
s_mul_i32 s55,s56,1024
s_add_u32 s54,s54,s55
s_sub_u32 s68,s68,s54
s_add_u32 s20,s52,s54
s_addc_u32 s21,s53,0
buffer_load_dwordx4 v21,s[12:15],s28 offen offset:1024 lds
s_mov_b32 s22,67108864
s_mov_b32 s23,0x20000
s_mul_i32 s54,s56,229376
s_add_u32 s96,s96,s54
s_addc_u32 s97,s97,0
s_mov_b32 s98,229376
s_mov_b32 s99,0x20000
s_mov_b64 s[32:33],s[12:13]
s_mov_b64 s[34:35],s[14:15]
buffer_load_dwordx4 v22,s[12:15],s28 offen offset:2048 lds
s_mov_b32 s36,0
s_add_u32 s37,s25,49152
s_add_u32 s38,s25,81920
s_add_u32 s40,s29,1310720
s_add_u32 s39,s29,1572864
s_mov_b32 s41,524288
s_mov_b32 s42,256
s_mov_b32 s43,s69
buffer_load_dwordx4 v23,s[12:15],s28 offen offset:3072 lds
s_mov_b32 s45,24576
s_mov_b32 s46,16384
v_mov_b64 v[64:65],0
v_mov_b64 v[66:67],0
v_mov_b64 v[68:69],0
v_mov_b64 v[70:71],0
v_mov_b64 v[72:73],0
v_mov_b64 v[74:75],0
s_add_u32 m0,s25,32768
s_add_u32 s28,s29,1048576
buffer_load_dwordx4 v20,s[12:15],s28 offen lds
v_mov_b64 v[76:77],0
v_mov_b64 v[78:79],0
v_mov_b64 v[80:81],0
v_mov_b64 v[82:83],0
v_mov_b64 v[84:85],0
v_mov_b64 v[86:87],0
v_mov_b64 v[88:89],0
v_mov_b64 v[90:91],0
buffer_load_dwordx4 v21,s[12:15],s28 offen offset:1024 lds
v_mov_b64 v[92:93],0
v_mov_b64 v[94:95],0
v_mov_b64 v[96:97],0
v_mov_b64 v[98:99],0
v_mov_b64 v[100:101],0
v_mov_b64 v[102:103],0
v_mov_b64 v[104:105],0
v_mov_b64 v[106:107],0
buffer_load_dwordx4 v22,s[12:15],s28 offen offset:2048 lds
v_mov_b64 v[108:109],0
v_mov_b64 v[110:111],0
v_mov_b64 v[112:113],0
v_mov_b64 v[114:115],0
v_mov_b64 v[116:117],0
v_mov_b64 v[118:119],0
v_mov_b64 v[120:121],0
v_mov_b64 v[122:123],0
buffer_load_dwordx4 v23,s[12:15],s28 offen offset:3072 lds
v_mov_b64 v[124:125],0
v_mov_b64 v[126:127],0
v_mov_b64 v[128:129],0
v_mov_b64 v[130:131],0
v_mov_b64 v[132:133],0
v_mov_b64 v[134:135],0
v_mov_b64 v[136:137],0
v_mov_b64 v[138:139],0
s_mov_b32 m0,s25
s_nop 0
buffer_load_dwordx4 v12,s[4:7],s25 offen nt lds
v_mov_b64 v[140:141],0
v_mov_b64 v[142:143],0
v_mov_b64 v[144:145],0
v_mov_b64 v[146:147],0
v_mov_b64 v[148:149],0
v_mov_b64 v[150:151],0
v_mov_b64 v[152:153],0
v_mov_b64 v[154:155],0
buffer_load_dwordx4 v13,s[4:7],s25 offen offset:1024 nt lds
v_mov_b64 v[156:157],0
v_mov_b64 v[158:159],0
v_mov_b64 v[160:161],0
v_mov_b64 v[162:163],0
v_mov_b64 v[164:165],0
v_mov_b64 v[166:167],0
v_mov_b64 v[168:169],0
v_mov_b64 v[170:171],0
buffer_load_dwordx4 v14,s[4:7],s25 offen offset:2048 nt lds
v_mov_b64 v[172:173],0
v_mov_b64 v[174:175],0
v_mov_b64 v[176:177],0
v_mov_b64 v[178:179],0
v_mov_b64 v[180:181],0
v_mov_b64 v[182:183],0
v_mov_b64 v[184:185],0
v_mov_b64 v[186:187],0
buffer_load_dwordx4 v15,s[4:7],s25 offen offset:3072 nt lds
v_mov_b64 v[188:189],0
v_mov_b64 v[190:191],0
v_mov_b64 v[192:193],0
v_mov_b64 v[194:195],0
v_mov_b64 v[196:197],0
v_mov_b64 v[198:199],0
v_mov_b64 v[200:201],0
v_mov_b64 v[202:203],0
v_mov_b64 v[204:205],0
v_mov_b64 v[206:207],0
v_mov_b64 v[208:209],0
v_mov_b64 v[210:211],0
v_mov_b64 v[212:213],0
v_mov_b64 v[214:215],0
v_mov_b64 v[216:217],0
v_mov_b64 v[218:219],0
v_mov_b64 v[220:221],0
v_mov_b64 v[222:223],0
v_mov_b64 v[224:225],0
v_mov_b64 v[226:227],0
v_mov_b64 v[228:229],0
v_mov_b64 v[230:231],0
v_mov_b64 v[232:233],0
v_mov_b64 v[234:235],0
v_mov_b64 v[236:237],0
v_mov_b64 v[238:239],0
v_mov_b64 v[240:241],0
v_mov_b64 v[242:243],0
v_mov_b64 v[244:245],0
v_mov_b64 v[246:247],0
v_mov_b64 v[248:249],0
v_mov_b64 v[250:251],0
v_mov_b64 v[252:253],0
v_mov_b64 v[254:255],0
s_waitcnt vmcnt(26)
s_barrier
ds_read_b128 a[0:3],v44 offset:0
ds_read_b128 a[4:7],v44 offset:2048
ds_read_b128 a[8:11],v44 offset:4096
ds_read_b64_tr_b16 a[192:193],v16 offset:0
ds_read_b64_tr_b16 a[194:195],v16 offset:8192
ds_read_b64_tr_b16 a[196:197],v16 offset:8
ds_read_b64_tr_b16 a[198:199],v16 offset:8200
ds_read_b64_tr_b16 a[200:201],v17 offset:0
ds_read_b64_tr_b16 a[202:203],v17 offset:8192
ds_read_b64_tr_b16 a[204:205],v17 offset:8
ds_read_b64_tr_b16 a[206:207],v17 offset:8200
ds_read_b64_tr_b16 a[208:209],v18 offset:0
ds_read_b64_tr_b16 a[210:211],v18 offset:8192
s_waitcnt lgkmcnt(8)
v_add_u32 v44,24576,v44
QLOOP_A:
s_waitcnt vmcnt(22)
s_barrier
s_mov_b32 m0,s38
v_mfma_f32_16x16x32_bf16 v[64:67],a[192:195],a[0:3],v[64:67]
ds_read_b128 a[12:15],v45 offset:0
ds_read_b64_tr_b16 a[212:213],v18 offset:8
v_mfma_f32_16x16x32_bf16 v[128:131],a[192:195],a[4:7],v[128:131]
buffer_load_dwordx4 v20,s[32:35],s40 offen lds
v_mfma_f32_16x16x32_bf16 v[192:195],a[192:195],a[8:11],v[192:195]
ds_read_b64_tr_b16 a[214:215],v18 offset:8200
s_waitcnt lgkmcnt(9)
v_mfma_f32_16x16x32_bf16 v[68:71],a[196:199],a[0:3],v[68:71]
ds_read_b128 a[16:19],v45 offset:2048
ds_read_b64_tr_b16 a[216:217],v19 offset:0
v_mfma_f32_16x16x32_bf16 v[132:135],a[196:199],a[4:7],v[132:135]
buffer_load_dwordx4 v21,s[32:35],s40 offen offset:1024 lds
v_mfma_f32_16x16x32_bf16 v[196:199],a[196:199],a[8:11],v[196:199]
ds_read_b64_tr_b16 a[218:219],v19 offset:8192
s_waitcnt lgkmcnt(10)
v_mfma_f32_16x16x32_bf16 v[72:75],a[200:203],a[0:3],v[72:75]
ds_read_b128 a[20:23],v45 offset:4096
ds_read_b64_tr_b16 a[220:221],v19 offset:8
v_mfma_f32_16x16x32_bf16 v[136:139],a[200:203],a[4:7],v[136:139]
buffer_load_dwordx4 v22,s[32:35],s40 offen offset:2048 lds
v_mfma_f32_16x16x32_bf16 v[200:203],a[200:203],a[8:11],v[200:203]
ds_read_b64_tr_b16 a[222:223],v19 offset:8200
s_waitcnt lgkmcnt(11)
v_mfma_f32_16x16x32_bf16 v[76:79],a[204:207],a[0:3],v[76:79]
v_add_u32 v45,s45,v45
ds_read_b64_tr_b16 a[192:193],v16 offset:256
v_mfma_f32_16x16x32_bf16 v[140:143],a[204:207],a[4:7],v[140:143]
buffer_load_dwordx4 v23,s[32:35],s40 offen offset:3072 lds
v_mfma_f32_16x16x32_bf16 v[204:207],a[204:207],a[8:11],v[204:207]
ds_read_b64_tr_b16 a[194:195],v16 offset:8448
s_waitcnt lgkmcnt(11)
v_mfma_f32_16x16x32_bf16 v[80:83],a[208:211],a[0:3],v[80:83]
s_mov_b32 m0,s43
ds_read_b64_tr_b16 a[196:197],v16 offset:264
v_mfma_f32_16x16x32_bf16 v[144:147],a[208:211],a[4:7],v[144:147]
v_mfma_f32_16x16x32_bf16 v[208:211],a[208:211],a[8:11],v[208:211]
ds_read_b64_tr_b16 a[198:199],v16 offset:8456
s_waitcnt lgkmcnt(10)
v_mfma_f32_16x16x32_bf16 v[84:87],a[212:215],a[0:3],v[84:87]
ds_read_b64_tr_b16 a[200:201],v17 offset:256
v_mfma_f32_16x16x32_bf16 v[148:151],a[212:215],a[4:7],v[148:151]
v_mfma_f32_16x16x32_bf16 v[212:215],a[212:215],a[8:11],v[212:215]
ds_read_b64_tr_b16 a[202:203],v17 offset:8448
s_waitcnt lgkmcnt(9)
v_mfma_f32_16x16x32_bf16 v[88:91],a[216:219],a[0:3],v[88:91]
ds_read_b64_tr_b16 a[204:205],v17 offset:264
v_mfma_f32_16x16x32_bf16 v[152:155],a[216:219],a[4:7],v[152:155]
v_mfma_f32_16x16x32_bf16 v[216:219],a[216:219],a[8:11],v[216:219]
ds_read_b64_tr_b16 a[206:207],v17 offset:8456
s_waitcnt lgkmcnt(8)
v_mfma_f32_16x16x32_bf16 v[92:95],a[220:223],a[0:3],v[92:95]
s_waitcnt lgkmcnt(10)
ds_read_b64_tr_b16 a[208:209],v18 offset:256
v_mfma_f32_16x16x32_bf16 v[156:159],a[220:223],a[4:7],v[156:159]
buffer_load_dwordx4 v24,s[16:19],s42 offen lds
v_mfma_f32_16x16x32_bf16 v[220:223],a[220:223],a[8:11],v[220:223]
ds_read_b64_tr_b16 a[210:211],v18 offset:8448
s_waitcnt lgkmcnt(8)
v_mfma_f32_16x16x32_bf16 v[96:99],a[192:195],a[0:3],v[96:99]
ds_read_b64_tr_b16 a[212:213],v18 offset:264
v_mfma_f32_16x16x32_bf16 v[160:163],a[192:195],a[4:7],v[160:163]
buffer_load_dwordx4 v25,s[16:19],s42 offen offset:1024 lds
v_mfma_f32_16x16x32_bf16 v[224:227],a[192:195],a[8:11],v[224:227]
ds_read_b64_tr_b16 a[214:215],v18 offset:8456
s_waitcnt lgkmcnt(8)
v_mfma_f32_16x16x32_bf16 v[100:103],a[196:199],a[0:3],v[100:103]
ds_read_b64_tr_b16 a[216:217],v19 offset:256
v_mfma_f32_16x16x32_bf16 v[164:167],a[196:199],a[4:7],v[164:167]
buffer_load_dwordx4 v26,s[16:19],s42 offen offset:2048 lds
v_mfma_f32_16x16x32_bf16 v[228:231],a[196:199],a[8:11],v[228:231]
ds_read_b64_tr_b16 a[218:219],v19 offset:8448
s_waitcnt lgkmcnt(8)
v_mfma_f32_16x16x32_bf16 v[104:107],a[200:203],a[0:3],v[104:107]
ds_read_b64_tr_b16 a[220:221],v19 offset:264
v_mfma_f32_16x16x32_bf16 v[168:171],a[200:203],a[4:7],v[168:171]
buffer_load_dwordx4 v27,s[16:19],s42 offen offset:3072 lds
v_mfma_f32_16x16x32_bf16 v[232:235],a[200:203],a[8:11],v[232:235]
ds_read_b64_tr_b16 a[222:223],v19 offset:8456
s_waitcnt lgkmcnt(8)
v_mfma_f32_16x16x32_bf16 v[108:111],a[204:207],a[0:3],v[108:111]
s_add_u32 m0,s43,4096
ds_read_b64_tr_b16 a[192:193],v16 offset:49152
v_mfma_f32_16x16x32_bf16 v[172:175],a[204:207],a[4:7],v[172:175]
buffer_load_dwordx4 v28,s[16:19],s42 offen lds
v_mfma_f32_16x16x32_bf16 v[236:239],a[204:207],a[8:11],v[236:239]
ds_read_b64_tr_b16 a[194:195],v16 offset:57344
s_waitcnt lgkmcnt(8)
v_mfma_f32_16x16x32_bf16 v[112:115],a[208:211],a[0:3],v[112:115]
ds_read_b64_tr_b16 a[196:197],v16 offset:49160
v_mfma_f32_16x16x32_bf16 v[176:179],a[208:211],a[4:7],v[176:179]
buffer_load_dwordx4 v29,s[16:19],s42 offen offset:1024 lds
v_mfma_f32_16x16x32_bf16 v[240:243],a[208:211],a[8:11],v[240:243]
ds_read_b64_tr_b16 a[198:199],v16 offset:57352
s_waitcnt lgkmcnt(8)
v_mfma_f32_16x16x32_bf16 v[116:119],a[212:215],a[0:3],v[116:119]
ds_read_b64_tr_b16 a[200:201],v17 offset:49152
v_mfma_f32_16x16x32_bf16 v[180:183],a[212:215],a[4:7],v[180:183]
v_mfma_f32_16x16x32_bf16 v[244:247],a[212:215],a[8:11],v[244:247]
ds_read_b64_tr_b16 a[202:203],v17 offset:57344
s_waitcnt lgkmcnt(8)
v_mfma_f32_16x16x32_bf16 v[120:123],a[216:219],a[0:3],v[120:123]
ds_read_b64_tr_b16 a[204:205],v17 offset:49160
v_mfma_f32_16x16x32_bf16 v[184:187],a[216:219],a[4:7],v[184:187]
v_mfma_f32_16x16x32_bf16 v[248:251],a[216:219],a[8:11],v[248:251]
ds_read_b64_tr_b16 a[206:207],v17 offset:57352
s_waitcnt lgkmcnt(8)
v_mfma_f32_16x16x32_bf16 v[124:127],a[220:223],a[0:3],v[124:127]
ds_read_b64_tr_b16 a[208:209],v18 offset:49152
v_mfma_f32_16x16x32_bf16 v[188:191],a[220:223],a[4:7],v[188:191]
v_mfma_f32_16x16x32_bf16 v[252:255],a[220:223],a[8:11],v[252:255]
ds_read_b64_tr_b16 a[210:211],v18 offset:57344
s_waitcnt lgkmcnt(8)
s_cmp_eq_u32 s36,4
s_cbranch_scc0 QSW_A
s_mov_b64 s[12:13],s[4:5]
s_mov_b32 s14,s6
s_mov_b64 s[32:33],s[8:9]
s_mov_b32 s34,s10
s_mov_b32 s41,16384
s_add_u32 s39,s25,16384
s_sub_u32 s40,s25,16384
s_mov_b32 s18,0
v_mov_b32 v20,v12
v_mov_b32 v21,v13
v_mov_b32 v22,v14
v_mov_b32 v23,v15
QSW_A:
s_waitcnt vmcnt(24)
s_barrier
s_mov_b32 m0,s37
v_mfma_f32_16x16x32_bf16 v[64:67],a[192:195],a[12:15],v[64:67]
s_cmp_ge_u32 s37,49152
ds_read_b64_tr_b16 a[212:213],v18 offset:49160
v_mfma_f32_16x16x32_bf16 v[128:131],a[192:195],a[16:19],v[128:131]
buffer_load_dwordx4 v20,s[12:15],s39 offen lds
v_mfma_f32_16x16x32_bf16 v[192:195],a[192:195],a[20:23],v[192:195]
ds_read_b64_tr_b16 a[214:215],v18 offset:57352
s_waitcnt lgkmcnt(8)
v_mfma_f32_16x16x32_bf16 v[68:71],a[196:199],a[12:15],v[68:71]
s_cselect_b32 s44,0xffff8000,s46
ds_read_b64_tr_b16 a[216:217],v19 offset:49152
v_mfma_f32_16x16x32_bf16 v[132:135],a[196:199],a[16:19],v[132:135]
buffer_load_dwordx4 v21,s[12:15],s39 offen offset:1024 lds
v_mfma_f32_16x16x32_bf16 v[196:199],a[196:199],a[20:23],v[196:199]
ds_read_b64_tr_b16 a[218:219],v19 offset:57344
s_waitcnt lgkmcnt(8)
v_mfma_f32_16x16x32_bf16 v[72:75],a[200:203],a[12:15],v[72:75]
s_add_u32 s38,s37,49152
ds_read_b64_tr_b16 a[220:221],v19 offset:49160
v_mfma_f32_16x16x32_bf16 v[136:139],a[200:203],a[16:19],v[136:139]
buffer_load_dwordx4 v22,s[12:15],s39 offen offset:2048 lds
v_mfma_f32_16x16x32_bf16 v[200:203],a[200:203],a[20:23],v[200:203]
ds_read_b64_tr_b16 a[222:223],v19 offset:57352
s_waitcnt lgkmcnt(8)
v_mfma_f32_16x16x32_bf16 v[76:79],a[204:207],a[12:15],v[76:79]
s_add_u32 s37,s37,s44
ds_read_b64_tr_b16 a[192:193],v16 offset:49408
v_mfma_f32_16x16x32_bf16 v[140:143],a[204:207],a[16:19],v[140:143]
buffer_load_dwordx4 v23,s[12:15],s39 offen offset:3072 lds
v_mfma_f32_16x16x32_bf16 v[204:207],a[204:207],a[20:23],v[204:207]
ds_read_b64_tr_b16 a[194:195],v16 offset:57600
s_waitcnt lgkmcnt(8)
v_mfma_f32_16x16x32_bf16 v[80:83],a[208:211],a[12:15],v[80:83]
s_add_u32 s39,s39,s41
ds_read_b64_tr_b16 a[196:197],v16 offset:49416
v_mfma_f32_16x16x32_bf16 v[144:147],a[208:211],a[16:19],v[144:147]
v_mfma_f32_16x16x32_bf16 v[208:211],a[208:211],a[20:23],v[208:211]
ds_read_b64_tr_b16 a[198:199],v16 offset:57608
s_waitcnt lgkmcnt(8)
v_mfma_f32_16x16x32_bf16 v[84:87],a[212:215],a[12:15],v[84:87]
s_add_u32 s40,s40,s41
ds_read_b64_tr_b16 a[200:201],v17 offset:49408
v_mfma_f32_16x16x32_bf16 v[148:151],a[212:215],a[16:19],v[148:151]
v_add_u32 v16,s44,v16
v_mfma_f32_16x16x32_bf16 v[212:215],a[212:215],a[20:23],v[212:215]
ds_read_b64_tr_b16 a[202:203],v17 offset:57600
s_waitcnt lgkmcnt(8)
v_mfma_f32_16x16x32_bf16 v[88:91],a[216:219],a[12:15],v[88:91]
s_add_u32 s42,s42,128
ds_read_b64_tr_b16 a[204:205],v17 offset:49416
v_mfma_f32_16x16x32_bf16 v[152:155],a[216:219],a[16:19],v[152:155]
v_mfma_f32_16x16x32_bf16 v[216:219],a[216:219],a[20:23],v[216:219]
ds_read_b64_tr_b16 a[206:207],v17 offset:57608
s_waitcnt lgkmcnt(8)
v_mfma_f32_16x16x32_bf16 v[92:95],a[220:223],a[12:15],v[92:95]
s_add_u32 s43,s43,s45
ds_read_b64_tr_b16 a[208:209],v18 offset:49408
v_mfma_f32_16x16x32_bf16 v[156:159],a[220:223],a[16:19],v[156:159]
v_add_u32 v17,s44,v17
v_mfma_f32_16x16x32_bf16 v[220:223],a[220:223],a[20:23],v[220:223]
ds_read_b64_tr_b16 a[210:211],v18 offset:57600
s_waitcnt lgkmcnt(8)
v_mfma_f32_16x16x32_bf16 v[96:99],a[192:195],a[12:15],v[96:99]
s_add_u32 s36,s36,1
ds_read_b64_tr_b16 a[212:213],v18 offset:49416
v_mfma_f32_16x16x32_bf16 v[160:163],a[192:195],a[16:19],v[160:163]
v_mfma_f32_16x16x32_bf16 v[224:227],a[192:195],a[20:23],v[224:227]
ds_read_b64_tr_b16 a[214:215],v18 offset:57608
s_waitcnt lgkmcnt(8)
v_mfma_f32_16x16x32_bf16 v[100:103],a[196:199],a[12:15],v[100:103]
ds_read_b64_tr_b16 a[216:217],v19 offset:49408
v_mfma_f32_16x16x32_bf16 v[164:167],a[196:199],a[16:19],v[164:167]
s_waitcnt vmcnt(18)
ds_read_b128 a[0:3],v44 offset:0
v_mfma_f32_16x16x32_bf16 v[228:231],a[196:199],a[20:23],v[228:231]
ds_read_b64_tr_b16 a[218:219],v19 offset:57600
s_waitcnt lgkmcnt(9)
v_mfma_f32_16x16x32_bf16 v[104:107],a[200:203],a[12:15],v[104:107]
ds_read_b64_tr_b16 a[220:221],v19 offset:49416
v_mfma_f32_16x16x32_bf16 v[168:171],a[200:203],a[16:19],v[168:171]
ds_read_b128 a[4:7],v44 offset:2048
ds_read_b128 a[8:11],v44 offset:4096
v_mfma_f32_16x16x32_bf16 v[232:235],a[200:203],a[20:23],v[232:235]
ds_read_b64_tr_b16 a[222:223],v19 offset:57608
s_waitcnt lgkmcnt(11)
v_mfma_f32_16x16x32_bf16 v[108:111],a[204:207],a[12:15],v[108:111]
ds_read_b64_tr_b16 a[192:193],v16 offset:0
v_mfma_f32_16x16x32_bf16 v[172:175],a[204:207],a[16:19],v[172:175]
v_subrev_u32 v44,s45,v44
v_mfma_f32_16x16x32_bf16 v[236:239],a[204:207],a[20:23],v[236:239]
ds_read_b64_tr_b16 a[194:195],v16 offset:8192
s_waitcnt lgkmcnt(11)
v_mfma_f32_16x16x32_bf16 v[112:115],a[208:211],a[12:15],v[112:115]
ds_read_b64_tr_b16 a[196:197],v16 offset:8
v_mfma_f32_16x16x32_bf16 v[176:179],a[208:211],a[16:19],v[176:179]
s_sub_u32 s45,0,s45
v_add_u32 v18,s44,v18
v_mfma_f32_16x16x32_bf16 v[240:243],a[208:211],a[20:23],v[240:243]
ds_read_b64_tr_b16 a[198:199],v16 offset:8200
s_waitcnt lgkmcnt(11)
v_mfma_f32_16x16x32_bf16 v[116:119],a[212:215],a[12:15],v[116:119]
ds_read_b64_tr_b16 a[200:201],v17 offset:0
v_mfma_f32_16x16x32_bf16 v[180:183],a[212:215],a[16:19],v[180:183]
v_add_u32 v19,s44,v19
v_mfma_f32_16x16x32_bf16 v[244:247],a[212:215],a[20:23],v[244:247]
ds_read_b64_tr_b16 a[202:203],v17 offset:8192
s_waitcnt lgkmcnt(10)
v_mfma_f32_16x16x32_bf16 v[120:123],a[216:219],a[12:15],v[120:123]
ds_read_b64_tr_b16 a[204:205],v17 offset:8
v_mfma_f32_16x16x32_bf16 v[184:187],a[216:219],a[16:19],v[184:187]
v_mfma_f32_16x16x32_bf16 v[248:251],a[216:219],a[20:23],v[248:251]
ds_read_b64_tr_b16 a[206:207],v17 offset:8200
s_waitcnt lgkmcnt(8)
v_mfma_f32_16x16x32_bf16 v[124:127],a[220:223],a[12:15],v[124:127]
ds_read_b64_tr_b16 a[208:209],v18 offset:0
v_mfma_f32_16x16x32_bf16 v[188:191],a[220:223],a[16:19],v[188:191]
v_mfma_f32_16x16x32_bf16 v[252:255],a[220:223],a[20:23],v[252:255]
ds_read_b64_tr_b16 a[210:211],v18 offset:8192
s_waitcnt lgkmcnt(8)
s_cmp_lt_u32 s36,7
s_cbranch_scc1 QLOOP_A
v_pk_mul_f32 v[64:65],s[60:61],v[64:65]
v_pk_mul_f32 v[66:67],s[60:61],v[66:67]
v_pk_mul_f32 v[68:69],s[60:61],v[68:69]
v_pk_mul_f32 v[70:71],s[60:61],v[70:71]
v_cvt_pk_bf16_f32 v16,v64,v65
v_cvt_pk_bf16_f32 v17,v66,v67
v_cvt_pk_bf16_f32 v18,v68,v69
v_cvt_pk_bf16_f32 v19,v70,v71
v_pk_mul_f32 v[72:73],s[60:61],v[72:73]
v_pk_mul_f32 v[74:75],s[60:61],v[74:75]
v_pk_mul_f32 v[76:77],s[60:61],v[76:77]
v_pk_mul_f32 v[78:79],s[60:61],v[78:79]
v_cvt_pk_bf16_f32 v20,v72,v73
v_cvt_pk_bf16_f32 v21,v74,v75
v_cvt_pk_bf16_f32 v22,v76,v77
v_cvt_pk_bf16_f32 v23,v78,v79
v_pk_mul_f32 v[80:81],s[60:61],v[80:81]
v_pk_mul_f32 v[82:83],s[60:61],v[82:83]
v_pk_mul_f32 v[84:85],s[60:61],v[84:85]
v_pk_mul_f32 v[86:87],s[60:61],v[86:87]
v_cvt_pk_bf16_f32 v24,v80,v81
v_cvt_pk_bf16_f32 v25,v82,v83
v_cvt_pk_bf16_f32 v26,v84,v85
v_cvt_pk_bf16_f32 v27,v86,v87
v_pk_mul_f32 v[88:89],s[60:61],v[88:89]
v_pk_mul_f32 v[90:91],s[60:61],v[90:91]
v_pk_mul_f32 v[92:93],s[60:61],v[92:93]
v_pk_mul_f32 v[94:95],s[60:61],v[94:95]
v_cvt_pk_bf16_f32 v28,v88,v89
v_cvt_pk_bf16_f32 v29,v90,v91
v_cvt_pk_bf16_f32 v30,v92,v93
v_cvt_pk_bf16_f32 v31,v94,v95
v_pk_mul_f32 v[96:97],s[60:61],v[96:97]
v_pk_mul_f32 v[98:99],s[60:61],v[98:99]
v_pk_mul_f32 v[100:101],s[60:61],v[100:101]
v_pk_mul_f32 v[102:103],s[60:61],v[102:103]
v_cvt_pk_bf16_f32 v32,v96,v97
v_cvt_pk_bf16_f32 v33,v98,v99
v_cvt_pk_bf16_f32 v34,v100,v101
v_cvt_pk_bf16_f32 v35,v102,v103
v_pk_mul_f32 v[104:105],s[60:61],v[104:105]
v_pk_mul_f32 v[106:107],s[60:61],v[106:107]
v_pk_mul_f32 v[108:109],s[60:61],v[108:109]
v_pk_mul_f32 v[110:111],s[60:61],v[110:111]
v_cvt_pk_bf16_f32 v36,v104,v105
v_cvt_pk_bf16_f32 v37,v106,v107
v_cvt_pk_bf16_f32 v38,v108,v109
v_cvt_pk_bf16_f32 v39,v110,v111
v_pk_mul_f32 v[112:113],s[60:61],v[112:113]
v_pk_mul_f32 v[114:115],s[60:61],v[114:115]
v_pk_mul_f32 v[116:117],s[60:61],v[116:117]
v_pk_mul_f32 v[118:119],s[60:61],v[118:119]
v_cvt_pk_bf16_f32 v40,v112,v113
v_cvt_pk_bf16_f32 v41,v114,v115
v_cvt_pk_bf16_f32 v42,v116,v117
v_cvt_pk_bf16_f32 v43,v118,v119
v_pk_mul_f32 v[120:121],s[60:61],v[120:121]
v_pk_mul_f32 v[122:123],s[60:61],v[122:123]
v_pk_mul_f32 v[124:125],s[60:61],v[124:125]
v_pk_mul_f32 v[126:127],s[60:61],v[126:127]
v_cvt_pk_bf16_f32 v44,v120,v121
v_cvt_pk_bf16_f32 v45,v122,v123
v_cvt_pk_bf16_f32 v46,v124,v125
v_cvt_pk_bf16_f32 v47,v126,v127
v_pk_mul_f32 v[128:129],s[60:61],v[128:129]
v_pk_mul_f32 v[130:131],s[60:61],v[130:131]
v_pk_mul_f32 v[132:133],s[60:61],v[132:133]
v_pk_mul_f32 v[134:135],s[60:61],v[134:135]
v_cvt_pk_bf16_f32 v48,v128,v129
v_cvt_pk_bf16_f32 v49,v130,v131
v_cvt_pk_bf16_f32 v50,v132,v133
v_cvt_pk_bf16_f32 v51,v134,v135
v_pk_mul_f32 v[136:137],s[60:61],v[136:137]
v_pk_mul_f32 v[138:139],s[60:61],v[138:139]
v_pk_mul_f32 v[140:141],s[60:61],v[140:141]
v_pk_mul_f32 v[142:143],s[60:61],v[142:143]
v_cvt_pk_bf16_f32 v52,v136,v137
v_cvt_pk_bf16_f32 v53,v138,v139
v_cvt_pk_bf16_f32 v54,v140,v141
v_cvt_pk_bf16_f32 v55,v142,v143
v_pk_mul_f32 v[144:145],s[60:61],v[144:145]
v_pk_mul_f32 v[146:147],s[60:61],v[146:147]
v_pk_mul_f32 v[148:149],s[60:61],v[148:149]
v_pk_mul_f32 v[150:151],s[60:61],v[150:151]
v_cvt_pk_bf16_f32 v56,v144,v145
v_cvt_pk_bf16_f32 v57,v146,v147
v_cvt_pk_bf16_f32 v58,v148,v149
v_cvt_pk_bf16_f32 v59,v150,v151
v_pk_mul_f32 v[152:153],s[60:61],v[152:153]
v_pk_mul_f32 v[154:155],s[60:61],v[154:155]
v_pk_mul_f32 v[156:157],s[60:61],v[156:157]
v_pk_mul_f32 v[158:159],s[60:61],v[158:159]
v_cvt_pk_bf16_f32 v60,v152,v153
v_cvt_pk_bf16_f32 v61,v154,v155
v_cvt_pk_bf16_f32 v62,v156,v157
v_cvt_pk_bf16_f32 v63,v158,v159
v_pk_mul_f32 v[160:161],s[60:61],v[160:161]
v_pk_mul_f32 v[162:163],s[60:61],v[162:163]
v_pk_mul_f32 v[164:165],s[60:61],v[164:165]
v_pk_mul_f32 v[166:167],s[60:61],v[166:167]
v_cvt_pk_bf16_f32 v64,v160,v161
v_cvt_pk_bf16_f32 v65,v162,v163
v_cvt_pk_bf16_f32 v66,v164,v165
v_cvt_pk_bf16_f32 v67,v166,v167
v_pk_mul_f32 v[168:169],s[60:61],v[168:169]
v_pk_mul_f32 v[170:171],s[60:61],v[170:171]
v_pk_mul_f32 v[172:173],s[60:61],v[172:173]
v_pk_mul_f32 v[174:175],s[60:61],v[174:175]
v_cvt_pk_bf16_f32 v68,v168,v169
v_cvt_pk_bf16_f32 v69,v170,v171
v_cvt_pk_bf16_f32 v70,v172,v173
v_cvt_pk_bf16_f32 v71,v174,v175
v_pk_mul_f32 v[176:177],s[60:61],v[176:177]
v_pk_mul_f32 v[178:179],s[60:61],v[178:179]
v_pk_mul_f32 v[180:181],s[60:61],v[180:181]
v_pk_mul_f32 v[182:183],s[60:61],v[182:183]
v_cvt_pk_bf16_f32 v72,v176,v177
v_cvt_pk_bf16_f32 v73,v178,v179
v_cvt_pk_bf16_f32 v74,v180,v181
v_cvt_pk_bf16_f32 v75,v182,v183
v_pk_mul_f32 v[184:185],s[60:61],v[184:185]
v_pk_mul_f32 v[186:187],s[60:61],v[186:187]
v_pk_mul_f32 v[188:189],s[60:61],v[188:189]
v_pk_mul_f32 v[190:191],s[60:61],v[190:191]
v_cvt_pk_bf16_f32 v76,v184,v185
v_cvt_pk_bf16_f32 v77,v186,v187
v_cvt_pk_bf16_f32 v78,v188,v189
v_cvt_pk_bf16_f32 v79,v190,v191
v_pk_mul_f32 v[192:193],s[60:61],v[192:193]
v_pk_mul_f32 v[194:195],s[60:61],v[194:195]
v_pk_mul_f32 v[196:197],s[60:61],v[196:197]
v_pk_mul_f32 v[198:199],s[60:61],v[198:199]
v_cvt_pk_bf16_f32 v80,v192,v193
v_cvt_pk_bf16_f32 v81,v194,v195
v_cvt_pk_bf16_f32 v82,v196,v197
v_cvt_pk_bf16_f32 v83,v198,v199
v_pk_mul_f32 v[200:201],s[60:61],v[200:201]
v_pk_mul_f32 v[202:203],s[60:61],v[202:203]
v_pk_mul_f32 v[204:205],s[60:61],v[204:205]
v_pk_mul_f32 v[206:207],s[60:61],v[206:207]
v_cvt_pk_bf16_f32 v84,v200,v201
v_cvt_pk_bf16_f32 v85,v202,v203
v_cvt_pk_bf16_f32 v86,v204,v205
v_cvt_pk_bf16_f32 v87,v206,v207
v_pk_mul_f32 v[208:209],s[60:61],v[208:209]
v_pk_mul_f32 v[210:211],s[60:61],v[210:211]
v_pk_mul_f32 v[212:213],s[60:61],v[212:213]
v_pk_mul_f32 v[214:215],s[60:61],v[214:215]
v_cvt_pk_bf16_f32 v88,v208,v209
v_cvt_pk_bf16_f32 v89,v210,v211
v_cvt_pk_bf16_f32 v90,v212,v213
v_cvt_pk_bf16_f32 v91,v214,v215
s_waitcnt lgkmcnt(0)
ds_read_b128 a[192:195],v0 offset:0
ds_read_b128 a[196:199],v1 offset:0
ds_read_b128 a[200:203],v2 offset:0
ds_read_b128 a[204:207],v3 offset:0
ds_read_b128 a[208:211],v0 offset:256
ds_read_b128 a[212:215],v1 offset:256
ds_read_b128 a[216:219],v2 offset:256
ds_read_b128 a[220:223],v3 offset:256
v_pk_mul_f32 v[216:217],s[60:61],v[216:217]
v_pk_mul_f32 v[218:219],s[60:61],v[218:219]
v_pk_mul_f32 v[220:221],s[60:61],v[220:221]
v_pk_mul_f32 v[222:223],s[60:61],v[222:223]
v_cvt_pk_bf16_f32 v92,v216,v217
v_cvt_pk_bf16_f32 v93,v218,v219
v_cvt_pk_bf16_f32 v94,v220,v221
v_cvt_pk_bf16_f32 v95,v222,v223
v_pk_mul_f32 v[224:225],s[60:61],v[224:225]
v_pk_mul_f32 v[226:227],s[60:61],v[226:227]
v_pk_mul_f32 v[228:229],s[60:61],v[228:229]
v_pk_mul_f32 v[230:231],s[60:61],v[230:231]
v_cvt_pk_bf16_f32 v96,v224,v225
v_cvt_pk_bf16_f32 v97,v226,v227
v_cvt_pk_bf16_f32 v98,v228,v229
v_cvt_pk_bf16_f32 v99,v230,v231
v_pk_mul_f32 v[232:233],s[60:61],v[232:233]
v_pk_mul_f32 v[234:235],s[60:61],v[234:235]
v_pk_mul_f32 v[236:237],s[60:61],v[236:237]
v_pk_mul_f32 v[238:239],s[60:61],v[238:239]
v_cvt_pk_bf16_f32 v100,v232,v233
v_cvt_pk_bf16_f32 v101,v234,v235
v_cvt_pk_bf16_f32 v102,v236,v237
v_cvt_pk_bf16_f32 v103,v238,v239
v_pk_mul_f32 v[240:241],s[60:61],v[240:241]
v_pk_mul_f32 v[242:243],s[60:61],v[242:243]
v_pk_mul_f32 v[244:245],s[60:61],v[244:245]
v_pk_mul_f32 v[246:247],s[60:61],v[246:247]
v_cvt_pk_bf16_f32 v104,v240,v241
v_cvt_pk_bf16_f32 v105,v242,v243
v_cvt_pk_bf16_f32 v106,v244,v245
v_cvt_pk_bf16_f32 v107,v246,v247
v_pk_mul_f32 v[248:249],s[60:61],v[248:249]
v_pk_mul_f32 v[250:251],s[60:61],v[250:251]
v_pk_mul_f32 v[252:253],s[60:61],v[252:253]
v_pk_mul_f32 v[254:255],s[60:61],v[254:255]
v_cvt_pk_bf16_f32 v108,v248,v249
v_cvt_pk_bf16_f32 v109,v250,v251
v_cvt_pk_bf16_f32 v110,v252,v253
v_cvt_pk_bf16_f32 v111,v254,v255
v_mov_b32 v208,0x7f800000
v_mov_b32 v212,0x7f800000
v_mov_b32 v216,0x7f800000
PRE_A:
s_waitcnt lgkmcnt(3)
v_mfma_f32_16x16x32_bf16 v[112:115],a[192:195],v[16:19],0
ds_read_b128 a[224:227],v0 offset:8192
v_mov_b32 v232,0x3f803f80
v_mfma_f32_16x16x32_bf16 v[112:115],a[196:199],v[20:23],v[112:115]
v_mov_b32 v233,0x3f803f80
v_mov_b32 v234,0x3f803f80
v_mfma_f32_16x16x32_bf16 v[112:115],a[200:203],v[24:27],v[112:115]
v_mov_b32 v235,0x3f803f80
v_mbcnt_lo_u32_b32 v253,-1,0
v_mfma_f32_16x16x32_bf16 v[112:115],a[204:207],v[28:31],v[112:115]
ds_read_b128 a[228:231],v1 offset:8192
v_mbcnt_hi_u32_b32 v253,-1,v253
v_mfma_f32_16x16x32_bf16 v[112:115],a[208:211],v[32:35],v[112:115]
s_lshl_b32 s31,s24,11
s_waitcnt lgkmcnt(2)
v_mfma_f32_16x16x32_bf16 v[112:115],a[212:215],v[36:39],v[112:115]
s_add_u32 s31,s31,147456
v_lshl_add_u32 v250,v253,4,s31
v_mfma_f32_16x16x32_bf16 v[112:115],a[216:219],v[40:43],v[112:115]
ds_read_b128 a[232:235],v2 offset:8192
s_add_u32 s26,s25,32768
v_mfma_f32_16x16x32_bf16 v[112:115],a[220:223],v[44:47],v[112:115]
v_mfma_f32_16x16x32_bf16 v[128:131],a[192:195],v[48:51],0
v_mfma_f32_16x16x32_bf16 v[128:131],a[196:199],v[52:55],v[128:131]
ds_read_b128 a[236:239],v3 offset:8192
v_mfma_f32_16x16x32_bf16 v[128:131],a[200:203],v[56:59],v[128:131]
v_mfma_f32_16x16x32_bf16 v[128:131],a[204:207],v[60:63],v[128:131]
v_mfma_f32_16x16x32_bf16 v[128:131],a[208:211],v[64:67],v[128:131]
ds_read_b128 a[240:243],v0 offset:8448
v_mfma_f32_16x16x32_bf16 v[128:131],a[212:215],v[68:71],v[128:131]
v_mfma_f32_16x16x32_bf16 v[128:131],a[216:219],v[72:75],v[128:131]
v_max3_f32 v184,-v208,v112,v113
v_max3_f32 v184,v184,v114,v115
v_mfma_f32_16x16x32_bf16 v[128:131],a[220:223],v[76:79],v[128:131]
ds_read_b128 a[244:247],v1 offset:8448
v_mov_b32 v188,v184
v_mfma_f32_16x16x32_bf16 v[144:147],a[192:195],v[80:83],0
v_mfma_f32_16x16x32_bf16 v[144:147],a[196:199],v[84:87],v[144:147]
v_permlane32_swap_b32 v184,v188
v_mfma_f32_16x16x32_bf16 v[144:147],a[200:203],v[88:91],v[144:147]
ds_read_b128 a[248:251],v2 offset:8448
v_mfma_f32_16x16x32_bf16 v[144:147],a[204:207],v[92:95],v[144:147]
v_max_f32 v184,v184,v188
v_mov_b32 v188,v184
v_mfma_f32_16x16x32_bf16 v[144:147],a[208:211],v[96:99],v[144:147]
v_mfma_f32_16x16x32_bf16 v[144:147],a[212:215],v[100:103],v[144:147]
ds_read_b128 a[252:255],v3 offset:8448
v_permlane16_swap_b32 v184,v188
v_mfma_f32_16x16x32_bf16 v[144:147],a[216:219],v[104:107],v[144:147]
v_max3_f32 v185,-v212,v128,v129
v_max3_f32 v185,v185,v130,v131
v_mfma_f32_16x16x32_bf16 v[144:147],a[220:223],v[108:111],v[144:147]
v_max_f32 v184,v184,v188
s_waitcnt lgkmcnt(2)
v_mfma_f32_16x16x32_bf16 v[116:119],a[224:227],v[16:19],0
ds_read_b128 a[192:195],v0 offset:16384
v_sub_f32 v208,0,v184
v_mfma_f32_16x16x32_bf16 v[116:119],a[228:231],v[20:23],v[116:119]
v_sub_f32 v209,0,v184
v_sub_f32 v210,0,v184
v_mfma_f32_16x16x32_bf16 v[116:119],a[232:235],v[24:27],v[116:119]
v_sub_f32 v211,0,v184
v_mov_b32 v189,v185
v_mfma_f32_16x16x32_bf16 v[116:119],a[236:239],v[28:31],v[116:119]
ds_read_b128 a[196:199],v1 offset:16384
v_add_f32 v112,v112,v208
v_mfma_f32_16x16x32_bf16 v[116:119],a[240:243],v[32:35],v[116:119]
v_permlane32_swap_b32 v185,v189
v_mfma_f32_16x16x32_bf16 v[116:119],a[244:247],v[36:39],v[116:119]
s_waitcnt lgkmcnt(2)
v_mfma_f32_16x16x32_bf16 v[116:119],a[248:251],v[40:43],v[116:119]
ds_read_b128 a[200:203],v2 offset:16384
v_max_f32 v185,v185,v189
v_mfma_f32_16x16x32_bf16 v[116:119],a[252:255],v[44:47],v[116:119]
v_mov_b32 v189,v185
v_max3_f32 v186,-v216,v144,v145
v_mfma_f32_16x16x32_bf16 v[132:135],a[224:227],v[48:51],0
v_max3_f32 v186,v186,v146,v147
v_mov_b32 v190,v186
v_mfma_f32_16x16x32_bf16 v[132:135],a[228:231],v[52:55],v[132:135]
ds_read_b128 a[204:207],v3 offset:16384
v_permlane16_swap_b32 v185,v189
v_mfma_f32_16x16x32_bf16 v[132:135],a[232:235],v[56:59],v[132:135]
v_permlane32_swap_b32 v186,v190
v_add_f32 v113,v113,v208
v_mfma_f32_16x16x32_bf16 v[132:135],a[236:239],v[60:63],v[132:135]
v_max_f32 v185,v185,v189
v_sub_f32 v212,0,v185
v_mfma_f32_16x16x32_bf16 v[132:135],a[240:243],v[64:67],v[132:135]
ds_read_b128 a[208:211],v0 offset:16640
v_sub_f32 v213,0,v185
v_mfma_f32_16x16x32_bf16 v[132:135],a[244:247],v[68:71],v[132:135]
v_sub_f32 v214,0,v185
v_sub_f32 v215,0,v185
v_mfma_f32_16x16x32_bf16 v[132:135],a[248:251],v[72:75],v[132:135]
v_max_f32 v186,v186,v190
v_mov_b32 v190,v186
v_mfma_f32_16x16x32_bf16 v[132:135],a[252:255],v[76:79],v[132:135]
ds_read_b128 a[212:215],v1 offset:16640
v_add_f32 v114,v114,v208
v_mfma_f32_16x16x32_bf16 v[148:151],a[224:227],v[80:83],0
v_permlane16_swap_b32 v186,v190
v_add_f32 v115,v115,v208
v_mfma_f32_16x16x32_bf16 v[148:151],a[228:231],v[84:87],v[148:151]
v_exp_f32 v112,v112
v_mfma_f32_16x16x32_bf16 v[148:151],a[232:235],v[88:91],v[148:151]
ds_read_b128 a[216:219],v2 offset:16640
v_max_f32 v186,v186,v190
v_mfma_f32_16x16x32_bf16 v[148:151],a[236:239],v[92:95],v[148:151]
v_sub_f32 v216,0,v186
v_sub_f32 v217,0,v186
v_mfma_f32_16x16x32_bf16 v[148:151],a[240:243],v[96:99],v[148:151]
ds_read_b128 a[220:223],v3 offset:16640
v_sub_f32 v218,0,v186
v_mfma_f32_16x16x32_bf16 v[148:151],a[244:247],v[100:103],v[148:151]
v_sub_f32 v219,0,v186
v_mfma_f32_16x16x32_bf16 v[148:151],a[248:251],v[104:107],v[148:151]
v_exp_f32 v113,v113
v_mfma_f32_16x16x32_bf16 v[148:151],a[252:255],v[108:111],v[148:151]
ds_read_b128 a[224:227],v0 offset:24576
s_waitcnt lgkmcnt(3)
v_mfma_f32_16x16x32_bf16 v[120:123],a[192:195],v[16:19],v[208:211]
v_cvt_pk_bf16_f32 v160,v112,v113
v_add_f32 v128,v128,v212
v_mfma_f32_16x16x32_bf16 v[120:123],a[196:199],v[20:23],v[120:123]
v_exp_f32 v114,v114
v_mfma_f32_16x16x32_bf16 v[120:123],a[200:203],v[24:27],v[120:123]
ds_read_b128 a[228:231],v1 offset:24576
v_add_f32 v129,v129,v212
v_mfma_f32_16x16x32_bf16 v[120:123],a[204:207],v[28:31],v[120:123]
v_exp_f32 v115,v115
v_mfma_f32_16x16x32_bf16 v[120:123],a[208:211],v[32:35],v[120:123]
v_cvt_pk_bf16_f32 v161,v114,v115
v_add_f32 v130,v130,v212
v_mfma_f32_16x16x32_bf16 v[120:123],a[212:215],v[36:39],v[120:123]
ds_read_b128 a[232:235],v2 offset:24576
s_waitcnt lgkmcnt(3)
v_mfma_f32_16x16x32_bf16 v[120:123],a[216:219],v[40:43],v[120:123]
v_exp_f32 v128,v128
v_mfma_f32_16x16x32_bf16 v[120:123],a[220:223],v[44:47],v[120:123]
v_exp_f32 v129,v129
v_mfma_f32_16x16x32_bf16 v[136:139],a[192:195],v[48:51],v[212:215]
ds_read_b128 a[236:239],v3 offset:24576
v_cvt_pk_bf16_f32 v176,v128,v129
v_mfma_f32_16x16x32_bf16 v[136:139],a[196:199],v[52:55],v[136:139]
v_exp_f32 v130,v130
v_mfma_f32_16x16x32_bf16 v[136:139],a[200:203],v[56:59],v[136:139]
v_add_f32 v131,v131,v212
v_add_f32 v149,v149,v216
v_mfma_f32_16x16x32_bf16 v[136:139],a[204:207],v[60:63],v[136:139]
ds_read_b128 a[240:243],v0 offset:24832
v_add_f32 v144,v144,v216
v_mfma_f32_16x16x32_bf16 v[136:139],a[208:211],v[64:67],v[136:139]
v_exp_f32 v131,v131
v_mfma_f32_16x16x32_bf16 v[136:139],a[212:215],v[68:71],v[136:139]
v_cvt_pk_bf16_f32 v177,v130,v131
v_add_f32 v145,v145,v216
v_mfma_f32_16x16x32_bf16 v[136:139],a[216:219],v[72:75],v[136:139]
ds_read_b128 a[244:247],v1 offset:24832
v_add_f32 v146,v146,v216
v_mfma_f32_16x16x32_bf16 v[136:139],a[220:223],v[76:79],v[136:139]
v_exp_f32 v144,v144
v_mfma_f32_16x16x32_bf16 v[152:155],a[192:195],v[80:83],v[216:219]
v_exp_f32 v145,v145
v_mfma_f32_16x16x32_bf16 v[152:155],a[196:199],v[84:87],v[152:155]
ds_read_b128 a[248:251],v2 offset:24832
v_cvt_pk_bf16_f32 v192,v144,v145
v_mfma_f32_16x16x32_bf16 v[152:155],a[200:203],v[88:91],v[152:155]
v_exp_f32 v146,v146
v_mfma_f32_16x16x32_bf16 v[152:155],a[204:207],v[92:95],v[152:155]
v_add_f32 v147,v147,v216
v_add_f32 v116,v116,v208
v_mfma_f32_16x16x32_bf16 v[152:155],a[208:211],v[96:99],v[152:155]
ds_read_b128 a[252:255],v3 offset:24832
v_add_f32 v148,v148,v216
v_mfma_f32_16x16x32_bf16 v[152:155],a[212:215],v[100:103],v[152:155]
v_exp_f32 v147,v147
v_mfma_f32_16x16x32_bf16 v[152:155],a[216:219],v[104:107],v[152:155]
v_cvt_pk_bf16_f32 v193,v146,v147
v_add_f32 v117,v117,v208
v_mfma_f32_16x16x32_bf16 v[152:155],a[220:223],v[108:111],v[152:155]
v_add_f32 v118,v118,v208
s_waitcnt lgkmcnt(2)
v_mfma_f32_16x16x32_bf16 v[124:127],a[224:227],v[16:19],v[208:211]
v_exp_f32 v116,v116
v_mfma_f32_16x16x32_bf16 v[124:127],a[228:231],v[20:23],v[124:127]
v_exp_f32 v117,v117
v_mfma_f32_16x16x32_bf16 v[124:127],a[232:235],v[24:27],v[124:127]
s_waitcnt lgkmcnt(0)
s_waitcnt vmcnt(0)
s_barrier
v_mfma_f32_16x16x32_bf16 v[124:127],a[236:239],v[28:31],v[124:127]
ds_read_b128 a[192:195],v0 offset:32768
s_add_u32 m0,s25,0
v_mfma_f32_16x16x32_bf16 v[124:127],a[240:243],v[32:35],v[124:127]
s_add_u32 s28,s25,65536
v_cvt_pk_bf16_f32 v162,v116,v117
v_mfma_f32_16x16x32_bf16 v[124:127],a[244:247],v[36:39],v[124:127]
v_add_f32 v119,v119,v208
s_waitcnt lgkmcnt(1)
v_mfma_f32_16x16x32_bf16 v[124:127],a[248:251],v[40:43],v[124:127]
ds_read_b128 a[196:199],v1 offset:32768
v_add_f32 v132,v132,v212
v_mfma_f32_16x16x32_bf16 v[124:127],a[252:255],v[44:47],v[124:127]
buffer_load_dwordx4 v12,s[4:7],s28 offen nt lds
v_mfma_f32_16x16x32_bf16 v[140:143],a[224:227],v[48:51],v[212:215]
ds_read_b128 a[200:203],v2 offset:32768
v_add_f32 v133,v133,v212
v_mfma_f32_16x16x32_bf16 v[140:143],a[228:231],v[52:55],v[140:143]
buffer_load_dwordx4 v13,s[4:7],s28 offen offset:1024 nt lds
v_mfma_f32_16x16x32_bf16 v[140:143],a[232:235],v[56:59],v[140:143]
buffer_load_dwordx4 v14,s[4:7],s28 offen offset:2048 nt lds
v_mfma_f32_16x16x32_bf16 v[140:143],a[236:239],v[60:63],v[140:143]
ds_read_b128 a[204:207],v3 offset:32768
v_add_f32 v134,v134,v212
v_mfma_f32_16x16x32_bf16 v[140:143],a[240:243],v[64:67],v[140:143]
buffer_load_dwordx4 v15,s[4:7],s28 offen offset:3072 nt lds
v_mfma_f32_16x16x32_bf16 v[140:143],a[244:247],v[68:71],v[140:143]
v_exp_f32 v118,v118
v_mfma_f32_16x16x32_bf16 v[140:143],a[248:251],v[72:75],v[140:143]
ds_read_b128 a[208:211],v0 offset:33024
v_add_f32 v135,v135,v212
v_mfma_f32_16x16x32_bf16 v[140:143],a[252:255],v[76:79],v[140:143]
v_exp_f32 v119,v119
v_mfma_f32_16x16x32_bf16 v[156:159],a[224:227],v[80:83],v[216:219]
ds_read_b128 a[212:215],v1 offset:33024
v_cvt_pk_bf16_f32 v163,v118,v119
v_mfma_f32_16x16x32_bf16 v[156:159],a[228:231],v[84:87],v[156:159]
v_exp_f32 v132,v132
v_mfma_f32_16x16x32_bf16 v[156:159],a[232:235],v[88:91],v[156:159]
v_exp_f32 v133,v133
v_add_f32 v151,v151,v216
v_mfma_f32_16x16x32_bf16 v[156:159],a[236:239],v[92:95],v[156:159]
ds_read_b128 a[216:219],v2 offset:33024
v_cvt_pk_bf16_f32 v178,v132,v133
v_exp_f32 v148,v148
v_mfma_f32_16x16x32_bf16 v[156:159],a[240:243],v[96:99],v[156:159]
v_exp_f32 v134,v134
v_exp_f32 v149,v149
v_mfma_f32_16x16x32_bf16 v[156:159],a[244:247],v[100:103],v[156:159]
v_exp_f32 v135,v135
v_add_f32 v150,v150,v216
v_exp_f32 v151,v151
v_mfma_f32_16x16x32_bf16 v[156:159],a[248:251],v[104:107],v[156:159]
ds_read_b128 a[220:223],v3 offset:33024
v_cvt_pk_bf16_f32 v179,v134,v135
v_exp_f32 v150,v150
v_mfma_f32_16x16x32_bf16 v[156:159],a[252:255],v[108:111],v[156:159]
v_cvt_pk_bf16_f32 v194,v148,v149
v_cvt_pk_bf16_f32 v195,v150,v151
M0_A:
s_waitcnt lgkmcnt(2)
v_mfma_f32_16x16x32_bf16 v[112:115],a[192:195],v[16:19],v[208:211]
ds_read_b128 a[224:227],v0 offset:40960
v_mfma_f32_16x16x32_bf16 v[112:115],a[196:199],v[20:23],v[112:115]
v_exp_f32 v120,v120
v_mfma_f32_16x16x32_bf16 v[112:115],a[200:203],v[24:27],v[112:115]
v_exp_f32 v121,v121
v_mfma_f32_16x16x32_bf16 v[112:115],a[204:207],v[28:31],v[112:115]
ds_read_b128 a[228:231],v1 offset:40960
v_cvt_pk_bf16_f32 v164,v120,v121
v_mfma_f32_16x16x32_bf16 v[112:115],a[208:211],v[32:35],v[112:115]
v_exp_f32 v122,v122
v_mfma_f32_16x16x32_bf16 v[112:115],a[212:215],v[36:39],v[112:115]
s_waitcnt lgkmcnt(2)
v_mfma_f32_16x16x32_bf16 v[112:115],a[216:219],v[40:43],v[112:115]
ds_read_b128 a[232:235],v2 offset:40960
v_mfma_f32_16x16x32_bf16 v[112:115],a[220:223],v[44:47],v[112:115]
v_exp_f32 v123,v123
v_mfma_f32_16x16x32_bf16 v[128:131],a[192:195],v[48:51],v[212:215]
v_cvt_pk_bf16_f32 v165,v122,v123
v_mfma_f32_16x16x32_bf16 v[128:131],a[196:199],v[52:55],v[128:131]
ds_read_b128 a[236:239],v3 offset:40960
v_mfma_f32_16x16x32_bf16 v[128:131],a[200:203],v[56:59],v[128:131]
v_exp_f32 v136,v136
v_mfma_f32_16x16x32_bf16 v[128:131],a[204:207],v[60:63],v[128:131]
v_mfma_f32_16x16x32_bf16 v[128:131],a[208:211],v[64:67],v[128:131]
ds_read_b128 a[240:243],v0 offset:41216
v_mfma_f32_16x16x32_bf16 v[128:131],a[212:215],v[68:71],v[128:131]
v_exp_f32 v137,v137
v_mfma_f32_16x16x32_bf16 v[128:131],a[216:219],v[72:75],v[128:131]
v_cvt_pk_bf16_f32 v180,v136,v137
v_mfma_f32_16x16x32_bf16 v[128:131],a[220:223],v[76:79],v[128:131]
ds_read_b128 a[244:247],v1 offset:41216
v_mfma_f32_16x16x32_bf16 v[144:147],a[192:195],v[80:83],v[216:219]
v_exp_f32 v138,v138
v_mfma_f32_16x16x32_bf16 v[144:147],a[196:199],v[84:87],v[144:147]
v_exp_f32 v139,v139
v_mfma_f32_16x16x32_bf16 v[144:147],a[200:203],v[88:91],v[144:147]
ds_read_b128 a[248:251],v2 offset:41216
v_cvt_pk_bf16_f32 v181,v138,v139
v_mfma_f32_16x16x32_bf16 v[144:147],a[204:207],v[92:95],v[144:147]
v_exp_f32 v152,v152
v_mfma_f32_16x16x32_bf16 v[144:147],a[208:211],v[96:99],v[144:147]
v_mfma_f32_16x16x32_bf16 v[144:147],a[212:215],v[100:103],v[144:147]
ds_read_b128 a[252:255],v3 offset:41216
v_mfma_f32_16x16x32_bf16 v[144:147],a[216:219],v[104:107],v[144:147]
v_exp_f32 v153,v153
v_mfma_f32_16x16x32_bf16 v[144:147],a[220:223],v[108:111],v[144:147]
v_cvt_pk_bf16_f32 v196,v152,v153
s_waitcnt lgkmcnt(2)
v_mfma_f32_16x16x32_bf16 v[116:119],a[224:227],v[16:19],v[208:211]
ds_read_b128 a[192:195],v0 offset:49152
v_mfma_f32_16x16x32_bf16 v[116:119],a[228:231],v[20:23],v[116:119]
v_exp_f32 v154,v154
v_mfma_f32_16x16x32_bf16 v[116:119],a[232:235],v[24:27],v[116:119]
v_exp_f32 v155,v155
v_mfma_f32_16x16x32_bf16 v[116:119],a[236:239],v[28:31],v[116:119]
ds_read_b128 a[196:199],v1 offset:49152
v_cvt_pk_bf16_f32 v197,v154,v155
v_mfma_f32_16x16x32_bf16 v[116:119],a[240:243],v[32:35],v[116:119]
v_exp_f32 v124,v124
v_mfma_f32_16x16x32_bf16 v[116:119],a[244:247],v[36:39],v[116:119]
s_waitcnt lgkmcnt(2)
v_mfma_f32_16x16x32_bf16 v[116:119],a[248:251],v[40:43],v[116:119]
ds_read_b128 a[200:203],v2 offset:49152
v_mfma_f32_16x16x32_bf16 v[116:119],a[252:255],v[44:47],v[116:119]
v_exp_f32 v125,v125
v_mfma_f32_16x16x32_bf16 v[132:135],a[224:227],v[48:51],v[212:215]
v_cvt_pk_bf16_f32 v166,v124,v125
v_mfma_f32_16x16x32_bf16 v[132:135],a[228:231],v[52:55],v[132:135]
ds_read_b128 a[204:207],v3 offset:49152
v_mfma_f32_16x16x32_bf16 v[132:135],a[232:235],v[56:59],v[132:135]
v_exp_f32 v126,v126
v_mfma_f32_16x16x32_bf16 v[132:135],a[236:239],v[60:63],v[132:135]
v_mfma_f32_16x16x32_bf16 v[132:135],a[240:243],v[64:67],v[132:135]
ds_read_b128 a[208:211],v0 offset:49408
v_mfma_f32_16x16x32_bf16 v[132:135],a[244:247],v[68:71],v[132:135]
v_exp_f32 v127,v127
v_mfma_f32_16x16x32_bf16 v[132:135],a[248:251],v[72:75],v[132:135]
v_cvt_pk_bf16_f32 v167,v126,v127
v_mfma_f32_16x16x32_bf16 v[132:135],a[252:255],v[76:79],v[132:135]
ds_read_b128 a[212:215],v1 offset:49408
v_mfma_f32_16x16x32_bf16 v[148:151],a[224:227],v[80:83],v[216:219]
v_exp_f32 v140,v140
v_mfma_f32_16x16x32_bf16 v[148:151],a[228:231],v[84:87],v[148:151]
v_exp_f32 v141,v141
v_mfma_f32_16x16x32_bf16 v[148:151],a[232:235],v[88:91],v[148:151]
ds_read_b128 a[216:219],v2 offset:49408
v_cvt_pk_bf16_f32 v182,v140,v141
v_mfma_f32_16x16x32_bf16 v[148:151],a[236:239],v[92:95],v[148:151]
v_mfma_f32_16x16x32_bf16 v[148:151],a[240:243],v[96:99],v[148:151]
ds_read_b128 a[220:223],v3 offset:49408
v_mfma_f32_16x16x32_bf16 v[148:151],a[244:247],v[100:103],v[148:151]
v_exp_f32 v142,v142
v_mfma_f32_16x16x32_bf16 v[148:151],a[248:251],v[104:107],v[148:151]
v_mfma_f32_16x16x32_bf16 v[148:151],a[252:255],v[108:111],v[148:151]
ds_read_b128 a[224:227],v0 offset:57344
s_waitcnt lgkmcnt(3)
v_mfma_f32_16x16x32_bf16 v[120:123],a[192:195],v[16:19],v[208:211]
v_exp_f32 v143,v143
v_mfma_f32_16x16x32_bf16 v[120:123],a[196:199],v[20:23],v[120:123]
v_cvt_pk_bf16_f32 v183,v142,v143
v_mfma_f32_16x16x32_bf16 v[120:123],a[200:203],v[24:27],v[120:123]
ds_read_b128 a[228:231],v1 offset:57344
v_mfma_f32_16x16x32_bf16 v[120:123],a[204:207],v[28:31],v[120:123]
v_exp_f32 v156,v156
v_mfma_f32_16x16x32_bf16 v[120:123],a[208:211],v[32:35],v[120:123]
v_exp_f32 v157,v157
v_mfma_f32_16x16x32_bf16 v[120:123],a[212:215],v[36:39],v[120:123]
ds_read_b128 a[232:235],v2 offset:57344
s_waitcnt lgkmcnt(3)
v_mfma_f32_16x16x32_bf16 v[120:123],a[216:219],v[40:43],v[120:123]
v_cvt_pk_bf16_f32 v198,v156,v157
v_mfma_f32_16x16x32_bf16 v[120:123],a[220:223],v[44:47],v[120:123]
v_exp_f32 v158,v158
v_mfma_f32_16x16x32_bf16 v[136:139],a[192:195],v[48:51],v[212:215]
ds_read_b128 a[236:239],v3 offset:57344
v_mfma_f32_16x16x32_bf16 v[136:139],a[196:199],v[52:55],v[136:139]
v_mfma_f32_16x16x32_bf16 v[136:139],a[200:203],v[56:59],v[136:139]
v_exp_f32 v159,v159
v_mfma_f32_16x16x32_bf16 v[136:139],a[204:207],v[60:63],v[136:139]
ds_read_b128 a[240:243],v0 offset:57600
v_cvt_pk_bf16_f32 v199,v158,v159
v_mfma_f32_16x16x32_bf16 v[136:139],a[208:211],v[64:67],v[136:139]
v_mfma_f32_16x16x32_bf16 v[136:139],a[212:215],v[68:71],v[136:139]
v_exp_f32 v112,v112
v_mfma_f32_16x16x32_bf16 v[136:139],a[216:219],v[72:75],v[136:139]
ds_read_b128 a[244:247],v1 offset:57600
v_mfma_f32_16x16x32_bf16 v[136:139],a[220:223],v[76:79],v[136:139]
v_exp_f32 v113,v113
v_mfma_f32_16x16x32_bf16 v[152:155],a[192:195],v[80:83],v[216:219]
v_cvt_pk_bf16_f32 v168,v112,v113
v_mfma_f32_16x16x32_bf16 v[152:155],a[196:199],v[84:87],v[152:155]
ds_read_b128 a[248:251],v2 offset:57600
v_mfma_f32_16x16x32_bf16 v[152:155],a[200:203],v[88:91],v[152:155]
v_exp_f32 v114,v114
v_mfma_f32_16x16x32_bf16 v[152:155],a[204:207],v[92:95],v[152:155]
v_mfma_f32_16x16x32_bf16 v[152:155],a[208:211],v[96:99],v[152:155]
ds_read_b128 a[252:255],v3 offset:57600
v_mfma_f32_16x16x32_bf16 v[152:155],a[212:215],v[100:103],v[152:155]
v_exp_f32 v115,v115
v_mfma_f32_16x16x32_bf16 v[152:155],a[216:219],v[104:107],v[152:155]
v_cvt_pk_bf16_f32 v169,v114,v115
v_mfma_f32_16x16x32_bf16 v[152:155],a[220:223],v[108:111],v[152:155]
s_waitcnt lgkmcnt(2)
v_mfma_f32_16x16x32_bf16 v[124:127],a[224:227],v[16:19],v[208:211]
v_exp_f32 v128,v128
v_mfma_f32_16x16x32_bf16 v[124:127],a[228:231],v[20:23],v[124:127]
v_exp_f32 v129,v129
v_mfma_f32_16x16x32_bf16 v[124:127],a[232:235],v[24:27],v[124:127]
s_waitcnt lgkmcnt(0)
s_waitcnt vmcnt(14)
s_barrier
v_mfma_f32_16x16x32_bf16 v[124:127],a[236:239],v[28:31],v[124:127]
ds_read_b64_tr_b16 a[192:193],v4 offset:0
ds_read_b64_tr_b16 a[194:195],v4 offset:8192
s_add_u32 m0,s25,32768
s_add_u32 s28,s25,98304
buffer_load_dwordx4 v12,s[4:7],s28 offen nt lds
buffer_load_dwordx4 v13,s[4:7],s28 offen offset:1024 nt lds
buffer_load_dwordx4 v14,s[4:7],s28 offen offset:2048 nt lds
buffer_load_dwordx4 v15,s[4:7],s28 offen offset:3072 nt lds
s_add_u32 m0,s25,49152
s_add_u32 s28,s25,114688
buffer_load_dwordx4 v12,s[4:7],s28 offen nt lds
buffer_load_dwordx4 v13,s[4:7],s28 offen offset:1024 nt lds
buffer_load_dwordx4 v14,s[4:7],s28 offen offset:2048 nt lds
buffer_load_dwordx4 v15,s[4:7],s28 offen offset:3072 nt lds
v_mfma_f32_16x16x32_bf16 v[124:127],a[240:243],v[32:35],v[124:127]
v_cvt_pk_bf16_f32 v184,v128,v129
v_mfma_f32_16x16x32_bf16 v[124:127],a[244:247],v[36:39],v[124:127]
s_waitcnt lgkmcnt(2)
v_mfma_f32_16x16x32_bf16 v[124:127],a[248:251],v[40:43],v[124:127]
ds_read_b64_tr_b16 a[196:197],v4 offset:16384
ds_read_b64_tr_b16 a[198:199],v4 offset:24576
v_mfma_f32_16x16x32_bf16 v[124:127],a[252:255],v[44:47],v[124:127]
v_exp_f32 v130,v130
v_mfma_f32_16x16x32_bf16 v[140:143],a[224:227],v[48:51],v[212:215]
v_mfma_f32_16x16x32_bf16 v[140:143],a[228:231],v[52:55],v[140:143]
ds_read_b64_tr_b16 a[200:201],v5 offset:0
ds_read_b64_tr_b16 a[202:203],v5 offset:8192
v_mfma_f32_16x16x32_bf16 v[140:143],a[232:235],v[56:59],v[140:143]
v_exp_f32 v131,v131
v_mfma_f32_16x16x32_bf16 v[140:143],a[236:239],v[60:63],v[140:143]
v_cvt_pk_bf16_f32 v185,v130,v131
v_mfma_f32_16x16x32_bf16 v[140:143],a[240:243],v[64:67],v[140:143]
ds_read_b64_tr_b16 a[204:205],v5 offset:16384
ds_read_b64_tr_b16 a[206:207],v5 offset:24576
v_mfma_f32_16x16x32_bf16 v[140:143],a[244:247],v[68:71],v[140:143]
v_exp_f32 v144,v144
v_mfma_f32_16x16x32_bf16 v[140:143],a[248:251],v[72:75],v[140:143]
v_mfma_f32_16x16x32_bf16 v[140:143],a[252:255],v[76:79],v[140:143]
ds_read_b64_tr_b16 a[208:209],v6 offset:0
ds_read_b64_tr_b16 a[210:211],v6 offset:8192
v_mfma_f32_16x16x32_bf16 v[156:159],a[224:227],v[80:83],v[216:219]
v_exp_f32 v145,v145
v_mfma_f32_16x16x32_bf16 v[156:159],a[228:231],v[84:87],v[156:159]
v_cvt_pk_bf16_f32 v200,v144,v145
v_mfma_f32_16x16x32_bf16 v[156:159],a[232:235],v[88:91],v[156:159]
ds_read_b64_tr_b16 a[212:213],v6 offset:16384
ds_read_b64_tr_b16 a[214:215],v6 offset:24576
v_mfma_f32_16x16x32_bf16 v[156:159],a[236:239],v[92:95],v[156:159]
v_exp_f32 v146,v146
v_mfma_f32_16x16x32_bf16 v[156:159],a[240:243],v[96:99],v[156:159]
v_mfma_f32_16x16x32_bf16 v[156:159],a[244:247],v[100:103],v[156:159]
ds_read_b64_tr_b16 a[216:217],v7 offset:0
ds_read_b64_tr_b16 a[218:219],v7 offset:8192
v_mfma_f32_16x16x32_bf16 v[156:159],a[248:251],v[104:107],v[156:159]
v_exp_f32 v147,v147
v_mfma_f32_16x16x32_bf16 v[156:159],a[252:255],v[108:111],v[156:159]
v_cvt_pk_bf16_f32 v201,v146,v147
v_mfma_f32_16x16x32_bf16 v[220:223],v[232:235],v[160:163],0
ds_read_b64_tr_b16 a[220:221],v7 offset:16384
ds_read_b64_tr_b16 a[222:223],v7 offset:24576
v_mfma_f32_16x16x32_bf16 v[220:223],v[232:235],v[164:167],v[220:223]
v_exp_f32 v116,v116
v_mfma_f32_16x16x32_bf16 v[224:227],v[232:235],v[176:179],0
v_mfma_f32_16x16x32_bf16 v[224:227],v[232:235],v[180:183],v[224:227]
ds_read_b64_tr_b16 a[224:225],v8 offset:0
ds_read_b64_tr_b16 a[226:227],v8 offset:8192
v_mfma_f32_16x16x32_bf16 v[228:231],v[232:235],v[192:195],0
v_exp_f32 v117,v117
v_mfma_f32_16x16x32_bf16 v[228:231],v[232:235],v[196:199],v[228:231]
v_cvt_pk_bf16_f32 v170,v116,v117
s_waitcnt lgkmcnt(4)
v_mfma_f32_16x16x32_bf16 a[0:3],a[192:195],v[160:163],0
ds_read_b64_tr_b16 a[228:229],v8 offset:16384
ds_read_b64_tr_b16 a[230:231],v8 offset:24576
v_mfma_f32_16x16x32_bf16 a[0:3],a[196:199],v[164:167],a[0:3]
v_exp_f32 v118,v118
v_mfma_f32_16x16x32_bf16 a[64:67],a[192:195],v[176:179],0
v_mfma_f32_16x16x32_bf16 a[64:67],a[196:199],v[180:183],a[64:67]
ds_read_b64_tr_b16 a[232:233],v9 offset:0
ds_read_b64_tr_b16 a[234:235],v9 offset:8192
v_mfma_f32_16x16x32_bf16 a[128:131],a[192:195],v[192:195],0
v_exp_f32 v119,v119
v_mfma_f32_16x16x32_bf16 a[128:131],a[196:199],v[196:199],a[128:131]
v_cvt_pk_bf16_f32 v171,v118,v119
v_mfma_f32_16x16x32_bf16 a[4:7],a[200:203],v[160:163],0
ds_read_b64_tr_b16 a[236:237],v9 offset:16384
ds_read_b64_tr_b16 a[238:239],v9 offset:24576
v_mfma_f32_16x16x32_bf16 a[4:7],a[204:207],v[164:167],a[4:7]
v_mfma_f32_16x16x32_bf16 a[68:71],a[200:203],v[176:179],0
v_exp_f32 v132,v132
v_mfma_f32_16x16x32_bf16 a[68:71],a[204:207],v[180:183],a[68:71]
ds_read_b64_tr_b16 a[240:241],v10 offset:0
ds_read_b64_tr_b16 a[242:243],v10 offset:8192
v_mfma_f32_16x16x32_bf16 a[132:135],a[200:203],v[192:195],0
v_mfma_f32_16x16x32_bf16 a[132:135],a[204:207],v[196:199],a[132:135]
v_exp_f32 v133,v133
v_mfma_f32_16x16x32_bf16 a[8:11],a[208:211],v[160:163],0
ds_read_b64_tr_b16 a[244:245],v10 offset:16384
ds_read_b64_tr_b16 a[246:247],v10 offset:24576
v_mfma_f32_16x16x32_bf16 a[8:11],a[212:215],v[164:167],a[8:11]
v_cvt_pk_bf16_f32 v186,v132,v133
v_mfma_f32_16x16x32_bf16 a[72:75],a[208:211],v[176:179],0
v_exp_f32 v134,v134
v_mfma_f32_16x16x32_bf16 a[72:75],a[212:215],v[180:183],a[72:75]
ds_read_b64_tr_b16 a[248:249],v11 offset:0
ds_read_b64_tr_b16 a[250:251],v11 offset:8192
v_mfma_f32_16x16x32_bf16 a[136:139],a[208:211],v[192:195],0
v_mfma_f32_16x16x32_bf16 a[136:139],a[212:215],v[196:199],a[136:139]
v_exp_f32 v135,v135
v_mfma_f32_16x16x32_bf16 a[12:15],a[216:219],v[160:163],0
ds_read_b64_tr_b16 a[252:253],v11 offset:16384
ds_read_b64_tr_b16 a[254:255],v11 offset:24576
s_waitcnt lgkmcnt(6)
v_mfma_f32_16x16x32_bf16 a[12:15],a[220:223],v[164:167],a[12:15]
v_cvt_pk_bf16_f32 v187,v134,v135
v_mfma_f32_16x16x32_bf16 a[76:79],a[216:219],v[176:179],0
v_exp_f32 v148,v148
v_mfma_f32_16x16x32_bf16 a[76:79],a[220:223],v[180:183],a[76:79]
ds_read_b64_tr_b16 a[192:193],v4 offset:256
ds_read_b64_tr_b16 a[194:195],v4 offset:8448
v_mfma_f32_16x16x32_bf16 a[140:143],a[216:219],v[192:195],0
v_mfma_f32_16x16x32_bf16 a[140:143],a[220:223],v[196:199],a[140:143]
v_exp_f32 v149,v149
v_mfma_f32_16x16x32_bf16 a[16:19],a[224:227],v[160:163],0
ds_read_b64_tr_b16 a[196:197],v4 offset:16640
ds_read_b64_tr_b16 a[198:199],v4 offset:24832
v_mfma_f32_16x16x32_bf16 a[16:19],a[228:231],v[164:167],a[16:19]
v_cvt_pk_bf16_f32 v202,v148,v149
v_mfma_f32_16x16x32_bf16 a[80:83],a[224:227],v[176:179],0
v_exp_f32 v150,v150
v_mfma_f32_16x16x32_bf16 a[80:83],a[228:231],v[180:183],a[80:83]
ds_read_b64_tr_b16 a[200:201],v5 offset:256
ds_read_b64_tr_b16 a[202:203],v5 offset:8448
v_mfma_f32_16x16x32_bf16 a[144:147],a[224:227],v[192:195],0
v_mfma_f32_16x16x32_bf16 a[144:147],a[228:231],v[196:199],a[144:147]
v_exp_f32 v151,v151
v_mfma_f32_16x16x32_bf16 a[20:23],a[232:235],v[160:163],0
ds_read_b64_tr_b16 a[204:205],v5 offset:16640
ds_read_b64_tr_b16 a[206:207],v5 offset:24832
v_mfma_f32_16x16x32_bf16 a[20:23],a[236:239],v[164:167],a[20:23]
v_cvt_pk_bf16_f32 v203,v150,v151
v_mfma_f32_16x16x32_bf16 a[84:87],a[232:235],v[176:179],0
v_exp_f32 v120,v120
v_mfma_f32_16x16x32_bf16 a[84:87],a[236:239],v[180:183],a[84:87]
ds_read_b64_tr_b16 a[208:209],v6 offset:256
ds_read_b64_tr_b16 a[210:211],v6 offset:8448
v_mfma_f32_16x16x32_bf16 a[148:151],a[232:235],v[192:195],0
v_mfma_f32_16x16x32_bf16 a[148:151],a[236:239],v[196:199],a[148:151]
v_exp_f32 v121,v121
v_mfma_f32_16x16x32_bf16 a[24:27],a[240:243],v[160:163],0
ds_read_b64_tr_b16 a[212:213],v6 offset:16640
ds_read_b64_tr_b16 a[214:215],v6 offset:24832
s_waitcnt lgkmcnt(6)
v_mfma_f32_16x16x32_bf16 a[24:27],a[244:247],v[164:167],a[24:27]
v_cvt_pk_bf16_f32 v172,v120,v121
v_mfma_f32_16x16x32_bf16 a[88:91],a[240:243],v[176:179],0
v_exp_f32 v122,v122
v_mfma_f32_16x16x32_bf16 a[88:91],a[244:247],v[180:183],a[88:91]
ds_read_b64_tr_b16 a[216:217],v7 offset:256
ds_read_b64_tr_b16 a[218:219],v7 offset:8448
v_mfma_f32_16x16x32_bf16 a[152:155],a[240:243],v[192:195],0
v_mfma_f32_16x16x32_bf16 a[152:155],a[244:247],v[196:199],a[152:155]
v_exp_f32 v123,v123
v_mfma_f32_16x16x32_bf16 a[28:31],a[248:251],v[160:163],0
ds_read_b64_tr_b16 a[220:221],v7 offset:16640
ds_read_b64_tr_b16 a[222:223],v7 offset:24832
v_mfma_f32_16x16x32_bf16 a[28:31],a[252:255],v[164:167],a[28:31]
v_cvt_pk_bf16_f32 v173,v122,v123
v_mfma_f32_16x16x32_bf16 a[92:95],a[248:251],v[176:179],0
v_exp_f32 v136,v136
v_mfma_f32_16x16x32_bf16 a[92:95],a[252:255],v[180:183],a[92:95]
ds_read_b64_tr_b16 a[224:225],v8 offset:256
ds_read_b64_tr_b16 a[226:227],v8 offset:8448
v_mfma_f32_16x16x32_bf16 a[156:159],a[248:251],v[192:195],0
v_mfma_f32_16x16x32_bf16 a[156:159],a[252:255],v[196:199],a[156:159]
v_exp_f32 v137,v137
v_mfma_f32_16x16x32_bf16 a[32:35],a[192:195],v[160:163],0
ds_read_b64_tr_b16 a[228:229],v8 offset:16640
ds_read_b64_tr_b16 a[230:231],v8 offset:24832
v_mfma_f32_16x16x32_bf16 a[32:35],a[196:199],v[164:167],a[32:35]
v_cvt_pk_bf16_f32 v188,v136,v137
v_mfma_f32_16x16x32_bf16 a[96:99],a[192:195],v[176:179],0
v_mfma_f32_16x16x32_bf16 a[96:99],a[196:199],v[180:183],a[96:99]
ds_read_b64_tr_b16 a[232:233],v9 offset:256
ds_read_b64_tr_b16 a[234:235],v9 offset:8448
v_mfma_f32_16x16x32_bf16 a[160:163],a[192:195],v[192:195],0
v_exp_f32 v138,v138
v_mfma_f32_16x16x32_bf16 a[160:163],a[196:199],v[196:199],a[160:163]
v_mfma_f32_16x16x32_bf16 a[36:39],a[200:203],v[160:163],0
ds_read_b64_tr_b16 a[236:237],v9 offset:16640
ds_read_b64_tr_b16 a[238:239],v9 offset:24832
s_waitcnt lgkmcnt(6)
v_mfma_f32_16x16x32_bf16 a[36:39],a[204:207],v[164:167],a[36:39]
v_exp_f32 v139,v139
v_mfma_f32_16x16x32_bf16 a[100:103],a[200:203],v[176:179],0
v_cvt_pk_bf16_f32 v189,v138,v139
v_mfma_f32_16x16x32_bf16 a[100:103],a[204:207],v[180:183],a[100:103]
ds_read_b64_tr_b16 a[240:241],v10 offset:256
ds_read_b64_tr_b16 a[242:243],v10 offset:8448
v_mfma_f32_16x16x32_bf16 a[164:167],a[200:203],v[192:195],0
v_exp_f32 v152,v152
v_mfma_f32_16x16x32_bf16 a[164:167],a[204:207],v[196:199],a[164:167]
v_mfma_f32_16x16x32_bf16 a[40:43],a[208:211],v[160:163],0
ds_read_b64_tr_b16 a[244:245],v10 offset:16640
ds_read_b64_tr_b16 a[246:247],v10 offset:24832
v_mfma_f32_16x16x32_bf16 a[40:43],a[212:215],v[164:167],a[40:43]
v_exp_f32 v153,v153
v_mfma_f32_16x16x32_bf16 a[104:107],a[208:211],v[176:179],0
v_cvt_pk_bf16_f32 v204,v152,v153
v_mfma_f32_16x16x32_bf16 a[104:107],a[212:215],v[180:183],a[104:107]
ds_read_b64_tr_b16 a[248:249],v11 offset:256
ds_read_b64_tr_b16 a[250:251],v11 offset:8448
v_mfma_f32_16x16x32_bf16 a[168:171],a[208:211],v[192:195],0
v_exp_f32 v154,v154
v_mfma_f32_16x16x32_bf16 a[168:171],a[212:215],v[196:199],a[168:171]
v_mfma_f32_16x16x32_bf16 a[44:47],a[216:219],v[160:163],0
ds_read_b64_tr_b16 a[252:253],v11 offset:16640
ds_read_b64_tr_b16 a[254:255],v11 offset:24832
v_mfma_f32_16x16x32_bf16 a[44:47],a[220:223],v[164:167],a[44:47]
v_exp_f32 v155,v155
v_mfma_f32_16x16x32_bf16 a[108:111],a[216:219],v[176:179],0
v_cvt_pk_bf16_f32 v205,v154,v155
v_mfma_f32_16x16x32_bf16 a[108:111],a[220:223],v[180:183],a[108:111]
v_mfma_f32_16x16x32_bf16 a[172:175],a[216:219],v[192:195],0
v_exp_f32 v124,v124
v_mfma_f32_16x16x32_bf16 a[172:175],a[220:223],v[196:199],a[172:175]
v_mfma_f32_16x16x32_bf16 a[48:51],a[224:227],v[160:163],0
s_waitcnt lgkmcnt(0)
s_waitcnt vmcnt(8)
s_barrier
s_waitcnt lgkmcnt(2)
v_mfma_f32_16x16x32_bf16 a[48:51],a[228:231],v[164:167],a[48:51]
ds_read_b128 a[192:195],v0 offset:0
s_add_u32 m0,s25,65536
s_add_u32 s28,s25,65536
buffer_load_dwordx4 v12,s[8:11],s28 offen nt lds
buffer_load_dwordx4 v13,s[8:11],s28 offen offset:1024 nt lds
buffer_load_dwordx4 v14,s[8:11],s28 offen offset:2048 nt lds
buffer_load_dwordx4 v15,s[8:11],s28 offen offset:3072 nt lds
s_add_u32 m0,s25,81920
s_add_u32 s28,s25,81920
buffer_load_dwordx4 v12,s[8:11],s28 offen nt lds
buffer_load_dwordx4 v13,s[8:11],s28 offen offset:1024 nt lds
buffer_load_dwordx4 v14,s[8:11],s28 offen offset:2048 nt lds
buffer_load_dwordx4 v15,s[8:11],s28 offen offset:3072 nt lds
v_mfma_f32_16x16x32_bf16 a[112:115],a[224:227],v[176:179],0
v_exp_f32 v125,v125
v_mfma_f32_16x16x32_bf16 a[112:115],a[228:231],v[180:183],a[112:115]
v_cvt_pk_bf16_f32 v174,v124,v125
v_mfma_f32_16x16x32_bf16 a[176:179],a[224:227],v[192:195],0
ds_read_b128 a[196:199],v1 offset:0
v_mfma_f32_16x16x32_bf16 a[176:179],a[228:231],v[196:199],a[176:179]
v_exp_f32 v126,v126
v_mfma_f32_16x16x32_bf16 a[52:55],a[232:235],v[160:163],0
v_mfma_f32_16x16x32_bf16 a[52:55],a[236:239],v[164:167],a[52:55]
ds_read_b128 a[200:203],v2 offset:0
v_mfma_f32_16x16x32_bf16 a[116:119],a[232:235],v[176:179],0
v_exp_f32 v127,v127
v_mfma_f32_16x16x32_bf16 a[116:119],a[236:239],v[180:183],a[116:119]
v_cvt_pk_bf16_f32 v175,v126,v127
v_mfma_f32_16x16x32_bf16 a[180:183],a[232:235],v[192:195],0
ds_read_b128 a[204:207],v3 offset:0
v_mfma_f32_16x16x32_bf16 a[180:183],a[236:239],v[196:199],a[180:183]
v_exp_f32 v140,v140
v_mfma_f32_16x16x32_bf16 a[56:59],a[240:243],v[160:163],0
v_exp_f32 v141,v141
v_mfma_f32_16x16x32_bf16 a[56:59],a[244:247],v[164:167],a[56:59]
ds_read_b128 a[208:211],v0 offset:256
v_cvt_pk_bf16_f32 v190,v140,v141
v_mfma_f32_16x16x32_bf16 a[120:123],a[240:243],v[176:179],0
v_mfma_f32_16x16x32_bf16 a[120:123],a[244:247],v[180:183],a[120:123]
v_exp_f32 v142,v142
v_mfma_f32_16x16x32_bf16 a[184:187],a[240:243],v[192:195],0
ds_read_b128 a[212:215],v1 offset:256
v_mfma_f32_16x16x32_bf16 a[184:187],a[244:247],v[196:199],a[184:187]
v_exp_f32 v143,v143
v_mfma_f32_16x16x32_bf16 a[60:63],a[248:251],v[160:163],0
v_cvt_pk_bf16_f32 v191,v142,v143
s_waitcnt lgkmcnt(6)
v_mfma_f32_16x16x32_bf16 a[60:63],a[252:255],v[164:167],a[60:63]
ds_read_b128 a[216:219],v2 offset:256
v_mfma_f32_16x16x32_bf16 a[124:127],a[248:251],v[176:179],0
v_mfma_f32_16x16x32_bf16 a[124:127],a[252:255],v[180:183],a[124:127]
v_mfma_f32_16x16x32_bf16 a[188:191],a[248:251],v[192:195],0
ds_read_b128 a[220:223],v3 offset:256
v_mfma_f32_16x16x32_bf16 a[188:191],a[252:255],v[196:199],a[188:191]
LOOP_A:
s_waitcnt lgkmcnt(2)
v_mfma_f32_16x16x32_bf16 v[112:115],a[192:195],v[16:19],v[208:211]
ds_read_b128 a[224:227],v0 offset:8192
v_mfma_f32_16x16x32_bf16 v[112:115],a[196:199],v[20:23],v[112:115]
v_exp_f32 v156,v156
v_mfma_f32_16x16x32_bf16 v[112:115],a[200:203],v[24:27],v[112:115]
v_mfma_f32_16x16x32_bf16 v[112:115],a[204:207],v[28:31],v[112:115]
ds_read_b128 a[228:231],v1 offset:8192
v_mfma_f32_16x16x32_bf16 v[112:115],a[208:211],v[32:35],v[112:115]
v_exp_f32 v157,v157
v_mfma_f32_16x16x32_bf16 v[112:115],a[212:215],v[36:39],v[112:115]
v_cvt_pk_bf16_f32 v206,v156,v157
s_waitcnt lgkmcnt(2)
v_mfma_f32_16x16x32_bf16 v[112:115],a[216:219],v[40:43],v[112:115]
ds_read_b128 a[232:235],v2 offset:8192
v_mfma_f32_16x16x32_bf16 v[112:115],a[220:223],v[44:47],v[112:115]
v_exp_f32 v158,v158
v_mfma_f32_16x16x32_bf16 v[128:131],a[192:195],v[48:51],v[212:215]
v_mfma_f32_16x16x32_bf16 v[128:131],a[196:199],v[52:55],v[128:131]
ds_read_b128 a[236:239],v3 offset:8192
v_mfma_f32_16x16x32_bf16 v[128:131],a[200:203],v[56:59],v[128:131]
v_exp_f32 v159,v159
v_mfma_f32_16x16x32_bf16 v[128:131],a[204:207],v[60:63],v[128:131]
v_cvt_pk_bf16_f32 v207,v158,v159
v_mfma_f32_16x16x32_bf16 v[128:131],a[208:211],v[64:67],v[128:131]
ds_read_b128 a[240:243],v0 offset:8448
v_mfma_f32_16x16x32_bf16 v[128:131],a[212:215],v[68:71],v[128:131]
v_mfma_f32_16x16x32_bf16 v[128:131],a[216:219],v[72:75],v[128:131]
v_exp_f32 v112,v112
v_mfma_f32_16x16x32_bf16 v[128:131],a[220:223],v[76:79],v[128:131]
ds_read_b128 a[244:247],v1 offset:8448
v_mfma_f32_16x16x32_bf16 v[144:147],a[192:195],v[80:83],v[216:219]
v_mfma_f32_16x16x32_bf16 v[144:147],a[196:199],v[84:87],v[144:147]
v_exp_f32 v113,v113
v_mfma_f32_16x16x32_bf16 v[144:147],a[200:203],v[88:91],v[144:147]
ds_read_b128 a[248:251],v2 offset:8448
v_cvt_pk_bf16_f32 v160,v112,v113
v_mfma_f32_16x16x32_bf16 v[144:147],a[204:207],v[92:95],v[144:147]
v_mfma_f32_16x16x32_bf16 v[144:147],a[208:211],v[96:99],v[144:147]
v_mfma_f32_16x16x32_bf16 v[144:147],a[212:215],v[100:103],v[144:147]
ds_read_b128 a[252:255],v3 offset:8448
v_mfma_f32_16x16x32_bf16 v[144:147],a[216:219],v[104:107],v[144:147]
v_exp_f32 v114,v114
v_mfma_f32_16x16x32_bf16 v[144:147],a[220:223],v[108:111],v[144:147]
s_waitcnt lgkmcnt(2)
v_mfma_f32_16x16x32_bf16 v[116:119],a[224:227],v[16:19],v[208:211]
ds_read_b128 a[192:195],v0 offset:16384
v_mfma_f32_16x16x32_bf16 v[116:119],a[228:231],v[20:23],v[116:119]
v_exp_f32 v115,v115
v_mfma_f32_16x16x32_bf16 v[116:119],a[232:235],v[24:27],v[116:119]
v_cvt_pk_bf16_f32 v161,v114,v115
v_mfma_f32_16x16x32_bf16 v[116:119],a[236:239],v[28:31],v[116:119]
ds_read_b128 a[196:199],v1 offset:16384
v_mfma_f32_16x16x32_bf16 v[116:119],a[240:243],v[32:35],v[116:119]
v_exp_f32 v128,v128
v_mfma_f32_16x16x32_bf16 v[116:119],a[244:247],v[36:39],v[116:119]
s_waitcnt lgkmcnt(2)
v_mfma_f32_16x16x32_bf16 v[116:119],a[248:251],v[40:43],v[116:119]
ds_read_b128 a[200:203],v2 offset:16384
v_mfma_f32_16x16x32_bf16 v[116:119],a[252:255],v[44:47],v[116:119]
v_exp_f32 v129,v129
v_mfma_f32_16x16x32_bf16 v[132:135],a[224:227],v[48:51],v[212:215]
v_cvt_pk_bf16_f32 v176,v128,v129
v_mfma_f32_16x16x32_bf16 v[132:135],a[228:231],v[52:55],v[132:135]
ds_read_b128 a[204:207],v3 offset:16384
v_mfma_f32_16x16x32_bf16 v[132:135],a[232:235],v[56:59],v[132:135]
v_mfma_f32_16x16x32_bf16 v[132:135],a[236:239],v[60:63],v[132:135]
v_exp_f32 v130,v130
v_mfma_f32_16x16x32_bf16 v[132:135],a[240:243],v[64:67],v[132:135]
ds_read_b128 a[208:211],v0 offset:16640
v_mfma_f32_16x16x32_bf16 v[132:135],a[244:247],v[68:71],v[132:135]
v_mfma_f32_16x16x32_bf16 v[132:135],a[248:251],v[72:75],v[132:135]
v_mfma_f32_16x16x32_bf16 v[132:135],a[252:255],v[76:79],v[132:135]
ds_read_b128 a[212:215],v1 offset:16640
v_mfma_f32_16x16x32_bf16 v[148:151],a[224:227],v[80:83],v[216:219]
v_exp_f32 v131,v131
v_mfma_f32_16x16x32_bf16 v[148:151],a[228:231],v[84:87],v[148:151]
v_cvt_pk_bf16_f32 v177,v130,v131
v_mfma_f32_16x16x32_bf16 v[148:151],a[232:235],v[88:91],v[148:151]
ds_read_b128 a[216:219],v2 offset:16640
v_mfma_f32_16x16x32_bf16 v[148:151],a[236:239],v[92:95],v[148:151]
v_exp_f32 v144,v144
v_mfma_f32_16x16x32_bf16 v[148:151],a[240:243],v[96:99],v[148:151]
ds_read_b128 a[220:223],v3 offset:16640
v_mfma_f32_16x16x32_bf16 v[148:151],a[244:247],v[100:103],v[148:151]
v_mfma_f32_16x16x32_bf16 v[148:151],a[248:251],v[104:107],v[148:151]
v_exp_f32 v145,v145
v_mfma_f32_16x16x32_bf16 v[148:151],a[252:255],v[108:111],v[148:151]
ds_read_b128 a[224:227],v0 offset:24576
s_waitcnt lgkmcnt(3)
v_mfma_f32_16x16x32_bf16 v[120:123],a[192:195],v[16:19],v[208:211]
v_cvt_pk_bf16_f32 v192,v144,v145
v_mfma_f32_16x16x32_bf16 v[120:123],a[196:199],v[20:23],v[120:123]
v_mfma_f32_16x16x32_bf16 v[120:123],a[200:203],v[24:27],v[120:123]
ds_read_b128 a[228:231],v1 offset:24576
v_mfma_f32_16x16x32_bf16 v[120:123],a[204:207],v[28:31],v[120:123]
v_exp_f32 v146,v146
v_mfma_f32_16x16x32_bf16 v[120:123],a[208:211],v[32:35],v[120:123]
v_mfma_f32_16x16x32_bf16 v[120:123],a[212:215],v[36:39],v[120:123]
ds_read_b128 a[232:235],v2 offset:24576
s_waitcnt lgkmcnt(3)
v_mfma_f32_16x16x32_bf16 v[120:123],a[216:219],v[40:43],v[120:123]
v_exp_f32 v147,v147
v_mfma_f32_16x16x32_bf16 v[120:123],a[220:223],v[44:47],v[120:123]
v_cvt_pk_bf16_f32 v193,v146,v147
v_mfma_f32_16x16x32_bf16 v[136:139],a[192:195],v[48:51],v[212:215]
ds_read_b128 a[236:239],v3 offset:24576
v_mfma_f32_16x16x32_bf16 v[136:139],a[196:199],v[52:55],v[136:139]
v_mfma_f32_16x16x32_bf16 v[136:139],a[200:203],v[56:59],v[136:139]
v_exp_f32 v116,v116
v_mfma_f32_16x16x32_bf16 v[136:139],a[204:207],v[60:63],v[136:139]
ds_read_b128 a[240:243],v0 offset:24832
v_mfma_f32_16x16x32_bf16 v[136:139],a[208:211],v[64:67],v[136:139]
v_mfma_f32_16x16x32_bf16 v[136:139],a[212:215],v[68:71],v[136:139]
v_exp_f32 v117,v117
v_mfma_f32_16x16x32_bf16 v[136:139],a[216:219],v[72:75],v[136:139]
ds_read_b128 a[244:247],v1 offset:24832
v_cvt_pk_bf16_f32 v162,v116,v117
v_mfma_f32_16x16x32_bf16 v[136:139],a[220:223],v[76:79],v[136:139]
v_mfma_f32_16x16x32_bf16 v[152:155],a[192:195],v[80:83],v[216:219]
v_mfma_f32_16x16x32_bf16 v[152:155],a[196:199],v[84:87],v[152:155]
ds_read_b128 a[248:251],v2 offset:24832
v_mfma_f32_16x16x32_bf16 v[152:155],a[200:203],v[88:91],v[152:155]
v_exp_f32 v118,v118
v_mfma_f32_16x16x32_bf16 v[152:155],a[204:207],v[92:95],v[152:155]
v_mfma_f32_16x16x32_bf16 v[152:155],a[208:211],v[96:99],v[152:155]
ds_read_b128 a[252:255],v3 offset:24832
v_mfma_f32_16x16x32_bf16 v[152:155],a[212:215],v[100:103],v[152:155]
v_exp_f32 v119,v119
v_mfma_f32_16x16x32_bf16 v[152:155],a[216:219],v[104:107],v[152:155]
v_cvt_pk_bf16_f32 v163,v118,v119
v_mfma_f32_16x16x32_bf16 v[152:155],a[220:223],v[108:111],v[152:155]
s_waitcnt lgkmcnt(2)
v_mfma_f32_16x16x32_bf16 v[124:127],a[224:227],v[16:19],v[208:211]
v_exp_f32 v132,v132
v_mfma_f32_16x16x32_bf16 v[124:127],a[228:231],v[20:23],v[124:127]
v_mfma_f32_16x16x32_bf16 v[124:127],a[232:235],v[24:27],v[124:127]
s_waitcnt lgkmcnt(0)
s_barrier
v_mfma_f32_16x16x32_bf16 v[124:127],a[236:239],v[28:31],v[124:127]
ds_read_b64_tr_b16 a[192:193],v4 offset:32768
ds_read_b64_tr_b16 a[194:195],v4 offset:40960
s_add_u32 m0,s25,0
s_add_u32 s28,s26,98304
buffer_load_dwordx4 v12,s[4:7],s28 offen nt lds
buffer_load_dwordx4 v13,s[4:7],s28 offen offset:1024 nt lds
buffer_load_dwordx4 v14,s[4:7],s28 offen offset:2048 nt lds
buffer_load_dwordx4 v15,s[4:7],s28 offen offset:3072 nt lds
v_mfma_f32_16x16x32_bf16 v[124:127],a[240:243],v[32:35],v[124:127]
v_exp_f32 v133,v133
v_mfma_f32_16x16x32_bf16 v[124:127],a[244:247],v[36:39],v[124:127]
v_cvt_pk_bf16_f32 v178,v132,v133
s_waitcnt lgkmcnt(2)
v_mfma_f32_16x16x32_bf16 v[124:127],a[248:251],v[40:43],v[124:127]
ds_read_b64_tr_b16 a[196:197],v4 offset:49152
ds_read_b64_tr_b16 a[198:199],v4 offset:57344
v_mfma_f32_16x16x32_bf16 v[124:127],a[252:255],v[44:47],v[124:127]
v_mfma_f32_16x16x32_bf16 v[140:143],a[224:227],v[48:51],v[212:215]
v_mfma_f32_16x16x32_bf16 v[140:143],a[228:231],v[52:55],v[140:143]
ds_read_b64_tr_b16 a[200:201],v5 offset:32768
ds_read_b64_tr_b16 a[202:203],v5 offset:40960
v_mfma_f32_16x16x32_bf16 v[140:143],a[232:235],v[56:59],v[140:143]
v_exp_f32 v134,v134
v_mfma_f32_16x16x32_bf16 v[140:143],a[236:239],v[60:63],v[140:143]
v_mfma_f32_16x16x32_bf16 v[140:143],a[240:243],v[64:67],v[140:143]
ds_read_b64_tr_b16 a[204:205],v5 offset:49152
ds_read_b64_tr_b16 a[206:207],v5 offset:57344
v_mfma_f32_16x16x32_bf16 v[140:143],a[244:247],v[68:71],v[140:143]
v_mfma_f32_16x16x32_bf16 v[140:143],a[248:251],v[72:75],v[140:143]
v_exp_f32 v135,v135
v_mfma_f32_16x16x32_bf16 v[140:143],a[252:255],v[76:79],v[140:143]
ds_read_b64_tr_b16 a[208:209],v6 offset:32768
ds_read_b64_tr_b16 a[210:211],v6 offset:40960
v_mfma_f32_16x16x32_bf16 v[156:159],a[224:227],v[80:83],v[216:219]
v_cvt_pk_bf16_f32 v179,v134,v135
v_mfma_f32_16x16x32_bf16 v[156:159],a[228:231],v[84:87],v[156:159]
v_mfma_f32_16x16x32_bf16 v[156:159],a[232:235],v[88:91],v[156:159]
ds_read_b64_tr_b16 a[212:213],v6 offset:49152
ds_read_b64_tr_b16 a[214:215],v6 offset:57344
v_mfma_f32_16x16x32_bf16 v[156:159],a[236:239],v[92:95],v[156:159]
v_exp_f32 v148,v148
v_mfma_f32_16x16x32_bf16 v[156:159],a[240:243],v[96:99],v[156:159]
v_mfma_f32_16x16x32_bf16 v[156:159],a[244:247],v[100:103],v[156:159]
ds_read_b64_tr_b16 a[216:217],v7 offset:32768
ds_read_b64_tr_b16 a[218:219],v7 offset:40960
v_mfma_f32_16x16x32_bf16 v[156:159],a[248:251],v[104:107],v[156:159]
v_mfma_f32_16x16x32_bf16 v[156:159],a[252:255],v[108:111],v[156:159]
v_exp_f32 v149,v149
v_mfma_f32_16x16x32_bf16 v[220:223],v[232:235],v[168:171],v[220:223]
ds_read_b64_tr_b16 a[220:221],v7 offset:49152
ds_read_b64_tr_b16 a[222:223],v7 offset:57344
v_mfma_f32_16x16x32_bf16 v[220:223],v[232:235],v[172:175],v[220:223]
v_cvt_pk_bf16_f32 v194,v148,v149
v_mfma_f32_16x16x32_bf16 v[224:227],v[232:235],v[184:187],v[224:227]
v_mfma_f32_16x16x32_bf16 v[224:227],v[232:235],v[188:191],v[224:227]
ds_read_b64_tr_b16 a[224:225],v8 offset:32768
ds_read_b64_tr_b16 a[226:227],v8 offset:40960
v_mfma_f32_16x16x32_bf16 v[228:231],v[232:235],v[200:203],v[228:231]
v_exp_f32 v150,v150
v_mfma_f32_16x16x32_bf16 v[228:231],v[232:235],v[204:207],v[228:231]
s_waitcnt lgkmcnt(4)
v_mfma_f32_16x16x32_bf16 a[0:3],a[192:195],v[168:171],a[0:3]
ds_read_b64_tr_b16 a[228:229],v8 offset:49152
ds_read_b64_tr_b16 a[230:231],v8 offset:57344
v_mfma_f32_16x16x32_bf16 a[0:3],a[196:199],v[172:175],a[0:3]
v_mfma_f32_16x16x32_bf16 a[64:67],a[192:195],v[184:187],a[64:67]
v_exp_f32 v151,v151
v_mfma_f32_16x16x32_bf16 a[64:67],a[196:199],v[188:191],a[64:67]
ds_read_b64_tr_b16 a[232:233],v9 offset:32768
ds_read_b64_tr_b16 a[234:235],v9 offset:40960
v_mfma_f32_16x16x32_bf16 a[128:131],a[192:195],v[200:203],a[128:131]
v_cvt_pk_bf16_f32 v195,v150,v151
v_mfma_f32_16x16x32_bf16 a[128:131],a[196:199],v[204:207],a[128:131]
v_mfma_f32_16x16x32_bf16 a[4:7],a[200:203],v[168:171],a[4:7]
ds_read_b64_tr_b16 a[236:237],v9 offset:49152
ds_read_b64_tr_b16 a[238:239],v9 offset:57344
v_mfma_f32_16x16x32_bf16 a[4:7],a[204:207],v[172:175],a[4:7]
v_exp_f32 v120,v120
v_mfma_f32_16x16x32_bf16 a[68:71],a[200:203],v[184:187],a[68:71]
v_mfma_f32_16x16x32_bf16 a[68:71],a[204:207],v[188:191],a[68:71]
ds_read_b64_tr_b16 a[240:241],v10 offset:32768
ds_read_b64_tr_b16 a[242:243],v10 offset:40960
v_mfma_f32_16x16x32_bf16 a[132:135],a[200:203],v[200:203],a[132:135]
v_mfma_f32_16x16x32_bf16 a[132:135],a[204:207],v[204:207],a[132:135]
v_exp_f32 v121,v121
v_mfma_f32_16x16x32_bf16 a[8:11],a[208:211],v[168:171],a[8:11]
ds_read_b64_tr_b16 a[244:245],v10 offset:49152
ds_read_b64_tr_b16 a[246:247],v10 offset:57344
v_mfma_f32_16x16x32_bf16 a[8:11],a[212:215],v[172:175],a[8:11]
v_cvt_pk_bf16_f32 v164,v120,v121
v_mfma_f32_16x16x32_bf16 a[72:75],a[208:211],v[184:187],a[72:75]
v_mfma_f32_16x16x32_bf16 a[72:75],a[212:215],v[188:191],a[72:75]
ds_read_b64_tr_b16 a[248:249],v11 offset:32768
ds_read_b64_tr_b16 a[250:251],v11 offset:40960
v_mfma_f32_16x16x32_bf16 a[136:139],a[208:211],v[200:203],a[136:139]
v_exp_f32 v122,v122
v_mfma_f32_16x16x32_bf16 a[136:139],a[212:215],v[204:207],a[136:139]
v_mfma_f32_16x16x32_bf16 a[12:15],a[216:219],v[168:171],a[12:15]
ds_read_b64_tr_b16 a[252:253],v11 offset:49152
ds_read_b64_tr_b16 a[254:255],v11 offset:57344
s_waitcnt lgkmcnt(6)
v_mfma_f32_16x16x32_bf16 a[12:15],a[220:223],v[172:175],a[12:15]
v_mfma_f32_16x16x32_bf16 a[76:79],a[216:219],v[184:187],a[76:79]
v_exp_f32 v123,v123
v_mfma_f32_16x16x32_bf16 a[76:79],a[220:223],v[188:191],a[76:79]
ds_read_b64_tr_b16 a[192:193],v4 offset:33024
ds_read_b64_tr_b16 a[194:195],v4 offset:41216
v_mfma_f32_16x16x32_bf16 a[140:143],a[216:219],v[200:203],a[140:143]
v_cvt_pk_bf16_f32 v165,v122,v123
v_mfma_f32_16x16x32_bf16 a[140:143],a[220:223],v[204:207],a[140:143]
v_mfma_f32_16x16x32_bf16 a[16:19],a[224:227],v[168:171],a[16:19]
ds_read_b64_tr_b16 a[196:197],v4 offset:49408
ds_read_b64_tr_b16 a[198:199],v4 offset:57600
v_mfma_f32_16x16x32_bf16 a[16:19],a[228:231],v[172:175],a[16:19]
v_exp_f32 v136,v136
v_mfma_f32_16x16x32_bf16 a[80:83],a[224:227],v[184:187],a[80:83]
v_mfma_f32_16x16x32_bf16 a[80:83],a[228:231],v[188:191],a[80:83]
ds_read_b64_tr_b16 a[200:201],v5 offset:33024
ds_read_b64_tr_b16 a[202:203],v5 offset:41216
v_mfma_f32_16x16x32_bf16 a[144:147],a[224:227],v[200:203],a[144:147]
v_mfma_f32_16x16x32_bf16 a[144:147],a[228:231],v[204:207],a[144:147]
v_exp_f32 v137,v137
v_mfma_f32_16x16x32_bf16 a[20:23],a[232:235],v[168:171],a[20:23]
ds_read_b64_tr_b16 a[204:205],v5 offset:49408
ds_read_b64_tr_b16 a[206:207],v5 offset:57600
v_mfma_f32_16x16x32_bf16 a[20:23],a[236:239],v[172:175],a[20:23]
v_cvt_pk_bf16_f32 v180,v136,v137
v_mfma_f32_16x16x32_bf16 a[84:87],a[232:235],v[184:187],a[84:87]
v_mfma_f32_16x16x32_bf16 a[84:87],a[236:239],v[188:191],a[84:87]
ds_read_b64_tr_b16 a[208:209],v6 offset:33024
ds_read_b64_tr_b16 a[210:211],v6 offset:41216
v_mfma_f32_16x16x32_bf16 a[148:151],a[232:235],v[200:203],a[148:151]
v_exp_f32 v138,v138
v_mfma_f32_16x16x32_bf16 a[148:151],a[236:239],v[204:207],a[148:151]
v_mfma_f32_16x16x32_bf16 a[24:27],a[240:243],v[168:171],a[24:27]
ds_read_b64_tr_b16 a[212:213],v6 offset:49408
ds_read_b64_tr_b16 a[214:215],v6 offset:57600
s_waitcnt lgkmcnt(6)
v_mfma_f32_16x16x32_bf16 a[24:27],a[244:247],v[172:175],a[24:27]
v_mfma_f32_16x16x32_bf16 a[88:91],a[240:243],v[184:187],a[88:91]
v_exp_f32 v139,v139
v_mfma_f32_16x16x32_bf16 a[88:91],a[244:247],v[188:191],a[88:91]
ds_read_b64_tr_b16 a[216:217],v7 offset:33024
ds_read_b64_tr_b16 a[218:219],v7 offset:41216
v_mfma_f32_16x16x32_bf16 a[152:155],a[240:243],v[200:203],a[152:155]
v_cvt_pk_bf16_f32 v181,v138,v139
v_mfma_f32_16x16x32_bf16 a[152:155],a[244:247],v[204:207],a[152:155]
v_mfma_f32_16x16x32_bf16 a[28:31],a[248:251],v[168:171],a[28:31]
ds_read_b64_tr_b16 a[220:221],v7 offset:49408
ds_read_b64_tr_b16 a[222:223],v7 offset:57600
v_mfma_f32_16x16x32_bf16 a[28:31],a[252:255],v[172:175],a[28:31]
v_exp_f32 v152,v152
v_mfma_f32_16x16x32_bf16 a[92:95],a[248:251],v[184:187],a[92:95]
v_mfma_f32_16x16x32_bf16 a[92:95],a[252:255],v[188:191],a[92:95]
ds_read_b64_tr_b16 a[224:225],v8 offset:33024
ds_read_b64_tr_b16 a[226:227],v8 offset:41216
v_mfma_f32_16x16x32_bf16 a[156:159],a[248:251],v[200:203],a[156:159]
v_mfma_f32_16x16x32_bf16 a[156:159],a[252:255],v[204:207],a[156:159]
v_exp_f32 v153,v153
v_mfma_f32_16x16x32_bf16 a[32:35],a[192:195],v[168:171],a[32:35]
ds_read_b64_tr_b16 a[228:229],v8 offset:49408
ds_read_b64_tr_b16 a[230:231],v8 offset:57600
v_mfma_f32_16x16x32_bf16 a[32:35],a[196:199],v[172:175],a[32:35]
v_cvt_pk_bf16_f32 v196,v152,v153
v_mfma_f32_16x16x32_bf16 a[96:99],a[192:195],v[184:187],a[96:99]
v_mfma_f32_16x16x32_bf16 a[96:99],a[196:199],v[188:191],a[96:99]
ds_read_b64_tr_b16 a[232:233],v9 offset:33024
ds_read_b64_tr_b16 a[234:235],v9 offset:41216
v_mfma_f32_16x16x32_bf16 a[160:163],a[192:195],v[200:203],a[160:163]
v_exp_f32 v154,v154
v_mfma_f32_16x16x32_bf16 a[160:163],a[196:199],v[204:207],a[160:163]
v_mfma_f32_16x16x32_bf16 a[36:39],a[200:203],v[168:171],a[36:39]
ds_read_b64_tr_b16 a[236:237],v9 offset:49408
ds_read_b64_tr_b16 a[238:239],v9 offset:57600
s_waitcnt lgkmcnt(6)
v_mfma_f32_16x16x32_bf16 a[36:39],a[204:207],v[172:175],a[36:39]
v_mfma_f32_16x16x32_bf16 a[100:103],a[200:203],v[184:187],a[100:103]
v_exp_f32 v155,v155
v_mfma_f32_16x16x32_bf16 a[100:103],a[204:207],v[188:191],a[100:103]
ds_read_b64_tr_b16 a[240:241],v10 offset:33024
ds_read_b64_tr_b16 a[242:243],v10 offset:41216
v_mfma_f32_16x16x32_bf16 a[164:167],a[200:203],v[200:203],a[164:167]
v_cvt_pk_bf16_f32 v197,v154,v155
v_mfma_f32_16x16x32_bf16 a[164:167],a[204:207],v[204:207],a[164:167]
v_mfma_f32_16x16x32_bf16 a[40:43],a[208:211],v[168:171],a[40:43]
ds_read_b64_tr_b16 a[244:245],v10 offset:49408
ds_read_b64_tr_b16 a[246:247],v10 offset:57600
v_mfma_f32_16x16x32_bf16 a[40:43],a[212:215],v[172:175],a[40:43]
v_exp_f32 v124,v124
v_mfma_f32_16x16x32_bf16 a[104:107],a[208:211],v[184:187],a[104:107]
v_mfma_f32_16x16x32_bf16 a[104:107],a[212:215],v[188:191],a[104:107]
ds_read_b64_tr_b16 a[248:249],v11 offset:33024
ds_read_b64_tr_b16 a[250:251],v11 offset:41216
v_mfma_f32_16x16x32_bf16 a[168:171],a[208:211],v[200:203],a[168:171]
v_mfma_f32_16x16x32_bf16 a[168:171],a[212:215],v[204:207],a[168:171]
v_exp_f32 v125,v125
v_mfma_f32_16x16x32_bf16 a[44:47],a[216:219],v[168:171],a[44:47]
ds_read_b64_tr_b16 a[252:253],v11 offset:49408
ds_read_b64_tr_b16 a[254:255],v11 offset:57600
v_mfma_f32_16x16x32_bf16 a[44:47],a[220:223],v[172:175],a[44:47]
v_cvt_pk_bf16_f32 v166,v124,v125
v_mfma_f32_16x16x32_bf16 a[108:111],a[216:219],v[184:187],a[108:111]
v_mfma_f32_16x16x32_bf16 a[108:111],a[220:223],v[188:191],a[108:111]
v_exp_f32 v126,v126
v_mfma_f32_16x16x32_bf16 a[172:175],a[216:219],v[200:203],a[172:175]
v_mfma_f32_16x16x32_bf16 a[172:175],a[220:223],v[204:207],a[172:175]
v_mfma_f32_16x16x32_bf16 a[48:51],a[224:227],v[168:171],a[48:51]
s_waitcnt lgkmcnt(0)
s_waitcnt vmcnt(4)
s_barrier
s_waitcnt lgkmcnt(2)
v_mfma_f32_16x16x32_bf16 a[48:51],a[228:231],v[172:175],a[48:51]
ds_read_b128 a[192:195],v0 offset:32768
v_mfma_f32_16x16x32_bf16 a[112:115],a[224:227],v[184:187],a[112:115]
v_exp_f32 v127,v127
v_mfma_f32_16x16x32_bf16 a[112:115],a[228:231],v[188:191],a[112:115]
v_cvt_pk_bf16_f32 v167,v126,v127
v_mfma_f32_16x16x32_bf16 a[176:179],a[224:227],v[200:203],a[176:179]
ds_read_b128 a[196:199],v1 offset:32768
v_mfma_f32_16x16x32_bf16 a[176:179],a[228:231],v[204:207],a[176:179]
v_mfma_f32_16x16x32_bf16 a[52:55],a[232:235],v[168:171],a[52:55]
v_exp_f32 v140,v140
v_mfma_f32_16x16x32_bf16 a[52:55],a[236:239],v[172:175],a[52:55]
ds_read_b128 a[200:203],v2 offset:32768
v_mfma_f32_16x16x32_bf16 a[116:119],a[232:235],v[184:187],a[116:119]
v_mfma_f32_16x16x32_bf16 a[116:119],a[236:239],v[188:191],a[116:119]
v_exp_f32 v141,v141
v_mfma_f32_16x16x32_bf16 a[180:183],a[232:235],v[200:203],a[180:183]
ds_read_b128 a[204:207],v3 offset:32768
v_cvt_pk_bf16_f32 v182,v140,v141
v_mfma_f32_16x16x32_bf16 a[180:183],a[236:239],v[204:207],a[180:183]
v_mfma_f32_16x16x32_bf16 a[56:59],a[240:243],v[168:171],a[56:59]
v_mfma_f32_16x16x32_bf16 a[56:59],a[244:247],v[172:175],a[56:59]
ds_read_b128 a[208:211],v0 offset:33024
v_mfma_f32_16x16x32_bf16 a[120:123],a[240:243],v[184:187],a[120:123]
v_exp_f32 v142,v142
v_mfma_f32_16x16x32_bf16 a[120:123],a[244:247],v[188:191],a[120:123]
v_mfma_f32_16x16x32_bf16 a[184:187],a[240:243],v[200:203],a[184:187]
ds_read_b128 a[212:215],v1 offset:33024
v_mfma_f32_16x16x32_bf16 a[184:187],a[244:247],v[204:207],a[184:187]
v_exp_f32 v143,v143
v_mfma_f32_16x16x32_bf16 a[60:63],a[248:251],v[168:171],a[60:63]
v_cvt_pk_bf16_f32 v183,v142,v143
s_waitcnt lgkmcnt(6)
v_mfma_f32_16x16x32_bf16 a[60:63],a[252:255],v[172:175],a[60:63]
ds_read_b128 a[216:219],v2 offset:33024
v_mfma_f32_16x16x32_bf16 a[124:127],a[248:251],v[184:187],a[124:127]
v_mfma_f32_16x16x32_bf16 a[124:127],a[252:255],v[188:191],a[124:127]
v_mfma_f32_16x16x32_bf16 a[188:191],a[248:251],v[200:203],a[188:191]
ds_read_b128 a[220:223],v3 offset:33024
v_mfma_f32_16x16x32_bf16 a[188:191],a[252:255],v[204:207],a[188:191]
s_waitcnt lgkmcnt(2)
v_mfma_f32_16x16x32_bf16 v[112:115],a[192:195],v[16:19],v[208:211]
ds_read_b128 a[224:227],v0 offset:40960
v_mfma_f32_16x16x32_bf16 v[112:115],a[196:199],v[20:23],v[112:115]
v_exp_f32 v156,v156
v_mfma_f32_16x16x32_bf16 v[112:115],a[200:203],v[24:27],v[112:115]
v_mfma_f32_16x16x32_bf16 v[112:115],a[204:207],v[28:31],v[112:115]
ds_read_b128 a[228:231],v1 offset:40960
v_mfma_f32_16x16x32_bf16 v[112:115],a[208:211],v[32:35],v[112:115]
v_exp_f32 v157,v157
v_mfma_f32_16x16x32_bf16 v[112:115],a[212:215],v[36:39],v[112:115]
v_cvt_pk_bf16_f32 v198,v156,v157
s_waitcnt lgkmcnt(2)
v_mfma_f32_16x16x32_bf16 v[112:115],a[216:219],v[40:43],v[112:115]
ds_read_b128 a[232:235],v2 offset:40960
v_mfma_f32_16x16x32_bf16 v[112:115],a[220:223],v[44:47],v[112:115]
v_exp_f32 v158,v158
v_mfma_f32_16x16x32_bf16 v[128:131],a[192:195],v[48:51],v[212:215]
v_mfma_f32_16x16x32_bf16 v[128:131],a[196:199],v[52:55],v[128:131]
ds_read_b128 a[236:239],v3 offset:40960
v_mfma_f32_16x16x32_bf16 v[128:131],a[200:203],v[56:59],v[128:131]
v_exp_f32 v159,v159
v_mfma_f32_16x16x32_bf16 v[128:131],a[204:207],v[60:63],v[128:131]
v_cvt_pk_bf16_f32 v199,v158,v159
v_mfma_f32_16x16x32_bf16 v[128:131],a[208:211],v[64:67],v[128:131]
ds_read_b128 a[240:243],v0 offset:41216
v_mfma_f32_16x16x32_bf16 v[128:131],a[212:215],v[68:71],v[128:131]
v_mfma_f32_16x16x32_bf16 v[128:131],a[216:219],v[72:75],v[128:131]
v_exp_f32 v112,v112
v_mfma_f32_16x16x32_bf16 v[128:131],a[220:223],v[76:79],v[128:131]
ds_read_b128 a[244:247],v1 offset:41216
v_mfma_f32_16x16x32_bf16 v[144:147],a[192:195],v[80:83],v[216:219]
v_mfma_f32_16x16x32_bf16 v[144:147],a[196:199],v[84:87],v[144:147]
v_exp_f32 v113,v113
v_mfma_f32_16x16x32_bf16 v[144:147],a[200:203],v[88:91],v[144:147]
ds_read_b128 a[248:251],v2 offset:41216
v_cvt_pk_bf16_f32 v168,v112,v113
v_mfma_f32_16x16x32_bf16 v[144:147],a[204:207],v[92:95],v[144:147]
v_mfma_f32_16x16x32_bf16 v[144:147],a[208:211],v[96:99],v[144:147]
v_mfma_f32_16x16x32_bf16 v[144:147],a[212:215],v[100:103],v[144:147]
ds_read_b128 a[252:255],v3 offset:41216
v_mfma_f32_16x16x32_bf16 v[144:147],a[216:219],v[104:107],v[144:147]
v_exp_f32 v114,v114
v_mfma_f32_16x16x32_bf16 v[144:147],a[220:223],v[108:111],v[144:147]
s_waitcnt lgkmcnt(2)
v_mfma_f32_16x16x32_bf16 v[116:119],a[224:227],v[16:19],v[208:211]
ds_read_b128 a[192:195],v0 offset:49152
v_mfma_f32_16x16x32_bf16 v[116:119],a[228:231],v[20:23],v[116:119]
v_exp_f32 v115,v115
v_mfma_f32_16x16x32_bf16 v[116:119],a[232:235],v[24:27],v[116:119]
v_cvt_pk_bf16_f32 v169,v114,v115
v_mfma_f32_16x16x32_bf16 v[116:119],a[236:239],v[28:31],v[116:119]
ds_read_b128 a[196:199],v1 offset:49152
v_mfma_f32_16x16x32_bf16 v[116:119],a[240:243],v[32:35],v[116:119]
v_exp_f32 v128,v128
v_mfma_f32_16x16x32_bf16 v[116:119],a[244:247],v[36:39],v[116:119]
s_waitcnt lgkmcnt(2)
v_mfma_f32_16x16x32_bf16 v[116:119],a[248:251],v[40:43],v[116:119]
ds_read_b128 a[200:203],v2 offset:49152
v_mfma_f32_16x16x32_bf16 v[116:119],a[252:255],v[44:47],v[116:119]
v_exp_f32 v129,v129
v_mfma_f32_16x16x32_bf16 v[132:135],a[224:227],v[48:51],v[212:215]
v_cvt_pk_bf16_f32 v184,v128,v129
v_mfma_f32_16x16x32_bf16 v[132:135],a[228:231],v[52:55],v[132:135]
ds_read_b128 a[204:207],v3 offset:49152
v_mfma_f32_16x16x32_bf16 v[132:135],a[232:235],v[56:59],v[132:135]
v_mfma_f32_16x16x32_bf16 v[132:135],a[236:239],v[60:63],v[132:135]
v_exp_f32 v130,v130
v_mfma_f32_16x16x32_bf16 v[132:135],a[240:243],v[64:67],v[132:135]
ds_read_b128 a[208:211],v0 offset:49408
v_mfma_f32_16x16x32_bf16 v[132:135],a[244:247],v[68:71],v[132:135]
v_mfma_f32_16x16x32_bf16 v[132:135],a[248:251],v[72:75],v[132:135]
v_mfma_f32_16x16x32_bf16 v[132:135],a[252:255],v[76:79],v[132:135]
ds_read_b128 a[212:215],v1 offset:49408
v_mfma_f32_16x16x32_bf16 v[148:151],a[224:227],v[80:83],v[216:219]
v_exp_f32 v131,v131
v_mfma_f32_16x16x32_bf16 v[148:151],a[228:231],v[84:87],v[148:151]
v_cvt_pk_bf16_f32 v185,v130,v131
v_mfma_f32_16x16x32_bf16 v[148:151],a[232:235],v[88:91],v[148:151]
ds_read_b128 a[216:219],v2 offset:49408
v_mfma_f32_16x16x32_bf16 v[148:151],a[236:239],v[92:95],v[148:151]
v_exp_f32 v144,v144
v_mfma_f32_16x16x32_bf16 v[148:151],a[240:243],v[96:99],v[148:151]
ds_read_b128 a[220:223],v3 offset:49408
v_mfma_f32_16x16x32_bf16 v[148:151],a[244:247],v[100:103],v[148:151]
v_mfma_f32_16x16x32_bf16 v[148:151],a[248:251],v[104:107],v[148:151]
v_exp_f32 v145,v145
v_mfma_f32_16x16x32_bf16 v[148:151],a[252:255],v[108:111],v[148:151]
ds_read_b128 a[224:227],v0 offset:57344
s_waitcnt lgkmcnt(3)
v_mfma_f32_16x16x32_bf16 v[120:123],a[192:195],v[16:19],v[208:211]
v_cvt_pk_bf16_f32 v200,v144,v145
v_mfma_f32_16x16x32_bf16 v[120:123],a[196:199],v[20:23],v[120:123]
v_mfma_f32_16x16x32_bf16 v[120:123],a[200:203],v[24:27],v[120:123]
ds_read_b128 a[228:231],v1 offset:57344
v_mfma_f32_16x16x32_bf16 v[120:123],a[204:207],v[28:31],v[120:123]
v_exp_f32 v146,v146
v_mfma_f32_16x16x32_bf16 v[120:123],a[208:211],v[32:35],v[120:123]
v_mfma_f32_16x16x32_bf16 v[120:123],a[212:215],v[36:39],v[120:123]
ds_read_b128 a[232:235],v2 offset:57344
s_waitcnt lgkmcnt(3)
v_mfma_f32_16x16x32_bf16 v[120:123],a[216:219],v[40:43],v[120:123]
v_exp_f32 v147,v147
v_mfma_f32_16x16x32_bf16 v[120:123],a[220:223],v[44:47],v[120:123]
v_cvt_pk_bf16_f32 v201,v146,v147
v_mfma_f32_16x16x32_bf16 v[136:139],a[192:195],v[48:51],v[212:215]
ds_read_b128 a[236:239],v3 offset:57344
v_mfma_f32_16x16x32_bf16 v[136:139],a[196:199],v[52:55],v[136:139]
v_mfma_f32_16x16x32_bf16 v[136:139],a[200:203],v[56:59],v[136:139]
v_exp_f32 v116,v116
v_mfma_f32_16x16x32_bf16 v[136:139],a[204:207],v[60:63],v[136:139]
ds_read_b128 a[240:243],v0 offset:57600
v_mfma_f32_16x16x32_bf16 v[136:139],a[208:211],v[64:67],v[136:139]
v_mfma_f32_16x16x32_bf16 v[136:139],a[212:215],v[68:71],v[136:139]
v_exp_f32 v117,v117
v_mfma_f32_16x16x32_bf16 v[136:139],a[216:219],v[72:75],v[136:139]
ds_read_b128 a[244:247],v1 offset:57600
v_cvt_pk_bf16_f32 v170,v116,v117
v_mfma_f32_16x16x32_bf16 v[136:139],a[220:223],v[76:79],v[136:139]
v_mfma_f32_16x16x32_bf16 v[152:155],a[192:195],v[80:83],v[216:219]
v_mfma_f32_16x16x32_bf16 v[152:155],a[196:199],v[84:87],v[152:155]
ds_read_b128 a[248:251],v2 offset:57600
v_mfma_f32_16x16x32_bf16 v[152:155],a[200:203],v[88:91],v[152:155]
v_exp_f32 v118,v118
v_mfma_f32_16x16x32_bf16 v[152:155],a[204:207],v[92:95],v[152:155]
v_mfma_f32_16x16x32_bf16 v[152:155],a[208:211],v[96:99],v[152:155]
ds_read_b128 a[252:255],v3 offset:57600
v_mfma_f32_16x16x32_bf16 v[152:155],a[212:215],v[100:103],v[152:155]
v_exp_f32 v119,v119
v_mfma_f32_16x16x32_bf16 v[152:155],a[216:219],v[104:107],v[152:155]
v_cvt_pk_bf16_f32 v171,v118,v119
v_mfma_f32_16x16x32_bf16 v[152:155],a[220:223],v[108:111],v[152:155]
s_waitcnt lgkmcnt(2)
v_mfma_f32_16x16x32_bf16 v[124:127],a[224:227],v[16:19],v[208:211]
v_exp_f32 v132,v132
v_mfma_f32_16x16x32_bf16 v[124:127],a[228:231],v[20:23],v[124:127]
v_mfma_f32_16x16x32_bf16 v[124:127],a[232:235],v[24:27],v[124:127]
s_waitcnt lgkmcnt(0)
s_waitcnt vmcnt(4)
s_barrier
v_mfma_f32_16x16x32_bf16 v[124:127],a[236:239],v[28:31],v[124:127]
ds_read_b64_tr_b16 a[192:193],v4 offset:0
ds_read_b64_tr_b16 a[194:195],v4 offset:8192
s_add_u32 m0,s25,32768
s_add_u32 s28,s26,131072
buffer_load_dwordx4 v12,s[4:7],s28 offen nt lds
buffer_load_dwordx4 v13,s[4:7],s28 offen offset:1024 nt lds
buffer_load_dwordx4 v14,s[4:7],s28 offen offset:2048 nt lds
buffer_load_dwordx4 v15,s[4:7],s28 offen offset:3072 nt lds
v_mfma_f32_16x16x32_bf16 v[124:127],a[240:243],v[32:35],v[124:127]
v_exp_f32 v133,v133
v_mfma_f32_16x16x32_bf16 v[124:127],a[244:247],v[36:39],v[124:127]
v_cvt_pk_bf16_f32 v186,v132,v133
s_waitcnt lgkmcnt(2)
v_mfma_f32_16x16x32_bf16 v[124:127],a[248:251],v[40:43],v[124:127]
ds_read_b64_tr_b16 a[196:197],v4 offset:16384
ds_read_b64_tr_b16 a[198:199],v4 offset:24576
v_mfma_f32_16x16x32_bf16 v[124:127],a[252:255],v[44:47],v[124:127]
v_mfma_f32_16x16x32_bf16 v[140:143],a[224:227],v[48:51],v[212:215]
v_mfma_f32_16x16x32_bf16 v[140:143],a[228:231],v[52:55],v[140:143]
ds_read_b64_tr_b16 a[200:201],v5 offset:0
ds_read_b64_tr_b16 a[202:203],v5 offset:8192
v_mfma_f32_16x16x32_bf16 v[140:143],a[232:235],v[56:59],v[140:143]
v_exp_f32 v134,v134
v_mfma_f32_16x16x32_bf16 v[140:143],a[236:239],v[60:63],v[140:143]
v_mfma_f32_16x16x32_bf16 v[140:143],a[240:243],v[64:67],v[140:143]
ds_read_b64_tr_b16 a[204:205],v5 offset:16384
ds_read_b64_tr_b16 a[206:207],v5 offset:24576
v_mfma_f32_16x16x32_bf16 v[140:143],a[244:247],v[68:71],v[140:143]
v_mfma_f32_16x16x32_bf16 v[140:143],a[248:251],v[72:75],v[140:143]
v_exp_f32 v135,v135
v_mfma_f32_16x16x32_bf16 v[140:143],a[252:255],v[76:79],v[140:143]
ds_read_b64_tr_b16 a[208:209],v6 offset:0
ds_read_b64_tr_b16 a[210:211],v6 offset:8192
v_mfma_f32_16x16x32_bf16 v[156:159],a[224:227],v[80:83],v[216:219]
v_cvt_pk_bf16_f32 v187,v134,v135
v_mfma_f32_16x16x32_bf16 v[156:159],a[228:231],v[84:87],v[156:159]
v_mfma_f32_16x16x32_bf16 v[156:159],a[232:235],v[88:91],v[156:159]
ds_read_b64_tr_b16 a[212:213],v6 offset:16384
ds_read_b64_tr_b16 a[214:215],v6 offset:24576
v_mfma_f32_16x16x32_bf16 v[156:159],a[236:239],v[92:95],v[156:159]
v_exp_f32 v148,v148
v_mfma_f32_16x16x32_bf16 v[156:159],a[240:243],v[96:99],v[156:159]
v_mfma_f32_16x16x32_bf16 v[156:159],a[244:247],v[100:103],v[156:159]
ds_read_b64_tr_b16 a[216:217],v7 offset:0
ds_read_b64_tr_b16 a[218:219],v7 offset:8192
v_mfma_f32_16x16x32_bf16 v[156:159],a[248:251],v[104:107],v[156:159]
v_mfma_f32_16x16x32_bf16 v[156:159],a[252:255],v[108:111],v[156:159]
v_exp_f32 v149,v149
v_mfma_f32_16x16x32_bf16 v[220:223],v[232:235],v[160:163],v[220:223]
ds_read_b64_tr_b16 a[220:221],v7 offset:16384
ds_read_b64_tr_b16 a[222:223],v7 offset:24576
v_mfma_f32_16x16x32_bf16 v[220:223],v[232:235],v[164:167],v[220:223]
v_cvt_pk_bf16_f32 v202,v148,v149
v_mfma_f32_16x16x32_bf16 v[224:227],v[232:235],v[176:179],v[224:227]
v_mfma_f32_16x16x32_bf16 v[224:227],v[232:235],v[180:183],v[224:227]
ds_read_b64_tr_b16 a[224:225],v8 offset:0
ds_read_b64_tr_b16 a[226:227],v8 offset:8192
v_mfma_f32_16x16x32_bf16 v[228:231],v[232:235],v[192:195],v[228:231]
v_exp_f32 v150,v150
v_mfma_f32_16x16x32_bf16 v[228:231],v[232:235],v[196:199],v[228:231]
s_waitcnt lgkmcnt(4)
v_mfma_f32_16x16x32_bf16 a[0:3],a[192:195],v[160:163],a[0:3]
ds_read_b64_tr_b16 a[228:229],v8 offset:16384
ds_read_b64_tr_b16 a[230:231],v8 offset:24576
v_mfma_f32_16x16x32_bf16 a[0:3],a[196:199],v[164:167],a[0:3]
v_mfma_f32_16x16x32_bf16 a[64:67],a[192:195],v[176:179],a[64:67]
v_exp_f32 v151,v151
v_mfma_f32_16x16x32_bf16 a[64:67],a[196:199],v[180:183],a[64:67]
ds_read_b64_tr_b16 a[232:233],v9 offset:0
ds_read_b64_tr_b16 a[234:235],v9 offset:8192
v_mfma_f32_16x16x32_bf16 a[128:131],a[192:195],v[192:195],a[128:131]
v_cvt_pk_bf16_f32 v203,v150,v151
v_mfma_f32_16x16x32_bf16 a[128:131],a[196:199],v[196:199],a[128:131]
v_mfma_f32_16x16x32_bf16 a[4:7],a[200:203],v[160:163],a[4:7]
ds_read_b64_tr_b16 a[236:237],v9 offset:16384
ds_read_b64_tr_b16 a[238:239],v9 offset:24576
v_mfma_f32_16x16x32_bf16 a[4:7],a[204:207],v[164:167],a[4:7]
v_exp_f32 v120,v120
v_mfma_f32_16x16x32_bf16 a[68:71],a[200:203],v[176:179],a[68:71]
v_mfma_f32_16x16x32_bf16 a[68:71],a[204:207],v[180:183],a[68:71]
ds_read_b64_tr_b16 a[240:241],v10 offset:0
ds_read_b64_tr_b16 a[242:243],v10 offset:8192
v_mfma_f32_16x16x32_bf16 a[132:135],a[200:203],v[192:195],a[132:135]
v_mfma_f32_16x16x32_bf16 a[132:135],a[204:207],v[196:199],a[132:135]
v_exp_f32 v121,v121
v_mfma_f32_16x16x32_bf16 a[8:11],a[208:211],v[160:163],a[8:11]
ds_read_b64_tr_b16 a[244:245],v10 offset:16384
ds_read_b64_tr_b16 a[246:247],v10 offset:24576
v_mfma_f32_16x16x32_bf16 a[8:11],a[212:215],v[164:167],a[8:11]
v_cvt_pk_bf16_f32 v172,v120,v121
v_mfma_f32_16x16x32_bf16 a[72:75],a[208:211],v[176:179],a[72:75]
v_mfma_f32_16x16x32_bf16 a[72:75],a[212:215],v[180:183],a[72:75]
ds_read_b64_tr_b16 a[248:249],v11 offset:0
ds_read_b64_tr_b16 a[250:251],v11 offset:8192
v_mfma_f32_16x16x32_bf16 a[136:139],a[208:211],v[192:195],a[136:139]
v_exp_f32 v122,v122
v_mfma_f32_16x16x32_bf16 a[136:139],a[212:215],v[196:199],a[136:139]
v_mfma_f32_16x16x32_bf16 a[12:15],a[216:219],v[160:163],a[12:15]
ds_read_b64_tr_b16 a[252:253],v11 offset:16384
ds_read_b64_tr_b16 a[254:255],v11 offset:24576
s_waitcnt lgkmcnt(6)
v_mfma_f32_16x16x32_bf16 a[12:15],a[220:223],v[164:167],a[12:15]
v_mfma_f32_16x16x32_bf16 a[76:79],a[216:219],v[176:179],a[76:79]
v_exp_f32 v123,v123
v_mfma_f32_16x16x32_bf16 a[76:79],a[220:223],v[180:183],a[76:79]
ds_read_b64_tr_b16 a[192:193],v4 offset:256
ds_read_b64_tr_b16 a[194:195],v4 offset:8448
v_mfma_f32_16x16x32_bf16 a[140:143],a[216:219],v[192:195],a[140:143]
v_cvt_pk_bf16_f32 v173,v122,v123
v_mfma_f32_16x16x32_bf16 a[140:143],a[220:223],v[196:199],a[140:143]
v_mfma_f32_16x16x32_bf16 a[16:19],a[224:227],v[160:163],a[16:19]
ds_read_b64_tr_b16 a[196:197],v4 offset:16640
ds_read_b64_tr_b16 a[198:199],v4 offset:24832
v_mfma_f32_16x16x32_bf16 a[16:19],a[228:231],v[164:167],a[16:19]
v_exp_f32 v136,v136
v_mfma_f32_16x16x32_bf16 a[80:83],a[224:227],v[176:179],a[80:83]
v_mfma_f32_16x16x32_bf16 a[80:83],a[228:231],v[180:183],a[80:83]
ds_read_b64_tr_b16 a[200:201],v5 offset:256
ds_read_b64_tr_b16 a[202:203],v5 offset:8448
v_mfma_f32_16x16x32_bf16 a[144:147],a[224:227],v[192:195],a[144:147]
v_mfma_f32_16x16x32_bf16 a[144:147],a[228:231],v[196:199],a[144:147]
v_exp_f32 v137,v137
v_mfma_f32_16x16x32_bf16 a[20:23],a[232:235],v[160:163],a[20:23]
ds_read_b64_tr_b16 a[204:205],v5 offset:16640
ds_read_b64_tr_b16 a[206:207],v5 offset:24832
v_mfma_f32_16x16x32_bf16 a[20:23],a[236:239],v[164:167],a[20:23]
v_cvt_pk_bf16_f32 v188,v136,v137
v_mfma_f32_16x16x32_bf16 a[84:87],a[232:235],v[176:179],a[84:87]
v_mfma_f32_16x16x32_bf16 a[84:87],a[236:239],v[180:183],a[84:87]
ds_read_b64_tr_b16 a[208:209],v6 offset:256
ds_read_b64_tr_b16 a[210:211],v6 offset:8448
v_mfma_f32_16x16x32_bf16 a[148:151],a[232:235],v[192:195],a[148:151]
v_exp_f32 v138,v138
v_mfma_f32_16x16x32_bf16 a[148:151],a[236:239],v[196:199],a[148:151]
v_mfma_f32_16x16x32_bf16 a[24:27],a[240:243],v[160:163],a[24:27]
ds_read_b64_tr_b16 a[212:213],v6 offset:16640
ds_read_b64_tr_b16 a[214:215],v6 offset:24832
s_waitcnt lgkmcnt(6)
v_mfma_f32_16x16x32_bf16 a[24:27],a[244:247],v[164:167],a[24:27]
v_mfma_f32_16x16x32_bf16 a[88:91],a[240:243],v[176:179],a[88:91]
v_exp_f32 v139,v139
v_mfma_f32_16x16x32_bf16 a[88:91],a[244:247],v[180:183],a[88:91]
ds_read_b64_tr_b16 a[216:217],v7 offset:256
ds_read_b64_tr_b16 a[218:219],v7 offset:8448
v_mfma_f32_16x16x32_bf16 a[152:155],a[240:243],v[192:195],a[152:155]
v_cvt_pk_bf16_f32 v189,v138,v139
v_mfma_f32_16x16x32_bf16 a[152:155],a[244:247],v[196:199],a[152:155]
v_mfma_f32_16x16x32_bf16 a[28:31],a[248:251],v[160:163],a[28:31]
ds_read_b64_tr_b16 a[220:221],v7 offset:16640
ds_read_b64_tr_b16 a[222:223],v7 offset:24832
v_mfma_f32_16x16x32_bf16 a[28:31],a[252:255],v[164:167],a[28:31]
v_exp_f32 v152,v152
v_mfma_f32_16x16x32_bf16 a[92:95],a[248:251],v[176:179],a[92:95]
v_mfma_f32_16x16x32_bf16 a[92:95],a[252:255],v[180:183],a[92:95]
ds_read_b64_tr_b16 a[224:225],v8 offset:256
ds_read_b64_tr_b16 a[226:227],v8 offset:8448
v_mfma_f32_16x16x32_bf16 a[156:159],a[248:251],v[192:195],a[156:159]
v_mfma_f32_16x16x32_bf16 a[156:159],a[252:255],v[196:199],a[156:159]
v_exp_f32 v153,v153
v_mfma_f32_16x16x32_bf16 a[32:35],a[192:195],v[160:163],a[32:35]
ds_read_b64_tr_b16 a[228:229],v8 offset:16640
ds_read_b64_tr_b16 a[230:231],v8 offset:24832
v_mfma_f32_16x16x32_bf16 a[32:35],a[196:199],v[164:167],a[32:35]
v_cvt_pk_bf16_f32 v204,v152,v153
v_mfma_f32_16x16x32_bf16 a[96:99],a[192:195],v[176:179],a[96:99]
v_mfma_f32_16x16x32_bf16 a[96:99],a[196:199],v[180:183],a[96:99]
ds_read_b64_tr_b16 a[232:233],v9 offset:256
ds_read_b64_tr_b16 a[234:235],v9 offset:8448
v_mfma_f32_16x16x32_bf16 a[160:163],a[192:195],v[192:195],a[160:163]
v_exp_f32 v154,v154
v_mfma_f32_16x16x32_bf16 a[160:163],a[196:199],v[196:199],a[160:163]
v_mfma_f32_16x16x32_bf16 a[36:39],a[200:203],v[160:163],a[36:39]
ds_read_b64_tr_b16 a[236:237],v9 offset:16640
ds_read_b64_tr_b16 a[238:239],v9 offset:24832
s_waitcnt lgkmcnt(6)
v_mfma_f32_16x16x32_bf16 a[36:39],a[204:207],v[164:167],a[36:39]
v_mfma_f32_16x16x32_bf16 a[100:103],a[200:203],v[176:179],a[100:103]
v_exp_f32 v155,v155
v_mfma_f32_16x16x32_bf16 a[100:103],a[204:207],v[180:183],a[100:103]
ds_read_b64_tr_b16 a[240:241],v10 offset:256
ds_read_b64_tr_b16 a[242:243],v10 offset:8448
v_mfma_f32_16x16x32_bf16 a[164:167],a[200:203],v[192:195],a[164:167]
v_cvt_pk_bf16_f32 v205,v154,v155
v_mfma_f32_16x16x32_bf16 a[164:167],a[204:207],v[196:199],a[164:167]
v_mfma_f32_16x16x32_bf16 a[40:43],a[208:211],v[160:163],a[40:43]
ds_read_b64_tr_b16 a[244:245],v10 offset:16640
ds_read_b64_tr_b16 a[246:247],v10 offset:24832
v_mfma_f32_16x16x32_bf16 a[40:43],a[212:215],v[164:167],a[40:43]
v_exp_f32 v124,v124
v_mfma_f32_16x16x32_bf16 a[104:107],a[208:211],v[176:179],a[104:107]
v_mfma_f32_16x16x32_bf16 a[104:107],a[212:215],v[180:183],a[104:107]
ds_read_b64_tr_b16 a[248:249],v11 offset:256
ds_read_b64_tr_b16 a[250:251],v11 offset:8448
v_mfma_f32_16x16x32_bf16 a[168:171],a[208:211],v[192:195],a[168:171]
v_mfma_f32_16x16x32_bf16 a[168:171],a[212:215],v[196:199],a[168:171]
v_exp_f32 v125,v125
v_mfma_f32_16x16x32_bf16 a[44:47],a[216:219],v[160:163],a[44:47]
ds_read_b64_tr_b16 a[252:253],v11 offset:16640
ds_read_b64_tr_b16 a[254:255],v11 offset:24832
v_mfma_f32_16x16x32_bf16 a[44:47],a[220:223],v[164:167],a[44:47]
v_cvt_pk_bf16_f32 v174,v124,v125
v_mfma_f32_16x16x32_bf16 a[108:111],a[216:219],v[176:179],a[108:111]
v_mfma_f32_16x16x32_bf16 a[108:111],a[220:223],v[180:183],a[108:111]
v_exp_f32 v126,v126
v_mfma_f32_16x16x32_bf16 a[172:175],a[216:219],v[192:195],a[172:175]
v_mfma_f32_16x16x32_bf16 a[172:175],a[220:223],v[196:199],a[172:175]
v_mfma_f32_16x16x32_bf16 a[48:51],a[224:227],v[160:163],a[48:51]
s_waitcnt lgkmcnt(0)
s_waitcnt vmcnt(4)
s_barrier
s_waitcnt lgkmcnt(2)
v_mfma_f32_16x16x32_bf16 a[48:51],a[228:231],v[164:167],a[48:51]
ds_read_b128 a[192:195],v0 offset:0
v_mfma_f32_16x16x32_bf16 a[112:115],a[224:227],v[176:179],a[112:115]
v_exp_f32 v127,v127
v_mfma_f32_16x16x32_bf16 a[112:115],a[228:231],v[180:183],a[112:115]
v_cvt_pk_bf16_f32 v175,v126,v127
v_mfma_f32_16x16x32_bf16 a[176:179],a[224:227],v[192:195],a[176:179]
ds_read_b128 a[196:199],v1 offset:0
v_mfma_f32_16x16x32_bf16 a[176:179],a[228:231],v[196:199],a[176:179]
v_mfma_f32_16x16x32_bf16 a[52:55],a[232:235],v[160:163],a[52:55]
v_exp_f32 v140,v140
v_mfma_f32_16x16x32_bf16 a[52:55],a[236:239],v[164:167],a[52:55]
ds_read_b128 a[200:203],v2 offset:0
v_mfma_f32_16x16x32_bf16 a[116:119],a[232:235],v[176:179],a[116:119]
v_mfma_f32_16x16x32_bf16 a[116:119],a[236:239],v[180:183],a[116:119]
v_exp_f32 v141,v141
v_mfma_f32_16x16x32_bf16 a[180:183],a[232:235],v[192:195],a[180:183]
ds_read_b128 a[204:207],v3 offset:0
v_cvt_pk_bf16_f32 v190,v140,v141
v_mfma_f32_16x16x32_bf16 a[180:183],a[236:239],v[196:199],a[180:183]
v_mfma_f32_16x16x32_bf16 a[56:59],a[240:243],v[160:163],a[56:59]
v_mfma_f32_16x16x32_bf16 a[56:59],a[244:247],v[164:167],a[56:59]
ds_read_b128 a[208:211],v0 offset:256
v_mfma_f32_16x16x32_bf16 a[120:123],a[240:243],v[176:179],a[120:123]
v_exp_f32 v142,v142
v_mfma_f32_16x16x32_bf16 a[120:123],a[244:247],v[180:183],a[120:123]
v_mfma_f32_16x16x32_bf16 a[184:187],a[240:243],v[192:195],a[184:187]
ds_read_b128 a[212:215],v1 offset:256
v_mfma_f32_16x16x32_bf16 a[184:187],a[244:247],v[196:199],a[184:187]
v_exp_f32 v143,v143
v_mfma_f32_16x16x32_bf16 a[60:63],a[248:251],v[160:163],a[60:63]
v_cvt_pk_bf16_f32 v191,v142,v143
s_waitcnt lgkmcnt(6)
v_mfma_f32_16x16x32_bf16 a[60:63],a[252:255],v[164:167],a[60:63]
ds_read_b128 a[216:219],v2 offset:256
v_mfma_f32_16x16x32_bf16 a[124:127],a[248:251],v[176:179],a[124:127]
v_mfma_f32_16x16x32_bf16 a[124:127],a[252:255],v[180:183],a[124:127]
v_mfma_f32_16x16x32_bf16 a[188:191],a[248:251],v[192:195],a[188:191]
ds_read_b128 a[220:223],v3 offset:256
v_mfma_f32_16x16x32_bf16 a[188:191],a[252:255],v[196:199],a[188:191]
s_add_u32 s26,s26,65536
s_cmp_lt_u32 s26,950272
s_cbranch_scc1 LOOP_A
M29_A:
s_waitcnt lgkmcnt(2)
v_mfma_f32_16x16x32_bf16 v[112:115],a[192:195],v[16:19],v[208:211]
ds_read_b128 a[224:227],v0 offset:8192
v_lshrrev_b32 v254,3,v253
v_mfma_f32_16x16x32_bf16 v[112:115],a[196:199],v[20:23],v[112:115]
v_and_b32 v255,7,v253
v_and_b32 v251,6,v254
v_mfma_f32_16x16x32_bf16 v[112:115],a[200:203],v[24:27],v[112:115]
v_xor_b32 v255,v255,v251
v_lshlrev_b32 v255,4,v255
v_mfma_f32_16x16x32_bf16 v[112:115],a[204:207],v[28:31],v[112:115]
ds_read_b128 a[228:231],v1 offset:8192
v_mul_u32_u24 v254,0x380,v254
v_mfma_f32_16x16x32_bf16 v[112:115],a[208:211],v[32:35],v[112:115]
v_add_u32 v236,v254,v255
v_add_u32 v237,6144,v236
v_mfma_f32_16x16x32_bf16 v[112:115],a[212:215],v[36:39],v[112:115]
v_add_u32 v238,12288,v236
s_waitcnt lgkmcnt(2)
v_mfma_f32_16x16x32_bf16 v[112:115],a[216:219],v[40:43],v[112:115]
ds_read_b128 a[232:235],v2 offset:8192
v_add_u32 v239,18432,v236
v_mfma_f32_16x16x32_bf16 v[112:115],a[220:223],v[44:47],v[112:115]
v_lshrrev_b32 v254,2,v253
v_and_b32 v255,3,v253
v_mfma_f32_16x16x32_bf16 v[128:131],a[192:195],v[48:51],v[212:215]
v_bfe_u32 v251,v253,3,2
v_lshlrev_b32 v254,7,v254
v_mfma_f32_16x16x32_bf16 v[128:131],a[196:199],v[52:55],v[128:131]
ds_read_b128 a[236:239],v3 offset:8192
v_lshl_add_u32 v254,v255,3,v254
v_mfma_f32_16x16x32_bf16 v[128:131],a[200:203],v[56:59],v[128:131]
v_xor_b32 v255,0,v251
v_lshl_add_u32 v244,v255,5,v254
v_mfma_f32_16x16x32_bf16 v[128:131],a[204:207],v[60:63],v[128:131]
v_add_u32 v240,81920,v244
v_xor_b32 v255,1,v251
v_mfma_f32_16x16x32_bf16 v[128:131],a[208:211],v[64:67],v[128:131]
ds_read_b128 a[240:243],v0 offset:8448
v_lshl_add_u32 v245,v255,5,v254
v_mfma_f32_16x16x32_bf16 v[128:131],a[212:215],v[68:71],v[128:131]
v_add_u32 v241,81920,v245
v_xor_b32 v255,2,v251
v_mfma_f32_16x16x32_bf16 v[128:131],a[216:219],v[72:75],v[128:131]
v_lshl_add_u32 v246,v255,5,v254
v_add_u32 v242,81920,v246
v_mfma_f32_16x16x32_bf16 v[128:131],a[220:223],v[76:79],v[128:131]
ds_read_b128 a[244:247],v1 offset:8448
v_xor_b32 v255,3,v251
v_mfma_f32_16x16x32_bf16 v[144:147],a[192:195],v[80:83],v[216:219]
v_lshl_add_u32 v247,v255,5,v254
v_add_u32 v243,81920,v247
v_mfma_f32_16x16x32_bf16 v[144:147],a[196:199],v[84:87],v[144:147]
v_lshlrev_b32 v248,4,v253
v_add_u32 v249,16384,v248
v_mfma_f32_16x16x32_bf16 v[144:147],a[200:203],v[88:91],v[144:147]
ds_read_b128 a[248:251],v2 offset:8448
s_mul_i32 s31,s24,5120
v_mfma_f32_16x16x32_bf16 v[144:147],a[204:207],v[92:95],v[144:147]
s_add_u32 s31,s31,65536
v_lshl_add_u32 v252,v253,3,s31
v_mfma_f32_16x16x32_bf16 v[144:147],a[208:211],v[96:99],v[144:147]
v_mov_b32 v251,v252
v_mfma_f32_16x16x32_bf16 v[144:147],a[212:215],v[100:103],v[144:147]
ds_read_b128 a[252:255],v3 offset:8448
v_mfma_f32_16x16x32_bf16 v[144:147],a[216:219],v[104:107],v[144:147]
v_exp_f32 v156,v156
v_mfma_f32_16x16x32_bf16 v[144:147],a[220:223],v[108:111],v[144:147]
s_waitcnt lgkmcnt(2)
v_mfma_f32_16x16x32_bf16 v[116:119],a[224:227],v[16:19],v[208:211]
ds_read_b128 a[192:195],v0 offset:16384
v_mfma_f32_16x16x32_bf16 v[116:119],a[228:231],v[20:23],v[116:119]
v_exp_f32 v157,v157
v_mfma_f32_16x16x32_bf16 v[116:119],a[232:235],v[24:27],v[116:119]
v_cvt_pk_bf16_f32 v206,v156,v157
v_mfma_f32_16x16x32_bf16 v[116:119],a[236:239],v[28:31],v[116:119]
ds_read_b128 a[196:199],v1 offset:16384
v_mfma_f32_16x16x32_bf16 v[116:119],a[240:243],v[32:35],v[116:119]
v_exp_f32 v158,v158
v_mfma_f32_16x16x32_bf16 v[116:119],a[244:247],v[36:39],v[116:119]
s_waitcnt lgkmcnt(2)
v_mfma_f32_16x16x32_bf16 v[116:119],a[248:251],v[40:43],v[116:119]
ds_read_b128 a[200:203],v2 offset:16384
v_mfma_f32_16x16x32_bf16 v[116:119],a[252:255],v[44:47],v[116:119]
v_exp_f32 v159,v159
v_mfma_f32_16x16x32_bf16 v[132:135],a[224:227],v[48:51],v[212:215]
v_cvt_pk_bf16_f32 v207,v158,v159
v_mfma_f32_16x16x32_bf16 v[132:135],a[228:231],v[52:55],v[132:135]
ds_read_b128 a[204:207],v3 offset:16384
v_mfma_f32_16x16x32_bf16 v[132:135],a[232:235],v[56:59],v[132:135]
v_exp_f32 v112,v112
v_mfma_f32_16x16x32_bf16 v[132:135],a[236:239],v[60:63],v[132:135]
v_exp_f32 v113,v113
v_mfma_f32_16x16x32_bf16 v[132:135],a[240:243],v[64:67],v[132:135]
ds_read_b128 a[208:211],v0 offset:16640
v_cvt_pk_bf16_f32 v160,v112,v113
v_mfma_f32_16x16x32_bf16 v[132:135],a[244:247],v[68:71],v[132:135]
v_exp_f32 v114,v114
v_mfma_f32_16x16x32_bf16 v[132:135],a[248:251],v[72:75],v[132:135]
v_mfma_f32_16x16x32_bf16 v[132:135],a[252:255],v[76:79],v[132:135]
ds_read_b128 a[212:215],v1 offset:16640
v_mfma_f32_16x16x32_bf16 v[148:151],a[224:227],v[80:83],v[216:219]
v_exp_f32 v115,v115
v_mfma_f32_16x16x32_bf16 v[148:151],a[228:231],v[84:87],v[148:151]
v_cvt_pk_bf16_f32 v161,v114,v115
v_mfma_f32_16x16x32_bf16 v[148:151],a[232:235],v[88:91],v[148:151]
ds_read_b128 a[216:219],v2 offset:16640
v_mfma_f32_16x16x32_bf16 v[148:151],a[236:239],v[92:95],v[148:151]
v_exp_f32 v128,v128
v_mfma_f32_16x16x32_bf16 v[148:151],a[240:243],v[96:99],v[148:151]
ds_read_b128 a[220:223],v3 offset:16640
v_mfma_f32_16x16x32_bf16 v[148:151],a[244:247],v[100:103],v[148:151]
v_mfma_f32_16x16x32_bf16 v[148:151],a[248:251],v[104:107],v[148:151]
v_exp_f32 v129,v129
v_mfma_f32_16x16x32_bf16 v[148:151],a[252:255],v[108:111],v[148:151]
ds_read_b128 a[224:227],v0 offset:24576
s_waitcnt lgkmcnt(3)
v_mfma_f32_16x16x32_bf16 v[120:123],a[192:195],v[16:19],v[208:211]
v_cvt_pk_bf16_f32 v176,v128,v129
v_mfma_f32_16x16x32_bf16 v[120:123],a[196:199],v[20:23],v[120:123]
v_exp_f32 v130,v130
v_mfma_f32_16x16x32_bf16 v[120:123],a[200:203],v[24:27],v[120:123]
ds_read_b128 a[228:231],v1 offset:24576
v_mfma_f32_16x16x32_bf16 v[120:123],a[204:207],v[28:31],v[120:123]
v_mfma_f32_16x16x32_bf16 v[120:123],a[208:211],v[32:35],v[120:123]
v_exp_f32 v131,v131
v_mfma_f32_16x16x32_bf16 v[120:123],a[212:215],v[36:39],v[120:123]
ds_read_b128 a[232:235],v2 offset:24576
s_waitcnt lgkmcnt(3)
v_mfma_f32_16x16x32_bf16 v[120:123],a[216:219],v[40:43],v[120:123]
v_cvt_pk_bf16_f32 v177,v130,v131
v_mfma_f32_16x16x32_bf16 v[120:123],a[220:223],v[44:47],v[120:123]
v_exp_f32 v144,v144
v_mfma_f32_16x16x32_bf16 v[136:139],a[192:195],v[48:51],v[212:215]
ds_read_b128 a[236:239],v3 offset:24576
v_mfma_f32_16x16x32_bf16 v[136:139],a[196:199],v[52:55],v[136:139]
v_exp_f32 v145,v145
v_mfma_f32_16x16x32_bf16 v[136:139],a[200:203],v[56:59],v[136:139]
v_cvt_pk_bf16_f32 v192,v144,v145
v_mfma_f32_16x16x32_bf16 v[136:139],a[204:207],v[60:63],v[136:139]
ds_read_b128 a[240:243],v0 offset:24832
v_mfma_f32_16x16x32_bf16 v[136:139],a[208:211],v[64:67],v[136:139]
v_exp_f32 v146,v146
v_mfma_f32_16x16x32_bf16 v[136:139],a[212:215],v[68:71],v[136:139]
v_mfma_f32_16x16x32_bf16 v[136:139],a[216:219],v[72:75],v[136:139]
ds_read_b128 a[244:247],v1 offset:24832
v_mfma_f32_16x16x32_bf16 v[136:139],a[220:223],v[76:79],v[136:139]
v_exp_f32 v147,v147
v_mfma_f32_16x16x32_bf16 v[152:155],a[192:195],v[80:83],v[216:219]
v_cvt_pk_bf16_f32 v193,v146,v147
v_mfma_f32_16x16x32_bf16 v[152:155],a[196:199],v[84:87],v[152:155]
ds_read_b128 a[248:251],v2 offset:24832
v_mfma_f32_16x16x32_bf16 v[152:155],a[200:203],v[88:91],v[152:155]
v_exp_f32 v116,v116
v_mfma_f32_16x16x32_bf16 v[152:155],a[204:207],v[92:95],v[152:155]
v_mfma_f32_16x16x32_bf16 v[152:155],a[208:211],v[96:99],v[152:155]
ds_read_b128 a[252:255],v3 offset:24832
v_mfma_f32_16x16x32_bf16 v[152:155],a[212:215],v[100:103],v[152:155]
v_mfma_f32_16x16x32_bf16 v[152:155],a[216:219],v[104:107],v[152:155]
v_mfma_f32_16x16x32_bf16 v[152:155],a[220:223],v[108:111],v[152:155]
s_waitcnt lgkmcnt(2)
v_mfma_f32_16x16x32_bf16 v[124:127],a[224:227],v[16:19],v[208:211]
v_exp_f32 v118,v118
v_mfma_f32_16x16x32_bf16 v[124:127],a[228:231],v[20:23],v[124:127]
v_exp_f32 v117,v117
v_mfma_f32_16x16x32_bf16 v[124:127],a[232:235],v[24:27],v[124:127]
s_waitcnt lgkmcnt(0)
s_barrier
v_mfma_f32_16x16x32_bf16 v[124:127],a[236:239],v[28:31],v[124:127]
ds_read_b64_tr_b16 a[192:193],v4 offset:32768
ds_read_b64_tr_b16 a[194:195],v4 offset:40960
v_mfma_f32_16x16x32_bf16 v[124:127],a[240:243],v[32:35],v[124:127]
s_add_u32 m0,s25,131072
s_add_u32 s28,s67,0
v_mfma_f32_16x16x32_bf16 v[124:127],a[244:247],v[36:39],v[124:127]
v_cvt_pk_bf16_f32 v162,v116,v117
s_waitcnt lgkmcnt(2)
v_mfma_f32_16x16x32_bf16 v[124:127],a[248:251],v[40:43],v[124:127]
ds_read_b64_tr_b16 a[196:197],v4 offset:49152
ds_read_b64_tr_b16 a[198:199],v4 offset:57344
v_mfma_f32_16x16x32_bf16 v[124:127],a[252:255],v[44:47],v[124:127]
buffer_load_dwordx4 v236,s[96:99],s28 offen lds
v_mfma_f32_16x16x32_bf16 v[140:143],a[224:227],v[48:51],v[212:215]
buffer_load_dwordx4 v237,s[96:99],s28 offen offset:1024 lds
v_mfma_f32_16x16x32_bf16 v[140:143],a[228:231],v[52:55],v[140:143]
ds_read_b64_tr_b16 a[200:201],v5 offset:32768
ds_read_b64_tr_b16 a[202:203],v5 offset:40960
v_mfma_f32_16x16x32_bf16 v[140:143],a[232:235],v[56:59],v[140:143]
buffer_load_dwordx4 v238,s[96:99],s28 offen offset:2048 lds
v_mfma_f32_16x16x32_bf16 v[140:143],a[236:239],v[60:63],v[140:143]
buffer_load_dwordx4 v239,s[96:99],s28 offen offset:3072 lds
v_mfma_f32_16x16x32_bf16 v[140:143],a[240:243],v[64:67],v[140:143]
ds_read_b64_tr_b16 a[204:205],v5 offset:49152
ds_read_b64_tr_b16 a[206:207],v5 offset:57344
v_mfma_f32_16x16x32_bf16 v[140:143],a[244:247],v[68:71],v[140:143]
s_add_u32 m0,s25,0
s_add_u32 s28,s67,128
v_mfma_f32_16x16x32_bf16 v[140:143],a[248:251],v[72:75],v[140:143]
buffer_load_dwordx4 v236,s[96:99],s28 offen lds
v_mfma_f32_16x16x32_bf16 v[140:143],a[252:255],v[76:79],v[140:143]
ds_read_b64_tr_b16 a[208:209],v6 offset:32768
ds_read_b64_tr_b16 a[210:211],v6 offset:40960
v_mfma_f32_16x16x32_bf16 v[156:159],a[224:227],v[80:83],v[216:219]
buffer_load_dwordx4 v237,s[96:99],s28 offen offset:1024 lds
v_mfma_f32_16x16x32_bf16 v[156:159],a[228:231],v[84:87],v[156:159]
buffer_load_dwordx4 v238,s[96:99],s28 offen offset:2048 lds
v_mfma_f32_16x16x32_bf16 v[156:159],a[232:235],v[88:91],v[156:159]
ds_read_b64_tr_b16 a[212:213],v6 offset:49152
ds_read_b64_tr_b16 a[214:215],v6 offset:57344
v_mfma_f32_16x16x32_bf16 v[156:159],a[236:239],v[92:95],v[156:159]
buffer_load_dwordx4 v239,s[96:99],s28 offen offset:3072 lds
v_mfma_f32_16x16x32_bf16 v[156:159],a[240:243],v[96:99],v[156:159]
s_add_u32 m0,s25,16384
s_add_u32 s28,s67,114688
v_mfma_f32_16x16x32_bf16 v[156:159],a[244:247],v[100:103],v[156:159]
ds_read_b64_tr_b16 a[216:217],v7 offset:32768
ds_read_b64_tr_b16 a[218:219],v7 offset:40960
v_mfma_f32_16x16x32_bf16 v[156:159],a[248:251],v[104:107],v[156:159]
buffer_load_dwordx4 v236,s[96:99],s28 offen lds
v_mfma_f32_16x16x32_bf16 v[156:159],a[252:255],v[108:111],v[156:159]
buffer_load_dwordx4 v237,s[96:99],s28 offen offset:1024 lds
v_mfma_f32_16x16x32_bf16 v[220:223],v[232:235],v[168:171],v[220:223]
ds_read_b64_tr_b16 a[220:221],v7 offset:49152
ds_read_b64_tr_b16 a[222:223],v7 offset:57344
v_mfma_f32_16x16x32_bf16 v[220:223],v[232:235],v[172:175],v[220:223]
buffer_load_dwordx4 v238,s[96:99],s28 offen offset:2048 lds
v_mfma_f32_16x16x32_bf16 v[224:227],v[232:235],v[184:187],v[224:227]
buffer_load_dwordx4 v239,s[96:99],s28 offen offset:3072 lds
v_mfma_f32_16x16x32_bf16 v[224:227],v[232:235],v[188:191],v[224:227]
ds_read_b64_tr_b16 a[224:225],v8 offset:32768
ds_read_b64_tr_b16 a[226:227],v8 offset:40960
v_mfma_f32_16x16x32_bf16 v[228:231],v[232:235],v[200:203],v[228:231]
v_exp_f32 v119,v119
v_mfma_f32_16x16x32_bf16 v[228:231],v[232:235],v[204:207],v[228:231]
v_cvt_pk_bf16_f32 v163,v118,v119
s_waitcnt lgkmcnt(4)
v_mfma_f32_16x16x32_bf16 a[0:3],a[192:195],v[168:171],a[0:3]
ds_read_b64_tr_b16 a[228:229],v8 offset:49152
ds_read_b64_tr_b16 a[230:231],v8 offset:57344
v_mfma_f32_16x16x32_bf16 a[0:3],a[196:199],v[172:175],a[0:3]
v_exp_f32 v132,v132
v_mfma_f32_16x16x32_bf16 a[64:67],a[192:195],v[184:187],a[64:67]
v_mfma_f32_16x16x32_bf16 a[64:67],a[196:199],v[188:191],a[64:67]
ds_read_b64_tr_b16 a[232:233],v9 offset:32768
ds_read_b64_tr_b16 a[234:235],v9 offset:40960
v_mfma_f32_16x16x32_bf16 a[128:131],a[192:195],v[200:203],a[128:131]
v_exp_f32 v133,v133
v_mfma_f32_16x16x32_bf16 a[128:131],a[196:199],v[204:207],a[128:131]
v_cvt_pk_bf16_f32 v178,v132,v133
v_mfma_f32_16x16x32_bf16 a[4:7],a[200:203],v[168:171],a[4:7]
ds_read_b64_tr_b16 a[236:237],v9 offset:49152
ds_read_b64_tr_b16 a[238:239],v9 offset:57344
v_mfma_f32_16x16x32_bf16 a[4:7],a[204:207],v[172:175],a[4:7]
v_exp_f32 v134,v134
v_mfma_f32_16x16x32_bf16 a[68:71],a[200:203],v[184:187],a[68:71]
v_mfma_f32_16x16x32_bf16 a[68:71],a[204:207],v[188:191],a[68:71]
ds_read_b64_tr_b16 a[240:241],v10 offset:32768
ds_read_b64_tr_b16 a[242:243],v10 offset:40960
v_mfma_f32_16x16x32_bf16 a[132:135],a[200:203],v[200:203],a[132:135]
v_exp_f32 v135,v135
v_mfma_f32_16x16x32_bf16 a[132:135],a[204:207],v[204:207],a[132:135]
v_cvt_pk_bf16_f32 v179,v134,v135
v_mfma_f32_16x16x32_bf16 a[8:11],a[208:211],v[168:171],a[8:11]
ds_read_b64_tr_b16 a[244:245],v10 offset:49152
ds_read_b64_tr_b16 a[246:247],v10 offset:57344
v_mfma_f32_16x16x32_bf16 a[8:11],a[212:215],v[172:175],a[8:11]
v_mfma_f32_16x16x32_bf16 a[72:75],a[208:211],v[184:187],a[72:75]
v_exp_f32 v148,v148
v_mfma_f32_16x16x32_bf16 a[72:75],a[212:215],v[188:191],a[72:75]
ds_read_b64_tr_b16 a[248:249],v11 offset:32768
ds_read_b64_tr_b16 a[250:251],v11 offset:40960
v_mfma_f32_16x16x32_bf16 a[136:139],a[208:211],v[200:203],a[136:139]
v_mfma_f32_16x16x32_bf16 a[136:139],a[212:215],v[204:207],a[136:139]
v_exp_f32 v149,v149
v_mfma_f32_16x16x32_bf16 a[12:15],a[216:219],v[168:171],a[12:15]
ds_read_b64_tr_b16 a[252:253],v11 offset:49152
ds_read_b64_tr_b16 a[254:255],v11 offset:57344
s_waitcnt lgkmcnt(6)
v_mfma_f32_16x16x32_bf16 a[12:15],a[220:223],v[172:175],a[12:15]
v_cvt_pk_bf16_f32 v194,v148,v149
v_mfma_f32_16x16x32_bf16 a[76:79],a[216:219],v[184:187],a[76:79]
v_mfma_f32_16x16x32_bf16 a[76:79],a[220:223],v[188:191],a[76:79]
ds_read_b64_tr_b16 a[192:193],v4 offset:33024
ds_read_b64_tr_b16 a[194:195],v4 offset:41216
v_mfma_f32_16x16x32_bf16 a[140:143],a[216:219],v[200:203],a[140:143]
v_exp_f32 v150,v150
v_mfma_f32_16x16x32_bf16 a[140:143],a[220:223],v[204:207],a[140:143]
v_mfma_f32_16x16x32_bf16 a[16:19],a[224:227],v[168:171],a[16:19]
ds_read_b64_tr_b16 a[196:197],v4 offset:49408
ds_read_b64_tr_b16 a[198:199],v4 offset:57600
v_mfma_f32_16x16x32_bf16 a[16:19],a[228:231],v[172:175],a[16:19]
v_exp_f32 v151,v151
v_mfma_f32_16x16x32_bf16 a[80:83],a[224:227],v[184:187],a[80:83]
v_cvt_pk_bf16_f32 v195,v150,v151
v_mfma_f32_16x16x32_bf16 a[80:83],a[228:231],v[188:191],a[80:83]
ds_read_b64_tr_b16 a[200:201],v5 offset:33024
ds_read_b64_tr_b16 a[202:203],v5 offset:41216
v_mfma_f32_16x16x32_bf16 a[144:147],a[224:227],v[200:203],a[144:147]
v_exp_f32 v120,v120
v_mfma_f32_16x16x32_bf16 a[144:147],a[228:231],v[204:207],a[144:147]
v_mfma_f32_16x16x32_bf16 a[20:23],a[232:235],v[168:171],a[20:23]
ds_read_b64_tr_b16 a[204:205],v5 offset:49408
ds_read_b64_tr_b16 a[206:207],v5 offset:57600
v_mfma_f32_16x16x32_bf16 a[20:23],a[236:239],v[172:175],a[20:23]
v_exp_f32 v121,v121
v_mfma_f32_16x16x32_bf16 a[84:87],a[232:235],v[184:187],a[84:87]
v_cvt_pk_bf16_f32 v164,v120,v121
v_mfma_f32_16x16x32_bf16 a[84:87],a[236:239],v[188:191],a[84:87]
ds_read_b64_tr_b16 a[208:209],v6 offset:33024
ds_read_b64_tr_b16 a[210:211],v6 offset:41216
v_mfma_f32_16x16x32_bf16 a[148:151],a[232:235],v[200:203],a[148:151]
v_exp_f32 v122,v122
v_mfma_f32_16x16x32_bf16 a[148:151],a[236:239],v[204:207],a[148:151]
v_mfma_f32_16x16x32_bf16 a[24:27],a[240:243],v[168:171],a[24:27]
ds_read_b64_tr_b16 a[212:213],v6 offset:49408
ds_read_b64_tr_b16 a[214:215],v6 offset:57600
s_waitcnt lgkmcnt(6)
v_mfma_f32_16x16x32_bf16 a[24:27],a[244:247],v[172:175],a[24:27]
v_exp_f32 v123,v123
v_mfma_f32_16x16x32_bf16 a[88:91],a[240:243],v[184:187],a[88:91]
v_cvt_pk_bf16_f32 v165,v122,v123
v_mfma_f32_16x16x32_bf16 a[88:91],a[244:247],v[188:191],a[88:91]
ds_read_b64_tr_b16 a[216:217],v7 offset:33024
ds_read_b64_tr_b16 a[218:219],v7 offset:41216
v_mfma_f32_16x16x32_bf16 a[152:155],a[240:243],v[200:203],a[152:155]
v_mfma_f32_16x16x32_bf16 a[152:155],a[244:247],v[204:207],a[152:155]
v_exp_f32 v136,v136
v_mfma_f32_16x16x32_bf16 a[28:31],a[248:251],v[168:171],a[28:31]
ds_read_b64_tr_b16 a[220:221],v7 offset:49408
ds_read_b64_tr_b16 a[222:223],v7 offset:57600
v_mfma_f32_16x16x32_bf16 a[28:31],a[252:255],v[172:175],a[28:31]
v_mfma_f32_16x16x32_bf16 a[92:95],a[248:251],v[184:187],a[92:95]
v_exp_f32 v137,v137
v_mfma_f32_16x16x32_bf16 a[92:95],a[252:255],v[188:191],a[92:95]
ds_read_b64_tr_b16 a[224:225],v8 offset:33024
ds_read_b64_tr_b16 a[226:227],v8 offset:41216
v_mfma_f32_16x16x32_bf16 a[156:159],a[248:251],v[200:203],a[156:159]
v_cvt_pk_bf16_f32 v180,v136,v137
v_mfma_f32_16x16x32_bf16 a[156:159],a[252:255],v[204:207],a[156:159]
v_mfma_f32_16x16x32_bf16 a[32:35],a[192:195],v[168:171],a[32:35]
ds_read_b64_tr_b16 a[228:229],v8 offset:49408
ds_read_b64_tr_b16 a[230:231],v8 offset:57600
v_mfma_f32_16x16x32_bf16 a[32:35],a[196:199],v[172:175],a[32:35]
v_exp_f32 v138,v138
v_mfma_f32_16x16x32_bf16 a[96:99],a[192:195],v[184:187],a[96:99]
v_mfma_f32_16x16x32_bf16 a[96:99],a[196:199],v[188:191],a[96:99]
ds_read_b64_tr_b16 a[232:233],v9 offset:33024
ds_read_b64_tr_b16 a[234:235],v9 offset:41216
v_mfma_f32_16x16x32_bf16 a[160:163],a[192:195],v[200:203],a[160:163]
v_exp_f32 v139,v139
v_mfma_f32_16x16x32_bf16 a[160:163],a[196:199],v[204:207],a[160:163]
v_cvt_pk_bf16_f32 v181,v138,v139
v_mfma_f32_16x16x32_bf16 a[36:39],a[200:203],v[168:171],a[36:39]
ds_read_b64_tr_b16 a[236:237],v9 offset:49408
ds_read_b64_tr_b16 a[238:239],v9 offset:57600
s_waitcnt lgkmcnt(6)
v_mfma_f32_16x16x32_bf16 a[36:39],a[204:207],v[172:175],a[36:39]
v_exp_f32 v152,v152
v_mfma_f32_16x16x32_bf16 a[100:103],a[200:203],v[184:187],a[100:103]
v_mfma_f32_16x16x32_bf16 a[100:103],a[204:207],v[188:191],a[100:103]
ds_read_b64_tr_b16 a[240:241],v10 offset:33024
ds_read_b64_tr_b16 a[242:243],v10 offset:41216
v_mfma_f32_16x16x32_bf16 a[164:167],a[200:203],v[200:203],a[164:167]
v_exp_f32 v153,v153
v_mfma_f32_16x16x32_bf16 a[164:167],a[204:207],v[204:207],a[164:167]
v_cvt_pk_bf16_f32 v196,v152,v153
v_mfma_f32_16x16x32_bf16 a[40:43],a[208:211],v[168:171],a[40:43]
ds_read_b64_tr_b16 a[244:245],v10 offset:49408
ds_read_b64_tr_b16 a[246:247],v10 offset:57600
v_mfma_f32_16x16x32_bf16 a[40:43],a[212:215],v[172:175],a[40:43]
v_mfma_f32_16x16x32_bf16 a[104:107],a[208:211],v[184:187],a[104:107]
v_exp_f32 v154,v154
v_mfma_f32_16x16x32_bf16 a[104:107],a[212:215],v[188:191],a[104:107]
ds_read_b64_tr_b16 a[248:249],v11 offset:33024
ds_read_b64_tr_b16 a[250:251],v11 offset:41216
v_mfma_f32_16x16x32_bf16 a[168:171],a[208:211],v[200:203],a[168:171]
v_mfma_f32_16x16x32_bf16 a[168:171],a[212:215],v[204:207],a[168:171]
v_exp_f32 v155,v155
v_mfma_f32_16x16x32_bf16 a[44:47],a[216:219],v[168:171],a[44:47]
ds_read_b64_tr_b16 a[252:253],v11 offset:49408
ds_read_b64_tr_b16 a[254:255],v11 offset:57600
v_mfma_f32_16x16x32_bf16 a[44:47],a[220:223],v[172:175],a[44:47]
v_cvt_pk_bf16_f32 v197,v154,v155
v_mfma_f32_16x16x32_bf16 a[108:111],a[216:219],v[184:187],a[108:111]
v_mfma_f32_16x16x32_bf16 a[108:111],a[220:223],v[188:191],a[108:111]
v_exp_f32 v124,v124
v_mfma_f32_16x16x32_bf16 a[172:175],a[216:219],v[200:203],a[172:175]
v_mfma_f32_16x16x32_bf16 a[172:175],a[220:223],v[204:207],a[172:175]
v_exp_f32 v125,v125
v_mfma_f32_16x16x32_bf16 a[48:51],a[224:227],v[168:171],a[48:51]
s_waitcnt lgkmcnt(0)
s_waitcnt vmcnt(12)
s_barrier
s_waitcnt lgkmcnt(2)
v_mfma_f32_16x16x32_bf16 a[48:51],a[228:231],v[172:175],a[48:51]
ds_read_b128 a[192:195],v0 offset:32768
v_cvt_pk_bf16_f32 v166,v124,v125
v_mfma_f32_16x16x32_bf16 a[112:115],a[224:227],v[184:187],a[112:115]
v_mfma_f32_16x16x32_bf16 a[112:115],a[228:231],v[188:191],a[112:115]
v_exp_f32 v126,v126
v_mfma_f32_16x16x32_bf16 a[176:179],a[224:227],v[200:203],a[176:179]
ds_read_b128 a[196:199],v1 offset:32768
v_mfma_f32_16x16x32_bf16 a[176:179],a[228:231],v[204:207],a[176:179]
v_mfma_f32_16x16x32_bf16 a[52:55],a[232:235],v[168:171],a[52:55]
v_exp_f32 v127,v127
v_mfma_f32_16x16x32_bf16 a[52:55],a[236:239],v[172:175],a[52:55]
ds_read_b128 a[200:203],v2 offset:32768
v_cvt_pk_bf16_f32 v167,v126,v127
v_mfma_f32_16x16x32_bf16 a[116:119],a[232:235],v[184:187],a[116:119]
v_mfma_f32_16x16x32_bf16 a[116:119],a[236:239],v[188:191],a[116:119]
v_exp_f32 v140,v140
v_mfma_f32_16x16x32_bf16 a[180:183],a[232:235],v[200:203],a[180:183]
ds_read_b128 a[204:207],v3 offset:32768
v_mfma_f32_16x16x32_bf16 a[180:183],a[236:239],v[204:207],a[180:183]
v_mfma_f32_16x16x32_bf16 a[56:59],a[240:243],v[168:171],a[56:59]
v_exp_f32 v141,v141
v_mfma_f32_16x16x32_bf16 a[56:59],a[244:247],v[172:175],a[56:59]
ds_read_b128 a[208:211],v0 offset:33024
v_cvt_pk_bf16_f32 v182,v140,v141
v_mfma_f32_16x16x32_bf16 a[120:123],a[240:243],v[184:187],a[120:123]
v_mfma_f32_16x16x32_bf16 a[120:123],a[244:247],v[188:191],a[120:123]
v_exp_f32 v142,v142
v_mfma_f32_16x16x32_bf16 a[184:187],a[240:243],v[200:203],a[184:187]
ds_read_b128 a[212:215],v1 offset:33024
v_mfma_f32_16x16x32_bf16 a[184:187],a[244:247],v[204:207],a[184:187]
v_exp_f32 v143,v143
v_mfma_f32_16x16x32_bf16 a[60:63],a[248:251],v[168:171],a[60:63]
v_cvt_pk_bf16_f32 v183,v142,v143
s_waitcnt lgkmcnt(6)
v_mfma_f32_16x16x32_bf16 a[60:63],a[252:255],v[172:175],a[60:63]
ds_read_b128 a[216:219],v2 offset:33024
v_mfma_f32_16x16x32_bf16 a[124:127],a[248:251],v[184:187],a[124:127]
v_mfma_f32_16x16x32_bf16 a[124:127],a[252:255],v[188:191],a[124:127]
v_mfma_f32_16x16x32_bf16 a[188:191],a[248:251],v[200:203],a[188:191]
ds_read_b128 a[220:223],v3 offset:33024
v_mfma_f32_16x16x32_bf16 a[188:191],a[252:255],v[204:207],a[188:191]
s_waitcnt lgkmcnt(2)
v_mfma_f32_16x16x32_bf16 v[112:115],a[192:195],v[16:19],v[208:211]
ds_read_b128 a[224:227],v0 offset:40960
v_mfma_f32_16x16x32_bf16 v[112:115],a[196:199],v[20:23],v[112:115]
v_exp_f32 v156,v156
v_mfma_f32_16x16x32_bf16 v[112:115],a[200:203],v[24:27],v[112:115]
v_mfma_f32_16x16x32_bf16 v[112:115],a[204:207],v[28:31],v[112:115]
ds_read_b128 a[228:231],v1 offset:40960
v_mfma_f32_16x16x32_bf16 v[112:115],a[208:211],v[32:35],v[112:115]
v_exp_f32 v157,v157
v_mfma_f32_16x16x32_bf16 v[112:115],a[212:215],v[36:39],v[112:115]
v_cvt_pk_bf16_f32 v198,v156,v157
s_waitcnt lgkmcnt(2)
v_mfma_f32_16x16x32_bf16 v[112:115],a[216:219],v[40:43],v[112:115]
ds_read_b128 a[232:235],v2 offset:40960
v_mfma_f32_16x16x32_bf16 v[112:115],a[220:223],v[44:47],v[112:115]
v_exp_f32 v158,v158
v_mfma_f32_16x16x32_bf16 v[128:131],a[192:195],v[48:51],v[212:215]
v_mfma_f32_16x16x32_bf16 v[128:131],a[196:199],v[52:55],v[128:131]
ds_read_b128 a[236:239],v3 offset:40960
v_mfma_f32_16x16x32_bf16 v[128:131],a[200:203],v[56:59],v[128:131]
v_exp_f32 v159,v159
v_mfma_f32_16x16x32_bf16 v[128:131],a[204:207],v[60:63],v[128:131]
v_cvt_pk_bf16_f32 v199,v158,v159
v_mfma_f32_16x16x32_bf16 v[128:131],a[208:211],v[64:67],v[128:131]
ds_read_b128 a[240:243],v0 offset:41216
v_mfma_f32_16x16x32_bf16 v[128:131],a[212:215],v[68:71],v[128:131]
v_mfma_f32_16x16x32_bf16 v[128:131],a[216:219],v[72:75],v[128:131]
v_exp_f32 v112,v112
v_mfma_f32_16x16x32_bf16 v[128:131],a[220:223],v[76:79],v[128:131]
ds_read_b128 a[244:247],v1 offset:41216
v_mfma_f32_16x16x32_bf16 v[144:147],a[192:195],v[80:83],v[216:219]
v_exp_f32 v113,v113
v_mfma_f32_16x16x32_bf16 v[144:147],a[196:199],v[84:87],v[144:147]
v_cvt_pk_bf16_f32 v168,v112,v113
v_mfma_f32_16x16x32_bf16 v[144:147],a[200:203],v[88:91],v[144:147]
ds_read_b128 a[248:251],v2 offset:41216
v_mfma_f32_16x16x32_bf16 v[144:147],a[204:207],v[92:95],v[144:147]
v_exp_f32 v114,v114
v_mfma_f32_16x16x32_bf16 v[144:147],a[208:211],v[96:99],v[144:147]
v_mfma_f32_16x16x32_bf16 v[144:147],a[212:215],v[100:103],v[144:147]
ds_read_b128 a[252:255],v3 offset:41216
v_mfma_f32_16x16x32_bf16 v[144:147],a[216:219],v[104:107],v[144:147]
v_exp_f32 v115,v115
v_mfma_f32_16x16x32_bf16 v[144:147],a[220:223],v[108:111],v[144:147]
v_cvt_pk_bf16_f32 v169,v114,v115
s_waitcnt lgkmcnt(2)
v_mfma_f32_16x16x32_bf16 v[116:119],a[224:227],v[16:19],v[208:211]
ds_read_b128 a[192:195],v0 offset:49152
v_mfma_f32_16x16x32_bf16 v[116:119],a[228:231],v[20:23],v[116:119]
v_exp_f32 v128,v128
v_mfma_f32_16x16x32_bf16 v[116:119],a[232:235],v[24:27],v[116:119]
v_mfma_f32_16x16x32_bf16 v[116:119],a[236:239],v[28:31],v[116:119]
ds_read_b128 a[196:199],v1 offset:49152
v_mfma_f32_16x16x32_bf16 v[116:119],a[240:243],v[32:35],v[116:119]
v_exp_f32 v129,v129
v_mfma_f32_16x16x32_bf16 v[116:119],a[244:247],v[36:39],v[116:119]
v_cvt_pk_bf16_f32 v184,v128,v129
s_waitcnt lgkmcnt(2)
v_mfma_f32_16x16x32_bf16 v[116:119],a[248:251],v[40:43],v[116:119]
ds_read_b128 a[200:203],v2 offset:49152
v_mfma_f32_16x16x32_bf16 v[116:119],a[252:255],v[44:47],v[116:119]
v_exp_f32 v130,v130
v_mfma_f32_16x16x32_bf16 v[132:135],a[224:227],v[48:51],v[212:215]
v_mfma_f32_16x16x32_bf16 v[132:135],a[228:231],v[52:55],v[132:135]
ds_read_b128 a[204:207],v3 offset:49152
v_mfma_f32_16x16x32_bf16 v[132:135],a[232:235],v[56:59],v[132:135]
v_exp_f32 v131,v131
v_mfma_f32_16x16x32_bf16 v[132:135],a[236:239],v[60:63],v[132:135]
v_cvt_pk_bf16_f32 v185,v130,v131
v_mfma_f32_16x16x32_bf16 v[132:135],a[240:243],v[64:67],v[132:135]
ds_read_b128 a[208:211],v0 offset:49408
v_mfma_f32_16x16x32_bf16 v[132:135],a[244:247],v[68:71],v[132:135]
v_exp_f32 v144,v144
v_mfma_f32_16x16x32_bf16 v[132:135],a[248:251],v[72:75],v[132:135]
v_mfma_f32_16x16x32_bf16 v[132:135],a[252:255],v[76:79],v[132:135]
ds_read_b128 a[212:215],v1 offset:49408
v_mfma_f32_16x16x32_bf16 v[148:151],a[224:227],v[80:83],v[216:219]
v_exp_f32 v145,v145
v_mfma_f32_16x16x32_bf16 v[148:151],a[228:231],v[84:87],v[148:151]
v_cvt_pk_bf16_f32 v200,v144,v145
v_mfma_f32_16x16x32_bf16 v[148:151],a[232:235],v[88:91],v[148:151]
ds_read_b128 a[216:219],v2 offset:49408
v_mfma_f32_16x16x32_bf16 v[148:151],a[236:239],v[92:95],v[148:151]
v_exp_f32 v146,v146
v_mfma_f32_16x16x32_bf16 v[148:151],a[240:243],v[96:99],v[148:151]
ds_read_b128 a[220:223],v3 offset:49408
v_mfma_f32_16x16x32_bf16 v[148:151],a[244:247],v[100:103],v[148:151]
v_exp_f32 v147,v147
v_mfma_f32_16x16x32_bf16 v[148:151],a[248:251],v[104:107],v[148:151]
v_cvt_pk_bf16_f32 v201,v146,v147
v_mfma_f32_16x16x32_bf16 v[148:151],a[252:255],v[108:111],v[148:151]
ds_read_b128 a[224:227],v0 offset:57344
s_waitcnt lgkmcnt(3)
v_mfma_f32_16x16x32_bf16 v[120:123],a[192:195],v[16:19],v[208:211]
v_exp_f32 v116,v116
v_mfma_f32_16x16x32_bf16 v[120:123],a[196:199],v[20:23],v[120:123]
v_mfma_f32_16x16x32_bf16 v[120:123],a[200:203],v[24:27],v[120:123]
ds_read_b128 a[228:231],v1 offset:57344
v_mfma_f32_16x16x32_bf16 v[120:123],a[204:207],v[28:31],v[120:123]
v_exp_f32 v117,v117
v_mfma_f32_16x16x32_bf16 v[120:123],a[208:211],v[32:35],v[120:123]
v_cvt_pk_bf16_f32 v170,v116,v117
v_mfma_f32_16x16x32_bf16 v[120:123],a[212:215],v[36:39],v[120:123]
ds_read_b128 a[232:235],v2 offset:57344
s_waitcnt lgkmcnt(3)
v_mfma_f32_16x16x32_bf16 v[120:123],a[216:219],v[40:43],v[120:123]
v_exp_f32 v118,v118
v_mfma_f32_16x16x32_bf16 v[120:123],a[220:223],v[44:47],v[120:123]
v_mfma_f32_16x16x32_bf16 v[136:139],a[192:195],v[48:51],v[212:215]
ds_read_b128 a[236:239],v3 offset:57344
v_mfma_f32_16x16x32_bf16 v[136:139],a[196:199],v[52:55],v[136:139]
v_exp_f32 v119,v119
v_mfma_f32_16x16x32_bf16 v[136:139],a[200:203],v[56:59],v[136:139]
v_cvt_pk_bf16_f32 v171,v118,v119
v_mfma_f32_16x16x32_bf16 v[136:139],a[204:207],v[60:63],v[136:139]
ds_read_b128 a[240:243],v0 offset:57600
v_mfma_f32_16x16x32_bf16 v[136:139],a[208:211],v[64:67],v[136:139]
v_exp_f32 v132,v132
v_mfma_f32_16x16x32_bf16 v[136:139],a[212:215],v[68:71],v[136:139]
v_mfma_f32_16x16x32_bf16 v[136:139],a[216:219],v[72:75],v[136:139]
ds_read_b128 a[244:247],v1 offset:57600
v_mfma_f32_16x16x32_bf16 v[136:139],a[220:223],v[76:79],v[136:139]
v_exp_f32 v133,v133
v_mfma_f32_16x16x32_bf16 v[152:155],a[192:195],v[80:83],v[216:219]
v_cvt_pk_bf16_f32 v186,v132,v133
v_mfma_f32_16x16x32_bf16 v[152:155],a[196:199],v[84:87],v[152:155]
ds_read_b128 a[248:251],v2 offset:57600
v_mfma_f32_16x16x32_bf16 v[152:155],a[200:203],v[88:91],v[152:155]
v_exp_f32 v134,v134
v_mfma_f32_16x16x32_bf16 v[152:155],a[204:207],v[92:95],v[152:155]
v_mfma_f32_16x16x32_bf16 v[152:155],a[208:211],v[96:99],v[152:155]
ds_read_b128 a[252:255],v3 offset:57600
v_mfma_f32_16x16x32_bf16 v[152:155],a[212:215],v[100:103],v[152:155]
v_exp_f32 v135,v135
v_mfma_f32_16x16x32_bf16 v[152:155],a[216:219],v[104:107],v[152:155]
v_cvt_pk_bf16_f32 v187,v134,v135
v_mfma_f32_16x16x32_bf16 v[152:155],a[220:223],v[108:111],v[152:155]
s_waitcnt lgkmcnt(2)
v_mfma_f32_16x16x32_bf16 v[124:127],a[224:227],v[16:19],v[208:211]
v_exp_f32 v148,v148
v_mfma_f32_16x16x32_bf16 v[124:127],a[228:231],v[20:23],v[124:127]
v_exp_f32 v149,v149
v_mfma_f32_16x16x32_bf16 v[124:127],a[232:235],v[24:27],v[124:127]
s_waitcnt lgkmcnt(0)
s_barrier
v_mfma_f32_16x16x32_bf16 v[124:127],a[236:239],v[28:31],v[124:127]
ds_read_b64_tr_b16 a[192:193],v4 offset:0
ds_read_b64_tr_b16 a[194:195],v4 offset:8192
v_mfma_f32_16x16x32_bf16 v[124:127],a[240:243],v[32:35],v[124:127]
s_add_u32 m0,s25,32768
s_add_u32 s28,s67,114816
v_mfma_f32_16x16x32_bf16 v[124:127],a[244:247],v[36:39],v[124:127]
v_cvt_pk_bf16_f32 v202,v148,v149
s_waitcnt lgkmcnt(2)
v_mfma_f32_16x16x32_bf16 v[124:127],a[248:251],v[40:43],v[124:127]
ds_read_b64_tr_b16 a[196:197],v4 offset:16384
ds_read_b64_tr_b16 a[198:199],v4 offset:24576
v_mfma_f32_16x16x32_bf16 v[124:127],a[252:255],v[44:47],v[124:127]
buffer_load_dwordx4 v236,s[96:99],s28 offen lds
v_mfma_f32_16x16x32_bf16 v[140:143],a[224:227],v[48:51],v[212:215]
buffer_load_dwordx4 v237,s[96:99],s28 offen offset:1024 lds
v_mfma_f32_16x16x32_bf16 v[140:143],a[228:231],v[52:55],v[140:143]
ds_read_b64_tr_b16 a[200:201],v5 offset:0
ds_read_b64_tr_b16 a[202:203],v5 offset:8192
v_mfma_f32_16x16x32_bf16 v[140:143],a[232:235],v[56:59],v[140:143]
buffer_load_dwordx4 v238,s[96:99],s28 offen offset:2048 lds
v_mfma_f32_16x16x32_bf16 v[140:143],a[236:239],v[60:63],v[140:143]
buffer_load_dwordx4 v239,s[96:99],s28 offen offset:3072 lds
v_mfma_f32_16x16x32_bf16 v[140:143],a[240:243],v[64:67],v[140:143]
ds_read_b64_tr_b16 a[204:205],v5 offset:16384
ds_read_b64_tr_b16 a[206:207],v5 offset:24576
v_mfma_f32_16x16x32_bf16 v[140:143],a[244:247],v[68:71],v[140:143]
s_add_u32 m0,s25,49152
s_add_u32 s28,s67,256
v_mfma_f32_16x16x32_bf16 v[140:143],a[248:251],v[72:75],v[140:143]
buffer_load_dwordx4 v236,s[96:99],s28 offen lds
v_mfma_f32_16x16x32_bf16 v[140:143],a[252:255],v[76:79],v[140:143]
ds_read_b64_tr_b16 a[208:209],v6 offset:0
ds_read_b64_tr_b16 a[210:211],v6 offset:8192
v_mfma_f32_16x16x32_bf16 v[156:159],a[224:227],v[80:83],v[216:219]
buffer_load_dwordx4 v237,s[96:99],s28 offen offset:1024 lds
v_mfma_f32_16x16x32_bf16 v[156:159],a[228:231],v[84:87],v[156:159]
buffer_load_dwordx4 v238,s[96:99],s28 offen offset:2048 lds
v_mfma_f32_16x16x32_bf16 v[156:159],a[232:235],v[88:91],v[156:159]
ds_read_b64_tr_b16 a[212:213],v6 offset:16384
ds_read_b64_tr_b16 a[214:215],v6 offset:24576
v_mfma_f32_16x16x32_bf16 v[156:159],a[236:239],v[92:95],v[156:159]
buffer_load_dwordx4 v239,s[96:99],s28 offen offset:3072 lds
v_mfma_f32_16x16x32_bf16 v[156:159],a[240:243],v[96:99],v[156:159]
v_exp_f32 v150,v150
v_mfma_f32_16x16x32_bf16 v[156:159],a[244:247],v[100:103],v[156:159]
ds_read_b64_tr_b16 a[216:217],v7 offset:0
ds_read_b64_tr_b16 a[218:219],v7 offset:8192
v_mfma_f32_16x16x32_bf16 v[156:159],a[248:251],v[104:107],v[156:159]
v_mfma_f32_16x16x32_bf16 v[156:159],a[252:255],v[108:111],v[156:159]
v_exp_f32 v151,v151
v_mfma_f32_16x16x32_bf16 v[220:223],v[232:235],v[160:163],v[220:223]
ds_read_b64_tr_b16 a[220:221],v7 offset:16384
ds_read_b64_tr_b16 a[222:223],v7 offset:24576
v_mfma_f32_16x16x32_bf16 v[220:223],v[232:235],v[164:167],v[220:223]
v_cvt_pk_bf16_f32 v203,v150,v151
v_mfma_f32_16x16x32_bf16 v[224:227],v[232:235],v[176:179],v[224:227]
v_mfma_f32_16x16x32_bf16 v[224:227],v[232:235],v[180:183],v[224:227]
ds_read_b64_tr_b16 a[224:225],v8 offset:0
ds_read_b64_tr_b16 a[226:227],v8 offset:8192
v_mfma_f32_16x16x32_bf16 v[228:231],v[232:235],v[192:195],v[228:231]
v_mfma_f32_16x16x32_bf16 v[228:231],v[232:235],v[196:199],v[228:231]
s_waitcnt lgkmcnt(4)
v_mfma_f32_16x16x32_bf16 a[0:3],a[192:195],v[160:163],a[0:3]
ds_read_b64_tr_b16 a[228:229],v8 offset:16384
ds_read_b64_tr_b16 a[230:231],v8 offset:24576
v_mfma_f32_16x16x32_bf16 a[0:3],a[196:199],v[164:167],a[0:3]
v_exp_f32 v120,v120
v_mfma_f32_16x16x32_bf16 a[64:67],a[192:195],v[176:179],a[64:67]
v_mfma_f32_16x16x32_bf16 a[64:67],a[196:199],v[180:183],a[64:67]
ds_read_b64_tr_b16 a[232:233],v9 offset:0
ds_read_b64_tr_b16 a[234:235],v9 offset:8192
v_mfma_f32_16x16x32_bf16 a[128:131],a[192:195],v[192:195],a[128:131]
v_exp_f32 v121,v121
v_mfma_f32_16x16x32_bf16 a[128:131],a[196:199],v[196:199],a[128:131]
v_cvt_pk_bf16_f32 v172,v120,v121
v_mfma_f32_16x16x32_bf16 a[4:7],a[200:203],v[160:163],a[4:7]
ds_read_b64_tr_b16 a[236:237],v9 offset:16384
ds_read_b64_tr_b16 a[238:239],v9 offset:24576
v_mfma_f32_16x16x32_bf16 a[4:7],a[204:207],v[164:167],a[4:7]
v_exp_f32 v122,v122
v_mfma_f32_16x16x32_bf16 a[68:71],a[200:203],v[176:179],a[68:71]
v_mfma_f32_16x16x32_bf16 a[68:71],a[204:207],v[180:183],a[68:71]
ds_read_b64_tr_b16 a[240:241],v10 offset:0
ds_read_b64_tr_b16 a[242:243],v10 offset:8192
v_mfma_f32_16x16x32_bf16 a[132:135],a[200:203],v[192:195],a[132:135]
v_exp_f32 v123,v123
v_mfma_f32_16x16x32_bf16 a[132:135],a[204:207],v[196:199],a[132:135]
v_cvt_pk_bf16_f32 v173,v122,v123
v_mfma_f32_16x16x32_bf16 a[8:11],a[208:211],v[160:163],a[8:11]
ds_read_b64_tr_b16 a[244:245],v10 offset:16384
ds_read_b64_tr_b16 a[246:247],v10 offset:24576
v_mfma_f32_16x16x32_bf16 a[8:11],a[212:215],v[164:167],a[8:11]
v_mfma_f32_16x16x32_bf16 a[72:75],a[208:211],v[176:179],a[72:75]
v_exp_f32 v136,v136
v_mfma_f32_16x16x32_bf16 a[72:75],a[212:215],v[180:183],a[72:75]
ds_read_b64_tr_b16 a[248:249],v11 offset:0
ds_read_b64_tr_b16 a[250:251],v11 offset:8192
v_mfma_f32_16x16x32_bf16 a[136:139],a[208:211],v[192:195],a[136:139]
v_mfma_f32_16x16x32_bf16 a[136:139],a[212:215],v[196:199],a[136:139]
v_exp_f32 v137,v137
v_mfma_f32_16x16x32_bf16 a[12:15],a[216:219],v[160:163],a[12:15]
ds_read_b64_tr_b16 a[252:253],v11 offset:16384
ds_read_b64_tr_b16 a[254:255],v11 offset:24576
s_waitcnt lgkmcnt(6)
v_mfma_f32_16x16x32_bf16 a[12:15],a[220:223],v[164:167],a[12:15]
v_cvt_pk_bf16_f32 v188,v136,v137
v_mfma_f32_16x16x32_bf16 a[76:79],a[216:219],v[176:179],a[76:79]
v_mfma_f32_16x16x32_bf16 a[76:79],a[220:223],v[180:183],a[76:79]
ds_read_b64_tr_b16 a[192:193],v4 offset:256
ds_read_b64_tr_b16 a[194:195],v4 offset:8448
v_mfma_f32_16x16x32_bf16 a[140:143],a[216:219],v[192:195],a[140:143]
v_exp_f32 v138,v138
v_mfma_f32_16x16x32_bf16 a[140:143],a[220:223],v[196:199],a[140:143]
v_mfma_f32_16x16x32_bf16 a[16:19],a[224:227],v[160:163],a[16:19]
ds_read_b64_tr_b16 a[196:197],v4 offset:16640
ds_read_b64_tr_b16 a[198:199],v4 offset:24832
v_mfma_f32_16x16x32_bf16 a[16:19],a[228:231],v[164:167],a[16:19]
v_exp_f32 v139,v139
v_mfma_f32_16x16x32_bf16 a[80:83],a[224:227],v[176:179],a[80:83]
v_cvt_pk_bf16_f32 v189,v138,v139
v_mfma_f32_16x16x32_bf16 a[80:83],a[228:231],v[180:183],a[80:83]
ds_read_b64_tr_b16 a[200:201],v5 offset:256
ds_read_b64_tr_b16 a[202:203],v5 offset:8448
v_mfma_f32_16x16x32_bf16 a[144:147],a[224:227],v[192:195],a[144:147]
v_exp_f32 v152,v152
v_mfma_f32_16x16x32_bf16 a[144:147],a[228:231],v[196:199],a[144:147]
v_mfma_f32_16x16x32_bf16 a[20:23],a[232:235],v[160:163],a[20:23]
ds_read_b64_tr_b16 a[204:205],v5 offset:16640
ds_read_b64_tr_b16 a[206:207],v5 offset:24832
v_mfma_f32_16x16x32_bf16 a[20:23],a[236:239],v[164:167],a[20:23]
v_exp_f32 v153,v153
v_mfma_f32_16x16x32_bf16 a[84:87],a[232:235],v[176:179],a[84:87]
v_cvt_pk_bf16_f32 v204,v152,v153
v_mfma_f32_16x16x32_bf16 a[84:87],a[236:239],v[180:183],a[84:87]
ds_read_b64_tr_b16 a[208:209],v6 offset:256
ds_read_b64_tr_b16 a[210:211],v6 offset:8448
v_mfma_f32_16x16x32_bf16 a[148:151],a[232:235],v[192:195],a[148:151]
v_exp_f32 v154,v154
v_mfma_f32_16x16x32_bf16 a[148:151],a[236:239],v[196:199],a[148:151]
v_mfma_f32_16x16x32_bf16 a[24:27],a[240:243],v[160:163],a[24:27]
ds_read_b64_tr_b16 a[212:213],v6 offset:16640
ds_read_b64_tr_b16 a[214:215],v6 offset:24832
s_waitcnt lgkmcnt(6)
v_mfma_f32_16x16x32_bf16 a[24:27],a[244:247],v[164:167],a[24:27]
v_exp_f32 v155,v155
v_mfma_f32_16x16x32_bf16 a[88:91],a[240:243],v[176:179],a[88:91]
v_cvt_pk_bf16_f32 v205,v154,v155
v_mfma_f32_16x16x32_bf16 a[88:91],a[244:247],v[180:183],a[88:91]
ds_read_b64_tr_b16 a[216:217],v7 offset:256
ds_read_b64_tr_b16 a[218:219],v7 offset:8448
v_mfma_f32_16x16x32_bf16 a[152:155],a[240:243],v[192:195],a[152:155]
v_mfma_f32_16x16x32_bf16 a[152:155],a[244:247],v[196:199],a[152:155]
v_exp_f32 v124,v124
v_mfma_f32_16x16x32_bf16 a[28:31],a[248:251],v[160:163],a[28:31]
ds_read_b64_tr_b16 a[220:221],v7 offset:16640
ds_read_b64_tr_b16 a[222:223],v7 offset:24832
v_mfma_f32_16x16x32_bf16 a[28:31],a[252:255],v[164:167],a[28:31]
v_mfma_f32_16x16x32_bf16 a[92:95],a[248:251],v[176:179],a[92:95]
v_exp_f32 v125,v125
v_mfma_f32_16x16x32_bf16 a[92:95],a[252:255],v[180:183],a[92:95]
ds_read_b64_tr_b16 a[224:225],v8 offset:256
ds_read_b64_tr_b16 a[226:227],v8 offset:8448
v_mfma_f32_16x16x32_bf16 a[156:159],a[248:251],v[192:195],a[156:159]
v_cvt_pk_bf16_f32 v174,v124,v125
v_mfma_f32_16x16x32_bf16 a[156:159],a[252:255],v[196:199],a[156:159]
v_mfma_f32_16x16x32_bf16 a[32:35],a[192:195],v[160:163],a[32:35]
ds_read_b64_tr_b16 a[228:229],v8 offset:16640
ds_read_b64_tr_b16 a[230:231],v8 offset:24832
v_mfma_f32_16x16x32_bf16 a[32:35],a[196:199],v[164:167],a[32:35]
v_exp_f32 v126,v126
v_mfma_f32_16x16x32_bf16 a[96:99],a[192:195],v[176:179],a[96:99]
v_mfma_f32_16x16x32_bf16 a[96:99],a[196:199],v[180:183],a[96:99]
ds_read_b64_tr_b16 a[232:233],v9 offset:256
ds_read_b64_tr_b16 a[234:235],v9 offset:8448
v_mfma_f32_16x16x32_bf16 a[160:163],a[192:195],v[192:195],a[160:163]
v_exp_f32 v127,v127
v_mfma_f32_16x16x32_bf16 a[160:163],a[196:199],v[196:199],a[160:163]
v_cvt_pk_bf16_f32 v175,v126,v127
v_mfma_f32_16x16x32_bf16 a[36:39],a[200:203],v[160:163],a[36:39]
ds_read_b64_tr_b16 a[236:237],v9 offset:16640
ds_read_b64_tr_b16 a[238:239],v9 offset:24832
s_waitcnt lgkmcnt(6)
v_mfma_f32_16x16x32_bf16 a[36:39],a[204:207],v[164:167],a[36:39]
v_mfma_f32_16x16x32_bf16 a[100:103],a[200:203],v[176:179],a[100:103]
v_exp_f32 v140,v140
v_mfma_f32_16x16x32_bf16 a[100:103],a[204:207],v[180:183],a[100:103]
ds_read_b64_tr_b16 a[240:241],v10 offset:256
ds_read_b64_tr_b16 a[242:243],v10 offset:8448
v_mfma_f32_16x16x32_bf16 a[164:167],a[200:203],v[192:195],a[164:167]
v_mfma_f32_16x16x32_bf16 a[164:167],a[204:207],v[196:199],a[164:167]
v_exp_f32 v141,v141
v_mfma_f32_16x16x32_bf16 a[40:43],a[208:211],v[160:163],a[40:43]
ds_read_b64_tr_b16 a[244:245],v10 offset:16640
ds_read_b64_tr_b16 a[246:247],v10 offset:24832
v_mfma_f32_16x16x32_bf16 a[40:43],a[212:215],v[164:167],a[40:43]
v_cvt_pk_bf16_f32 v190,v140,v141
v_mfma_f32_16x16x32_bf16 a[104:107],a[208:211],v[176:179],a[104:107]
v_mfma_f32_16x16x32_bf16 a[104:107],a[212:215],v[180:183],a[104:107]
ds_read_b64_tr_b16 a[248:249],v11 offset:256
ds_read_b64_tr_b16 a[250:251],v11 offset:8448
v_mfma_f32_16x16x32_bf16 a[168:171],a[208:211],v[192:195],a[168:171]
v_exp_f32 v142,v142
v_mfma_f32_16x16x32_bf16 a[168:171],a[212:215],v[196:199],a[168:171]
v_mfma_f32_16x16x32_bf16 a[44:47],a[216:219],v[160:163],a[44:47]
ds_read_b64_tr_b16 a[252:253],v11 offset:16640
ds_read_b64_tr_b16 a[254:255],v11 offset:24832
v_mfma_f32_16x16x32_bf16 a[44:47],a[220:223],v[164:167],a[44:47]
v_exp_f32 v143,v143
v_mfma_f32_16x16x32_bf16 a[108:111],a[216:219],v[176:179],a[108:111]
v_cvt_pk_bf16_f32 v191,v142,v143
v_mfma_f32_16x16x32_bf16 a[108:111],a[220:223],v[180:183],a[108:111]
v_mfma_f32_16x16x32_bf16 a[172:175],a[216:219],v[192:195],a[172:175]
v_exp_f32 v156,v156
v_mfma_f32_16x16x32_bf16 a[172:175],a[220:223],v[196:199],a[172:175]
v_exp_f32 v157,v157
v_mfma_f32_16x16x32_bf16 a[48:51],a[224:227],v[160:163],a[48:51]
s_waitcnt lgkmcnt(0)
s_barrier
s_waitcnt lgkmcnt(2)
v_mfma_f32_16x16x32_bf16 a[48:51],a[228:231],v[164:167],a[48:51]
ds_read_b64_tr_b16 a[192:193],v4 offset:32768
ds_read_b64_tr_b16 a[194:195],v4 offset:40960
v_mfma_f32_16x16x32_bf16 a[112:115],a[224:227],v[176:179],a[112:115]
s_add_u32 m0,s25,81920
s_add_u32 s28,s67,114944
v_mfma_f32_16x16x32_bf16 a[112:115],a[228:231],v[180:183],a[112:115]
buffer_load_dwordx4 v236,s[96:99],s28 offen lds
v_mfma_f32_16x16x32_bf16 a[176:179],a[224:227],v[192:195],a[176:179]
ds_read_b64_tr_b16 a[196:197],v4 offset:49152
ds_read_b64_tr_b16 a[198:199],v4 offset:57344
v_mfma_f32_16x16x32_bf16 a[176:179],a[228:231],v[196:199],a[176:179]
buffer_load_dwordx4 v237,s[96:99],s28 offen offset:1024 lds
v_mfma_f32_16x16x32_bf16 a[52:55],a[232:235],v[160:163],a[52:55]
buffer_load_dwordx4 v238,s[96:99],s28 offen offset:2048 lds
v_mfma_f32_16x16x32_bf16 a[52:55],a[236:239],v[164:167],a[52:55]
ds_read_b64_tr_b16 a[200:201],v5 offset:32768
ds_read_b64_tr_b16 a[202:203],v5 offset:40960
v_mfma_f32_16x16x32_bf16 a[116:119],a[232:235],v[176:179],a[116:119]
buffer_load_dwordx4 v239,s[96:99],s28 offen offset:3072 lds
v_mfma_f32_16x16x32_bf16 a[116:119],a[236:239],v[180:183],a[116:119]
v_cvt_pk_bf16_f32 v206,v156,v157
v_mfma_f32_16x16x32_bf16 a[180:183],a[232:235],v[192:195],a[180:183]
ds_read_b64_tr_b16 a[204:205],v5 offset:49152
ds_read_b64_tr_b16 a[206:207],v5 offset:57344
v_mfma_f32_16x16x32_bf16 a[180:183],a[236:239],v[196:199],a[180:183]
v_exp_f32 v158,v158
v_mfma_f32_16x16x32_bf16 a[56:59],a[240:243],v[160:163],a[56:59]
v_mfma_f32_16x16x32_bf16 a[56:59],a[244:247],v[164:167],a[56:59]
ds_read_b64_tr_b16 a[208:209],v6 offset:32768
ds_read_b64_tr_b16 a[210:211],v6 offset:40960
v_mfma_f32_16x16x32_bf16 a[120:123],a[240:243],v[176:179],a[120:123]
v_mfma_f32_16x16x32_bf16 a[120:123],a[244:247],v[180:183],a[120:123]
v_exp_f32 v159,v159
v_mfma_f32_16x16x32_bf16 a[184:187],a[240:243],v[192:195],a[184:187]
ds_read_b64_tr_b16 a[212:213],v6 offset:49152
ds_read_b64_tr_b16 a[214:215],v6 offset:57344
v_mfma_f32_16x16x32_bf16 a[184:187],a[244:247],v[196:199],a[184:187]
v_cvt_pk_bf16_f32 v207,v158,v159
v_mfma_f32_16x16x32_bf16 a[60:63],a[248:251],v[160:163],a[60:63]
s_waitcnt lgkmcnt(12)
v_mfma_f32_16x16x32_bf16 a[60:63],a[252:255],v[164:167],a[60:63]
ds_read_b64_tr_b16 a[216:217],v7 offset:32768
ds_read_b64_tr_b16 a[218:219],v7 offset:40960
v_mfma_f32_16x16x32_bf16 a[124:127],a[248:251],v[176:179],a[124:127]
v_mfma_f32_16x16x32_bf16 a[124:127],a[252:255],v[180:183],a[124:127]
v_mfma_f32_16x16x32_bf16 a[188:191],a[248:251],v[192:195],a[188:191]
ds_read_b64_tr_b16 a[220:221],v7 offset:49152
ds_read_b64_tr_b16 a[222:223],v7 offset:57344
v_mfma_f32_16x16x32_bf16 a[188:191],a[252:255],v[196:199],a[188:191]
v_mfma_f32_16x16x32_bf16 v[220:223],v[232:235],v[168:171],v[220:223]
v_mfma_f32_16x16x32_bf16 v[220:223],v[232:235],v[172:175],v[220:223]
ds_read_b64_tr_b16 a[224:225],v8 offset:32768
ds_read_b64_tr_b16 a[226:227],v8 offset:40960
v_mfma_f32_16x16x32_bf16 v[224:227],v[232:235],v[184:187],v[224:227]
v_mfma_f32_16x16x32_bf16 v[224:227],v[232:235],v[188:191],v[224:227]
v_mfma_f32_16x16x32_bf16 v[228:231],v[232:235],v[200:203],v[228:231]
ds_read_b64_tr_b16 a[228:229],v8 offset:49152
ds_read_b64_tr_b16 a[230:231],v8 offset:57344
v_mfma_f32_16x16x32_bf16 v[228:231],v[232:235],v[204:207],v[228:231]
s_waitcnt lgkmcnt(4)
v_mfma_f32_16x16x32_bf16 a[0:3],a[192:195],v[168:171],a[0:3]
v_mfma_f32_16x16x32_bf16 a[0:3],a[196:199],v[172:175],a[0:3]
ds_read_b64_tr_b16 a[232:233],v9 offset:32768
ds_read_b64_tr_b16 a[234:235],v9 offset:40960
v_mfma_f32_16x16x32_bf16 a[64:67],a[192:195],v[184:187],a[64:67]
v_mfma_f32_16x16x32_bf16 a[64:67],a[196:199],v[188:191],a[64:67]
s_mov_b32 s28,0x4e800000
s_mov_b32 s66,0
v_cmp_ngt_f32 vcc,s28,v220
s_cmp_lg_u64 vcc,0
v_mfma_f32_16x16x32_bf16 a[128:131],a[192:195],v[200:203],a[128:131]
ds_read_b64_tr_b16 a[236:237],v9 offset:49152
ds_read_b64_tr_b16 a[238:239],v9 offset:57344
s_cselect_b32 s66,1,s66
v_cmp_ngt_f32 vcc,s28,v224
v_mfma_f32_16x16x32_bf16 a[128:131],a[196:199],v[204:207],a[128:131]
s_cmp_lg_u64 vcc,0
s_cselect_b32 s66,1,s66
v_cmp_ngt_f32 vcc,s28,v228
s_cmp_lg_u64 vcc,0
v_mfma_f32_16x16x32_bf16 a[4:7],a[200:203],v[168:171],a[4:7]
s_cselect_b32 s66,1,s66
s_lshl_b32 s28,s24,2
s_add_u32 s28,s28,155648
v_mov_b32 v221,s28
v_mfma_f32_16x16x32_bf16 a[4:7],a[204:207],v[172:175],a[4:7]
ds_read_b64_tr_b16 a[240:241],v10 offset:32768
ds_read_b64_tr_b16 a[242:243],v10 offset:40960
v_mov_b32 v222,s66
v_mov_b32 v223,155648
v_mfma_f32_16x16x32_bf16 a[68:71],a[200:203],v[184:187],a[68:71]
ds_write_b32 v221,v222
v_rcp_f32 v220,v220
v_mfma_f32_16x16x32_bf16 a[68:71],a[204:207],v[188:191],a[68:71]
v_rcp_f32 v224,v224
v_rcp_f32 v228,v228
v_mfma_f32_16x16x32_bf16 a[132:135],a[200:203],v[200:203],a[132:135]
ds_read_b64_tr_b16 a[244:245],v10 offset:49152
ds_read_b64_tr_b16 a[246:247],v10 offset:57344
v_lshrrev_b32 v226,2,v248
v_and_b32 v226,60,v226
v_mfma_f32_16x16x32_bf16 a[132:135],a[204:207],v[204:207],a[132:135]
buffer_store_dword v220,v226,s[20:23],s68 offen offset:0
buffer_store_dword v224,v226,s[20:23],s68 offen offset:64
buffer_store_dword v228,v226,s[20:23],s68 offen offset:128
v_accvgpr_read_b32 v208,a0
v_mfma_f32_16x16x32_bf16 a[8:11],a[208:211],v[168:171],a[8:11]
v_accvgpr_read_b32 v209,a1
v_accvgpr_read_b32 v210,a2
v_accvgpr_read_b32 v211,a3
v_cvt_pk_bf16_f32 v112,v208,v209
v_mfma_f32_16x16x32_bf16 a[8:11],a[212:215],v[172:175],a[8:11]
ds_read_b64_tr_b16 a[248:249],v11 offset:32768
ds_read_b64_tr_b16 a[250:251],v11 offset:40960
v_cvt_pk_bf16_f32 v113,v210,v211
v_accvgpr_read_b32 v212,a64
v_mfma_f32_16x16x32_bf16 a[72:75],a[208:211],v[184:187],a[72:75]
v_accvgpr_read_b32 v213,a65
v_accvgpr_read_b32 v214,a66
v_accvgpr_read_b32 v215,a67
v_cvt_pk_bf16_f32 v128,v212,v213
v_mfma_f32_16x16x32_bf16 a[72:75],a[212:215],v[188:191],a[72:75]
v_cvt_pk_bf16_f32 v129,v214,v215
v_accvgpr_read_b32 v208,a128
v_accvgpr_read_b32 v209,a129
v_accvgpr_read_b32 v210,a130
v_mfma_f32_16x16x32_bf16 a[136:139],a[208:211],v[200:203],a[136:139]
ds_read_b64_tr_b16 a[252:253],v11 offset:49152
ds_read_b64_tr_b16 a[254:255],v11 offset:57344
v_accvgpr_read_b32 v211,a131
v_cvt_pk_bf16_f32 v144,v208,v209
v_mfma_f32_16x16x32_bf16 a[136:139],a[212:215],v[204:207],a[136:139]
v_cvt_pk_bf16_f32 v145,v210,v211
v_accvgpr_read_b32 v212,a4
v_accvgpr_read_b32 v213,a5
v_accvgpr_read_b32 v214,a6
v_mfma_f32_16x16x32_bf16 a[12:15],a[216:219],v[168:171],a[12:15]
v_accvgpr_read_b32 v215,a7
v_cvt_pk_bf16_f32 v114,v212,v213
v_cvt_pk_bf16_f32 v115,v214,v215
v_accvgpr_read_b32 v208,a68
v_mfma_f32_16x16x32_bf16 a[12:15],a[220:223],v[172:175],a[12:15]
ds_read_b64_tr_b16 a[192:193],v4 offset:33024
ds_read_b64_tr_b16 a[194:195],v4 offset:41216
v_accvgpr_read_b32 v209,a69
v_accvgpr_read_b32 v210,a70
v_mfma_f32_16x16x32_bf16 a[76:79],a[216:219],v[184:187],a[76:79]
v_accvgpr_read_b32 v211,a71
v_cvt_pk_bf16_f32 v130,v208,v209
v_cvt_pk_bf16_f32 v131,v210,v211
v_accvgpr_read_b32 v212,a132
v_mfma_f32_16x16x32_bf16 a[76:79],a[220:223],v[188:191],a[76:79]
v_accvgpr_read_b32 v213,a133
v_accvgpr_read_b32 v214,a134
v_accvgpr_read_b32 v215,a135
v_cvt_pk_bf16_f32 v146,v212,v213
v_mfma_f32_16x16x32_bf16 a[140:143],a[216:219],v[200:203],a[140:143]
ds_read_b64_tr_b16 a[196:197],v4 offset:49408
ds_read_b64_tr_b16 a[198:199],v4 offset:57600
v_cvt_pk_bf16_f32 v147,v214,v215
v_accvgpr_read_b32 v208,a8
v_mfma_f32_16x16x32_bf16 a[140:143],a[220:223],v[204:207],a[140:143]
v_accvgpr_read_b32 v209,a9
v_accvgpr_read_b32 v210,a10
v_accvgpr_read_b32 v211,a11
s_waitcnt lgkmcnt(4)
v_mfma_f32_16x16x32_bf16 a[16:19],a[224:227],v[168:171],a[16:19]
v_cvt_pk_bf16_f32 v116,v208,v209
v_cvt_pk_bf16_f32 v117,v210,v211
v_accvgpr_read_b32 v212,a72
v_accvgpr_read_b32 v213,a73
v_mfma_f32_16x16x32_bf16 a[16:19],a[228:231],v[172:175],a[16:19]
v_accvgpr_read_b32 v214,a74
v_accvgpr_read_b32 v215,a75
v_cvt_pk_bf16_f32 v132,v212,v213
v_cvt_pk_bf16_f32 v133,v214,v215
v_mfma_f32_16x16x32_bf16 a[80:83],a[224:227],v[184:187],a[80:83]
ds_read_b64_tr_b16 a[200:201],v5 offset:33024
ds_read_b64_tr_b16 a[202:203],v5 offset:41216
v_accvgpr_read_b32 v208,a136
v_accvgpr_read_b32 v209,a137
v_mfma_f32_16x16x32_bf16 a[80:83],a[228:231],v[188:191],a[80:83]
v_accvgpr_read_b32 v210,a138
v_accvgpr_read_b32 v211,a139
v_cvt_pk_bf16_f32 v148,v208,v209
v_cvt_pk_bf16_f32 v149,v210,v211
v_mfma_f32_16x16x32_bf16 a[144:147],a[224:227],v[200:203],a[144:147]
v_accvgpr_read_b32 v212,a12
v_accvgpr_read_b32 v213,a13
v_accvgpr_read_b32 v214,a14
v_accvgpr_read_b32 v215,a15
v_mfma_f32_16x16x32_bf16 a[144:147],a[228:231],v[204:207],a[144:147]
ds_read_b64_tr_b16 a[204:205],v5 offset:49408
ds_read_b64_tr_b16 a[206:207],v5 offset:57600
v_cvt_pk_bf16_f32 v118,v212,v213
v_cvt_pk_bf16_f32 v119,v214,v215
v_mfma_f32_16x16x32_bf16 a[20:23],a[232:235],v[168:171],a[20:23]
v_accvgpr_read_b32 v208,a76
v_accvgpr_read_b32 v209,a77
v_accvgpr_read_b32 v210,a78
v_accvgpr_read_b32 v211,a79
v_mfma_f32_16x16x32_bf16 a[20:23],a[236:239],v[172:175],a[20:23]
v_cvt_pk_bf16_f32 v134,v208,v209
v_cvt_pk_bf16_f32 v135,v210,v211
v_accvgpr_read_b32 v212,a140
v_accvgpr_read_b32 v213,a141
v_mfma_f32_16x16x32_bf16 a[84:87],a[232:235],v[184:187],a[84:87]
ds_read_b64_tr_b16 a[208:209],v6 offset:33024
ds_read_b64_tr_b16 a[210:211],v6 offset:41216
v_accvgpr_read_b32 v214,a142
v_accvgpr_read_b32 v215,a143
v_mfma_f32_16x16x32_bf16 a[84:87],a[236:239],v[188:191],a[84:87]
v_cvt_pk_bf16_f32 v150,v212,v213
v_cvt_pk_bf16_f32 v151,v214,v215
v_accvgpr_read_b32 v208,a16
v_accvgpr_read_b32 v209,a17
v_mfma_f32_16x16x32_bf16 a[148:151],a[232:235],v[200:203],a[148:151]
v_accvgpr_read_b32 v210,a18
v_accvgpr_read_b32 v211,a19
v_cvt_pk_bf16_f32 v120,v208,v209
v_cvt_pk_bf16_f32 v121,v210,v211
v_mfma_f32_16x16x32_bf16 a[148:151],a[236:239],v[204:207],a[148:151]
ds_read_b64_tr_b16 a[212:213],v6 offset:49408
ds_read_b64_tr_b16 a[214:215],v6 offset:57600
v_accvgpr_read_b32 v212,a80
v_accvgpr_read_b32 v213,a81
v_mfma_f32_16x16x32_bf16 a[24:27],a[240:243],v[168:171],a[24:27]
v_accvgpr_read_b32 v214,a82
v_accvgpr_read_b32 v215,a83
v_cvt_pk_bf16_f32 v136,v212,v213
v_cvt_pk_bf16_f32 v137,v214,v215
v_mfma_f32_16x16x32_bf16 a[24:27],a[244:247],v[172:175],a[24:27]
v_accvgpr_read_b32 v208,a144
v_accvgpr_read_b32 v209,a145
v_accvgpr_read_b32 v210,a146
v_accvgpr_read_b32 v211,a147
v_mfma_f32_16x16x32_bf16 a[88:91],a[240:243],v[184:187],a[88:91]
ds_read_b64_tr_b16 a[216:217],v7 offset:33024
ds_read_b64_tr_b16 a[218:219],v7 offset:41216
v_cvt_pk_bf16_f32 v152,v208,v209
v_cvt_pk_bf16_f32 v153,v210,v211
v_mfma_f32_16x16x32_bf16 a[88:91],a[244:247],v[188:191],a[88:91]
v_accvgpr_read_b32 v212,a20
v_accvgpr_read_b32 v213,a21
v_accvgpr_read_b32 v214,a22
v_accvgpr_read_b32 v215,a23
v_mfma_f32_16x16x32_bf16 a[152:155],a[240:243],v[200:203],a[152:155]
v_cvt_pk_bf16_f32 v122,v212,v213
v_cvt_pk_bf16_f32 v123,v214,v215
v_accvgpr_read_b32 v208,a84
v_accvgpr_read_b32 v209,a85
v_mfma_f32_16x16x32_bf16 a[152:155],a[244:247],v[204:207],a[152:155]
ds_read_b64_tr_b16 a[220:221],v7 offset:49408
ds_read_b64_tr_b16 a[222:223],v7 offset:57600
v_accvgpr_read_b32 v210,a86
v_accvgpr_read_b32 v211,a87
v_mfma_f32_16x16x32_bf16 a[28:31],a[248:251],v[168:171],a[28:31]
v_cvt_pk_bf16_f32 v138,v208,v209
v_cvt_pk_bf16_f32 v139,v210,v211
v_accvgpr_read_b32 v212,a148
v_accvgpr_read_b32 v213,a149
v_mfma_f32_16x16x32_bf16 a[28:31],a[252:255],v[172:175],a[28:31]
v_accvgpr_read_b32 v214,a150
v_accvgpr_read_b32 v215,a151
v_cvt_pk_bf16_f32 v154,v212,v213
v_cvt_pk_bf16_f32 v155,v214,v215
v_mfma_f32_16x16x32_bf16 a[92:95],a[248:251],v[184:187],a[92:95]
ds_read_b64_tr_b16 a[224:225],v8 offset:33024
ds_read_b64_tr_b16 a[226:227],v8 offset:41216
v_accvgpr_read_b32 v208,a24
v_accvgpr_read_b32 v209,a25
v_mfma_f32_16x16x32_bf16 a[92:95],a[252:255],v[188:191],a[92:95]
v_accvgpr_read_b32 v210,a26
v_accvgpr_read_b32 v211,a27
v_cvt_pk_bf16_f32 v124,v208,v209
v_cvt_pk_bf16_f32 v125,v210,v211
v_mfma_f32_16x16x32_bf16 a[156:159],a[248:251],v[200:203],a[156:159]
v_accvgpr_read_b32 v212,a88
v_accvgpr_read_b32 v213,a89
v_accvgpr_read_b32 v214,a90
v_accvgpr_read_b32 v215,a91
v_mfma_f32_16x16x32_bf16 a[156:159],a[252:255],v[204:207],a[156:159]
ds_read_b64_tr_b16 a[228:229],v8 offset:49408
ds_read_b64_tr_b16 a[230:231],v8 offset:57600
v_cvt_pk_bf16_f32 v140,v212,v213
s_waitcnt lgkmcnt(6)
v_mfma_f32_16x16x32_bf16 a[32:35],a[192:195],v[168:171],a[32:35]
v_cvt_pk_bf16_f32 v141,v214,v215
v_accvgpr_read_b32 v208,a152
v_accvgpr_read_b32 v209,a153
v_accvgpr_read_b32 v210,a154
v_mfma_f32_16x16x32_bf16 a[32:35],a[196:199],v[172:175],a[32:35]
v_accvgpr_read_b32 v211,a155
v_cvt_pk_bf16_f32 v156,v208,v209
v_cvt_pk_bf16_f32 v157,v210,v211
v_accvgpr_read_b32 v212,a28
v_mfma_f32_16x16x32_bf16 a[96:99],a[192:195],v[184:187],a[96:99]
ds_read_b64_tr_b16 a[232:233],v9 offset:33024
ds_read_b64_tr_b16 a[234:235],v9 offset:41216
v_accvgpr_read_b32 v213,a29
v_accvgpr_read_b32 v214,a30
v_mfma_f32_16x16x32_bf16 a[96:99],a[196:199],v[188:191],a[96:99]
v_accvgpr_read_b32 v215,a31
v_cvt_pk_bf16_f32 v126,v212,v213
v_cvt_pk_bf16_f32 v127,v214,v215
v_accvgpr_read_b32 v208,a92
v_mfma_f32_16x16x32_bf16 a[160:163],a[192:195],v[200:203],a[160:163]
v_accvgpr_read_b32 v209,a93
v_accvgpr_read_b32 v210,a94
v_accvgpr_read_b32 v211,a95
v_cvt_pk_bf16_f32 v142,v208,v209
v_mfma_f32_16x16x32_bf16 a[160:163],a[196:199],v[204:207],a[160:163]
v_cvt_pk_bf16_f32 v143,v210,v211
v_accvgpr_read_b32 v212,a156
v_accvgpr_read_b32 v213,a157
v_accvgpr_read_b32 v214,a158
v_mfma_f32_16x16x32_bf16 a[36:39],a[200:203],v[168:171],a[36:39]
ds_read_b64_tr_b16 a[236:237],v9 offset:49408
ds_read_b64_tr_b16 a[238:239],v9 offset:57600
v_accvgpr_read_b32 v215,a159
v_cvt_pk_bf16_f32 v158,v212,v213
v_mfma_f32_16x16x32_bf16 a[36:39],a[204:207],v[172:175],a[36:39]
v_cvt_pk_bf16_f32 v159,v214,v215
v_accvgpr_read_b32 v208,a32
v_accvgpr_read_b32 v209,a33
v_accvgpr_read_b32 v210,a34
v_mfma_f32_16x16x32_bf16 a[100:103],a[200:203],v[184:187],a[100:103]
v_accvgpr_read_b32 v211,a35
v_cvt_pk_bf16_f32 v160,v208,v209
v_cvt_pk_bf16_f32 v161,v210,v211
v_accvgpr_read_b32 v212,a96
v_mfma_f32_16x16x32_bf16 a[100:103],a[204:207],v[188:191],a[100:103]
ds_read_b64_tr_b16 a[240:241],v10 offset:33024
ds_read_b64_tr_b16 a[242:243],v10 offset:41216
v_accvgpr_read_b32 v213,a97
v_accvgpr_read_b32 v214,a98
v_mfma_f32_16x16x32_bf16 a[164:167],a[200:203],v[200:203],a[164:167]
v_accvgpr_read_b32 v215,a99
v_cvt_pk_bf16_f32 v176,v212,v213
v_cvt_pk_bf16_f32 v177,v214,v215
v_accvgpr_read_b32 v208,a160
v_mfma_f32_16x16x32_bf16 a[164:167],a[204:207],v[204:207],a[164:167]
v_accvgpr_read_b32 v209,a161
v_accvgpr_read_b32 v210,a162
v_accvgpr_read_b32 v211,a163
v_cvt_pk_bf16_f32 v192,v208,v209
v_mfma_f32_16x16x32_bf16 a[40:43],a[208:211],v[168:171],a[40:43]
ds_read_b64_tr_b16 a[244:245],v10 offset:49408
ds_read_b64_tr_b16 a[246:247],v10 offset:57600
v_cvt_pk_bf16_f32 v193,v210,v211
v_accvgpr_read_b32 v212,a36
v_mfma_f32_16x16x32_bf16 a[40:43],a[212:215],v[172:175],a[40:43]
v_accvgpr_read_b32 v213,a37
v_accvgpr_read_b32 v214,a38
v_accvgpr_read_b32 v215,a39
v_cvt_pk_bf16_f32 v162,v212,v213
v_mfma_f32_16x16x32_bf16 a[104:107],a[208:211],v[184:187],a[104:107]
v_cvt_pk_bf16_f32 v163,v214,v215
v_accvgpr_read_b32 v208,a100
v_accvgpr_read_b32 v209,a101
v_accvgpr_read_b32 v210,a102
v_mfma_f32_16x16x32_bf16 a[104:107],a[212:215],v[188:191],a[104:107]
ds_read_b64_tr_b16 a[248:249],v11 offset:33024
ds_read_b64_tr_b16 a[250:251],v11 offset:41216
v_accvgpr_read_b32 v211,a103
v_cvt_pk_bf16_f32 v178,v208,v209
v_mfma_f32_16x16x32_bf16 a[168:171],a[208:211],v[200:203],a[168:171]
v_cvt_pk_bf16_f32 v179,v210,v211
v_accvgpr_read_b32 v212,a164
v_accvgpr_read_b32 v213,a165
v_accvgpr_read_b32 v214,a166
v_mfma_f32_16x16x32_bf16 a[168:171],a[212:215],v[204:207],a[168:171]
v_accvgpr_read_b32 v215,a167
v_cvt_pk_bf16_f32 v194,v212,v213
v_cvt_pk_bf16_f32 v195,v214,v215
v_accvgpr_read_b32 v208,a40
v_mfma_f32_16x16x32_bf16 a[44:47],a[216:219],v[168:171],a[44:47]
ds_read_b64_tr_b16 a[252:253],v11 offset:49408
ds_read_b64_tr_b16 a[254:255],v11 offset:57600
v_accvgpr_read_b32 v209,a41
s_waitcnt lgkmcnt(6)
v_mfma_f32_16x16x32_bf16 a[44:47],a[220:223],v[172:175],a[44:47]
v_accvgpr_read_b32 v210,a42
v_accvgpr_read_b32 v211,a43
v_cvt_pk_bf16_f32 v164,v208,v209
v_cvt_pk_bf16_f32 v165,v210,v211
v_mfma_f32_16x16x32_bf16 a[108:111],a[216:219],v[184:187],a[108:111]
v_accvgpr_read_b32 v212,a104
v_accvgpr_read_b32 v213,a105
v_accvgpr_read_b32 v214,a106
v_accvgpr_read_b32 v215,a107
v_mfma_f32_16x16x32_bf16 a[108:111],a[220:223],v[188:191],a[108:111]
v_cvt_pk_bf16_f32 v180,v212,v213
v_cvt_pk_bf16_f32 v181,v214,v215
v_accvgpr_read_b32 v208,a168
v_accvgpr_read_b32 v209,a169
v_mfma_f32_16x16x32_bf16 a[172:175],a[216:219],v[200:203],a[172:175]
v_accvgpr_read_b32 v210,a170
v_accvgpr_read_b32 v211,a171
v_cvt_pk_bf16_f32 v196,v208,v209
v_cvt_pk_bf16_f32 v197,v210,v211
v_mfma_f32_16x16x32_bf16 a[172:175],a[220:223],v[204:207],a[172:175]
v_accvgpr_read_b32 v212,a44
v_accvgpr_read_b32 v213,a45
v_accvgpr_read_b32 v214,a46
v_accvgpr_read_b32 v215,a47
v_mfma_f32_16x16x32_bf16 a[48:51],a[224:227],v[168:171],a[48:51]
v_cvt_pk_bf16_f32 v166,v212,v213
s_waitcnt lgkmcnt(0)
s_waitcnt vmcnt(19)
s_barrier
v_mfma_f32_16x16x32_bf16 a[48:51],a[228:231],v[172:175],a[48:51]
ds_read_b64_tr_b16 a[192:193],v240 offset:49152
ds_read_b64_tr_b16 a[194:195],v240 offset:51200
ds_read_b128 v[216:219],v223
v_cvt_pk_bf16_f32 v167,v214,v215
v_mfma_f32_16x16x32_bf16 a[112:115],a[224:227],v[184:187],a[112:115]
s_add_u32 m0,s25,98304
s_add_u32 s28,s67,384
v_accvgpr_read_b32 v208,a108
v_accvgpr_read_b32 v209,a109
v_mfma_f32_16x16x32_bf16 a[112:115],a[228:231],v[188:191],a[112:115]
buffer_load_dwordx4 v236,s[96:99],s28 offen lds
v_accvgpr_read_b32 v210,a110
v_accvgpr_read_b32 v211,a111
v_mfma_f32_16x16x32_bf16 a[176:179],a[224:227],v[200:203],a[176:179]
ds_read_b64_tr_b16 a[196:197],v240 offset:53248
ds_read_b64_tr_b16 a[198:199],v240 offset:55296
v_cvt_pk_bf16_f32 v182,v208,v209
v_cvt_pk_bf16_f32 v183,v210,v211
v_mfma_f32_16x16x32_bf16 a[176:179],a[228:231],v[204:207],a[176:179]
buffer_load_dwordx4 v237,s[96:99],s28 offen offset:1024 lds
v_accvgpr_read_b32 v212,a172
v_accvgpr_read_b32 v213,a173
v_mfma_f32_16x16x32_bf16 a[52:55],a[232:235],v[168:171],a[52:55]
buffer_load_dwordx4 v238,s[96:99],s28 offen offset:2048 lds
v_accvgpr_read_b32 v214,a174
v_accvgpr_read_b32 v215,a175
v_mfma_f32_16x16x32_bf16 a[52:55],a[236:239],v[172:175],a[52:55]
ds_read_b64_tr_b16 a[200:201],v240 offset:57344
ds_read_b64_tr_b16 a[202:203],v240 offset:59392
v_cvt_pk_bf16_f32 v198,v212,v213
v_cvt_pk_bf16_f32 v199,v214,v215
v_mfma_f32_16x16x32_bf16 a[116:119],a[232:235],v[184:187],a[116:119]
buffer_load_dwordx4 v239,s[96:99],s28 offen offset:3072 lds
s_add_u32 m0,s25,114688
v_mfma_f32_16x16x32_bf16 a[116:119],a[236:239],v[188:191],a[116:119]
s_add_u32 s28,s67,115072
buffer_load_dwordx4 v236,s[96:99],s28 offen lds
v_mfma_f32_16x16x32_bf16 a[180:183],a[232:235],v[200:203],a[180:183]
ds_read_b64_tr_b16 a[204:205],v240 offset:61440
ds_read_b64_tr_b16 a[206:207],v240 offset:63488
v_mfma_f32_16x16x32_bf16 a[180:183],a[236:239],v[204:207],a[180:183]
buffer_load_dwordx4 v237,s[96:99],s28 offen offset:1024 lds
v_mfma_f32_16x16x32_bf16 a[56:59],a[240:243],v[168:171],a[56:59]
buffer_load_dwordx4 v238,s[96:99],s28 offen offset:2048 lds
s_waitcnt lgkmcnt(9)
v_mfma_f32_16x16x32_bf16 a[56:59],a[244:247],v[172:175],a[56:59]
ds_read_b64_tr_b16 a[208:209],v241 offset:49152
ds_read_b64_tr_b16 a[210:211],v241 offset:51200
v_mfma_f32_16x16x32_bf16 a[120:123],a[240:243],v[184:187],a[120:123]
buffer_load_dwordx4 v239,s[96:99],s28 offen offset:3072 lds
v_mfma_f32_16x16x32_bf16 a[120:123],a[244:247],v[188:191],a[120:123]
v_mfma_f32_16x16x32_bf16 a[184:187],a[240:243],v[200:203],a[184:187]
ds_read_b64_tr_b16 a[212:213],v241 offset:53248
ds_read_b64_tr_b16 a[214:215],v241 offset:55296
v_mfma_f32_16x16x32_bf16 a[184:187],a[244:247],v[204:207],a[184:187]
v_mfma_f32_16x16x32_bf16 a[60:63],a[248:251],v[168:171],a[60:63]
v_mfma_f32_16x16x32_bf16 a[60:63],a[252:255],v[172:175],a[60:63]
ds_read_b64_tr_b16 a[216:217],v241 offset:57344
ds_read_b64_tr_b16 a[218:219],v241 offset:59392
v_mfma_f32_16x16x32_bf16 a[124:127],a[248:251],v[184:187],a[124:127]
v_mfma_f32_16x16x32_bf16 a[124:127],a[252:255],v[188:191],a[124:127]
s_waitcnt lgkmcnt(12)
v_or3_b32 v216,v216,v217,v218
v_or_b32 v216,v216,v219
v_mfma_f32_16x16x32_bf16 a[188:191],a[248:251],v[200:203],a[188:191]
ds_read_b64_tr_b16 a[220:221],v241 offset:61440
ds_read_b64_tr_b16 a[222:223],v241 offset:63488
v_mfma_f32_16x16x32_bf16 a[188:191],a[252:255],v[204:207],a[188:191]
v_readfirstlane_b32 s66,v216
s_andn2_b32 s66,s66,s30
s_cbranch_scc1 FALLBACK_A
s_waitcnt lgkmcnt(4)
v_mfma_f32_16x16x32_bf16 v[16:19],a[192:195],v[112:115],0
ds_read_b64_tr_b16 a[224:225],v242 offset:49152
ds_read_b64_tr_b16 a[226:227],v242 offset:51200
v_mfma_f32_16x16x32_bf16 v[16:19],a[196:199],v[116:119],v[16:19]
v_mfma_f32_16x16x32_bf16 v[16:19],a[200:203],v[120:123],v[16:19]
v_mfma_f32_16x16x32_bf16 v[16:19],a[204:207],v[124:127],v[16:19]
ds_read_b64_tr_b16 a[228:229],v242 offset:53248
ds_read_b64_tr_b16 a[230:231],v242 offset:55296
v_accvgpr_read_b32 v208,a48
v_mfma_f32_16x16x32_bf16 v[20:23],a[192:195],v[128:131],0
v_accvgpr_read_b32 v209,a49
v_accvgpr_read_b32 v210,a50
v_accvgpr_read_b32 v211,a51
v_mfma_f32_16x16x32_bf16 v[20:23],a[196:199],v[132:135],v[20:23]
v_cvt_pk_bf16_f32 v168,v208,v209
v_cvt_pk_bf16_f32 v169,v210,v211
v_accvgpr_read_b32 v212,a112
v_mfma_f32_16x16x32_bf16 v[20:23],a[200:203],v[136:139],v[20:23]
ds_read_b64_tr_b16 a[232:233],v242 offset:57344
ds_read_b64_tr_b16 a[234:235],v242 offset:59392
v_accvgpr_read_b32 v213,a113
v_mfma_f32_16x16x32_bf16 v[20:23],a[204:207],v[140:143],v[20:23]
v_accvgpr_read_b32 v214,a114
v_accvgpr_read_b32 v215,a115
v_cvt_pk_bf16_f32 v184,v212,v213
v_mfma_f32_16x16x32_bf16 v[24:27],a[192:195],v[144:147],0
v_cvt_pk_bf16_f32 v185,v214,v215
v_accvgpr_read_b32 v208,a176
v_accvgpr_read_b32 v209,a177
v_mfma_f32_16x16x32_bf16 v[24:27],a[196:199],v[148:151],v[24:27]
ds_read_b64_tr_b16 a[236:237],v242 offset:61440
ds_read_b64_tr_b16 a[238:239],v242 offset:63488
v_accvgpr_read_b32 v210,a178
v_mfma_f32_16x16x32_bf16 v[24:27],a[200:203],v[152:155],v[24:27]
v_accvgpr_read_b32 v211,a179
v_cvt_pk_bf16_f32 v200,v208,v209
v_cvt_pk_bf16_f32 v201,v210,v211
v_mfma_f32_16x16x32_bf16 v[24:27],a[204:207],v[156:159],v[24:27]
v_accvgpr_read_b32 v212,a52
v_accvgpr_read_b32 v213,a53
v_accvgpr_read_b32 v214,a54
v_mfma_f32_16x16x32_bf16 v[28:31],a[208:211],v[112:115],0
ds_read_b64_tr_b16 a[240:241],v243 offset:49152
ds_read_b64_tr_b16 a[242:243],v243 offset:51200
v_accvgpr_read_b32 v215,a55
v_mfma_f32_16x16x32_bf16 v[28:31],a[212:215],v[116:119],v[28:31]
v_cvt_pk_bf16_f32 v170,v212,v213
v_cvt_pk_bf16_f32 v171,v214,v215
s_waitcnt lgkmcnt(4)
v_mfma_f32_16x16x32_bf16 v[28:31],a[216:219],v[120:123],v[28:31]
v_accvgpr_read_b32 v208,a116
v_accvgpr_read_b32 v209,a117
v_accvgpr_read_b32 v210,a118
v_mfma_f32_16x16x32_bf16 v[28:31],a[220:223],v[124:127],v[28:31]
ds_read_b64_tr_b16 a[244:245],v243 offset:53248
ds_read_b64_tr_b16 a[246:247],v243 offset:55296
v_accvgpr_read_b32 v211,a119
v_mfma_f32_16x16x32_bf16 v[32:35],a[208:211],v[128:131],0
v_cvt_pk_bf16_f32 v186,v208,v209
v_cvt_pk_bf16_f32 v187,v210,v211
v_accvgpr_read_b32 v212,a180
v_mfma_f32_16x16x32_bf16 v[32:35],a[212:215],v[132:135],v[32:35]
v_accvgpr_read_b32 v213,a181
v_accvgpr_read_b32 v214,a182
v_accvgpr_read_b32 v215,a183
v_mfma_f32_16x16x32_bf16 v[32:35],a[216:219],v[136:139],v[32:35]
ds_read_b64_tr_b16 a[248:249],v243 offset:57344
ds_read_b64_tr_b16 a[250:251],v243 offset:59392
v_cvt_pk_bf16_f32 v202,v212,v213
v_mfma_f32_16x16x32_bf16 v[32:35],a[220:223],v[140:143],v[32:35]
v_cvt_pk_bf16_f32 v203,v214,v215
v_mfma_f32_16x16x32_bf16 v[36:39],a[208:211],v[144:147],0
v_mfma_f32_16x16x32_bf16 v[36:39],a[212:215],v[148:151],v[36:39]
ds_read_b64_tr_b16 a[252:253],v243 offset:61440
ds_read_b64_tr_b16 a[254:255],v243 offset:63488
v_mfma_f32_16x16x32_bf16 v[36:39],a[216:219],v[152:155],v[36:39]
v_mfma_f32_16x16x32_bf16 v[36:39],a[220:223],v[156:159],v[36:39]
v_mfma_f32_16x16x32_bf16 v[40:43],a[224:227],v[112:115],0
ds_read_b64_tr_b16 a[192:193],v244 offset:0
ds_read_b64_tr_b16 a[194:195],v244 offset:2048
v_mfma_f32_16x16x32_bf16 v[40:43],a[228:231],v[116:119],v[40:43]
v_mfma_f32_16x16x32_bf16 v[40:43],a[232:235],v[120:123],v[40:43]
s_waitcnt lgkmcnt(4)
v_mfma_f32_16x16x32_bf16 v[40:43],a[236:239],v[124:127],v[40:43]
ds_read_b64_tr_b16 a[196:197],v244 offset:4096
ds_read_b64_tr_b16 a[198:199],v244 offset:6144
v_mfma_f32_16x16x32_bf16 v[44:47],a[224:227],v[128:131],0
v_mfma_f32_16x16x32_bf16 v[44:47],a[228:231],v[132:135],v[44:47]
v_mfma_f32_16x16x32_bf16 v[44:47],a[232:235],v[136:139],v[44:47]
ds_read_b64_tr_b16 a[200:201],v244 offset:8192
ds_read_b64_tr_b16 a[202:203],v244 offset:10240
v_mfma_f32_16x16x32_bf16 v[44:47],a[236:239],v[140:143],v[44:47]
v_mfma_f32_16x16x32_bf16 v[48:51],a[224:227],v[144:147],0
v_mfma_f32_16x16x32_bf16 v[48:51],a[228:231],v[148:151],v[48:51]
ds_read_b64_tr_b16 a[204:205],v244 offset:12288
ds_read_b64_tr_b16 a[206:207],v244 offset:14336
v_mfma_f32_16x16x32_bf16 v[48:51],a[232:235],v[152:155],v[48:51]
v_mfma_f32_16x16x32_bf16 v[48:51],a[236:239],v[156:159],v[48:51]
v_mfma_f32_16x16x32_bf16 v[52:55],a[240:243],v[112:115],0
ds_read_b64_tr_b16 a[208:209],v245 offset:0
ds_read_b64_tr_b16 a[210:211],v245 offset:2048
v_mfma_f32_16x16x32_bf16 v[52:55],a[244:247],v[116:119],v[52:55]
v_mfma_f32_16x16x32_bf16 v[52:55],a[248:251],v[120:123],v[52:55]
s_waitcnt lgkmcnt(10)
v_mfma_f32_16x16x32_bf16 v[52:55],a[252:255],v[124:127],v[52:55]
ds_read_b64_tr_b16 a[212:213],v245 offset:4096
ds_read_b64_tr_b16 a[214:215],v245 offset:6144
v_mfma_f32_16x16x32_bf16 v[56:59],a[240:243],v[128:131],0
v_mfma_f32_16x16x32_bf16 v[56:59],a[244:247],v[132:135],v[56:59]
v_mfma_f32_16x16x32_bf16 v[56:59],a[248:251],v[136:139],v[56:59]
ds_read_b64_tr_b16 a[216:217],v245 offset:8192
ds_read_b64_tr_b16 a[218:219],v245 offset:10240
v_mfma_f32_16x16x32_bf16 v[56:59],a[252:255],v[140:143],v[56:59]
v_mfma_f32_16x16x32_bf16 v[60:63],a[240:243],v[144:147],0
v_mfma_f32_16x16x32_bf16 v[60:63],a[244:247],v[148:151],v[60:63]
ds_read_b64_tr_b16 a[220:221],v245 offset:12288
ds_read_b64_tr_b16 a[222:223],v245 offset:14336
v_mfma_f32_16x16x32_bf16 v[60:63],a[248:251],v[152:155],v[60:63]
v_mfma_f32_16x16x32_bf16 v[60:63],a[252:255],v[156:159],v[60:63]
s_waitcnt vmcnt(23)
s_barrier
s_waitcnt lgkmcnt(4)
v_mfma_f32_16x16x32_bf16 v[64:67],a[192:195],v[112:115],0
ds_read_b64_tr_b16 a[224:225],v246 offset:0
ds_read_b64_tr_b16 a[226:227],v246 offset:2048
v_accvgpr_read_b32 v208,a56
v_mfma_f32_16x16x32_bf16 v[64:67],a[196:199],v[116:119],v[64:67]
s_add_u32 m0,s25,131072
s_add_u32 s28,s67,512
v_accvgpr_read_b32 v209,a57
v_mfma_f32_16x16x32_bf16 v[64:67],a[200:203],v[120:123],v[64:67]
buffer_load_dwordx4 v236,s[96:99],s28 offen lds
v_accvgpr_read_b32 v210,a58
v_mfma_f32_16x16x32_bf16 v[64:67],a[204:207],v[124:127],v[64:67]
ds_read_b64_tr_b16 a[228:229],v246 offset:4096
ds_read_b64_tr_b16 a[230:231],v246 offset:6144
v_accvgpr_read_b32 v211,a59
v_mfma_f32_16x16x32_bf16 v[68:71],a[192:195],v[128:131],0
buffer_load_dwordx4 v237,s[96:99],s28 offen offset:1024 lds
v_cvt_pk_bf16_f32 v172,v208,v209
v_mfma_f32_16x16x32_bf16 v[68:71],a[196:199],v[132:135],v[68:71]
buffer_load_dwordx4 v238,s[96:99],s28 offen offset:2048 lds
v_cvt_pk_bf16_f32 v173,v210,v211
v_mfma_f32_16x16x32_bf16 v[68:71],a[200:203],v[136:139],v[68:71]
ds_read_b64_tr_b16 a[232:233],v246 offset:8192
ds_read_b64_tr_b16 a[234:235],v246 offset:10240
v_accvgpr_read_b32 v212,a120
v_mfma_f32_16x16x32_bf16 v[68:71],a[204:207],v[140:143],v[68:71]
buffer_load_dwordx4 v239,s[96:99],s28 offen offset:3072 lds
v_accvgpr_read_b32 v213,a121
v_mfma_f32_16x16x32_bf16 v[72:75],a[192:195],v[144:147],0
v_accvgpr_read_b32 v214,a122
v_accvgpr_read_b32 v215,a123
v_cvt_pk_bf16_f32 v188,v212,v213
v_mfma_f32_16x16x32_bf16 v[72:75],a[196:199],v[148:151],v[72:75]
ds_read_b64_tr_b16 a[236:237],v246 offset:12288
ds_read_b64_tr_b16 a[238:239],v246 offset:14336
v_cvt_pk_bf16_f32 v189,v214,v215
v_mfma_f32_16x16x32_bf16 v[72:75],a[200:203],v[152:155],v[72:75]
v_accvgpr_read_b32 v208,a184
v_accvgpr_read_b32 v209,a185
v_accvgpr_read_b32 v210,a186
v_mfma_f32_16x16x32_bf16 v[72:75],a[204:207],v[156:159],v[72:75]
v_accvgpr_read_b32 v211,a187
v_cvt_pk_bf16_f32 v204,v208,v209
v_cvt_pk_bf16_f32 v205,v210,v211
v_mfma_f32_16x16x32_bf16 v[76:79],a[208:211],v[112:115],0
ds_read_b64_tr_b16 a[240:241],v247 offset:0
ds_read_b64_tr_b16 a[242:243],v247 offset:2048
v_accvgpr_read_b32 v212,a60
v_mfma_f32_16x16x32_bf16 v[76:79],a[212:215],v[116:119],v[76:79]
v_accvgpr_read_b32 v213,a61
v_accvgpr_read_b32 v214,a62
s_waitcnt lgkmcnt(4)
v_mfma_f32_16x16x32_bf16 v[76:79],a[216:219],v[120:123],v[76:79]
v_accvgpr_read_b32 v215,a63
v_cvt_pk_bf16_f32 v174,v212,v213
v_cvt_pk_bf16_f32 v175,v214,v215
v_mfma_f32_16x16x32_bf16 v[76:79],a[220:223],v[124:127],v[76:79]
ds_read_b64_tr_b16 a[244:245],v247 offset:4096
ds_read_b64_tr_b16 a[246:247],v247 offset:6144
v_accvgpr_read_b32 v208,a124
v_mfma_f32_16x16x32_bf16 v[80:83],a[208:211],v[128:131],0
v_accvgpr_read_b32 v209,a125
v_accvgpr_read_b32 v210,a126
v_accvgpr_read_b32 v211,a127
v_mfma_f32_16x16x32_bf16 v[80:83],a[212:215],v[132:135],v[80:83]
v_cvt_pk_bf16_f32 v190,v208,v209
v_cvt_pk_bf16_f32 v191,v210,v211
v_accvgpr_read_b32 v212,a188
v_mfma_f32_16x16x32_bf16 v[80:83],a[216:219],v[136:139],v[80:83]
ds_read_b64_tr_b16 a[248:249],v247 offset:8192
ds_read_b64_tr_b16 a[250:251],v247 offset:10240
v_accvgpr_read_b32 v213,a189
v_mfma_f32_16x16x32_bf16 v[80:83],a[220:223],v[140:143],v[80:83]
v_accvgpr_read_b32 v214,a190
v_accvgpr_read_b32 v215,a191
v_cvt_pk_bf16_f32 v206,v212,v213
v_mfma_f32_16x16x32_bf16 v[84:87],a[208:211],v[144:147],0
v_cvt_pk_bf16_f32 v207,v214,v215
v_mfma_f32_16x16x32_bf16 v[84:87],a[212:215],v[148:151],v[84:87]
ds_read_b64_tr_b16 a[252:253],v247 offset:12288
ds_read_b64_tr_b16 a[254:255],v247 offset:14336
v_mfma_f32_16x16x32_bf16 v[84:87],a[216:219],v[152:155],v[84:87]
v_mfma_f32_16x16x32_bf16 v[84:87],a[220:223],v[156:159],v[84:87]
v_mfma_f32_16x16x32_bf16 v[88:91],a[224:227],v[112:115],0
ds_read_b64_tr_b16 a[192:193],v244 offset:16384
ds_read_b64_tr_b16 a[194:195],v244 offset:18432
v_mfma_f32_16x16x32_bf16 v[88:91],a[228:231],v[116:119],v[88:91]
v_mfma_f32_16x16x32_bf16 v[88:91],a[232:235],v[120:123],v[88:91]
s_waitcnt lgkmcnt(4)
v_mfma_f32_16x16x32_bf16 v[88:91],a[236:239],v[124:127],v[88:91]
ds_read_b64_tr_b16 a[196:197],v244 offset:20480
ds_read_b64_tr_b16 a[198:199],v244 offset:22528
v_mfma_f32_16x16x32_bf16 v[92:95],a[224:227],v[128:131],0
v_mfma_f32_16x16x32_bf16 v[92:95],a[228:231],v[132:135],v[92:95]
v_mfma_f32_16x16x32_bf16 v[92:95],a[232:235],v[136:139],v[92:95]
ds_read_b64_tr_b16 a[200:201],v244 offset:24576
ds_read_b64_tr_b16 a[202:203],v244 offset:26624
v_mfma_f32_16x16x32_bf16 v[92:95],a[236:239],v[140:143],v[92:95]
v_mfma_f32_16x16x32_bf16 v[96:99],a[224:227],v[144:147],0
v_mfma_f32_16x16x32_bf16 v[96:99],a[228:231],v[148:151],v[96:99]
ds_read_b64_tr_b16 a[204:205],v244 offset:28672
ds_read_b64_tr_b16 a[206:207],v244 offset:30720
v_mfma_f32_16x16x32_bf16 v[96:99],a[232:235],v[152:155],v[96:99]
v_mfma_f32_16x16x32_bf16 v[96:99],a[236:239],v[156:159],v[96:99]
v_mfma_f32_16x16x32_bf16 v[100:103],a[240:243],v[112:115],0
ds_read_b64_tr_b16 a[208:209],v245 offset:16384
ds_read_b64_tr_b16 a[210:211],v245 offset:18432
v_mfma_f32_16x16x32_bf16 v[100:103],a[244:247],v[116:119],v[100:103]
v_mfma_f32_16x16x32_bf16 v[100:103],a[248:251],v[120:123],v[100:103]
s_waitcnt lgkmcnt(10)
v_mfma_f32_16x16x32_bf16 v[100:103],a[252:255],v[124:127],v[100:103]
ds_read_b64_tr_b16 a[212:213],v245 offset:20480
ds_read_b64_tr_b16 a[214:215],v245 offset:22528
v_mfma_f32_16x16x32_bf16 v[104:107],a[240:243],v[128:131],0
v_mfma_f32_16x16x32_bf16 v[104:107],a[244:247],v[132:135],v[104:107]
v_mfma_f32_16x16x32_bf16 v[104:107],a[248:251],v[136:139],v[104:107]
ds_read_b64_tr_b16 a[216:217],v245 offset:24576
ds_read_b64_tr_b16 a[218:219],v245 offset:26624
v_mfma_f32_16x16x32_bf16 v[104:107],a[252:255],v[140:143],v[104:107]
v_mfma_f32_16x16x32_bf16 v[108:111],a[240:243],v[144:147],0
v_mfma_f32_16x16x32_bf16 v[108:111],a[244:247],v[148:151],v[108:111]
ds_read_b64_tr_b16 a[220:221],v245 offset:28672
ds_read_b64_tr_b16 a[222:223],v245 offset:30720
v_mfma_f32_16x16x32_bf16 v[108:111],a[248:251],v[152:155],v[108:111]
v_mfma_f32_16x16x32_bf16 v[108:111],a[252:255],v[156:159],v[108:111]
s_waitcnt vmcnt(23)
s_barrier
s_waitcnt lgkmcnt(4)
v_mfma_f32_16x16x32_bf16 v[16:19],a[192:195],v[160:163],v[16:19]
ds_read_b64_tr_b16 a[224:225],v246 offset:16384
ds_read_b64_tr_b16 a[226:227],v246 offset:18432
v_mfma_f32_16x16x32_bf16 v[16:19],a[196:199],v[164:167],v[16:19]
s_add_u32 m0,s25,0
s_add_u32 s28,s67,115200
v_mfma_f32_16x16x32_bf16 v[16:19],a[200:203],v[168:171],v[16:19]
buffer_load_dwordx4 v236,s[96:99],s28 offen lds
v_mfma_f32_16x16x32_bf16 v[16:19],a[204:207],v[172:175],v[16:19]
ds_read_b64_tr_b16 a[228:229],v246 offset:20480
ds_read_b64_tr_b16 a[230:231],v246 offset:22528
v_mfma_f32_16x16x32_bf16 v[20:23],a[192:195],v[176:179],v[20:23]
buffer_load_dwordx4 v237,s[96:99],s28 offen offset:1024 lds
v_mfma_f32_16x16x32_bf16 v[20:23],a[196:199],v[180:183],v[20:23]
buffer_load_dwordx4 v238,s[96:99],s28 offen offset:2048 lds
v_mfma_f32_16x16x32_bf16 v[20:23],a[200:203],v[184:187],v[20:23]
ds_read_b64_tr_b16 a[232:233],v246 offset:24576
ds_read_b64_tr_b16 a[234:235],v246 offset:26624
v_mfma_f32_16x16x32_bf16 v[20:23],a[204:207],v[188:191],v[20:23]
buffer_load_dwordx4 v239,s[96:99],s28 offen offset:3072 lds
v_mfma_f32_16x16x32_bf16 v[24:27],a[192:195],v[192:195],v[24:27]
v_mfma_f32_16x16x32_bf16 v[24:27],a[196:199],v[196:199],v[24:27]
ds_read_b64_tr_b16 a[236:237],v246 offset:28672
ds_read_b64_tr_b16 a[238:239],v246 offset:30720
v_mfma_f32_16x16x32_bf16 v[24:27],a[200:203],v[200:203],v[24:27]
v_mfma_f32_16x16x32_bf16 v[24:27],a[204:207],v[204:207],v[24:27]
v_mfma_f32_16x16x32_bf16 v[28:31],a[208:211],v[160:163],v[28:31]
ds_read_b64_tr_b16 a[240:241],v247 offset:16384
ds_read_b64_tr_b16 a[242:243],v247 offset:18432
v_mfma_f32_16x16x32_bf16 v[28:31],a[212:215],v[164:167],v[28:31]
s_waitcnt lgkmcnt(4)
v_mfma_f32_16x16x32_bf16 v[28:31],a[216:219],v[168:171],v[28:31]
v_mfma_f32_16x16x32_bf16 v[28:31],a[220:223],v[172:175],v[28:31]
ds_read_b64_tr_b16 a[244:245],v247 offset:20480
ds_read_b64_tr_b16 a[246:247],v247 offset:22528
v_mfma_f32_16x16x32_bf16 v[32:35],a[208:211],v[176:179],v[32:35]
v_mfma_f32_16x16x32_bf16 v[32:35],a[212:215],v[180:183],v[32:35]
v_mfma_f32_16x16x32_bf16 v[32:35],a[216:219],v[184:187],v[32:35]
ds_read_b64_tr_b16 a[248:249],v247 offset:24576
ds_read_b64_tr_b16 a[250:251],v247 offset:26624
v_mfma_f32_16x16x32_bf16 v[32:35],a[220:223],v[188:191],v[32:35]
v_mfma_f32_16x16x32_bf16 v[36:39],a[208:211],v[192:195],v[36:39]
v_mfma_f32_16x16x32_bf16 v[36:39],a[212:215],v[196:199],v[36:39]
ds_read_b64_tr_b16 a[252:253],v247 offset:28672
ds_read_b64_tr_b16 a[254:255],v247 offset:30720
v_mfma_f32_16x16x32_bf16 v[36:39],a[216:219],v[200:203],v[36:39]
v_mfma_f32_16x16x32_bf16 v[36:39],a[220:223],v[204:207],v[36:39]
v_mfma_f32_16x16x32_bf16 v[40:43],a[224:227],v[160:163],v[40:43]
ds_read_b64_tr_b16 a[192:193],v244 offset:32768
ds_read_b64_tr_b16 a[194:195],v244 offset:34816
v_mfma_f32_16x16x32_bf16 v[40:43],a[228:231],v[164:167],v[40:43]
v_mfma_f32_16x16x32_bf16 v[40:43],a[232:235],v[168:171],v[40:43]
s_waitcnt lgkmcnt(4)
v_mfma_f32_16x16x32_bf16 v[40:43],a[236:239],v[172:175],v[40:43]
ds_read_b64_tr_b16 a[196:197],v244 offset:36864
ds_read_b64_tr_b16 a[198:199],v244 offset:38912
v_mfma_f32_16x16x32_bf16 v[44:47],a[224:227],v[176:179],v[44:47]
v_mfma_f32_16x16x32_bf16 v[44:47],a[228:231],v[180:183],v[44:47]
v_mfma_f32_16x16x32_bf16 v[44:47],a[232:235],v[184:187],v[44:47]
ds_read_b64_tr_b16 a[200:201],v244 offset:40960
ds_read_b64_tr_b16 a[202:203],v244 offset:43008
v_mfma_f32_16x16x32_bf16 v[44:47],a[236:239],v[188:191],v[44:47]
v_mfma_f32_16x16x32_bf16 v[48:51],a[224:227],v[192:195],v[48:51]
v_mfma_f32_16x16x32_bf16 v[48:51],a[228:231],v[196:199],v[48:51]
ds_read_b64_tr_b16 a[204:205],v244 offset:45056
ds_read_b64_tr_b16 a[206:207],v244 offset:47104
v_mfma_f32_16x16x32_bf16 v[48:51],a[232:235],v[200:203],v[48:51]
v_mfma_f32_16x16x32_bf16 v[48:51],a[236:239],v[204:207],v[48:51]
v_mfma_f32_16x16x32_bf16 v[52:55],a[240:243],v[160:163],v[52:55]
ds_read_b64_tr_b16 a[208:209],v245 offset:32768
ds_read_b64_tr_b16 a[210:211],v245 offset:34816
v_mfma_f32_16x16x32_bf16 v[52:55],a[244:247],v[164:167],v[52:55]
v_mfma_f32_16x16x32_bf16 v[52:55],a[248:251],v[168:171],v[52:55]
s_waitcnt lgkmcnt(10)
v_mfma_f32_16x16x32_bf16 v[52:55],a[252:255],v[172:175],v[52:55]
ds_read_b64_tr_b16 a[212:213],v245 offset:36864
ds_read_b64_tr_b16 a[214:215],v245 offset:38912
v_mfma_f32_16x16x32_bf16 v[56:59],a[240:243],v[176:179],v[56:59]
v_mfma_f32_16x16x32_bf16 v[56:59],a[244:247],v[180:183],v[56:59]
v_mfma_f32_16x16x32_bf16 v[56:59],a[248:251],v[184:187],v[56:59]
ds_read_b64_tr_b16 a[216:217],v245 offset:40960
ds_read_b64_tr_b16 a[218:219],v245 offset:43008
v_mfma_f32_16x16x32_bf16 v[56:59],a[252:255],v[188:191],v[56:59]
v_mfma_f32_16x16x32_bf16 v[60:63],a[240:243],v[192:195],v[60:63]
v_mfma_f32_16x16x32_bf16 v[60:63],a[244:247],v[196:199],v[60:63]
ds_read_b64_tr_b16 a[220:221],v245 offset:45056
ds_read_b64_tr_b16 a[222:223],v245 offset:47104
v_mfma_f32_16x16x32_bf16 v[60:63],a[248:251],v[200:203],v[60:63]
v_mfma_f32_16x16x32_bf16 v[60:63],a[252:255],v[204:207],v[60:63]
s_waitcnt vmcnt(23)
s_barrier
s_waitcnt lgkmcnt(4)
v_mfma_f32_16x16x32_bf16 v[64:67],a[192:195],v[160:163],v[64:67]
ds_read_b64_tr_b16 a[224:225],v246 offset:32768
ds_read_b64_tr_b16 a[226:227],v246 offset:34816
v_mfma_f32_16x16x32_bf16 v[64:67],a[196:199],v[164:167],v[64:67]
s_add_u32 m0,s25,16384
s_add_u32 s28,s67,640
v_mfma_f32_16x16x32_bf16 v[64:67],a[200:203],v[168:171],v[64:67]
buffer_load_dwordx4 v236,s[96:99],s28 offen lds
v_mfma_f32_16x16x32_bf16 v[64:67],a[204:207],v[172:175],v[64:67]
ds_read_b64_tr_b16 a[228:229],v246 offset:36864
ds_read_b64_tr_b16 a[230:231],v246 offset:38912
v_mfma_f32_16x16x32_bf16 v[68:71],a[192:195],v[176:179],v[68:71]
buffer_load_dwordx4 v237,s[96:99],s28 offen offset:1024 lds
v_mfma_f32_16x16x32_bf16 v[68:71],a[196:199],v[180:183],v[68:71]
buffer_load_dwordx4 v238,s[96:99],s28 offen offset:2048 lds
v_mfma_f32_16x16x32_bf16 v[68:71],a[200:203],v[184:187],v[68:71]
ds_read_b64_tr_b16 a[232:233],v246 offset:40960
ds_read_b64_tr_b16 a[234:235],v246 offset:43008
v_mfma_f32_16x16x32_bf16 v[68:71],a[204:207],v[188:191],v[68:71]
buffer_load_dwordx4 v239,s[96:99],s28 offen offset:3072 lds
v_mfma_f32_16x16x32_bf16 v[72:75],a[192:195],v[192:195],v[72:75]
v_cvt_pk_bf16_f32 v16,v16,v17
v_cvt_pk_bf16_f32 v17,v18,v19
v_mfma_f32_16x16x32_bf16 v[72:75],a[196:199],v[196:199],v[72:75]
ds_read_b64_tr_b16 a[236:237],v246 offset:45056
ds_read_b64_tr_b16 a[238:239],v246 offset:47104
v_mfma_f32_16x16x32_bf16 v[72:75],a[200:203],v[200:203],v[72:75]
v_cvt_pk_bf16_f32 v18,v28,v29
v_cvt_pk_bf16_f32 v19,v30,v31
v_mfma_f32_16x16x32_bf16 v[72:75],a[204:207],v[204:207],v[72:75]
buffer_store_dwordx4 v[16:19],v248,s[20:23],s62 offen sc0 sc1
v_mfma_f32_16x16x32_bf16 v[76:79],a[208:211],v[160:163],v[76:79]
ds_read_b64_tr_b16 a[240:241],v247 offset:32768
ds_read_b64_tr_b16 a[242:243],v247 offset:34816
v_mfma_f32_16x16x32_bf16 v[76:79],a[212:215],v[164:167],v[76:79]
v_cvt_pk_bf16_f32 v20,v20,v21
s_waitcnt lgkmcnt(4)
v_mfma_f32_16x16x32_bf16 v[76:79],a[216:219],v[168:171],v[76:79]
v_cvt_pk_bf16_f32 v21,v22,v23
v_cvt_pk_bf16_f32 v22,v32,v33
v_mfma_f32_16x16x32_bf16 v[76:79],a[220:223],v[172:175],v[76:79]
ds_read_b64_tr_b16 a[244:245],v247 offset:36864
ds_read_b64_tr_b16 a[246:247],v247 offset:38912
v_mfma_f32_16x16x32_bf16 v[80:83],a[208:211],v[176:179],v[80:83]
v_cvt_pk_bf16_f32 v23,v34,v35
v_mfma_f32_16x16x32_bf16 v[80:83],a[212:215],v[180:183],v[80:83]
buffer_store_dwordx4 v[20:23],v248,s[20:23],s63 offen sc0 sc1
v_mfma_f32_16x16x32_bf16 v[80:83],a[216:219],v[184:187],v[80:83]
ds_read_b64_tr_b16 a[248:249],v247 offset:40960
ds_read_b64_tr_b16 a[250:251],v247 offset:43008
v_mfma_f32_16x16x32_bf16 v[80:83],a[220:223],v[188:191],v[80:83]
v_cvt_pk_bf16_f32 v24,v24,v25
v_cvt_pk_bf16_f32 v25,v26,v27
v_mfma_f32_16x16x32_bf16 v[84:87],a[208:211],v[192:195],v[84:87]
v_cvt_pk_bf16_f32 v26,v36,v37
v_cvt_pk_bf16_f32 v27,v38,v39
v_mfma_f32_16x16x32_bf16 v[84:87],a[212:215],v[196:199],v[84:87]
ds_read_b64_tr_b16 a[252:253],v247 offset:45056
ds_read_b64_tr_b16 a[254:255],v247 offset:47104
v_mfma_f32_16x16x32_bf16 v[84:87],a[216:219],v[200:203],v[84:87]
buffer_store_dwordx4 v[24:27],v248,s[20:23],s64 offen sc0 sc1
v_mfma_f32_16x16x32_bf16 v[84:87],a[220:223],v[204:207],v[84:87]
v_cvt_pk_bf16_f32 v40,v40,v41
v_cvt_pk_bf16_f32 v41,v42,v43
v_mfma_f32_16x16x32_bf16 v[88:91],a[224:227],v[160:163],v[88:91]
ds_read_b64_tr_b16 a[192:193],v244 offset:49152
ds_read_b64_tr_b16 a[194:195],v244 offset:51200
v_mfma_f32_16x16x32_bf16 v[88:91],a[228:231],v[164:167],v[88:91]
v_cvt_pk_bf16_f32 v42,v52,v53
v_cvt_pk_bf16_f32 v43,v54,v55
v_mfma_f32_16x16x32_bf16 v[88:91],a[232:235],v[168:171],v[88:91]
s_waitcnt lgkmcnt(4)
v_mfma_f32_16x16x32_bf16 v[88:91],a[236:239],v[172:175],v[88:91]
ds_read_b64_tr_b16 a[196:197],v244 offset:53248
ds_read_b64_tr_b16 a[198:199],v244 offset:55296
v_mfma_f32_16x16x32_bf16 v[92:95],a[224:227],v[176:179],v[92:95]
buffer_store_dwordx4 v[40:43],v249,s[20:23],s62 offen sc0 sc1
v_mfma_f32_16x16x32_bf16 v[92:95],a[228:231],v[180:183],v[92:95]
s_add_u32 s62,s62,32768
v_cvt_pk_bf16_f32 v44,v44,v45
v_mfma_f32_16x16x32_bf16 v[92:95],a[232:235],v[184:187],v[92:95]
ds_read_b64_tr_b16 a[200:201],v244 offset:57344
ds_read_b64_tr_b16 a[202:203],v244 offset:59392
v_mfma_f32_16x16x32_bf16 v[92:95],a[236:239],v[188:191],v[92:95]
v_cvt_pk_bf16_f32 v45,v46,v47
v_cvt_pk_bf16_f32 v46,v56,v57
v_mfma_f32_16x16x32_bf16 v[96:99],a[224:227],v[192:195],v[96:99]
v_cvt_pk_bf16_f32 v47,v58,v59
v_mfma_f32_16x16x32_bf16 v[96:99],a[228:231],v[196:199],v[96:99]
ds_read_b64_tr_b16 a[204:205],v244 offset:61440
ds_read_b64_tr_b16 a[206:207],v244 offset:63488
v_mfma_f32_16x16x32_bf16 v[96:99],a[232:235],v[200:203],v[96:99]
buffer_store_dwordx4 v[44:47],v249,s[20:23],s63 offen sc0 sc1
v_mfma_f32_16x16x32_bf16 v[96:99],a[236:239],v[204:207],v[96:99]
s_add_u32 s63,s63,32768
v_cvt_pk_bf16_f32 v48,v48,v49
v_mfma_f32_16x16x32_bf16 v[100:103],a[240:243],v[160:163],v[100:103]
ds_read_b64_tr_b16 a[208:209],v245 offset:49152
ds_read_b64_tr_b16 a[210:211],v245 offset:51200
v_mfma_f32_16x16x32_bf16 v[100:103],a[244:247],v[164:167],v[100:103]
v_cvt_pk_bf16_f32 v49,v50,v51
v_cvt_pk_bf16_f32 v50,v60,v61
v_mfma_f32_16x16x32_bf16 v[100:103],a[248:251],v[168:171],v[100:103]
v_cvt_pk_bf16_f32 v51,v62,v63
s_waitcnt lgkmcnt(10)
v_mfma_f32_16x16x32_bf16 v[100:103],a[252:255],v[172:175],v[100:103]
ds_read_b64_tr_b16 a[212:213],v245 offset:53248
ds_read_b64_tr_b16 a[214:215],v245 offset:55296
v_mfma_f32_16x16x32_bf16 v[104:107],a[240:243],v[176:179],v[104:107]
buffer_store_dwordx4 v[48:51],v249,s[20:23],s64 offen sc0 sc1
v_mfma_f32_16x16x32_bf16 v[104:107],a[244:247],v[180:183],v[104:107]
s_add_u32 s64,s64,32768
v_mfma_f32_16x16x32_bf16 v[104:107],a[248:251],v[184:187],v[104:107]
ds_read_b64_tr_b16 a[216:217],v245 offset:57344
ds_read_b64_tr_b16 a[218:219],v245 offset:59392
v_mfma_f32_16x16x32_bf16 v[104:107],a[252:255],v[188:191],v[104:107]
v_mfma_f32_16x16x32_bf16 v[108:111],a[240:243],v[192:195],v[108:111]
v_mfma_f32_16x16x32_bf16 v[108:111],a[244:247],v[196:199],v[108:111]
ds_read_b64_tr_b16 a[220:221],v245 offset:61440
ds_read_b64_tr_b16 a[222:223],v245 offset:63488
v_mfma_f32_16x16x32_bf16 v[108:111],a[248:251],v[200:203],v[108:111]
v_mfma_f32_16x16x32_bf16 v[108:111],a[252:255],v[204:207],v[108:111]
s_waitcnt vmcnt(29)
s_barrier
s_waitcnt lgkmcnt(4)
v_mfma_f32_16x16x32_bf16 v[16:19],a[192:195],v[112:115],0
ds_read_b64_tr_b16 a[224:225],v246 offset:49152
ds_read_b64_tr_b16 a[226:227],v246 offset:51200
v_mfma_f32_16x16x32_bf16 v[16:19],a[196:199],v[116:119],v[16:19]
s_add_u32 m0,s25,32768
s_add_u32 s28,s67,115328
v_mfma_f32_16x16x32_bf16 v[16:19],a[200:203],v[120:123],v[16:19]
buffer_load_dwordx4 v236,s[96:99],s28 offen lds
v_mfma_f32_16x16x32_bf16 v[16:19],a[204:207],v[124:127],v[16:19]
ds_read_b64_tr_b16 a[228:229],v246 offset:53248
ds_read_b64_tr_b16 a[230:231],v246 offset:55296
v_mfma_f32_16x16x32_bf16 v[20:23],a[192:195],v[128:131],0
buffer_load_dwordx4 v237,s[96:99],s28 offen offset:1024 lds
v_mfma_f32_16x16x32_bf16 v[20:23],a[196:199],v[132:135],v[20:23]
buffer_load_dwordx4 v238,s[96:99],s28 offen offset:2048 lds
v_mfma_f32_16x16x32_bf16 v[20:23],a[200:203],v[136:139],v[20:23]
ds_read_b64_tr_b16 a[232:233],v246 offset:57344
ds_read_b64_tr_b16 a[234:235],v246 offset:59392
v_mfma_f32_16x16x32_bf16 v[20:23],a[204:207],v[140:143],v[20:23]
buffer_load_dwordx4 v239,s[96:99],s28 offen offset:3072 lds
v_mfma_f32_16x16x32_bf16 v[24:27],a[192:195],v[144:147],0
v_cvt_pk_bf16_f32 v64,v64,v65
v_cvt_pk_bf16_f32 v65,v66,v67
v_mfma_f32_16x16x32_bf16 v[24:27],a[196:199],v[148:151],v[24:27]
ds_read_b64_tr_b16 a[236:237],v246 offset:61440
ds_read_b64_tr_b16 a[238:239],v246 offset:63488
v_mfma_f32_16x16x32_bf16 v[24:27],a[200:203],v[152:155],v[24:27]
v_cvt_pk_bf16_f32 v66,v76,v77
v_cvt_pk_bf16_f32 v67,v78,v79
v_mfma_f32_16x16x32_bf16 v[24:27],a[204:207],v[156:159],v[24:27]
buffer_store_dwordx4 v[64:67],v248,s[20:23],s62 offen sc0 sc1
v_mfma_f32_16x16x32_bf16 v[28:31],a[208:211],v[112:115],0
ds_read_b64_tr_b16 a[240:241],v247 offset:49152
ds_read_b64_tr_b16 a[242:243],v247 offset:51200
v_mfma_f32_16x16x32_bf16 v[28:31],a[212:215],v[116:119],v[28:31]
v_cvt_pk_bf16_f32 v68,v68,v69
s_waitcnt lgkmcnt(4)
v_mfma_f32_16x16x32_bf16 v[28:31],a[216:219],v[120:123],v[28:31]
v_cvt_pk_bf16_f32 v69,v70,v71
v_cvt_pk_bf16_f32 v70,v80,v81
v_mfma_f32_16x16x32_bf16 v[28:31],a[220:223],v[124:127],v[28:31]
ds_read_b64_tr_b16 a[244:245],v247 offset:53248
ds_read_b64_tr_b16 a[246:247],v247 offset:55296
v_mfma_f32_16x16x32_bf16 v[32:35],a[208:211],v[128:131],0
v_cvt_pk_bf16_f32 v71,v82,v83
v_mfma_f32_16x16x32_bf16 v[32:35],a[212:215],v[132:135],v[32:35]
buffer_store_dwordx4 v[68:71],v248,s[20:23],s63 offen sc0 sc1
v_mfma_f32_16x16x32_bf16 v[32:35],a[216:219],v[136:139],v[32:35]
ds_read_b64_tr_b16 a[248:249],v247 offset:57344
ds_read_b64_tr_b16 a[250:251],v247 offset:59392
v_mfma_f32_16x16x32_bf16 v[32:35],a[220:223],v[140:143],v[32:35]
v_cvt_pk_bf16_f32 v72,v72,v73
v_cvt_pk_bf16_f32 v73,v74,v75
v_mfma_f32_16x16x32_bf16 v[36:39],a[208:211],v[144:147],0
v_cvt_pk_bf16_f32 v74,v84,v85
v_cvt_pk_bf16_f32 v75,v86,v87
v_mfma_f32_16x16x32_bf16 v[36:39],a[212:215],v[148:151],v[36:39]
ds_read_b64_tr_b16 a[252:253],v247 offset:61440
ds_read_b64_tr_b16 a[254:255],v247 offset:63488
v_mfma_f32_16x16x32_bf16 v[36:39],a[216:219],v[152:155],v[36:39]
buffer_store_dwordx4 v[72:75],v248,s[20:23],s64 offen sc0 sc1
v_mfma_f32_16x16x32_bf16 v[36:39],a[220:223],v[156:159],v[36:39]
v_mfma_f32_16x16x32_bf16 v[40:43],a[224:227],v[112:115],0
ds_read_b64_tr_b16 a[192:193],v240 offset:0
ds_read_b64_tr_b16 a[194:195],v240 offset:2048
v_mfma_f32_16x16x32_bf16 v[40:43],a[228:231],v[116:119],v[40:43]
v_mfma_f32_16x16x32_bf16 v[40:43],a[232:235],v[120:123],v[40:43]
s_waitcnt lgkmcnt(4)
v_mfma_f32_16x16x32_bf16 v[40:43],a[236:239],v[124:127],v[40:43]
ds_read_b64_tr_b16 a[196:197],v240 offset:4096
ds_read_b64_tr_b16 a[198:199],v240 offset:6144
v_mfma_f32_16x16x32_bf16 v[44:47],a[224:227],v[128:131],0
v_mfma_f32_16x16x32_bf16 v[44:47],a[228:231],v[132:135],v[44:47]
v_mfma_f32_16x16x32_bf16 v[44:47],a[232:235],v[136:139],v[44:47]
ds_read_b64_tr_b16 a[200:201],v240 offset:8192
ds_read_b64_tr_b16 a[202:203],v240 offset:10240
v_mfma_f32_16x16x32_bf16 v[44:47],a[236:239],v[140:143],v[44:47]
v_mfma_f32_16x16x32_bf16 v[48:51],a[224:227],v[144:147],0
v_mfma_f32_16x16x32_bf16 v[48:51],a[228:231],v[148:151],v[48:51]
ds_read_b64_tr_b16 a[204:205],v240 offset:12288
ds_read_b64_tr_b16 a[206:207],v240 offset:14336
v_mfma_f32_16x16x32_bf16 v[48:51],a[232:235],v[152:155],v[48:51]
v_mfma_f32_16x16x32_bf16 v[48:51],a[236:239],v[156:159],v[48:51]
v_mfma_f32_16x16x32_bf16 v[52:55],a[240:243],v[112:115],0
ds_read_b64_tr_b16 a[208:209],v241 offset:0
ds_read_b64_tr_b16 a[210:211],v241 offset:2048
v_mfma_f32_16x16x32_bf16 v[52:55],a[244:247],v[116:119],v[52:55]
v_mfma_f32_16x16x32_bf16 v[52:55],a[248:251],v[120:123],v[52:55]
s_waitcnt lgkmcnt(10)
v_mfma_f32_16x16x32_bf16 v[52:55],a[252:255],v[124:127],v[52:55]
ds_read_b64_tr_b16 a[212:213],v241 offset:4096
ds_read_b64_tr_b16 a[214:215],v241 offset:6144
v_mfma_f32_16x16x32_bf16 v[56:59],a[240:243],v[128:131],0
v_mfma_f32_16x16x32_bf16 v[56:59],a[244:247],v[132:135],v[56:59]
v_mfma_f32_16x16x32_bf16 v[56:59],a[248:251],v[136:139],v[56:59]
ds_read_b64_tr_b16 a[216:217],v241 offset:8192
ds_read_b64_tr_b16 a[218:219],v241 offset:10240
v_mfma_f32_16x16x32_bf16 v[56:59],a[252:255],v[140:143],v[56:59]
v_mfma_f32_16x16x32_bf16 v[60:63],a[240:243],v[144:147],0
v_mfma_f32_16x16x32_bf16 v[60:63],a[244:247],v[148:151],v[60:63]
ds_read_b64_tr_b16 a[220:221],v241 offset:12288
ds_read_b64_tr_b16 a[222:223],v241 offset:14336
v_mfma_f32_16x16x32_bf16 v[60:63],a[248:251],v[152:155],v[60:63]
v_mfma_f32_16x16x32_bf16 v[60:63],a[252:255],v[156:159],v[60:63]
s_waitcnt vmcnt(29)
s_barrier
s_waitcnt lgkmcnt(4)
v_mfma_f32_16x16x32_bf16 v[16:19],a[192:195],v[160:163],v[16:19]
ds_read_b64_tr_b16 a[224:225],v242 offset:0
ds_read_b64_tr_b16 a[226:227],v242 offset:2048
v_mfma_f32_16x16x32_bf16 v[16:19],a[196:199],v[164:167],v[16:19]
s_add_u32 m0,s25,49152
s_add_u32 s28,s67,768
v_mfma_f32_16x16x32_bf16 v[16:19],a[200:203],v[168:171],v[16:19]
buffer_load_dwordx4 v236,s[96:99],s28 offen lds
v_mfma_f32_16x16x32_bf16 v[16:19],a[204:207],v[172:175],v[16:19]
ds_read_b64_tr_b16 a[228:229],v242 offset:4096
ds_read_b64_tr_b16 a[230:231],v242 offset:6144
v_mfma_f32_16x16x32_bf16 v[20:23],a[192:195],v[176:179],v[20:23]
buffer_load_dwordx4 v237,s[96:99],s28 offen offset:1024 lds
v_mfma_f32_16x16x32_bf16 v[20:23],a[196:199],v[180:183],v[20:23]
buffer_load_dwordx4 v238,s[96:99],s28 offen offset:2048 lds
v_mfma_f32_16x16x32_bf16 v[20:23],a[200:203],v[184:187],v[20:23]
ds_read_b64_tr_b16 a[232:233],v242 offset:8192
ds_read_b64_tr_b16 a[234:235],v242 offset:10240
v_mfma_f32_16x16x32_bf16 v[20:23],a[204:207],v[188:191],v[20:23]
buffer_load_dwordx4 v239,s[96:99],s28 offen offset:3072 lds
v_mfma_f32_16x16x32_bf16 v[24:27],a[192:195],v[192:195],v[24:27]
v_cvt_pk_bf16_f32 v88,v88,v89
v_cvt_pk_bf16_f32 v89,v90,v91
v_mfma_f32_16x16x32_bf16 v[24:27],a[196:199],v[196:199],v[24:27]
ds_read_b64_tr_b16 a[236:237],v242 offset:12288
ds_read_b64_tr_b16 a[238:239],v242 offset:14336
v_mfma_f32_16x16x32_bf16 v[24:27],a[200:203],v[200:203],v[24:27]
v_cvt_pk_bf16_f32 v90,v100,v101
v_cvt_pk_bf16_f32 v91,v102,v103
v_mfma_f32_16x16x32_bf16 v[24:27],a[204:207],v[204:207],v[24:27]
buffer_store_dwordx4 v[88:91],v249,s[20:23],s62 offen sc0 sc1
v_mfma_f32_16x16x32_bf16 v[28:31],a[208:211],v[160:163],v[28:31]
ds_read_b64_tr_b16 a[240:241],v243 offset:0
ds_read_b64_tr_b16 a[242:243],v243 offset:2048
v_mfma_f32_16x16x32_bf16 v[28:31],a[212:215],v[164:167],v[28:31]
s_add_u32 s62,s62,32768
s_waitcnt lgkmcnt(4)
v_mfma_f32_16x16x32_bf16 v[28:31],a[216:219],v[168:171],v[28:31]
v_cvt_pk_bf16_f32 v92,v92,v93
v_cvt_pk_bf16_f32 v93,v94,v95
v_mfma_f32_16x16x32_bf16 v[28:31],a[220:223],v[172:175],v[28:31]
ds_read_b64_tr_b16 a[244:245],v243 offset:4096
ds_read_b64_tr_b16 a[246:247],v243 offset:6144
v_mfma_f32_16x16x32_bf16 v[32:35],a[208:211],v[176:179],v[32:35]
v_cvt_pk_bf16_f32 v94,v104,v105
v_cvt_pk_bf16_f32 v95,v106,v107
v_mfma_f32_16x16x32_bf16 v[32:35],a[212:215],v[180:183],v[32:35]
buffer_store_dwordx4 v[92:95],v249,s[20:23],s63 offen sc0 sc1
v_mfma_f32_16x16x32_bf16 v[32:35],a[216:219],v[184:187],v[32:35]
ds_read_b64_tr_b16 a[248:249],v243 offset:8192
ds_read_b64_tr_b16 a[250:251],v243 offset:10240
v_mfma_f32_16x16x32_bf16 v[32:35],a[220:223],v[188:191],v[32:35]
s_add_u32 s63,s63,32768
v_cvt_pk_bf16_f32 v96,v96,v97
v_mfma_f32_16x16x32_bf16 v[36:39],a[208:211],v[192:195],v[36:39]
v_cvt_pk_bf16_f32 v97,v98,v99
v_cvt_pk_bf16_f32 v98,v108,v109
v_mfma_f32_16x16x32_bf16 v[36:39],a[212:215],v[196:199],v[36:39]
ds_read_b64_tr_b16 a[252:253],v243 offset:12288
ds_read_b64_tr_b16 a[254:255],v243 offset:14336
v_mfma_f32_16x16x32_bf16 v[36:39],a[216:219],v[200:203],v[36:39]
v_cvt_pk_bf16_f32 v99,v110,v111
v_mfma_f32_16x16x32_bf16 v[36:39],a[220:223],v[204:207],v[36:39]
buffer_store_dwordx4 v[96:99],v249,s[20:23],s64 offen sc0 sc1
v_mfma_f32_16x16x32_bf16 v[40:43],a[224:227],v[160:163],v[40:43]
ds_read_b64_tr_b16 a[192:193],v240 offset:16384
ds_read_b64_tr_b16 a[194:195],v240 offset:18432
v_mfma_f32_16x16x32_bf16 v[40:43],a[228:231],v[164:167],v[40:43]
s_add_u32 s64,s64,32768
v_mfma_f32_16x16x32_bf16 v[40:43],a[232:235],v[168:171],v[40:43]
s_waitcnt lgkmcnt(4)
v_mfma_f32_16x16x32_bf16 v[40:43],a[236:239],v[172:175],v[40:43]
ds_read_b64_tr_b16 a[196:197],v240 offset:20480
ds_read_b64_tr_b16 a[198:199],v240 offset:22528
v_mfma_f32_16x16x32_bf16 v[44:47],a[224:227],v[176:179],v[44:47]
v_mfma_f32_16x16x32_bf16 v[44:47],a[228:231],v[180:183],v[44:47]
v_mfma_f32_16x16x32_bf16 v[44:47],a[232:235],v[184:187],v[44:47]
ds_read_b64_tr_b16 a[200:201],v240 offset:24576
ds_read_b64_tr_b16 a[202:203],v240 offset:26624
v_mfma_f32_16x16x32_bf16 v[44:47],a[236:239],v[188:191],v[44:47]
v_mfma_f32_16x16x32_bf16 v[48:51],a[224:227],v[192:195],v[48:51]
v_mfma_f32_16x16x32_bf16 v[48:51],a[228:231],v[196:199],v[48:51]
ds_read_b64_tr_b16 a[204:205],v240 offset:28672
ds_read_b64_tr_b16 a[206:207],v240 offset:30720
v_mfma_f32_16x16x32_bf16 v[48:51],a[232:235],v[200:203],v[48:51]
v_mfma_f32_16x16x32_bf16 v[48:51],a[236:239],v[204:207],v[48:51]
v_mfma_f32_16x16x32_bf16 v[52:55],a[240:243],v[160:163],v[52:55]
ds_read_b64_tr_b16 a[208:209],v241 offset:16384
ds_read_b64_tr_b16 a[210:211],v241 offset:18432
v_mfma_f32_16x16x32_bf16 v[52:55],a[244:247],v[164:167],v[52:55]
v_mfma_f32_16x16x32_bf16 v[52:55],a[248:251],v[168:171],v[52:55]
s_waitcnt lgkmcnt(10)
v_mfma_f32_16x16x32_bf16 v[52:55],a[252:255],v[172:175],v[52:55]
ds_read_b64_tr_b16 a[212:213],v241 offset:20480
ds_read_b64_tr_b16 a[214:215],v241 offset:22528
v_mfma_f32_16x16x32_bf16 v[56:59],a[240:243],v[176:179],v[56:59]
v_mfma_f32_16x16x32_bf16 v[56:59],a[244:247],v[180:183],v[56:59]
v_mfma_f32_16x16x32_bf16 v[56:59],a[248:251],v[184:187],v[56:59]
ds_read_b64_tr_b16 a[216:217],v241 offset:24576
ds_read_b64_tr_b16 a[218:219],v241 offset:26624
v_mfma_f32_16x16x32_bf16 v[56:59],a[252:255],v[188:191],v[56:59]
v_mfma_f32_16x16x32_bf16 v[60:63],a[240:243],v[192:195],v[60:63]
v_mfma_f32_16x16x32_bf16 v[60:63],a[244:247],v[196:199],v[60:63]
ds_read_b64_tr_b16 a[220:221],v241 offset:28672
ds_read_b64_tr_b16 a[222:223],v241 offset:30720
v_mfma_f32_16x16x32_bf16 v[60:63],a[248:251],v[200:203],v[60:63]
v_mfma_f32_16x16x32_bf16 v[60:63],a[252:255],v[204:207],v[60:63]
s_waitcnt vmcnt(32)
s_barrier
s_waitcnt lgkmcnt(4)
v_mfma_f32_16x16x32_bf16 v[64:67],a[192:195],v[112:115],0
ds_read_b64_tr_b16 a[224:225],v242 offset:16384
ds_read_b64_tr_b16 a[226:227],v242 offset:18432
v_mfma_f32_16x16x32_bf16 v[64:67],a[196:199],v[116:119],v[64:67]
s_add_u32 m0,s25,81920
s_add_u32 s28,s67,115456
v_mfma_f32_16x16x32_bf16 v[64:67],a[200:203],v[120:123],v[64:67]
buffer_load_dwordx4 v236,s[96:99],s28 offen lds
v_mfma_f32_16x16x32_bf16 v[64:67],a[204:207],v[124:127],v[64:67]
ds_read_b64_tr_b16 a[228:229],v242 offset:20480
ds_read_b64_tr_b16 a[230:231],v242 offset:22528
v_mfma_f32_16x16x32_bf16 v[68:71],a[192:195],v[128:131],0
buffer_load_dwordx4 v237,s[96:99],s28 offen offset:1024 lds
v_mfma_f32_16x16x32_bf16 v[68:71],a[196:199],v[132:135],v[68:71]
buffer_load_dwordx4 v238,s[96:99],s28 offen offset:2048 lds
v_mfma_f32_16x16x32_bf16 v[68:71],a[200:203],v[136:139],v[68:71]
ds_read_b64_tr_b16 a[232:233],v242 offset:24576
ds_read_b64_tr_b16 a[234:235],v242 offset:26624
v_mfma_f32_16x16x32_bf16 v[68:71],a[204:207],v[140:143],v[68:71]
buffer_load_dwordx4 v239,s[96:99],s28 offen offset:3072 lds
v_mfma_f32_16x16x32_bf16 v[72:75],a[192:195],v[144:147],0
v_cvt_pk_bf16_f32 v16,v16,v17
v_cvt_pk_bf16_f32 v17,v18,v19
v_mfma_f32_16x16x32_bf16 v[72:75],a[196:199],v[148:151],v[72:75]
ds_read_b64_tr_b16 a[236:237],v242 offset:28672
ds_read_b64_tr_b16 a[238:239],v242 offset:30720
v_mfma_f32_16x16x32_bf16 v[72:75],a[200:203],v[152:155],v[72:75]
v_cvt_pk_bf16_f32 v18,v28,v29
v_cvt_pk_bf16_f32 v19,v30,v31
v_mfma_f32_16x16x32_bf16 v[72:75],a[204:207],v[156:159],v[72:75]
buffer_store_dwordx4 v[16:19],v248,s[20:23],s62 offen sc0 sc1
v_mfma_f32_16x16x32_bf16 v[76:79],a[208:211],v[112:115],0
ds_read_b64_tr_b16 a[240:241],v243 offset:16384
ds_read_b64_tr_b16 a[242:243],v243 offset:18432
v_mfma_f32_16x16x32_bf16 v[76:79],a[212:215],v[116:119],v[76:79]
v_cvt_pk_bf16_f32 v20,v20,v21
s_waitcnt lgkmcnt(4)
v_mfma_f32_16x16x32_bf16 v[76:79],a[216:219],v[120:123],v[76:79]
v_cvt_pk_bf16_f32 v21,v22,v23
v_cvt_pk_bf16_f32 v22,v32,v33
v_mfma_f32_16x16x32_bf16 v[76:79],a[220:223],v[124:127],v[76:79]
ds_read_b64_tr_b16 a[244:245],v243 offset:20480
ds_read_b64_tr_b16 a[246:247],v243 offset:22528
v_mfma_f32_16x16x32_bf16 v[80:83],a[208:211],v[128:131],0
v_cvt_pk_bf16_f32 v23,v34,v35
v_mfma_f32_16x16x32_bf16 v[80:83],a[212:215],v[132:135],v[80:83]
buffer_store_dwordx4 v[20:23],v248,s[20:23],s63 offen sc0 sc1
v_mfma_f32_16x16x32_bf16 v[80:83],a[216:219],v[136:139],v[80:83]
ds_read_b64_tr_b16 a[248:249],v243 offset:24576
ds_read_b64_tr_b16 a[250:251],v243 offset:26624
v_mfma_f32_16x16x32_bf16 v[80:83],a[220:223],v[140:143],v[80:83]
v_cvt_pk_bf16_f32 v24,v24,v25
v_cvt_pk_bf16_f32 v25,v26,v27
v_mfma_f32_16x16x32_bf16 v[84:87],a[208:211],v[144:147],0
v_cvt_pk_bf16_f32 v26,v36,v37
v_cvt_pk_bf16_f32 v27,v38,v39
v_mfma_f32_16x16x32_bf16 v[84:87],a[212:215],v[148:151],v[84:87]
ds_read_b64_tr_b16 a[252:253],v243 offset:28672
ds_read_b64_tr_b16 a[254:255],v243 offset:30720
v_mfma_f32_16x16x32_bf16 v[84:87],a[216:219],v[152:155],v[84:87]
buffer_store_dwordx4 v[24:27],v248,s[20:23],s64 offen sc0 sc1
v_mfma_f32_16x16x32_bf16 v[84:87],a[220:223],v[156:159],v[84:87]
v_mfma_f32_16x16x32_bf16 v[88:91],a[224:227],v[112:115],0
ds_read_b64_tr_b16 a[192:193],v240 offset:32768
ds_read_b64_tr_b16 a[194:195],v240 offset:34816
v_mfma_f32_16x16x32_bf16 v[88:91],a[228:231],v[116:119],v[88:91]
v_mfma_f32_16x16x32_bf16 v[88:91],a[232:235],v[120:123],v[88:91]
s_waitcnt lgkmcnt(4)
v_mfma_f32_16x16x32_bf16 v[88:91],a[236:239],v[124:127],v[88:91]
ds_read_b64_tr_b16 a[196:197],v240 offset:36864
ds_read_b64_tr_b16 a[198:199],v240 offset:38912
v_mfma_f32_16x16x32_bf16 v[92:95],a[224:227],v[128:131],0
v_mfma_f32_16x16x32_bf16 v[92:95],a[228:231],v[132:135],v[92:95]
v_mfma_f32_16x16x32_bf16 v[92:95],a[232:235],v[136:139],v[92:95]
ds_read_b64_tr_b16 a[200:201],v240 offset:40960
ds_read_b64_tr_b16 a[202:203],v240 offset:43008
v_mfma_f32_16x16x32_bf16 v[92:95],a[236:239],v[140:143],v[92:95]
v_mfma_f32_16x16x32_bf16 v[96:99],a[224:227],v[144:147],0
v_mfma_f32_16x16x32_bf16 v[96:99],a[228:231],v[148:151],v[96:99]
ds_read_b64_tr_b16 a[204:205],v240 offset:45056
ds_read_b64_tr_b16 a[206:207],v240 offset:47104
v_mfma_f32_16x16x32_bf16 v[96:99],a[232:235],v[152:155],v[96:99]
v_mfma_f32_16x16x32_bf16 v[96:99],a[236:239],v[156:159],v[96:99]
v_mfma_f32_16x16x32_bf16 v[100:103],a[240:243],v[112:115],0
ds_read_b64_tr_b16 a[208:209],v241 offset:32768
ds_read_b64_tr_b16 a[210:211],v241 offset:34816
v_mfma_f32_16x16x32_bf16 v[100:103],a[244:247],v[116:119],v[100:103]
v_mfma_f32_16x16x32_bf16 v[100:103],a[248:251],v[120:123],v[100:103]
s_waitcnt lgkmcnt(10)
v_mfma_f32_16x16x32_bf16 v[100:103],a[252:255],v[124:127],v[100:103]
ds_read_b64_tr_b16 a[212:213],v241 offset:36864
ds_read_b64_tr_b16 a[214:215],v241 offset:38912
v_mfma_f32_16x16x32_bf16 v[104:107],a[240:243],v[128:131],0
v_mfma_f32_16x16x32_bf16 v[104:107],a[244:247],v[132:135],v[104:107]
v_mfma_f32_16x16x32_bf16 v[104:107],a[248:251],v[136:139],v[104:107]
ds_read_b64_tr_b16 a[216:217],v241 offset:40960
ds_read_b64_tr_b16 a[218:219],v241 offset:43008
v_mfma_f32_16x16x32_bf16 v[104:107],a[252:255],v[140:143],v[104:107]
v_mfma_f32_16x16x32_bf16 v[108:111],a[240:243],v[144:147],0
v_mfma_f32_16x16x32_bf16 v[108:111],a[244:247],v[148:151],v[108:111]
ds_read_b64_tr_b16 a[220:221],v241 offset:45056
ds_read_b64_tr_b16 a[222:223],v241 offset:47104
v_mfma_f32_16x16x32_bf16 v[108:111],a[248:251],v[152:155],v[108:111]
v_mfma_f32_16x16x32_bf16 v[108:111],a[252:255],v[156:159],v[108:111]
s_waitcnt vmcnt(35)
s_barrier
s_waitcnt lgkmcnt(4)
v_mfma_f32_16x16x32_bf16 v[64:67],a[192:195],v[160:163],v[64:67]
ds_read_b64_tr_b16 a[224:225],v242 offset:32768
ds_read_b64_tr_b16 a[226:227],v242 offset:34816
v_mfma_f32_16x16x32_bf16 v[64:67],a[196:199],v[164:167],v[64:67]
v_mfma_f32_16x16x32_bf16 v[64:67],a[200:203],v[168:171],v[64:67]
v_mfma_f32_16x16x32_bf16 v[64:67],a[204:207],v[172:175],v[64:67]
ds_read_b64_tr_b16 a[228:229],v242 offset:36864
ds_read_b64_tr_b16 a[230:231],v242 offset:38912
v_mfma_f32_16x16x32_bf16 v[68:71],a[192:195],v[176:179],v[68:71]
v_cvt_pk_bf16_f32 v40,v40,v41
v_cvt_pk_bf16_f32 v41,v42,v43
v_mfma_f32_16x16x32_bf16 v[68:71],a[196:199],v[180:183],v[68:71]
v_cvt_pk_bf16_f32 v42,v52,v53
v_cvt_pk_bf16_f32 v43,v54,v55
v_mfma_f32_16x16x32_bf16 v[68:71],a[200:203],v[184:187],v[68:71]
ds_read_b64_tr_b16 a[232:233],v242 offset:40960
ds_read_b64_tr_b16 a[234:235],v242 offset:43008
v_mfma_f32_16x16x32_bf16 v[68:71],a[204:207],v[188:191],v[68:71]
buffer_store_dwordx4 v[40:43],v249,s[20:23],s62 offen sc0 sc1
v_mfma_f32_16x16x32_bf16 v[72:75],a[192:195],v[192:195],v[72:75]
s_add_u32 s62,s62,32768
v_cvt_pk_bf16_f32 v44,v44,v45
v_mfma_f32_16x16x32_bf16 v[72:75],a[196:199],v[196:199],v[72:75]
ds_read_b64_tr_b16 a[236:237],v242 offset:45056
ds_read_b64_tr_b16 a[238:239],v242 offset:47104
v_mfma_f32_16x16x32_bf16 v[72:75],a[200:203],v[200:203],v[72:75]
v_cvt_pk_bf16_f32 v45,v46,v47
v_cvt_pk_bf16_f32 v46,v56,v57
v_mfma_f32_16x16x32_bf16 v[72:75],a[204:207],v[204:207],v[72:75]
v_cvt_pk_bf16_f32 v47,v58,v59
v_mfma_f32_16x16x32_bf16 v[76:79],a[208:211],v[160:163],v[76:79]
ds_read_b64_tr_b16 a[240:241],v243 offset:32768
ds_read_b64_tr_b16 a[242:243],v243 offset:34816
v_mfma_f32_16x16x32_bf16 v[76:79],a[212:215],v[164:167],v[76:79]
s_waitcnt lgkmcnt(4)
v_mfma_f32_16x16x32_bf16 v[76:79],a[216:219],v[168:171],v[76:79]
buffer_store_dwordx4 v[44:47],v249,s[20:23],s63 offen sc0 sc1
v_mfma_f32_16x16x32_bf16 v[76:79],a[220:223],v[172:175],v[76:79]
ds_read_b64_tr_b16 a[244:245],v243 offset:36864
ds_read_b64_tr_b16 a[246:247],v243 offset:38912
v_mfma_f32_16x16x32_bf16 v[80:83],a[208:211],v[176:179],v[80:83]
s_add_u32 s63,s63,32768
v_cvt_pk_bf16_f32 v48,v48,v49
v_mfma_f32_16x16x32_bf16 v[80:83],a[212:215],v[180:183],v[80:83]
v_cvt_pk_bf16_f32 v49,v50,v51
v_cvt_pk_bf16_f32 v50,v60,v61
v_mfma_f32_16x16x32_bf16 v[80:83],a[216:219],v[184:187],v[80:83]
ds_read_b64_tr_b16 a[248:249],v243 offset:40960
ds_read_b64_tr_b16 a[250:251],v243 offset:43008
v_mfma_f32_16x16x32_bf16 v[80:83],a[220:223],v[188:191],v[80:83]
v_cvt_pk_bf16_f32 v51,v62,v63
v_mfma_f32_16x16x32_bf16 v[84:87],a[208:211],v[192:195],v[84:87]
buffer_store_dwordx4 v[48:51],v249,s[20:23],s64 offen sc0 sc1
v_mfma_f32_16x16x32_bf16 v[84:87],a[212:215],v[196:199],v[84:87]
ds_read_b64_tr_b16 a[252:253],v243 offset:45056
ds_read_b64_tr_b16 a[254:255],v243 offset:47104
v_mfma_f32_16x16x32_bf16 v[84:87],a[216:219],v[200:203],v[84:87]
s_add_u32 s64,s64,32768
v_mfma_f32_16x16x32_bf16 v[84:87],a[220:223],v[204:207],v[84:87]
v_mfma_f32_16x16x32_bf16 v[88:91],a[224:227],v[160:163],v[88:91]
ds_read_b64_tr_b16 a[192:193],v240 offset:49152
ds_read_b64_tr_b16 a[194:195],v240 offset:51200
v_mfma_f32_16x16x32_bf16 v[88:91],a[228:231],v[164:167],v[88:91]
v_mfma_f32_16x16x32_bf16 v[88:91],a[232:235],v[168:171],v[88:91]
s_waitcnt lgkmcnt(4)
v_mfma_f32_16x16x32_bf16 v[88:91],a[236:239],v[172:175],v[88:91]
ds_read_b64_tr_b16 a[196:197],v240 offset:53248
ds_read_b64_tr_b16 a[198:199],v240 offset:55296
v_mfma_f32_16x16x32_bf16 v[92:95],a[224:227],v[176:179],v[92:95]
v_mfma_f32_16x16x32_bf16 v[92:95],a[228:231],v[180:183],v[92:95]
v_mfma_f32_16x16x32_bf16 v[92:95],a[232:235],v[184:187],v[92:95]
ds_read_b64_tr_b16 a[200:201],v240 offset:57344
ds_read_b64_tr_b16 a[202:203],v240 offset:59392
v_mfma_f32_16x16x32_bf16 v[92:95],a[236:239],v[188:191],v[92:95]
v_mfma_f32_16x16x32_bf16 v[96:99],a[224:227],v[192:195],v[96:99]
v_mfma_f32_16x16x32_bf16 v[96:99],a[228:231],v[196:199],v[96:99]
ds_read_b64_tr_b16 a[204:205],v240 offset:61440
ds_read_b64_tr_b16 a[206:207],v240 offset:63488
v_mfma_f32_16x16x32_bf16 v[96:99],a[232:235],v[200:203],v[96:99]
v_mfma_f32_16x16x32_bf16 v[96:99],a[236:239],v[204:207],v[96:99]
v_mfma_f32_16x16x32_bf16 v[100:103],a[240:243],v[160:163],v[100:103]
ds_read_b64_tr_b16 a[208:209],v241 offset:49152
ds_read_b64_tr_b16 a[210:211],v241 offset:51200
v_mfma_f32_16x16x32_bf16 v[100:103],a[244:247],v[164:167],v[100:103]
v_mfma_f32_16x16x32_bf16 v[100:103],a[248:251],v[168:171],v[100:103]
s_waitcnt lgkmcnt(10)
v_mfma_f32_16x16x32_bf16 v[100:103],a[252:255],v[172:175],v[100:103]
ds_read_b64_tr_b16 a[212:213],v241 offset:53248
ds_read_b64_tr_b16 a[214:215],v241 offset:55296
v_mfma_f32_16x16x32_bf16 v[104:107],a[240:243],v[176:179],v[104:107]
v_mfma_f32_16x16x32_bf16 v[104:107],a[244:247],v[180:183],v[104:107]
v_mfma_f32_16x16x32_bf16 v[104:107],a[248:251],v[184:187],v[104:107]
ds_read_b64_tr_b16 a[216:217],v241 offset:57344
ds_read_b64_tr_b16 a[218:219],v241 offset:59392
v_mfma_f32_16x16x32_bf16 v[104:107],a[252:255],v[188:191],v[104:107]
v_mfma_f32_16x16x32_bf16 v[108:111],a[240:243],v[192:195],v[108:111]
v_mfma_f32_16x16x32_bf16 v[108:111],a[244:247],v[196:199],v[108:111]
ds_read_b64_tr_b16 a[220:221],v241 offset:61440
ds_read_b64_tr_b16 a[222:223],v241 offset:63488
v_mfma_f32_16x16x32_bf16 v[108:111],a[248:251],v[200:203],v[108:111]
v_mfma_f32_16x16x32_bf16 v[108:111],a[252:255],v[204:207],v[108:111]
s_waitcnt vmcnt(34)
s_barrier
s_waitcnt lgkmcnt(4)
v_mfma_f32_16x16x32_bf16 v[16:19],a[192:195],v[112:115],0
ds_read_b64_tr_b16 a[224:225],v242 offset:49152
ds_read_b64_tr_b16 a[226:227],v242 offset:51200
v_mfma_f32_16x16x32_bf16 v[16:19],a[196:199],v[116:119],v[16:19]
v_mfma_f32_16x16x32_bf16 v[16:19],a[200:203],v[120:123],v[16:19]
v_mfma_f32_16x16x32_bf16 v[16:19],a[204:207],v[124:127],v[16:19]
ds_read_b64_tr_b16 a[228:229],v242 offset:53248
ds_read_b64_tr_b16 a[230:231],v242 offset:55296
v_mfma_f32_16x16x32_bf16 v[20:23],a[192:195],v[128:131],0
v_cvt_pk_bf16_f32 v64,v64,v65
v_cvt_pk_bf16_f32 v65,v66,v67
v_mfma_f32_16x16x32_bf16 v[20:23],a[196:199],v[132:135],v[20:23]
v_cvt_pk_bf16_f32 v66,v76,v77
v_cvt_pk_bf16_f32 v67,v78,v79
v_mfma_f32_16x16x32_bf16 v[20:23],a[200:203],v[136:139],v[20:23]
ds_read_b64_tr_b16 a[232:233],v242 offset:57344
ds_read_b64_tr_b16 a[234:235],v242 offset:59392
v_mfma_f32_16x16x32_bf16 v[20:23],a[204:207],v[140:143],v[20:23]
buffer_store_dwordx4 v[64:67],v248,s[20:23],s62 offen sc0 sc1
v_mfma_f32_16x16x32_bf16 v[24:27],a[192:195],v[144:147],0
v_cvt_pk_bf16_f32 v68,v68,v69
v_cvt_pk_bf16_f32 v69,v70,v71
v_mfma_f32_16x16x32_bf16 v[24:27],a[196:199],v[148:151],v[24:27]
ds_read_b64_tr_b16 a[236:237],v242 offset:61440
ds_read_b64_tr_b16 a[238:239],v242 offset:63488
v_mfma_f32_16x16x32_bf16 v[24:27],a[200:203],v[152:155],v[24:27]
v_cvt_pk_bf16_f32 v70,v80,v81
v_cvt_pk_bf16_f32 v71,v82,v83
v_mfma_f32_16x16x32_bf16 v[24:27],a[204:207],v[156:159],v[24:27]
buffer_store_dwordx4 v[68:71],v248,s[20:23],s63 offen sc0 sc1
v_mfma_f32_16x16x32_bf16 v[28:31],a[208:211],v[112:115],0
ds_read_b64_tr_b16 a[240:241],v243 offset:49152
ds_read_b64_tr_b16 a[242:243],v243 offset:51200
v_mfma_f32_16x16x32_bf16 v[28:31],a[212:215],v[116:119],v[28:31]
v_cvt_pk_bf16_f32 v72,v72,v73
s_waitcnt lgkmcnt(4)
v_mfma_f32_16x16x32_bf16 v[28:31],a[216:219],v[120:123],v[28:31]
v_cvt_pk_bf16_f32 v73,v74,v75
v_cvt_pk_bf16_f32 v74,v84,v85
v_mfma_f32_16x16x32_bf16 v[28:31],a[220:223],v[124:127],v[28:31]
ds_read_b64_tr_b16 a[244:245],v243 offset:53248
ds_read_b64_tr_b16 a[246:247],v243 offset:55296
v_mfma_f32_16x16x32_bf16 v[32:35],a[208:211],v[128:131],0
v_cvt_pk_bf16_f32 v75,v86,v87
v_mfma_f32_16x16x32_bf16 v[32:35],a[212:215],v[132:135],v[32:35]
buffer_store_dwordx4 v[72:75],v248,s[20:23],s64 offen sc0 sc1
v_mfma_f32_16x16x32_bf16 v[32:35],a[216:219],v[136:139],v[32:35]
ds_read_b64_tr_b16 a[248:249],v243 offset:57344
ds_read_b64_tr_b16 a[250:251],v243 offset:59392
v_mfma_f32_16x16x32_bf16 v[32:35],a[220:223],v[140:143],v[32:35]
v_mfma_f32_16x16x32_bf16 v[36:39],a[208:211],v[144:147],0
v_mfma_f32_16x16x32_bf16 v[36:39],a[212:215],v[148:151],v[36:39]
ds_read_b64_tr_b16 a[252:253],v243 offset:61440
ds_read_b64_tr_b16 a[254:255],v243 offset:63488
v_mfma_f32_16x16x32_bf16 v[36:39],a[216:219],v[152:155],v[36:39]
v_mfma_f32_16x16x32_bf16 v[36:39],a[220:223],v[156:159],v[36:39]
v_mfma_f32_16x16x32_bf16 v[40:43],a[224:227],v[112:115],0
ds_read_b64_tr_b16 a[192:193],v244 offset:0
ds_read_b64_tr_b16 a[194:195],v244 offset:2048
v_mfma_f32_16x16x32_bf16 v[40:43],a[228:231],v[116:119],v[40:43]
v_mfma_f32_16x16x32_bf16 v[40:43],a[232:235],v[120:123],v[40:43]
s_waitcnt lgkmcnt(4)
v_mfma_f32_16x16x32_bf16 v[40:43],a[236:239],v[124:127],v[40:43]
ds_read_b64_tr_b16 a[196:197],v244 offset:4096
ds_read_b64_tr_b16 a[198:199],v244 offset:6144
v_mfma_f32_16x16x32_bf16 v[44:47],a[224:227],v[128:131],0
v_mfma_f32_16x16x32_bf16 v[44:47],a[228:231],v[132:135],v[44:47]
v_mfma_f32_16x16x32_bf16 v[44:47],a[232:235],v[136:139],v[44:47]
ds_read_b64_tr_b16 a[200:201],v244 offset:8192
ds_read_b64_tr_b16 a[202:203],v244 offset:10240
v_mfma_f32_16x16x32_bf16 v[44:47],a[236:239],v[140:143],v[44:47]
v_mfma_f32_16x16x32_bf16 v[48:51],a[224:227],v[144:147],0
v_mfma_f32_16x16x32_bf16 v[48:51],a[228:231],v[148:151],v[48:51]
ds_read_b64_tr_b16 a[204:205],v244 offset:12288
ds_read_b64_tr_b16 a[206:207],v244 offset:14336
v_mfma_f32_16x16x32_bf16 v[48:51],a[232:235],v[152:155],v[48:51]
v_mfma_f32_16x16x32_bf16 v[48:51],a[236:239],v[156:159],v[48:51]
v_mfma_f32_16x16x32_bf16 v[52:55],a[240:243],v[112:115],0
ds_read_b64_tr_b16 a[208:209],v245 offset:0
ds_read_b64_tr_b16 a[210:211],v245 offset:2048
v_mfma_f32_16x16x32_bf16 v[52:55],a[244:247],v[116:119],v[52:55]
v_mfma_f32_16x16x32_bf16 v[52:55],a[248:251],v[120:123],v[52:55]
s_waitcnt lgkmcnt(10)
v_mfma_f32_16x16x32_bf16 v[52:55],a[252:255],v[124:127],v[52:55]
ds_read_b64_tr_b16 a[212:213],v245 offset:4096
ds_read_b64_tr_b16 a[214:215],v245 offset:6144
v_mfma_f32_16x16x32_bf16 v[56:59],a[240:243],v[128:131],0
v_mfma_f32_16x16x32_bf16 v[56:59],a[244:247],v[132:135],v[56:59]
v_mfma_f32_16x16x32_bf16 v[56:59],a[248:251],v[136:139],v[56:59]
ds_read_b64_tr_b16 a[216:217],v245 offset:8192
ds_read_b64_tr_b16 a[218:219],v245 offset:10240
v_mfma_f32_16x16x32_bf16 v[56:59],a[252:255],v[140:143],v[56:59]
v_mfma_f32_16x16x32_bf16 v[60:63],a[240:243],v[144:147],0
v_mfma_f32_16x16x32_bf16 v[60:63],a[244:247],v[148:151],v[60:63]
ds_read_b64_tr_b16 a[220:221],v245 offset:12288
ds_read_b64_tr_b16 a[222:223],v245 offset:14336
v_mfma_f32_16x16x32_bf16 v[60:63],a[248:251],v[152:155],v[60:63]
v_mfma_f32_16x16x32_bf16 v[60:63],a[252:255],v[156:159],v[60:63]
s_waitcnt vmcnt(33)
s_barrier
s_waitcnt lgkmcnt(4)
v_mfma_f32_16x16x32_bf16 v[16:19],a[192:195],v[160:163],v[16:19]
ds_read_b64_tr_b16 a[224:225],v246 offset:0
ds_read_b64_tr_b16 a[226:227],v246 offset:2048
v_mfma_f32_16x16x32_bf16 v[16:19],a[196:199],v[164:167],v[16:19]
v_mfma_f32_16x16x32_bf16 v[16:19],a[200:203],v[168:171],v[16:19]
v_mfma_f32_16x16x32_bf16 v[16:19],a[204:207],v[172:175],v[16:19]
ds_read_b64_tr_b16 a[228:229],v246 offset:4096
ds_read_b64_tr_b16 a[230:231],v246 offset:6144
v_mfma_f32_16x16x32_bf16 v[20:23],a[192:195],v[176:179],v[20:23]
v_cvt_pk_bf16_f32 v88,v88,v89
v_cvt_pk_bf16_f32 v89,v90,v91
v_mfma_f32_16x16x32_bf16 v[20:23],a[196:199],v[180:183],v[20:23]
v_cvt_pk_bf16_f32 v90,v100,v101
v_cvt_pk_bf16_f32 v91,v102,v103
v_mfma_f32_16x16x32_bf16 v[20:23],a[200:203],v[184:187],v[20:23]
ds_read_b64_tr_b16 a[232:233],v246 offset:8192
ds_read_b64_tr_b16 a[234:235],v246 offset:10240
v_mfma_f32_16x16x32_bf16 v[20:23],a[204:207],v[188:191],v[20:23]
buffer_store_dwordx4 v[88:91],v249,s[20:23],s62 offen sc0 sc1
v_mfma_f32_16x16x32_bf16 v[24:27],a[192:195],v[192:195],v[24:27]
s_add_u32 s62,s62,32768
v_cvt_pk_bf16_f32 v92,v92,v93
v_mfma_f32_16x16x32_bf16 v[24:27],a[196:199],v[196:199],v[24:27]
ds_read_b64_tr_b16 a[236:237],v246 offset:12288
ds_read_b64_tr_b16 a[238:239],v246 offset:14336
v_mfma_f32_16x16x32_bf16 v[24:27],a[200:203],v[200:203],v[24:27]
v_cvt_pk_bf16_f32 v93,v94,v95
v_cvt_pk_bf16_f32 v94,v104,v105
v_mfma_f32_16x16x32_bf16 v[24:27],a[204:207],v[204:207],v[24:27]
v_cvt_pk_bf16_f32 v95,v106,v107
v_mfma_f32_16x16x32_bf16 v[28:31],a[208:211],v[160:163],v[28:31]
ds_read_b64_tr_b16 a[240:241],v247 offset:0
ds_read_b64_tr_b16 a[242:243],v247 offset:2048
v_mfma_f32_16x16x32_bf16 v[28:31],a[212:215],v[164:167],v[28:31]
s_waitcnt lgkmcnt(4)
v_mfma_f32_16x16x32_bf16 v[28:31],a[216:219],v[168:171],v[28:31]
buffer_store_dwordx4 v[92:95],v249,s[20:23],s63 offen sc0 sc1
v_mfma_f32_16x16x32_bf16 v[28:31],a[220:223],v[172:175],v[28:31]
ds_read_b64_tr_b16 a[244:245],v247 offset:4096
ds_read_b64_tr_b16 a[246:247],v247 offset:6144
v_mfma_f32_16x16x32_bf16 v[32:35],a[208:211],v[176:179],v[32:35]
s_add_u32 s63,s63,32768
v_cvt_pk_bf16_f32 v96,v96,v97
v_mfma_f32_16x16x32_bf16 v[32:35],a[212:215],v[180:183],v[32:35]
v_cvt_pk_bf16_f32 v97,v98,v99
v_cvt_pk_bf16_f32 v98,v108,v109
v_mfma_f32_16x16x32_bf16 v[32:35],a[216:219],v[184:187],v[32:35]
ds_read_b64_tr_b16 a[248:249],v247 offset:8192
ds_read_b64_tr_b16 a[250:251],v247 offset:10240
v_mfma_f32_16x16x32_bf16 v[32:35],a[220:223],v[188:191],v[32:35]
v_cvt_pk_bf16_f32 v99,v110,v111
v_mfma_f32_16x16x32_bf16 v[36:39],a[208:211],v[192:195],v[36:39]
buffer_store_dwordx4 v[96:99],v249,s[20:23],s64 offen sc0 sc1
v_mfma_f32_16x16x32_bf16 v[36:39],a[212:215],v[196:199],v[36:39]
ds_read_b64_tr_b16 a[252:253],v247 offset:12288
ds_read_b64_tr_b16 a[254:255],v247 offset:14336
v_mfma_f32_16x16x32_bf16 v[36:39],a[216:219],v[200:203],v[36:39]
s_add_u32 s64,s64,32768
v_mfma_f32_16x16x32_bf16 v[36:39],a[220:223],v[204:207],v[36:39]
v_mfma_f32_16x16x32_bf16 v[40:43],a[224:227],v[160:163],v[40:43]
ds_read_b64_tr_b16 a[192:193],v244 offset:16384
ds_read_b64_tr_b16 a[194:195],v244 offset:18432
v_mfma_f32_16x16x32_bf16 v[40:43],a[228:231],v[164:167],v[40:43]
v_mfma_f32_16x16x32_bf16 v[40:43],a[232:235],v[168:171],v[40:43]
s_waitcnt lgkmcnt(4)
v_mfma_f32_16x16x32_bf16 v[40:43],a[236:239],v[172:175],v[40:43]
ds_read_b64_tr_b16 a[196:197],v244 offset:20480
ds_read_b64_tr_b16 a[198:199],v244 offset:22528
v_mfma_f32_16x16x32_bf16 v[44:47],a[224:227],v[176:179],v[44:47]
v_mfma_f32_16x16x32_bf16 v[44:47],a[228:231],v[180:183],v[44:47]
v_mfma_f32_16x16x32_bf16 v[44:47],a[232:235],v[184:187],v[44:47]
ds_read_b64_tr_b16 a[200:201],v244 offset:24576
ds_read_b64_tr_b16 a[202:203],v244 offset:26624
v_mfma_f32_16x16x32_bf16 v[44:47],a[236:239],v[188:191],v[44:47]
v_mfma_f32_16x16x32_bf16 v[48:51],a[224:227],v[192:195],v[48:51]
v_mfma_f32_16x16x32_bf16 v[48:51],a[228:231],v[196:199],v[48:51]
ds_read_b64_tr_b16 a[204:205],v244 offset:28672
ds_read_b64_tr_b16 a[206:207],v244 offset:30720
v_mfma_f32_16x16x32_bf16 v[48:51],a[232:235],v[200:203],v[48:51]
v_mfma_f32_16x16x32_bf16 v[48:51],a[236:239],v[204:207],v[48:51]
v_mfma_f32_16x16x32_bf16 v[52:55],a[240:243],v[160:163],v[52:55]
ds_read_b64_tr_b16 a[208:209],v245 offset:16384
ds_read_b64_tr_b16 a[210:211],v245 offset:18432
v_mfma_f32_16x16x32_bf16 v[52:55],a[244:247],v[164:167],v[52:55]
v_mfma_f32_16x16x32_bf16 v[52:55],a[248:251],v[168:171],v[52:55]
s_waitcnt lgkmcnt(10)
v_mfma_f32_16x16x32_bf16 v[52:55],a[252:255],v[172:175],v[52:55]
ds_read_b64_tr_b16 a[212:213],v245 offset:20480
ds_read_b64_tr_b16 a[214:215],v245 offset:22528
v_mfma_f32_16x16x32_bf16 v[56:59],a[240:243],v[176:179],v[56:59]
v_mfma_f32_16x16x32_bf16 v[56:59],a[244:247],v[180:183],v[56:59]
v_mfma_f32_16x16x32_bf16 v[56:59],a[248:251],v[184:187],v[56:59]
ds_read_b64_tr_b16 a[216:217],v245 offset:24576
ds_read_b64_tr_b16 a[218:219],v245 offset:26624
v_mfma_f32_16x16x32_bf16 v[56:59],a[252:255],v[188:191],v[56:59]
v_mfma_f32_16x16x32_bf16 v[60:63],a[240:243],v[192:195],v[60:63]
v_mfma_f32_16x16x32_bf16 v[60:63],a[244:247],v[196:199],v[60:63]
ds_read_b64_tr_b16 a[220:221],v245 offset:28672
ds_read_b64_tr_b16 a[222:223],v245 offset:30720
v_mfma_f32_16x16x32_bf16 v[60:63],a[248:251],v[200:203],v[60:63]
v_mfma_f32_16x16x32_bf16 v[60:63],a[252:255],v[204:207],v[60:63]
s_waitcnt vmcnt(26)
s_barrier
s_waitcnt lgkmcnt(4)
v_mfma_f32_16x16x32_bf16 v[64:67],a[192:195],v[112:115],0
ds_read_b64_tr_b16 a[224:225],v246 offset:16384
ds_read_b64_tr_b16 a[226:227],v246 offset:18432
v_mfma_f32_16x16x32_bf16 v[64:67],a[196:199],v[116:119],v[64:67]
v_mfma_f32_16x16x32_bf16 v[64:67],a[200:203],v[120:123],v[64:67]
v_mfma_f32_16x16x32_bf16 v[64:67],a[204:207],v[124:127],v[64:67]
ds_read_b64_tr_b16 a[228:229],v246 offset:20480
ds_read_b64_tr_b16 a[230:231],v246 offset:22528
v_mfma_f32_16x16x32_bf16 v[68:71],a[192:195],v[128:131],0
v_cvt_pk_bf16_f32 v16,v16,v17
v_cvt_pk_bf16_f32 v17,v18,v19
v_mfma_f32_16x16x32_bf16 v[68:71],a[196:199],v[132:135],v[68:71]
v_cvt_pk_bf16_f32 v18,v28,v29
v_cvt_pk_bf16_f32 v19,v30,v31
v_mfma_f32_16x16x32_bf16 v[68:71],a[200:203],v[136:139],v[68:71]
ds_read_b64_tr_b16 a[232:233],v246 offset:24576
ds_read_b64_tr_b16 a[234:235],v246 offset:26624
v_mfma_f32_16x16x32_bf16 v[68:71],a[204:207],v[140:143],v[68:71]
buffer_store_dwordx4 v[16:19],v248,s[20:23],s62 offen sc0 sc1
v_mfma_f32_16x16x32_bf16 v[72:75],a[192:195],v[144:147],0
v_cvt_pk_bf16_f32 v20,v20,v21
v_cvt_pk_bf16_f32 v21,v22,v23
v_mfma_f32_16x16x32_bf16 v[72:75],a[196:199],v[148:151],v[72:75]
ds_read_b64_tr_b16 a[236:237],v246 offset:28672
ds_read_b64_tr_b16 a[238:239],v246 offset:30720
v_mfma_f32_16x16x32_bf16 v[72:75],a[200:203],v[152:155],v[72:75]
v_cvt_pk_bf16_f32 v22,v32,v33
v_cvt_pk_bf16_f32 v23,v34,v35
v_mfma_f32_16x16x32_bf16 v[72:75],a[204:207],v[156:159],v[72:75]
buffer_store_dwordx4 v[20:23],v248,s[20:23],s63 offen sc0 sc1
v_mfma_f32_16x16x32_bf16 v[76:79],a[208:211],v[112:115],0
ds_read_b64_tr_b16 a[240:241],v247 offset:16384
ds_read_b64_tr_b16 a[242:243],v247 offset:18432
v_mfma_f32_16x16x32_bf16 v[76:79],a[212:215],v[116:119],v[76:79]
v_cvt_pk_bf16_f32 v24,v24,v25
s_waitcnt lgkmcnt(4)
v_mfma_f32_16x16x32_bf16 v[76:79],a[216:219],v[120:123],v[76:79]
v_cvt_pk_bf16_f32 v25,v26,v27
v_cvt_pk_bf16_f32 v26,v36,v37
v_mfma_f32_16x16x32_bf16 v[76:79],a[220:223],v[124:127],v[76:79]
ds_read_b64_tr_b16 a[244:245],v247 offset:20480
ds_read_b64_tr_b16 a[246:247],v247 offset:22528
v_mfma_f32_16x16x32_bf16 v[80:83],a[208:211],v[128:131],0
v_cvt_pk_bf16_f32 v27,v38,v39
v_mfma_f32_16x16x32_bf16 v[80:83],a[212:215],v[132:135],v[80:83]
buffer_store_dwordx4 v[24:27],v248,s[20:23],s64 offen sc0 sc1
v_mfma_f32_16x16x32_bf16 v[80:83],a[216:219],v[136:139],v[80:83]
ds_read_b64_tr_b16 a[248:249],v247 offset:24576
ds_read_b64_tr_b16 a[250:251],v247 offset:26624
v_mfma_f32_16x16x32_bf16 v[80:83],a[220:223],v[140:143],v[80:83]
v_mfma_f32_16x16x32_bf16 v[84:87],a[208:211],v[144:147],0
v_mfma_f32_16x16x32_bf16 v[84:87],a[212:215],v[148:151],v[84:87]
ds_read_b64_tr_b16 a[252:253],v247 offset:28672
ds_read_b64_tr_b16 a[254:255],v247 offset:30720
v_mfma_f32_16x16x32_bf16 v[84:87],a[216:219],v[152:155],v[84:87]
v_mfma_f32_16x16x32_bf16 v[84:87],a[220:223],v[156:159],v[84:87]
v_mfma_f32_16x16x32_bf16 v[88:91],a[224:227],v[112:115],0
ds_read_b64_tr_b16 a[192:193],v244 offset:32768
ds_read_b64_tr_b16 a[194:195],v244 offset:34816
v_mfma_f32_16x16x32_bf16 v[88:91],a[228:231],v[116:119],v[88:91]
v_mfma_f32_16x16x32_bf16 v[88:91],a[232:235],v[120:123],v[88:91]
s_waitcnt lgkmcnt(4)
v_mfma_f32_16x16x32_bf16 v[88:91],a[236:239],v[124:127],v[88:91]
ds_read_b64_tr_b16 a[196:197],v244 offset:36864
ds_read_b64_tr_b16 a[198:199],v244 offset:38912
v_mfma_f32_16x16x32_bf16 v[92:95],a[224:227],v[128:131],0
v_mfma_f32_16x16x32_bf16 v[92:95],a[228:231],v[132:135],v[92:95]
v_mfma_f32_16x16x32_bf16 v[92:95],a[232:235],v[136:139],v[92:95]
ds_read_b64_tr_b16 a[200:201],v244 offset:40960
ds_read_b64_tr_b16 a[202:203],v244 offset:43008
v_mfma_f32_16x16x32_bf16 v[92:95],a[236:239],v[140:143],v[92:95]
v_mfma_f32_16x16x32_bf16 v[96:99],a[224:227],v[144:147],0
v_mfma_f32_16x16x32_bf16 v[96:99],a[228:231],v[148:151],v[96:99]
ds_read_b64_tr_b16 a[204:205],v244 offset:45056
ds_read_b64_tr_b16 a[206:207],v244 offset:47104
v_mfma_f32_16x16x32_bf16 v[96:99],a[232:235],v[152:155],v[96:99]
v_mfma_f32_16x16x32_bf16 v[96:99],a[236:239],v[156:159],v[96:99]
v_mfma_f32_16x16x32_bf16 v[100:103],a[240:243],v[112:115],0
ds_read_b64_tr_b16 a[208:209],v245 offset:32768
ds_read_b64_tr_b16 a[210:211],v245 offset:34816
v_mfma_f32_16x16x32_bf16 v[100:103],a[244:247],v[116:119],v[100:103]
v_mfma_f32_16x16x32_bf16 v[100:103],a[248:251],v[120:123],v[100:103]
s_waitcnt lgkmcnt(10)
v_mfma_f32_16x16x32_bf16 v[100:103],a[252:255],v[124:127],v[100:103]
ds_read_b64_tr_b16 a[212:213],v245 offset:36864
ds_read_b64_tr_b16 a[214:215],v245 offset:38912
v_mfma_f32_16x16x32_bf16 v[104:107],a[240:243],v[128:131],0
v_mfma_f32_16x16x32_bf16 v[104:107],a[244:247],v[132:135],v[104:107]
v_mfma_f32_16x16x32_bf16 v[104:107],a[248:251],v[136:139],v[104:107]
ds_read_b64_tr_b16 a[216:217],v245 offset:40960
ds_read_b64_tr_b16 a[218:219],v245 offset:43008
v_mfma_f32_16x16x32_bf16 v[104:107],a[252:255],v[140:143],v[104:107]
v_mfma_f32_16x16x32_bf16 v[108:111],a[240:243],v[144:147],0
v_mfma_f32_16x16x32_bf16 v[108:111],a[244:247],v[148:151],v[108:111]
ds_read_b64_tr_b16 a[220:221],v245 offset:45056
ds_read_b64_tr_b16 a[222:223],v245 offset:47104
v_mfma_f32_16x16x32_bf16 v[108:111],a[248:251],v[152:155],v[108:111]
v_mfma_f32_16x16x32_bf16 v[108:111],a[252:255],v[156:159],v[108:111]
s_waitcnt vmcnt(22)
s_barrier
s_waitcnt lgkmcnt(4)
v_mfma_f32_16x16x32_bf16 v[64:67],a[192:195],v[160:163],v[64:67]
ds_read_b64_tr_b16 a[224:225],v246 offset:32768
ds_read_b64_tr_b16 a[226:227],v246 offset:34816
v_mfma_f32_16x16x32_bf16 v[64:67],a[196:199],v[164:167],v[64:67]
v_mfma_f32_16x16x32_bf16 v[64:67],a[200:203],v[168:171],v[64:67]
v_mfma_f32_16x16x32_bf16 v[64:67],a[204:207],v[172:175],v[64:67]
ds_read_b64_tr_b16 a[228:229],v246 offset:36864
ds_read_b64_tr_b16 a[230:231],v246 offset:38912
v_mfma_f32_16x16x32_bf16 v[68:71],a[192:195],v[176:179],v[68:71]
v_cvt_pk_bf16_f32 v40,v40,v41
v_cvt_pk_bf16_f32 v41,v42,v43
v_mfma_f32_16x16x32_bf16 v[68:71],a[196:199],v[180:183],v[68:71]
v_cvt_pk_bf16_f32 v42,v52,v53
v_cvt_pk_bf16_f32 v43,v54,v55
v_mfma_f32_16x16x32_bf16 v[68:71],a[200:203],v[184:187],v[68:71]
ds_read_b64_tr_b16 a[232:233],v246 offset:40960
ds_read_b64_tr_b16 a[234:235],v246 offset:43008
v_mfma_f32_16x16x32_bf16 v[68:71],a[204:207],v[188:191],v[68:71]
buffer_store_dwordx4 v[40:43],v249,s[20:23],s62 offen sc0 sc1
v_mfma_f32_16x16x32_bf16 v[72:75],a[192:195],v[192:195],v[72:75]
s_add_u32 s62,s62,32768
v_cvt_pk_bf16_f32 v44,v44,v45
v_mfma_f32_16x16x32_bf16 v[72:75],a[196:199],v[196:199],v[72:75]
ds_read_b64_tr_b16 a[236:237],v246 offset:45056
ds_read_b64_tr_b16 a[238:239],v246 offset:47104
v_mfma_f32_16x16x32_bf16 v[72:75],a[200:203],v[200:203],v[72:75]
v_cvt_pk_bf16_f32 v45,v46,v47
v_cvt_pk_bf16_f32 v46,v56,v57
v_mfma_f32_16x16x32_bf16 v[72:75],a[204:207],v[204:207],v[72:75]
v_cvt_pk_bf16_f32 v47,v58,v59
v_mfma_f32_16x16x32_bf16 v[76:79],a[208:211],v[160:163],v[76:79]
ds_read_b64_tr_b16 a[240:241],v247 offset:32768
ds_read_b64_tr_b16 a[242:243],v247 offset:34816
v_mfma_f32_16x16x32_bf16 v[76:79],a[212:215],v[164:167],v[76:79]
s_waitcnt lgkmcnt(4)
v_mfma_f32_16x16x32_bf16 v[76:79],a[216:219],v[168:171],v[76:79]
buffer_store_dwordx4 v[44:47],v249,s[20:23],s63 offen sc0 sc1
v_mfma_f32_16x16x32_bf16 v[76:79],a[220:223],v[172:175],v[76:79]
ds_read_b64_tr_b16 a[244:245],v247 offset:36864
ds_read_b64_tr_b16 a[246:247],v247 offset:38912
v_mfma_f32_16x16x32_bf16 v[80:83],a[208:211],v[176:179],v[80:83]
s_add_u32 s63,s63,32768
v_cvt_pk_bf16_f32 v48,v48,v49
v_mfma_f32_16x16x32_bf16 v[80:83],a[212:215],v[180:183],v[80:83]
v_cvt_pk_bf16_f32 v49,v50,v51
v_cvt_pk_bf16_f32 v50,v60,v61
v_mfma_f32_16x16x32_bf16 v[80:83],a[216:219],v[184:187],v[80:83]
ds_read_b64_tr_b16 a[248:249],v247 offset:40960
ds_read_b64_tr_b16 a[250:251],v247 offset:43008
v_mfma_f32_16x16x32_bf16 v[80:83],a[220:223],v[188:191],v[80:83]
v_cvt_pk_bf16_f32 v51,v62,v63
v_mfma_f32_16x16x32_bf16 v[84:87],a[208:211],v[192:195],v[84:87]
buffer_store_dwordx4 v[48:51],v249,s[20:23],s64 offen sc0 sc1
v_mfma_f32_16x16x32_bf16 v[84:87],a[212:215],v[196:199],v[84:87]
ds_read_b64_tr_b16 a[252:253],v247 offset:45056
ds_read_b64_tr_b16 a[254:255],v247 offset:47104
v_mfma_f32_16x16x32_bf16 v[84:87],a[216:219],v[200:203],v[84:87]
s_add_u32 s64,s64,32768
v_mfma_f32_16x16x32_bf16 v[84:87],a[220:223],v[204:207],v[84:87]
v_mfma_f32_16x16x32_bf16 v[88:91],a[224:227],v[160:163],v[88:91]
ds_read_b64_tr_b16 a[192:193],v244 offset:49152
ds_read_b64_tr_b16 a[194:195],v244 offset:51200
v_mfma_f32_16x16x32_bf16 v[88:91],a[228:231],v[164:167],v[88:91]
v_mfma_f32_16x16x32_bf16 v[88:91],a[232:235],v[168:171],v[88:91]
s_waitcnt lgkmcnt(4)
v_mfma_f32_16x16x32_bf16 v[88:91],a[236:239],v[172:175],v[88:91]
ds_read_b64_tr_b16 a[196:197],v244 offset:53248
ds_read_b64_tr_b16 a[198:199],v244 offset:55296
v_mfma_f32_16x16x32_bf16 v[92:95],a[224:227],v[176:179],v[92:95]
v_mfma_f32_16x16x32_bf16 v[92:95],a[228:231],v[180:183],v[92:95]
v_mfma_f32_16x16x32_bf16 v[92:95],a[232:235],v[184:187],v[92:95]
ds_read_b64_tr_b16 a[200:201],v244 offset:57344
ds_read_b64_tr_b16 a[202:203],v244 offset:59392
v_mfma_f32_16x16x32_bf16 v[92:95],a[236:239],v[188:191],v[92:95]
v_mfma_f32_16x16x32_bf16 v[96:99],a[224:227],v[192:195],v[96:99]
v_mfma_f32_16x16x32_bf16 v[96:99],a[228:231],v[196:199],v[96:99]
ds_read_b64_tr_b16 a[204:205],v244 offset:61440
ds_read_b64_tr_b16 a[206:207],v244 offset:63488
v_mfma_f32_16x16x32_bf16 v[96:99],a[232:235],v[200:203],v[96:99]
v_mfma_f32_16x16x32_bf16 v[96:99],a[236:239],v[204:207],v[96:99]
v_mfma_f32_16x16x32_bf16 v[100:103],a[240:243],v[160:163],v[100:103]
ds_read_b64_tr_b16 a[208:209],v245 offset:49152
ds_read_b64_tr_b16 a[210:211],v245 offset:51200
v_mfma_f32_16x16x32_bf16 v[100:103],a[244:247],v[164:167],v[100:103]
v_mfma_f32_16x16x32_bf16 v[100:103],a[248:251],v[168:171],v[100:103]
s_waitcnt lgkmcnt(10)
v_mfma_f32_16x16x32_bf16 v[100:103],a[252:255],v[172:175],v[100:103]
ds_read_b64_tr_b16 a[212:213],v245 offset:53248
ds_read_b64_tr_b16 a[214:215],v245 offset:55296
v_mfma_f32_16x16x32_bf16 v[104:107],a[240:243],v[176:179],v[104:107]
v_mfma_f32_16x16x32_bf16 v[104:107],a[244:247],v[180:183],v[104:107]
v_mfma_f32_16x16x32_bf16 v[104:107],a[248:251],v[184:187],v[104:107]
ds_read_b64_tr_b16 a[216:217],v245 offset:57344
ds_read_b64_tr_b16 a[218:219],v245 offset:59392
v_mfma_f32_16x16x32_bf16 v[104:107],a[252:255],v[188:191],v[104:107]
v_mfma_f32_16x16x32_bf16 v[108:111],a[240:243],v[192:195],v[108:111]
v_mfma_f32_16x16x32_bf16 v[108:111],a[244:247],v[196:199],v[108:111]
ds_read_b64_tr_b16 a[220:221],v245 offset:61440
ds_read_b64_tr_b16 a[222:223],v245 offset:63488
v_mfma_f32_16x16x32_bf16 v[108:111],a[248:251],v[200:203],v[108:111]
v_mfma_f32_16x16x32_bf16 v[108:111],a[252:255],v[204:207],v[108:111]
s_waitcnt vmcnt(18)
s_barrier
s_waitcnt lgkmcnt(4)
v_mfma_f32_16x16x32_bf16 v[16:19],a[192:195],v[112:115],0
ds_read_b64_tr_b16 a[224:225],v246 offset:49152
ds_read_b64_tr_b16 a[226:227],v246 offset:51200
v_mfma_f32_16x16x32_bf16 v[16:19],a[196:199],v[116:119],v[16:19]
v_mfma_f32_16x16x32_bf16 v[16:19],a[200:203],v[120:123],v[16:19]
v_mfma_f32_16x16x32_bf16 v[16:19],a[204:207],v[124:127],v[16:19]
ds_read_b64_tr_b16 a[228:229],v246 offset:53248
ds_read_b64_tr_b16 a[230:231],v246 offset:55296
v_mfma_f32_16x16x32_bf16 v[20:23],a[192:195],v[128:131],0
v_cvt_pk_bf16_f32 v64,v64,v65
v_cvt_pk_bf16_f32 v65,v66,v67
v_mfma_f32_16x16x32_bf16 v[20:23],a[196:199],v[132:135],v[20:23]
v_cvt_pk_bf16_f32 v66,v76,v77
v_cvt_pk_bf16_f32 v67,v78,v79
v_mfma_f32_16x16x32_bf16 v[20:23],a[200:203],v[136:139],v[20:23]
ds_read_b64_tr_b16 a[232:233],v246 offset:57344
ds_read_b64_tr_b16 a[234:235],v246 offset:59392
v_mfma_f32_16x16x32_bf16 v[20:23],a[204:207],v[140:143],v[20:23]
buffer_store_dwordx4 v[64:67],v248,s[20:23],s62 offen sc0 sc1
v_mfma_f32_16x16x32_bf16 v[24:27],a[192:195],v[144:147],0
v_cvt_pk_bf16_f32 v68,v68,v69
v_cvt_pk_bf16_f32 v69,v70,v71
v_mfma_f32_16x16x32_bf16 v[24:27],a[196:199],v[148:151],v[24:27]
ds_read_b64_tr_b16 a[236:237],v246 offset:61440
ds_read_b64_tr_b16 a[238:239],v246 offset:63488
v_mfma_f32_16x16x32_bf16 v[24:27],a[200:203],v[152:155],v[24:27]
v_cvt_pk_bf16_f32 v70,v80,v81
v_cvt_pk_bf16_f32 v71,v82,v83
v_mfma_f32_16x16x32_bf16 v[24:27],a[204:207],v[156:159],v[24:27]
buffer_store_dwordx4 v[68:71],v248,s[20:23],s63 offen sc0 sc1
v_mfma_f32_16x16x32_bf16 v[28:31],a[208:211],v[112:115],0
ds_read_b64_tr_b16 a[240:241],v247 offset:49152
ds_read_b64_tr_b16 a[242:243],v247 offset:51200
v_mfma_f32_16x16x32_bf16 v[28:31],a[212:215],v[116:119],v[28:31]
v_cvt_pk_bf16_f32 v72,v72,v73
s_waitcnt lgkmcnt(4)
v_mfma_f32_16x16x32_bf16 v[28:31],a[216:219],v[120:123],v[28:31]
v_cvt_pk_bf16_f32 v73,v74,v75
v_cvt_pk_bf16_f32 v74,v84,v85
v_mfma_f32_16x16x32_bf16 v[28:31],a[220:223],v[124:127],v[28:31]
ds_read_b64_tr_b16 a[244:245],v247 offset:53248
ds_read_b64_tr_b16 a[246:247],v247 offset:55296
v_mfma_f32_16x16x32_bf16 v[32:35],a[208:211],v[128:131],0
v_cvt_pk_bf16_f32 v75,v86,v87
v_mfma_f32_16x16x32_bf16 v[32:35],a[212:215],v[132:135],v[32:35]
buffer_store_dwordx4 v[72:75],v248,s[20:23],s64 offen sc0 sc1
v_mfma_f32_16x16x32_bf16 v[32:35],a[216:219],v[136:139],v[32:35]
ds_read_b64_tr_b16 a[248:249],v247 offset:57344
ds_read_b64_tr_b16 a[250:251],v247 offset:59392
v_mfma_f32_16x16x32_bf16 v[32:35],a[220:223],v[140:143],v[32:35]
v_mfma_f32_16x16x32_bf16 v[36:39],a[208:211],v[144:147],0
v_mfma_f32_16x16x32_bf16 v[36:39],a[212:215],v[148:151],v[36:39]
ds_read_b64_tr_b16 a[252:253],v247 offset:61440
ds_read_b64_tr_b16 a[254:255],v247 offset:63488
v_mfma_f32_16x16x32_bf16 v[36:39],a[216:219],v[152:155],v[36:39]
v_mfma_f32_16x16x32_bf16 v[36:39],a[220:223],v[156:159],v[36:39]
v_mfma_f32_16x16x32_bf16 v[40:43],a[224:227],v[112:115],0
ds_read_b64_tr_b16 a[192:193],v240 offset:0
ds_read_b64_tr_b16 a[194:195],v240 offset:2048
v_mfma_f32_16x16x32_bf16 v[40:43],a[228:231],v[116:119],v[40:43]
v_mfma_f32_16x16x32_bf16 v[40:43],a[232:235],v[120:123],v[40:43]
s_waitcnt lgkmcnt(4)
v_mfma_f32_16x16x32_bf16 v[40:43],a[236:239],v[124:127],v[40:43]
ds_read_b64_tr_b16 a[196:197],v240 offset:4096
ds_read_b64_tr_b16 a[198:199],v240 offset:6144
v_mfma_f32_16x16x32_bf16 v[44:47],a[224:227],v[128:131],0
v_mfma_f32_16x16x32_bf16 v[44:47],a[228:231],v[132:135],v[44:47]
v_mfma_f32_16x16x32_bf16 v[44:47],a[232:235],v[136:139],v[44:47]
ds_read_b64_tr_b16 a[200:201],v240 offset:8192
ds_read_b64_tr_b16 a[202:203],v240 offset:10240
v_mfma_f32_16x16x32_bf16 v[44:47],a[236:239],v[140:143],v[44:47]
v_mfma_f32_16x16x32_bf16 v[48:51],a[224:227],v[144:147],0
v_mfma_f32_16x16x32_bf16 v[48:51],a[228:231],v[148:151],v[48:51]
ds_read_b64_tr_b16 a[204:205],v240 offset:12288
ds_read_b64_tr_b16 a[206:207],v240 offset:14336
v_mfma_f32_16x16x32_bf16 v[48:51],a[232:235],v[152:155],v[48:51]
v_mfma_f32_16x16x32_bf16 v[48:51],a[236:239],v[156:159],v[48:51]
v_mfma_f32_16x16x32_bf16 v[52:55],a[240:243],v[112:115],0
ds_read_b64_tr_b16 a[208:209],v241 offset:0
ds_read_b64_tr_b16 a[210:211],v241 offset:2048
v_mfma_f32_16x16x32_bf16 v[52:55],a[244:247],v[116:119],v[52:55]
v_mfma_f32_16x16x32_bf16 v[52:55],a[248:251],v[120:123],v[52:55]
s_waitcnt lgkmcnt(10)
v_mfma_f32_16x16x32_bf16 v[52:55],a[252:255],v[124:127],v[52:55]
ds_read_b64_tr_b16 a[212:213],v241 offset:4096
ds_read_b64_tr_b16 a[214:215],v241 offset:6144
v_mfma_f32_16x16x32_bf16 v[56:59],a[240:243],v[128:131],0
v_mfma_f32_16x16x32_bf16 v[56:59],a[244:247],v[132:135],v[56:59]
v_mfma_f32_16x16x32_bf16 v[56:59],a[248:251],v[136:139],v[56:59]
ds_read_b64_tr_b16 a[216:217],v241 offset:8192
ds_read_b64_tr_b16 a[218:219],v241 offset:10240
v_mfma_f32_16x16x32_bf16 v[56:59],a[252:255],v[140:143],v[56:59]
v_mfma_f32_16x16x32_bf16 v[60:63],a[240:243],v[144:147],0
v_mfma_f32_16x16x32_bf16 v[60:63],a[244:247],v[148:151],v[60:63]
ds_read_b64_tr_b16 a[220:221],v241 offset:12288
ds_read_b64_tr_b16 a[222:223],v241 offset:14336
v_mfma_f32_16x16x32_bf16 v[60:63],a[248:251],v[152:155],v[60:63]
v_mfma_f32_16x16x32_bf16 v[60:63],a[252:255],v[156:159],v[60:63]
s_waitcnt lgkmcnt(4)
v_mfma_f32_16x16x32_bf16 v[16:19],a[192:195],v[160:163],v[16:19]
ds_read_b64_tr_b16 a[224:225],v242 offset:0
ds_read_b64_tr_b16 a[226:227],v242 offset:2048
v_mfma_f32_16x16x32_bf16 v[16:19],a[196:199],v[164:167],v[16:19]
v_mfma_f32_16x16x32_bf16 v[16:19],a[200:203],v[168:171],v[16:19]
v_mfma_f32_16x16x32_bf16 v[16:19],a[204:207],v[172:175],v[16:19]
v_mfma_f32_16x16x32_bf16 v[20:23],a[192:195],v[176:179],v[20:23]
v_cvt_pk_bf16_f32 v88,v88,v89
v_cvt_pk_bf16_f32 v89,v90,v91
v_mfma_f32_16x16x32_bf16 v[20:23],a[196:199],v[180:183],v[20:23]
ds_read_b64_tr_b16 a[228:229],v242 offset:4096
ds_read_b64_tr_b16 a[230:231],v242 offset:6144
v_mfma_f32_16x16x32_bf16 v[20:23],a[200:203],v[184:187],v[20:23]
v_cvt_pk_bf16_f32 v90,v100,v101
v_cvt_pk_bf16_f32 v91,v102,v103
v_mfma_f32_16x16x32_bf16 v[20:23],a[204:207],v[188:191],v[20:23]
buffer_store_dwordx4 v[88:91],v249,s[20:23],s62 offen sc0 sc1
v_mfma_f32_16x16x32_bf16 v[24:27],a[192:195],v[192:195],v[24:27]
s_add_u32 s62,s62,32768
v_cvt_pk_bf16_f32 v92,v92,v93
v_mfma_f32_16x16x32_bf16 v[24:27],a[196:199],v[196:199],v[24:27]
ds_read_b64_tr_b16 a[232:233],v242 offset:8192
ds_read_b64_tr_b16 a[234:235],v242 offset:10240
v_mfma_f32_16x16x32_bf16 v[24:27],a[200:203],v[200:203],v[24:27]
v_cvt_pk_bf16_f32 v93,v94,v95
v_cvt_pk_bf16_f32 v94,v104,v105
v_mfma_f32_16x16x32_bf16 v[24:27],a[204:207],v[204:207],v[24:27]
v_cvt_pk_bf16_f32 v95,v106,v107
v_mfma_f32_16x16x32_bf16 v[28:31],a[208:211],v[160:163],v[28:31]
buffer_store_dwordx4 v[92:95],v249,s[20:23],s63 offen sc0 sc1
v_mfma_f32_16x16x32_bf16 v[28:31],a[212:215],v[164:167],v[28:31]
ds_read_b64_tr_b16 a[236:237],v242 offset:12288
ds_read_b64_tr_b16 a[238:239],v242 offset:14336
s_waitcnt lgkmcnt(4)
v_mfma_f32_16x16x32_bf16 v[28:31],a[216:219],v[168:171],v[28:31]
s_add_u32 s63,s63,32768
v_cvt_pk_bf16_f32 v96,v96,v97
v_mfma_f32_16x16x32_bf16 v[28:31],a[220:223],v[172:175],v[28:31]
v_cvt_pk_bf16_f32 v97,v98,v99
v_cvt_pk_bf16_f32 v98,v108,v109
v_mfma_f32_16x16x32_bf16 v[32:35],a[208:211],v[176:179],v[32:35]
v_cvt_pk_bf16_f32 v99,v110,v111
v_mfma_f32_16x16x32_bf16 v[32:35],a[212:215],v[180:183],v[32:35]
buffer_store_dwordx4 v[96:99],v249,s[20:23],s64 offen sc0 sc1
v_mfma_f32_16x16x32_bf16 v[32:35],a[216:219],v[184:187],v[32:35]
ds_read_b64_tr_b16 a[240:241],v243 offset:0
ds_read_b64_tr_b16 a[242:243],v243 offset:2048
v_mfma_f32_16x16x32_bf16 v[32:35],a[220:223],v[188:191],v[32:35]
s_add_u32 s64,s64,32768
v_mfma_f32_16x16x32_bf16 v[36:39],a[208:211],v[192:195],v[36:39]
v_mfma_f32_16x16x32_bf16 v[36:39],a[212:215],v[196:199],v[36:39]
v_mfma_f32_16x16x32_bf16 v[36:39],a[216:219],v[200:203],v[36:39]
ds_read_b64_tr_b16 a[244:245],v243 offset:4096
ds_read_b64_tr_b16 a[246:247],v243 offset:6144
v_mfma_f32_16x16x32_bf16 v[36:39],a[220:223],v[204:207],v[36:39]
v_mfma_f32_16x16x32_bf16 v[40:43],a[224:227],v[160:163],v[40:43]
v_mfma_f32_16x16x32_bf16 v[40:43],a[228:231],v[164:167],v[40:43]
s_waitcnt lgkmcnt(2)
v_mfma_f32_16x16x32_bf16 v[40:43],a[232:235],v[168:171],v[40:43]
v_mfma_f32_16x16x32_bf16 v[40:43],a[236:239],v[172:175],v[40:43]
ds_read_b64_tr_b16 a[248:249],v243 offset:8192
ds_read_b64_tr_b16 a[250:251],v243 offset:10240
v_mfma_f32_16x16x32_bf16 v[44:47],a[224:227],v[176:179],v[44:47]
v_mfma_f32_16x16x32_bf16 v[44:47],a[228:231],v[180:183],v[44:47]
v_mfma_f32_16x16x32_bf16 v[44:47],a[232:235],v[184:187],v[44:47]
v_mfma_f32_16x16x32_bf16 v[44:47],a[236:239],v[188:191],v[44:47]
ds_read_b64_tr_b16 a[252:253],v243 offset:12288
ds_read_b64_tr_b16 a[254:255],v243 offset:14336
v_mfma_f32_16x16x32_bf16 v[48:51],a[224:227],v[192:195],v[48:51]
v_mfma_f32_16x16x32_bf16 v[48:51],a[228:231],v[196:199],v[48:51]
v_mfma_f32_16x16x32_bf16 v[48:51],a[232:235],v[200:203],v[48:51]
v_mfma_f32_16x16x32_bf16 v[48:51],a[236:239],v[204:207],v[48:51]
v_mfma_f32_16x16x32_bf16 v[52:55],a[240:243],v[160:163],v[52:55]
s_waitcnt lgkmcnt(2)
v_mfma_f32_16x16x32_bf16 v[52:55],a[244:247],v[164:167],v[52:55]
v_mfma_f32_16x16x32_bf16 v[52:55],a[248:251],v[168:171],v[52:55]
s_waitcnt lgkmcnt(0)
v_mfma_f32_16x16x32_bf16 v[52:55],a[252:255],v[172:175],v[52:55]
v_mfma_f32_16x16x32_bf16 v[56:59],a[240:243],v[176:179],v[56:59]
v_mfma_f32_16x16x32_bf16 v[56:59],a[244:247],v[180:183],v[56:59]
v_mfma_f32_16x16x32_bf16 v[56:59],a[248:251],v[184:187],v[56:59]
v_mfma_f32_16x16x32_bf16 v[56:59],a[252:255],v[188:191],v[56:59]
v_mfma_f32_16x16x32_bf16 v[60:63],a[240:243],v[192:195],v[60:63]
v_mfma_f32_16x16x32_bf16 v[60:63],a[244:247],v[196:199],v[60:63]
v_mfma_f32_16x16x32_bf16 v[60:63],a[248:251],v[200:203],v[60:63]
v_mfma_f32_16x16x32_bf16 v[60:63],a[252:255],v[204:207],v[60:63]
s_nop 5
v_cvt_pk_bf16_f32 v16,v16,v17
v_cvt_pk_bf16_f32 v17,v18,v19
v_cvt_pk_bf16_f32 v18,v28,v29
v_cvt_pk_bf16_f32 v19,v30,v31
buffer_store_dwordx4 v[16:19],v248,s[20:23],s62 offen sc0 sc1
v_cvt_pk_bf16_f32 v20,v20,v21
v_cvt_pk_bf16_f32 v21,v22,v23
v_cvt_pk_bf16_f32 v22,v32,v33
v_cvt_pk_bf16_f32 v23,v34,v35
buffer_store_dwordx4 v[20:23],v248,s[20:23],s63 offen sc0 sc1
v_cvt_pk_bf16_f32 v24,v24,v25
v_cvt_pk_bf16_f32 v25,v26,v27
v_cvt_pk_bf16_f32 v26,v36,v37
v_cvt_pk_bf16_f32 v27,v38,v39
buffer_store_dwordx4 v[24:27],v248,s[20:23],s64 offen sc0 sc1
v_cvt_pk_bf16_f32 v40,v40,v41
v_cvt_pk_bf16_f32 v41,v42,v43
v_cvt_pk_bf16_f32 v42,v52,v53
v_cvt_pk_bf16_f32 v43,v54,v55
buffer_store_dwordx4 v[40:43],v249,s[20:23],s62 offen sc0 sc1
s_add_u32 s62,s62,32768
v_cvt_pk_bf16_f32 v44,v44,v45
v_cvt_pk_bf16_f32 v45,v46,v47
v_cvt_pk_bf16_f32 v46,v56,v57
v_cvt_pk_bf16_f32 v47,v58,v59
buffer_store_dwordx4 v[44:47],v249,s[20:23],s63 offen sc0 sc1
s_add_u32 s63,s63,32768
v_cvt_pk_bf16_f32 v48,v48,v49
v_cvt_pk_bf16_f32 v49,v50,v51
v_cvt_pk_bf16_f32 v50,v60,v61
v_cvt_pk_bf16_f32 v51,v62,v63
buffer_store_dwordx4 v[48:51],v249,s[20:23],s64 offen sc0 sc1
s_add_u32 s64,s64,32768
s_endpgm
FALLBACK_A:
s_waitcnt vmcnt(0) lgkmcnt(0)
s_mov_b32 s30,1
s_mov_b32 s65,0
v_mov_b32 v168,0xff800000
v_mov_b32 v169,0xff800000
v_mov_b32 v170,0xff800000
FBLOOP_A:
s_barrier
s_mov_b32 m0,s25
s_add_u32 s28,s25,s65
buffer_load_dwordx4 v12,s[4:7],s28 offen lds
buffer_load_dwordx4 v13,s[4:7],s28 offen offset:1024 lds
buffer_load_dwordx4 v14,s[4:7],s28 offen offset:2048 lds
buffer_load_dwordx4 v15,s[4:7],s28 offen offset:3072 lds
s_waitcnt vmcnt(0)
s_barrier
ds_read_b128 a[192:195],v0 offset:0
ds_read_b128 a[196:199],v1 offset:0
ds_read_b128 a[200:203],v2 offset:0
ds_read_b128 a[204:207],v3 offset:0
ds_read_b128 a[208:211],v0 offset:256
ds_read_b128 a[212:215],v1 offset:256
ds_read_b128 a[216:219],v2 offset:256
ds_read_b128 a[220:223],v3 offset:256
ds_read_b128 a[224:227],v0 offset:8192
ds_read_b128 a[228:231],v1 offset:8192
ds_read_b128 a[232:235],v2 offset:8192
ds_read_b128 a[236:239],v3 offset:8192
ds_read_b128 a[240:243],v0 offset:8448
ds_read_b128 a[244:247],v1 offset:8448
ds_read_b128 a[248:251],v2 offset:8448
ds_read_b128 a[252:255],v3 offset:8448
s_waitcnt lgkmcnt(0)
v_mfma_f32_16x16x32_bf16 v[112:115],a[192:195],v[16:19],0
v_mfma_f32_16x16x32_bf16 v[112:115],a[196:199],v[20:23],v[112:115]
v_mfma_f32_16x16x32_bf16 v[112:115],a[200:203],v[24:27],v[112:115]
v_mfma_f32_16x16x32_bf16 v[112:115],a[204:207],v[28:31],v[112:115]
v_mfma_f32_16x16x32_bf16 v[112:115],a[208:211],v[32:35],v[112:115]
v_mfma_f32_16x16x32_bf16 v[112:115],a[212:215],v[36:39],v[112:115]
v_mfma_f32_16x16x32_bf16 v[112:115],a[216:219],v[40:43],v[112:115]
v_mfma_f32_16x16x32_bf16 v[112:115],a[220:223],v[44:47],v[112:115]
v_mfma_f32_16x16x32_bf16 v[128:131],a[192:195],v[48:51],0
v_mfma_f32_16x16x32_bf16 v[128:131],a[196:199],v[52:55],v[128:131]
v_mfma_f32_16x16x32_bf16 v[128:131],a[200:203],v[56:59],v[128:131]
v_mfma_f32_16x16x32_bf16 v[128:131],a[204:207],v[60:63],v[128:131]
v_mfma_f32_16x16x32_bf16 v[128:131],a[208:211],v[64:67],v[128:131]
v_mfma_f32_16x16x32_bf16 v[128:131],a[212:215],v[68:71],v[128:131]
v_mfma_f32_16x16x32_bf16 v[128:131],a[216:219],v[72:75],v[128:131]
v_mfma_f32_16x16x32_bf16 v[128:131],a[220:223],v[76:79],v[128:131]
v_mfma_f32_16x16x32_bf16 v[144:147],a[192:195],v[80:83],0
v_mfma_f32_16x16x32_bf16 v[144:147],a[196:199],v[84:87],v[144:147]
v_mfma_f32_16x16x32_bf16 v[144:147],a[200:203],v[88:91],v[144:147]
v_mfma_f32_16x16x32_bf16 v[144:147],a[204:207],v[92:95],v[144:147]
v_mfma_f32_16x16x32_bf16 v[144:147],a[208:211],v[96:99],v[144:147]
v_mfma_f32_16x16x32_bf16 v[144:147],a[212:215],v[100:103],v[144:147]
v_mfma_f32_16x16x32_bf16 v[144:147],a[216:219],v[104:107],v[144:147]
v_mfma_f32_16x16x32_bf16 v[144:147],a[220:223],v[108:111],v[144:147]
v_mfma_f32_16x16x32_bf16 v[116:119],a[224:227],v[16:19],0
v_mfma_f32_16x16x32_bf16 v[116:119],a[228:231],v[20:23],v[116:119]
v_mfma_f32_16x16x32_bf16 v[116:119],a[232:235],v[24:27],v[116:119]
v_mfma_f32_16x16x32_bf16 v[116:119],a[236:239],v[28:31],v[116:119]
v_mfma_f32_16x16x32_bf16 v[116:119],a[240:243],v[32:35],v[116:119]
v_mfma_f32_16x16x32_bf16 v[116:119],a[244:247],v[36:39],v[116:119]
v_mfma_f32_16x16x32_bf16 v[116:119],a[248:251],v[40:43],v[116:119]
v_mfma_f32_16x16x32_bf16 v[116:119],a[252:255],v[44:47],v[116:119]
v_mfma_f32_16x16x32_bf16 v[132:135],a[224:227],v[48:51],0
v_mfma_f32_16x16x32_bf16 v[132:135],a[228:231],v[52:55],v[132:135]
v_mfma_f32_16x16x32_bf16 v[132:135],a[232:235],v[56:59],v[132:135]
v_mfma_f32_16x16x32_bf16 v[132:135],a[236:239],v[60:63],v[132:135]
v_mfma_f32_16x16x32_bf16 v[132:135],a[240:243],v[64:67],v[132:135]
v_mfma_f32_16x16x32_bf16 v[132:135],a[244:247],v[68:71],v[132:135]
v_mfma_f32_16x16x32_bf16 v[132:135],a[248:251],v[72:75],v[132:135]
v_mfma_f32_16x16x32_bf16 v[132:135],a[252:255],v[76:79],v[132:135]
v_mfma_f32_16x16x32_bf16 v[148:151],a[224:227],v[80:83],0
v_mfma_f32_16x16x32_bf16 v[148:151],a[228:231],v[84:87],v[148:151]
v_mfma_f32_16x16x32_bf16 v[148:151],a[232:235],v[88:91],v[148:151]
v_mfma_f32_16x16x32_bf16 v[148:151],a[236:239],v[92:95],v[148:151]
v_mfma_f32_16x16x32_bf16 v[148:151],a[240:243],v[96:99],v[148:151]
v_mfma_f32_16x16x32_bf16 v[148:151],a[244:247],v[100:103],v[148:151]
v_mfma_f32_16x16x32_bf16 v[148:151],a[248:251],v[104:107],v[148:151]
v_mfma_f32_16x16x32_bf16 v[148:151],a[252:255],v[108:111],v[148:151]
s_nop 7
v_max3_f32 v168,v168,v112,v113
v_max3_f32 v168,v168,v114,v115
v_max3_f32 v168,v168,v116,v117
v_max3_f32 v168,v168,v118,v119
v_max3_f32 v169,v169,v128,v129
v_max3_f32 v169,v169,v130,v131
v_max3_f32 v169,v169,v132,v133
v_max3_f32 v169,v169,v134,v135
v_max3_f32 v170,v170,v144,v145
v_max3_f32 v170,v170,v146,v147
v_max3_f32 v170,v170,v148,v149
v_max3_f32 v170,v170,v150,v151
s_add_u32 s65,s65,16384
s_cmp_lt_u32 s65,1048576
s_cbranch_scc1 FBLOOP_A
v_mov_b32 v172,v168
v_mov_b32 v173,v169
v_mov_b32 v174,v170
s_nop 1
v_permlane32_swap_b32 v168,v172
v_permlane32_swap_b32 v169,v173
v_permlane32_swap_b32 v170,v174
s_nop 1
v_max_f32 v168,v168,v172
v_max_f32 v169,v169,v173
v_max_f32 v170,v170,v174
v_mov_b32 v172,v168
v_mov_b32 v173,v169
v_mov_b32 v174,v170
s_nop 1
v_permlane16_swap_b32 v168,v172
v_permlane16_swap_b32 v169,v173
v_permlane16_swap_b32 v170,v174
s_nop 1
v_max_f32 v168,v168,v172
v_max_f32 v169,v169,v173
v_max_f32 v170,v170,v174
v_sub_f32 v208,0,v168
v_sub_f32 v212,0,v169
v_sub_f32 v216,0,v170
s_barrier
s_add_u32 m0,s25,0
s_add_u32 s28,s25,0
buffer_load_dwordx4 v12,s[4:7],s28 offen nt lds
buffer_load_dwordx4 v13,s[4:7],s28 offen offset:1024 nt lds
buffer_load_dwordx4 v14,s[4:7],s28 offen offset:2048 nt lds
buffer_load_dwordx4 v15,s[4:7],s28 offen offset:3072 nt lds
s_add_u32 m0,s25,32768
s_add_u32 s28,s25,32768
buffer_load_dwordx4 v12,s[4:7],s28 offen nt lds
buffer_load_dwordx4 v13,s[4:7],s28 offen offset:1024 nt lds
buffer_load_dwordx4 v14,s[4:7],s28 offen offset:2048 nt lds
buffer_load_dwordx4 v15,s[4:7],s28 offen offset:3072 nt lds
s_waitcnt vmcnt(0)
s_barrier
ds_read_b128 a[192:195],v0 offset:0
ds_read_b128 a[196:199],v1 offset:0
ds_read_b128 a[200:203],v2 offset:0
ds_read_b128 a[204:207],v3 offset:0
ds_read_b128 a[208:211],v0 offset:256
ds_read_b128 a[212:215],v1 offset:256
ds_read_b128 a[216:219],v2 offset:256
ds_read_b128 a[220:223],v3 offset:256
s_branch PRE_A
START_B:
s_add_u32 m0,s25,49152
s_add_u32 s28,s29,0
buffer_load_dwordx4 v20,s[12:15],s28 offen lds
buffer_load_dwordx4 v21,s[12:15],s28 offen offset:1024 lds
buffer_load_dwordx4 v22,s[12:15],s28 offen offset:2048 lds
buffer_load_dwordx4 v23,s[12:15],s28 offen offset:3072 lds
s_add_u32 m0,s69,0
s_mov_b32 s28,0
buffer_load_dwordx4 v24,s[16:19],s28 offen lds
buffer_load_dwordx4 v25,s[16:19],s28 offen offset:1024 lds
buffer_load_dwordx4 v26,s[16:19],s28 offen offset:2048 lds
buffer_load_dwordx4 v27,s[16:19],s28 offen offset:3072 lds
s_add_u32 m0,s25,98304
s_add_u32 s28,s29,262144
buffer_load_dwordx4 v20,s[12:15],s28 offen lds
v_lshl_add_u32 v12,v34,9,v12
v_lshl_add_u32 v13,v34,9,v13
v_lshl_add_u32 v14,v34,9,v14
v_lshl_add_u32 v15,v34,9,v15
s_lshl_b32 s59,s57,4
s_add_u32 s59,s59,s56
s_sub_u32 s54,1,s58
s_lshr_b32 s59,s59,s54
buffer_load_dwordx4 v21,s[12:15],s28 offen offset:1024 lds
s_lshl_b32 s59,s59,20
s_cmp_eq_u32 s58,0
s_cselect_b64 s[4:5],s[34:35],s[44:45]
s_cselect_b64 s[8:9],s[36:37],s[46:47]
s_cselect_b64 s[96:97],s[40:41],s[50:51]
s_add_u32 s4,s4,s59
s_addc_u32 s5,s5,0
s_mov_b32 s6,0x100000
s_mov_b32 s7,0x20000
s_add_u32 s8,s8,s59
s_addc_u32 s9,s9,0
s_mov_b32 s10,0x100000
s_mov_b32 s11,0x20000
buffer_load_dwordx4 v22,s[12:15],s28 offen offset:2048 lds
v_lshrrev_b32 v36,2,v33
v_lshl_add_u32 v36,v32,2,v36
v_and_b32 v38,3,v33
v_and_b32 v39,7,v36
v_lshlrev_b32 v36,9,v36
v_xor_b32 v37,0,v39
v_lshlrev_b32 v37,5,v37
v_lshl_add_u32 v37,v38,3,v37
buffer_load_dwordx4 v23,s[12:15],s28 offen offset:3072 lds
v_add_u32 v37,v37,v36
v_add_u32 v4,65536,v37
v_xor_b32 v37,1,v39
v_lshlrev_b32 v37,5,v37
v_lshl_add_u32 v37,v38,3,v37
v_add_u32 v37,v37,v36
v_add_u32 v5,65536,v37
v_xor_b32 v37,2,v39
s_add_u32 m0,s25,16384
s_add_u32 s28,s29,524288
buffer_load_dwordx4 v20,s[12:15],s28 offen lds
v_lshlrev_b32 v37,5,v37
v_lshl_add_u32 v37,v38,3,v37
v_add_u32 v37,v37,v36
v_add_u32 v6,65536,v37
v_xor_b32 v37,3,v39
v_lshlrev_b32 v37,5,v37
v_lshl_add_u32 v37,v38,3,v37
v_add_u32 v37,v37,v36
buffer_load_dwordx4 v21,s[12:15],s28 offen offset:1024 lds
v_add_u32 v7,65536,v37
v_xor_b32 v37,4,v39
v_lshlrev_b32 v37,5,v37
v_lshl_add_u32 v37,v38,3,v37
v_add_u32 v37,v37,v36
v_add_u32 v8,65536,v37
v_xor_b32 v37,5,v39
v_lshlrev_b32 v37,5,v37
buffer_load_dwordx4 v22,s[12:15],s28 offen offset:2048 lds
v_lshl_add_u32 v37,v38,3,v37
v_add_u32 v37,v37,v36
v_add_u32 v9,65536,v37
v_xor_b32 v37,6,v39
v_lshlrev_b32 v37,5,v37
v_lshl_add_u32 v37,v38,3,v37
v_add_u32 v37,v37,v36
v_add_u32 v10,65536,v37
buffer_load_dwordx4 v23,s[12:15],s28 offen offset:3072 lds
v_xor_b32 v37,7,v39
v_lshlrev_b32 v37,5,v37
v_lshl_add_u32 v37,v38,3,v37
v_add_u32 v37,v37,v36
v_add_u32 v11,65536,v37
v_lshlrev_b32 v39,1,v39
v_add_u32 v36,49152,v36
v_add_u32 v37,0,v38
s_add_u32 m0,s69,24576
s_mov_b32 s28,128
buffer_load_dwordx4 v24,s[16:19],s28 offen lds
v_xor_b32 v37,v37,v39
v_lshl_add_u32 v16,v37,4,v36
v_add_u32 v37,4,v38
v_xor_b32 v37,v37,v39
v_lshl_add_u32 v17,v37,4,v36
v_add_u32 v37,8,v38
v_xor_b32 v37,v37,v39
v_lshl_add_u32 v18,v37,4,v36
buffer_load_dwordx4 v25,s[16:19],s28 offen offset:1024 lds
v_add_u32 v37,12,v38
v_xor_b32 v37,v37,v39
v_lshl_add_u32 v19,v37,4,v36
v_lshrrev_b32 v37,1,v33
v_xor_b32 v37,v37,v32
v_lshlrev_b32 v36,7,v33
v_add_u32 v36,s69,v36
v_lshl_add_u32 v44,v37,4,v36
buffer_load_dwordx4 v26,s[16:19],s28 offen offset:2048 lds
v_xor_b32 v37,4,v37
v_lshl_add_u32 v45,v37,4,v36
v_and_b32 v36,7,v33
v_lshlrev_b32 v36,1,v36
v_add_u32 v37,0,v32
v_xor_b32 v37,v37,v36
v_lshlrev_b32 v37,4,v37
v_lshl_add_u32 v0,v33,9,v37
buffer_load_dwordx4 v27,s[16:19],s28 offen offset:3072 lds
v_add_u32 v37,4,v32
v_xor_b32 v37,v37,v36
v_lshlrev_b32 v37,4,v37
v_lshl_add_u32 v1,v33,9,v37
v_add_u32 v37,8,v32
v_xor_b32 v37,v37,v36
v_lshlrev_b32 v37,4,v37
v_lshl_add_u32 v2,v33,9,v37
s_add_u32 m0,s25,65536
s_add_u32 s28,s29,786432
buffer_load_dwordx4 v20,s[12:15],s28 offen lds
v_add_u32 v37,12,v32
v_xor_b32 v37,v37,v36
v_lshlrev_b32 v37,4,v37
v_lshl_add_u32 v3,v33,9,v37
s_mov_b32 s30,0
s_mov_b32 s60,0x3db8aa3b
s_mov_b32 s61,s60
s_mul_i32 s62,s24,688128
buffer_load_dwordx4 v21,s[12:15],s28 offen offset:1024 lds
s_add_u32 s63,s62,229376
s_add_u32 s64,s62,458752
s_mul_i32 s67,s24,28672
s_lshl_b32 s54,s58,3
s_add_u32 s54,s54,s57
s_lshl_b32 s68,s54,4
s_add_u32 s68,s68,s56
s_lshl_b32 s68,s68,10
buffer_load_dwordx4 v22,s[12:15],s28 offen offset:2048 lds
s_add_u32 s68,50331648,s68
s_mul_i32 s55,s24,192
s_add_u32 s68,s68,s55
s_mul_i32 s54,s54,2523136
s_mul_i32 s55,s56,1024
s_add_u32 s54,s54,s55
s_sub_u32 s68,s68,s54
s_add_u32 s20,s52,s54
s_addc_u32 s21,s53,0
buffer_load_dwordx4 v23,s[12:15],s28 offen offset:3072 lds
s_mov_b32 s22,67108864
s_mov_b32 s23,0x20000
s_mul_i32 s54,s56,229376
s_add_u32 s96,s96,s54
s_addc_u32 s97,s97,0
s_mov_b32 s98,229376
s_mov_b32 s99,0x20000
s_mov_b64 s[32:33],s[12:13]
s_mov_b64 s[34:35],s[14:15]
s_add_u32 m0,s25,32768
s_add_u32 s28,s29,1048576
buffer_load_dwordx4 v20,s[12:15],s28 offen lds
s_mov_b32 s36,0
s_add_u32 s37,s25,49152
s_add_u32 s38,s25,81920
s_add_u32 s40,s29,1310720
s_add_u32 s39,s29,1572864
s_mov_b32 s41,524288
s_mov_b32 s42,256
s_mov_b32 s43,s69
buffer_load_dwordx4 v21,s[12:15],s28 offen offset:1024 lds
s_mov_b32 s45,24576
s_mov_b32 s46,16384
v_mov_b64 v[64:65],0
v_mov_b64 v[66:67],0
v_mov_b64 v[68:69],0
v_mov_b64 v[70:71],0
v_mov_b64 v[72:73],0
v_mov_b64 v[74:75],0
buffer_load_dwordx4 v22,s[12:15],s28 offen offset:2048 lds
v_mov_b64 v[76:77],0
v_mov_b64 v[78:79],0
v_mov_b64 v[80:81],0
v_mov_b64 v[82:83],0
v_mov_b64 v[84:85],0
v_mov_b64 v[86:87],0
v_mov_b64 v[88:89],0
v_mov_b64 v[90:91],0
buffer_load_dwordx4 v23,s[12:15],s28 offen offset:3072 lds
v_mov_b64 v[92:93],0
v_mov_b64 v[94:95],0
v_mov_b64 v[96:97],0
v_mov_b64 v[98:99],0
v_mov_b64 v[100:101],0
v_mov_b64 v[102:103],0
v_mov_b64 v[104:105],0
v_mov_b64 v[106:107],0
s_mov_b32 m0,s25
s_nop 0
buffer_load_dwordx4 v12,s[4:7],s25 offen nt lds
v_mov_b64 v[108:109],0
v_mov_b64 v[110:111],0
v_mov_b64 v[112:113],0
v_mov_b64 v[114:115],0
v_mov_b64 v[116:117],0
v_mov_b64 v[118:119],0
v_mov_b64 v[120:121],0
v_mov_b64 v[122:123],0
buffer_load_dwordx4 v13,s[4:7],s25 offen offset:1024 nt lds
v_mov_b64 v[124:125],0
v_mov_b64 v[126:127],0
v_mov_b64 v[128:129],0
v_mov_b64 v[130:131],0
v_mov_b64 v[132:133],0
v_mov_b64 v[134:135],0
v_mov_b64 v[136:137],0
v_mov_b64 v[138:139],0
buffer_load_dwordx4 v14,s[4:7],s25 offen offset:2048 nt lds
v_mov_b64 v[140:141],0
v_mov_b64 v[142:143],0
v_mov_b64 v[144:145],0
v_mov_b64 v[146:147],0
v_mov_b64 v[148:149],0
v_mov_b64 v[150:151],0
v_mov_b64 v[152:153],0
v_mov_b64 v[154:155],0
buffer_load_dwordx4 v15,s[4:7],s25 offen offset:3072 nt lds
v_mov_b64 v[156:157],0
v_mov_b64 v[158:159],0
v_mov_b64 v[160:161],0
v_mov_b64 v[162:163],0
v_mov_b64 v[164:165],0
v_mov_b64 v[166:167],0
v_mov_b64 v[168:169],0
v_mov_b64 v[170:171],0
v_mov_b64 v[172:173],0
v_mov_b64 v[174:175],0
v_mov_b64 v[176:177],0
v_mov_b64 v[178:179],0
v_mov_b64 v[180:181],0
v_mov_b64 v[182:183],0
v_mov_b64 v[184:185],0
v_mov_b64 v[186:187],0
v_mov_b64 v[188:189],0
v_mov_b64 v[190:191],0
s_waitcnt vmcnt(24)
s_barrier
ds_read_b128 a[0:3],v44 offset:0
ds_read_b128 a[4:7],v44 offset:2048
ds_read_b64_tr_b16 a[192:193],v16 offset:0
ds_read_b64_tr_b16 a[194:195],v16 offset:8192
ds_read_b64_tr_b16 a[196:197],v16 offset:8
ds_read_b64_tr_b16 a[198:199],v16 offset:8200
ds_read_b64_tr_b16 a[200:201],v17 offset:0
ds_read_b64_tr_b16 a[202:203],v17 offset:8192
ds_read_b64_tr_b16 a[204:205],v17 offset:8
ds_read_b64_tr_b16 a[206:207],v17 offset:8200
ds_read_b64_tr_b16 a[208:209],v18 offset:0
ds_read_b64_tr_b16 a[210:211],v18 offset:8192
s_waitcnt lgkmcnt(8)
v_add_u32 v44,24576,v44
QLOOP_B:
s_waitcnt vmcnt(20)
s_barrier
s_mov_b32 m0,s38
v_mfma_f32_16x16x32_bf16 v[64:67],a[192:195],a[0:3],v[64:67]
ds_read_b128 a[12:15],v45 offset:0
ds_read_b64_tr_b16 a[212:213],v18 offset:8
ds_read_b64_tr_b16 a[214:215],v18 offset:8200
v_mfma_f32_16x16x32_bf16 v[128:131],a[192:195],a[4:7],v[128:131]
buffer_load_dwordx4 v20,s[32:35],s40 offen lds
s_waitcnt lgkmcnt(9)
v_mfma_f32_16x16x32_bf16 v[68:71],a[196:199],a[0:3],v[68:71]
ds_read_b128 a[16:19],v45 offset:2048
ds_read_b64_tr_b16 a[216:217],v19 offset:0
ds_read_b64_tr_b16 a[218:219],v19 offset:8192
v_mfma_f32_16x16x32_bf16 v[132:135],a[196:199],a[4:7],v[132:135]
buffer_load_dwordx4 v21,s[32:35],s40 offen offset:1024 lds
s_waitcnt lgkmcnt(10)
v_mfma_f32_16x16x32_bf16 v[72:75],a[200:203],a[0:3],v[72:75]
ds_read_b64_tr_b16 a[220:221],v19 offset:8
ds_read_b64_tr_b16 a[222:223],v19 offset:8200
v_mfma_f32_16x16x32_bf16 v[136:139],a[200:203],a[4:7],v[136:139]
buffer_load_dwordx4 v22,s[32:35],s40 offen offset:2048 lds
s_waitcnt lgkmcnt(10)
v_mfma_f32_16x16x32_bf16 v[76:79],a[204:207],a[0:3],v[76:79]
v_add_u32 v45,s45,v45
ds_read_b64_tr_b16 a[192:193],v16 offset:256
ds_read_b64_tr_b16 a[194:195],v16 offset:8448
v_mfma_f32_16x16x32_bf16 v[140:143],a[204:207],a[4:7],v[140:143]
buffer_load_dwordx4 v23,s[32:35],s40 offen offset:3072 lds
s_waitcnt lgkmcnt(10)
v_mfma_f32_16x16x32_bf16 v[80:83],a[208:211],a[0:3],v[80:83]
s_mov_b32 m0,s43
ds_read_b64_tr_b16 a[196:197],v16 offset:264
ds_read_b64_tr_b16 a[198:199],v16 offset:8456
v_mfma_f32_16x16x32_bf16 v[144:147],a[208:211],a[4:7],v[144:147]
s_waitcnt lgkmcnt(9)
v_mfma_f32_16x16x32_bf16 v[84:87],a[212:215],a[0:3],v[84:87]
ds_read_b64_tr_b16 a[200:201],v17 offset:256
ds_read_b64_tr_b16 a[202:203],v17 offset:8448
v_mfma_f32_16x16x32_bf16 v[148:151],a[212:215],a[4:7],v[148:151]
s_waitcnt lgkmcnt(8)
v_mfma_f32_16x16x32_bf16 v[88:91],a[216:219],a[0:3],v[88:91]
ds_read_b64_tr_b16 a[204:205],v17 offset:264
ds_read_b64_tr_b16 a[206:207],v17 offset:8456
v_mfma_f32_16x16x32_bf16 v[152:155],a[216:219],a[4:7],v[152:155]
s_waitcnt lgkmcnt(8)
v_mfma_f32_16x16x32_bf16 v[92:95],a[220:223],a[0:3],v[92:95]
s_waitcnt lgkmcnt(12)
ds_read_b64_tr_b16 a[208:209],v18 offset:256
ds_read_b64_tr_b16 a[210:211],v18 offset:8448
v_mfma_f32_16x16x32_bf16 v[156:159],a[220:223],a[4:7],v[156:159]
buffer_load_dwordx4 v24,s[16:19],s42 offen lds
s_waitcnt lgkmcnt(8)
v_mfma_f32_16x16x32_bf16 v[96:99],a[192:195],a[0:3],v[96:99]
ds_read_b64_tr_b16 a[212:213],v18 offset:264
ds_read_b64_tr_b16 a[214:215],v18 offset:8456
v_mfma_f32_16x16x32_bf16 v[160:163],a[192:195],a[4:7],v[160:163]
buffer_load_dwordx4 v25,s[16:19],s42 offen offset:1024 lds
s_waitcnt lgkmcnt(8)
v_mfma_f32_16x16x32_bf16 v[100:103],a[196:199],a[0:3],v[100:103]
ds_read_b64_tr_b16 a[216:217],v19 offset:256
ds_read_b64_tr_b16 a[218:219],v19 offset:8448
v_mfma_f32_16x16x32_bf16 v[164:167],a[196:199],a[4:7],v[164:167]
buffer_load_dwordx4 v26,s[16:19],s42 offen offset:2048 lds
s_waitcnt lgkmcnt(8)
v_mfma_f32_16x16x32_bf16 v[104:107],a[200:203],a[0:3],v[104:107]
ds_read_b64_tr_b16 a[220:221],v19 offset:264
ds_read_b64_tr_b16 a[222:223],v19 offset:8456
v_mfma_f32_16x16x32_bf16 v[168:171],a[200:203],a[4:7],v[168:171]
buffer_load_dwordx4 v27,s[16:19],s42 offen offset:3072 lds
s_waitcnt lgkmcnt(8)
v_mfma_f32_16x16x32_bf16 v[108:111],a[204:207],a[0:3],v[108:111]
ds_read_b64_tr_b16 a[192:193],v16 offset:49152
ds_read_b64_tr_b16 a[194:195],v16 offset:57344
v_mfma_f32_16x16x32_bf16 v[172:175],a[204:207],a[4:7],v[172:175]
s_waitcnt lgkmcnt(8)
v_mfma_f32_16x16x32_bf16 v[112:115],a[208:211],a[0:3],v[112:115]
ds_read_b64_tr_b16 a[196:197],v16 offset:49160
ds_read_b64_tr_b16 a[198:199],v16 offset:57352
v_mfma_f32_16x16x32_bf16 v[176:179],a[208:211],a[4:7],v[176:179]
s_waitcnt lgkmcnt(8)
v_mfma_f32_16x16x32_bf16 v[116:119],a[212:215],a[0:3],v[116:119]
ds_read_b64_tr_b16 a[200:201],v17 offset:49152
ds_read_b64_tr_b16 a[202:203],v17 offset:57344
v_mfma_f32_16x16x32_bf16 v[180:183],a[212:215],a[4:7],v[180:183]
s_waitcnt lgkmcnt(8)
v_mfma_f32_16x16x32_bf16 v[120:123],a[216:219],a[0:3],v[120:123]
ds_read_b64_tr_b16 a[204:205],v17 offset:49160
ds_read_b64_tr_b16 a[206:207],v17 offset:57352
v_mfma_f32_16x16x32_bf16 v[184:187],a[216:219],a[4:7],v[184:187]
s_waitcnt lgkmcnt(8)
v_mfma_f32_16x16x32_bf16 v[124:127],a[220:223],a[0:3],v[124:127]
ds_read_b64_tr_b16 a[208:209],v18 offset:49152
ds_read_b64_tr_b16 a[210:211],v18 offset:57344
v_mfma_f32_16x16x32_bf16 v[188:191],a[220:223],a[4:7],v[188:191]
s_waitcnt lgkmcnt(8)
s_cmp_eq_u32 s36,4
s_cbranch_scc0 QSW_B
s_mov_b64 s[12:13],s[4:5]
s_mov_b32 s14,s6
s_mov_b64 s[32:33],s[8:9]
s_mov_b32 s34,s10
s_mov_b32 s41,16384
s_add_u32 s39,s25,16384
s_sub_u32 s40,s25,16384
s_mov_b32 s18,0
v_mov_b32 v20,v12
v_mov_b32 v21,v13
v_mov_b32 v22,v14
v_mov_b32 v23,v15
QSW_B:
s_waitcnt vmcnt(20)
s_barrier
s_mov_b32 m0,s37
v_mfma_f32_16x16x32_bf16 v[64:67],a[192:195],a[12:15],v[64:67]
s_cmp_ge_u32 s37,49152
ds_read_b64_tr_b16 a[212:213],v18 offset:49160
ds_read_b64_tr_b16 a[214:215],v18 offset:57352
v_mfma_f32_16x16x32_bf16 v[128:131],a[192:195],a[16:19],v[128:131]
buffer_load_dwordx4 v20,s[12:15],s39 offen lds
s_waitcnt lgkmcnt(8)
v_mfma_f32_16x16x32_bf16 v[68:71],a[196:199],a[12:15],v[68:71]
s_cselect_b32 s44,0xffff8000,s46
ds_read_b64_tr_b16 a[216:217],v19 offset:49152
ds_read_b64_tr_b16 a[218:219],v19 offset:57344
v_mfma_f32_16x16x32_bf16 v[132:135],a[196:199],a[16:19],v[132:135]
buffer_load_dwordx4 v21,s[12:15],s39 offen offset:1024 lds
s_waitcnt lgkmcnt(8)
v_mfma_f32_16x16x32_bf16 v[72:75],a[200:203],a[12:15],v[72:75]
s_add_u32 s38,s37,49152
ds_read_b64_tr_b16 a[220:221],v19 offset:49160
ds_read_b64_tr_b16 a[222:223],v19 offset:57352
v_mfma_f32_16x16x32_bf16 v[136:139],a[200:203],a[16:19],v[136:139]
buffer_load_dwordx4 v22,s[12:15],s39 offen offset:2048 lds
s_waitcnt lgkmcnt(8)
v_mfma_f32_16x16x32_bf16 v[76:79],a[204:207],a[12:15],v[76:79]
s_add_u32 s37,s37,s44
ds_read_b64_tr_b16 a[192:193],v16 offset:49408
ds_read_b64_tr_b16 a[194:195],v16 offset:57600
v_mfma_f32_16x16x32_bf16 v[140:143],a[204:207],a[16:19],v[140:143]
buffer_load_dwordx4 v23,s[12:15],s39 offen offset:3072 lds
s_waitcnt lgkmcnt(8)
v_mfma_f32_16x16x32_bf16 v[80:83],a[208:211],a[12:15],v[80:83]
s_add_u32 s39,s39,s41
ds_read_b64_tr_b16 a[196:197],v16 offset:49416
ds_read_b64_tr_b16 a[198:199],v16 offset:57608
v_mfma_f32_16x16x32_bf16 v[144:147],a[208:211],a[16:19],v[144:147]
s_waitcnt lgkmcnt(8)
v_mfma_f32_16x16x32_bf16 v[84:87],a[212:215],a[12:15],v[84:87]
s_add_u32 s40,s40,s41
ds_read_b64_tr_b16 a[200:201],v17 offset:49408
ds_read_b64_tr_b16 a[202:203],v17 offset:57600
v_mfma_f32_16x16x32_bf16 v[148:151],a[212:215],a[16:19],v[148:151]
v_add_u32 v16,s44,v16
s_waitcnt lgkmcnt(8)
v_mfma_f32_16x16x32_bf16 v[88:91],a[216:219],a[12:15],v[88:91]
s_add_u32 s42,s42,128
ds_read_b64_tr_b16 a[204:205],v17 offset:49416
ds_read_b64_tr_b16 a[206:207],v17 offset:57608
v_mfma_f32_16x16x32_bf16 v[152:155],a[216:219],a[16:19],v[152:155]
s_waitcnt lgkmcnt(8)
v_mfma_f32_16x16x32_bf16 v[92:95],a[220:223],a[12:15],v[92:95]
s_add_u32 s43,s43,s45
ds_read_b64_tr_b16 a[208:209],v18 offset:49408
ds_read_b64_tr_b16 a[210:211],v18 offset:57600
v_mfma_f32_16x16x32_bf16 v[156:159],a[220:223],a[16:19],v[156:159]
v_add_u32 v17,s44,v17
s_waitcnt lgkmcnt(8)
v_mfma_f32_16x16x32_bf16 v[96:99],a[192:195],a[12:15],v[96:99]
s_add_u32 s36,s36,1
ds_read_b64_tr_b16 a[212:213],v18 offset:49416
ds_read_b64_tr_b16 a[214:215],v18 offset:57608
v_mfma_f32_16x16x32_bf16 v[160:163],a[192:195],a[16:19],v[160:163]
s_waitcnt lgkmcnt(8)
v_mfma_f32_16x16x32_bf16 v[100:103],a[196:199],a[12:15],v[100:103]
ds_read_b64_tr_b16 a[216:217],v19 offset:49408
ds_read_b64_tr_b16 a[218:219],v19 offset:57600
v_mfma_f32_16x16x32_bf16 v[164:167],a[196:199],a[16:19],v[164:167]
s_waitcnt vmcnt(16)
ds_read_b128 a[0:3],v44 offset:0
s_waitcnt lgkmcnt(9)
v_mfma_f32_16x16x32_bf16 v[104:107],a[200:203],a[12:15],v[104:107]
ds_read_b64_tr_b16 a[220:221],v19 offset:49416
ds_read_b64_tr_b16 a[222:223],v19 offset:57608
v_mfma_f32_16x16x32_bf16 v[168:171],a[200:203],a[16:19],v[168:171]
ds_read_b128 a[4:7],v44 offset:2048
s_waitcnt lgkmcnt(10)
v_mfma_f32_16x16x32_bf16 v[108:111],a[204:207],a[12:15],v[108:111]
ds_read_b64_tr_b16 a[192:193],v16 offset:0
ds_read_b64_tr_b16 a[194:195],v16 offset:8192
v_mfma_f32_16x16x32_bf16 v[172:175],a[204:207],a[16:19],v[172:175]
v_subrev_u32 v44,s45,v44
s_waitcnt lgkmcnt(10)
v_mfma_f32_16x16x32_bf16 v[112:115],a[208:211],a[12:15],v[112:115]
ds_read_b64_tr_b16 a[196:197],v16 offset:8
ds_read_b64_tr_b16 a[198:199],v16 offset:8200
v_mfma_f32_16x16x32_bf16 v[176:179],a[208:211],a[16:19],v[176:179]
s_sub_u32 s45,0,s45
v_add_u32 v18,s44,v18
s_waitcnt lgkmcnt(10)
v_mfma_f32_16x16x32_bf16 v[116:119],a[212:215],a[12:15],v[116:119]
ds_read_b64_tr_b16 a[200:201],v17 offset:0
ds_read_b64_tr_b16 a[202:203],v17 offset:8192
v_mfma_f32_16x16x32_bf16 v[180:183],a[212:215],a[16:19],v[180:183]
v_add_u32 v19,s44,v19
s_waitcnt lgkmcnt(10)
v_mfma_f32_16x16x32_bf16 v[120:123],a[216:219],a[12:15],v[120:123]
ds_read_b64_tr_b16 a[204:205],v17 offset:8
ds_read_b64_tr_b16 a[206:207],v17 offset:8200
v_mfma_f32_16x16x32_bf16 v[184:187],a[216:219],a[16:19],v[184:187]
s_waitcnt lgkmcnt(9)
v_mfma_f32_16x16x32_bf16 v[124:127],a[220:223],a[12:15],v[124:127]
ds_read_b64_tr_b16 a[208:209],v18 offset:0
ds_read_b64_tr_b16 a[210:211],v18 offset:8192
v_mfma_f32_16x16x32_bf16 v[188:191],a[220:223],a[16:19],v[188:191]
s_waitcnt lgkmcnt(8)
s_cmp_lt_u32 s36,7
s_cbranch_scc1 QLOOP_B
v_pk_mul_f32 v[64:65],s[60:61],v[64:65]
v_pk_mul_f32 v[66:67],s[60:61],v[66:67]
v_pk_mul_f32 v[68:69],s[60:61],v[68:69]
v_pk_mul_f32 v[70:71],s[60:61],v[70:71]
v_cvt_pk_bf16_f32 v16,v64,v65
v_cvt_pk_bf16_f32 v17,v66,v67
v_cvt_pk_bf16_f32 v18,v68,v69
v_cvt_pk_bf16_f32 v19,v70,v71
v_pk_mul_f32 v[72:73],s[60:61],v[72:73]
v_pk_mul_f32 v[74:75],s[60:61],v[74:75]
v_pk_mul_f32 v[76:77],s[60:61],v[76:77]
v_pk_mul_f32 v[78:79],s[60:61],v[78:79]
v_cvt_pk_bf16_f32 v20,v72,v73
v_cvt_pk_bf16_f32 v21,v74,v75
v_cvt_pk_bf16_f32 v22,v76,v77
v_cvt_pk_bf16_f32 v23,v78,v79
v_pk_mul_f32 v[80:81],s[60:61],v[80:81]
v_pk_mul_f32 v[82:83],s[60:61],v[82:83]
v_pk_mul_f32 v[84:85],s[60:61],v[84:85]
v_pk_mul_f32 v[86:87],s[60:61],v[86:87]
v_cvt_pk_bf16_f32 v24,v80,v81
v_cvt_pk_bf16_f32 v25,v82,v83
v_cvt_pk_bf16_f32 v26,v84,v85
v_cvt_pk_bf16_f32 v27,v86,v87
v_pk_mul_f32 v[88:89],s[60:61],v[88:89]
v_pk_mul_f32 v[90:91],s[60:61],v[90:91]
v_pk_mul_f32 v[92:93],s[60:61],v[92:93]
v_pk_mul_f32 v[94:95],s[60:61],v[94:95]
v_cvt_pk_bf16_f32 v28,v88,v89
v_cvt_pk_bf16_f32 v29,v90,v91
v_cvt_pk_bf16_f32 v30,v92,v93
v_cvt_pk_bf16_f32 v31,v94,v95
v_pk_mul_f32 v[96:97],s[60:61],v[96:97]
v_pk_mul_f32 v[98:99],s[60:61],v[98:99]
v_pk_mul_f32 v[100:101],s[60:61],v[100:101]
v_pk_mul_f32 v[102:103],s[60:61],v[102:103]
v_cvt_pk_bf16_f32 v32,v96,v97
v_cvt_pk_bf16_f32 v33,v98,v99
v_cvt_pk_bf16_f32 v34,v100,v101
v_cvt_pk_bf16_f32 v35,v102,v103
v_pk_mul_f32 v[104:105],s[60:61],v[104:105]
v_pk_mul_f32 v[106:107],s[60:61],v[106:107]
v_pk_mul_f32 v[108:109],s[60:61],v[108:109]
v_pk_mul_f32 v[110:111],s[60:61],v[110:111]
v_cvt_pk_bf16_f32 v36,v104,v105
v_cvt_pk_bf16_f32 v37,v106,v107
v_cvt_pk_bf16_f32 v38,v108,v109
v_cvt_pk_bf16_f32 v39,v110,v111
v_pk_mul_f32 v[112:113],s[60:61],v[112:113]
v_pk_mul_f32 v[114:115],s[60:61],v[114:115]
v_pk_mul_f32 v[116:117],s[60:61],v[116:117]
v_pk_mul_f32 v[118:119],s[60:61],v[118:119]
v_cvt_pk_bf16_f32 v40,v112,v113
v_cvt_pk_bf16_f32 v41,v114,v115
v_cvt_pk_bf16_f32 v42,v116,v117
v_cvt_pk_bf16_f32 v43,v118,v119
v_pk_mul_f32 v[120:121],s[60:61],v[120:121]
v_pk_mul_f32 v[122:123],s[60:61],v[122:123]
v_pk_mul_f32 v[124:125],s[60:61],v[124:125]
v_pk_mul_f32 v[126:127],s[60:61],v[126:127]
v_cvt_pk_bf16_f32 v44,v120,v121
v_cvt_pk_bf16_f32 v45,v122,v123
v_cvt_pk_bf16_f32 v46,v124,v125
v_cvt_pk_bf16_f32 v47,v126,v127
v_pk_mul_f32 v[128:129],s[60:61],v[128:129]
v_pk_mul_f32 v[130:131],s[60:61],v[130:131]
v_pk_mul_f32 v[132:133],s[60:61],v[132:133]
v_pk_mul_f32 v[134:135],s[60:61],v[134:135]
v_cvt_pk_bf16_f32 v48,v128,v129
v_cvt_pk_bf16_f32 v49,v130,v131
v_cvt_pk_bf16_f32 v50,v132,v133
v_cvt_pk_bf16_f32 v51,v134,v135
v_pk_mul_f32 v[136:137],s[60:61],v[136:137]
v_pk_mul_f32 v[138:139],s[60:61],v[138:139]
v_pk_mul_f32 v[140:141],s[60:61],v[140:141]
v_pk_mul_f32 v[142:143],s[60:61],v[142:143]
v_cvt_pk_bf16_f32 v52,v136,v137
v_cvt_pk_bf16_f32 v53,v138,v139
v_cvt_pk_bf16_f32 v54,v140,v141
v_cvt_pk_bf16_f32 v55,v142,v143
v_pk_mul_f32 v[144:145],s[60:61],v[144:145]
v_pk_mul_f32 v[146:147],s[60:61],v[146:147]
v_pk_mul_f32 v[148:149],s[60:61],v[148:149]
v_pk_mul_f32 v[150:151],s[60:61],v[150:151]
v_cvt_pk_bf16_f32 v56,v144,v145
v_cvt_pk_bf16_f32 v57,v146,v147
v_cvt_pk_bf16_f32 v58,v148,v149
v_cvt_pk_bf16_f32 v59,v150,v151
s_waitcnt lgkmcnt(0)
ds_read_b128 a[192:195],v0 offset:0
ds_read_b128 a[196:199],v1 offset:0
ds_read_b128 a[200:203],v2 offset:0
ds_read_b128 a[204:207],v3 offset:0
ds_read_b128 a[208:211],v0 offset:256
ds_read_b128 a[212:215],v1 offset:256
ds_read_b128 a[216:219],v2 offset:256
ds_read_b128 a[220:223],v3 offset:256
v_pk_mul_f32 v[152:153],s[60:61],v[152:153]
v_pk_mul_f32 v[154:155],s[60:61],v[154:155]
v_pk_mul_f32 v[156:157],s[60:61],v[156:157]
v_pk_mul_f32 v[158:159],s[60:61],v[158:159]
v_cvt_pk_bf16_f32 v60,v152,v153
v_cvt_pk_bf16_f32 v61,v154,v155
v_cvt_pk_bf16_f32 v62,v156,v157
v_cvt_pk_bf16_f32 v63,v158,v159
v_pk_mul_f32 v[160:161],s[60:61],v[160:161]
v_pk_mul_f32 v[162:163],s[60:61],v[162:163]
v_pk_mul_f32 v[164:165],s[60:61],v[164:165]
v_pk_mul_f32 v[166:167],s[60:61],v[166:167]
v_cvt_pk_bf16_f32 v64,v160,v161
v_cvt_pk_bf16_f32 v65,v162,v163
v_cvt_pk_bf16_f32 v66,v164,v165
v_cvt_pk_bf16_f32 v67,v166,v167
v_pk_mul_f32 v[168:169],s[60:61],v[168:169]
v_pk_mul_f32 v[170:171],s[60:61],v[170:171]
v_pk_mul_f32 v[172:173],s[60:61],v[172:173]
v_pk_mul_f32 v[174:175],s[60:61],v[174:175]
v_cvt_pk_bf16_f32 v68,v168,v169
v_cvt_pk_bf16_f32 v69,v170,v171
v_cvt_pk_bf16_f32 v70,v172,v173
v_cvt_pk_bf16_f32 v71,v174,v175
v_pk_mul_f32 v[176:177],s[60:61],v[176:177]
v_pk_mul_f32 v[178:179],s[60:61],v[178:179]
v_pk_mul_f32 v[180:181],s[60:61],v[180:181]
v_pk_mul_f32 v[182:183],s[60:61],v[182:183]
v_cvt_pk_bf16_f32 v72,v176,v177
v_cvt_pk_bf16_f32 v73,v178,v179
v_cvt_pk_bf16_f32 v74,v180,v181
v_cvt_pk_bf16_f32 v75,v182,v183
v_pk_mul_f32 v[184:185],s[60:61],v[184:185]
v_pk_mul_f32 v[186:187],s[60:61],v[186:187]
v_pk_mul_f32 v[188:189],s[60:61],v[188:189]
v_pk_mul_f32 v[190:191],s[60:61],v[190:191]
v_cvt_pk_bf16_f32 v76,v184,v185
v_cvt_pk_bf16_f32 v77,v186,v187
v_cvt_pk_bf16_f32 v78,v188,v189
v_cvt_pk_bf16_f32 v79,v190,v191
v_mov_b32 v208,0x7f800000
v_mov_b32 v212,0x7f800000
v_mbcnt_lo_u32_b32 v253,-1,0
v_mbcnt_hi_u32_b32 v253,-1,v253
s_getpc_b64 s[38:39]
CW0:
s_lshr_b32 s40,s2,3
s_mul_i32 s40,s40,1536
s_add_u32 s38,s38,(M29_A-CW0)&0xffffffff
s_addc_u32 s39,s39,((M29_A-CW0)>>32)&0xffffffff
s_cmp_ge_u32 s40,(M29_A-M29_A+(FALLBACK_A-M29_A+1535)/1536*1536)
s_cselect_b32 s41,M29_B-M29_A-(M29_A-M29_A+(FALLBACK_A-M29_A+1535)/1536*1536),0
s_add_u32 s40,s40,s41
s_cmp_ge_u32 s40,(M29_B-M29_A+(FALLBACK_B-M29_B+1535)/1536*1536)
s_cselect_b32 s41,oproj_kernel-M29_A-(M29_B-M29_A+(FALLBACK_B-M29_B+1535)/1536*1536),0
s_add_u32 s40,s40,s41
v_min_u32 v80,11,v253
v_lshl_add_u32 v80,v80,7,s40
v_min_u32 v80,K2_END-M29_A-4,v80
v_mov_b32 v81,0
v_lshl_add_u64 v[82:83],v[80:81],0,s[38:39]
global_load_dword v111,v[82:83],off
PRE_B:
s_waitcnt lgkmcnt(3)
v_mfma_f32_16x16x32_bf16 v[112:115],a[192:195],v[16:19],0
ds_read_b128 a[224:227],v0 offset:8192
v_mov_b32 v232,0x3f803f80
v_mov_b32 v233,0x3f803f80
v_mov_b32 v234,0x3f803f80
v_mfma_f32_16x16x32_bf16 v[112:115],a[196:199],v[20:23],v[112:115]
ds_read_b128 a[228:231],v1 offset:8192
v_mov_b32 v235,0x3f803f80
v_mbcnt_lo_u32_b32 v253,-1,0
v_mbcnt_hi_u32_b32 v253,-1,v253
v_mfma_f32_16x16x32_bf16 v[112:115],a[200:203],v[24:27],v[112:115]
s_mov_b32 s31,147456
v_lshl_add_u32 v250,v253,4,s31
s_mov_b32 s26,32768
v_mfma_f32_16x16x32_bf16 v[112:115],a[204:207],v[28:31],v[112:115]
ds_read_b128 a[232:235],v2 offset:8192
v_mfma_f32_16x16x32_bf16 v[112:115],a[208:211],v[32:35],v[112:115]
s_waitcnt lgkmcnt(3)
v_mfma_f32_16x16x32_bf16 v[112:115],a[212:215],v[36:39],v[112:115]
ds_read_b128 a[236:239],v3 offset:8192
v_mfma_f32_16x16x32_bf16 v[112:115],a[216:219],v[40:43],v[112:115]
v_mfma_f32_16x16x32_bf16 v[112:115],a[220:223],v[44:47],v[112:115]
ds_read_b128 a[240:243],v0 offset:8448
v_mfma_f32_16x16x32_bf16 v[128:131],a[192:195],v[48:51],0
ds_read_b128 a[244:247],v1 offset:8448
v_mfma_f32_16x16x32_bf16 v[128:131],a[196:199],v[52:55],v[128:131]
v_mfma_f32_16x16x32_bf16 v[128:131],a[200:203],v[56:59],v[128:131]
ds_read_b128 a[248:251],v2 offset:8448
v_mfma_f32_16x16x32_bf16 v[128:131],a[204:207],v[60:63],v[128:131]
v_mfma_f32_16x16x32_bf16 v[128:131],a[208:211],v[64:67],v[128:131]
ds_read_b128 a[252:255],v3 offset:8448
v_mfma_f32_16x16x32_bf16 v[128:131],a[212:215],v[68:71],v[128:131]
v_mfma_f32_16x16x32_bf16 v[128:131],a[216:219],v[72:75],v[128:131]
ds_read_b128 a[192:195],v0 offset:16384
v_max3_f32 v184,-v208,v112,v113
v_max3_f32 v184,v184,v114,v115
v_mov_b32 v188,v184
v_mfma_f32_16x16x32_bf16 v[128:131],a[220:223],v[76:79],v[128:131]
ds_read_b128 a[196:199],v1 offset:16384
s_waitcnt lgkmcnt(4)
v_mfma_f32_16x16x32_bf16 v[116:119],a[224:227],v[16:19],0
v_permlane32_swap_b32 v184,v188
v_mfma_f32_16x16x32_bf16 v[116:119],a[228:231],v[20:23],v[116:119]
ds_read_b128 a[200:203],v2 offset:16384
v_mfma_f32_16x16x32_bf16 v[116:119],a[232:235],v[24:27],v[116:119]
v_max_f32 v184,v184,v188
v_mov_b32 v188,v184
v_mfma_f32_16x16x32_bf16 v[116:119],a[236:239],v[28:31],v[116:119]
ds_read_b128 a[204:207],v3 offset:16384
v_mfma_f32_16x16x32_bf16 v[116:119],a[240:243],v[32:35],v[116:119]
v_permlane16_swap_b32 v184,v188
v_mfma_f32_16x16x32_bf16 v[116:119],a[244:247],v[36:39],v[116:119]
ds_read_b128 a[208:211],v0 offset:16640
s_waitcnt lgkmcnt(4)
v_mfma_f32_16x16x32_bf16 v[116:119],a[248:251],v[40:43],v[116:119]
ds_read_b128 a[212:215],v1 offset:16640
v_max_f32 v184,v184,v188
v_sub_f32 v208,0,v184
v_sub_f32 v209,0,v184
v_mfma_f32_16x16x32_bf16 v[116:119],a[252:255],v[44:47],v[116:119]
v_sub_f32 v210,0,v184
v_sub_f32 v211,0,v184
v_max3_f32 v185,-v212,v128,v129
v_max3_f32 v185,v185,v130,v131
v_mfma_f32_16x16x32_bf16 v[132:135],a[224:227],v[48:51],0
ds_read_b128 a[216:219],v2 offset:16640
v_mov_b32 v189,v185
v_add_f32 v112,v112,v208
v_mfma_f32_16x16x32_bf16 v[132:135],a[228:231],v[52:55],v[132:135]
v_exp_f32 v112,v112
v_add_f32 v113,v113,v208
v_mfma_f32_16x16x32_bf16 v[132:135],a[232:235],v[56:59],v[132:135]
ds_read_b128 a[220:223],v3 offset:16640
v_permlane32_swap_b32 v185,v189
v_exp_f32 v113,v113
v_mfma_f32_16x16x32_bf16 v[132:135],a[236:239],v[60:63],v[132:135]
v_cvt_pk_bf16_f32 v160,v112,v113
v_add_f32 v114,v114,v208
v_exp_f32 v114,v114
v_mfma_f32_16x16x32_bf16 v[132:135],a[240:243],v[64:67],v[132:135]
ds_read_b128 a[224:227],v0 offset:24576
v_max_f32 v185,v185,v189
v_mov_b32 v189,v185
v_mfma_f32_16x16x32_bf16 v[132:135],a[244:247],v[68:71],v[132:135]
ds_read_b128 a[228:231],v1 offset:24576
v_add_f32 v115,v115,v208
v_exp_f32 v115,v115
v_mfma_f32_16x16x32_bf16 v[132:135],a[248:251],v[72:75],v[132:135]
v_permlane16_swap_b32 v185,v189
v_cvt_pk_bf16_f32 v161,v114,v115
v_mfma_f32_16x16x32_bf16 v[132:135],a[252:255],v[76:79],v[132:135]
ds_read_b128 a[232:235],v2 offset:24576
v_mfma_f32_16x16x32_bf16 v[120:123],a[192:195],v[16:19],v[208:211]
v_max_f32 v185,v185,v189
v_sub_f32 v212,0,v185
v_sub_f32 v213,0,v185
s_waitcnt lgkmcnt(4)
v_mfma_f32_16x16x32_bf16 v[120:123],a[196:199],v[20:23],v[120:123]
ds_read_b128 a[236:239],v3 offset:24576
v_sub_f32 v214,0,v185
v_sub_f32 v215,0,v185
v_mfma_f32_16x16x32_bf16 v[120:123],a[200:203],v[24:27],v[120:123]
v_add_f32 v128,v128,v212
v_exp_f32 v128,v128
v_mfma_f32_16x16x32_bf16 v[120:123],a[204:207],v[28:31],v[120:123]
ds_read_b128 a[240:243],v0 offset:24832
v_add_f32 v129,v129,v212
v_exp_f32 v129,v129
v_mfma_f32_16x16x32_bf16 v[120:123],a[208:211],v[32:35],v[120:123]
ds_read_b128 a[244:247],v1 offset:24832
v_cvt_pk_bf16_f32 v176,v128,v129
v_add_f32 v130,v130,v212
v_mfma_f32_16x16x32_bf16 v[120:123],a[212:215],v[36:39],v[120:123]
v_exp_f32 v130,v130
v_add_f32 v131,v131,v212
v_mfma_f32_16x16x32_bf16 v[120:123],a[216:219],v[40:43],v[120:123]
ds_read_b128 a[248:251],v2 offset:24832
v_exp_f32 v131,v131
s_waitcnt lgkmcnt(4)
v_mfma_f32_16x16x32_bf16 v[120:123],a[220:223],v[44:47],v[120:123]
v_cvt_pk_bf16_f32 v177,v130,v131
v_add_f32 v116,v116,v208
v_exp_f32 v116,v116
v_mfma_f32_16x16x32_bf16 v[136:139],a[192:195],v[48:51],v[212:215]
ds_read_b128 a[252:255],v3 offset:24832
v_add_f32 v117,v117,v208
v_exp_f32 v117,v117
v_mfma_f32_16x16x32_bf16 v[136:139],a[196:199],v[52:55],v[136:139]
v_cvt_pk_bf16_f32 v162,v116,v117
v_add_f32 v118,v118,v208
v_exp_f32 v118,v118
v_mfma_f32_16x16x32_bf16 v[136:139],a[200:203],v[56:59],v[136:139]
v_add_f32 v119,v119,v208
v_exp_f32 v119,v119
v_mfma_f32_16x16x32_bf16 v[136:139],a[204:207],v[60:63],v[136:139]
v_cvt_pk_bf16_f32 v163,v118,v119
v_mfma_f32_16x16x32_bf16 v[136:139],a[208:211],v[64:67],v[136:139]
v_add_f32 v132,v132,v212
v_exp_f32 v132,v132
v_mfma_f32_16x16x32_bf16 v[136:139],a[212:215],v[68:71],v[136:139]
v_mfma_f32_16x16x32_bf16 v[136:139],a[216:219],v[72:75],v[136:139]
s_waitcnt lgkmcnt(0)
s_waitcnt vmcnt(1)
s_barrier
v_mfma_f32_16x16x32_bf16 v[136:139],a[220:223],v[76:79],v[136:139]
ds_read_b128 a[192:195],v0 offset:32768
s_mov_b32 m0,12288
s_mov_b32 s28,77824
v_mfma_f32_16x16x32_bf16 v[124:127],a[224:227],v[16:19],v[208:211]
buffer_load_dwordx4 v12,s[4:7],s28 offen nt lds
buffer_load_dwordx4 v13,s[4:7],s28 offen offset:1024 nt lds
v_mfma_f32_16x16x32_bf16 v[124:127],a[228:231],v[20:23],v[124:127]
ds_read_b128 a[196:199],v1 offset:32768
buffer_load_dwordx4 v14,s[4:7],s28 offen offset:2048 nt lds
v_add_f32 v133,v133,v212
v_mfma_f32_16x16x32_bf16 v[124:127],a[232:235],v[24:27],v[124:127]
buffer_load_dwordx4 v15,s[4:7],s28 offen offset:3072 nt lds
s_mov_b32 m0,16384
s_waitcnt lgkmcnt(2)
v_mfma_f32_16x16x32_bf16 v[124:127],a[236:239],v[28:31],v[124:127]
ds_read_b128 a[200:203],v2 offset:32768
s_mov_b32 s28,81920
buffer_load_dwordx4 v12,s[4:7],s28 offen nt lds
v_mfma_f32_16x16x32_bf16 v[124:127],a[240:243],v[32:35],v[124:127]
buffer_load_dwordx4 v13,s[4:7],s28 offen offset:1024 nt lds
buffer_load_dwordx4 v14,s[4:7],s28 offen offset:2048 nt lds
v_mfma_f32_16x16x32_bf16 v[124:127],a[244:247],v[36:39],v[124:127]
ds_read_b128 a[204:207],v3 offset:32768
buffer_load_dwordx4 v15,s[4:7],s28 offen offset:3072 nt lds
s_mov_b32 m0,20480
v_mfma_f32_16x16x32_bf16 v[124:127],a[248:251],v[40:43],v[124:127]
s_mov_b32 s28,86016
buffer_load_dwordx4 v12,s[4:7],s28 offen nt lds
v_exp_f32 v133,v133
v_mfma_f32_16x16x32_bf16 v[124:127],a[252:255],v[44:47],v[124:127]
ds_read_b128 a[208:211],v0 offset:33024
buffer_load_dwordx4 v13,s[4:7],s28 offen offset:1024 nt lds
v_cvt_pk_bf16_f32 v178,v132,v133
v_mfma_f32_16x16x32_bf16 v[140:143],a[224:227],v[48:51],v[212:215]
buffer_load_dwordx4 v14,s[4:7],s28 offen offset:2048 nt lds
buffer_load_dwordx4 v15,s[4:7],s28 offen offset:3072 nt lds
v_mfma_f32_16x16x32_bf16 v[140:143],a[228:231],v[52:55],v[140:143]
s_mov_b32 m0,24576
s_mov_b32 s28,90112
buffer_load_dwordx4 v12,s[4:7],s28 offen nt lds
v_mfma_f32_16x16x32_bf16 v[140:143],a[232:235],v[56:59],v[140:143]
ds_read_b128 a[212:215],v1 offset:33024
buffer_load_dwordx4 v13,s[4:7],s28 offen offset:1024 nt lds
v_add_f32 v134,v134,v212
v_mfma_f32_16x16x32_bf16 v[140:143],a[236:239],v[60:63],v[140:143]
buffer_load_dwordx4 v14,s[4:7],s28 offen offset:2048 nt lds
buffer_load_dwordx4 v15,s[4:7],s28 offen offset:3072 nt lds
v_mfma_f32_16x16x32_bf16 v[140:143],a[240:243],v[64:67],v[140:143]
ds_read_b128 a[216:219],v2 offset:33024
s_mov_b32 m0,28672
s_mov_b32 s28,94208
v_exp_f32 v134,v134
v_mfma_f32_16x16x32_bf16 v[140:143],a[244:247],v[68:71],v[140:143]
buffer_load_dwordx4 v12,s[4:7],s28 offen nt lds
buffer_load_dwordx4 v13,s[4:7],s28 offen offset:1024 nt lds
v_mfma_f32_16x16x32_bf16 v[140:143],a[248:251],v[72:75],v[140:143]
ds_read_b128 a[220:223],v3 offset:33024
buffer_load_dwordx4 v14,s[4:7],s28 offen offset:2048 nt lds
v_add_f32 v135,v135,v212
v_exp_f32 v135,v135
v_mfma_f32_16x16x32_bf16 v[140:143],a[252:255],v[76:79],v[140:143]
buffer_load_dwordx4 v15,s[4:7],s28 offen offset:3072 nt lds
v_cvt_pk_bf16_f32 v179,v134,v135
M0_B:
s_waitcnt lgkmcnt(3)
v_mfma_f32_16x16x32_bf16 v[112:115],a[192:195],v[16:19],v[208:211]
ds_read_b128 a[224:227],v0 offset:40960
s_mov_b32 m0,98304
s_mov_b32 s28,32768
v_mfma_f32_16x16x32_bf16 v[112:115],a[196:199],v[20:23],v[112:115]
ds_read_b128 a[228:231],v1 offset:40960
buffer_load_dwordx4 v12,s[8:11],s28 offen nt lds
v_mfma_f32_16x16x32_bf16 v[112:115],a[200:203],v[24:27],v[112:115]
buffer_load_dwordx4 v13,s[8:11],s28 offen offset:1024 nt lds
buffer_load_dwordx4 v14,s[8:11],s28 offen offset:2048 nt lds
v_mfma_f32_16x16x32_bf16 v[112:115],a[204:207],v[28:31],v[112:115]
ds_read_b128 a[232:235],v2 offset:40960
buffer_load_dwordx4 v15,s[8:11],s28 offen offset:3072 nt lds
s_mov_b32 m0,102400
v_mfma_f32_16x16x32_bf16 v[112:115],a[208:211],v[32:35],v[112:115]
s_mov_b32 s28,36864
buffer_load_dwordx4 v12,s[8:11],s28 offen nt lds
s_waitcnt lgkmcnt(4)
v_mfma_f32_16x16x32_bf16 v[112:115],a[212:215],v[36:39],v[112:115]
ds_read_b128 a[236:239],v3 offset:40960
buffer_load_dwordx4 v13,s[8:11],s28 offen offset:1024 nt lds
v_mfma_f32_16x16x32_bf16 v[112:115],a[216:219],v[40:43],v[112:115]
buffer_load_dwordx4 v14,s[8:11],s28 offen offset:2048 nt lds
s_waitcnt lgkmcnt(4)
v_mfma_f32_16x16x32_bf16 v[112:115],a[220:223],v[44:47],v[112:115]
ds_read_b128 a[240:243],v0 offset:41216
buffer_load_dwordx4 v15,s[8:11],s28 offen offset:3072 nt lds
s_mov_b32 m0,106496
v_mfma_f32_16x16x32_bf16 v[128:131],a[192:195],v[48:51],v[212:215]
ds_read_b128 a[244:247],v1 offset:41216
s_mov_b32 s28,40960
buffer_load_dwordx4 v12,s[8:11],s28 offen nt lds
v_mfma_f32_16x16x32_bf16 v[128:131],a[196:199],v[52:55],v[128:131]
buffer_load_dwordx4 v13,s[8:11],s28 offen offset:1024 nt lds
buffer_load_dwordx4 v14,s[8:11],s28 offen offset:2048 nt lds
v_mfma_f32_16x16x32_bf16 v[128:131],a[200:203],v[56:59],v[128:131]
ds_read_b128 a[248:251],v2 offset:41216
buffer_load_dwordx4 v15,s[8:11],s28 offen offset:3072 nt lds
s_mov_b32 m0,110592
v_mfma_f32_16x16x32_bf16 v[128:131],a[204:207],v[60:63],v[128:131]
s_mov_b32 s28,45056
buffer_load_dwordx4 v12,s[8:11],s28 offen nt lds
v_mfma_f32_16x16x32_bf16 v[128:131],a[208:211],v[64:67],v[128:131]
ds_read_b128 a[252:255],v3 offset:41216
buffer_load_dwordx4 v13,s[8:11],s28 offen offset:1024 nt lds
v_mfma_f32_16x16x32_bf16 v[128:131],a[212:215],v[68:71],v[128:131]
buffer_load_dwordx4 v14,s[8:11],s28 offen offset:2048 nt lds
buffer_load_dwordx4 v15,s[8:11],s28 offen offset:3072 nt lds
v_mfma_f32_16x16x32_bf16 v[128:131],a[216:219],v[72:75],v[128:131]
ds_read_b128 a[192:195],v0 offset:49152
s_mov_b32 m0,114688
s_mov_b32 s28,49152
v_mfma_f32_16x16x32_bf16 v[128:131],a[220:223],v[76:79],v[128:131]
ds_read_b128 a[196:199],v1 offset:49152
buffer_load_dwordx4 v12,s[8:11],s28 offen nt lds
s_waitcnt lgkmcnt(4)
v_mfma_f32_16x16x32_bf16 v[116:119],a[224:227],v[16:19],v[208:211]
buffer_load_dwordx4 v13,s[8:11],s28 offen offset:1024 nt lds
buffer_load_dwordx4 v14,s[8:11],s28 offen offset:2048 nt lds
v_mfma_f32_16x16x32_bf16 v[116:119],a[228:231],v[20:23],v[116:119]
ds_read_b128 a[200:203],v2 offset:49152
buffer_load_dwordx4 v15,s[8:11],s28 offen offset:3072 nt lds
s_mov_b32 m0,118784
v_mfma_f32_16x16x32_bf16 v[116:119],a[232:235],v[24:27],v[116:119]
s_mov_b32 s28,53248
buffer_load_dwordx4 v12,s[8:11],s28 offen nt lds
v_mfma_f32_16x16x32_bf16 v[116:119],a[236:239],v[28:31],v[116:119]
ds_read_b128 a[204:207],v3 offset:49152
buffer_load_dwordx4 v13,s[8:11],s28 offen offset:1024 nt lds
v_exp_f32 v123,v123
v_mfma_f32_16x16x32_bf16 v[116:119],a[240:243],v[32:35],v[116:119]
buffer_load_dwordx4 v14,s[8:11],s28 offen offset:2048 nt lds
buffer_load_dwordx4 v15,s[8:11],s28 offen offset:3072 nt lds
v_mfma_f32_16x16x32_bf16 v[116:119],a[244:247],v[36:39],v[116:119]
ds_read_b128 a[208:211],v0 offset:49408
s_mov_b32 m0,122880
s_mov_b32 s28,57344
s_waitcnt lgkmcnt(4)
v_mfma_f32_16x16x32_bf16 v[116:119],a[248:251],v[40:43],v[116:119]
ds_read_b128 a[212:215],v1 offset:49408
buffer_load_dwordx4 v12,s[8:11],s28 offen nt lds
v_mfma_f32_16x16x32_bf16 v[116:119],a[252:255],v[44:47],v[116:119]
buffer_load_dwordx4 v13,s[8:11],s28 offen offset:1024 nt lds
buffer_load_dwordx4 v14,s[8:11],s28 offen offset:2048 nt lds
v_mfma_f32_16x16x32_bf16 v[132:135],a[224:227],v[48:51],v[212:215]
ds_read_b128 a[216:219],v2 offset:49408
buffer_load_dwordx4 v15,s[8:11],s28 offen offset:3072 nt lds
s_mov_b32 m0,126976
v_mfma_f32_16x16x32_bf16 v[132:135],a[228:231],v[52:55],v[132:135]
s_mov_b32 s28,61440
buffer_load_dwordx4 v12,s[8:11],s28 offen nt lds
v_mfma_f32_16x16x32_bf16 v[132:135],a[232:235],v[56:59],v[132:135]
ds_read_b128 a[220:223],v3 offset:49408
buffer_load_dwordx4 v13,s[8:11],s28 offen offset:1024 nt lds
v_exp_f32 v143,v143
v_mfma_f32_16x16x32_bf16 v[132:135],a[236:239],v[60:63],v[132:135]
buffer_load_dwordx4 v14,s[8:11],s28 offen offset:2048 nt lds
buffer_load_dwordx4 v15,s[8:11],s28 offen offset:3072 nt lds
v_mfma_f32_16x16x32_bf16 v[132:135],a[240:243],v[64:67],v[132:135]
ds_read_b128 a[224:227],v0 offset:57344
v_exp_f32 v120,v120
v_exp_f32 v142,v142
v_mfma_f32_16x16x32_bf16 v[132:135],a[244:247],v[68:71],v[132:135]
ds_read_b128 a[228:231],v1 offset:57344
v_exp_f32 v121,v121
v_exp_f32 v141,v141
v_mfma_f32_16x16x32_bf16 v[132:135],a[248:251],v[72:75],v[132:135]
v_cvt_pk_bf16_f32 v164,v120,v121
v_exp_f32 v122,v122
v_exp_f32 v140,v140
v_mfma_f32_16x16x32_bf16 v[132:135],a[252:255],v[76:79],v[132:135]
ds_read_b128 a[232:235],v2 offset:57344
v_cvt_pk_bf16_f32 v165,v122,v123
v_exp_f32 v136,v136
v_mfma_f32_16x16x32_bf16 v[120:123],a[192:195],v[16:19],v[208:211]
v_exp_f32 v137,v137
v_exp_f32 v127,v127
s_waitcnt lgkmcnt(4)
v_mfma_f32_16x16x32_bf16 v[120:123],a[196:199],v[20:23],v[120:123]
ds_read_b128 a[236:239],v3 offset:57344
v_cvt_pk_bf16_f32 v180,v136,v137
v_exp_f32 v138,v138
v_mfma_f32_16x16x32_bf16 v[120:123],a[200:203],v[24:27],v[120:123]
v_exp_f32 v139,v139
v_exp_f32 v124,v124
v_mfma_f32_16x16x32_bf16 v[120:123],a[204:207],v[28:31],v[120:123]
ds_read_b128 a[240:243],v0 offset:57600
v_cvt_pk_bf16_f32 v181,v138,v139
v_exp_f32 v125,v125
v_mfma_f32_16x16x32_bf16 v[120:123],a[208:211],v[32:35],v[120:123]
ds_read_b128 a[244:247],v1 offset:57600
v_cvt_pk_bf16_f32 v166,v124,v125
v_exp_f32 v126,v126
v_mfma_f32_16x16x32_bf16 v[120:123],a[212:215],v[36:39],v[120:123]
v_cvt_pk_bf16_f32 v167,v126,v127
v_cvt_pk_bf16_f32 v182,v140,v141
v_cvt_pk_bf16_f32 v183,v142,v143
v_mfma_f32_16x16x32_bf16 v[120:123],a[216:219],v[40:43],v[120:123]
ds_read_b128 a[248:251],v2 offset:57600
v_exp_f32 v112,v112
s_waitcnt lgkmcnt(4)
v_mfma_f32_16x16x32_bf16 v[120:123],a[220:223],v[44:47],v[120:123]
v_mfma_f32_16x16x32_bf16 v[136:139],a[192:195],v[48:51],v[212:215]
ds_read_b128 a[252:255],v3 offset:57600
v_mfma_f32_16x16x32_bf16 v[136:139],a[196:199],v[52:55],v[136:139]
v_exp_f32 v113,v113
v_mfma_f32_16x16x32_bf16 v[136:139],a[200:203],v[56:59],v[136:139]
v_cvt_pk_bf16_f32 v168,v112,v113
v_mfma_f32_16x16x32_bf16 v[136:139],a[204:207],v[60:63],v[136:139]
v_mfma_f32_16x16x32_bf16 v[136:139],a[208:211],v[64:67],v[136:139]
v_mfma_f32_16x16x32_bf16 v[136:139],a[212:215],v[68:71],v[136:139]
v_exp_f32 v114,v114
v_mfma_f32_16x16x32_bf16 v[136:139],a[216:219],v[72:75],v[136:139]
s_waitcnt lgkmcnt(0)
s_waitcnt vmcnt(61)
s_barrier
v_mfma_f32_16x16x32_bf16 v[136:139],a[220:223],v[76:79],v[136:139]
ds_read_b64_tr_b16 a[192:193],v4 offset:0
ds_read_b64_tr_b16 a[194:195],v4 offset:8192
s_mov_b32 m0,45056
s_mov_b32 s28,110592
v_mfma_f32_16x16x32_bf16 v[124:127],a[224:227],v[16:19],v[208:211]
buffer_load_dwordx4 v12,s[4:7],s28 offen nt lds
buffer_load_dwordx4 v13,s[4:7],s28 offen offset:1024 nt lds
v_mfma_f32_16x16x32_bf16 v[124:127],a[228:231],v[20:23],v[124:127]
ds_read_b64_tr_b16 a[196:197],v4 offset:16384
ds_read_b64_tr_b16 a[198:199],v4 offset:24576
buffer_load_dwordx4 v14,s[4:7],s28 offen offset:2048 nt lds
v_mfma_f32_16x16x32_bf16 v[124:127],a[232:235],v[24:27],v[124:127]
buffer_load_dwordx4 v15,s[4:7],s28 offen offset:3072 nt lds
s_mov_b32 m0,61440
s_waitcnt lgkmcnt(4)
v_mfma_f32_16x16x32_bf16 v[124:127],a[236:239],v[28:31],v[124:127]
ds_read_b64_tr_b16 a[200:201],v5 offset:0
ds_read_b64_tr_b16 a[202:203],v5 offset:8192
s_mov_b32 s28,126976
v_mfma_f32_16x16x32_bf16 v[124:127],a[240:243],v[32:35],v[124:127]
buffer_load_dwordx4 v12,s[4:7],s28 offen nt lds
buffer_load_dwordx4 v13,s[4:7],s28 offen offset:1024 nt lds
v_mfma_f32_16x16x32_bf16 v[124:127],a[244:247],v[36:39],v[124:127]
ds_read_b64_tr_b16 a[204:205],v5 offset:16384
ds_read_b64_tr_b16 a[206:207],v5 offset:24576
buffer_load_dwordx4 v14,s[4:7],s28 offen offset:2048 nt lds
v_mfma_f32_16x16x32_bf16 v[124:127],a[248:251],v[40:43],v[124:127]
buffer_load_dwordx4 v15,s[4:7],s28 offen offset:3072 nt lds
v_exp_f32 v115,v115
v_mfma_f32_16x16x32_bf16 v[124:127],a[252:255],v[44:47],v[124:127]
ds_read_b64_tr_b16 a[208:209],v6 offset:0
ds_read_b64_tr_b16 a[210:211],v6 offset:8192
v_cvt_pk_bf16_f32 v169,v114,v115
v_mfma_f32_16x16x32_bf16 v[140:143],a[224:227],v[48:51],v[212:215]
v_exp_f32 v128,v128
v_mfma_f32_16x16x32_bf16 v[140:143],a[228:231],v[52:55],v[140:143]
ds_read_b64_tr_b16 a[212:213],v6 offset:16384
ds_read_b64_tr_b16 a[214:215],v6 offset:24576
v_exp_f32 v129,v129
v_mfma_f32_16x16x32_bf16 v[140:143],a[232:235],v[56:59],v[140:143]
v_cvt_pk_bf16_f32 v184,v128,v129
v_mfma_f32_16x16x32_bf16 v[140:143],a[236:239],v[60:63],v[140:143]
ds_read_b64_tr_b16 a[216:217],v7 offset:0
ds_read_b64_tr_b16 a[218:219],v7 offset:8192
v_mfma_f32_16x16x32_bf16 v[140:143],a[240:243],v[64:67],v[140:143]
v_exp_f32 v130,v130
v_mfma_f32_16x16x32_bf16 v[140:143],a[244:247],v[68:71],v[140:143]
ds_read_b64_tr_b16 a[220:221],v7 offset:16384
ds_read_b64_tr_b16 a[222:223],v7 offset:24576
v_mfma_f32_16x16x32_bf16 v[140:143],a[248:251],v[72:75],v[140:143]
v_mfma_f32_16x16x32_bf16 v[140:143],a[252:255],v[76:79],v[140:143]
ds_read_b64_tr_b16 a[224:225],v8 offset:0
ds_read_b64_tr_b16 a[226:227],v8 offset:8192
v_exp_f32 v131,v131
v_mfma_f32_16x16x32_bf16 v[220:223],v[232:235],v[160:163],0
v_cvt_pk_bf16_f32 v185,v130,v131
v_mfma_f32_16x16x32_bf16 v[220:223],v[232:235],v[164:167],v[220:223]
ds_read_b64_tr_b16 a[228:229],v8 offset:16384
ds_read_b64_tr_b16 a[230:231],v8 offset:24576
v_mfma_f32_16x16x32_bf16 v[224:227],v[232:235],v[176:179],0
v_exp_f32 v116,v116
v_mfma_f32_16x16x32_bf16 v[224:227],v[232:235],v[180:183],v[224:227]
ds_read_b64_tr_b16 a[232:233],v9 offset:0
ds_read_b64_tr_b16 a[234:235],v9 offset:8192
s_waitcnt lgkmcnt(8)
v_mfma_f32_16x16x32_bf16 a[0:3],a[192:195],v[160:163],0
v_mfma_f32_16x16x32_bf16 a[0:3],a[196:199],v[164:167],a[0:3]
ds_read_b64_tr_b16 a[236:237],v9 offset:16384
ds_read_b64_tr_b16 a[238:239],v9 offset:24576
v_exp_f32 v117,v117
v_mfma_f32_16x16x32_bf16 a[64:67],a[192:195],v[176:179],0
v_cvt_pk_bf16_f32 v170,v116,v117
v_mfma_f32_16x16x32_bf16 a[64:67],a[196:199],v[180:183],a[64:67]
ds_read_b64_tr_b16 a[240:241],v10 offset:0
ds_read_b64_tr_b16 a[242:243],v10 offset:8192
v_mfma_f32_16x16x32_bf16 a[4:7],a[200:203],v[160:163],0
v_exp_f32 v118,v118
v_mfma_f32_16x16x32_bf16 a[4:7],a[204:207],v[164:167],a[4:7]
ds_read_b64_tr_b16 a[244:245],v10 offset:16384
ds_read_b64_tr_b16 a[246:247],v10 offset:24576
v_mfma_f32_16x16x32_bf16 a[68:71],a[200:203],v[176:179],0
v_mfma_f32_16x16x32_bf16 a[68:71],a[204:207],v[180:183],a[68:71]
ds_read_b64_tr_b16 a[248:249],v11 offset:0
ds_read_b64_tr_b16 a[250:251],v11 offset:8192
v_exp_f32 v119,v119
v_mfma_f32_16x16x32_bf16 a[8:11],a[208:211],v[160:163],0
v_cvt_pk_bf16_f32 v171,v118,v119
v_mfma_f32_16x16x32_bf16 a[8:11],a[212:215],v[164:167],a[8:11]
ds_read_b64_tr_b16 a[252:253],v11 offset:16384
ds_read_b64_tr_b16 a[254:255],v11 offset:24576
v_mfma_f32_16x16x32_bf16 a[72:75],a[208:211],v[176:179],0
ds_read_b64_tr_b16 a[192:193],v4 offset:256
ds_read_b64_tr_b16 a[194:195],v4 offset:8448
v_exp_f32 v132,v132
v_mfma_f32_16x16x32_bf16 a[72:75],a[212:215],v[180:183],a[72:75]
v_mfma_f32_16x16x32_bf16 a[12:15],a[216:219],v[160:163],0
ds_read_b64_tr_b16 a[196:197],v4 offset:16640
ds_read_b64_tr_b16 a[198:199],v4 offset:24832
s_waitcnt lgkmcnt(8)
v_mfma_f32_16x16x32_bf16 a[12:15],a[220:223],v[164:167],a[12:15]
v_exp_f32 v133,v133
v_mfma_f32_16x16x32_bf16 a[76:79],a[216:219],v[176:179],0
ds_read_b64_tr_b16 a[200:201],v5 offset:256
ds_read_b64_tr_b16 a[202:203],v5 offset:8448
v_cvt_pk_bf16_f32 v186,v132,v133
v_mfma_f32_16x16x32_bf16 a[76:79],a[220:223],v[180:183],a[76:79]
v_mfma_f32_16x16x32_bf16 a[16:19],a[224:227],v[160:163],0
ds_read_b64_tr_b16 a[204:205],v5 offset:16640
ds_read_b64_tr_b16 a[206:207],v5 offset:24832
v_exp_f32 v134,v134
v_mfma_f32_16x16x32_bf16 a[16:19],a[228:231],v[164:167],a[16:19]
v_mfma_f32_16x16x32_bf16 a[80:83],a[224:227],v[176:179],0
ds_read_b64_tr_b16 a[208:209],v6 offset:256
ds_read_b64_tr_b16 a[210:211],v6 offset:8448
v_mfma_f32_16x16x32_bf16 a[80:83],a[228:231],v[180:183],a[80:83]
v_exp_f32 v135,v135
v_mfma_f32_16x16x32_bf16 a[20:23],a[232:235],v[160:163],0
ds_read_b64_tr_b16 a[212:213],v6 offset:16640
ds_read_b64_tr_b16 a[214:215],v6 offset:24832
v_cvt_pk_bf16_f32 v187,v134,v135
v_mfma_f32_16x16x32_bf16 a[20:23],a[236:239],v[164:167],a[20:23]
v_mfma_f32_16x16x32_bf16 a[84:87],a[232:235],v[176:179],0
ds_read_b64_tr_b16 a[216:217],v7 offset:256
ds_read_b64_tr_b16 a[218:219],v7 offset:8448
v_exp_f32 v120,v120
v_mfma_f32_16x16x32_bf16 a[84:87],a[236:239],v[180:183],a[84:87]
v_mfma_f32_16x16x32_bf16 a[24:27],a[240:243],v[160:163],0
ds_read_b64_tr_b16 a[220:221],v7 offset:16640
ds_read_b64_tr_b16 a[222:223],v7 offset:24832
v_mfma_f32_16x16x32_bf16 a[24:27],a[244:247],v[164:167],a[24:27]
v_exp_f32 v121,v121
v_mfma_f32_16x16x32_bf16 a[88:91],a[240:243],v[176:179],0
ds_read_b64_tr_b16 a[224:225],v8 offset:256
ds_read_b64_tr_b16 a[226:227],v8 offset:8448
v_cvt_pk_bf16_f32 v172,v120,v121
v_mfma_f32_16x16x32_bf16 a[88:91],a[244:247],v[180:183],a[88:91]
s_waitcnt lgkmcnt(6)
v_mfma_f32_16x16x32_bf16 a[28:31],a[248:251],v[160:163],0
ds_read_b64_tr_b16 a[228:229],v8 offset:16640
ds_read_b64_tr_b16 a[230:231],v8 offset:24832
v_exp_f32 v122,v122
v_mfma_f32_16x16x32_bf16 a[28:31],a[252:255],v[164:167],a[28:31]
v_mfma_f32_16x16x32_bf16 a[92:95],a[248:251],v[176:179],0
ds_read_b64_tr_b16 a[232:233],v9 offset:256
ds_read_b64_tr_b16 a[234:235],v9 offset:8448
v_mfma_f32_16x16x32_bf16 a[92:95],a[252:255],v[180:183],a[92:95]
v_exp_f32 v123,v123
v_mfma_f32_16x16x32_bf16 a[32:35],a[192:195],v[160:163],0
ds_read_b64_tr_b16 a[236:237],v9 offset:16640
ds_read_b64_tr_b16 a[238:239],v9 offset:24832
v_cvt_pk_bf16_f32 v173,v122,v123
v_mfma_f32_16x16x32_bf16 a[32:35],a[196:199],v[164:167],a[32:35]
v_mfma_f32_16x16x32_bf16 a[96:99],a[192:195],v[176:179],0
ds_read_b64_tr_b16 a[240:241],v10 offset:256
ds_read_b64_tr_b16 a[242:243],v10 offset:8448
v_exp_f32 v136,v136
v_mfma_f32_16x16x32_bf16 a[96:99],a[196:199],v[180:183],a[96:99]
v_mfma_f32_16x16x32_bf16 a[36:39],a[200:203],v[160:163],0
ds_read_b64_tr_b16 a[244:245],v10 offset:16640
ds_read_b64_tr_b16 a[246:247],v10 offset:24832
v_exp_f32 v137,v137
v_mfma_f32_16x16x32_bf16 a[36:39],a[204:207],v[164:167],a[36:39]
v_cvt_pk_bf16_f32 v188,v136,v137
v_mfma_f32_16x16x32_bf16 a[100:103],a[200:203],v[176:179],0
ds_read_b64_tr_b16 a[248:249],v11 offset:256
ds_read_b64_tr_b16 a[250:251],v11 offset:8448
v_mfma_f32_16x16x32_bf16 a[100:103],a[204:207],v[180:183],a[100:103]
v_exp_f32 v138,v138
v_mfma_f32_16x16x32_bf16 a[40:43],a[208:211],v[160:163],0
ds_read_b64_tr_b16 a[252:253],v11 offset:16640
ds_read_b64_tr_b16 a[254:255],v11 offset:24832
v_mfma_f32_16x16x32_bf16 a[40:43],a[212:215],v[164:167],a[40:43]
v_mfma_f32_16x16x32_bf16 a[104:107],a[208:211],v[176:179],0
v_exp_f32 v139,v139
v_mfma_f32_16x16x32_bf16 a[104:107],a[212:215],v[180:183],a[104:107]
v_cvt_pk_bf16_f32 v189,v138,v139
s_waitcnt lgkmcnt(4)
v_mfma_f32_16x16x32_bf16 a[44:47],a[216:219],v[160:163],0
v_mfma_f32_16x16x32_bf16 a[44:47],a[220:223],v[164:167],a[44:47]
v_exp_f32 v124,v124
v_exp_f32 v125,v125
v_mfma_f32_16x16x32_bf16 a[108:111],a[216:219],v[176:179],0
v_cvt_pk_bf16_f32 v174,v124,v125
s_waitcnt lgkmcnt(0)
s_waitcnt vmcnt(40)
s_barrier
v_mfma_f32_16x16x32_bf16 a[108:111],a[220:223],v[180:183],a[108:111]
ds_read_b128 a[192:195],v0 offset:0
s_mov_b32 m0,77824
s_mov_b32 s28,77824
v_mfma_f32_16x16x32_bf16 a[48:51],a[224:227],v[160:163],0
buffer_load_dwordx4 v12,s[8:11],s28 offen nt lds
buffer_load_dwordx4 v13,s[8:11],s28 offen offset:1024 nt lds
v_mfma_f32_16x16x32_bf16 a[48:51],a[228:231],v[164:167],a[48:51]
ds_read_b128 a[196:199],v1 offset:0
buffer_load_dwordx4 v14,s[8:11],s28 offen offset:2048 nt lds
v_mfma_f32_16x16x32_bf16 a[112:115],a[224:227],v[176:179],0
buffer_load_dwordx4 v15,s[8:11],s28 offen offset:3072 nt lds
s_mov_b32 m0,94208
s_mov_b32 s28,94208
v_mfma_f32_16x16x32_bf16 a[112:115],a[228:231],v[180:183],a[112:115]
ds_read_b128 a[200:203],v2 offset:0
buffer_load_dwordx4 v12,s[8:11],s28 offen nt lds
v_mfma_f32_16x16x32_bf16 a[52:55],a[232:235],v[160:163],0
buffer_load_dwordx4 v13,s[8:11],s28 offen offset:1024 nt lds
buffer_load_dwordx4 v14,s[8:11],s28 offen offset:2048 nt lds
v_mfma_f32_16x16x32_bf16 a[52:55],a[236:239],v[164:167],a[52:55]
ds_read_b128 a[204:207],v3 offset:0
buffer_load_dwordx4 v15,s[8:11],s28 offen offset:3072 nt lds
v_mfma_f32_16x16x32_bf16 a[116:119],a[232:235],v[176:179],0
v_exp_f32 v126,v126
v_mfma_f32_16x16x32_bf16 a[116:119],a[236:239],v[180:183],a[116:119]
v_mfma_f32_16x16x32_bf16 a[56:59],a[240:243],v[160:163],0
ds_read_b128 a[208:211],v0 offset:256
v_mfma_f32_16x16x32_bf16 a[56:59],a[244:247],v[164:167],a[56:59]
v_exp_f32 v127,v127
v_mfma_f32_16x16x32_bf16 a[120:123],a[240:243],v[176:179],0
ds_read_b128 a[212:215],v1 offset:256
v_cvt_pk_bf16_f32 v175,v126,v127
v_mfma_f32_16x16x32_bf16 a[120:123],a[244:247],v[180:183],a[120:123]
s_waitcnt lgkmcnt(6)
v_mfma_f32_16x16x32_bf16 a[60:63],a[248:251],v[160:163],0
ds_read_b128 a[216:219],v2 offset:256
v_mfma_f32_16x16x32_bf16 a[60:63],a[252:255],v[164:167],a[60:63]
v_mfma_f32_16x16x32_bf16 a[124:127],a[248:251],v[176:179],0
ds_read_b128 a[220:223],v3 offset:256
v_mfma_f32_16x16x32_bf16 a[124:127],a[252:255],v[180:183],a[124:127]
LOOP_B:
s_waitcnt lgkmcnt(3)
v_mfma_f32_16x16x32_bf16 v[112:115],a[192:195],v[16:19],v[208:211]
ds_read_b128 a[224:227],v0 offset:8192
v_exp_f32 v140,v140
v_mfma_f32_16x16x32_bf16 v[112:115],a[196:199],v[20:23],v[112:115]
ds_read_b128 a[228:231],v1 offset:8192
v_mfma_f32_16x16x32_bf16 v[112:115],a[200:203],v[24:27],v[112:115]
v_mfma_f32_16x16x32_bf16 v[112:115],a[204:207],v[28:31],v[112:115]
ds_read_b128 a[232:235],v2 offset:8192
v_exp_f32 v141,v141
v_mfma_f32_16x16x32_bf16 v[112:115],a[208:211],v[32:35],v[112:115]
v_cvt_pk_bf16_f32 v190,v140,v141
s_waitcnt lgkmcnt(4)
v_mfma_f32_16x16x32_bf16 v[112:115],a[212:215],v[36:39],v[112:115]
ds_read_b128 a[236:239],v3 offset:8192
v_mfma_f32_16x16x32_bf16 v[112:115],a[216:219],v[40:43],v[112:115]
v_exp_f32 v142,v142
s_waitcnt lgkmcnt(4)
v_mfma_f32_16x16x32_bf16 v[112:115],a[220:223],v[44:47],v[112:115]
ds_read_b128 a[240:243],v0 offset:8448
v_mfma_f32_16x16x32_bf16 v[128:131],a[192:195],v[48:51],v[212:215]
ds_read_b128 a[244:247],v1 offset:8448
v_mfma_f32_16x16x32_bf16 v[128:131],a[196:199],v[52:55],v[128:131]
v_exp_f32 v143,v143
v_mfma_f32_16x16x32_bf16 v[128:131],a[200:203],v[56:59],v[128:131]
ds_read_b128 a[248:251],v2 offset:8448
v_cvt_pk_bf16_f32 v191,v142,v143
v_mfma_f32_16x16x32_bf16 v[128:131],a[204:207],v[60:63],v[128:131]
v_mfma_f32_16x16x32_bf16 v[128:131],a[208:211],v[64:67],v[128:131]
ds_read_b128 a[252:255],v3 offset:8448
v_mfma_f32_16x16x32_bf16 v[128:131],a[212:215],v[68:71],v[128:131]
v_mfma_f32_16x16x32_bf16 v[128:131],a[216:219],v[72:75],v[128:131]
ds_read_b128 a[192:195],v0 offset:16384
v_exp_f32 v112,v112
v_mfma_f32_16x16x32_bf16 v[128:131],a[220:223],v[76:79],v[128:131]
ds_read_b128 a[196:199],v1 offset:16384
s_waitcnt lgkmcnt(4)
v_mfma_f32_16x16x32_bf16 v[116:119],a[224:227],v[16:19],v[208:211]
v_exp_f32 v113,v113
v_mfma_f32_16x16x32_bf16 v[116:119],a[228:231],v[20:23],v[116:119]
ds_read_b128 a[200:203],v2 offset:16384
v_cvt_pk_bf16_f32 v160,v112,v113
v_mfma_f32_16x16x32_bf16 v[116:119],a[232:235],v[24:27],v[116:119]
v_mfma_f32_16x16x32_bf16 v[116:119],a[236:239],v[28:31],v[116:119]
ds_read_b128 a[204:207],v3 offset:16384
v_exp_f32 v114,v114
v_mfma_f32_16x16x32_bf16 v[116:119],a[240:243],v[32:35],v[116:119]
v_mfma_f32_16x16x32_bf16 v[116:119],a[244:247],v[36:39],v[116:119]
ds_read_b128 a[208:211],v0 offset:16640
s_waitcnt lgkmcnt(4)
v_mfma_f32_16x16x32_bf16 v[116:119],a[248:251],v[40:43],v[116:119]
ds_read_b128 a[212:215],v1 offset:16640
v_exp_f32 v115,v115
v_mfma_f32_16x16x32_bf16 v[116:119],a[252:255],v[44:47],v[116:119]
v_cvt_pk_bf16_f32 v161,v114,v115
v_mfma_f32_16x16x32_bf16 v[132:135],a[224:227],v[48:51],v[212:215]
ds_read_b128 a[216:219],v2 offset:16640
v_mfma_f32_16x16x32_bf16 v[132:135],a[228:231],v[52:55],v[132:135]
v_exp_f32 v128,v128
v_mfma_f32_16x16x32_bf16 v[132:135],a[232:235],v[56:59],v[132:135]
ds_read_b128 a[220:223],v3 offset:16640
v_mfma_f32_16x16x32_bf16 v[132:135],a[236:239],v[60:63],v[132:135]
v_exp_f32 v129,v129
v_mfma_f32_16x16x32_bf16 v[132:135],a[240:243],v[64:67],v[132:135]
ds_read_b128 a[224:227],v0 offset:24576
v_cvt_pk_bf16_f32 v176,v128,v129
v_mfma_f32_16x16x32_bf16 v[132:135],a[244:247],v[68:71],v[132:135]
ds_read_b128 a[228:231],v1 offset:24576
v_mfma_f32_16x16x32_bf16 v[132:135],a[248:251],v[72:75],v[132:135]
v_exp_f32 v130,v130
v_mfma_f32_16x16x32_bf16 v[132:135],a[252:255],v[76:79],v[132:135]
ds_read_b128 a[232:235],v2 offset:24576
v_mfma_f32_16x16x32_bf16 v[120:123],a[192:195],v[16:19],v[208:211]
s_waitcnt lgkmcnt(4)
v_mfma_f32_16x16x32_bf16 v[120:123],a[196:199],v[20:23],v[120:123]
ds_read_b128 a[236:239],v3 offset:24576
v_exp_f32 v131,v131
v_mfma_f32_16x16x32_bf16 v[120:123],a[200:203],v[24:27],v[120:123]
v_cvt_pk_bf16_f32 v177,v130,v131
v_mfma_f32_16x16x32_bf16 v[120:123],a[204:207],v[28:31],v[120:123]
ds_read_b128 a[240:243],v0 offset:24832
v_mfma_f32_16x16x32_bf16 v[120:123],a[208:211],v[32:35],v[120:123]
ds_read_b128 a[244:247],v1 offset:24832
v_exp_f32 v116,v116
v_mfma_f32_16x16x32_bf16 v[120:123],a[212:215],v[36:39],v[120:123]
v_mfma_f32_16x16x32_bf16 v[120:123],a[216:219],v[40:43],v[120:123]
ds_read_b128 a[248:251],v2 offset:24832
s_waitcnt lgkmcnt(4)
v_mfma_f32_16x16x32_bf16 v[120:123],a[220:223],v[44:47],v[120:123]
v_mfma_f32_16x16x32_bf16 v[136:139],a[192:195],v[48:51],v[212:215]
ds_read_b128 a[252:255],v3 offset:24832
v_mfma_f32_16x16x32_bf16 v[136:139],a[196:199],v[52:55],v[136:139]
v_mfma_f32_16x16x32_bf16 v[136:139],a[200:203],v[56:59],v[136:139]
v_mfma_f32_16x16x32_bf16 v[136:139],a[204:207],v[60:63],v[136:139]
v_exp_f32 v117,v117
v_mfma_f32_16x16x32_bf16 v[136:139],a[208:211],v[64:67],v[136:139]
v_cvt_pk_bf16_f32 v162,v116,v117
v_mfma_f32_16x16x32_bf16 v[136:139],a[212:215],v[68:71],v[136:139]
v_exp_f32 v118,v118
v_mfma_f32_16x16x32_bf16 v[136:139],a[216:219],v[72:75],v[136:139]
s_waitcnt lgkmcnt(0)
s_waitcnt vmcnt(16)
s_barrier
v_mfma_f32_16x16x32_bf16 v[136:139],a[220:223],v[76:79],v[136:139]
ds_read_b64_tr_b16 a[192:193],v4 offset:32768
ds_read_b64_tr_b16 a[194:195],v4 offset:40960
s_mov_b32 m0,12288
s_add_u32 s28,s26,110592
v_mfma_f32_16x16x32_bf16 v[124:127],a[224:227],v[16:19],v[208:211]
buffer_load_dwordx4 v12,s[4:7],s28 offen nt lds
buffer_load_dwordx4 v13,s[4:7],s28 offen offset:1024 nt lds
v_mfma_f32_16x16x32_bf16 v[124:127],a[228:231],v[20:23],v[124:127]
ds_read_b64_tr_b16 a[196:197],v4 offset:49152
ds_read_b64_tr_b16 a[198:199],v4 offset:57344
buffer_load_dwordx4 v14,s[4:7],s28 offen offset:2048 nt lds
v_mfma_f32_16x16x32_bf16 v[124:127],a[232:235],v[24:27],v[124:127]
buffer_load_dwordx4 v15,s[4:7],s28 offen offset:3072 nt lds
s_mov_b32 m0,16384
s_waitcnt lgkmcnt(4)
v_mfma_f32_16x16x32_bf16 v[124:127],a[236:239],v[28:31],v[124:127]
ds_read_b64_tr_b16 a[200:201],v5 offset:32768
ds_read_b64_tr_b16 a[202:203],v5 offset:40960
s_add_u32 s28,s26,114688
v_mfma_f32_16x16x32_bf16 v[124:127],a[240:243],v[32:35],v[124:127]
buffer_load_dwordx4 v12,s[4:7],s28 offen nt lds
buffer_load_dwordx4 v13,s[4:7],s28 offen offset:1024 nt lds
v_mfma_f32_16x16x32_bf16 v[124:127],a[244:247],v[36:39],v[124:127]
ds_read_b64_tr_b16 a[204:205],v5 offset:49152
ds_read_b64_tr_b16 a[206:207],v5 offset:57344
buffer_load_dwordx4 v14,s[4:7],s28 offen offset:2048 nt lds
v_mfma_f32_16x16x32_bf16 v[124:127],a[248:251],v[40:43],v[124:127]
buffer_load_dwordx4 v15,s[4:7],s28 offen offset:3072 nt lds
s_mov_b32 m0,20480
s_add_u32 s28,s26,118784
v_mfma_f32_16x16x32_bf16 v[124:127],a[252:255],v[44:47],v[124:127]
ds_read_b64_tr_b16 a[208:209],v6 offset:32768
ds_read_b64_tr_b16 a[210:211],v6 offset:40960
buffer_load_dwordx4 v12,s[4:7],s28 offen nt lds
v_mfma_f32_16x16x32_bf16 v[140:143],a[224:227],v[48:51],v[212:215]
buffer_load_dwordx4 v13,s[4:7],s28 offen offset:1024 nt lds
buffer_load_dwordx4 v14,s[4:7],s28 offen offset:2048 nt lds
v_mfma_f32_16x16x32_bf16 v[140:143],a[228:231],v[52:55],v[140:143]
ds_read_b64_tr_b16 a[212:213],v6 offset:49152
ds_read_b64_tr_b16 a[214:215],v6 offset:57344
buffer_load_dwordx4 v15,s[4:7],s28 offen offset:3072 nt lds
v_mfma_f32_16x16x32_bf16 v[140:143],a[232:235],v[56:59],v[140:143]
s_mov_b32 m0,24576
s_add_u32 s28,s26,122880
buffer_load_dwordx4 v12,s[4:7],s28 offen nt lds
v_mfma_f32_16x16x32_bf16 v[140:143],a[236:239],v[60:63],v[140:143]
ds_read_b64_tr_b16 a[216:217],v7 offset:32768
ds_read_b64_tr_b16 a[218:219],v7 offset:40960
buffer_load_dwordx4 v13,s[4:7],s28 offen offset:1024 nt lds
v_mfma_f32_16x16x32_bf16 v[140:143],a[240:243],v[64:67],v[140:143]
buffer_load_dwordx4 v14,s[4:7],s28 offen offset:2048 nt lds
buffer_load_dwordx4 v15,s[4:7],s28 offen offset:3072 nt lds
v_mfma_f32_16x16x32_bf16 v[140:143],a[244:247],v[68:71],v[140:143]
ds_read_b64_tr_b16 a[220:221],v7 offset:49152
ds_read_b64_tr_b16 a[222:223],v7 offset:57344
s_mov_b32 m0,28672
s_add_u32 s28,s26,126976
v_mfma_f32_16x16x32_bf16 v[140:143],a[248:251],v[72:75],v[140:143]
buffer_load_dwordx4 v12,s[4:7],s28 offen nt lds
buffer_load_dwordx4 v13,s[4:7],s28 offen offset:1024 nt lds
v_mfma_f32_16x16x32_bf16 v[140:143],a[252:255],v[76:79],v[140:143]
ds_read_b64_tr_b16 a[224:225],v8 offset:32768
ds_read_b64_tr_b16 a[226:227],v8 offset:40960
buffer_load_dwordx4 v14,s[4:7],s28 offen offset:2048 nt lds
v_mfma_f32_16x16x32_bf16 v[220:223],v[232:235],v[168:171],v[220:223]
buffer_load_dwordx4 v15,s[4:7],s28 offen offset:3072 nt lds
v_exp_f32 v119,v119
v_mfma_f32_16x16x32_bf16 v[220:223],v[232:235],v[172:175],v[220:223]
ds_read_b64_tr_b16 a[228:229],v8 offset:49152
ds_read_b64_tr_b16 a[230:231],v8 offset:57344
v_cvt_pk_bf16_f32 v163,v118,v119
v_mfma_f32_16x16x32_bf16 v[224:227],v[232:235],v[184:187],v[224:227]
v_exp_f32 v132,v132
v_mfma_f32_16x16x32_bf16 v[224:227],v[232:235],v[188:191],v[224:227]
ds_read_b64_tr_b16 a[232:233],v9 offset:32768
ds_read_b64_tr_b16 a[234:235],v9 offset:40960
s_waitcnt lgkmcnt(8)
v_mfma_f32_16x16x32_bf16 a[0:3],a[192:195],v[168:171],a[0:3]
v_exp_f32 v133,v133
v_mfma_f32_16x16x32_bf16 a[0:3],a[196:199],v[172:175],a[0:3]
ds_read_b64_tr_b16 a[236:237],v9 offset:49152
ds_read_b64_tr_b16 a[238:239],v9 offset:57344
v_cvt_pk_bf16_f32 v178,v132,v133
v_mfma_f32_16x16x32_bf16 a[64:67],a[192:195],v[184:187],a[64:67]
v_mfma_f32_16x16x32_bf16 a[64:67],a[196:199],v[188:191],a[64:67]
ds_read_b64_tr_b16 a[240:241],v10 offset:32768
ds_read_b64_tr_b16 a[242:243],v10 offset:40960
v_exp_f32 v134,v134
v_mfma_f32_16x16x32_bf16 a[4:7],a[200:203],v[168:171],a[4:7]
v_mfma_f32_16x16x32_bf16 a[4:7],a[204:207],v[172:175],a[4:7]
ds_read_b64_tr_b16 a[244:245],v10 offset:49152
ds_read_b64_tr_b16 a[246:247],v10 offset:57344
v_mfma_f32_16x16x32_bf16 a[68:71],a[200:203],v[184:187],a[68:71]
v_mfma_f32_16x16x32_bf16 a[68:71],a[204:207],v[188:191],a[68:71]
ds_read_b64_tr_b16 a[248:249],v11 offset:32768
ds_read_b64_tr_b16 a[250:251],v11 offset:40960
v_exp_f32 v135,v135
v_mfma_f32_16x16x32_bf16 a[8:11],a[208:211],v[168:171],a[8:11]
v_cvt_pk_bf16_f32 v179,v134,v135
v_mfma_f32_16x16x32_bf16 a[8:11],a[212:215],v[172:175],a[8:11]
ds_read_b64_tr_b16 a[252:253],v11 offset:49152
ds_read_b64_tr_b16 a[254:255],v11 offset:57344
v_mfma_f32_16x16x32_bf16 a[72:75],a[208:211],v[184:187],a[72:75]
ds_read_b64_tr_b16 a[192:193],v4 offset:33024
ds_read_b64_tr_b16 a[194:195],v4 offset:41216
v_mfma_f32_16x16x32_bf16 a[72:75],a[212:215],v[188:191],a[72:75]
v_exp_f32 v120,v120
v_mfma_f32_16x16x32_bf16 a[12:15],a[216:219],v[168:171],a[12:15]
ds_read_b64_tr_b16 a[196:197],v4 offset:49408
ds_read_b64_tr_b16 a[198:199],v4 offset:57600
s_waitcnt lgkmcnt(8)
v_mfma_f32_16x16x32_bf16 a[12:15],a[220:223],v[172:175],a[12:15]
v_mfma_f32_16x16x32_bf16 a[76:79],a[216:219],v[184:187],a[76:79]
ds_read_b64_tr_b16 a[200:201],v5 offset:33024
ds_read_b64_tr_b16 a[202:203],v5 offset:41216
v_exp_f32 v121,v121
v_mfma_f32_16x16x32_bf16 a[76:79],a[220:223],v[188:191],a[76:79]
v_cvt_pk_bf16_f32 v164,v120,v121
v_mfma_f32_16x16x32_bf16 a[16:19],a[224:227],v[168:171],a[16:19]
ds_read_b64_tr_b16 a[204:205],v5 offset:49408
ds_read_b64_tr_b16 a[206:207],v5 offset:57600
v_mfma_f32_16x16x32_bf16 a[16:19],a[228:231],v[172:175],a[16:19]
v_exp_f32 v122,v122
v_mfma_f32_16x16x32_bf16 a[80:83],a[224:227],v[184:187],a[80:83]
ds_read_b64_tr_b16 a[208:209],v6 offset:33024
ds_read_b64_tr_b16 a[210:211],v6 offset:41216
v_mfma_f32_16x16x32_bf16 a[80:83],a[228:231],v[188:191],a[80:83]
v_mfma_f32_16x16x32_bf16 a[20:23],a[232:235],v[168:171],a[20:23]
ds_read_b64_tr_b16 a[212:213],v6 offset:49408
ds_read_b64_tr_b16 a[214:215],v6 offset:57600
v_exp_f32 v123,v123
v_mfma_f32_16x16x32_bf16 a[20:23],a[236:239],v[172:175],a[20:23]
v_cvt_pk_bf16_f32 v165,v122,v123
v_mfma_f32_16x16x32_bf16 a[84:87],a[232:235],v[184:187],a[84:87]
ds_read_b64_tr_b16 a[216:217],v7 offset:33024
ds_read_b64_tr_b16 a[218:219],v7 offset:41216
v_mfma_f32_16x16x32_bf16 a[84:87],a[236:239],v[188:191],a[84:87]
v_exp_f32 v136,v136
v_mfma_f32_16x16x32_bf16 a[24:27],a[240:243],v[168:171],a[24:27]
ds_read_b64_tr_b16 a[220:221],v7 offset:49408
ds_read_b64_tr_b16 a[222:223],v7 offset:57600
v_mfma_f32_16x16x32_bf16 a[24:27],a[244:247],v[172:175],a[24:27]
v_mfma_f32_16x16x32_bf16 a[88:91],a[240:243],v[184:187],a[88:91]
ds_read_b64_tr_b16 a[224:225],v8 offset:33024
ds_read_b64_tr_b16 a[226:227],v8 offset:41216
v_exp_f32 v137,v137
v_mfma_f32_16x16x32_bf16 a[88:91],a[244:247],v[188:191],a[88:91]
v_cvt_pk_bf16_f32 v180,v136,v137
s_waitcnt lgkmcnt(6)
v_mfma_f32_16x16x32_bf16 a[28:31],a[248:251],v[168:171],a[28:31]
ds_read_b64_tr_b16 a[228:229],v8 offset:49408
ds_read_b64_tr_b16 a[230:231],v8 offset:57600
v_mfma_f32_16x16x32_bf16 a[28:31],a[252:255],v[172:175],a[28:31]
v_exp_f32 v138,v138
v_mfma_f32_16x16x32_bf16 a[92:95],a[248:251],v[184:187],a[92:95]
ds_read_b64_tr_b16 a[232:233],v9 offset:33024
ds_read_b64_tr_b16 a[234:235],v9 offset:41216
v_mfma_f32_16x16x32_bf16 a[92:95],a[252:255],v[188:191],a[92:95]
v_mfma_f32_16x16x32_bf16 a[32:35],a[192:195],v[168:171],a[32:35]
ds_read_b64_tr_b16 a[236:237],v9 offset:49408
ds_read_b64_tr_b16 a[238:239],v9 offset:57600
v_exp_f32 v139,v139
v_mfma_f32_16x16x32_bf16 a[32:35],a[196:199],v[172:175],a[32:35]
v_cvt_pk_bf16_f32 v181,v138,v139
v_mfma_f32_16x16x32_bf16 a[96:99],a[192:195],v[184:187],a[96:99]
ds_read_b64_tr_b16 a[240:241],v10 offset:33024
ds_read_b64_tr_b16 a[242:243],v10 offset:41216
v_mfma_f32_16x16x32_bf16 a[96:99],a[196:199],v[188:191],a[96:99]
v_mfma_f32_16x16x32_bf16 a[36:39],a[200:203],v[168:171],a[36:39]
ds_read_b64_tr_b16 a[244:245],v10 offset:49408
ds_read_b64_tr_b16 a[246:247],v10 offset:57600
v_exp_f32 v124,v124
v_mfma_f32_16x16x32_bf16 a[36:39],a[204:207],v[172:175],a[36:39]
v_mfma_f32_16x16x32_bf16 a[100:103],a[200:203],v[184:187],a[100:103]
ds_read_b64_tr_b16 a[248:249],v11 offset:33024
ds_read_b64_tr_b16 a[250:251],v11 offset:41216
v_mfma_f32_16x16x32_bf16 a[100:103],a[204:207],v[188:191],a[100:103]
v_mfma_f32_16x16x32_bf16 a[40:43],a[208:211],v[168:171],a[40:43]
ds_read_b64_tr_b16 a[252:253],v11 offset:49408
ds_read_b64_tr_b16 a[254:255],v11 offset:57600
v_mfma_f32_16x16x32_bf16 a[40:43],a[212:215],v[172:175],a[40:43]
v_mfma_f32_16x16x32_bf16 a[104:107],a[208:211],v[184:187],a[104:107]
v_exp_f32 v125,v125
v_mfma_f32_16x16x32_bf16 a[104:107],a[212:215],v[188:191],a[104:107]
v_cvt_pk_bf16_f32 v166,v124,v125
s_waitcnt lgkmcnt(4)
v_mfma_f32_16x16x32_bf16 a[44:47],a[216:219],v[168:171],a[44:47]
v_mfma_f32_16x16x32_bf16 a[44:47],a[220:223],v[172:175],a[44:47]
v_exp_f32 v126,v126
v_exp_f32 v127,v127
v_mfma_f32_16x16x32_bf16 a[108:111],a[216:219],v[184:187],a[108:111]
v_cvt_pk_bf16_f32 v167,v126,v127
s_waitcnt lgkmcnt(0)
s_waitcnt vmcnt(28)
s_barrier
v_mfma_f32_16x16x32_bf16 a[108:111],a[220:223],v[188:191],a[108:111]
ds_read_b128 a[192:195],v0 offset:32768
s_mov_b32 m0,98304
s_add_u32 s28,s26,65536
v_mfma_f32_16x16x32_bf16 a[48:51],a[224:227],v[168:171],a[48:51]
buffer_load_dwordx4 v12,s[8:11],s28 offen nt lds
buffer_load_dwordx4 v13,s[8:11],s28 offen offset:1024 nt lds
v_mfma_f32_16x16x32_bf16 a[48:51],a[228:231],v[172:175],a[48:51]
ds_read_b128 a[196:199],v1 offset:32768
buffer_load_dwordx4 v14,s[8:11],s28 offen offset:2048 nt lds
v_mfma_f32_16x16x32_bf16 a[112:115],a[224:227],v[184:187],a[112:115]
buffer_load_dwordx4 v15,s[8:11],s28 offen offset:3072 nt lds
s_mov_b32 m0,102400
s_add_u32 s28,s26,69632
v_mfma_f32_16x16x32_bf16 a[112:115],a[228:231],v[188:191],a[112:115]
ds_read_b128 a[200:203],v2 offset:32768
buffer_load_dwordx4 v12,s[8:11],s28 offen nt lds
v_mfma_f32_16x16x32_bf16 a[52:55],a[232:235],v[168:171],a[52:55]
buffer_load_dwordx4 v13,s[8:11],s28 offen offset:1024 nt lds
buffer_load_dwordx4 v14,s[8:11],s28 offen offset:2048 nt lds
v_mfma_f32_16x16x32_bf16 a[52:55],a[236:239],v[172:175],a[52:55]
ds_read_b128 a[204:207],v3 offset:32768
buffer_load_dwordx4 v15,s[8:11],s28 offen offset:3072 nt lds
s_mov_b32 m0,106496
v_mfma_f32_16x16x32_bf16 a[116:119],a[232:235],v[184:187],a[116:119]
s_add_u32 s28,s26,73728
buffer_load_dwordx4 v12,s[8:11],s28 offen nt lds
v_mfma_f32_16x16x32_bf16 a[116:119],a[236:239],v[188:191],a[116:119]
buffer_load_dwordx4 v13,s[8:11],s28 offen offset:1024 nt lds
buffer_load_dwordx4 v14,s[8:11],s28 offen offset:2048 nt lds
v_mfma_f32_16x16x32_bf16 a[56:59],a[240:243],v[168:171],a[56:59]
ds_read_b128 a[208:211],v0 offset:33024
buffer_load_dwordx4 v15,s[8:11],s28 offen offset:3072 nt lds
s_mov_b32 m0,110592
v_mfma_f32_16x16x32_bf16 a[56:59],a[244:247],v[172:175],a[56:59]
s_add_u32 s28,s26,77824
buffer_load_dwordx4 v12,s[8:11],s28 offen nt lds
v_mfma_f32_16x16x32_bf16 a[120:123],a[240:243],v[184:187],a[120:123]
ds_read_b128 a[212:215],v1 offset:33024
buffer_load_dwordx4 v13,s[8:11],s28 offen offset:1024 nt lds
v_mfma_f32_16x16x32_bf16 a[120:123],a[244:247],v[188:191],a[120:123]
buffer_load_dwordx4 v14,s[8:11],s28 offen offset:2048 nt lds
s_waitcnt lgkmcnt(6)
v_mfma_f32_16x16x32_bf16 a[60:63],a[248:251],v[168:171],a[60:63]
ds_read_b128 a[216:219],v2 offset:33024
buffer_load_dwordx4 v15,s[8:11],s28 offen offset:3072 nt lds
s_mov_b32 m0,114688
v_mfma_f32_16x16x32_bf16 a[60:63],a[252:255],v[172:175],a[60:63]
s_add_u32 s28,s26,81920
buffer_load_dwordx4 v12,s[8:11],s28 offen nt lds
v_mfma_f32_16x16x32_bf16 a[124:127],a[248:251],v[184:187],a[124:127]
ds_read_b128 a[220:223],v3 offset:33024
buffer_load_dwordx4 v13,s[8:11],s28 offen offset:1024 nt lds
v_mfma_f32_16x16x32_bf16 a[124:127],a[252:255],v[188:191],a[124:127]
buffer_load_dwordx4 v14,s[8:11],s28 offen offset:2048 nt lds
buffer_load_dwordx4 v15,s[8:11],s28 offen offset:3072 nt lds
s_mov_b32 m0,118784
s_add_u32 s28,s26,86016
buffer_load_dwordx4 v12,s[8:11],s28 offen nt lds
buffer_load_dwordx4 v13,s[8:11],s28 offen offset:1024 nt lds
buffer_load_dwordx4 v14,s[8:11],s28 offen offset:2048 nt lds
buffer_load_dwordx4 v15,s[8:11],s28 offen offset:3072 nt lds
s_mov_b32 m0,122880
s_add_u32 s28,s26,90112
buffer_load_dwordx4 v12,s[8:11],s28 offen nt lds
buffer_load_dwordx4 v13,s[8:11],s28 offen offset:1024 nt lds
buffer_load_dwordx4 v14,s[8:11],s28 offen offset:2048 nt lds
buffer_load_dwordx4 v15,s[8:11],s28 offen offset:3072 nt lds
s_mov_b32 m0,126976
s_add_u32 s28,s26,94208
buffer_load_dwordx4 v12,s[8:11],s28 offen nt lds
buffer_load_dwordx4 v13,s[8:11],s28 offen offset:1024 nt lds
buffer_load_dwordx4 v14,s[8:11],s28 offen offset:2048 nt lds
buffer_load_dwordx4 v15,s[8:11],s28 offen offset:3072 nt lds
s_waitcnt lgkmcnt(3)
v_mfma_f32_16x16x32_bf16 v[112:115],a[192:195],v[16:19],v[208:211]
ds_read_b128 a[224:227],v0 offset:40960
v_exp_f32 v140,v140
v_mfma_f32_16x16x32_bf16 v[112:115],a[196:199],v[20:23],v[112:115]
ds_read_b128 a[228:231],v1 offset:40960
v_mfma_f32_16x16x32_bf16 v[112:115],a[200:203],v[24:27],v[112:115]
v_mfma_f32_16x16x32_bf16 v[112:115],a[204:207],v[28:31],v[112:115]
ds_read_b128 a[232:235],v2 offset:40960
v_exp_f32 v141,v141
v_mfma_f32_16x16x32_bf16 v[112:115],a[208:211],v[32:35],v[112:115]
v_cvt_pk_bf16_f32 v182,v140,v141
s_waitcnt lgkmcnt(4)
v_mfma_f32_16x16x32_bf16 v[112:115],a[212:215],v[36:39],v[112:115]
ds_read_b128 a[236:239],v3 offset:40960
v_mfma_f32_16x16x32_bf16 v[112:115],a[216:219],v[40:43],v[112:115]
v_exp_f32 v142,v142
s_waitcnt lgkmcnt(4)
v_mfma_f32_16x16x32_bf16 v[112:115],a[220:223],v[44:47],v[112:115]
ds_read_b128 a[240:243],v0 offset:41216
v_mfma_f32_16x16x32_bf16 v[128:131],a[192:195],v[48:51],v[212:215]
ds_read_b128 a[244:247],v1 offset:41216
v_mfma_f32_16x16x32_bf16 v[128:131],a[196:199],v[52:55],v[128:131]
v_exp_f32 v143,v143
v_mfma_f32_16x16x32_bf16 v[128:131],a[200:203],v[56:59],v[128:131]
ds_read_b128 a[248:251],v2 offset:41216
v_cvt_pk_bf16_f32 v183,v142,v143
v_mfma_f32_16x16x32_bf16 v[128:131],a[204:207],v[60:63],v[128:131]
v_mfma_f32_16x16x32_bf16 v[128:131],a[208:211],v[64:67],v[128:131]
ds_read_b128 a[252:255],v3 offset:41216
v_mfma_f32_16x16x32_bf16 v[128:131],a[212:215],v[68:71],v[128:131]
v_mfma_f32_16x16x32_bf16 v[128:131],a[216:219],v[72:75],v[128:131]
ds_read_b128 a[192:195],v0 offset:49152
v_exp_f32 v112,v112
v_mfma_f32_16x16x32_bf16 v[128:131],a[220:223],v[76:79],v[128:131]
ds_read_b128 a[196:199],v1 offset:49152
s_waitcnt lgkmcnt(4)
v_mfma_f32_16x16x32_bf16 v[116:119],a[224:227],v[16:19],v[208:211]
v_exp_f32 v113,v113
v_mfma_f32_16x16x32_bf16 v[116:119],a[228:231],v[20:23],v[116:119]
ds_read_b128 a[200:203],v2 offset:49152
v_cvt_pk_bf16_f32 v168,v112,v113
v_mfma_f32_16x16x32_bf16 v[116:119],a[232:235],v[24:27],v[116:119]
v_mfma_f32_16x16x32_bf16 v[116:119],a[236:239],v[28:31],v[116:119]
ds_read_b128 a[204:207],v3 offset:49152
v_exp_f32 v114,v114
v_mfma_f32_16x16x32_bf16 v[116:119],a[240:243],v[32:35],v[116:119]
v_mfma_f32_16x16x32_bf16 v[116:119],a[244:247],v[36:39],v[116:119]
ds_read_b128 a[208:211],v0 offset:49408
s_waitcnt lgkmcnt(4)
v_mfma_f32_16x16x32_bf16 v[116:119],a[248:251],v[40:43],v[116:119]
ds_read_b128 a[212:215],v1 offset:49408
v_exp_f32 v115,v115
v_mfma_f32_16x16x32_bf16 v[116:119],a[252:255],v[44:47],v[116:119]
v_cvt_pk_bf16_f32 v169,v114,v115
v_mfma_f32_16x16x32_bf16 v[132:135],a[224:227],v[48:51],v[212:215]
ds_read_b128 a[216:219],v2 offset:49408
v_mfma_f32_16x16x32_bf16 v[132:135],a[228:231],v[52:55],v[132:135]
v_exp_f32 v128,v128
v_mfma_f32_16x16x32_bf16 v[132:135],a[232:235],v[56:59],v[132:135]
ds_read_b128 a[220:223],v3 offset:49408
v_mfma_f32_16x16x32_bf16 v[132:135],a[236:239],v[60:63],v[132:135]
v_exp_f32 v129,v129
v_mfma_f32_16x16x32_bf16 v[132:135],a[240:243],v[64:67],v[132:135]
ds_read_b128 a[224:227],v0 offset:57344
v_cvt_pk_bf16_f32 v184,v128,v129
v_mfma_f32_16x16x32_bf16 v[132:135],a[244:247],v[68:71],v[132:135]
ds_read_b128 a[228:231],v1 offset:57344
v_mfma_f32_16x16x32_bf16 v[132:135],a[248:251],v[72:75],v[132:135]
v_exp_f32 v130,v130
v_mfma_f32_16x16x32_bf16 v[132:135],a[252:255],v[76:79],v[132:135]
ds_read_b128 a[232:235],v2 offset:57344
v_mfma_f32_16x16x32_bf16 v[120:123],a[192:195],v[16:19],v[208:211]
s_waitcnt lgkmcnt(4)
v_mfma_f32_16x16x32_bf16 v[120:123],a[196:199],v[20:23],v[120:123]
ds_read_b128 a[236:239],v3 offset:57344
v_exp_f32 v131,v131
v_mfma_f32_16x16x32_bf16 v[120:123],a[200:203],v[24:27],v[120:123]
v_cvt_pk_bf16_f32 v185,v130,v131
v_mfma_f32_16x16x32_bf16 v[120:123],a[204:207],v[28:31],v[120:123]
ds_read_b128 a[240:243],v0 offset:57600
v_mfma_f32_16x16x32_bf16 v[120:123],a[208:211],v[32:35],v[120:123]
ds_read_b128 a[244:247],v1 offset:57600
v_exp_f32 v116,v116
v_mfma_f32_16x16x32_bf16 v[120:123],a[212:215],v[36:39],v[120:123]
v_mfma_f32_16x16x32_bf16 v[120:123],a[216:219],v[40:43],v[120:123]
ds_read_b128 a[248:251],v2 offset:57600
s_waitcnt lgkmcnt(4)
v_mfma_f32_16x16x32_bf16 v[120:123],a[220:223],v[44:47],v[120:123]
v_mfma_f32_16x16x32_bf16 v[136:139],a[192:195],v[48:51],v[212:215]
ds_read_b128 a[252:255],v3 offset:57600
v_mfma_f32_16x16x32_bf16 v[136:139],a[196:199],v[52:55],v[136:139]
v_mfma_f32_16x16x32_bf16 v[136:139],a[200:203],v[56:59],v[136:139]
v_mfma_f32_16x16x32_bf16 v[136:139],a[204:207],v[60:63],v[136:139]
v_exp_f32 v117,v117
v_mfma_f32_16x16x32_bf16 v[136:139],a[208:211],v[64:67],v[136:139]
v_cvt_pk_bf16_f32 v170,v116,v117
v_mfma_f32_16x16x32_bf16 v[136:139],a[212:215],v[68:71],v[136:139]
v_exp_f32 v118,v118
v_mfma_f32_16x16x32_bf16 v[136:139],a[216:219],v[72:75],v[136:139]
s_waitcnt lgkmcnt(0)
s_waitcnt vmcnt(52)
s_barrier
v_mfma_f32_16x16x32_bf16 v[136:139],a[220:223],v[76:79],v[136:139]
ds_read_b64_tr_b16 a[192:193],v4 offset:0
ds_read_b64_tr_b16 a[194:195],v4 offset:8192
s_mov_b32 m0,45056
s_add_u32 s28,s26,143360
v_mfma_f32_16x16x32_bf16 v[124:127],a[224:227],v[16:19],v[208:211]
buffer_load_dwordx4 v12,s[4:7],s28 offen nt lds
buffer_load_dwordx4 v13,s[4:7],s28 offen offset:1024 nt lds
v_mfma_f32_16x16x32_bf16 v[124:127],a[228:231],v[20:23],v[124:127]
ds_read_b64_tr_b16 a[196:197],v4 offset:16384
ds_read_b64_tr_b16 a[198:199],v4 offset:24576
buffer_load_dwordx4 v14,s[4:7],s28 offen offset:2048 nt lds
v_mfma_f32_16x16x32_bf16 v[124:127],a[232:235],v[24:27],v[124:127]
buffer_load_dwordx4 v15,s[4:7],s28 offen offset:3072 nt lds
s_mov_b32 m0,49152
s_waitcnt lgkmcnt(4)
v_mfma_f32_16x16x32_bf16 v[124:127],a[236:239],v[28:31],v[124:127]
ds_read_b64_tr_b16 a[200:201],v5 offset:0
ds_read_b64_tr_b16 a[202:203],v5 offset:8192
s_add_u32 s28,s26,147456
v_mfma_f32_16x16x32_bf16 v[124:127],a[240:243],v[32:35],v[124:127]
buffer_load_dwordx4 v12,s[4:7],s28 offen nt lds
buffer_load_dwordx4 v13,s[4:7],s28 offen offset:1024 nt lds
v_mfma_f32_16x16x32_bf16 v[124:127],a[244:247],v[36:39],v[124:127]
ds_read_b64_tr_b16 a[204:205],v5 offset:16384
ds_read_b64_tr_b16 a[206:207],v5 offset:24576
buffer_load_dwordx4 v14,s[4:7],s28 offen offset:2048 nt lds
v_mfma_f32_16x16x32_bf16 v[124:127],a[248:251],v[40:43],v[124:127]
buffer_load_dwordx4 v15,s[4:7],s28 offen offset:3072 nt lds
s_mov_b32 m0,53248
s_add_u32 s28,s26,151552
v_mfma_f32_16x16x32_bf16 v[124:127],a[252:255],v[44:47],v[124:127]
ds_read_b64_tr_b16 a[208:209],v6 offset:0
ds_read_b64_tr_b16 a[210:211],v6 offset:8192
buffer_load_dwordx4 v12,s[4:7],s28 offen nt lds
v_mfma_f32_16x16x32_bf16 v[140:143],a[224:227],v[48:51],v[212:215]
buffer_load_dwordx4 v13,s[4:7],s28 offen offset:1024 nt lds
buffer_load_dwordx4 v14,s[4:7],s28 offen offset:2048 nt lds
v_mfma_f32_16x16x32_bf16 v[140:143],a[228:231],v[52:55],v[140:143]
ds_read_b64_tr_b16 a[212:213],v6 offset:16384
ds_read_b64_tr_b16 a[214:215],v6 offset:24576
buffer_load_dwordx4 v15,s[4:7],s28 offen offset:3072 nt lds
v_mfma_f32_16x16x32_bf16 v[140:143],a[232:235],v[56:59],v[140:143]
s_mov_b32 m0,57344
s_add_u32 s28,s26,155648
buffer_load_dwordx4 v12,s[4:7],s28 offen nt lds
v_mfma_f32_16x16x32_bf16 v[140:143],a[236:239],v[60:63],v[140:143]
ds_read_b64_tr_b16 a[216:217],v7 offset:0
ds_read_b64_tr_b16 a[218:219],v7 offset:8192
buffer_load_dwordx4 v13,s[4:7],s28 offen offset:1024 nt lds
v_mfma_f32_16x16x32_bf16 v[140:143],a[240:243],v[64:67],v[140:143]
buffer_load_dwordx4 v14,s[4:7],s28 offen offset:2048 nt lds
buffer_load_dwordx4 v15,s[4:7],s28 offen offset:3072 nt lds
v_mfma_f32_16x16x32_bf16 v[140:143],a[244:247],v[68:71],v[140:143]
ds_read_b64_tr_b16 a[220:221],v7 offset:16384
ds_read_b64_tr_b16 a[222:223],v7 offset:24576
s_mov_b32 m0,61440
s_add_u32 s28,s26,159744
v_mfma_f32_16x16x32_bf16 v[140:143],a[248:251],v[72:75],v[140:143]
buffer_load_dwordx4 v12,s[4:7],s28 offen nt lds
buffer_load_dwordx4 v13,s[4:7],s28 offen offset:1024 nt lds
v_mfma_f32_16x16x32_bf16 v[140:143],a[252:255],v[76:79],v[140:143]
ds_read_b64_tr_b16 a[224:225],v8 offset:0
ds_read_b64_tr_b16 a[226:227],v8 offset:8192
buffer_load_dwordx4 v14,s[4:7],s28 offen offset:2048 nt lds
v_mfma_f32_16x16x32_bf16 v[220:223],v[232:235],v[160:163],v[220:223]
buffer_load_dwordx4 v15,s[4:7],s28 offen offset:3072 nt lds
v_exp_f32 v119,v119
v_mfma_f32_16x16x32_bf16 v[220:223],v[232:235],v[164:167],v[220:223]
ds_read_b64_tr_b16 a[228:229],v8 offset:16384
ds_read_b64_tr_b16 a[230:231],v8 offset:24576
v_cvt_pk_bf16_f32 v171,v118,v119
v_mfma_f32_16x16x32_bf16 v[224:227],v[232:235],v[176:179],v[224:227]
v_exp_f32 v132,v132
v_mfma_f32_16x16x32_bf16 v[224:227],v[232:235],v[180:183],v[224:227]
ds_read_b64_tr_b16 a[232:233],v9 offset:0
ds_read_b64_tr_b16 a[234:235],v9 offset:8192
s_waitcnt lgkmcnt(8)
v_mfma_f32_16x16x32_bf16 a[0:3],a[192:195],v[160:163],a[0:3]
v_exp_f32 v133,v133
v_mfma_f32_16x16x32_bf16 a[0:3],a[196:199],v[164:167],a[0:3]
ds_read_b64_tr_b16 a[236:237],v9 offset:16384
ds_read_b64_tr_b16 a[238:239],v9 offset:24576
v_cvt_pk_bf16_f32 v186,v132,v133
v_mfma_f32_16x16x32_bf16 a[64:67],a[192:195],v[176:179],a[64:67]
v_mfma_f32_16x16x32_bf16 a[64:67],a[196:199],v[180:183],a[64:67]
ds_read_b64_tr_b16 a[240:241],v10 offset:0
ds_read_b64_tr_b16 a[242:243],v10 offset:8192
v_exp_f32 v134,v134
v_mfma_f32_16x16x32_bf16 a[4:7],a[200:203],v[160:163],a[4:7]
v_mfma_f32_16x16x32_bf16 a[4:7],a[204:207],v[164:167],a[4:7]
ds_read_b64_tr_b16 a[244:245],v10 offset:16384
ds_read_b64_tr_b16 a[246:247],v10 offset:24576
v_mfma_f32_16x16x32_bf16 a[68:71],a[200:203],v[176:179],a[68:71]
v_mfma_f32_16x16x32_bf16 a[68:71],a[204:207],v[180:183],a[68:71]
ds_read_b64_tr_b16 a[248:249],v11 offset:0
ds_read_b64_tr_b16 a[250:251],v11 offset:8192
v_exp_f32 v135,v135
v_mfma_f32_16x16x32_bf16 a[8:11],a[208:211],v[160:163],a[8:11]
v_cvt_pk_bf16_f32 v187,v134,v135
v_mfma_f32_16x16x32_bf16 a[8:11],a[212:215],v[164:167],a[8:11]
ds_read_b64_tr_b16 a[252:253],v11 offset:16384
ds_read_b64_tr_b16 a[254:255],v11 offset:24576
v_mfma_f32_16x16x32_bf16 a[72:75],a[208:211],v[176:179],a[72:75]
ds_read_b64_tr_b16 a[192:193],v4 offset:256
ds_read_b64_tr_b16 a[194:195],v4 offset:8448
v_mfma_f32_16x16x32_bf16 a[72:75],a[212:215],v[180:183],a[72:75]
v_exp_f32 v120,v120
v_mfma_f32_16x16x32_bf16 a[12:15],a[216:219],v[160:163],a[12:15]
ds_read_b64_tr_b16 a[196:197],v4 offset:16640
ds_read_b64_tr_b16 a[198:199],v4 offset:24832
s_waitcnt lgkmcnt(8)
v_mfma_f32_16x16x32_bf16 a[12:15],a[220:223],v[164:167],a[12:15]
v_mfma_f32_16x16x32_bf16 a[76:79],a[216:219],v[176:179],a[76:79]
ds_read_b64_tr_b16 a[200:201],v5 offset:256
ds_read_b64_tr_b16 a[202:203],v5 offset:8448
v_exp_f32 v121,v121
v_mfma_f32_16x16x32_bf16 a[76:79],a[220:223],v[180:183],a[76:79]
v_cvt_pk_bf16_f32 v172,v120,v121
v_mfma_f32_16x16x32_bf16 a[16:19],a[224:227],v[160:163],a[16:19]
ds_read_b64_tr_b16 a[204:205],v5 offset:16640
ds_read_b64_tr_b16 a[206:207],v5 offset:24832
v_mfma_f32_16x16x32_bf16 a[16:19],a[228:231],v[164:167],a[16:19]
v_exp_f32 v122,v122
v_mfma_f32_16x16x32_bf16 a[80:83],a[224:227],v[176:179],a[80:83]
ds_read_b64_tr_b16 a[208:209],v6 offset:256
ds_read_b64_tr_b16 a[210:211],v6 offset:8448
v_mfma_f32_16x16x32_bf16 a[80:83],a[228:231],v[180:183],a[80:83]
v_mfma_f32_16x16x32_bf16 a[20:23],a[232:235],v[160:163],a[20:23]
ds_read_b64_tr_b16 a[212:213],v6 offset:16640
ds_read_b64_tr_b16 a[214:215],v6 offset:24832
v_exp_f32 v123,v123
v_mfma_f32_16x16x32_bf16 a[20:23],a[236:239],v[164:167],a[20:23]
v_cvt_pk_bf16_f32 v173,v122,v123
v_mfma_f32_16x16x32_bf16 a[84:87],a[232:235],v[176:179],a[84:87]
ds_read_b64_tr_b16 a[216:217],v7 offset:256
ds_read_b64_tr_b16 a[218:219],v7 offset:8448
v_mfma_f32_16x16x32_bf16 a[84:87],a[236:239],v[180:183],a[84:87]
v_exp_f32 v136,v136
v_mfma_f32_16x16x32_bf16 a[24:27],a[240:243],v[160:163],a[24:27]
ds_read_b64_tr_b16 a[220:221],v7 offset:16640
ds_read_b64_tr_b16 a[222:223],v7 offset:24832
v_mfma_f32_16x16x32_bf16 a[24:27],a[244:247],v[164:167],a[24:27]
v_mfma_f32_16x16x32_bf16 a[88:91],a[240:243],v[176:179],a[88:91]
ds_read_b64_tr_b16 a[224:225],v8 offset:256
ds_read_b64_tr_b16 a[226:227],v8 offset:8448
v_exp_f32 v137,v137
v_mfma_f32_16x16x32_bf16 a[88:91],a[244:247],v[180:183],a[88:91]
v_cvt_pk_bf16_f32 v188,v136,v137
s_waitcnt lgkmcnt(6)
v_mfma_f32_16x16x32_bf16 a[28:31],a[248:251],v[160:163],a[28:31]
ds_read_b64_tr_b16 a[228:229],v8 offset:16640
ds_read_b64_tr_b16 a[230:231],v8 offset:24832
v_mfma_f32_16x16x32_bf16 a[28:31],a[252:255],v[164:167],a[28:31]
v_exp_f32 v138,v138
v_mfma_f32_16x16x32_bf16 a[92:95],a[248:251],v[176:179],a[92:95]
ds_read_b64_tr_b16 a[232:233],v9 offset:256
ds_read_b64_tr_b16 a[234:235],v9 offset:8448
v_mfma_f32_16x16x32_bf16 a[92:95],a[252:255],v[180:183],a[92:95]
v_mfma_f32_16x16x32_bf16 a[32:35],a[192:195],v[160:163],a[32:35]
ds_read_b64_tr_b16 a[236:237],v9 offset:16640
ds_read_b64_tr_b16 a[238:239],v9 offset:24832
v_exp_f32 v139,v139
v_mfma_f32_16x16x32_bf16 a[32:35],a[196:199],v[164:167],a[32:35]
v_cvt_pk_bf16_f32 v189,v138,v139
v_mfma_f32_16x16x32_bf16 a[96:99],a[192:195],v[176:179],a[96:99]
ds_read_b64_tr_b16 a[240:241],v10 offset:256
ds_read_b64_tr_b16 a[242:243],v10 offset:8448
v_mfma_f32_16x16x32_bf16 a[96:99],a[196:199],v[180:183],a[96:99]
v_mfma_f32_16x16x32_bf16 a[36:39],a[200:203],v[160:163],a[36:39]
ds_read_b64_tr_b16 a[244:245],v10 offset:16640
ds_read_b64_tr_b16 a[246:247],v10 offset:24832
v_exp_f32 v124,v124
v_mfma_f32_16x16x32_bf16 a[36:39],a[204:207],v[164:167],a[36:39]
v_mfma_f32_16x16x32_bf16 a[100:103],a[200:203],v[176:179],a[100:103]
ds_read_b64_tr_b16 a[248:249],v11 offset:256
ds_read_b64_tr_b16 a[250:251],v11 offset:8448
v_mfma_f32_16x16x32_bf16 a[100:103],a[204:207],v[180:183],a[100:103]
v_mfma_f32_16x16x32_bf16 a[40:43],a[208:211],v[160:163],a[40:43]
ds_read_b64_tr_b16 a[252:253],v11 offset:16640
ds_read_b64_tr_b16 a[254:255],v11 offset:24832
v_mfma_f32_16x16x32_bf16 a[40:43],a[212:215],v[164:167],a[40:43]
v_mfma_f32_16x16x32_bf16 a[104:107],a[208:211],v[176:179],a[104:107]
v_exp_f32 v125,v125
v_mfma_f32_16x16x32_bf16 a[104:107],a[212:215],v[180:183],a[104:107]
v_cvt_pk_bf16_f32 v174,v124,v125
s_waitcnt lgkmcnt(4)
v_mfma_f32_16x16x32_bf16 a[44:47],a[216:219],v[160:163],a[44:47]
v_mfma_f32_16x16x32_bf16 a[44:47],a[220:223],v[164:167],a[44:47]
v_exp_f32 v126,v126
v_exp_f32 v127,v127
v_mfma_f32_16x16x32_bf16 a[108:111],a[216:219],v[176:179],a[108:111]
v_cvt_pk_bf16_f32 v175,v126,v127
s_waitcnt lgkmcnt(0)
s_waitcnt vmcnt(52)
s_barrier
v_mfma_f32_16x16x32_bf16 a[108:111],a[220:223],v[180:183],a[108:111]
ds_read_b128 a[192:195],v0 offset:0
s_mov_b32 m0,65536
s_add_u32 s28,s26,98304
v_mfma_f32_16x16x32_bf16 a[48:51],a[224:227],v[160:163],a[48:51]
buffer_load_dwordx4 v12,s[8:11],s28 offen nt lds
buffer_load_dwordx4 v13,s[8:11],s28 offen offset:1024 nt lds
v_mfma_f32_16x16x32_bf16 a[48:51],a[228:231],v[164:167],a[48:51]
ds_read_b128 a[196:199],v1 offset:0
buffer_load_dwordx4 v14,s[8:11],s28 offen offset:2048 nt lds
v_mfma_f32_16x16x32_bf16 a[112:115],a[224:227],v[176:179],a[112:115]
buffer_load_dwordx4 v15,s[8:11],s28 offen offset:3072 nt lds
s_mov_b32 m0,69632
s_add_u32 s28,s26,102400
v_mfma_f32_16x16x32_bf16 a[112:115],a[228:231],v[180:183],a[112:115]
ds_read_b128 a[200:203],v2 offset:0
buffer_load_dwordx4 v12,s[8:11],s28 offen nt lds
v_mfma_f32_16x16x32_bf16 a[52:55],a[232:235],v[160:163],a[52:55]
buffer_load_dwordx4 v13,s[8:11],s28 offen offset:1024 nt lds
buffer_load_dwordx4 v14,s[8:11],s28 offen offset:2048 nt lds
v_mfma_f32_16x16x32_bf16 a[52:55],a[236:239],v[164:167],a[52:55]
ds_read_b128 a[204:207],v3 offset:0
buffer_load_dwordx4 v15,s[8:11],s28 offen offset:3072 nt lds
s_mov_b32 m0,73728
v_mfma_f32_16x16x32_bf16 a[116:119],a[232:235],v[176:179],a[116:119]
s_add_u32 s28,s26,106496
buffer_load_dwordx4 v12,s[8:11],s28 offen nt lds
v_mfma_f32_16x16x32_bf16 a[116:119],a[236:239],v[180:183],a[116:119]
buffer_load_dwordx4 v13,s[8:11],s28 offen offset:1024 nt lds
buffer_load_dwordx4 v14,s[8:11],s28 offen offset:2048 nt lds
v_mfma_f32_16x16x32_bf16 a[56:59],a[240:243],v[160:163],a[56:59]
ds_read_b128 a[208:211],v0 offset:256
buffer_load_dwordx4 v15,s[8:11],s28 offen offset:3072 nt lds
s_mov_b32 m0,77824
v_mfma_f32_16x16x32_bf16 a[56:59],a[244:247],v[164:167],a[56:59]
s_add_u32 s28,s26,110592
buffer_load_dwordx4 v12,s[8:11],s28 offen nt lds
v_mfma_f32_16x16x32_bf16 a[120:123],a[240:243],v[176:179],a[120:123]
ds_read_b128 a[212:215],v1 offset:256
buffer_load_dwordx4 v13,s[8:11],s28 offen offset:1024 nt lds
v_mfma_f32_16x16x32_bf16 a[120:123],a[244:247],v[180:183],a[120:123]
buffer_load_dwordx4 v14,s[8:11],s28 offen offset:2048 nt lds
s_waitcnt lgkmcnt(6)
v_mfma_f32_16x16x32_bf16 a[60:63],a[248:251],v[160:163],a[60:63]
ds_read_b128 a[216:219],v2 offset:256
buffer_load_dwordx4 v15,s[8:11],s28 offen offset:3072 nt lds
s_mov_b32 m0,81920
v_mfma_f32_16x16x32_bf16 a[60:63],a[252:255],v[164:167],a[60:63]
s_add_u32 s28,s26,114688
buffer_load_dwordx4 v12,s[8:11],s28 offen nt lds
v_mfma_f32_16x16x32_bf16 a[124:127],a[248:251],v[176:179],a[124:127]
ds_read_b128 a[220:223],v3 offset:256
buffer_load_dwordx4 v13,s[8:11],s28 offen offset:1024 nt lds
v_mfma_f32_16x16x32_bf16 a[124:127],a[252:255],v[180:183],a[124:127]
buffer_load_dwordx4 v14,s[8:11],s28 offen offset:2048 nt lds
buffer_load_dwordx4 v15,s[8:11],s28 offen offset:3072 nt lds
s_mov_b32 m0,86016
s_add_u32 s28,s26,118784
buffer_load_dwordx4 v12,s[8:11],s28 offen nt lds
buffer_load_dwordx4 v13,s[8:11],s28 offen offset:1024 nt lds
buffer_load_dwordx4 v14,s[8:11],s28 offen offset:2048 nt lds
buffer_load_dwordx4 v15,s[8:11],s28 offen offset:3072 nt lds
s_mov_b32 m0,90112
s_add_u32 s28,s26,122880
buffer_load_dwordx4 v12,s[8:11],s28 offen nt lds
buffer_load_dwordx4 v13,s[8:11],s28 offen offset:1024 nt lds
buffer_load_dwordx4 v14,s[8:11],s28 offen offset:2048 nt lds
buffer_load_dwordx4 v15,s[8:11],s28 offen offset:3072 nt lds
s_mov_b32 m0,94208
s_add_u32 s28,s26,126976
buffer_load_dwordx4 v12,s[8:11],s28 offen nt lds
buffer_load_dwordx4 v13,s[8:11],s28 offen offset:1024 nt lds
buffer_load_dwordx4 v14,s[8:11],s28 offen offset:2048 nt lds
buffer_load_dwordx4 v15,s[8:11],s28 offen offset:3072 nt lds
s_add_u32 s26,s26,65536
s_cmp_lt_u32 s26,950272
s_cbranch_scc1 LOOP_B
M29_B:
s_waitcnt lgkmcnt(3)
v_mfma_f32_16x16x32_bf16 v[112:115],a[192:195],v[16:19],v[208:211]
ds_read_b128 a[224:227],v0 offset:8192
v_lshrrev_b32 v254,3,v253
v_and_b32 v255,7,v253
v_and_b32 v251,6,v254
v_mfma_f32_16x16x32_bf16 v[112:115],a[196:199],v[20:23],v[112:115]
ds_read_b128 a[228:231],v1 offset:8192
v_xor_b32 v255,v255,v251
v_lshlrev_b32 v255,4,v255
v_mul_u32_u24 v254,0x380,v254
v_mfma_f32_16x16x32_bf16 v[112:115],a[200:203],v[24:27],v[112:115]
v_add_u32 v236,v254,v255
v_add_u32 v237,6144,v236
v_add_u32 v238,12288,v236
v_add_u32 v239,18432,v236
v_mfma_f32_16x16x32_bf16 v[112:115],a[204:207],v[28:31],v[112:115]
ds_read_b128 a[232:235],v2 offset:8192
v_lshrrev_b32 v254,2,v253
v_and_b32 v255,3,v253
v_bfe_u32 v251,v253,3,2
v_mfma_f32_16x16x32_bf16 v[112:115],a[208:211],v[32:35],v[112:115]
v_lshlrev_b32 v254,7,v254
v_lshl_add_u32 v254,v255,3,v254
v_xor_b32 v255,0,v251
s_waitcnt lgkmcnt(4)
v_mfma_f32_16x16x32_bf16 v[112:115],a[212:215],v[36:39],v[112:115]
ds_read_b128 a[236:239],v3 offset:8192
v_lshl_add_u32 v244,v255,5,v254
v_add_u32 v240,81920,v244
v_xor_b32 v255,1,v251
v_mfma_f32_16x16x32_bf16 v[112:115],a[216:219],v[40:43],v[112:115]
v_lshl_add_u32 v245,v255,5,v254
v_add_u32 v241,81920,v245
v_xor_b32 v255,2,v251
s_waitcnt lgkmcnt(4)
v_mfma_f32_16x16x32_bf16 v[112:115],a[220:223],v[44:47],v[112:115]
ds_read_b128 a[240:243],v0 offset:8448
v_lshl_add_u32 v246,v255,5,v254
v_add_u32 v242,81920,v246
v_xor_b32 v255,3,v251
v_mfma_f32_16x16x32_bf16 v[128:131],a[192:195],v[48:51],v[212:215]
ds_read_b128 a[244:247],v1 offset:8448
v_lshl_add_u32 v247,v255,5,v254
v_add_u32 v243,81920,v247
v_lshlrev_b32 v248,4,v253
v_mfma_f32_16x16x32_bf16 v[128:131],a[196:199],v[52:55],v[128:131]
v_add_u32 v249,16384,v248
s_mov_b32 s31,65536
v_lshl_add_u32 v252,v253,3,s31
v_mov_b32 v251,v252
v_mfma_f32_16x16x32_bf16 v[128:131],a[200:203],v[56:59],v[128:131]
ds_read_b128 a[248:251],v2 offset:8448
v_exp_f32 v140,v140
v_mfma_f32_16x16x32_bf16 v[128:131],a[204:207],v[60:63],v[128:131]
v_exp_f32 v141,v141
v_exp_f32 v142,v142
v_mfma_f32_16x16x32_bf16 v[128:131],a[208:211],v[64:67],v[128:131]
ds_read_b128 a[252:255],v3 offset:8448
v_cvt_pk_bf16_f32 v190,v140,v141
v_mfma_f32_16x16x32_bf16 v[128:131],a[212:215],v[68:71],v[128:131]
v_mfma_f32_16x16x32_bf16 v[128:131],a[216:219],v[72:75],v[128:131]
ds_read_b128 a[192:195],v0 offset:16384
v_mfma_f32_16x16x32_bf16 v[128:131],a[220:223],v[76:79],v[128:131]
ds_read_b128 a[196:199],v1 offset:16384
v_exp_f32 v143,v143
s_waitcnt lgkmcnt(4)
v_mfma_f32_16x16x32_bf16 v[116:119],a[224:227],v[16:19],v[208:211]
v_cvt_pk_bf16_f32 v191,v142,v143
v_mfma_f32_16x16x32_bf16 v[116:119],a[228:231],v[20:23],v[116:119]
ds_read_b128 a[200:203],v2 offset:16384
v_mfma_f32_16x16x32_bf16 v[116:119],a[232:235],v[24:27],v[116:119]
v_mfma_f32_16x16x32_bf16 v[116:119],a[236:239],v[28:31],v[116:119]
ds_read_b128 a[204:207],v3 offset:16384
v_mfma_f32_16x16x32_bf16 v[116:119],a[240:243],v[32:35],v[116:119]
v_mfma_f32_16x16x32_bf16 v[116:119],a[244:247],v[36:39],v[116:119]
ds_read_b128 a[208:211],v0 offset:16640
v_exp_f32 v112,v112
s_waitcnt lgkmcnt(4)
v_mfma_f32_16x16x32_bf16 v[116:119],a[248:251],v[40:43],v[116:119]
ds_read_b128 a[212:215],v1 offset:16640
v_mfma_f32_16x16x32_bf16 v[116:119],a[252:255],v[44:47],v[116:119]
v_exp_f32 v113,v113
v_mfma_f32_16x16x32_bf16 v[132:135],a[224:227],v[48:51],v[212:215]
ds_read_b128 a[216:219],v2 offset:16640
v_cvt_pk_bf16_f32 v160,v112,v113
v_mfma_f32_16x16x32_bf16 v[132:135],a[228:231],v[52:55],v[132:135]
v_mfma_f32_16x16x32_bf16 v[132:135],a[232:235],v[56:59],v[132:135]
ds_read_b128 a[220:223],v3 offset:16640
v_exp_f32 v114,v114
v_mfma_f32_16x16x32_bf16 v[132:135],a[236:239],v[60:63],v[132:135]
v_mfma_f32_16x16x32_bf16 v[132:135],a[240:243],v[64:67],v[132:135]
ds_read_b128 a[224:227],v0 offset:24576
v_mfma_f32_16x16x32_bf16 v[132:135],a[244:247],v[68:71],v[132:135]
ds_read_b128 a[228:231],v1 offset:24576
v_exp_f32 v115,v115
v_mfma_f32_16x16x32_bf16 v[132:135],a[248:251],v[72:75],v[132:135]
v_cvt_pk_bf16_f32 v161,v114,v115
v_mfma_f32_16x16x32_bf16 v[132:135],a[252:255],v[76:79],v[132:135]
ds_read_b128 a[232:235],v2 offset:24576
v_mfma_f32_16x16x32_bf16 v[120:123],a[192:195],v[16:19],v[208:211]
v_exp_f32 v128,v128
s_waitcnt lgkmcnt(4)
v_mfma_f32_16x16x32_bf16 v[120:123],a[196:199],v[20:23],v[120:123]
ds_read_b128 a[236:239],v3 offset:24576
v_mfma_f32_16x16x32_bf16 v[120:123],a[200:203],v[24:27],v[120:123]
v_exp_f32 v129,v129
v_mfma_f32_16x16x32_bf16 v[120:123],a[204:207],v[28:31],v[120:123]
ds_read_b128 a[240:243],v0 offset:24832
v_cvt_pk_bf16_f32 v176,v128,v129
v_mfma_f32_16x16x32_bf16 v[120:123],a[208:211],v[32:35],v[120:123]
ds_read_b128 a[244:247],v1 offset:24832
v_mfma_f32_16x16x32_bf16 v[120:123],a[212:215],v[36:39],v[120:123]
v_exp_f32 v130,v130
v_mfma_f32_16x16x32_bf16 v[120:123],a[216:219],v[40:43],v[120:123]
ds_read_b128 a[248:251],v2 offset:24832
s_waitcnt lgkmcnt(4)
v_mfma_f32_16x16x32_bf16 v[120:123],a[220:223],v[44:47],v[120:123]
v_mfma_f32_16x16x32_bf16 v[136:139],a[192:195],v[48:51],v[212:215]
ds_read_b128 a[252:255],v3 offset:24832
v_exp_f32 v131,v131
v_mfma_f32_16x16x32_bf16 v[136:139],a[196:199],v[52:55],v[136:139]
v_cvt_pk_bf16_f32 v177,v130,v131
v_mfma_f32_16x16x32_bf16 v[136:139],a[200:203],v[56:59],v[136:139]
v_mfma_f32_16x16x32_bf16 v[136:139],a[204:207],v[60:63],v[136:139]
v_exp_f32 v116,v116
v_mfma_f32_16x16x32_bf16 v[136:139],a[208:211],v[64:67],v[136:139]
v_mfma_f32_16x16x32_bf16 v[136:139],a[212:215],v[68:71],v[136:139]
v_exp_f32 v117,v117
v_mfma_f32_16x16x32_bf16 v[136:139],a[216:219],v[72:75],v[136:139]
v_cvt_pk_bf16_f32 v162,v116,v117
s_waitcnt lgkmcnt(0)
s_waitcnt vmcnt(52)
s_barrier
v_mfma_f32_16x16x32_bf16 v[136:139],a[220:223],v[76:79],v[136:139]
ds_read_b64_tr_b16 a[192:193],v4 offset:32768
ds_read_b64_tr_b16 a[194:195],v4 offset:40960
s_add_u32 m0,s25,131072
s_add_u32 s28,s67,0
v_mfma_f32_16x16x32_bf16 v[124:127],a[224:227],v[16:19],v[208:211]
buffer_load_dwordx4 v236,s[96:99],s28 offen lds
buffer_load_dwordx4 v237,s[96:99],s28 offen offset:1024 lds
v_mfma_f32_16x16x32_bf16 v[124:127],a[228:231],v[20:23],v[124:127]
ds_read_b64_tr_b16 a[196:197],v4 offset:49152
ds_read_b64_tr_b16 a[198:199],v4 offset:57344
buffer_load_dwordx4 v238,s[96:99],s28 offen offset:2048 lds
v_mfma_f32_16x16x32_bf16 v[124:127],a[232:235],v[24:27],v[124:127]
buffer_load_dwordx4 v239,s[96:99],s28 offen offset:3072 lds
s_add_u32 m0,s25,0
s_waitcnt lgkmcnt(4)
v_mfma_f32_16x16x32_bf16 v[124:127],a[236:239],v[28:31],v[124:127]
ds_read_b64_tr_b16 a[200:201],v5 offset:32768
ds_read_b64_tr_b16 a[202:203],v5 offset:40960
s_add_u32 s28,s67,128
v_mfma_f32_16x16x32_bf16 v[124:127],a[240:243],v[32:35],v[124:127]
buffer_load_dwordx4 v236,s[96:99],s28 offen lds
buffer_load_dwordx4 v237,s[96:99],s28 offen offset:1024 lds
v_mfma_f32_16x16x32_bf16 v[124:127],a[244:247],v[36:39],v[124:127]
ds_read_b64_tr_b16 a[204:205],v5 offset:49152
ds_read_b64_tr_b16 a[206:207],v5 offset:57344
buffer_load_dwordx4 v238,s[96:99],s28 offen offset:2048 lds
v_mfma_f32_16x16x32_bf16 v[124:127],a[248:251],v[40:43],v[124:127]
buffer_load_dwordx4 v239,s[96:99],s28 offen offset:3072 lds
s_add_u32 m0,s25,16384
s_add_u32 s28,s67,114688
v_mfma_f32_16x16x32_bf16 v[124:127],a[252:255],v[44:47],v[124:127]
ds_read_b64_tr_b16 a[208:209],v6 offset:32768
ds_read_b64_tr_b16 a[210:211],v6 offset:40960
buffer_load_dwordx4 v236,s[96:99],s28 offen lds
v_mfma_f32_16x16x32_bf16 v[140:143],a[224:227],v[48:51],v[212:215]
buffer_load_dwordx4 v237,s[96:99],s28 offen offset:1024 lds
buffer_load_dwordx4 v238,s[96:99],s28 offen offset:2048 lds
v_mfma_f32_16x16x32_bf16 v[140:143],a[228:231],v[52:55],v[140:143]
ds_read_b64_tr_b16 a[212:213],v6 offset:49152
ds_read_b64_tr_b16 a[214:215],v6 offset:57344
buffer_load_dwordx4 v239,s[96:99],s28 offen offset:3072 lds
v_mfma_f32_16x16x32_bf16 v[140:143],a[232:235],v[56:59],v[140:143]
v_exp_f32 v118,v118
v_mfma_f32_16x16x32_bf16 v[140:143],a[236:239],v[60:63],v[140:143]
ds_read_b64_tr_b16 a[216:217],v7 offset:32768
ds_read_b64_tr_b16 a[218:219],v7 offset:40960
v_mfma_f32_16x16x32_bf16 v[140:143],a[240:243],v[64:67],v[140:143]
v_exp_f32 v119,v119
v_mfma_f32_16x16x32_bf16 v[140:143],a[244:247],v[68:71],v[140:143]
ds_read_b64_tr_b16 a[220:221],v7 offset:49152
ds_read_b64_tr_b16 a[222:223],v7 offset:57344
v_cvt_pk_bf16_f32 v163,v118,v119
v_mfma_f32_16x16x32_bf16 v[140:143],a[248:251],v[72:75],v[140:143]
v_mfma_f32_16x16x32_bf16 v[140:143],a[252:255],v[76:79],v[140:143]
ds_read_b64_tr_b16 a[224:225],v8 offset:32768
ds_read_b64_tr_b16 a[226:227],v8 offset:40960
v_mfma_f32_16x16x32_bf16 v[220:223],v[232:235],v[168:171],v[220:223]
v_mfma_f32_16x16x32_bf16 v[220:223],v[232:235],v[172:175],v[220:223]
ds_read_b64_tr_b16 a[228:229],v8 offset:49152
ds_read_b64_tr_b16 a[230:231],v8 offset:57344
v_mfma_f32_16x16x32_bf16 v[224:227],v[232:235],v[184:187],v[224:227]
v_exp_f32 v132,v132
v_mfma_f32_16x16x32_bf16 v[224:227],v[232:235],v[188:191],v[224:227]
ds_read_b64_tr_b16 a[232:233],v9 offset:32768
ds_read_b64_tr_b16 a[234:235],v9 offset:40960
s_waitcnt lgkmcnt(8)
v_mfma_f32_16x16x32_bf16 a[0:3],a[192:195],v[168:171],a[0:3]
v_mfma_f32_16x16x32_bf16 a[0:3],a[196:199],v[172:175],a[0:3]
ds_read_b64_tr_b16 a[236:237],v9 offset:49152
ds_read_b64_tr_b16 a[238:239],v9 offset:57344
v_exp_f32 v133,v133
v_mfma_f32_16x16x32_bf16 a[64:67],a[192:195],v[184:187],a[64:67]
v_cvt_pk_bf16_f32 v178,v132,v133
v_mfma_f32_16x16x32_bf16 a[64:67],a[196:199],v[188:191],a[64:67]
ds_read_b64_tr_b16 a[240:241],v10 offset:32768
ds_read_b64_tr_b16 a[242:243],v10 offset:40960
v_mfma_f32_16x16x32_bf16 a[4:7],a[200:203],v[168:171],a[4:7]
v_exp_f32 v134,v134
v_mfma_f32_16x16x32_bf16 a[4:7],a[204:207],v[172:175],a[4:7]
ds_read_b64_tr_b16 a[244:245],v10 offset:49152
ds_read_b64_tr_b16 a[246:247],v10 offset:57344
v_mfma_f32_16x16x32_bf16 a[68:71],a[200:203],v[184:187],a[68:71]
v_mfma_f32_16x16x32_bf16 a[68:71],a[204:207],v[188:191],a[68:71]
ds_read_b64_tr_b16 a[248:249],v11 offset:32768
ds_read_b64_tr_b16 a[250:251],v11 offset:40960
v_exp_f32 v135,v135
v_mfma_f32_16x16x32_bf16 a[8:11],a[208:211],v[168:171],a[8:11]
v_cvt_pk_bf16_f32 v179,v134,v135
v_mfma_f32_16x16x32_bf16 a[8:11],a[212:215],v[172:175],a[8:11]
ds_read_b64_tr_b16 a[252:253],v11 offset:49152
ds_read_b64_tr_b16 a[254:255],v11 offset:57344
v_mfma_f32_16x16x32_bf16 a[72:75],a[208:211],v[184:187],a[72:75]
ds_read_b64_tr_b16 a[192:193],v4 offset:33024
ds_read_b64_tr_b16 a[194:195],v4 offset:41216
v_mfma_f32_16x16x32_bf16 a[72:75],a[212:215],v[188:191],a[72:75]
v_exp_f32 v120,v120
v_mfma_f32_16x16x32_bf16 a[12:15],a[216:219],v[168:171],a[12:15]
ds_read_b64_tr_b16 a[196:197],v4 offset:49408
ds_read_b64_tr_b16 a[198:199],v4 offset:57600
s_waitcnt lgkmcnt(8)
v_mfma_f32_16x16x32_bf16 a[12:15],a[220:223],v[172:175],a[12:15]
v_mfma_f32_16x16x32_bf16 a[76:79],a[216:219],v[184:187],a[76:79]
ds_read_b64_tr_b16 a[200:201],v5 offset:33024
ds_read_b64_tr_b16 a[202:203],v5 offset:41216
v_exp_f32 v121,v121
v_mfma_f32_16x16x32_bf16 a[76:79],a[220:223],v[188:191],a[76:79]
v_cvt_pk_bf16_f32 v164,v120,v121
v_mfma_f32_16x16x32_bf16 a[16:19],a[224:227],v[168:171],a[16:19]
ds_read_b64_tr_b16 a[204:205],v5 offset:49408
ds_read_b64_tr_b16 a[206:207],v5 offset:57600
v_mfma_f32_16x16x32_bf16 a[16:19],a[228:231],v[172:175],a[16:19]
v_exp_f32 v122,v122
v_mfma_f32_16x16x32_bf16 a[80:83],a[224:227],v[184:187],a[80:83]
ds_read_b64_tr_b16 a[208:209],v6 offset:33024
ds_read_b64_tr_b16 a[210:211],v6 offset:41216
v_mfma_f32_16x16x32_bf16 a[80:83],a[228:231],v[188:191],a[80:83]
v_mfma_f32_16x16x32_bf16 a[20:23],a[232:235],v[168:171],a[20:23]
ds_read_b64_tr_b16 a[212:213],v6 offset:49408
ds_read_b64_tr_b16 a[214:215],v6 offset:57600
v_exp_f32 v123,v123
v_mfma_f32_16x16x32_bf16 a[20:23],a[236:239],v[172:175],a[20:23]
v_cvt_pk_bf16_f32 v165,v122,v123
v_mfma_f32_16x16x32_bf16 a[84:87],a[232:235],v[184:187],a[84:87]
ds_read_b64_tr_b16 a[216:217],v7 offset:33024
ds_read_b64_tr_b16 a[218:219],v7 offset:41216
v_mfma_f32_16x16x32_bf16 a[84:87],a[236:239],v[188:191],a[84:87]
v_exp_f32 v136,v136
v_mfma_f32_16x16x32_bf16 a[24:27],a[240:243],v[168:171],a[24:27]
ds_read_b64_tr_b16 a[220:221],v7 offset:49408
ds_read_b64_tr_b16 a[222:223],v7 offset:57600
v_mfma_f32_16x16x32_bf16 a[24:27],a[244:247],v[172:175],a[24:27]
v_mfma_f32_16x16x32_bf16 a[88:91],a[240:243],v[184:187],a[88:91]
ds_read_b64_tr_b16 a[224:225],v8 offset:33024
ds_read_b64_tr_b16 a[226:227],v8 offset:41216
v_exp_f32 v137,v137
v_mfma_f32_16x16x32_bf16 a[88:91],a[244:247],v[188:191],a[88:91]
v_cvt_pk_bf16_f32 v180,v136,v137
s_waitcnt lgkmcnt(6)
v_mfma_f32_16x16x32_bf16 a[28:31],a[248:251],v[168:171],a[28:31]
ds_read_b64_tr_b16 a[228:229],v8 offset:49408
ds_read_b64_tr_b16 a[230:231],v8 offset:57600
v_mfma_f32_16x16x32_bf16 a[28:31],a[252:255],v[172:175],a[28:31]
v_exp_f32 v138,v138
v_mfma_f32_16x16x32_bf16 a[92:95],a[248:251],v[184:187],a[92:95]
ds_read_b64_tr_b16 a[232:233],v9 offset:33024
ds_read_b64_tr_b16 a[234:235],v9 offset:41216
v_mfma_f32_16x16x32_bf16 a[92:95],a[252:255],v[188:191],a[92:95]
v_mfma_f32_16x16x32_bf16 a[32:35],a[192:195],v[168:171],a[32:35]
ds_read_b64_tr_b16 a[236:237],v9 offset:49408
ds_read_b64_tr_b16 a[238:239],v9 offset:57600
v_exp_f32 v139,v139
v_mfma_f32_16x16x32_bf16 a[32:35],a[196:199],v[172:175],a[32:35]
v_cvt_pk_bf16_f32 v181,v138,v139
v_mfma_f32_16x16x32_bf16 a[96:99],a[192:195],v[184:187],a[96:99]
ds_read_b64_tr_b16 a[240:241],v10 offset:33024
ds_read_b64_tr_b16 a[242:243],v10 offset:41216
v_mfma_f32_16x16x32_bf16 a[96:99],a[196:199],v[188:191],a[96:99]
v_mfma_f32_16x16x32_bf16 a[36:39],a[200:203],v[168:171],a[36:39]
ds_read_b64_tr_b16 a[244:245],v10 offset:49408
ds_read_b64_tr_b16 a[246:247],v10 offset:57600
v_exp_f32 v124,v124
v_mfma_f32_16x16x32_bf16 a[36:39],a[204:207],v[172:175],a[36:39]
v_mfma_f32_16x16x32_bf16 a[100:103],a[200:203],v[184:187],a[100:103]
ds_read_b64_tr_b16 a[248:249],v11 offset:33024
ds_read_b64_tr_b16 a[250:251],v11 offset:41216
v_mfma_f32_16x16x32_bf16 a[100:103],a[204:207],v[188:191],a[100:103]
v_mfma_f32_16x16x32_bf16 a[40:43],a[208:211],v[168:171],a[40:43]
ds_read_b64_tr_b16 a[252:253],v11 offset:49408
ds_read_b64_tr_b16 a[254:255],v11 offset:57600
v_mfma_f32_16x16x32_bf16 a[40:43],a[212:215],v[172:175],a[40:43]
v_mfma_f32_16x16x32_bf16 a[104:107],a[208:211],v[184:187],a[104:107]
v_exp_f32 v125,v125
v_mfma_f32_16x16x32_bf16 a[104:107],a[212:215],v[188:191],a[104:107]
v_cvt_pk_bf16_f32 v166,v124,v125
s_waitcnt lgkmcnt(4)
v_mfma_f32_16x16x32_bf16 a[44:47],a[216:219],v[168:171],a[44:47]
v_mfma_f32_16x16x32_bf16 a[44:47],a[220:223],v[172:175],a[44:47]
v_exp_f32 v126,v126
v_exp_f32 v127,v127
v_mfma_f32_16x16x32_bf16 a[108:111],a[216:219],v[184:187],a[108:111]
v_cvt_pk_bf16_f32 v167,v126,v127
s_waitcnt lgkmcnt(0)
s_waitcnt vmcnt(44)
s_barrier
v_mfma_f32_16x16x32_bf16 a[108:111],a[220:223],v[188:191],a[108:111]
ds_read_b128 a[192:195],v0 offset:32768
s_mov_b32 m0,98304
s_mov_b32 s28,1015808
v_mfma_f32_16x16x32_bf16 a[48:51],a[224:227],v[168:171],a[48:51]
buffer_load_dwordx4 v12,s[8:11],s28 offen nt lds
buffer_load_dwordx4 v13,s[8:11],s28 offen offset:1024 nt lds
v_mfma_f32_16x16x32_bf16 a[48:51],a[228:231],v[172:175],a[48:51]
ds_read_b128 a[196:199],v1 offset:32768
buffer_load_dwordx4 v14,s[8:11],s28 offen offset:2048 nt lds
v_mfma_f32_16x16x32_bf16 a[112:115],a[224:227],v[184:187],a[112:115]
buffer_load_dwordx4 v15,s[8:11],s28 offen offset:3072 nt lds
s_mov_b32 m0,102400
s_mov_b32 s28,1019904
v_mfma_f32_16x16x32_bf16 a[112:115],a[228:231],v[188:191],a[112:115]
ds_read_b128 a[200:203],v2 offset:32768
buffer_load_dwordx4 v12,s[8:11],s28 offen nt lds
v_mfma_f32_16x16x32_bf16 a[52:55],a[232:235],v[168:171],a[52:55]
buffer_load_dwordx4 v13,s[8:11],s28 offen offset:1024 nt lds
buffer_load_dwordx4 v14,s[8:11],s28 offen offset:2048 nt lds
v_mfma_f32_16x16x32_bf16 a[52:55],a[236:239],v[172:175],a[52:55]
ds_read_b128 a[204:207],v3 offset:32768
buffer_load_dwordx4 v15,s[8:11],s28 offen offset:3072 nt lds
s_mov_b32 m0,106496
v_mfma_f32_16x16x32_bf16 a[116:119],a[232:235],v[184:187],a[116:119]
s_mov_b32 s28,1024000
buffer_load_dwordx4 v12,s[8:11],s28 offen nt lds
v_mfma_f32_16x16x32_bf16 a[116:119],a[236:239],v[188:191],a[116:119]
buffer_load_dwordx4 v13,s[8:11],s28 offen offset:1024 nt lds
buffer_load_dwordx4 v14,s[8:11],s28 offen offset:2048 nt lds
v_mfma_f32_16x16x32_bf16 a[56:59],a[240:243],v[168:171],a[56:59]
ds_read_b128 a[208:211],v0 offset:33024
buffer_load_dwordx4 v15,s[8:11],s28 offen offset:3072 nt lds
s_mov_b32 m0,110592
v_mfma_f32_16x16x32_bf16 a[56:59],a[244:247],v[172:175],a[56:59]
s_mov_b32 s28,1028096
buffer_load_dwordx4 v12,s[8:11],s28 offen nt lds
v_mfma_f32_16x16x32_bf16 a[120:123],a[240:243],v[184:187],a[120:123]
ds_read_b128 a[212:215],v1 offset:33024
buffer_load_dwordx4 v13,s[8:11],s28 offen offset:1024 nt lds
v_mfma_f32_16x16x32_bf16 a[120:123],a[244:247],v[188:191],a[120:123]
buffer_load_dwordx4 v14,s[8:11],s28 offen offset:2048 nt lds
s_waitcnt lgkmcnt(6)
v_mfma_f32_16x16x32_bf16 a[60:63],a[248:251],v[168:171],a[60:63]
ds_read_b128 a[216:219],v2 offset:33024
buffer_load_dwordx4 v15,s[8:11],s28 offen offset:3072 nt lds
s_mov_b32 m0,114688
v_mfma_f32_16x16x32_bf16 a[60:63],a[252:255],v[172:175],a[60:63]
s_mov_b32 s28,1032192
buffer_load_dwordx4 v12,s[8:11],s28 offen nt lds
v_mfma_f32_16x16x32_bf16 a[124:127],a[248:251],v[184:187],a[124:127]
ds_read_b128 a[220:223],v3 offset:33024
buffer_load_dwordx4 v13,s[8:11],s28 offen offset:1024 nt lds
v_mfma_f32_16x16x32_bf16 a[124:127],a[252:255],v[188:191],a[124:127]
buffer_load_dwordx4 v14,s[8:11],s28 offen offset:2048 nt lds
buffer_load_dwordx4 v15,s[8:11],s28 offen offset:3072 nt lds
s_mov_b32 m0,118784
s_mov_b32 s28,1036288
buffer_load_dwordx4 v12,s[8:11],s28 offen nt lds
buffer_load_dwordx4 v13,s[8:11],s28 offen offset:1024 nt lds
buffer_load_dwordx4 v14,s[8:11],s28 offen offset:2048 nt lds
buffer_load_dwordx4 v15,s[8:11],s28 offen offset:3072 nt lds
s_mov_b32 m0,122880
s_mov_b32 s28,1040384
buffer_load_dwordx4 v12,s[8:11],s28 offen nt lds
buffer_load_dwordx4 v13,s[8:11],s28 offen offset:1024 nt lds
buffer_load_dwordx4 v14,s[8:11],s28 offen offset:2048 nt lds
buffer_load_dwordx4 v15,s[8:11],s28 offen offset:3072 nt lds
s_mov_b32 m0,126976
s_mov_b32 s28,1044480
buffer_load_dwordx4 v12,s[8:11],s28 offen nt lds
buffer_load_dwordx4 v13,s[8:11],s28 offen offset:1024 nt lds
buffer_load_dwordx4 v14,s[8:11],s28 offen offset:2048 nt lds
buffer_load_dwordx4 v15,s[8:11],s28 offen offset:3072 nt lds
s_waitcnt lgkmcnt(3)
v_mfma_f32_16x16x32_bf16 v[112:115],a[192:195],v[16:19],v[208:211]
ds_read_b128 a[224:227],v0 offset:40960
v_exp_f32 v140,v140
v_mfma_f32_16x16x32_bf16 v[112:115],a[196:199],v[20:23],v[112:115]
ds_read_b128 a[228:231],v1 offset:40960
v_mfma_f32_16x16x32_bf16 v[112:115],a[200:203],v[24:27],v[112:115]
v_mfma_f32_16x16x32_bf16 v[112:115],a[204:207],v[28:31],v[112:115]
ds_read_b128 a[232:235],v2 offset:40960
v_exp_f32 v141,v141
v_mfma_f32_16x16x32_bf16 v[112:115],a[208:211],v[32:35],v[112:115]
v_cvt_pk_bf16_f32 v182,v140,v141
s_waitcnt lgkmcnt(4)
v_mfma_f32_16x16x32_bf16 v[112:115],a[212:215],v[36:39],v[112:115]
ds_read_b128 a[236:239],v3 offset:40960
v_mfma_f32_16x16x32_bf16 v[112:115],a[216:219],v[40:43],v[112:115]
v_exp_f32 v142,v142
s_waitcnt lgkmcnt(4)
v_mfma_f32_16x16x32_bf16 v[112:115],a[220:223],v[44:47],v[112:115]
ds_read_b128 a[240:243],v0 offset:41216
v_mfma_f32_16x16x32_bf16 v[128:131],a[192:195],v[48:51],v[212:215]
ds_read_b128 a[244:247],v1 offset:41216
v_mfma_f32_16x16x32_bf16 v[128:131],a[196:199],v[52:55],v[128:131]
v_exp_f32 v143,v143
v_mfma_f32_16x16x32_bf16 v[128:131],a[200:203],v[56:59],v[128:131]
ds_read_b128 a[248:251],v2 offset:41216
v_cvt_pk_bf16_f32 v183,v142,v143
v_mfma_f32_16x16x32_bf16 v[128:131],a[204:207],v[60:63],v[128:131]
v_mfma_f32_16x16x32_bf16 v[128:131],a[208:211],v[64:67],v[128:131]
ds_read_b128 a[252:255],v3 offset:41216
v_mfma_f32_16x16x32_bf16 v[128:131],a[212:215],v[68:71],v[128:131]
v_mfma_f32_16x16x32_bf16 v[128:131],a[216:219],v[72:75],v[128:131]
ds_read_b128 a[192:195],v0 offset:49152
v_exp_f32 v112,v112
v_mfma_f32_16x16x32_bf16 v[128:131],a[220:223],v[76:79],v[128:131]
ds_read_b128 a[196:199],v1 offset:49152
s_waitcnt lgkmcnt(4)
v_mfma_f32_16x16x32_bf16 v[116:119],a[224:227],v[16:19],v[208:211]
v_mfma_f32_16x16x32_bf16 v[116:119],a[228:231],v[20:23],v[116:119]
ds_read_b128 a[200:203],v2 offset:49152
v_exp_f32 v113,v113
v_mfma_f32_16x16x32_bf16 v[116:119],a[232:235],v[24:27],v[116:119]
v_cvt_pk_bf16_f32 v168,v112,v113
v_mfma_f32_16x16x32_bf16 v[116:119],a[236:239],v[28:31],v[116:119]
ds_read_b128 a[204:207],v3 offset:49152
v_mfma_f32_16x16x32_bf16 v[116:119],a[240:243],v[32:35],v[116:119]
v_exp_f32 v114,v114
v_mfma_f32_16x16x32_bf16 v[116:119],a[244:247],v[36:39],v[116:119]
ds_read_b128 a[208:211],v0 offset:49408
s_waitcnt lgkmcnt(4)
v_mfma_f32_16x16x32_bf16 v[116:119],a[248:251],v[40:43],v[116:119]
ds_read_b128 a[212:215],v1 offset:49408
v_mfma_f32_16x16x32_bf16 v[116:119],a[252:255],v[44:47],v[116:119]
v_exp_f32 v115,v115
v_mfma_f32_16x16x32_bf16 v[132:135],a[224:227],v[48:51],v[212:215]
ds_read_b128 a[216:219],v2 offset:49408
v_cvt_pk_bf16_f32 v169,v114,v115
v_mfma_f32_16x16x32_bf16 v[132:135],a[228:231],v[52:55],v[132:135]
v_mfma_f32_16x16x32_bf16 v[132:135],a[232:235],v[56:59],v[132:135]
ds_read_b128 a[220:223],v3 offset:49408
v_exp_f32 v128,v128
v_mfma_f32_16x16x32_bf16 v[132:135],a[236:239],v[60:63],v[132:135]
v_mfma_f32_16x16x32_bf16 v[132:135],a[240:243],v[64:67],v[132:135]
ds_read_b128 a[224:227],v0 offset:57344
v_exp_f32 v129,v129
v_mfma_f32_16x16x32_bf16 v[132:135],a[244:247],v[68:71],v[132:135]
ds_read_b128 a[228:231],v1 offset:57344
v_cvt_pk_bf16_f32 v184,v128,v129
v_mfma_f32_16x16x32_bf16 v[132:135],a[248:251],v[72:75],v[132:135]
v_mfma_f32_16x16x32_bf16 v[132:135],a[252:255],v[76:79],v[132:135]
ds_read_b128 a[232:235],v2 offset:57344
v_exp_f32 v130,v130
v_mfma_f32_16x16x32_bf16 v[120:123],a[192:195],v[16:19],v[208:211]
s_waitcnt lgkmcnt(4)
v_mfma_f32_16x16x32_bf16 v[120:123],a[196:199],v[20:23],v[120:123]
ds_read_b128 a[236:239],v3 offset:57344
v_mfma_f32_16x16x32_bf16 v[120:123],a[200:203],v[24:27],v[120:123]
v_exp_f32 v131,v131
v_mfma_f32_16x16x32_bf16 v[120:123],a[204:207],v[28:31],v[120:123]
ds_read_b128 a[240:243],v0 offset:57600
v_cvt_pk_bf16_f32 v185,v130,v131
v_mfma_f32_16x16x32_bf16 v[120:123],a[208:211],v[32:35],v[120:123]
ds_read_b128 a[244:247],v1 offset:57600
v_mfma_f32_16x16x32_bf16 v[120:123],a[212:215],v[36:39],v[120:123]
v_exp_f32 v116,v116
v_mfma_f32_16x16x32_bf16 v[120:123],a[216:219],v[40:43],v[120:123]
ds_read_b128 a[248:251],v2 offset:57600
s_waitcnt lgkmcnt(4)
v_mfma_f32_16x16x32_bf16 v[120:123],a[220:223],v[44:47],v[120:123]
v_mfma_f32_16x16x32_bf16 v[136:139],a[192:195],v[48:51],v[212:215]
ds_read_b128 a[252:255],v3 offset:57600
v_mfma_f32_16x16x32_bf16 v[136:139],a[196:199],v[52:55],v[136:139]
v_exp_f32 v117,v117
v_mfma_f32_16x16x32_bf16 v[136:139],a[200:203],v[56:59],v[136:139]
v_cvt_pk_bf16_f32 v170,v116,v117
v_mfma_f32_16x16x32_bf16 v[136:139],a[204:207],v[60:63],v[136:139]
v_mfma_f32_16x16x32_bf16 v[136:139],a[208:211],v[64:67],v[136:139]
v_mfma_f32_16x16x32_bf16 v[136:139],a[212:215],v[68:71],v[136:139]
v_exp_f32 v118,v118
v_mfma_f32_16x16x32_bf16 v[136:139],a[216:219],v[72:75],v[136:139]
s_waitcnt lgkmcnt(0)
s_waitcnt vmcnt(44)
s_barrier
v_mfma_f32_16x16x32_bf16 v[136:139],a[220:223],v[76:79],v[136:139]
ds_read_b64_tr_b16 a[192:193],v4 offset:0
ds_read_b64_tr_b16 a[194:195],v4 offset:8192
s_add_u32 m0,s25,32768
s_add_u32 s28,s67,114816
v_mfma_f32_16x16x32_bf16 v[124:127],a[224:227],v[16:19],v[208:211]
buffer_load_dwordx4 v236,s[96:99],s28 offen lds
buffer_load_dwordx4 v237,s[96:99],s28 offen offset:1024 lds
v_mfma_f32_16x16x32_bf16 v[124:127],a[228:231],v[20:23],v[124:127]
ds_read_b64_tr_b16 a[196:197],v4 offset:16384
ds_read_b64_tr_b16 a[198:199],v4 offset:24576
buffer_load_dwordx4 v238,s[96:99],s28 offen offset:2048 lds
v_mfma_f32_16x16x32_bf16 v[124:127],a[232:235],v[24:27],v[124:127]
buffer_load_dwordx4 v239,s[96:99],s28 offen offset:3072 lds
s_add_u32 m0,s25,49152
s_waitcnt lgkmcnt(4)
v_mfma_f32_16x16x32_bf16 v[124:127],a[236:239],v[28:31],v[124:127]
ds_read_b64_tr_b16 a[200:201],v5 offset:0
ds_read_b64_tr_b16 a[202:203],v5 offset:8192
s_add_u32 s28,s67,256
v_mfma_f32_16x16x32_bf16 v[124:127],a[240:243],v[32:35],v[124:127]
buffer_load_dwordx4 v236,s[96:99],s28 offen lds
buffer_load_dwordx4 v237,s[96:99],s28 offen offset:1024 lds
v_mfma_f32_16x16x32_bf16 v[124:127],a[244:247],v[36:39],v[124:127]
ds_read_b64_tr_b16 a[204:205],v5 offset:16384
ds_read_b64_tr_b16 a[206:207],v5 offset:24576
buffer_load_dwordx4 v238,s[96:99],s28 offen offset:2048 lds
v_mfma_f32_16x16x32_bf16 v[124:127],a[248:251],v[40:43],v[124:127]
buffer_load_dwordx4 v239,s[96:99],s28 offen offset:3072 lds
v_exp_f32 v119,v119
v_mfma_f32_16x16x32_bf16 v[124:127],a[252:255],v[44:47],v[124:127]
ds_read_b64_tr_b16 a[208:209],v6 offset:0
ds_read_b64_tr_b16 a[210:211],v6 offset:8192
v_cvt_pk_bf16_f32 v171,v118,v119
v_mfma_f32_16x16x32_bf16 v[140:143],a[224:227],v[48:51],v[212:215]
v_exp_f32 v132,v132
v_mfma_f32_16x16x32_bf16 v[140:143],a[228:231],v[52:55],v[140:143]
ds_read_b64_tr_b16 a[212:213],v6 offset:16384
ds_read_b64_tr_b16 a[214:215],v6 offset:24576
v_mfma_f32_16x16x32_bf16 v[140:143],a[232:235],v[56:59],v[140:143]
v_mfma_f32_16x16x32_bf16 v[140:143],a[236:239],v[60:63],v[140:143]
ds_read_b64_tr_b16 a[216:217],v7 offset:0
ds_read_b64_tr_b16 a[218:219],v7 offset:8192
v_exp_f32 v133,v133
v_mfma_f32_16x16x32_bf16 v[140:143],a[240:243],v[64:67],v[140:143]
v_cvt_pk_bf16_f32 v186,v132,v133
v_mfma_f32_16x16x32_bf16 v[140:143],a[244:247],v[68:71],v[140:143]
ds_read_b64_tr_b16 a[220:221],v7 offset:16384
ds_read_b64_tr_b16 a[222:223],v7 offset:24576
v_mfma_f32_16x16x32_bf16 v[140:143],a[248:251],v[72:75],v[140:143]
v_exp_f32 v134,v134
v_mfma_f32_16x16x32_bf16 v[140:143],a[252:255],v[76:79],v[140:143]
ds_read_b64_tr_b16 a[224:225],v8 offset:0
ds_read_b64_tr_b16 a[226:227],v8 offset:8192
v_mfma_f32_16x16x32_bf16 v[220:223],v[232:235],v[160:163],v[220:223]
v_mfma_f32_16x16x32_bf16 v[220:223],v[232:235],v[164:167],v[220:223]
ds_read_b64_tr_b16 a[228:229],v8 offset:16384
ds_read_b64_tr_b16 a[230:231],v8 offset:24576
v_exp_f32 v135,v135
v_mfma_f32_16x16x32_bf16 v[224:227],v[232:235],v[176:179],v[224:227]
v_cvt_pk_bf16_f32 v187,v134,v135
v_mfma_f32_16x16x32_bf16 v[224:227],v[232:235],v[180:183],v[224:227]
ds_read_b64_tr_b16 a[232:233],v9 offset:0
ds_read_b64_tr_b16 a[234:235],v9 offset:8192
s_waitcnt lgkmcnt(8)
v_mfma_f32_16x16x32_bf16 a[0:3],a[192:195],v[160:163],a[0:3]
v_mfma_f32_16x16x32_bf16 a[0:3],a[196:199],v[164:167],a[0:3]
ds_read_b64_tr_b16 a[236:237],v9 offset:16384
ds_read_b64_tr_b16 a[238:239],v9 offset:24576
v_exp_f32 v120,v120
v_mfma_f32_16x16x32_bf16 a[64:67],a[192:195],v[176:179],a[64:67]
v_mfma_f32_16x16x32_bf16 a[64:67],a[196:199],v[180:183],a[64:67]
ds_read_b64_tr_b16 a[240:241],v10 offset:0
ds_read_b64_tr_b16 a[242:243],v10 offset:8192
v_mfma_f32_16x16x32_bf16 a[4:7],a[200:203],v[160:163],a[4:7]
v_exp_f32 v121,v121
v_mfma_f32_16x16x32_bf16 a[4:7],a[204:207],v[164:167],a[4:7]
ds_read_b64_tr_b16 a[244:245],v10 offset:16384
ds_read_b64_tr_b16 a[246:247],v10 offset:24576
v_cvt_pk_bf16_f32 v172,v120,v121
v_mfma_f32_16x16x32_bf16 a[68:71],a[200:203],v[176:179],a[68:71]
v_mfma_f32_16x16x32_bf16 a[68:71],a[204:207],v[180:183],a[68:71]
ds_read_b64_tr_b16 a[248:249],v11 offset:0
ds_read_b64_tr_b16 a[250:251],v11 offset:8192
v_mfma_f32_16x16x32_bf16 a[8:11],a[208:211],v[160:163],a[8:11]
v_exp_f32 v122,v122
v_mfma_f32_16x16x32_bf16 a[8:11],a[212:215],v[164:167],a[8:11]
ds_read_b64_tr_b16 a[252:253],v11 offset:16384
ds_read_b64_tr_b16 a[254:255],v11 offset:24576
v_mfma_f32_16x16x32_bf16 a[72:75],a[208:211],v[176:179],a[72:75]
ds_read_b64_tr_b16 a[192:193],v4 offset:256
ds_read_b64_tr_b16 a[194:195],v4 offset:8448
v_mfma_f32_16x16x32_bf16 a[72:75],a[212:215],v[180:183],a[72:75]
v_exp_f32 v123,v123
v_mfma_f32_16x16x32_bf16 a[12:15],a[216:219],v[160:163],a[12:15]
ds_read_b64_tr_b16 a[196:197],v4 offset:16640
ds_read_b64_tr_b16 a[198:199],v4 offset:24832
v_cvt_pk_bf16_f32 v173,v122,v123
s_waitcnt lgkmcnt(8)
v_mfma_f32_16x16x32_bf16 a[12:15],a[220:223],v[164:167],a[12:15]
v_mfma_f32_16x16x32_bf16 a[76:79],a[216:219],v[176:179],a[76:79]
ds_read_b64_tr_b16 a[200:201],v5 offset:256
ds_read_b64_tr_b16 a[202:203],v5 offset:8448
v_mfma_f32_16x16x32_bf16 a[76:79],a[220:223],v[180:183],a[76:79]
v_exp_f32 v136,v136
v_mfma_f32_16x16x32_bf16 a[16:19],a[224:227],v[160:163],a[16:19]
ds_read_b64_tr_b16 a[204:205],v5 offset:16640
ds_read_b64_tr_b16 a[206:207],v5 offset:24832
v_mfma_f32_16x16x32_bf16 a[16:19],a[228:231],v[164:167],a[16:19]
v_mfma_f32_16x16x32_bf16 a[80:83],a[224:227],v[176:179],a[80:83]
ds_read_b64_tr_b16 a[208:209],v6 offset:256
ds_read_b64_tr_b16 a[210:211],v6 offset:8448
v_exp_f32 v137,v137
v_mfma_f32_16x16x32_bf16 a[80:83],a[228:231],v[180:183],a[80:83]
v_cvt_pk_bf16_f32 v188,v136,v137
v_mfma_f32_16x16x32_bf16 a[20:23],a[232:235],v[160:163],a[20:23]
ds_read_b64_tr_b16 a[212:213],v6 offset:16640
ds_read_b64_tr_b16 a[214:215],v6 offset:24832
v_mfma_f32_16x16x32_bf16 a[20:23],a[236:239],v[164:167],a[20:23]
v_exp_f32 v138,v138
v_mfma_f32_16x16x32_bf16 a[84:87],a[232:235],v[176:179],a[84:87]
ds_read_b64_tr_b16 a[216:217],v7 offset:256
ds_read_b64_tr_b16 a[218:219],v7 offset:8448
v_mfma_f32_16x16x32_bf16 a[84:87],a[236:239],v[180:183],a[84:87]
v_mfma_f32_16x16x32_bf16 a[24:27],a[240:243],v[160:163],a[24:27]
ds_read_b64_tr_b16 a[220:221],v7 offset:16640
ds_read_b64_tr_b16 a[222:223],v7 offset:24832
v_exp_f32 v139,v139
v_mfma_f32_16x16x32_bf16 a[24:27],a[244:247],v[164:167],a[24:27]
v_cvt_pk_bf16_f32 v189,v138,v139
v_mfma_f32_16x16x32_bf16 a[88:91],a[240:243],v[176:179],a[88:91]
ds_read_b64_tr_b16 a[224:225],v8 offset:256
ds_read_b64_tr_b16 a[226:227],v8 offset:8448
v_mfma_f32_16x16x32_bf16 a[88:91],a[244:247],v[180:183],a[88:91]
s_waitcnt lgkmcnt(6)
v_mfma_f32_16x16x32_bf16 a[28:31],a[248:251],v[160:163],a[28:31]
ds_read_b64_tr_b16 a[228:229],v8 offset:16640
ds_read_b64_tr_b16 a[230:231],v8 offset:24832
v_exp_f32 v124,v124
v_mfma_f32_16x16x32_bf16 a[28:31],a[252:255],v[164:167],a[28:31]
v_mfma_f32_16x16x32_bf16 a[92:95],a[248:251],v[176:179],a[92:95]
ds_read_b64_tr_b16 a[232:233],v9 offset:256
ds_read_b64_tr_b16 a[234:235],v9 offset:8448
v_mfma_f32_16x16x32_bf16 a[92:95],a[252:255],v[180:183],a[92:95]
v_exp_f32 v125,v125
v_mfma_f32_16x16x32_bf16 a[32:35],a[192:195],v[160:163],a[32:35]
ds_read_b64_tr_b16 a[236:237],v9 offset:16640
ds_read_b64_tr_b16 a[238:239],v9 offset:24832
v_cvt_pk_bf16_f32 v174,v124,v125
v_mfma_f32_16x16x32_bf16 a[32:35],a[196:199],v[164:167],a[32:35]
v_mfma_f32_16x16x32_bf16 a[96:99],a[192:195],v[176:179],a[96:99]
ds_read_b64_tr_b16 a[240:241],v10 offset:256
ds_read_b64_tr_b16 a[242:243],v10 offset:8448
v_exp_f32 v126,v126
v_mfma_f32_16x16x32_bf16 a[96:99],a[196:199],v[180:183],a[96:99]
v_mfma_f32_16x16x32_bf16 a[36:39],a[200:203],v[160:163],a[36:39]
ds_read_b64_tr_b16 a[244:245],v10 offset:16640
ds_read_b64_tr_b16 a[246:247],v10 offset:24832
v_mfma_f32_16x16x32_bf16 a[36:39],a[204:207],v[164:167],a[36:39]
v_exp_f32 v127,v127
v_mfma_f32_16x16x32_bf16 a[100:103],a[200:203],v[176:179],a[100:103]
ds_read_b64_tr_b16 a[248:249],v11 offset:256
ds_read_b64_tr_b16 a[250:251],v11 offset:8448
v_cvt_pk_bf16_f32 v175,v126,v127
v_mfma_f32_16x16x32_bf16 a[100:103],a[204:207],v[180:183],a[100:103]
v_mfma_f32_16x16x32_bf16 a[40:43],a[208:211],v[160:163],a[40:43]
ds_read_b64_tr_b16 a[252:253],v11 offset:16640
ds_read_b64_tr_b16 a[254:255],v11 offset:24832
v_mfma_f32_16x16x32_bf16 a[40:43],a[212:215],v[164:167],a[40:43]
v_exp_f32 v140,v140
v_mfma_f32_16x16x32_bf16 a[104:107],a[208:211],v[176:179],a[104:107]
v_mfma_f32_16x16x32_bf16 a[104:107],a[212:215],v[180:183],a[104:107]
s_waitcnt lgkmcnt(4)
v_mfma_f32_16x16x32_bf16 a[44:47],a[216:219],v[160:163],a[44:47]
v_mfma_f32_16x16x32_bf16 a[44:47],a[220:223],v[164:167],a[44:47]
v_exp_f32 v141,v141
v_mfma_f32_16x16x32_bf16 a[108:111],a[216:219],v[176:179],a[108:111]
v_cvt_pk_bf16_f32 v190,v140,v141
s_waitcnt lgkmcnt(0)
s_waitcnt vmcnt(8)
s_barrier
v_mfma_f32_16x16x32_bf16 a[108:111],a[220:223],v[180:183],a[108:111]
ds_read_b64_tr_b16 a[192:193],v4 offset:32768
ds_read_b64_tr_b16 a[194:195],v4 offset:40960
s_add_u32 m0,s25,81920
s_add_u32 s28,s67,114944
v_mfma_f32_16x16x32_bf16 a[48:51],a[224:227],v[160:163],a[48:51]
buffer_load_dwordx4 v236,s[96:99],s28 offen lds
buffer_load_dwordx4 v237,s[96:99],s28 offen offset:1024 lds
v_mfma_f32_16x16x32_bf16 a[48:51],a[228:231],v[164:167],a[48:51]
ds_read_b64_tr_b16 a[196:197],v4 offset:49152
ds_read_b64_tr_b16 a[198:199],v4 offset:57344
buffer_load_dwordx4 v238,s[96:99],s28 offen offset:2048 lds
v_mfma_f32_16x16x32_bf16 a[112:115],a[224:227],v[176:179],a[112:115]
buffer_load_dwordx4 v239,s[96:99],s28 offen offset:3072 lds
v_mfma_f32_16x16x32_bf16 a[112:115],a[228:231],v[180:183],a[112:115]
ds_read_b64_tr_b16 a[200:201],v5 offset:32768
ds_read_b64_tr_b16 a[202:203],v5 offset:40960
v_exp_f32 v142,v142
v_mfma_f32_16x16x32_bf16 a[52:55],a[232:235],v[160:163],a[52:55]
s_lshl_b32 s38,s57,5
v_lshrrev_b32 v100,1,v253
v_add_u32 v100,s38,v100
v_mul_u32_u24 v100,0x380,v100
v_mfma_f32_16x16x32_bf16 a[52:55],a[236:239],v[164:167],a[52:55]
ds_read_b64_tr_b16 a[204:205],v5 offset:49152
ds_read_b64_tr_b16 a[206:207],v5 offset:57344
v_and_b32 v101,1,v253
v_lshl_add_u32 v100,v101,7,v100
v_mfma_f32_16x16x32_bf16 a[116:119],a[232:235],v[176:179],a[116:119]
buffer_load_dword v111,v100,s[96:99],0 offen offset:512
buffer_load_dword v111,v100,s[96:99],0 offen offset:640
v_mfma_f32_16x16x32_bf16 a[116:119],a[236:239],v[180:183],a[116:119]
v_mfma_f32_16x16x32_bf16 a[56:59],a[240:243],v[160:163],a[56:59]
ds_read_b64_tr_b16 a[208:209],v6 offset:32768
ds_read_b64_tr_b16 a[210:211],v6 offset:40960
v_exp_f32 v143,v143
v_mfma_f32_16x16x32_bf16 a[56:59],a[244:247],v[164:167],a[56:59]
v_cvt_pk_bf16_f32 v191,v142,v143
v_mfma_f32_16x16x32_bf16 a[120:123],a[240:243],v[176:179],a[120:123]
ds_read_b64_tr_b16 a[212:213],v6 offset:49152
ds_read_b64_tr_b16 a[214:215],v6 offset:57344
v_mfma_f32_16x16x32_bf16 a[120:123],a[244:247],v[180:183],a[120:123]
s_waitcnt lgkmcnt(12)
v_mfma_f32_16x16x32_bf16 a[60:63],a[248:251],v[160:163],a[60:63]
ds_read_b64_tr_b16 a[216:217],v7 offset:32768
ds_read_b64_tr_b16 a[218:219],v7 offset:40960
v_mfma_f32_16x16x32_bf16 a[60:63],a[252:255],v[164:167],a[60:63]
v_mfma_f32_16x16x32_bf16 a[124:127],a[248:251],v[176:179],a[124:127]
ds_read_b64_tr_b16 a[220:221],v7 offset:49152
ds_read_b64_tr_b16 a[222:223],v7 offset:57344
v_mfma_f32_16x16x32_bf16 a[124:127],a[252:255],v[180:183],a[124:127]
v_mfma_f32_16x16x32_bf16 v[220:223],v[232:235],v[168:171],v[220:223]
ds_read_b64_tr_b16 a[224:225],v8 offset:32768
ds_read_b64_tr_b16 a[226:227],v8 offset:40960
v_mfma_f32_16x16x32_bf16 v[220:223],v[232:235],v[172:175],v[220:223]
v_mfma_f32_16x16x32_bf16 v[224:227],v[232:235],v[184:187],v[224:227]
ds_read_b64_tr_b16 a[228:229],v8 offset:49152
ds_read_b64_tr_b16 a[230:231],v8 offset:57344
v_mfma_f32_16x16x32_bf16 v[224:227],v[232:235],v[188:191],v[224:227]
s_waitcnt lgkmcnt(6)
v_mfma_f32_16x16x32_bf16 a[0:3],a[192:195],v[168:171],a[0:3]
ds_read_b64_tr_b16 a[232:233],v9 offset:32768
ds_read_b64_tr_b16 a[234:235],v9 offset:40960
v_mfma_f32_16x16x32_bf16 a[0:3],a[196:199],v[172:175],a[0:3]
v_mfma_f32_16x16x32_bf16 a[64:67],a[192:195],v[184:187],a[64:67]
ds_read_b64_tr_b16 a[236:237],v9 offset:49152
ds_read_b64_tr_b16 a[238:239],v9 offset:57344
v_mfma_f32_16x16x32_bf16 a[64:67],a[196:199],v[188:191],a[64:67]
s_mov_b32 s28,0x4e800000
s_mov_b32 s66,0
v_cmp_ngt_f32 vcc,s28,v220
s_cmp_lg_u64 vcc,0
v_mfma_f32_16x16x32_bf16 a[4:7],a[200:203],v[168:171],a[4:7]
ds_read_b64_tr_b16 a[240:241],v10 offset:32768
ds_read_b64_tr_b16 a[242:243],v10 offset:40960
s_cselect_b32 s66,1,s66
v_cmp_ngt_f32 vcc,s28,v224
v_mfma_f32_16x16x32_bf16 a[4:7],a[204:207],v[172:175],a[4:7]
ds_read_b64_tr_b16 a[244:245],v10 offset:49152
ds_read_b64_tr_b16 a[246:247],v10 offset:57344
s_cmp_lg_u64 vcc,0
s_cselect_b32 s66,1,s66
v_mfma_f32_16x16x32_bf16 a[68:71],a[200:203],v[184:187],a[68:71]
s_lshl_b32 s28,s24,2
s_add_u32 s28,s28,155648
v_mov_b32 v221,s28
v_mov_b32 v222,s66
v_mfma_f32_16x16x32_bf16 a[68:71],a[204:207],v[188:191],a[68:71]
ds_read_b64_tr_b16 a[248:249],v11 offset:32768
ds_read_b64_tr_b16 a[250:251],v11 offset:40960
v_mov_b32 v223,155648
ds_write_b32 v221,v222
v_mfma_f32_16x16x32_bf16 a[8:11],a[208:211],v[168:171],a[8:11]
v_rcp_f32 v220,v220
v_rcp_f32 v224,v224
v_mfma_f32_16x16x32_bf16 a[8:11],a[212:215],v[172:175],a[8:11]
ds_read_b64_tr_b16 a[252:253],v11 offset:49152
ds_read_b64_tr_b16 a[254:255],v11 offset:57344
v_lshrrev_b32 v226,2,v248
v_and_b32 v226,60,v226
v_mfma_f32_16x16x32_bf16 a[72:75],a[208:211],v[184:187],a[72:75]
buffer_store_dword v220,v226,s[20:23],s68 offen offset:0
buffer_store_dword v224,v226,s[20:23],s68 offen offset:64
v_accvgpr_read_b32 v208,a0
v_accvgpr_read_b32 v209,a1
v_mfma_f32_16x16x32_bf16 a[72:75],a[212:215],v[188:191],a[72:75]
ds_read_b64_tr_b16 a[192:193],v4 offset:33024
ds_read_b64_tr_b16 a[194:195],v4 offset:41216
v_accvgpr_read_b32 v210,a2
v_accvgpr_read_b32 v211,a3
v_mfma_f32_16x16x32_bf16 a[12:15],a[216:219],v[168:171],a[12:15]
v_cvt_pk_bf16_f32 v112,v208,v209
v_cvt_pk_bf16_f32 v113,v210,v211
v_accvgpr_read_b32 v212,a64
s_waitcnt lgkmcnt(7)
v_mfma_f32_16x16x32_bf16 a[12:15],a[220:223],v[172:175],a[12:15]
ds_read_b64_tr_b16 a[196:197],v4 offset:49408
ds_read_b64_tr_b16 a[198:199],v4 offset:57600
v_accvgpr_read_b32 v213,a65
v_accvgpr_read_b32 v214,a66
v_mfma_f32_16x16x32_bf16 a[76:79],a[216:219],v[184:187],a[76:79]
v_accvgpr_read_b32 v215,a67
v_cvt_pk_bf16_f32 v128,v212,v213
v_cvt_pk_bf16_f32 v129,v214,v215
v_accvgpr_read_b32 v208,a4
v_mfma_f32_16x16x32_bf16 a[76:79],a[220:223],v[188:191],a[76:79]
ds_read_b64_tr_b16 a[200:201],v5 offset:33024
ds_read_b64_tr_b16 a[202:203],v5 offset:41216
v_accvgpr_read_b32 v209,a5
v_accvgpr_read_b32 v210,a6
v_mfma_f32_16x16x32_bf16 a[16:19],a[224:227],v[168:171],a[16:19]
v_accvgpr_read_b32 v211,a7
v_cvt_pk_bf16_f32 v114,v208,v209
v_cvt_pk_bf16_f32 v115,v210,v211
v_accvgpr_read_b32 v212,a68
v_mfma_f32_16x16x32_bf16 a[16:19],a[228:231],v[172:175],a[16:19]
ds_read_b64_tr_b16 a[204:205],v5 offset:49408
ds_read_b64_tr_b16 a[206:207],v5 offset:57600
v_accvgpr_read_b32 v213,a69
v_accvgpr_read_b32 v214,a70
v_mfma_f32_16x16x32_bf16 a[80:83],a[224:227],v[184:187],a[80:83]
v_accvgpr_read_b32 v215,a71
v_cvt_pk_bf16_f32 v130,v212,v213
v_cvt_pk_bf16_f32 v131,v214,v215
v_accvgpr_read_b32 v208,a8
v_mfma_f32_16x16x32_bf16 a[80:83],a[228:231],v[188:191],a[80:83]
ds_read_b64_tr_b16 a[208:209],v6 offset:33024
ds_read_b64_tr_b16 a[210:211],v6 offset:41216
v_accvgpr_read_b32 v209,a9
v_accvgpr_read_b32 v210,a10
v_mfma_f32_16x16x32_bf16 a[20:23],a[232:235],v[168:171],a[20:23]
v_accvgpr_read_b32 v211,a11
v_cvt_pk_bf16_f32 v116,v208,v209
v_cvt_pk_bf16_f32 v117,v210,v211
v_accvgpr_read_b32 v212,a72
v_mfma_f32_16x16x32_bf16 a[20:23],a[236:239],v[172:175],a[20:23]
ds_read_b64_tr_b16 a[212:213],v6 offset:49408
ds_read_b64_tr_b16 a[214:215],v6 offset:57600
v_accvgpr_read_b32 v213,a73
v_accvgpr_read_b32 v214,a74
v_mfma_f32_16x16x32_bf16 a[84:87],a[232:235],v[184:187],a[84:87]
v_accvgpr_read_b32 v215,a75
v_cvt_pk_bf16_f32 v132,v212,v213
v_cvt_pk_bf16_f32 v133,v214,v215
v_accvgpr_read_b32 v208,a12
v_mfma_f32_16x16x32_bf16 a[84:87],a[236:239],v[188:191],a[84:87]
ds_read_b64_tr_b16 a[216:217],v7 offset:33024
ds_read_b64_tr_b16 a[218:219],v7 offset:41216
v_accvgpr_read_b32 v209,a13
v_accvgpr_read_b32 v210,a14
v_mfma_f32_16x16x32_bf16 a[24:27],a[240:243],v[168:171],a[24:27]
v_accvgpr_read_b32 v211,a15
v_cvt_pk_bf16_f32 v118,v208,v209
v_cvt_pk_bf16_f32 v119,v210,v211
v_accvgpr_read_b32 v212,a76
v_mfma_f32_16x16x32_bf16 a[24:27],a[244:247],v[172:175],a[24:27]
ds_read_b64_tr_b16 a[220:221],v7 offset:49408
ds_read_b64_tr_b16 a[222:223],v7 offset:57600
v_accvgpr_read_b32 v213,a77
v_accvgpr_read_b32 v214,a78
v_mfma_f32_16x16x32_bf16 a[88:91],a[240:243],v[184:187],a[88:91]
v_accvgpr_read_b32 v215,a79
v_cvt_pk_bf16_f32 v134,v212,v213
v_cvt_pk_bf16_f32 v135,v214,v215
v_accvgpr_read_b32 v208,a16
v_mfma_f32_16x16x32_bf16 a[88:91],a[244:247],v[188:191],a[88:91]
ds_read_b64_tr_b16 a[224:225],v8 offset:33024
ds_read_b64_tr_b16 a[226:227],v8 offset:41216
v_accvgpr_read_b32 v209,a17
s_waitcnt lgkmcnt(8)
v_mfma_f32_16x16x32_bf16 a[28:31],a[248:251],v[168:171],a[28:31]
ds_read_b64_tr_b16 a[228:229],v8 offset:49408
ds_read_b64_tr_b16 a[230:231],v8 offset:57600
v_accvgpr_read_b32 v210,a18
v_accvgpr_read_b32 v211,a19
v_mfma_f32_16x16x32_bf16 a[28:31],a[252:255],v[172:175],a[28:31]
v_cvt_pk_bf16_f32 v120,v208,v209
v_cvt_pk_bf16_f32 v121,v210,v211
v_accvgpr_read_b32 v212,a80
v_accvgpr_read_b32 v213,a81
v_mfma_f32_16x16x32_bf16 a[92:95],a[248:251],v[184:187],a[92:95]
ds_read_b64_tr_b16 a[232:233],v9 offset:33024
ds_read_b64_tr_b16 a[234:235],v9 offset:41216
v_accvgpr_read_b32 v214,a82
v_accvgpr_read_b32 v215,a83
v_mfma_f32_16x16x32_bf16 a[92:95],a[252:255],v[188:191],a[92:95]
v_cvt_pk_bf16_f32 v136,v212,v213
v_cvt_pk_bf16_f32 v137,v214,v215
v_accvgpr_read_b32 v208,a20
v_accvgpr_read_b32 v209,a21
v_mfma_f32_16x16x32_bf16 a[32:35],a[192:195],v[168:171],a[32:35]
ds_read_b64_tr_b16 a[236:237],v9 offset:49408
ds_read_b64_tr_b16 a[238:239],v9 offset:57600
v_accvgpr_read_b32 v210,a22
v_accvgpr_read_b32 v211,a23
v_mfma_f32_16x16x32_bf16 a[32:35],a[196:199],v[172:175],a[32:35]
v_cvt_pk_bf16_f32 v122,v208,v209
v_cvt_pk_bf16_f32 v123,v210,v211
v_accvgpr_read_b32 v212,a84
v_accvgpr_read_b32 v213,a85
v_mfma_f32_16x16x32_bf16 a[96:99],a[192:195],v[184:187],a[96:99]
ds_read_b64_tr_b16 a[240:241],v10 offset:33024
ds_read_b64_tr_b16 a[242:243],v10 offset:41216
v_accvgpr_read_b32 v214,a86
v_accvgpr_read_b32 v215,a87
v_mfma_f32_16x16x32_bf16 a[96:99],a[196:199],v[188:191],a[96:99]
v_cvt_pk_bf16_f32 v138,v212,v213
v_cvt_pk_bf16_f32 v139,v214,v215
v_accvgpr_read_b32 v208,a24
v_accvgpr_read_b32 v209,a25
v_mfma_f32_16x16x32_bf16 a[36:39],a[200:203],v[168:171],a[36:39]
ds_read_b64_tr_b16 a[244:245],v10 offset:49408
ds_read_b64_tr_b16 a[246:247],v10 offset:57600
v_accvgpr_read_b32 v210,a26
v_accvgpr_read_b32 v211,a27
v_mfma_f32_16x16x32_bf16 a[36:39],a[204:207],v[172:175],a[36:39]
v_cvt_pk_bf16_f32 v124,v208,v209
v_cvt_pk_bf16_f32 v125,v210,v211
v_accvgpr_read_b32 v212,a88
v_accvgpr_read_b32 v213,a89
v_mfma_f32_16x16x32_bf16 a[100:103],a[200:203],v[184:187],a[100:103]
ds_read_b64_tr_b16 a[248:249],v11 offset:33024
ds_read_b64_tr_b16 a[250:251],v11 offset:41216
v_accvgpr_read_b32 v214,a90
v_accvgpr_read_b32 v215,a91
v_mfma_f32_16x16x32_bf16 a[100:103],a[204:207],v[188:191],a[100:103]
v_cvt_pk_bf16_f32 v140,v212,v213
v_cvt_pk_bf16_f32 v141,v214,v215
v_accvgpr_read_b32 v208,a28
v_accvgpr_read_b32 v209,a29
v_mfma_f32_16x16x32_bf16 a[40:43],a[208:211],v[168:171],a[40:43]
ds_read_b64_tr_b16 a[252:253],v11 offset:49408
ds_read_b64_tr_b16 a[254:255],v11 offset:57600
v_accvgpr_read_b32 v210,a30
s_waitcnt lgkmcnt(8)
v_mfma_f32_16x16x32_bf16 a[40:43],a[212:215],v[172:175],a[40:43]
v_accvgpr_read_b32 v211,a31
v_cvt_pk_bf16_f32 v126,v208,v209
v_cvt_pk_bf16_f32 v127,v210,v211
v_accvgpr_read_b32 v212,a92
v_mfma_f32_16x16x32_bf16 a[104:107],a[208:211],v[184:187],a[104:107]
v_accvgpr_read_b32 v213,a93
v_accvgpr_read_b32 v214,a94
v_accvgpr_read_b32 v215,a95
v_cvt_pk_bf16_f32 v142,v212,v213
v_mfma_f32_16x16x32_bf16 a[104:107],a[212:215],v[188:191],a[104:107]
v_cvt_pk_bf16_f32 v143,v214,v215
v_accvgpr_read_b32 v208,a32
v_accvgpr_read_b32 v209,a33
v_accvgpr_read_b32 v210,a34
v_mfma_f32_16x16x32_bf16 a[44:47],a[216:219],v[168:171],a[44:47]
v_accvgpr_read_b32 v211,a35
v_cvt_pk_bf16_f32 v160,v208,v209
v_cvt_pk_bf16_f32 v161,v210,v211
v_accvgpr_read_b32 v212,a96
v_mfma_f32_16x16x32_bf16 a[44:47],a[220:223],v[172:175],a[44:47]
v_accvgpr_read_b32 v213,a97
v_accvgpr_read_b32 v214,a98
v_accvgpr_read_b32 v215,a99
v_cvt_pk_bf16_f32 v176,v212,v213
v_mfma_f32_16x16x32_bf16 a[108:111],a[216:219],v[184:187],a[108:111]
v_cvt_pk_bf16_f32 v177,v214,v215
s_waitcnt lgkmcnt(0)
s_waitcnt vmcnt(52)
s_barrier
v_mfma_f32_16x16x32_bf16 a[108:111],a[220:223],v[188:191],a[108:111]
ds_read_b64_tr_b16 a[192:193],v240 offset:49152
ds_read_b64_tr_b16 a[194:195],v240 offset:51200
ds_read_b128 v[216:219],v223
v_accvgpr_read_b32 v208,a36
v_mfma_f32_16x16x32_bf16 a[48:51],a[224:227],v[168:171],a[48:51]
s_add_u32 m0,s25,98304
s_add_u32 s28,s67,384
v_accvgpr_read_b32 v209,a37
v_accvgpr_read_b32 v210,a38
v_mfma_f32_16x16x32_bf16 a[48:51],a[228:231],v[172:175],a[48:51]
ds_read_b64_tr_b16 a[196:197],v240 offset:53248
ds_read_b64_tr_b16 a[198:199],v240 offset:55296
v_accvgpr_read_b32 v211,a39
v_cvt_pk_bf16_f32 v162,v208,v209
v_mfma_f32_16x16x32_bf16 a[112:115],a[224:227],v[184:187],a[112:115]
buffer_load_dwordx4 v236,s[96:99],s28 offen lds
v_cvt_pk_bf16_f32 v163,v210,v211
v_accvgpr_read_b32 v212,a100
v_mfma_f32_16x16x32_bf16 a[112:115],a[228:231],v[188:191],a[112:115]
ds_read_b64_tr_b16 a[200:201],v240 offset:57344
ds_read_b64_tr_b16 a[202:203],v240 offset:59392
v_accvgpr_read_b32 v213,a101
v_accvgpr_read_b32 v214,a102
v_mfma_f32_16x16x32_bf16 a[52:55],a[232:235],v[168:171],a[52:55]
buffer_load_dwordx4 v237,s[96:99],s28 offen offset:1024 lds
v_accvgpr_read_b32 v215,a103
v_cvt_pk_bf16_f32 v178,v212,v213
v_mfma_f32_16x16x32_bf16 a[52:55],a[236:239],v[172:175],a[52:55]
ds_read_b64_tr_b16 a[204:205],v240 offset:61440
ds_read_b64_tr_b16 a[206:207],v240 offset:63488
v_cvt_pk_bf16_f32 v179,v214,v215
v_accvgpr_read_b32 v208,a40
v_mfma_f32_16x16x32_bf16 a[116:119],a[232:235],v[184:187],a[116:119]
buffer_load_dwordx4 v238,s[96:99],s28 offen offset:2048 lds
v_accvgpr_read_b32 v209,a41
v_accvgpr_read_b32 v210,a42
v_mfma_f32_16x16x32_bf16 a[116:119],a[236:239],v[188:191],a[116:119]
buffer_load_dwordx4 v239,s[96:99],s28 offen offset:3072 lds
v_accvgpr_read_b32 v211,a43
s_waitcnt lgkmcnt(9)
v_mfma_f32_16x16x32_bf16 a[56:59],a[240:243],v[168:171],a[56:59]
ds_read_b64_tr_b16 a[208:209],v241 offset:49152
ds_read_b64_tr_b16 a[210:211],v241 offset:51200
s_add_u32 m0,s25,114688
v_cvt_pk_bf16_f32 v164,v208,v209
v_mfma_f32_16x16x32_bf16 a[56:59],a[244:247],v[172:175],a[56:59]
s_add_u32 s28,s67,115072
buffer_load_dwordx4 v236,s[96:99],s28 offen lds
v_cvt_pk_bf16_f32 v165,v210,v211
v_mfma_f32_16x16x32_bf16 a[120:123],a[240:243],v[184:187],a[120:123]
ds_read_b64_tr_b16 a[212:213],v241 offset:53248
ds_read_b64_tr_b16 a[214:215],v241 offset:55296
v_accvgpr_read_b32 v212,a104
v_accvgpr_read_b32 v213,a105
v_mfma_f32_16x16x32_bf16 a[120:123],a[244:247],v[188:191],a[120:123]
buffer_load_dwordx4 v237,s[96:99],s28 offen offset:1024 lds
v_accvgpr_read_b32 v214,a106
v_accvgpr_read_b32 v215,a107
v_mfma_f32_16x16x32_bf16 a[60:63],a[248:251],v[168:171],a[60:63]
ds_read_b64_tr_b16 a[216:217],v241 offset:57344
ds_read_b64_tr_b16 a[218:219],v241 offset:59392
v_cvt_pk_bf16_f32 v180,v212,v213
v_cvt_pk_bf16_f32 v181,v214,v215
v_mfma_f32_16x16x32_bf16 a[60:63],a[252:255],v[172:175],a[60:63]
buffer_load_dwordx4 v238,s[96:99],s28 offen offset:2048 lds
s_waitcnt lgkmcnt(12)
v_or3_b32 v216,v216,v217,v218
v_or_b32 v216,v216,v219
v_mfma_f32_16x16x32_bf16 a[124:127],a[248:251],v[184:187],a[124:127]
ds_read_b64_tr_b16 a[220:221],v241 offset:61440
ds_read_b64_tr_b16 a[222:223],v241 offset:63488
v_mfma_f32_16x16x32_bf16 a[124:127],a[252:255],v[188:191],a[124:127]
buffer_load_dwordx4 v239,s[96:99],s28 offen offset:3072 lds
v_readfirstlane_b32 s66,v216
s_andn2_b32 s66,s66,s30
s_cbranch_scc1 FALLBACK_B
s_waitcnt lgkmcnt(6)
v_mfma_f32_16x16x32_bf16 v[16:19],a[192:195],v[112:115],0
ds_read_b64_tr_b16 a[224:225],v242 offset:49152
ds_read_b64_tr_b16 a[226:227],v242 offset:51200
v_mfma_f32_16x16x32_bf16 v[16:19],a[196:199],v[116:119],v[16:19]
v_mfma_f32_16x16x32_bf16 v[16:19],a[200:203],v[120:123],v[16:19]
ds_read_b64_tr_b16 a[228:229],v242 offset:53248
ds_read_b64_tr_b16 a[230:231],v242 offset:55296
v_mfma_f32_16x16x32_bf16 v[16:19],a[204:207],v[124:127],v[16:19]
v_accvgpr_read_b32 v208,a44
v_accvgpr_read_b32 v209,a45
v_accvgpr_read_b32 v210,a46
v_accvgpr_read_b32 v211,a47
v_mfma_f32_16x16x32_bf16 v[20:23],a[192:195],v[128:131],0
ds_read_b64_tr_b16 a[232:233],v242 offset:57344
ds_read_b64_tr_b16 a[234:235],v242 offset:59392
v_cvt_pk_bf16_f32 v166,v208,v209
v_cvt_pk_bf16_f32 v167,v210,v211
v_mfma_f32_16x16x32_bf16 v[20:23],a[196:199],v[132:135],v[20:23]
v_accvgpr_read_b32 v212,a108
v_accvgpr_read_b32 v213,a109
v_accvgpr_read_b32 v214,a110
v_accvgpr_read_b32 v215,a111
v_mfma_f32_16x16x32_bf16 v[20:23],a[200:203],v[136:139],v[20:23]
ds_read_b64_tr_b16 a[236:237],v242 offset:61440
ds_read_b64_tr_b16 a[238:239],v242 offset:63488
v_cvt_pk_bf16_f32 v182,v212,v213
v_cvt_pk_bf16_f32 v183,v214,v215
v_mfma_f32_16x16x32_bf16 v[20:23],a[204:207],v[140:143],v[20:23]
v_accvgpr_read_b32 v208,a48
v_accvgpr_read_b32 v209,a49
v_accvgpr_read_b32 v210,a50
v_accvgpr_read_b32 v211,a51
v_mfma_f32_16x16x32_bf16 v[24:27],a[208:211],v[112:115],0
ds_read_b64_tr_b16 a[240:241],v243 offset:49152
ds_read_b64_tr_b16 a[242:243],v243 offset:51200
v_cvt_pk_bf16_f32 v168,v208,v209
s_waitcnt lgkmcnt(8)
v_mfma_f32_16x16x32_bf16 v[24:27],a[212:215],v[116:119],v[24:27]
v_cvt_pk_bf16_f32 v169,v210,v211
v_accvgpr_read_b32 v212,a112
v_accvgpr_read_b32 v213,a113
v_accvgpr_read_b32 v214,a114
v_mfma_f32_16x16x32_bf16 v[24:27],a[216:219],v[120:123],v[24:27]
ds_read_b64_tr_b16 a[244:245],v243 offset:53248
ds_read_b64_tr_b16 a[246:247],v243 offset:55296
v_accvgpr_read_b32 v215,a115
v_cvt_pk_bf16_f32 v184,v212,v213
v_mfma_f32_16x16x32_bf16 v[24:27],a[220:223],v[124:127],v[24:27]
v_cvt_pk_bf16_f32 v185,v214,v215
v_accvgpr_read_b32 v208,a52
v_accvgpr_read_b32 v209,a53
v_accvgpr_read_b32 v210,a54
v_mfma_f32_16x16x32_bf16 v[28:31],a[208:211],v[128:131],0
ds_read_b64_tr_b16 a[248:249],v243 offset:57344
ds_read_b64_tr_b16 a[250:251],v243 offset:59392
v_accvgpr_read_b32 v211,a55
v_cvt_pk_bf16_f32 v170,v208,v209
v_mfma_f32_16x16x32_bf16 v[28:31],a[212:215],v[132:135],v[28:31]
v_cvt_pk_bf16_f32 v171,v210,v211
v_mfma_f32_16x16x32_bf16 v[28:31],a[216:219],v[136:139],v[28:31]
ds_read_b64_tr_b16 a[252:253],v243 offset:61440
ds_read_b64_tr_b16 a[254:255],v243 offset:63488
v_mfma_f32_16x16x32_bf16 v[28:31],a[220:223],v[140:143],v[28:31]
v_mfma_f32_16x16x32_bf16 v[32:35],a[224:227],v[112:115],0
ds_read_b64_tr_b16 a[192:193],v244 offset:0
ds_read_b64_tr_b16 a[194:195],v244 offset:2048
s_waitcnt lgkmcnt(8)
v_mfma_f32_16x16x32_bf16 v[32:35],a[228:231],v[116:119],v[32:35]
v_mfma_f32_16x16x32_bf16 v[32:35],a[232:235],v[120:123],v[32:35]
ds_read_b64_tr_b16 a[196:197],v244 offset:4096
ds_read_b64_tr_b16 a[198:199],v244 offset:6144
v_mfma_f32_16x16x32_bf16 v[32:35],a[236:239],v[124:127],v[32:35]
v_mfma_f32_16x16x32_bf16 v[36:39],a[224:227],v[128:131],0
ds_read_b64_tr_b16 a[200:201],v244 offset:8192
ds_read_b64_tr_b16 a[202:203],v244 offset:10240
v_mfma_f32_16x16x32_bf16 v[36:39],a[228:231],v[132:135],v[36:39]
v_mfma_f32_16x16x32_bf16 v[36:39],a[232:235],v[136:139],v[36:39]
ds_read_b64_tr_b16 a[204:205],v244 offset:12288
ds_read_b64_tr_b16 a[206:207],v244 offset:14336
v_mfma_f32_16x16x32_bf16 v[36:39],a[236:239],v[140:143],v[36:39]
v_mfma_f32_16x16x32_bf16 v[40:43],a[240:243],v[112:115],0
ds_read_b64_tr_b16 a[208:209],v245 offset:0
ds_read_b64_tr_b16 a[210:211],v245 offset:2048
s_waitcnt lgkmcnt(10)
v_mfma_f32_16x16x32_bf16 v[40:43],a[244:247],v[116:119],v[40:43]
v_mfma_f32_16x16x32_bf16 v[40:43],a[248:251],v[120:123],v[40:43]
ds_read_b64_tr_b16 a[212:213],v245 offset:4096
ds_read_b64_tr_b16 a[214:215],v245 offset:6144
v_mfma_f32_16x16x32_bf16 v[40:43],a[252:255],v[124:127],v[40:43]
v_mfma_f32_16x16x32_bf16 v[44:47],a[240:243],v[128:131],0
ds_read_b64_tr_b16 a[216:217],v245 offset:8192
ds_read_b64_tr_b16 a[218:219],v245 offset:10240
v_mfma_f32_16x16x32_bf16 v[44:47],a[244:247],v[132:135],v[44:47]
v_mfma_f32_16x16x32_bf16 v[44:47],a[248:251],v[136:139],v[44:47]
ds_read_b64_tr_b16 a[220:221],v245 offset:12288
ds_read_b64_tr_b16 a[222:223],v245 offset:14336
v_mfma_f32_16x16x32_bf16 v[44:47],a[252:255],v[140:143],v[44:47]
s_waitcnt vmcnt(56)
s_barrier
s_waitcnt lgkmcnt(6)
v_mfma_f32_16x16x32_bf16 v[48:51],a[192:195],v[112:115],0
ds_read_b64_tr_b16 a[224:225],v246 offset:0
ds_read_b64_tr_b16 a[226:227],v246 offset:2048
s_add_u32 m0,s25,131072
s_add_u32 s28,s67,512
v_mfma_f32_16x16x32_bf16 v[48:51],a[196:199],v[116:119],v[48:51]
buffer_load_dwordx4 v236,s[96:99],s28 offen lds
buffer_load_dwordx4 v237,s[96:99],s28 offen offset:1024 lds
v_mfma_f32_16x16x32_bf16 v[48:51],a[200:203],v[120:123],v[48:51]
ds_read_b64_tr_b16 a[228:229],v246 offset:4096
ds_read_b64_tr_b16 a[230:231],v246 offset:6144
buffer_load_dwordx4 v238,s[96:99],s28 offen offset:2048 lds
v_mfma_f32_16x16x32_bf16 v[48:51],a[204:207],v[124:127],v[48:51]
buffer_load_dwordx4 v239,s[96:99],s28 offen offset:3072 lds
v_accvgpr_read_b32 v212,a116
v_accvgpr_read_b32 v213,a117
v_mfma_f32_16x16x32_bf16 v[52:55],a[192:195],v[128:131],0
ds_read_b64_tr_b16 a[232:233],v246 offset:8192
ds_read_b64_tr_b16 a[234:235],v246 offset:10240
v_accvgpr_read_b32 v214,a118
v_accvgpr_read_b32 v215,a119
v_mfma_f32_16x16x32_bf16 v[52:55],a[196:199],v[132:135],v[52:55]
v_cvt_pk_bf16_f32 v186,v212,v213
v_cvt_pk_bf16_f32 v187,v214,v215
v_accvgpr_read_b32 v208,a56
v_accvgpr_read_b32 v209,a57
v_mfma_f32_16x16x32_bf16 v[52:55],a[200:203],v[136:139],v[52:55]
ds_read_b64_tr_b16 a[236:237],v246 offset:12288
ds_read_b64_tr_b16 a[238:239],v246 offset:14336
v_accvgpr_read_b32 v210,a58
v_accvgpr_read_b32 v211,a59
v_mfma_f32_16x16x32_bf16 v[52:55],a[204:207],v[140:143],v[52:55]
v_cvt_pk_bf16_f32 v172,v208,v209
v_cvt_pk_bf16_f32 v173,v210,v211
v_accvgpr_read_b32 v212,a120
v_accvgpr_read_b32 v213,a121
v_mfma_f32_16x16x32_bf16 v[56:59],a[208:211],v[112:115],0
ds_read_b64_tr_b16 a[240:241],v247 offset:0
ds_read_b64_tr_b16 a[242:243],v247 offset:2048
v_accvgpr_read_b32 v214,a122
s_waitcnt lgkmcnt(8)
v_mfma_f32_16x16x32_bf16 v[56:59],a[212:215],v[116:119],v[56:59]
v_accvgpr_read_b32 v215,a123
v_cvt_pk_bf16_f32 v188,v212,v213
v_cvt_pk_bf16_f32 v189,v214,v215
v_accvgpr_read_b32 v208,a60
v_mfma_f32_16x16x32_bf16 v[56:59],a[216:219],v[120:123],v[56:59]
ds_read_b64_tr_b16 a[244:245],v247 offset:4096
ds_read_b64_tr_b16 a[246:247],v247 offset:6144
v_accvgpr_read_b32 v209,a61
v_accvgpr_read_b32 v210,a62
v_mfma_f32_16x16x32_bf16 v[56:59],a[220:223],v[124:127],v[56:59]
v_accvgpr_read_b32 v211,a63
v_cvt_pk_bf16_f32 v174,v208,v209
v_cvt_pk_bf16_f32 v175,v210,v211
v_accvgpr_read_b32 v212,a124
v_mfma_f32_16x16x32_bf16 v[60:63],a[208:211],v[128:131],0
ds_read_b64_tr_b16 a[248:249],v247 offset:8192
ds_read_b64_tr_b16 a[250:251],v247 offset:10240
v_accvgpr_read_b32 v213,a125
v_accvgpr_read_b32 v214,a126
v_mfma_f32_16x16x32_bf16 v[60:63],a[212:215],v[132:135],v[60:63]
v_accvgpr_read_b32 v215,a127
v_cvt_pk_bf16_f32 v190,v212,v213
v_cvt_pk_bf16_f32 v191,v214,v215
v_mfma_f32_16x16x32_bf16 v[60:63],a[216:219],v[136:139],v[60:63]
ds_read_b64_tr_b16 a[252:253],v247 offset:12288
ds_read_b64_tr_b16 a[254:255],v247 offset:14336
v_mfma_f32_16x16x32_bf16 v[60:63],a[220:223],v[140:143],v[60:63]
v_mfma_f32_16x16x32_bf16 v[64:67],a[224:227],v[112:115],0
ds_read_b64_tr_b16 a[192:193],v244 offset:16384
ds_read_b64_tr_b16 a[194:195],v244 offset:18432
s_waitcnt lgkmcnt(8)
v_mfma_f32_16x16x32_bf16 v[64:67],a[228:231],v[116:119],v[64:67]
v_mfma_f32_16x16x32_bf16 v[64:67],a[232:235],v[120:123],v[64:67]
ds_read_b64_tr_b16 a[196:197],v244 offset:20480
ds_read_b64_tr_b16 a[198:199],v244 offset:22528
v_mfma_f32_16x16x32_bf16 v[64:67],a[236:239],v[124:127],v[64:67]
v_mfma_f32_16x16x32_bf16 v[68:71],a[224:227],v[128:131],0
ds_read_b64_tr_b16 a[200:201],v244 offset:24576
ds_read_b64_tr_b16 a[202:203],v244 offset:26624
v_mfma_f32_16x16x32_bf16 v[68:71],a[228:231],v[132:135],v[68:71]
v_mfma_f32_16x16x32_bf16 v[68:71],a[232:235],v[136:139],v[68:71]
ds_read_b64_tr_b16 a[204:205],v244 offset:28672
ds_read_b64_tr_b16 a[206:207],v244 offset:30720
v_mfma_f32_16x16x32_bf16 v[68:71],a[236:239],v[140:143],v[68:71]
v_mfma_f32_16x16x32_bf16 v[72:75],a[240:243],v[112:115],0
ds_read_b64_tr_b16 a[208:209],v245 offset:16384
ds_read_b64_tr_b16 a[210:211],v245 offset:18432
s_waitcnt lgkmcnt(10)
v_mfma_f32_16x16x32_bf16 v[72:75],a[244:247],v[116:119],v[72:75]
v_mfma_f32_16x16x32_bf16 v[72:75],a[248:251],v[120:123],v[72:75]
ds_read_b64_tr_b16 a[212:213],v245 offset:20480
ds_read_b64_tr_b16 a[214:215],v245 offset:22528
v_mfma_f32_16x16x32_bf16 v[72:75],a[252:255],v[124:127],v[72:75]
v_mfma_f32_16x16x32_bf16 v[76:79],a[240:243],v[128:131],0
ds_read_b64_tr_b16 a[216:217],v245 offset:24576
ds_read_b64_tr_b16 a[218:219],v245 offset:26624
v_mfma_f32_16x16x32_bf16 v[76:79],a[244:247],v[132:135],v[76:79]
v_mfma_f32_16x16x32_bf16 v[76:79],a[248:251],v[136:139],v[76:79]
ds_read_b64_tr_b16 a[220:221],v245 offset:28672
ds_read_b64_tr_b16 a[222:223],v245 offset:30720
v_mfma_f32_16x16x32_bf16 v[76:79],a[252:255],v[140:143],v[76:79]
s_waitcnt vmcnt(24)
s_barrier
s_waitcnt lgkmcnt(6)
v_mfma_f32_16x16x32_bf16 v[16:19],a[192:195],v[160:163],v[16:19]
ds_read_b64_tr_b16 a[224:225],v246 offset:16384
ds_read_b64_tr_b16 a[226:227],v246 offset:18432
s_add_u32 m0,s25,0
s_add_u32 s28,s67,115200
v_mfma_f32_16x16x32_bf16 v[16:19],a[196:199],v[164:167],v[16:19]
buffer_load_dwordx4 v236,s[96:99],s28 offen lds
buffer_load_dwordx4 v237,s[96:99],s28 offen offset:1024 lds
v_mfma_f32_16x16x32_bf16 v[16:19],a[200:203],v[168:171],v[16:19]
ds_read_b64_tr_b16 a[228:229],v246 offset:20480
ds_read_b64_tr_b16 a[230:231],v246 offset:22528
buffer_load_dwordx4 v238,s[96:99],s28 offen offset:2048 lds
v_mfma_f32_16x16x32_bf16 v[16:19],a[204:207],v[172:175],v[16:19]
buffer_load_dwordx4 v239,s[96:99],s28 offen offset:3072 lds
v_mfma_f32_16x16x32_bf16 v[20:23],a[192:195],v[176:179],v[20:23]
ds_read_b64_tr_b16 a[232:233],v246 offset:24576
ds_read_b64_tr_b16 a[234:235],v246 offset:26624
v_mfma_f32_16x16x32_bf16 v[20:23],a[196:199],v[180:183],v[20:23]
v_mfma_f32_16x16x32_bf16 v[20:23],a[200:203],v[184:187],v[20:23]
ds_read_b64_tr_b16 a[236:237],v246 offset:28672
ds_read_b64_tr_b16 a[238:239],v246 offset:30720
v_mfma_f32_16x16x32_bf16 v[20:23],a[204:207],v[188:191],v[20:23]
v_mfma_f32_16x16x32_bf16 v[24:27],a[208:211],v[160:163],v[24:27]
ds_read_b64_tr_b16 a[240:241],v247 offset:16384
ds_read_b64_tr_b16 a[242:243],v247 offset:18432
s_waitcnt lgkmcnt(8)
v_mfma_f32_16x16x32_bf16 v[24:27],a[212:215],v[164:167],v[24:27]
v_mfma_f32_16x16x32_bf16 v[24:27],a[216:219],v[168:171],v[24:27]
ds_read_b64_tr_b16 a[244:245],v247 offset:20480
ds_read_b64_tr_b16 a[246:247],v247 offset:22528
v_mfma_f32_16x16x32_bf16 v[24:27],a[220:223],v[172:175],v[24:27]
v_mfma_f32_16x16x32_bf16 v[28:31],a[208:211],v[176:179],v[28:31]
ds_read_b64_tr_b16 a[248:249],v247 offset:24576
ds_read_b64_tr_b16 a[250:251],v247 offset:26624
v_mfma_f32_16x16x32_bf16 v[28:31],a[212:215],v[180:183],v[28:31]
v_mfma_f32_16x16x32_bf16 v[28:31],a[216:219],v[184:187],v[28:31]
ds_read_b64_tr_b16 a[252:253],v247 offset:28672
ds_read_b64_tr_b16 a[254:255],v247 offset:30720
v_mfma_f32_16x16x32_bf16 v[28:31],a[220:223],v[188:191],v[28:31]
v_mfma_f32_16x16x32_bf16 v[32:35],a[224:227],v[160:163],v[32:35]
ds_read_b64_tr_b16 a[192:193],v244 offset:32768
ds_read_b64_tr_b16 a[194:195],v244 offset:34816
s_waitcnt lgkmcnt(8)
v_mfma_f32_16x16x32_bf16 v[32:35],a[228:231],v[164:167],v[32:35]
v_mfma_f32_16x16x32_bf16 v[32:35],a[232:235],v[168:171],v[32:35]
ds_read_b64_tr_b16 a[196:197],v244 offset:36864
ds_read_b64_tr_b16 a[198:199],v244 offset:38912
v_mfma_f32_16x16x32_bf16 v[32:35],a[236:239],v[172:175],v[32:35]
v_mfma_f32_16x16x32_bf16 v[36:39],a[224:227],v[176:179],v[36:39]
ds_read_b64_tr_b16 a[200:201],v244 offset:40960
ds_read_b64_tr_b16 a[202:203],v244 offset:43008
v_mfma_f32_16x16x32_bf16 v[36:39],a[228:231],v[180:183],v[36:39]
v_mfma_f32_16x16x32_bf16 v[36:39],a[232:235],v[184:187],v[36:39]
ds_read_b64_tr_b16 a[204:205],v244 offset:45056
ds_read_b64_tr_b16 a[206:207],v244 offset:47104
v_mfma_f32_16x16x32_bf16 v[36:39],a[236:239],v[188:191],v[36:39]
v_mfma_f32_16x16x32_bf16 v[40:43],a[240:243],v[160:163],v[40:43]
ds_read_b64_tr_b16 a[208:209],v245 offset:32768
ds_read_b64_tr_b16 a[210:211],v245 offset:34816
s_waitcnt lgkmcnt(10)
v_mfma_f32_16x16x32_bf16 v[40:43],a[244:247],v[164:167],v[40:43]
v_mfma_f32_16x16x32_bf16 v[40:43],a[248:251],v[168:171],v[40:43]
ds_read_b64_tr_b16 a[212:213],v245 offset:36864
ds_read_b64_tr_b16 a[214:215],v245 offset:38912
v_mfma_f32_16x16x32_bf16 v[40:43],a[252:255],v[172:175],v[40:43]
v_mfma_f32_16x16x32_bf16 v[44:47],a[240:243],v[176:179],v[44:47]
ds_read_b64_tr_b16 a[216:217],v245 offset:40960
ds_read_b64_tr_b16 a[218:219],v245 offset:43008
v_mfma_f32_16x16x32_bf16 v[44:47],a[244:247],v[180:183],v[44:47]
v_mfma_f32_16x16x32_bf16 v[44:47],a[248:251],v[184:187],v[44:47]
ds_read_b64_tr_b16 a[220:221],v245 offset:45056
ds_read_b64_tr_b16 a[222:223],v245 offset:47104
v_mfma_f32_16x16x32_bf16 v[44:47],a[252:255],v[188:191],v[44:47]
s_waitcnt vmcnt(24)
s_barrier
s_waitcnt lgkmcnt(6)
v_mfma_f32_16x16x32_bf16 v[48:51],a[192:195],v[160:163],v[48:51]
ds_read_b64_tr_b16 a[224:225],v246 offset:32768
ds_read_b64_tr_b16 a[226:227],v246 offset:34816
s_add_u32 m0,s25,16384
s_add_u32 s28,s67,640
v_mfma_f32_16x16x32_bf16 v[48:51],a[196:199],v[164:167],v[48:51]
buffer_load_dwordx4 v236,s[96:99],s28 offen lds
buffer_load_dwordx4 v237,s[96:99],s28 offen offset:1024 lds
v_mfma_f32_16x16x32_bf16 v[48:51],a[200:203],v[168:171],v[48:51]
ds_read_b64_tr_b16 a[228:229],v246 offset:36864
ds_read_b64_tr_b16 a[230:231],v246 offset:38912
buffer_load_dwordx4 v238,s[96:99],s28 offen offset:2048 lds
v_mfma_f32_16x16x32_bf16 v[48:51],a[204:207],v[172:175],v[48:51]
buffer_load_dwordx4 v239,s[96:99],s28 offen offset:3072 lds
v_mfma_f32_16x16x32_bf16 v[52:55],a[192:195],v[176:179],v[52:55]
ds_read_b64_tr_b16 a[232:233],v246 offset:40960
ds_read_b64_tr_b16 a[234:235],v246 offset:43008
v_cvt_pk_bf16_f32 v16,v16,v17
v_cvt_pk_bf16_f32 v17,v18,v19
v_mfma_f32_16x16x32_bf16 v[52:55],a[196:199],v[180:183],v[52:55]
v_cvt_pk_bf16_f32 v18,v24,v25
v_cvt_pk_bf16_f32 v19,v26,v27
buffer_store_dwordx4 v[16:19],v248,s[20:23],s62 offen sc0 sc1
v_mfma_f32_16x16x32_bf16 v[52:55],a[200:203],v[184:187],v[52:55]
ds_read_b64_tr_b16 a[236:237],v246 offset:45056
ds_read_b64_tr_b16 a[238:239],v246 offset:47104
v_cvt_pk_bf16_f32 v20,v20,v21
v_cvt_pk_bf16_f32 v21,v22,v23
v_mfma_f32_16x16x32_bf16 v[52:55],a[204:207],v[188:191],v[52:55]
v_cvt_pk_bf16_f32 v22,v28,v29
v_cvt_pk_bf16_f32 v23,v30,v31
buffer_store_dwordx4 v[20:23],v248,s[20:23],s63 offen sc0 sc1
v_mfma_f32_16x16x32_bf16 v[56:59],a[208:211],v[160:163],v[56:59]
ds_read_b64_tr_b16 a[240:241],v247 offset:32768
ds_read_b64_tr_b16 a[242:243],v247 offset:34816
v_cvt_pk_bf16_f32 v32,v32,v33
s_waitcnt lgkmcnt(8)
v_mfma_f32_16x16x32_bf16 v[56:59],a[212:215],v[164:167],v[56:59]
v_cvt_pk_bf16_f32 v33,v34,v35
v_cvt_pk_bf16_f32 v34,v40,v41
v_cvt_pk_bf16_f32 v35,v42,v43
v_mfma_f32_16x16x32_bf16 v[56:59],a[216:219],v[168:171],v[56:59]
ds_read_b64_tr_b16 a[244:245],v247 offset:36864
ds_read_b64_tr_b16 a[246:247],v247 offset:38912
buffer_store_dwordx4 v[32:35],v249,s[20:23],s62 offen sc0 sc1
v_mfma_f32_16x16x32_bf16 v[56:59],a[220:223],v[172:175],v[56:59]
s_add_u32 s62,s62,32768
v_cvt_pk_bf16_f32 v36,v36,v37
v_cvt_pk_bf16_f32 v37,v38,v39
v_cvt_pk_bf16_f32 v38,v44,v45
v_mfma_f32_16x16x32_bf16 v[60:63],a[208:211],v[176:179],v[60:63]
ds_read_b64_tr_b16 a[248:249],v247 offset:40960
ds_read_b64_tr_b16 a[250:251],v247 offset:43008
v_cvt_pk_bf16_f32 v39,v46,v47
v_mfma_f32_16x16x32_bf16 v[60:63],a[212:215],v[180:183],v[60:63]
buffer_store_dwordx4 v[36:39],v249,s[20:23],s63 offen sc0 sc1
s_add_u32 s63,s63,32768
v_mfma_f32_16x16x32_bf16 v[60:63],a[216:219],v[184:187],v[60:63]
ds_read_b64_tr_b16 a[252:253],v247 offset:45056
ds_read_b64_tr_b16 a[254:255],v247 offset:47104
v_mfma_f32_16x16x32_bf16 v[60:63],a[220:223],v[188:191],v[60:63]
v_mfma_f32_16x16x32_bf16 v[64:67],a[224:227],v[160:163],v[64:67]
ds_read_b64_tr_b16 a[192:193],v244 offset:49152
ds_read_b64_tr_b16 a[194:195],v244 offset:51200
s_waitcnt lgkmcnt(8)
v_mfma_f32_16x16x32_bf16 v[64:67],a[228:231],v[164:167],v[64:67]
v_mfma_f32_16x16x32_bf16 v[64:67],a[232:235],v[168:171],v[64:67]
ds_read_b64_tr_b16 a[196:197],v244 offset:53248
ds_read_b64_tr_b16 a[198:199],v244 offset:55296
v_mfma_f32_16x16x32_bf16 v[64:67],a[236:239],v[172:175],v[64:67]
v_mfma_f32_16x16x32_bf16 v[68:71],a[224:227],v[176:179],v[68:71]
ds_read_b64_tr_b16 a[200:201],v244 offset:57344
ds_read_b64_tr_b16 a[202:203],v244 offset:59392
v_mfma_f32_16x16x32_bf16 v[68:71],a[228:231],v[180:183],v[68:71]
v_mfma_f32_16x16x32_bf16 v[68:71],a[232:235],v[184:187],v[68:71]
ds_read_b64_tr_b16 a[204:205],v244 offset:61440
ds_read_b64_tr_b16 a[206:207],v244 offset:63488
v_mfma_f32_16x16x32_bf16 v[68:71],a[236:239],v[188:191],v[68:71]
v_mfma_f32_16x16x32_bf16 v[72:75],a[240:243],v[160:163],v[72:75]
ds_read_b64_tr_b16 a[208:209],v245 offset:49152
ds_read_b64_tr_b16 a[210:211],v245 offset:51200
s_waitcnt lgkmcnt(10)
v_mfma_f32_16x16x32_bf16 v[72:75],a[244:247],v[164:167],v[72:75]
v_mfma_f32_16x16x32_bf16 v[72:75],a[248:251],v[168:171],v[72:75]
ds_read_b64_tr_b16 a[212:213],v245 offset:53248
ds_read_b64_tr_b16 a[214:215],v245 offset:55296
v_mfma_f32_16x16x32_bf16 v[72:75],a[252:255],v[172:175],v[72:75]
v_mfma_f32_16x16x32_bf16 v[76:79],a[240:243],v[176:179],v[76:79]
ds_read_b64_tr_b16 a[216:217],v245 offset:57344
ds_read_b64_tr_b16 a[218:219],v245 offset:59392
v_mfma_f32_16x16x32_bf16 v[76:79],a[244:247],v[180:183],v[76:79]
v_mfma_f32_16x16x32_bf16 v[76:79],a[248:251],v[184:187],v[76:79]
ds_read_b64_tr_b16 a[220:221],v245 offset:61440
ds_read_b64_tr_b16 a[222:223],v245 offset:63488
v_mfma_f32_16x16x32_bf16 v[76:79],a[252:255],v[188:191],v[76:79]
s_waitcnt vmcnt(28)
s_barrier
s_waitcnt lgkmcnt(6)
v_mfma_f32_16x16x32_bf16 v[16:19],a[192:195],v[112:115],0
ds_read_b64_tr_b16 a[224:225],v246 offset:49152
ds_read_b64_tr_b16 a[226:227],v246 offset:51200
s_add_u32 m0,s25,32768
s_add_u32 s28,s67,115328
v_mfma_f32_16x16x32_bf16 v[16:19],a[196:199],v[116:119],v[16:19]
buffer_load_dwordx4 v236,s[96:99],s28 offen lds
buffer_load_dwordx4 v237,s[96:99],s28 offen offset:1024 lds
v_mfma_f32_16x16x32_bf16 v[16:19],a[200:203],v[120:123],v[16:19]
ds_read_b64_tr_b16 a[228:229],v246 offset:53248
ds_read_b64_tr_b16 a[230:231],v246 offset:55296
buffer_load_dwordx4 v238,s[96:99],s28 offen offset:2048 lds
v_mfma_f32_16x16x32_bf16 v[16:19],a[204:207],v[124:127],v[16:19]
buffer_load_dwordx4 v239,s[96:99],s28 offen offset:3072 lds
v_mfma_f32_16x16x32_bf16 v[20:23],a[192:195],v[128:131],0
ds_read_b64_tr_b16 a[232:233],v246 offset:57344
ds_read_b64_tr_b16 a[234:235],v246 offset:59392
v_cvt_pk_bf16_f32 v48,v48,v49
v_cvt_pk_bf16_f32 v49,v50,v51
v_mfma_f32_16x16x32_bf16 v[20:23],a[196:199],v[132:135],v[20:23]
v_cvt_pk_bf16_f32 v50,v56,v57
v_cvt_pk_bf16_f32 v51,v58,v59
buffer_store_dwordx4 v[48:51],v248,s[20:23],s62 offen sc0 sc1
v_mfma_f32_16x16x32_bf16 v[20:23],a[200:203],v[136:139],v[20:23]
ds_read_b64_tr_b16 a[236:237],v246 offset:61440
ds_read_b64_tr_b16 a[238:239],v246 offset:63488
v_cvt_pk_bf16_f32 v52,v52,v53
v_cvt_pk_bf16_f32 v53,v54,v55
v_mfma_f32_16x16x32_bf16 v[20:23],a[204:207],v[140:143],v[20:23]
v_cvt_pk_bf16_f32 v54,v60,v61
v_cvt_pk_bf16_f32 v55,v62,v63
buffer_store_dwordx4 v[52:55],v248,s[20:23],s63 offen sc0 sc1
v_mfma_f32_16x16x32_bf16 v[24:27],a[208:211],v[112:115],0
ds_read_b64_tr_b16 a[240:241],v247 offset:49152
ds_read_b64_tr_b16 a[242:243],v247 offset:51200
s_waitcnt lgkmcnt(8)
v_mfma_f32_16x16x32_bf16 v[24:27],a[212:215],v[116:119],v[24:27]
v_mfma_f32_16x16x32_bf16 v[24:27],a[216:219],v[120:123],v[24:27]
ds_read_b64_tr_b16 a[244:245],v247 offset:53248
ds_read_b64_tr_b16 a[246:247],v247 offset:55296
v_mfma_f32_16x16x32_bf16 v[24:27],a[220:223],v[124:127],v[24:27]
v_mfma_f32_16x16x32_bf16 v[28:31],a[208:211],v[128:131],0
ds_read_b64_tr_b16 a[248:249],v247 offset:57344
ds_read_b64_tr_b16 a[250:251],v247 offset:59392
v_mfma_f32_16x16x32_bf16 v[28:31],a[212:215],v[132:135],v[28:31]
v_mfma_f32_16x16x32_bf16 v[28:31],a[216:219],v[136:139],v[28:31]
ds_read_b64_tr_b16 a[252:253],v247 offset:61440
ds_read_b64_tr_b16 a[254:255],v247 offset:63488
v_mfma_f32_16x16x32_bf16 v[28:31],a[220:223],v[140:143],v[28:31]
v_mfma_f32_16x16x32_bf16 v[32:35],a[224:227],v[112:115],0
ds_read_b64_tr_b16 a[192:193],v240 offset:0
ds_read_b64_tr_b16 a[194:195],v240 offset:2048
s_waitcnt lgkmcnt(8)
v_mfma_f32_16x16x32_bf16 v[32:35],a[228:231],v[116:119],v[32:35]
v_mfma_f32_16x16x32_bf16 v[32:35],a[232:235],v[120:123],v[32:35]
ds_read_b64_tr_b16 a[196:197],v240 offset:4096
ds_read_b64_tr_b16 a[198:199],v240 offset:6144
v_mfma_f32_16x16x32_bf16 v[32:35],a[236:239],v[124:127],v[32:35]
v_mfma_f32_16x16x32_bf16 v[36:39],a[224:227],v[128:131],0
ds_read_b64_tr_b16 a[200:201],v240 offset:8192
ds_read_b64_tr_b16 a[202:203],v240 offset:10240
v_mfma_f32_16x16x32_bf16 v[36:39],a[228:231],v[132:135],v[36:39]
v_mfma_f32_16x16x32_bf16 v[36:39],a[232:235],v[136:139],v[36:39]
ds_read_b64_tr_b16 a[204:205],v240 offset:12288
ds_read_b64_tr_b16 a[206:207],v240 offset:14336
v_mfma_f32_16x16x32_bf16 v[36:39],a[236:239],v[140:143],v[36:39]
v_mfma_f32_16x16x32_bf16 v[40:43],a[240:243],v[112:115],0
ds_read_b64_tr_b16 a[208:209],v241 offset:0
ds_read_b64_tr_b16 a[210:211],v241 offset:2048
s_waitcnt lgkmcnt(10)
v_mfma_f32_16x16x32_bf16 v[40:43],a[244:247],v[116:119],v[40:43]
v_mfma_f32_16x16x32_bf16 v[40:43],a[248:251],v[120:123],v[40:43]
ds_read_b64_tr_b16 a[212:213],v241 offset:4096
ds_read_b64_tr_b16 a[214:215],v241 offset:6144
v_mfma_f32_16x16x32_bf16 v[40:43],a[252:255],v[124:127],v[40:43]
v_mfma_f32_16x16x32_bf16 v[44:47],a[240:243],v[128:131],0
ds_read_b64_tr_b16 a[216:217],v241 offset:8192
ds_read_b64_tr_b16 a[218:219],v241 offset:10240
v_mfma_f32_16x16x32_bf16 v[44:47],a[244:247],v[132:135],v[44:47]
v_mfma_f32_16x16x32_bf16 v[44:47],a[248:251],v[136:139],v[44:47]
ds_read_b64_tr_b16 a[220:221],v241 offset:12288
ds_read_b64_tr_b16 a[222:223],v241 offset:14336
v_mfma_f32_16x16x32_bf16 v[44:47],a[252:255],v[140:143],v[44:47]
s_waitcnt vmcnt(26)
s_barrier
s_waitcnt lgkmcnt(6)
v_mfma_f32_16x16x32_bf16 v[16:19],a[192:195],v[160:163],v[16:19]
ds_read_b64_tr_b16 a[224:225],v242 offset:0
ds_read_b64_tr_b16 a[226:227],v242 offset:2048
s_add_u32 m0,s25,49152
s_add_u32 s28,s67,768
v_mfma_f32_16x16x32_bf16 v[16:19],a[196:199],v[164:167],v[16:19]
buffer_load_dwordx4 v236,s[96:99],s28 offen lds
buffer_load_dwordx4 v237,s[96:99],s28 offen offset:1024 lds
v_mfma_f32_16x16x32_bf16 v[16:19],a[200:203],v[168:171],v[16:19]
ds_read_b64_tr_b16 a[228:229],v242 offset:4096
ds_read_b64_tr_b16 a[230:231],v242 offset:6144
buffer_load_dwordx4 v238,s[96:99],s28 offen offset:2048 lds
v_mfma_f32_16x16x32_bf16 v[16:19],a[204:207],v[172:175],v[16:19]
buffer_load_dwordx4 v239,s[96:99],s28 offen offset:3072 lds
v_mfma_f32_16x16x32_bf16 v[20:23],a[192:195],v[176:179],v[20:23]
ds_read_b64_tr_b16 a[232:233],v242 offset:8192
ds_read_b64_tr_b16 a[234:235],v242 offset:10240
v_cvt_pk_bf16_f32 v64,v64,v65
v_cvt_pk_bf16_f32 v65,v66,v67
v_mfma_f32_16x16x32_bf16 v[20:23],a[196:199],v[180:183],v[20:23]
v_cvt_pk_bf16_f32 v66,v72,v73
v_cvt_pk_bf16_f32 v67,v74,v75
buffer_store_dwordx4 v[64:67],v249,s[20:23],s62 offen sc0 sc1
v_mfma_f32_16x16x32_bf16 v[20:23],a[200:203],v[184:187],v[20:23]
ds_read_b64_tr_b16 a[236:237],v242 offset:12288
ds_read_b64_tr_b16 a[238:239],v242 offset:14336
s_add_u32 s62,s62,32768
v_cvt_pk_bf16_f32 v68,v68,v69
v_mfma_f32_16x16x32_bf16 v[20:23],a[204:207],v[188:191],v[20:23]
v_cvt_pk_bf16_f32 v69,v70,v71
v_cvt_pk_bf16_f32 v70,v76,v77
v_cvt_pk_bf16_f32 v71,v78,v79
v_mfma_f32_16x16x32_bf16 v[24:27],a[208:211],v[160:163],v[24:27]
ds_read_b64_tr_b16 a[240:241],v243 offset:0
ds_read_b64_tr_b16 a[242:243],v243 offset:2048
s_waitcnt lgkmcnt(8)
v_mfma_f32_16x16x32_bf16 v[24:27],a[212:215],v[164:167],v[24:27]
buffer_store_dwordx4 v[68:71],v249,s[20:23],s63 offen sc0 sc1
s_add_u32 s63,s63,32768
v_mfma_f32_16x16x32_bf16 v[24:27],a[216:219],v[168:171],v[24:27]
ds_read_b64_tr_b16 a[244:245],v243 offset:4096
ds_read_b64_tr_b16 a[246:247],v243 offset:6144
v_mfma_f32_16x16x32_bf16 v[24:27],a[220:223],v[172:175],v[24:27]
v_mfma_f32_16x16x32_bf16 v[28:31],a[208:211],v[176:179],v[28:31]
ds_read_b64_tr_b16 a[248:249],v243 offset:8192
ds_read_b64_tr_b16 a[250:251],v243 offset:10240
v_mfma_f32_16x16x32_bf16 v[28:31],a[212:215],v[180:183],v[28:31]
v_mfma_f32_16x16x32_bf16 v[28:31],a[216:219],v[184:187],v[28:31]
ds_read_b64_tr_b16 a[252:253],v243 offset:12288
ds_read_b64_tr_b16 a[254:255],v243 offset:14336
v_mfma_f32_16x16x32_bf16 v[28:31],a[220:223],v[188:191],v[28:31]
v_mfma_f32_16x16x32_bf16 v[32:35],a[224:227],v[160:163],v[32:35]
ds_read_b64_tr_b16 a[192:193],v240 offset:16384
ds_read_b64_tr_b16 a[194:195],v240 offset:18432
s_waitcnt lgkmcnt(8)
v_mfma_f32_16x16x32_bf16 v[32:35],a[228:231],v[164:167],v[32:35]
v_mfma_f32_16x16x32_bf16 v[32:35],a[232:235],v[168:171],v[32:35]
ds_read_b64_tr_b16 a[196:197],v240 offset:20480
ds_read_b64_tr_b16 a[198:199],v240 offset:22528
v_mfma_f32_16x16x32_bf16 v[32:35],a[236:239],v[172:175],v[32:35]
v_mfma_f32_16x16x32_bf16 v[36:39],a[224:227],v[176:179],v[36:39]
ds_read_b64_tr_b16 a[200:201],v240 offset:24576
ds_read_b64_tr_b16 a[202:203],v240 offset:26624
v_mfma_f32_16x16x32_bf16 v[36:39],a[228:231],v[180:183],v[36:39]
v_mfma_f32_16x16x32_bf16 v[36:39],a[232:235],v[184:187],v[36:39]
ds_read_b64_tr_b16 a[204:205],v240 offset:28672
ds_read_b64_tr_b16 a[206:207],v240 offset:30720
v_mfma_f32_16x16x32_bf16 v[36:39],a[236:239],v[188:191],v[36:39]
v_mfma_f32_16x16x32_bf16 v[40:43],a[240:243],v[160:163],v[40:43]
ds_read_b64_tr_b16 a[208:209],v241 offset:16384
ds_read_b64_tr_b16 a[210:211],v241 offset:18432
s_waitcnt lgkmcnt(10)
v_mfma_f32_16x16x32_bf16 v[40:43],a[244:247],v[164:167],v[40:43]
v_mfma_f32_16x16x32_bf16 v[40:43],a[248:251],v[168:171],v[40:43]
ds_read_b64_tr_b16 a[212:213],v241 offset:20480
ds_read_b64_tr_b16 a[214:215],v241 offset:22528
v_mfma_f32_16x16x32_bf16 v[40:43],a[252:255],v[172:175],v[40:43]
v_mfma_f32_16x16x32_bf16 v[44:47],a[240:243],v[176:179],v[44:47]
ds_read_b64_tr_b16 a[216:217],v241 offset:24576
ds_read_b64_tr_b16 a[218:219],v241 offset:26624
v_mfma_f32_16x16x32_bf16 v[44:47],a[244:247],v[180:183],v[44:47]
v_mfma_f32_16x16x32_bf16 v[44:47],a[248:251],v[184:187],v[44:47]
ds_read_b64_tr_b16 a[220:221],v241 offset:28672
ds_read_b64_tr_b16 a[222:223],v241 offset:30720
v_mfma_f32_16x16x32_bf16 v[44:47],a[252:255],v[188:191],v[44:47]
s_waitcnt vmcnt(28)
s_barrier
s_waitcnt lgkmcnt(6)
v_mfma_f32_16x16x32_bf16 v[48:51],a[192:195],v[112:115],0
ds_read_b64_tr_b16 a[224:225],v242 offset:16384
ds_read_b64_tr_b16 a[226:227],v242 offset:18432
s_add_u32 m0,s25,81920
s_add_u32 s28,s67,115456
v_mfma_f32_16x16x32_bf16 v[48:51],a[196:199],v[116:119],v[48:51]
buffer_load_dwordx4 v236,s[96:99],s28 offen lds
buffer_load_dwordx4 v237,s[96:99],s28 offen offset:1024 lds
v_mfma_f32_16x16x32_bf16 v[48:51],a[200:203],v[120:123],v[48:51]
ds_read_b64_tr_b16 a[228:229],v242 offset:20480
ds_read_b64_tr_b16 a[230:231],v242 offset:22528
buffer_load_dwordx4 v238,s[96:99],s28 offen offset:2048 lds
v_mfma_f32_16x16x32_bf16 v[48:51],a[204:207],v[124:127],v[48:51]
buffer_load_dwordx4 v239,s[96:99],s28 offen offset:3072 lds
v_mfma_f32_16x16x32_bf16 v[52:55],a[192:195],v[128:131],0
ds_read_b64_tr_b16 a[232:233],v242 offset:24576
ds_read_b64_tr_b16 a[234:235],v242 offset:26624
v_cvt_pk_bf16_f32 v16,v16,v17
v_cvt_pk_bf16_f32 v17,v18,v19
v_mfma_f32_16x16x32_bf16 v[52:55],a[196:199],v[132:135],v[52:55]
v_cvt_pk_bf16_f32 v18,v24,v25
v_cvt_pk_bf16_f32 v19,v26,v27
buffer_store_dwordx4 v[16:19],v248,s[20:23],s62 offen sc0 sc1
v_mfma_f32_16x16x32_bf16 v[52:55],a[200:203],v[136:139],v[52:55]
ds_read_b64_tr_b16 a[236:237],v242 offset:28672
ds_read_b64_tr_b16 a[238:239],v242 offset:30720
v_cvt_pk_bf16_f32 v20,v20,v21
v_cvt_pk_bf16_f32 v21,v22,v23
v_mfma_f32_16x16x32_bf16 v[52:55],a[204:207],v[140:143],v[52:55]
v_cvt_pk_bf16_f32 v22,v28,v29
v_cvt_pk_bf16_f32 v23,v30,v31
buffer_store_dwordx4 v[20:23],v248,s[20:23],s63 offen sc0 sc1
v_mfma_f32_16x16x32_bf16 v[56:59],a[208:211],v[112:115],0
ds_read_b64_tr_b16 a[240:241],v243 offset:16384
ds_read_b64_tr_b16 a[242:243],v243 offset:18432
s_waitcnt lgkmcnt(8)
v_mfma_f32_16x16x32_bf16 v[56:59],a[212:215],v[116:119],v[56:59]
v_mfma_f32_16x16x32_bf16 v[56:59],a[216:219],v[120:123],v[56:59]
ds_read_b64_tr_b16 a[244:245],v243 offset:20480
ds_read_b64_tr_b16 a[246:247],v243 offset:22528
v_mfma_f32_16x16x32_bf16 v[56:59],a[220:223],v[124:127],v[56:59]
v_mfma_f32_16x16x32_bf16 v[60:63],a[208:211],v[128:131],0
ds_read_b64_tr_b16 a[248:249],v243 offset:24576
ds_read_b64_tr_b16 a[250:251],v243 offset:26624
v_mfma_f32_16x16x32_bf16 v[60:63],a[212:215],v[132:135],v[60:63]
v_mfma_f32_16x16x32_bf16 v[60:63],a[216:219],v[136:139],v[60:63]
ds_read_b64_tr_b16 a[252:253],v243 offset:28672
ds_read_b64_tr_b16 a[254:255],v243 offset:30720
v_mfma_f32_16x16x32_bf16 v[60:63],a[220:223],v[140:143],v[60:63]
v_mfma_f32_16x16x32_bf16 v[64:67],a[224:227],v[112:115],0
ds_read_b64_tr_b16 a[192:193],v240 offset:32768
ds_read_b64_tr_b16 a[194:195],v240 offset:34816
s_waitcnt lgkmcnt(8)
v_mfma_f32_16x16x32_bf16 v[64:67],a[228:231],v[116:119],v[64:67]
v_mfma_f32_16x16x32_bf16 v[64:67],a[232:235],v[120:123],v[64:67]
ds_read_b64_tr_b16 a[196:197],v240 offset:36864
ds_read_b64_tr_b16 a[198:199],v240 offset:38912
v_mfma_f32_16x16x32_bf16 v[64:67],a[236:239],v[124:127],v[64:67]
v_mfma_f32_16x16x32_bf16 v[68:71],a[224:227],v[128:131],0
ds_read_b64_tr_b16 a[200:201],v240 offset:40960
ds_read_b64_tr_b16 a[202:203],v240 offset:43008
v_mfma_f32_16x16x32_bf16 v[68:71],a[228:231],v[132:135],v[68:71]
v_mfma_f32_16x16x32_bf16 v[68:71],a[232:235],v[136:139],v[68:71]
ds_read_b64_tr_b16 a[204:205],v240 offset:45056
ds_read_b64_tr_b16 a[206:207],v240 offset:47104
v_mfma_f32_16x16x32_bf16 v[68:71],a[236:239],v[140:143],v[68:71]
v_mfma_f32_16x16x32_bf16 v[72:75],a[240:243],v[112:115],0
ds_read_b64_tr_b16 a[208:209],v241 offset:32768
ds_read_b64_tr_b16 a[210:211],v241 offset:34816
s_waitcnt lgkmcnt(10)
v_mfma_f32_16x16x32_bf16 v[72:75],a[244:247],v[116:119],v[72:75]
v_mfma_f32_16x16x32_bf16 v[72:75],a[248:251],v[120:123],v[72:75]
ds_read_b64_tr_b16 a[212:213],v241 offset:36864
ds_read_b64_tr_b16 a[214:215],v241 offset:38912
v_mfma_f32_16x16x32_bf16 v[72:75],a[252:255],v[124:127],v[72:75]
v_mfma_f32_16x16x32_bf16 v[76:79],a[240:243],v[128:131],0
ds_read_b64_tr_b16 a[216:217],v241 offset:40960
ds_read_b64_tr_b16 a[218:219],v241 offset:43008
v_mfma_f32_16x16x32_bf16 v[76:79],a[244:247],v[132:135],v[76:79]
v_mfma_f32_16x16x32_bf16 v[76:79],a[248:251],v[136:139],v[76:79]
ds_read_b64_tr_b16 a[220:221],v241 offset:45056
ds_read_b64_tr_b16 a[222:223],v241 offset:47104
v_mfma_f32_16x16x32_bf16 v[76:79],a[252:255],v[140:143],v[76:79]
s_waitcnt vmcnt(30)
s_barrier
s_waitcnt lgkmcnt(6)
v_mfma_f32_16x16x32_bf16 v[48:51],a[192:195],v[160:163],v[48:51]
ds_read_b64_tr_b16 a[224:225],v242 offset:32768
ds_read_b64_tr_b16 a[226:227],v242 offset:34816
v_mfma_f32_16x16x32_bf16 v[48:51],a[196:199],v[164:167],v[48:51]
v_mfma_f32_16x16x32_bf16 v[48:51],a[200:203],v[168:171],v[48:51]
ds_read_b64_tr_b16 a[228:229],v242 offset:36864
ds_read_b64_tr_b16 a[230:231],v242 offset:38912
v_mfma_f32_16x16x32_bf16 v[48:51],a[204:207],v[172:175],v[48:51]
v_mfma_f32_16x16x32_bf16 v[52:55],a[192:195],v[176:179],v[52:55]
ds_read_b64_tr_b16 a[232:233],v242 offset:40960
ds_read_b64_tr_b16 a[234:235],v242 offset:43008
v_cvt_pk_bf16_f32 v32,v32,v33
v_cvt_pk_bf16_f32 v33,v34,v35
v_mfma_f32_16x16x32_bf16 v[52:55],a[196:199],v[180:183],v[52:55]
v_cvt_pk_bf16_f32 v34,v40,v41
v_cvt_pk_bf16_f32 v35,v42,v43
buffer_store_dwordx4 v[32:35],v249,s[20:23],s62 offen sc0 sc1
v_mfma_f32_16x16x32_bf16 v[52:55],a[200:203],v[184:187],v[52:55]
ds_read_b64_tr_b16 a[236:237],v242 offset:45056
ds_read_b64_tr_b16 a[238:239],v242 offset:47104
s_add_u32 s62,s62,32768
v_cvt_pk_bf16_f32 v36,v36,v37
v_mfma_f32_16x16x32_bf16 v[52:55],a[204:207],v[188:191],v[52:55]
v_cvt_pk_bf16_f32 v37,v38,v39
v_cvt_pk_bf16_f32 v38,v44,v45
v_cvt_pk_bf16_f32 v39,v46,v47
v_mfma_f32_16x16x32_bf16 v[56:59],a[208:211],v[160:163],v[56:59]
ds_read_b64_tr_b16 a[240:241],v243 offset:32768
ds_read_b64_tr_b16 a[242:243],v243 offset:34816
s_waitcnt lgkmcnt(8)
v_mfma_f32_16x16x32_bf16 v[56:59],a[212:215],v[164:167],v[56:59]
buffer_store_dwordx4 v[36:39],v249,s[20:23],s63 offen sc0 sc1
s_add_u32 s63,s63,32768
v_mfma_f32_16x16x32_bf16 v[56:59],a[216:219],v[168:171],v[56:59]
ds_read_b64_tr_b16 a[244:245],v243 offset:36864
ds_read_b64_tr_b16 a[246:247],v243 offset:38912
v_mfma_f32_16x16x32_bf16 v[56:59],a[220:223],v[172:175],v[56:59]
v_mfma_f32_16x16x32_bf16 v[60:63],a[208:211],v[176:179],v[60:63]
ds_read_b64_tr_b16 a[248:249],v243 offset:40960
ds_read_b64_tr_b16 a[250:251],v243 offset:43008
v_mfma_f32_16x16x32_bf16 v[60:63],a[212:215],v[180:183],v[60:63]
v_mfma_f32_16x16x32_bf16 v[60:63],a[216:219],v[184:187],v[60:63]
ds_read_b64_tr_b16 a[252:253],v243 offset:45056
ds_read_b64_tr_b16 a[254:255],v243 offset:47104
v_mfma_f32_16x16x32_bf16 v[60:63],a[220:223],v[188:191],v[60:63]
v_mfma_f32_16x16x32_bf16 v[64:67],a[224:227],v[160:163],v[64:67]
ds_read_b64_tr_b16 a[192:193],v240 offset:49152
ds_read_b64_tr_b16 a[194:195],v240 offset:51200
s_waitcnt lgkmcnt(8)
v_mfma_f32_16x16x32_bf16 v[64:67],a[228:231],v[164:167],v[64:67]
v_mfma_f32_16x16x32_bf16 v[64:67],a[232:235],v[168:171],v[64:67]
ds_read_b64_tr_b16 a[196:197],v240 offset:53248
ds_read_b64_tr_b16 a[198:199],v240 offset:55296
v_mfma_f32_16x16x32_bf16 v[64:67],a[236:239],v[172:175],v[64:67]
v_mfma_f32_16x16x32_bf16 v[68:71],a[224:227],v[176:179],v[68:71]
ds_read_b64_tr_b16 a[200:201],v240 offset:57344
ds_read_b64_tr_b16 a[202:203],v240 offset:59392
v_mfma_f32_16x16x32_bf16 v[68:71],a[228:231],v[180:183],v[68:71]
v_mfma_f32_16x16x32_bf16 v[68:71],a[232:235],v[184:187],v[68:71]
ds_read_b64_tr_b16 a[204:205],v240 offset:61440
ds_read_b64_tr_b16 a[206:207],v240 offset:63488
v_mfma_f32_16x16x32_bf16 v[68:71],a[236:239],v[188:191],v[68:71]
v_mfma_f32_16x16x32_bf16 v[72:75],a[240:243],v[160:163],v[72:75]
ds_read_b64_tr_b16 a[208:209],v241 offset:49152
ds_read_b64_tr_b16 a[210:211],v241 offset:51200
s_waitcnt lgkmcnt(10)
v_mfma_f32_16x16x32_bf16 v[72:75],a[244:247],v[164:167],v[72:75]
v_mfma_f32_16x16x32_bf16 v[72:75],a[248:251],v[168:171],v[72:75]
ds_read_b64_tr_b16 a[212:213],v241 offset:53248
ds_read_b64_tr_b16 a[214:215],v241 offset:55296
v_mfma_f32_16x16x32_bf16 v[72:75],a[252:255],v[172:175],v[72:75]
v_mfma_f32_16x16x32_bf16 v[76:79],a[240:243],v[176:179],v[76:79]
ds_read_b64_tr_b16 a[216:217],v241 offset:57344
ds_read_b64_tr_b16 a[218:219],v241 offset:59392
v_mfma_f32_16x16x32_bf16 v[76:79],a[244:247],v[180:183],v[76:79]
v_mfma_f32_16x16x32_bf16 v[76:79],a[248:251],v[184:187],v[76:79]
ds_read_b64_tr_b16 a[220:221],v241 offset:61440
ds_read_b64_tr_b16 a[222:223],v241 offset:63488
v_mfma_f32_16x16x32_bf16 v[76:79],a[252:255],v[188:191],v[76:79]
s_waitcnt vmcnt(28)
s_barrier
s_waitcnt lgkmcnt(6)
v_mfma_f32_16x16x32_bf16 v[16:19],a[192:195],v[112:115],0
ds_read_b64_tr_b16 a[224:225],v242 offset:49152
ds_read_b64_tr_b16 a[226:227],v242 offset:51200
v_mfma_f32_16x16x32_bf16 v[16:19],a[196:199],v[116:119],v[16:19]
v_mfma_f32_16x16x32_bf16 v[16:19],a[200:203],v[120:123],v[16:19]
ds_read_b64_tr_b16 a[228:229],v242 offset:53248
ds_read_b64_tr_b16 a[230:231],v242 offset:55296
v_mfma_f32_16x16x32_bf16 v[16:19],a[204:207],v[124:127],v[16:19]
v_mfma_f32_16x16x32_bf16 v[20:23],a[192:195],v[128:131],0
ds_read_b64_tr_b16 a[232:233],v242 offset:57344
ds_read_b64_tr_b16 a[234:235],v242 offset:59392
v_cvt_pk_bf16_f32 v48,v48,v49
v_cvt_pk_bf16_f32 v49,v50,v51
v_mfma_f32_16x16x32_bf16 v[20:23],a[196:199],v[132:135],v[20:23]
v_cvt_pk_bf16_f32 v50,v56,v57
v_cvt_pk_bf16_f32 v51,v58,v59
buffer_store_dwordx4 v[48:51],v248,s[20:23],s62 offen sc0 sc1
v_mfma_f32_16x16x32_bf16 v[20:23],a[200:203],v[136:139],v[20:23]
ds_read_b64_tr_b16 a[236:237],v242 offset:61440
ds_read_b64_tr_b16 a[238:239],v242 offset:63488
v_cvt_pk_bf16_f32 v52,v52,v53
v_cvt_pk_bf16_f32 v53,v54,v55
v_mfma_f32_16x16x32_bf16 v[20:23],a[204:207],v[140:143],v[20:23]
v_cvt_pk_bf16_f32 v54,v60,v61
v_cvt_pk_bf16_f32 v55,v62,v63
buffer_store_dwordx4 v[52:55],v248,s[20:23],s63 offen sc0 sc1
v_mfma_f32_16x16x32_bf16 v[24:27],a[208:211],v[112:115],0
ds_read_b64_tr_b16 a[240:241],v243 offset:49152
ds_read_b64_tr_b16 a[242:243],v243 offset:51200
s_waitcnt lgkmcnt(8)
v_mfma_f32_16x16x32_bf16 v[24:27],a[212:215],v[116:119],v[24:27]
v_mfma_f32_16x16x32_bf16 v[24:27],a[216:219],v[120:123],v[24:27]
ds_read_b64_tr_b16 a[244:245],v243 offset:53248
ds_read_b64_tr_b16 a[246:247],v243 offset:55296
v_mfma_f32_16x16x32_bf16 v[24:27],a[220:223],v[124:127],v[24:27]
v_mfma_f32_16x16x32_bf16 v[28:31],a[208:211],v[128:131],0
ds_read_b64_tr_b16 a[248:249],v243 offset:57344
ds_read_b64_tr_b16 a[250:251],v243 offset:59392
v_mfma_f32_16x16x32_bf16 v[28:31],a[212:215],v[132:135],v[28:31]
v_mfma_f32_16x16x32_bf16 v[28:31],a[216:219],v[136:139],v[28:31]
ds_read_b64_tr_b16 a[252:253],v243 offset:61440
ds_read_b64_tr_b16 a[254:255],v243 offset:63488
v_mfma_f32_16x16x32_bf16 v[28:31],a[220:223],v[140:143],v[28:31]
v_mfma_f32_16x16x32_bf16 v[32:35],a[224:227],v[112:115],0
ds_read_b64_tr_b16 a[192:193],v244 offset:0
ds_read_b64_tr_b16 a[194:195],v244 offset:2048
s_waitcnt lgkmcnt(8)
v_mfma_f32_16x16x32_bf16 v[32:35],a[228:231],v[116:119],v[32:35]
v_mfma_f32_16x16x32_bf16 v[32:35],a[232:235],v[120:123],v[32:35]
ds_read_b64_tr_b16 a[196:197],v244 offset:4096
ds_read_b64_tr_b16 a[198:199],v244 offset:6144
v_mfma_f32_16x16x32_bf16 v[32:35],a[236:239],v[124:127],v[32:35]
v_mfma_f32_16x16x32_bf16 v[36:39],a[224:227],v[128:131],0
ds_read_b64_tr_b16 a[200:201],v244 offset:8192
ds_read_b64_tr_b16 a[202:203],v244 offset:10240
v_mfma_f32_16x16x32_bf16 v[36:39],a[228:231],v[132:135],v[36:39]
v_mfma_f32_16x16x32_bf16 v[36:39],a[232:235],v[136:139],v[36:39]
ds_read_b64_tr_b16 a[204:205],v244 offset:12288
ds_read_b64_tr_b16 a[206:207],v244 offset:14336
v_mfma_f32_16x16x32_bf16 v[36:39],a[236:239],v[140:143],v[36:39]
v_mfma_f32_16x16x32_bf16 v[40:43],a[240:243],v[112:115],0
ds_read_b64_tr_b16 a[208:209],v245 offset:0
ds_read_b64_tr_b16 a[210:211],v245 offset:2048
s_waitcnt lgkmcnt(10)
v_mfma_f32_16x16x32_bf16 v[40:43],a[244:247],v[116:119],v[40:43]
v_mfma_f32_16x16x32_bf16 v[40:43],a[248:251],v[120:123],v[40:43]
ds_read_b64_tr_b16 a[212:213],v245 offset:4096
ds_read_b64_tr_b16 a[214:215],v245 offset:6144
v_mfma_f32_16x16x32_bf16 v[40:43],a[252:255],v[124:127],v[40:43]
v_mfma_f32_16x16x32_bf16 v[44:47],a[240:243],v[128:131],0
ds_read_b64_tr_b16 a[216:217],v245 offset:8192
ds_read_b64_tr_b16 a[218:219],v245 offset:10240
v_mfma_f32_16x16x32_bf16 v[44:47],a[244:247],v[132:135],v[44:47]
v_mfma_f32_16x16x32_bf16 v[44:47],a[248:251],v[136:139],v[44:47]
ds_read_b64_tr_b16 a[220:221],v245 offset:12288
ds_read_b64_tr_b16 a[222:223],v245 offset:14336
v_mfma_f32_16x16x32_bf16 v[44:47],a[252:255],v[140:143],v[44:47]
s_waitcnt vmcnt(26)
s_barrier
s_waitcnt lgkmcnt(6)
v_mfma_f32_16x16x32_bf16 v[16:19],a[192:195],v[160:163],v[16:19]
ds_read_b64_tr_b16 a[224:225],v246 offset:0
ds_read_b64_tr_b16 a[226:227],v246 offset:2048
v_mfma_f32_16x16x32_bf16 v[16:19],a[196:199],v[164:167],v[16:19]
v_mfma_f32_16x16x32_bf16 v[16:19],a[200:203],v[168:171],v[16:19]
ds_read_b64_tr_b16 a[228:229],v246 offset:4096
ds_read_b64_tr_b16 a[230:231],v246 offset:6144
v_mfma_f32_16x16x32_bf16 v[16:19],a[204:207],v[172:175],v[16:19]
v_mfma_f32_16x16x32_bf16 v[20:23],a[192:195],v[176:179],v[20:23]
ds_read_b64_tr_b16 a[232:233],v246 offset:8192
ds_read_b64_tr_b16 a[234:235],v246 offset:10240
v_cvt_pk_bf16_f32 v64,v64,v65
v_cvt_pk_bf16_f32 v65,v66,v67
v_mfma_f32_16x16x32_bf16 v[20:23],a[196:199],v[180:183],v[20:23]
v_cvt_pk_bf16_f32 v66,v72,v73
v_cvt_pk_bf16_f32 v67,v74,v75
buffer_store_dwordx4 v[64:67],v249,s[20:23],s62 offen sc0 sc1
v_mfma_f32_16x16x32_bf16 v[20:23],a[200:203],v[184:187],v[20:23]
ds_read_b64_tr_b16 a[236:237],v246 offset:12288
ds_read_b64_tr_b16 a[238:239],v246 offset:14336
s_add_u32 s62,s62,32768
v_cvt_pk_bf16_f32 v68,v68,v69
v_mfma_f32_16x16x32_bf16 v[20:23],a[204:207],v[188:191],v[20:23]
v_cvt_pk_bf16_f32 v69,v70,v71
v_cvt_pk_bf16_f32 v70,v76,v77
v_cvt_pk_bf16_f32 v71,v78,v79
v_mfma_f32_16x16x32_bf16 v[24:27],a[208:211],v[160:163],v[24:27]
ds_read_b64_tr_b16 a[240:241],v247 offset:0
ds_read_b64_tr_b16 a[242:243],v247 offset:2048
s_waitcnt lgkmcnt(8)
v_mfma_f32_16x16x32_bf16 v[24:27],a[212:215],v[164:167],v[24:27]
buffer_store_dwordx4 v[68:71],v249,s[20:23],s63 offen sc0 sc1
s_add_u32 s63,s63,32768
v_mfma_f32_16x16x32_bf16 v[24:27],a[216:219],v[168:171],v[24:27]
ds_read_b64_tr_b16 a[244:245],v247 offset:4096
ds_read_b64_tr_b16 a[246:247],v247 offset:6144
v_mfma_f32_16x16x32_bf16 v[24:27],a[220:223],v[172:175],v[24:27]
v_mfma_f32_16x16x32_bf16 v[28:31],a[208:211],v[176:179],v[28:31]
ds_read_b64_tr_b16 a[248:249],v247 offset:8192
ds_read_b64_tr_b16 a[250:251],v247 offset:10240
v_mfma_f32_16x16x32_bf16 v[28:31],a[212:215],v[180:183],v[28:31]
v_mfma_f32_16x16x32_bf16 v[28:31],a[216:219],v[184:187],v[28:31]
ds_read_b64_tr_b16 a[252:253],v247 offset:12288
ds_read_b64_tr_b16 a[254:255],v247 offset:14336
v_mfma_f32_16x16x32_bf16 v[28:31],a[220:223],v[188:191],v[28:31]
v_mfma_f32_16x16x32_bf16 v[32:35],a[224:227],v[160:163],v[32:35]
ds_read_b64_tr_b16 a[192:193],v244 offset:16384
ds_read_b64_tr_b16 a[194:195],v244 offset:18432
s_waitcnt lgkmcnt(8)
v_mfma_f32_16x16x32_bf16 v[32:35],a[228:231],v[164:167],v[32:35]
v_mfma_f32_16x16x32_bf16 v[32:35],a[232:235],v[168:171],v[32:35]
ds_read_b64_tr_b16 a[196:197],v244 offset:20480
ds_read_b64_tr_b16 a[198:199],v244 offset:22528
v_mfma_f32_16x16x32_bf16 v[32:35],a[236:239],v[172:175],v[32:35]
v_mfma_f32_16x16x32_bf16 v[36:39],a[224:227],v[176:179],v[36:39]
ds_read_b64_tr_b16 a[200:201],v244 offset:24576
ds_read_b64_tr_b16 a[202:203],v244 offset:26624
v_mfma_f32_16x16x32_bf16 v[36:39],a[228:231],v[180:183],v[36:39]
v_mfma_f32_16x16x32_bf16 v[36:39],a[232:235],v[184:187],v[36:39]
ds_read_b64_tr_b16 a[204:205],v244 offset:28672
ds_read_b64_tr_b16 a[206:207],v244 offset:30720
v_mfma_f32_16x16x32_bf16 v[36:39],a[236:239],v[188:191],v[36:39]
v_mfma_f32_16x16x32_bf16 v[40:43],a[240:243],v[160:163],v[40:43]
ds_read_b64_tr_b16 a[208:209],v245 offset:16384
ds_read_b64_tr_b16 a[210:211],v245 offset:18432
s_waitcnt lgkmcnt(10)
v_mfma_f32_16x16x32_bf16 v[40:43],a[244:247],v[164:167],v[40:43]
v_mfma_f32_16x16x32_bf16 v[40:43],a[248:251],v[168:171],v[40:43]
ds_read_b64_tr_b16 a[212:213],v245 offset:20480
ds_read_b64_tr_b16 a[214:215],v245 offset:22528
v_mfma_f32_16x16x32_bf16 v[40:43],a[252:255],v[172:175],v[40:43]
v_mfma_f32_16x16x32_bf16 v[44:47],a[240:243],v[176:179],v[44:47]
ds_read_b64_tr_b16 a[216:217],v245 offset:24576
ds_read_b64_tr_b16 a[218:219],v245 offset:26624
v_mfma_f32_16x16x32_bf16 v[44:47],a[244:247],v[180:183],v[44:47]
v_mfma_f32_16x16x32_bf16 v[44:47],a[248:251],v[184:187],v[44:47]
ds_read_b64_tr_b16 a[220:221],v245 offset:28672
ds_read_b64_tr_b16 a[222:223],v245 offset:30720
v_mfma_f32_16x16x32_bf16 v[44:47],a[252:255],v[188:191],v[44:47]
s_waitcnt vmcnt(20)
s_barrier
s_waitcnt lgkmcnt(6)
v_mfma_f32_16x16x32_bf16 v[48:51],a[192:195],v[112:115],0
ds_read_b64_tr_b16 a[224:225],v246 offset:16384
ds_read_b64_tr_b16 a[226:227],v246 offset:18432
v_mfma_f32_16x16x32_bf16 v[48:51],a[196:199],v[116:119],v[48:51]
v_mfma_f32_16x16x32_bf16 v[48:51],a[200:203],v[120:123],v[48:51]
ds_read_b64_tr_b16 a[228:229],v246 offset:20480
ds_read_b64_tr_b16 a[230:231],v246 offset:22528
v_mfma_f32_16x16x32_bf16 v[48:51],a[204:207],v[124:127],v[48:51]
v_mfma_f32_16x16x32_bf16 v[52:55],a[192:195],v[128:131],0
ds_read_b64_tr_b16 a[232:233],v246 offset:24576
ds_read_b64_tr_b16 a[234:235],v246 offset:26624
v_cvt_pk_bf16_f32 v16,v16,v17
v_cvt_pk_bf16_f32 v17,v18,v19
v_mfma_f32_16x16x32_bf16 v[52:55],a[196:199],v[132:135],v[52:55]
v_cvt_pk_bf16_f32 v18,v24,v25
v_cvt_pk_bf16_f32 v19,v26,v27
buffer_store_dwordx4 v[16:19],v248,s[20:23],s62 offen sc0 sc1
v_mfma_f32_16x16x32_bf16 v[52:55],a[200:203],v[136:139],v[52:55]
ds_read_b64_tr_b16 a[236:237],v246 offset:28672
ds_read_b64_tr_b16 a[238:239],v246 offset:30720
v_cvt_pk_bf16_f32 v20,v20,v21
v_cvt_pk_bf16_f32 v21,v22,v23
v_mfma_f32_16x16x32_bf16 v[52:55],a[204:207],v[140:143],v[52:55]
v_cvt_pk_bf16_f32 v22,v28,v29
v_cvt_pk_bf16_f32 v23,v30,v31
buffer_store_dwordx4 v[20:23],v248,s[20:23],s63 offen sc0 sc1
v_mfma_f32_16x16x32_bf16 v[56:59],a[208:211],v[112:115],0
ds_read_b64_tr_b16 a[240:241],v247 offset:16384
ds_read_b64_tr_b16 a[242:243],v247 offset:18432
s_waitcnt lgkmcnt(8)
v_mfma_f32_16x16x32_bf16 v[56:59],a[212:215],v[116:119],v[56:59]
v_mfma_f32_16x16x32_bf16 v[56:59],a[216:219],v[120:123],v[56:59]
ds_read_b64_tr_b16 a[244:245],v247 offset:20480
ds_read_b64_tr_b16 a[246:247],v247 offset:22528
v_mfma_f32_16x16x32_bf16 v[56:59],a[220:223],v[124:127],v[56:59]
v_mfma_f32_16x16x32_bf16 v[60:63],a[208:211],v[128:131],0
ds_read_b64_tr_b16 a[248:249],v247 offset:24576
ds_read_b64_tr_b16 a[250:251],v247 offset:26624
v_mfma_f32_16x16x32_bf16 v[60:63],a[212:215],v[132:135],v[60:63]
v_mfma_f32_16x16x32_bf16 v[60:63],a[216:219],v[136:139],v[60:63]
ds_read_b64_tr_b16 a[252:253],v247 offset:28672
ds_read_b64_tr_b16 a[254:255],v247 offset:30720
v_mfma_f32_16x16x32_bf16 v[60:63],a[220:223],v[140:143],v[60:63]
v_mfma_f32_16x16x32_bf16 v[64:67],a[224:227],v[112:115],0
ds_read_b64_tr_b16 a[192:193],v244 offset:32768
ds_read_b64_tr_b16 a[194:195],v244 offset:34816
s_waitcnt lgkmcnt(8)
v_mfma_f32_16x16x32_bf16 v[64:67],a[228:231],v[116:119],v[64:67]
v_mfma_f32_16x16x32_bf16 v[64:67],a[232:235],v[120:123],v[64:67]
ds_read_b64_tr_b16 a[196:197],v244 offset:36864
ds_read_b64_tr_b16 a[198:199],v244 offset:38912
v_mfma_f32_16x16x32_bf16 v[64:67],a[236:239],v[124:127],v[64:67]
v_mfma_f32_16x16x32_bf16 v[68:71],a[224:227],v[128:131],0
ds_read_b64_tr_b16 a[200:201],v244 offset:40960
ds_read_b64_tr_b16 a[202:203],v244 offset:43008
v_mfma_f32_16x16x32_bf16 v[68:71],a[228:231],v[132:135],v[68:71]
v_mfma_f32_16x16x32_bf16 v[68:71],a[232:235],v[136:139],v[68:71]
ds_read_b64_tr_b16 a[204:205],v244 offset:45056
ds_read_b64_tr_b16 a[206:207],v244 offset:47104
v_mfma_f32_16x16x32_bf16 v[68:71],a[236:239],v[140:143],v[68:71]
v_mfma_f32_16x16x32_bf16 v[72:75],a[240:243],v[112:115],0
ds_read_b64_tr_b16 a[208:209],v245 offset:32768
ds_read_b64_tr_b16 a[210:211],v245 offset:34816
s_waitcnt lgkmcnt(10)
v_mfma_f32_16x16x32_bf16 v[72:75],a[244:247],v[116:119],v[72:75]
v_mfma_f32_16x16x32_bf16 v[72:75],a[248:251],v[120:123],v[72:75]
ds_read_b64_tr_b16 a[212:213],v245 offset:36864
ds_read_b64_tr_b16 a[214:215],v245 offset:38912
v_mfma_f32_16x16x32_bf16 v[72:75],a[252:255],v[124:127],v[72:75]
v_mfma_f32_16x16x32_bf16 v[76:79],a[240:243],v[128:131],0
ds_read_b64_tr_b16 a[216:217],v245 offset:40960
ds_read_b64_tr_b16 a[218:219],v245 offset:43008
v_mfma_f32_16x16x32_bf16 v[76:79],a[244:247],v[132:135],v[76:79]
v_mfma_f32_16x16x32_bf16 v[76:79],a[248:251],v[136:139],v[76:79]
ds_read_b64_tr_b16 a[220:221],v245 offset:45056
ds_read_b64_tr_b16 a[222:223],v245 offset:47104
v_mfma_f32_16x16x32_bf16 v[76:79],a[252:255],v[140:143],v[76:79]
s_waitcnt vmcnt(16)
s_barrier
s_waitcnt lgkmcnt(6)
v_mfma_f32_16x16x32_bf16 v[48:51],a[192:195],v[160:163],v[48:51]
ds_read_b64_tr_b16 a[224:225],v246 offset:32768
ds_read_b64_tr_b16 a[226:227],v246 offset:34816
v_mfma_f32_16x16x32_bf16 v[48:51],a[196:199],v[164:167],v[48:51]
v_mfma_f32_16x16x32_bf16 v[48:51],a[200:203],v[168:171],v[48:51]
ds_read_b64_tr_b16 a[228:229],v246 offset:36864
ds_read_b64_tr_b16 a[230:231],v246 offset:38912
v_mfma_f32_16x16x32_bf16 v[48:51],a[204:207],v[172:175],v[48:51]
v_mfma_f32_16x16x32_bf16 v[52:55],a[192:195],v[176:179],v[52:55]
ds_read_b64_tr_b16 a[232:233],v246 offset:40960
ds_read_b64_tr_b16 a[234:235],v246 offset:43008
v_cvt_pk_bf16_f32 v32,v32,v33
v_cvt_pk_bf16_f32 v33,v34,v35
v_mfma_f32_16x16x32_bf16 v[52:55],a[196:199],v[180:183],v[52:55]
v_cvt_pk_bf16_f32 v34,v40,v41
v_cvt_pk_bf16_f32 v35,v42,v43
buffer_store_dwordx4 v[32:35],v249,s[20:23],s62 offen sc0 sc1
v_mfma_f32_16x16x32_bf16 v[52:55],a[200:203],v[184:187],v[52:55]
ds_read_b64_tr_b16 a[236:237],v246 offset:45056
ds_read_b64_tr_b16 a[238:239],v246 offset:47104
s_add_u32 s62,s62,32768
v_cvt_pk_bf16_f32 v36,v36,v37
v_mfma_f32_16x16x32_bf16 v[52:55],a[204:207],v[188:191],v[52:55]
v_cvt_pk_bf16_f32 v37,v38,v39
v_cvt_pk_bf16_f32 v38,v44,v45
v_cvt_pk_bf16_f32 v39,v46,v47
v_mfma_f32_16x16x32_bf16 v[56:59],a[208:211],v[160:163],v[56:59]
ds_read_b64_tr_b16 a[240:241],v247 offset:32768
ds_read_b64_tr_b16 a[242:243],v247 offset:34816
s_waitcnt lgkmcnt(8)
v_mfma_f32_16x16x32_bf16 v[56:59],a[212:215],v[164:167],v[56:59]
buffer_store_dwordx4 v[36:39],v249,s[20:23],s63 offen sc0 sc1
s_add_u32 s63,s63,32768
v_mfma_f32_16x16x32_bf16 v[56:59],a[216:219],v[168:171],v[56:59]
ds_read_b64_tr_b16 a[244:245],v247 offset:36864
ds_read_b64_tr_b16 a[246:247],v247 offset:38912
v_mfma_f32_16x16x32_bf16 v[56:59],a[220:223],v[172:175],v[56:59]
v_mfma_f32_16x16x32_bf16 v[60:63],a[208:211],v[176:179],v[60:63]
ds_read_b64_tr_b16 a[248:249],v247 offset:40960
ds_read_b64_tr_b16 a[250:251],v247 offset:43008
v_mfma_f32_16x16x32_bf16 v[60:63],a[212:215],v[180:183],v[60:63]
v_mfma_f32_16x16x32_bf16 v[60:63],a[216:219],v[184:187],v[60:63]
ds_read_b64_tr_b16 a[252:253],v247 offset:45056
ds_read_b64_tr_b16 a[254:255],v247 offset:47104
v_mfma_f32_16x16x32_bf16 v[60:63],a[220:223],v[188:191],v[60:63]
v_mfma_f32_16x16x32_bf16 v[64:67],a[224:227],v[160:163],v[64:67]
ds_read_b64_tr_b16 a[192:193],v244 offset:49152
ds_read_b64_tr_b16 a[194:195],v244 offset:51200
s_waitcnt lgkmcnt(8)
v_mfma_f32_16x16x32_bf16 v[64:67],a[228:231],v[164:167],v[64:67]
v_mfma_f32_16x16x32_bf16 v[64:67],a[232:235],v[168:171],v[64:67]
ds_read_b64_tr_b16 a[196:197],v244 offset:53248
ds_read_b64_tr_b16 a[198:199],v244 offset:55296
v_mfma_f32_16x16x32_bf16 v[64:67],a[236:239],v[172:175],v[64:67]
v_mfma_f32_16x16x32_bf16 v[68:71],a[224:227],v[176:179],v[68:71]
ds_read_b64_tr_b16 a[200:201],v244 offset:57344
ds_read_b64_tr_b16 a[202:203],v244 offset:59392
v_mfma_f32_16x16x32_bf16 v[68:71],a[228:231],v[180:183],v[68:71]
v_mfma_f32_16x16x32_bf16 v[68:71],a[232:235],v[184:187],v[68:71]
ds_read_b64_tr_b16 a[204:205],v244 offset:61440
ds_read_b64_tr_b16 a[206:207],v244 offset:63488
v_mfma_f32_16x16x32_bf16 v[68:71],a[236:239],v[188:191],v[68:71]
v_mfma_f32_16x16x32_bf16 v[72:75],a[240:243],v[160:163],v[72:75]
ds_read_b64_tr_b16 a[208:209],v245 offset:49152
ds_read_b64_tr_b16 a[210:211],v245 offset:51200
s_waitcnt lgkmcnt(10)
v_mfma_f32_16x16x32_bf16 v[72:75],a[244:247],v[164:167],v[72:75]
v_mfma_f32_16x16x32_bf16 v[72:75],a[248:251],v[168:171],v[72:75]
ds_read_b64_tr_b16 a[212:213],v245 offset:53248
ds_read_b64_tr_b16 a[214:215],v245 offset:55296
v_mfma_f32_16x16x32_bf16 v[72:75],a[252:255],v[172:175],v[72:75]
v_mfma_f32_16x16x32_bf16 v[76:79],a[240:243],v[176:179],v[76:79]
ds_read_b64_tr_b16 a[216:217],v245 offset:57344
ds_read_b64_tr_b16 a[218:219],v245 offset:59392
v_mfma_f32_16x16x32_bf16 v[76:79],a[244:247],v[180:183],v[76:79]
v_mfma_f32_16x16x32_bf16 v[76:79],a[248:251],v[184:187],v[76:79]
ds_read_b64_tr_b16 a[220:221],v245 offset:61440
ds_read_b64_tr_b16 a[222:223],v245 offset:63488
v_mfma_f32_16x16x32_bf16 v[76:79],a[252:255],v[188:191],v[76:79]
s_waitcnt vmcnt(12)
s_barrier
s_waitcnt lgkmcnt(6)
v_mfma_f32_16x16x32_bf16 v[16:19],a[192:195],v[112:115],0
ds_read_b64_tr_b16 a[224:225],v246 offset:49152
ds_read_b64_tr_b16 a[226:227],v246 offset:51200
v_mfma_f32_16x16x32_bf16 v[16:19],a[196:199],v[116:119],v[16:19]
v_mfma_f32_16x16x32_bf16 v[16:19],a[200:203],v[120:123],v[16:19]
ds_read_b64_tr_b16 a[228:229],v246 offset:53248
ds_read_b64_tr_b16 a[230:231],v246 offset:55296
v_mfma_f32_16x16x32_bf16 v[16:19],a[204:207],v[124:127],v[16:19]
v_mfma_f32_16x16x32_bf16 v[20:23],a[192:195],v[128:131],0
ds_read_b64_tr_b16 a[232:233],v246 offset:57344
ds_read_b64_tr_b16 a[234:235],v246 offset:59392
v_cvt_pk_bf16_f32 v48,v48,v49
v_cvt_pk_bf16_f32 v49,v50,v51
v_mfma_f32_16x16x32_bf16 v[20:23],a[196:199],v[132:135],v[20:23]
v_cvt_pk_bf16_f32 v50,v56,v57
v_cvt_pk_bf16_f32 v51,v58,v59
buffer_store_dwordx4 v[48:51],v248,s[20:23],s62 offen sc0 sc1
v_mfma_f32_16x16x32_bf16 v[20:23],a[200:203],v[136:139],v[20:23]
ds_read_b64_tr_b16 a[236:237],v246 offset:61440
ds_read_b64_tr_b16 a[238:239],v246 offset:63488
v_cvt_pk_bf16_f32 v52,v52,v53
v_cvt_pk_bf16_f32 v53,v54,v55
v_mfma_f32_16x16x32_bf16 v[20:23],a[204:207],v[140:143],v[20:23]
v_cvt_pk_bf16_f32 v54,v60,v61
v_cvt_pk_bf16_f32 v55,v62,v63
buffer_store_dwordx4 v[52:55],v248,s[20:23],s63 offen sc0 sc1
v_mfma_f32_16x16x32_bf16 v[24:27],a[208:211],v[112:115],0
ds_read_b64_tr_b16 a[240:241],v247 offset:49152
ds_read_b64_tr_b16 a[242:243],v247 offset:51200
s_waitcnt lgkmcnt(8)
v_mfma_f32_16x16x32_bf16 v[24:27],a[212:215],v[116:119],v[24:27]
v_mfma_f32_16x16x32_bf16 v[24:27],a[216:219],v[120:123],v[24:27]
ds_read_b64_tr_b16 a[244:245],v247 offset:53248
ds_read_b64_tr_b16 a[246:247],v247 offset:55296
v_mfma_f32_16x16x32_bf16 v[24:27],a[220:223],v[124:127],v[24:27]
v_mfma_f32_16x16x32_bf16 v[28:31],a[208:211],v[128:131],0
ds_read_b64_tr_b16 a[248:249],v247 offset:57344
ds_read_b64_tr_b16 a[250:251],v247 offset:59392
v_mfma_f32_16x16x32_bf16 v[28:31],a[212:215],v[132:135],v[28:31]
v_mfma_f32_16x16x32_bf16 v[28:31],a[216:219],v[136:139],v[28:31]
ds_read_b64_tr_b16 a[252:253],v247 offset:61440
ds_read_b64_tr_b16 a[254:255],v247 offset:63488
v_mfma_f32_16x16x32_bf16 v[28:31],a[220:223],v[140:143],v[28:31]
v_mfma_f32_16x16x32_bf16 v[32:35],a[224:227],v[112:115],0
ds_read_b64_tr_b16 a[192:193],v240 offset:0
ds_read_b64_tr_b16 a[194:195],v240 offset:2048
s_waitcnt lgkmcnt(8)
v_mfma_f32_16x16x32_bf16 v[32:35],a[228:231],v[116:119],v[32:35]
v_mfma_f32_16x16x32_bf16 v[32:35],a[232:235],v[120:123],v[32:35]
ds_read_b64_tr_b16 a[196:197],v240 offset:4096
ds_read_b64_tr_b16 a[198:199],v240 offset:6144
v_mfma_f32_16x16x32_bf16 v[32:35],a[236:239],v[124:127],v[32:35]
v_mfma_f32_16x16x32_bf16 v[36:39],a[224:227],v[128:131],0
ds_read_b64_tr_b16 a[200:201],v240 offset:8192
ds_read_b64_tr_b16 a[202:203],v240 offset:10240
v_mfma_f32_16x16x32_bf16 v[36:39],a[228:231],v[132:135],v[36:39]
v_mfma_f32_16x16x32_bf16 v[36:39],a[232:235],v[136:139],v[36:39]
ds_read_b64_tr_b16 a[204:205],v240 offset:12288
ds_read_b64_tr_b16 a[206:207],v240 offset:14336
v_mfma_f32_16x16x32_bf16 v[36:39],a[236:239],v[140:143],v[36:39]
v_mfma_f32_16x16x32_bf16 v[40:43],a[240:243],v[112:115],0
ds_read_b64_tr_b16 a[208:209],v241 offset:0
ds_read_b64_tr_b16 a[210:211],v241 offset:2048
s_waitcnt lgkmcnt(10)
v_mfma_f32_16x16x32_bf16 v[40:43],a[244:247],v[116:119],v[40:43]
v_mfma_f32_16x16x32_bf16 v[40:43],a[248:251],v[120:123],v[40:43]
ds_read_b64_tr_b16 a[212:213],v241 offset:4096
ds_read_b64_tr_b16 a[214:215],v241 offset:6144
v_mfma_f32_16x16x32_bf16 v[40:43],a[252:255],v[124:127],v[40:43]
v_mfma_f32_16x16x32_bf16 v[44:47],a[240:243],v[128:131],0
ds_read_b64_tr_b16 a[216:217],v241 offset:8192
ds_read_b64_tr_b16 a[218:219],v241 offset:10240
v_mfma_f32_16x16x32_bf16 v[44:47],a[244:247],v[132:135],v[44:47]
v_mfma_f32_16x16x32_bf16 v[44:47],a[248:251],v[136:139],v[44:47]
ds_read_b64_tr_b16 a[220:221],v241 offset:12288
ds_read_b64_tr_b16 a[222:223],v241 offset:14336
v_mfma_f32_16x16x32_bf16 v[44:47],a[252:255],v[140:143],v[44:47]
s_waitcnt lgkmcnt(6)
v_mfma_f32_16x16x32_bf16 v[16:19],a[192:195],v[160:163],v[16:19]
ds_read_b64_tr_b16 a[224:225],v242 offset:0
ds_read_b64_tr_b16 a[226:227],v242 offset:2048
v_mfma_f32_16x16x32_bf16 v[16:19],a[196:199],v[164:167],v[16:19]
v_mfma_f32_16x16x32_bf16 v[16:19],a[200:203],v[168:171],v[16:19]
ds_read_b64_tr_b16 a[228:229],v242 offset:4096
ds_read_b64_tr_b16 a[230:231],v242 offset:6144
v_mfma_f32_16x16x32_bf16 v[16:19],a[204:207],v[172:175],v[16:19]
v_mfma_f32_16x16x32_bf16 v[20:23],a[192:195],v[176:179],v[20:23]
v_cvt_pk_bf16_f32 v64,v64,v65
v_cvt_pk_bf16_f32 v65,v66,v67
v_cvt_pk_bf16_f32 v66,v72,v73
v_cvt_pk_bf16_f32 v67,v74,v75
v_mfma_f32_16x16x32_bf16 v[20:23],a[196:199],v[180:183],v[20:23]
ds_read_b64_tr_b16 a[232:233],v242 offset:8192
ds_read_b64_tr_b16 a[234:235],v242 offset:10240
buffer_store_dwordx4 v[64:67],v249,s[20:23],s62 offen sc0 sc1
v_mfma_f32_16x16x32_bf16 v[20:23],a[200:203],v[184:187],v[20:23]
s_add_u32 s62,s62,32768
v_cvt_pk_bf16_f32 v68,v68,v69
v_cvt_pk_bf16_f32 v69,v70,v71
v_cvt_pk_bf16_f32 v70,v76,v77
v_mfma_f32_16x16x32_bf16 v[20:23],a[204:207],v[188:191],v[20:23]
v_cvt_pk_bf16_f32 v71,v78,v79
buffer_store_dwordx4 v[68:71],v249,s[20:23],s63 offen sc0 sc1
s_add_u32 s63,s63,32768
v_mfma_f32_16x16x32_bf16 v[24:27],a[208:211],v[160:163],v[24:27]
ds_read_b64_tr_b16 a[236:237],v242 offset:12288
ds_read_b64_tr_b16 a[238:239],v242 offset:14336
s_waitcnt lgkmcnt(6)
v_mfma_f32_16x16x32_bf16 v[24:27],a[212:215],v[164:167],v[24:27]
v_mfma_f32_16x16x32_bf16 v[24:27],a[216:219],v[168:171],v[24:27]
v_mfma_f32_16x16x32_bf16 v[24:27],a[220:223],v[172:175],v[24:27]
ds_read_b64_tr_b16 a[240:241],v243 offset:0
ds_read_b64_tr_b16 a[242:243],v243 offset:2048
v_mfma_f32_16x16x32_bf16 v[28:31],a[208:211],v[176:179],v[28:31]
v_mfma_f32_16x16x32_bf16 v[28:31],a[212:215],v[180:183],v[28:31]
ds_read_b64_tr_b16 a[244:245],v243 offset:4096
ds_read_b64_tr_b16 a[246:247],v243 offset:6144
v_mfma_f32_16x16x32_bf16 v[28:31],a[216:219],v[184:187],v[28:31]
v_mfma_f32_16x16x32_bf16 v[28:31],a[220:223],v[188:191],v[28:31]
v_mfma_f32_16x16x32_bf16 v[32:35],a[224:227],v[160:163],v[32:35]
ds_read_b64_tr_b16 a[248:249],v243 offset:8192
ds_read_b64_tr_b16 a[250:251],v243 offset:10240
s_waitcnt lgkmcnt(6)
v_mfma_f32_16x16x32_bf16 v[32:35],a[228:231],v[164:167],v[32:35]
v_mfma_f32_16x16x32_bf16 v[32:35],a[232:235],v[168:171],v[32:35]
v_mfma_f32_16x16x32_bf16 v[32:35],a[236:239],v[172:175],v[32:35]
ds_read_b64_tr_b16 a[252:253],v243 offset:12288
ds_read_b64_tr_b16 a[254:255],v243 offset:14336
v_mfma_f32_16x16x32_bf16 v[36:39],a[224:227],v[176:179],v[36:39]
v_mfma_f32_16x16x32_bf16 v[36:39],a[228:231],v[180:183],v[36:39]
v_mfma_f32_16x16x32_bf16 v[36:39],a[232:235],v[184:187],v[36:39]
v_mfma_f32_16x16x32_bf16 v[36:39],a[236:239],v[188:191],v[36:39]
s_waitcnt lgkmcnt(2)
v_mfma_f32_16x16x32_bf16 v[40:43],a[240:243],v[160:163],v[40:43]
v_mfma_f32_16x16x32_bf16 v[40:43],a[244:247],v[164:167],v[40:43]
v_mfma_f32_16x16x32_bf16 v[40:43],a[248:251],v[168:171],v[40:43]
s_waitcnt lgkmcnt(0)
v_mfma_f32_16x16x32_bf16 v[40:43],a[252:255],v[172:175],v[40:43]
v_mfma_f32_16x16x32_bf16 v[44:47],a[240:243],v[176:179],v[44:47]
v_mfma_f32_16x16x32_bf16 v[44:47],a[244:247],v[180:183],v[44:47]
v_mfma_f32_16x16x32_bf16 v[44:47],a[248:251],v[184:187],v[44:47]
v_mfma_f32_16x16x32_bf16 v[44:47],a[252:255],v[188:191],v[44:47]
s_nop 5
v_cvt_pk_bf16_f32 v16,v16,v17
v_cvt_pk_bf16_f32 v17,v18,v19
v_cvt_pk_bf16_f32 v18,v24,v25
v_cvt_pk_bf16_f32 v19,v26,v27
buffer_store_dwordx4 v[16:19],v248,s[20:23],s62 offen sc0 sc1
v_cvt_pk_bf16_f32 v20,v20,v21
v_cvt_pk_bf16_f32 v21,v22,v23
v_cvt_pk_bf16_f32 v22,v28,v29
v_cvt_pk_bf16_f32 v23,v30,v31
buffer_store_dwordx4 v[20:23],v248,s[20:23],s63 offen sc0 sc1
v_cvt_pk_bf16_f32 v32,v32,v33
v_cvt_pk_bf16_f32 v33,v34,v35
v_cvt_pk_bf16_f32 v34,v40,v41
v_cvt_pk_bf16_f32 v35,v42,v43
buffer_store_dwordx4 v[32:35],v249,s[20:23],s62 offen sc0 sc1
s_add_u32 s62,s62,32768
v_cvt_pk_bf16_f32 v36,v36,v37
v_cvt_pk_bf16_f32 v37,v38,v39
v_cvt_pk_bf16_f32 v38,v44,v45
v_cvt_pk_bf16_f32 v39,v46,v47
buffer_store_dwordx4 v[36:39],v249,s[20:23],s63 offen sc0 sc1
s_add_u32 s63,s63,32768
s_endpgm
FALLBACK_B:
s_waitcnt vmcnt(0) lgkmcnt(0)
s_mov_b32 s30,1
s_mov_b32 s65,0
v_mov_b32 v168,0xff800000
v_mov_b32 v169,0xff800000
FBLOOP_B:
s_barrier
s_mov_b32 m0,s25
s_add_u32 s28,s25,s65
buffer_load_dwordx4 v12,s[4:7],s28 offen lds
buffer_load_dwordx4 v13,s[4:7],s28 offen offset:1024 lds
buffer_load_dwordx4 v14,s[4:7],s28 offen offset:2048 lds
buffer_load_dwordx4 v15,s[4:7],s28 offen offset:3072 lds
s_waitcnt vmcnt(0)
s_barrier
ds_read_b128 a[192:195],v0 offset:0
ds_read_b128 a[196:199],v1 offset:0
ds_read_b128 a[200:203],v2 offset:0
ds_read_b128 a[204:207],v3 offset:0
ds_read_b128 a[208:211],v0 offset:256
ds_read_b128 a[212:215],v1 offset:256
ds_read_b128 a[216:219],v2 offset:256
ds_read_b128 a[220:223],v3 offset:256
ds_read_b128 a[224:227],v0 offset:8192
ds_read_b128 a[228:231],v1 offset:8192
ds_read_b128 a[232:235],v2 offset:8192
ds_read_b128 a[236:239],v3 offset:8192
ds_read_b128 a[240:243],v0 offset:8448
ds_read_b128 a[244:247],v1 offset:8448
ds_read_b128 a[248:251],v2 offset:8448
ds_read_b128 a[252:255],v3 offset:8448
s_waitcnt lgkmcnt(0)
v_mfma_f32_16x16x32_bf16 v[112:115],a[192:195],v[16:19],0
v_mfma_f32_16x16x32_bf16 v[112:115],a[196:199],v[20:23],v[112:115]
v_mfma_f32_16x16x32_bf16 v[112:115],a[200:203],v[24:27],v[112:115]
v_mfma_f32_16x16x32_bf16 v[112:115],a[204:207],v[28:31],v[112:115]
v_mfma_f32_16x16x32_bf16 v[112:115],a[208:211],v[32:35],v[112:115]
v_mfma_f32_16x16x32_bf16 v[112:115],a[212:215],v[36:39],v[112:115]
v_mfma_f32_16x16x32_bf16 v[112:115],a[216:219],v[40:43],v[112:115]
v_mfma_f32_16x16x32_bf16 v[112:115],a[220:223],v[44:47],v[112:115]
v_mfma_f32_16x16x32_bf16 v[128:131],a[192:195],v[48:51],0
v_mfma_f32_16x16x32_bf16 v[128:131],a[196:199],v[52:55],v[128:131]
v_mfma_f32_16x16x32_bf16 v[128:131],a[200:203],v[56:59],v[128:131]
v_mfma_f32_16x16x32_bf16 v[128:131],a[204:207],v[60:63],v[128:131]
v_mfma_f32_16x16x32_bf16 v[128:131],a[208:211],v[64:67],v[128:131]
v_mfma_f32_16x16x32_bf16 v[128:131],a[212:215],v[68:71],v[128:131]
v_mfma_f32_16x16x32_bf16 v[128:131],a[216:219],v[72:75],v[128:131]
v_mfma_f32_16x16x32_bf16 v[128:131],a[220:223],v[76:79],v[128:131]
v_mfma_f32_16x16x32_bf16 v[116:119],a[224:227],v[16:19],0
v_mfma_f32_16x16x32_bf16 v[116:119],a[228:231],v[20:23],v[116:119]
v_mfma_f32_16x16x32_bf16 v[116:119],a[232:235],v[24:27],v[116:119]
v_mfma_f32_16x16x32_bf16 v[116:119],a[236:239],v[28:31],v[116:119]
v_mfma_f32_16x16x32_bf16 v[116:119],a[240:243],v[32:35],v[116:119]
v_mfma_f32_16x16x32_bf16 v[116:119],a[244:247],v[36:39],v[116:119]
v_mfma_f32_16x16x32_bf16 v[116:119],a[248:251],v[40:43],v[116:119]
v_mfma_f32_16x16x32_bf16 v[116:119],a[252:255],v[44:47],v[116:119]
v_mfma_f32_16x16x32_bf16 v[132:135],a[224:227],v[48:51],0
v_mfma_f32_16x16x32_bf16 v[132:135],a[228:231],v[52:55],v[132:135]
v_mfma_f32_16x16x32_bf16 v[132:135],a[232:235],v[56:59],v[132:135]
v_mfma_f32_16x16x32_bf16 v[132:135],a[236:239],v[60:63],v[132:135]
v_mfma_f32_16x16x32_bf16 v[132:135],a[240:243],v[64:67],v[132:135]
v_mfma_f32_16x16x32_bf16 v[132:135],a[244:247],v[68:71],v[132:135]
v_mfma_f32_16x16x32_bf16 v[132:135],a[248:251],v[72:75],v[132:135]
v_mfma_f32_16x16x32_bf16 v[132:135],a[252:255],v[76:79],v[132:135]
s_nop 7
v_max3_f32 v168,v168,v112,v113
v_max3_f32 v168,v168,v114,v115
v_max3_f32 v168,v168,v116,v117
v_max3_f32 v168,v168,v118,v119
v_max3_f32 v169,v169,v128,v129
v_max3_f32 v169,v169,v130,v131
v_max3_f32 v169,v169,v132,v133
v_max3_f32 v169,v169,v134,v135
s_add_u32 s65,s65,16384
s_cmp_lt_u32 s65,1048576
s_cbranch_scc1 FBLOOP_B
v_mov_b32 v172,v168
v_mov_b32 v173,v169
s_nop 1
v_permlane32_swap_b32 v168,v172
v_permlane32_swap_b32 v169,v173
s_nop 1
v_max_f32 v168,v168,v172
v_max_f32 v169,v169,v173
v_mov_b32 v172,v168
v_mov_b32 v173,v169
s_nop 1
v_permlane16_swap_b32 v168,v172
v_permlane16_swap_b32 v169,v173
s_nop 1
v_max_f32 v168,v168,v172
v_max_f32 v169,v169,v173
v_sub_f32 v208,0,v168
v_sub_f32 v212,0,v169
s_barrier
s_mov_b32 m0,12288
s_mov_b32 s28,12288
buffer_load_dwordx4 v12,s[4:7],s28 offen nt lds
buffer_load_dwordx4 v13,s[4:7],s28 offen offset:1024 nt lds
buffer_load_dwordx4 v14,s[4:7],s28 offen offset:2048 nt lds
buffer_load_dwordx4 v15,s[4:7],s28 offen offset:3072 nt lds
s_mov_b32 m0,16384
s_mov_b32 s28,16384
buffer_load_dwordx4 v12,s[4:7],s28 offen nt lds
buffer_load_dwordx4 v13,s[4:7],s28 offen offset:1024 nt lds
buffer_load_dwordx4 v14,s[4:7],s28 offen offset:2048 nt lds
buffer_load_dwordx4 v15,s[4:7],s28 offen offset:3072 nt lds
s_mov_b32 m0,20480
s_mov_b32 s28,20480
buffer_load_dwordx4 v12,s[4:7],s28 offen nt lds
buffer_load_dwordx4 v13,s[4:7],s28 offen offset:1024 nt lds
buffer_load_dwordx4 v14,s[4:7],s28 offen offset:2048 nt lds
buffer_load_dwordx4 v15,s[4:7],s28 offen offset:3072 nt lds
s_mov_b32 m0,24576
s_mov_b32 s28,24576
buffer_load_dwordx4 v12,s[4:7],s28 offen nt lds
buffer_load_dwordx4 v13,s[4:7],s28 offen offset:1024 nt lds
buffer_load_dwordx4 v14,s[4:7],s28 offen offset:2048 nt lds
buffer_load_dwordx4 v15,s[4:7],s28 offen offset:3072 nt lds
s_mov_b32 m0,28672
s_mov_b32 s28,28672
buffer_load_dwordx4 v12,s[4:7],s28 offen nt lds
buffer_load_dwordx4 v13,s[4:7],s28 offen offset:1024 nt lds
buffer_load_dwordx4 v14,s[4:7],s28 offen offset:2048 nt lds
buffer_load_dwordx4 v15,s[4:7],s28 offen offset:3072 nt lds
s_mov_b32 m0,45056
s_mov_b32 s28,45056
buffer_load_dwordx4 v12,s[4:7],s28 offen nt lds
buffer_load_dwordx4 v13,s[4:7],s28 offen offset:1024 nt lds
buffer_load_dwordx4 v14,s[4:7],s28 offen offset:2048 nt lds
buffer_load_dwordx4 v15,s[4:7],s28 offen offset:3072 nt lds
s_mov_b32 m0,49152
s_mov_b32 s28,49152
buffer_load_dwordx4 v12,s[4:7],s28 offen nt lds
buffer_load_dwordx4 v13,s[4:7],s28 offen offset:1024 nt lds
buffer_load_dwordx4 v14,s[4:7],s28 offen offset:2048 nt lds
buffer_load_dwordx4 v15,s[4:7],s28 offen offset:3072 nt lds
s_mov_b32 m0,53248
s_mov_b32 s28,53248
buffer_load_dwordx4 v12,s[4:7],s28 offen nt lds
buffer_load_dwordx4 v13,s[4:7],s28 offen offset:1024 nt lds
buffer_load_dwordx4 v14,s[4:7],s28 offen offset:2048 nt lds
buffer_load_dwordx4 v15,s[4:7],s28 offen offset:3072 nt lds
s_mov_b32 m0,57344
s_mov_b32 s28,57344
buffer_load_dwordx4 v12,s[4:7],s28 offen nt lds
buffer_load_dwordx4 v13,s[4:7],s28 offen offset:1024 nt lds
buffer_load_dwordx4 v14,s[4:7],s28 offen offset:2048 nt lds
buffer_load_dwordx4 v15,s[4:7],s28 offen offset:3072 nt lds
s_mov_b32 m0,61440
s_mov_b32 s28,61440
buffer_load_dwordx4 v12,s[4:7],s28 offen nt lds
buffer_load_dwordx4 v13,s[4:7],s28 offen offset:1024 nt lds
buffer_load_dwordx4 v14,s[4:7],s28 offen offset:2048 nt lds
buffer_load_dwordx4 v15,s[4:7],s28 offen offset:3072 nt lds
s_mov_b32 m0,65536
s_mov_b32 s28,0
buffer_load_dwordx4 v12,s[8:11],s28 offen nt lds
buffer_load_dwordx4 v13,s[8:11],s28 offen offset:1024 nt lds
buffer_load_dwordx4 v14,s[8:11],s28 offen offset:2048 nt lds
buffer_load_dwordx4 v15,s[8:11],s28 offen offset:3072 nt lds
s_mov_b32 m0,69632
s_mov_b32 s28,4096
buffer_load_dwordx4 v12,s[8:11],s28 offen nt lds
buffer_load_dwordx4 v13,s[8:11],s28 offen offset:1024 nt lds
buffer_load_dwordx4 v14,s[8:11],s28 offen offset:2048 nt lds
buffer_load_dwordx4 v15,s[8:11],s28 offen offset:3072 nt lds
s_mov_b32 m0,73728
s_mov_b32 s28,8192
buffer_load_dwordx4 v12,s[8:11],s28 offen nt lds
buffer_load_dwordx4 v13,s[8:11],s28 offen offset:1024 nt lds
buffer_load_dwordx4 v14,s[8:11],s28 offen offset:2048 nt lds
buffer_load_dwordx4 v15,s[8:11],s28 offen offset:3072 nt lds
s_mov_b32 m0,77824
s_mov_b32 s28,12288
buffer_load_dwordx4 v12,s[8:11],s28 offen nt lds
buffer_load_dwordx4 v13,s[8:11],s28 offen offset:1024 nt lds
buffer_load_dwordx4 v14,s[8:11],s28 offen offset:2048 nt lds
buffer_load_dwordx4 v15,s[8:11],s28 offen offset:3072 nt lds
s_mov_b32 m0,81920
s_mov_b32 s28,16384
buffer_load_dwordx4 v12,s[8:11],s28 offen nt lds
buffer_load_dwordx4 v13,s[8:11],s28 offen offset:1024 nt lds
buffer_load_dwordx4 v14,s[8:11],s28 offen offset:2048 nt lds
buffer_load_dwordx4 v15,s[8:11],s28 offen offset:3072 nt lds
s_mov_b32 m0,86016
s_mov_b32 s28,20480
buffer_load_dwordx4 v12,s[8:11],s28 offen nt lds
buffer_load_dwordx4 v13,s[8:11],s28 offen offset:1024 nt lds
buffer_load_dwordx4 v14,s[8:11],s28 offen offset:2048 nt lds
buffer_load_dwordx4 v15,s[8:11],s28 offen offset:3072 nt lds
s_mov_b32 m0,90112
s_mov_b32 s28,24576
buffer_load_dwordx4 v12,s[8:11],s28 offen nt lds
buffer_load_dwordx4 v13,s[8:11],s28 offen offset:1024 nt lds
buffer_load_dwordx4 v14,s[8:11],s28 offen offset:2048 nt lds
buffer_load_dwordx4 v15,s[8:11],s28 offen offset:3072 nt lds
s_mov_b32 m0,94208
s_mov_b32 s28,28672
buffer_load_dwordx4 v12,s[8:11],s28 offen nt lds
buffer_load_dwordx4 v13,s[8:11],s28 offen offset:1024 nt lds
buffer_load_dwordx4 v14,s[8:11],s28 offen offset:2048 nt lds
buffer_load_dwordx4 v15,s[8:11],s28 offen offset:3072 nt lds
s_waitcnt vmcnt(0)
s_barrier
ds_read_b128 a[192:195],v0 offset:0
ds_read_b128 a[196:199],v1 offset:0
ds_read_b128 a[200:203],v2 offset:0
ds_read_b128 a[204:207],v3 offset:0
ds_read_b128 a[208:211],v0 offset:256
ds_read_b128 a[212:215],v1 offset:256
ds_read_b128 a[216:219],v2 offset:256
ds_read_b128 a[220:223],v3 offset:256
s_branch PRE_B
K1_END:
s_endpgm
ALT:
s_getpc_b64 s[54:55]
CW22:
s_lshr_b32 s56,s2,3
s_mul_i32 s56,s56,768
s_add_u32 s56,s56,PRE_A2-CW22
s_cmp_ge_u32 s56,(PRE_A2-CW22+(M29_A2-PRE_A2+767)/768*768)
s_cselect_b32 s57,PRE_B2-CW22-(PRE_A2-CW22+(M29_A2-PRE_A2+767)/768*768),0
s_add_u32 s56,s56,s57
v_min_u32 v58,5,v0
v_lshl_add_u32 v58,v58,7,s56
v_min_u32 v58,M29_B2-CW22-4,v58
v_mov_b32 v59,0
v_lshl_add_u64 v[60:61],v[58:59],0,s[54:55]
global_load_dword v56,v[60:61],off
s_and_b32 s54,s2,7
s_lshr_b32 s55,s2,3
s_and_b32 s56,s54,3
s_lshl_b32 s56,s56,2
s_and_b32 s57,s55,3
s_add_u32 s56,s56,s57
s_and_b32 s57,s54,4
s_bfe_u32 s58,s55,0x20002
s_add_u32 s57,s57,s58
s_lshr_b32 s58,s55,4
v_lshrrev_b32 v30,6,v0
v_and_b32 v31,63,v0
v_readfirstlane_b32 s24,v30
v_lshrrev_b32 v32,4,v31
v_and_b32 v33,15,v31
v_lshrrev_b32 v34,5,v31
v_and_b32 v35,31,v31
v_add_u32 v36,0,v34
v_lshlrev_b32 v37,1,v36
v_xor_b32 v37,v37,v35
v_lshlrev_b32 v12,4,v37
v_lshl_add_u32 v20,v34,13,v12
v_add_u32 v36,2,v34
v_lshlrev_b32 v37,1,v36
v_xor_b32 v37,v37,v35
v_lshlrev_b32 v13,4,v37
v_lshl_add_u32 v21,v34,13,v13
v_add_u32 v21,15360,v21
v_add_u32 v36,4,v34
v_lshlrev_b32 v37,1,v36
v_xor_b32 v37,v37,v35
v_lshlrev_b32 v14,4,v37
v_lshl_add_u32 v22,v34,13,v14
v_add_u32 v22,63488,v22
v_add_u32 v36,6,v34
v_lshlrev_b32 v37,1,v36
v_xor_b32 v37,v37,v35
v_lshlrev_b32 v15,4,v37
v_lshl_add_u32 v23,v34,13,v15
v_add_u32 v23,78848,v23
v_lshrrev_b32 v36,3,v31
v_mad_u32_u24 v36,v30,48,v36
v_mul_u32_u24 v36,0x380,v36
v_and_b32 v37,7,v31
v_xor_b32 v37,v37,v32
v_lshl_add_u32 v24,v37,4,v36
v_xor_b32 v37,4,v37
v_lshl_add_u32 v36,v37,4,v36
v_add_u32 v25,6144,v36
v_add_u32 v26,12288,v24
v_add_u32 v27,18432,v36
v_add_u32 v28,28672,v24
v_add_u32 v29,34816,v36
s_lshl_b32 s25,s24,12
s_and_b32 s28,s24,1
s_lshl_b32 s29,s28,17
s_lshr_b32 s28,s24,1
s_lshl_b32 s28,s28,15
s_add_u32 s29,s29,s28
s_mul_i32 s69,s24,6144
s_add_u32 s69,s69,114688
s_lshl_b32 s54,s56,9
s_mul_i32 s55,s57,157696
s_sub_u32 s14,3670016,s54
s_mov_b32 s15,0x20000
s_mov_b32 s18,157696
s_mov_b32 s19,0x20000
s_cmp_eq_u32 s58,0
s_waitcnt lgkmcnt(0)
s_cselect_b64 s[12:13],s[38:39],s[48:49]
s_cselect_b64 s[16:17],s[32:33],s[42:43]
s_add_u32 s12,s12,s54
s_addc_u32 s13,s13,0
s_add_u32 s16,s16,s55
s_addc_u32 s17,s17,0
s_cmp_eq_u32 s24,3
s_cbranch_scc1 START_B2
START_A2:
s_add_u32 m0,s25,49152
s_add_u32 s28,s29,0
buffer_load_dwordx4 v20,s[12:15],s28 offen lds
buffer_load_dwordx4 v21,s[12:15],s28 offen offset:1024 lds
buffer_load_dwordx4 v22,s[12:15],s28 offen offset:2048 lds
buffer_load_dwordx4 v23,s[12:15],s28 offen offset:3072 lds
s_add_u32 m0,s69,0
s_mov_b32 s28,0
buffer_load_dwordx4 v24,s[16:19],s28 offen lds
buffer_load_dwordx4 v25,s[16:19],s28 offen offset:1024 lds
buffer_load_dwordx4 v26,s[16:19],s28 offen offset:2048 lds
buffer_load_dwordx4 v27,s[16:19],s28 offen offset:3072 lds
s_add_u32 m0,s69,4096
s_nop 0
buffer_load_dwordx4 v28,s[16:19],s28 offen lds
buffer_load_dwordx4 v29,s[16:19],s28 offen offset:1024 lds
s_add_u32 m0,s25,98304
s_add_u32 s28,s29,262144
buffer_load_dwordx4 v20,s[12:15],s28 offen lds
v_lshl_add_u32 v12,v34,9,v12
v_lshl_add_u32 v13,v34,9,v13
v_lshl_add_u32 v14,v34,9,v14
v_lshl_add_u32 v15,v34,9,v15
s_lshl_b32 s59,s57,4
s_add_u32 s59,s59,s56
s_sub_u32 s54,1,s58
s_lshr_b32 s59,s59,s54
buffer_load_dwordx4 v21,s[12:15],s28 offen offset:1024 lds
s_lshl_b32 s59,s59,20
s_cmp_eq_u32 s58,0
s_cselect_b64 s[4:5],s[34:35],s[44:45]
s_cselect_b64 s[8:9],s[36:37],s[46:47]
s_cselect_b64 s[96:97],s[40:41],s[50:51]
s_add_u32 s4,s4,s59
s_addc_u32 s5,s5,0
s_mov_b32 s6,0x100000
s_mov_b32 s7,0x20000
s_add_u32 s8,s8,s59
s_addc_u32 s9,s9,0
s_mov_b32 s10,0x100000
s_mov_b32 s11,0x20000
buffer_load_dwordx4 v22,s[12:15],s28 offen offset:2048 lds
v_lshrrev_b32 v36,2,v33
v_lshl_add_u32 v36,v32,2,v36
v_and_b32 v38,3,v33
v_and_b32 v39,7,v36
v_lshlrev_b32 v36,9,v36
v_xor_b32 v37,0,v39
v_lshlrev_b32 v37,5,v37
v_lshl_add_u32 v37,v38,3,v37
buffer_load_dwordx4 v23,s[12:15],s28 offen offset:3072 lds
v_add_u32 v37,v37,v36
v_add_u32 v4,65536,v37
v_xor_b32 v37,1,v39
v_lshlrev_b32 v37,5,v37
v_lshl_add_u32 v37,v38,3,v37
v_add_u32 v37,v37,v36
v_add_u32 v5,65536,v37
v_xor_b32 v37,2,v39
s_add_u32 m0,s25,16384
s_add_u32 s28,s29,524288
buffer_load_dwordx4 v20,s[12:15],s28 offen lds
v_lshlrev_b32 v37,5,v37
v_lshl_add_u32 v37,v38,3,v37
v_add_u32 v37,v37,v36
v_add_u32 v6,65536,v37
v_xor_b32 v37,3,v39
v_lshlrev_b32 v37,5,v37
v_lshl_add_u32 v37,v38,3,v37
v_add_u32 v37,v37,v36
buffer_load_dwordx4 v21,s[12:15],s28 offen offset:1024 lds
v_add_u32 v7,65536,v37
v_xor_b32 v37,4,v39
v_lshlrev_b32 v37,5,v37
v_lshl_add_u32 v37,v38,3,v37
v_add_u32 v37,v37,v36
v_add_u32 v8,65536,v37
v_xor_b32 v37,5,v39
v_lshlrev_b32 v37,5,v37
buffer_load_dwordx4 v22,s[12:15],s28 offen offset:2048 lds
v_lshl_add_u32 v37,v38,3,v37
v_add_u32 v37,v37,v36
v_add_u32 v9,65536,v37
v_xor_b32 v37,6,v39
v_lshlrev_b32 v37,5,v37
v_lshl_add_u32 v37,v38,3,v37
v_add_u32 v37,v37,v36
v_add_u32 v10,65536,v37
buffer_load_dwordx4 v23,s[12:15],s28 offen offset:3072 lds
v_xor_b32 v37,7,v39
v_lshlrev_b32 v37,5,v37
v_lshl_add_u32 v37,v38,3,v37
v_add_u32 v37,v37,v36
v_add_u32 v11,65536,v37
v_lshlrev_b32 v39,1,v39
v_add_u32 v36,49152,v36
v_add_u32 v37,0,v38
s_add_u32 m0,s69,24576
s_mov_b32 s28,128
buffer_load_dwordx4 v24,s[16:19],s28 offen lds
v_xor_b32 v37,v37,v39
v_lshl_add_u32 v16,v37,4,v36
v_add_u32 v37,4,v38
v_xor_b32 v37,v37,v39
v_lshl_add_u32 v17,v37,4,v36
v_add_u32 v37,8,v38
v_xor_b32 v37,v37,v39
v_lshl_add_u32 v18,v37,4,v36
buffer_load_dwordx4 v25,s[16:19],s28 offen offset:1024 lds
v_add_u32 v37,12,v38
v_xor_b32 v37,v37,v39
v_lshl_add_u32 v19,v37,4,v36
v_lshrrev_b32 v37,1,v33
v_xor_b32 v37,v37,v32
v_lshlrev_b32 v36,7,v33
v_add_u32 v36,s69,v36
v_lshl_add_u32 v44,v37,4,v36
buffer_load_dwordx4 v26,s[16:19],s28 offen offset:2048 lds
v_xor_b32 v37,4,v37
v_lshl_add_u32 v45,v37,4,v36
v_and_b32 v36,7,v33
v_lshlrev_b32 v36,1,v36
v_add_u32 v37,0,v32
v_xor_b32 v37,v37,v36
v_lshlrev_b32 v37,4,v37
v_lshl_add_u32 v0,v33,9,v37
buffer_load_dwordx4 v27,s[16:19],s28 offen offset:3072 lds
v_add_u32 v37,4,v32
v_xor_b32 v37,v37,v36
v_lshlrev_b32 v37,4,v37
v_lshl_add_u32 v1,v33,9,v37
v_add_u32 v37,8,v32
v_xor_b32 v37,v37,v36
v_lshlrev_b32 v37,4,v37
v_lshl_add_u32 v2,v33,9,v37
s_add_u32 m0,s69,28672
s_nop 0
buffer_load_dwordx4 v28,s[16:19],s28 offen lds
v_add_u32 v37,12,v32
v_xor_b32 v37,v37,v36
v_lshlrev_b32 v37,4,v37
v_lshl_add_u32 v3,v33,9,v37
s_mov_b32 s30,0
s_mov_b32 s60,0x3db8aa3b
s_mov_b32 s61,s60
s_mul_i32 s62,s24,688128
buffer_load_dwordx4 v29,s[16:19],s28 offen offset:1024 lds
s_add_u32 s63,s62,229376
s_add_u32 s64,s62,458752
s_mul_i32 s67,s24,28672
s_lshl_b32 s54,s58,3
s_add_u32 s54,s54,s57
s_lshl_b32 s68,s54,4
s_add_u32 s68,s68,s56
s_lshl_b32 s68,s68,10
s_add_u32 m0,s25,65536
s_add_u32 s28,s29,786432
buffer_load_dwordx4 v20,s[12:15],s28 offen lds
s_add_u32 s68,50331648,s68
s_mul_i32 s55,s24,192
s_add_u32 s68,s68,s55
s_mul_i32 s54,s54,2523136
s_mul_i32 s55,s56,1024
s_add_u32 s54,s54,s55
s_sub_u32 s68,s68,s54
s_add_u32 s20,s52,s54
s_addc_u32 s21,s53,0
buffer_load_dwordx4 v21,s[12:15],s28 offen offset:1024 lds
s_mov_b32 s22,67108864
s_mov_b32 s23,0x20000
s_mul_i32 s54,s56,229376
s_add_u32 s96,s96,s54
s_addc_u32 s97,s97,0
s_mov_b32 s98,229376
s_mov_b32 s99,0x20000
s_mov_b64 s[32:33],s[12:13]
s_mov_b64 s[34:35],s[14:15]
buffer_load_dwordx4 v22,s[12:15],s28 offen offset:2048 lds
s_mov_b32 s36,0
s_add_u32 s37,s25,49152
s_add_u32 s38,s25,81920
s_add_u32 s40,s29,1310720
s_add_u32 s39,s29,1572864
s_mov_b32 s41,524288
s_mov_b32 s42,256
s_mov_b32 s43,s69
buffer_load_dwordx4 v23,s[12:15],s28 offen offset:3072 lds
s_mov_b32 s45,24576
s_mov_b32 s46,16384
v_mov_b64 v[64:65],0
v_mov_b64 v[66:67],0
v_mov_b64 v[68:69],0
v_mov_b64 v[70:71],0
v_mov_b64 v[72:73],0
v_mov_b64 v[74:75],0
s_add_u32 m0,s25,32768
s_add_u32 s28,s29,1048576
buffer_load_dwordx4 v20,s[12:15],s28 offen lds
v_mov_b64 v[76:77],0
v_mov_b64 v[78:79],0
v_mov_b64 v[80:81],0
v_mov_b64 v[82:83],0
v_mov_b64 v[84:85],0
v_mov_b64 v[86:87],0
v_mov_b64 v[88:89],0
v_mov_b64 v[90:91],0
buffer_load_dwordx4 v21,s[12:15],s28 offen offset:1024 lds
v_mov_b64 v[92:93],0
v_mov_b64 v[94:95],0
v_mov_b64 v[96:97],0
v_mov_b64 v[98:99],0
v_mov_b64 v[100:101],0
v_mov_b64 v[102:103],0
v_mov_b64 v[104:105],0
v_mov_b64 v[106:107],0
buffer_load_dwordx4 v22,s[12:15],s28 offen offset:2048 lds
v_mov_b64 v[108:109],0
v_mov_b64 v[110:111],0
v_mov_b64 v[112:113],0
v_mov_b64 v[114:115],0
v_mov_b64 v[116:117],0
v_mov_b64 v[118:119],0
v_mov_b64 v[120:121],0
v_mov_b64 v[122:123],0
buffer_load_dwordx4 v23,s[12:15],s28 offen offset:3072 lds
v_mov_b64 v[124:125],0
v_mov_b64 v[126:127],0
v_mov_b64 v[128:129],0
v_mov_b64 v[130:131],0
v_mov_b64 v[132:133],0
v_mov_b64 v[134:135],0
v_mov_b64 v[136:137],0
v_mov_b64 v[138:139],0
s_mov_b32 m0,s25
s_nop 0
buffer_load_dwordx4 v12,s[4:7],s25 offen nt lds
v_mov_b64 v[140:141],0
v_mov_b64 v[142:143],0
v_mov_b64 v[144:145],0
v_mov_b64 v[146:147],0
v_mov_b64 v[148:149],0
v_mov_b64 v[150:151],0
v_mov_b64 v[152:153],0
v_mov_b64 v[154:155],0
buffer_load_dwordx4 v13,s[4:7],s25 offen offset:1024 nt lds
v_mov_b64 v[156:157],0
v_mov_b64 v[158:159],0
v_mov_b64 v[160:161],0
v_mov_b64 v[162:163],0
v_mov_b64 v[164:165],0
v_mov_b64 v[166:167],0
v_mov_b64 v[168:169],0
v_mov_b64 v[170:171],0
buffer_load_dwordx4 v14,s[4:7],s25 offen offset:2048 nt lds
v_mov_b64 v[172:173],0
v_mov_b64 v[174:175],0
v_mov_b64 v[176:177],0
v_mov_b64 v[178:179],0
v_mov_b64 v[180:181],0
v_mov_b64 v[182:183],0
v_mov_b64 v[184:185],0
v_mov_b64 v[186:187],0
buffer_load_dwordx4 v15,s[4:7],s25 offen offset:3072 nt lds
v_mov_b64 v[188:189],0
v_mov_b64 v[190:191],0
v_mov_b64 v[192:193],0
v_mov_b64 v[194:195],0
v_mov_b64 v[196:197],0
v_mov_b64 v[198:199],0
v_mov_b64 v[200:201],0
v_mov_b64 v[202:203],0
v_mov_b64 v[204:205],0
v_mov_b64 v[206:207],0
v_mov_b64 v[208:209],0
v_mov_b64 v[210:211],0
v_mov_b64 v[212:213],0
v_mov_b64 v[214:215],0
v_mov_b64 v[216:217],0
v_mov_b64 v[218:219],0
v_mov_b64 v[220:221],0
v_mov_b64 v[222:223],0
v_mov_b64 v[224:225],0
v_mov_b64 v[226:227],0
v_mov_b64 v[228:229],0
v_mov_b64 v[230:231],0
v_mov_b64 v[232:233],0
v_mov_b64 v[234:235],0
v_mov_b64 v[236:237],0
v_mov_b64 v[238:239],0
v_mov_b64 v[240:241],0
v_mov_b64 v[242:243],0
v_mov_b64 v[244:245],0
v_mov_b64 v[246:247],0
v_mov_b64 v[248:249],0
v_mov_b64 v[250:251],0
v_mov_b64 v[252:253],0
v_mov_b64 v[254:255],0
s_waitcnt vmcnt(26)
s_barrier
ds_read_b128 a[0:3],v44 offset:0
ds_read_b128 a[4:7],v44 offset:2048
ds_read_b128 a[8:11],v44 offset:4096
ds_read_b64_tr_b16 a[192:193],v16 offset:0
ds_read_b64_tr_b16 a[194:195],v16 offset:8192
ds_read_b64_tr_b16 a[196:197],v16 offset:8
ds_read_b64_tr_b16 a[198:199],v16 offset:8200
ds_read_b64_tr_b16 a[200:201],v17 offset:0
ds_read_b64_tr_b16 a[202:203],v17 offset:8192
ds_read_b64_tr_b16 a[204:205],v17 offset:8
ds_read_b64_tr_b16 a[206:207],v17 offset:8200
ds_read_b64_tr_b16 a[208:209],v18 offset:0
ds_read_b64_tr_b16 a[210:211],v18 offset:8192
s_waitcnt lgkmcnt(8)
v_add_u32 v44,24576,v44
QLOOP_A2:
s_waitcnt vmcnt(22)
s_barrier
s_mov_b32 m0,s38
v_mfma_f32_16x16x32_bf16 v[64:67],a[192:195],a[0:3],v[64:67]
ds_read_b128 a[12:15],v45 offset:0
ds_read_b64_tr_b16 a[212:213],v18 offset:8
v_mfma_f32_16x16x32_bf16 v[128:131],a[192:195],a[4:7],v[128:131]
buffer_load_dwordx4 v20,s[32:35],s40 offen lds
v_mfma_f32_16x16x32_bf16 v[192:195],a[192:195],a[8:11],v[192:195]
ds_read_b64_tr_b16 a[214:215],v18 offset:8200
s_waitcnt lgkmcnt(9)
v_mfma_f32_16x16x32_bf16 v[68:71],a[196:199],a[0:3],v[68:71]
ds_read_b128 a[16:19],v45 offset:2048
ds_read_b64_tr_b16 a[216:217],v19 offset:0
v_mfma_f32_16x16x32_bf16 v[132:135],a[196:199],a[4:7],v[132:135]
buffer_load_dwordx4 v21,s[32:35],s40 offen offset:1024 lds
v_mfma_f32_16x16x32_bf16 v[196:199],a[196:199],a[8:11],v[196:199]
ds_read_b64_tr_b16 a[218:219],v19 offset:8192
s_waitcnt lgkmcnt(10)
v_mfma_f32_16x16x32_bf16 v[72:75],a[200:203],a[0:3],v[72:75]
ds_read_b128 a[20:23],v45 offset:4096
ds_read_b64_tr_b16 a[220:221],v19 offset:8
v_mfma_f32_16x16x32_bf16 v[136:139],a[200:203],a[4:7],v[136:139]
buffer_load_dwordx4 v22,s[32:35],s40 offen offset:2048 lds
v_mfma_f32_16x16x32_bf16 v[200:203],a[200:203],a[8:11],v[200:203]
ds_read_b64_tr_b16 a[222:223],v19 offset:8200
s_waitcnt lgkmcnt(11)
v_mfma_f32_16x16x32_bf16 v[76:79],a[204:207],a[0:3],v[76:79]
v_add_u32 v45,s45,v45
ds_read_b64_tr_b16 a[192:193],v16 offset:256
v_mfma_f32_16x16x32_bf16 v[140:143],a[204:207],a[4:7],v[140:143]
buffer_load_dwordx4 v23,s[32:35],s40 offen offset:3072 lds
v_mfma_f32_16x16x32_bf16 v[204:207],a[204:207],a[8:11],v[204:207]
ds_read_b64_tr_b16 a[194:195],v16 offset:8448
s_waitcnt lgkmcnt(11)
v_mfma_f32_16x16x32_bf16 v[80:83],a[208:211],a[0:3],v[80:83]
s_mov_b32 m0,s43
ds_read_b64_tr_b16 a[196:197],v16 offset:264
v_mfma_f32_16x16x32_bf16 v[144:147],a[208:211],a[4:7],v[144:147]
v_mfma_f32_16x16x32_bf16 v[208:211],a[208:211],a[8:11],v[208:211]
ds_read_b64_tr_b16 a[198:199],v16 offset:8456
s_waitcnt lgkmcnt(10)
v_mfma_f32_16x16x32_bf16 v[84:87],a[212:215],a[0:3],v[84:87]
ds_read_b64_tr_b16 a[200:201],v17 offset:256
v_mfma_f32_16x16x32_bf16 v[148:151],a[212:215],a[4:7],v[148:151]
v_mfma_f32_16x16x32_bf16 v[212:215],a[212:215],a[8:11],v[212:215]
ds_read_b64_tr_b16 a[202:203],v17 offset:8448
s_waitcnt lgkmcnt(9)
v_mfma_f32_16x16x32_bf16 v[88:91],a[216:219],a[0:3],v[88:91]
ds_read_b64_tr_b16 a[204:205],v17 offset:264
v_mfma_f32_16x16x32_bf16 v[152:155],a[216:219],a[4:7],v[152:155]
v_mfma_f32_16x16x32_bf16 v[216:219],a[216:219],a[8:11],v[216:219]
ds_read_b64_tr_b16 a[206:207],v17 offset:8456
s_waitcnt lgkmcnt(8)
v_mfma_f32_16x16x32_bf16 v[92:95],a[220:223],a[0:3],v[92:95]
s_waitcnt lgkmcnt(10)
ds_read_b64_tr_b16 a[208:209],v18 offset:256
v_mfma_f32_16x16x32_bf16 v[156:159],a[220:223],a[4:7],v[156:159]
buffer_load_dwordx4 v24,s[16:19],s42 offen lds
v_mfma_f32_16x16x32_bf16 v[220:223],a[220:223],a[8:11],v[220:223]
ds_read_b64_tr_b16 a[210:211],v18 offset:8448
s_waitcnt lgkmcnt(8)
v_mfma_f32_16x16x32_bf16 v[96:99],a[192:195],a[0:3],v[96:99]
ds_read_b64_tr_b16 a[212:213],v18 offset:264
v_mfma_f32_16x16x32_bf16 v[160:163],a[192:195],a[4:7],v[160:163]
buffer_load_dwordx4 v25,s[16:19],s42 offen offset:1024 lds
v_mfma_f32_16x16x32_bf16 v[224:227],a[192:195],a[8:11],v[224:227]
ds_read_b64_tr_b16 a[214:215],v18 offset:8456
s_waitcnt lgkmcnt(8)
v_mfma_f32_16x16x32_bf16 v[100:103],a[196:199],a[0:3],v[100:103]
ds_read_b64_tr_b16 a[216:217],v19 offset:256
v_mfma_f32_16x16x32_bf16 v[164:167],a[196:199],a[4:7],v[164:167]
buffer_load_dwordx4 v26,s[16:19],s42 offen offset:2048 lds
v_mfma_f32_16x16x32_bf16 v[228:231],a[196:199],a[8:11],v[228:231]
ds_read_b64_tr_b16 a[218:219],v19 offset:8448
s_waitcnt lgkmcnt(8)
v_mfma_f32_16x16x32_bf16 v[104:107],a[200:203],a[0:3],v[104:107]
ds_read_b64_tr_b16 a[220:221],v19 offset:264
v_mfma_f32_16x16x32_bf16 v[168:171],a[200:203],a[4:7],v[168:171]
buffer_load_dwordx4 v27,s[16:19],s42 offen offset:3072 lds
v_mfma_f32_16x16x32_bf16 v[232:235],a[200:203],a[8:11],v[232:235]
ds_read_b64_tr_b16 a[222:223],v19 offset:8456
s_waitcnt lgkmcnt(8)
v_mfma_f32_16x16x32_bf16 v[108:111],a[204:207],a[0:3],v[108:111]
s_add_u32 m0,s43,4096
ds_read_b64_tr_b16 a[192:193],v16 offset:49152
v_mfma_f32_16x16x32_bf16 v[172:175],a[204:207],a[4:7],v[172:175]
buffer_load_dwordx4 v28,s[16:19],s42 offen lds
v_mfma_f32_16x16x32_bf16 v[236:239],a[204:207],a[8:11],v[236:239]
ds_read_b64_tr_b16 a[194:195],v16 offset:57344
s_waitcnt lgkmcnt(8)
v_mfma_f32_16x16x32_bf16 v[112:115],a[208:211],a[0:3],v[112:115]
ds_read_b64_tr_b16 a[196:197],v16 offset:49160
v_mfma_f32_16x16x32_bf16 v[176:179],a[208:211],a[4:7],v[176:179]
buffer_load_dwordx4 v29,s[16:19],s42 offen offset:1024 lds
v_mfma_f32_16x16x32_bf16 v[240:243],a[208:211],a[8:11],v[240:243]
ds_read_b64_tr_b16 a[198:199],v16 offset:57352
s_waitcnt lgkmcnt(8)
v_mfma_f32_16x16x32_bf16 v[116:119],a[212:215],a[0:3],v[116:119]
ds_read_b64_tr_b16 a[200:201],v17 offset:49152
v_mfma_f32_16x16x32_bf16 v[180:183],a[212:215],a[4:7],v[180:183]
v_mfma_f32_16x16x32_bf16 v[244:247],a[212:215],a[8:11],v[244:247]
ds_read_b64_tr_b16 a[202:203],v17 offset:57344
s_waitcnt lgkmcnt(8)
v_mfma_f32_16x16x32_bf16 v[120:123],a[216:219],a[0:3],v[120:123]
ds_read_b64_tr_b16 a[204:205],v17 offset:49160
v_mfma_f32_16x16x32_bf16 v[184:187],a[216:219],a[4:7],v[184:187]
v_mfma_f32_16x16x32_bf16 v[248:251],a[216:219],a[8:11],v[248:251]
ds_read_b64_tr_b16 a[206:207],v17 offset:57352
s_waitcnt lgkmcnt(8)
v_mfma_f32_16x16x32_bf16 v[124:127],a[220:223],a[0:3],v[124:127]
ds_read_b64_tr_b16 a[208:209],v18 offset:49152
v_mfma_f32_16x16x32_bf16 v[188:191],a[220:223],a[4:7],v[188:191]
v_mfma_f32_16x16x32_bf16 v[252:255],a[220:223],a[8:11],v[252:255]
ds_read_b64_tr_b16 a[210:211],v18 offset:57344
s_waitcnt lgkmcnt(8)
s_cmp_eq_u32 s36,4
s_cbranch_scc0 QSW_A2
s_mov_b64 s[12:13],s[4:5]
s_mov_b32 s14,s6
s_mov_b64 s[32:33],s[8:9]
s_mov_b32 s34,s10
s_mov_b32 s41,16384
s_add_u32 s39,s25,16384
s_sub_u32 s40,s25,16384
s_mov_b32 s18,0
v_mov_b32 v20,v12
v_mov_b32 v21,v13
v_mov_b32 v22,v14
v_mov_b32 v23,v15
QSW_A2:
s_waitcnt vmcnt(24)
s_barrier
s_mov_b32 m0,s37
v_mfma_f32_16x16x32_bf16 v[64:67],a[192:195],a[12:15],v[64:67]
s_cmp_ge_u32 s37,49152
ds_read_b64_tr_b16 a[212:213],v18 offset:49160
v_mfma_f32_16x16x32_bf16 v[128:131],a[192:195],a[16:19],v[128:131]
buffer_load_dwordx4 v20,s[12:15],s39 offen lds
v_mfma_f32_16x16x32_bf16 v[192:195],a[192:195],a[20:23],v[192:195]
ds_read_b64_tr_b16 a[214:215],v18 offset:57352
s_waitcnt lgkmcnt(8)
v_mfma_f32_16x16x32_bf16 v[68:71],a[196:199],a[12:15],v[68:71]
s_cselect_b32 s44,0xffff8000,s46
ds_read_b64_tr_b16 a[216:217],v19 offset:49152
v_mfma_f32_16x16x32_bf16 v[132:135],a[196:199],a[16:19],v[132:135]
buffer_load_dwordx4 v21,s[12:15],s39 offen offset:1024 lds
v_mfma_f32_16x16x32_bf16 v[196:199],a[196:199],a[20:23],v[196:199]
ds_read_b64_tr_b16 a[218:219],v19 offset:57344
s_waitcnt lgkmcnt(8)
v_mfma_f32_16x16x32_bf16 v[72:75],a[200:203],a[12:15],v[72:75]
s_add_u32 s38,s37,49152
ds_read_b64_tr_b16 a[220:221],v19 offset:49160
v_mfma_f32_16x16x32_bf16 v[136:139],a[200:203],a[16:19],v[136:139]
buffer_load_dwordx4 v22,s[12:15],s39 offen offset:2048 lds
v_mfma_f32_16x16x32_bf16 v[200:203],a[200:203],a[20:23],v[200:203]
ds_read_b64_tr_b16 a[222:223],v19 offset:57352
s_waitcnt lgkmcnt(8)
v_mfma_f32_16x16x32_bf16 v[76:79],a[204:207],a[12:15],v[76:79]
s_add_u32 s37,s37,s44
ds_read_b64_tr_b16 a[192:193],v16 offset:49408
v_mfma_f32_16x16x32_bf16 v[140:143],a[204:207],a[16:19],v[140:143]
buffer_load_dwordx4 v23,s[12:15],s39 offen offset:3072 lds
v_mfma_f32_16x16x32_bf16 v[204:207],a[204:207],a[20:23],v[204:207]
ds_read_b64_tr_b16 a[194:195],v16 offset:57600
s_waitcnt lgkmcnt(8)
v_mfma_f32_16x16x32_bf16 v[80:83],a[208:211],a[12:15],v[80:83]
s_add_u32 s39,s39,s41
ds_read_b64_tr_b16 a[196:197],v16 offset:49416
v_mfma_f32_16x16x32_bf16 v[144:147],a[208:211],a[16:19],v[144:147]
v_mfma_f32_16x16x32_bf16 v[208:211],a[208:211],a[20:23],v[208:211]
ds_read_b64_tr_b16 a[198:199],v16 offset:57608
s_waitcnt lgkmcnt(8)
v_mfma_f32_16x16x32_bf16 v[84:87],a[212:215],a[12:15],v[84:87]
s_add_u32 s40,s40,s41
ds_read_b64_tr_b16 a[200:201],v17 offset:49408
v_mfma_f32_16x16x32_bf16 v[148:151],a[212:215],a[16:19],v[148:151]
v_add_u32 v16,s44,v16
v_mfma_f32_16x16x32_bf16 v[212:215],a[212:215],a[20:23],v[212:215]
ds_read_b64_tr_b16 a[202:203],v17 offset:57600
s_waitcnt lgkmcnt(8)
v_mfma_f32_16x16x32_bf16 v[88:91],a[216:219],a[12:15],v[88:91]
s_add_u32 s42,s42,128
ds_read_b64_tr_b16 a[204:205],v17 offset:49416
v_mfma_f32_16x16x32_bf16 v[152:155],a[216:219],a[16:19],v[152:155]
v_mfma_f32_16x16x32_bf16 v[216:219],a[216:219],a[20:23],v[216:219]
ds_read_b64_tr_b16 a[206:207],v17 offset:57608
s_waitcnt lgkmcnt(8)
v_mfma_f32_16x16x32_bf16 v[92:95],a[220:223],a[12:15],v[92:95]
s_add_u32 s43,s43,s45
ds_read_b64_tr_b16 a[208:209],v18 offset:49408
v_mfma_f32_16x16x32_bf16 v[156:159],a[220:223],a[16:19],v[156:159]
v_add_u32 v17,s44,v17
v_mfma_f32_16x16x32_bf16 v[220:223],a[220:223],a[20:23],v[220:223]
ds_read_b64_tr_b16 a[210:211],v18 offset:57600
s_waitcnt lgkmcnt(8)
v_mfma_f32_16x16x32_bf16 v[96:99],a[192:195],a[12:15],v[96:99]
s_add_u32 s36,s36,1
ds_read_b64_tr_b16 a[212:213],v18 offset:49416
v_mfma_f32_16x16x32_bf16 v[160:163],a[192:195],a[16:19],v[160:163]
v_mfma_f32_16x16x32_bf16 v[224:227],a[192:195],a[20:23],v[224:227]
ds_read_b64_tr_b16 a[214:215],v18 offset:57608
s_waitcnt lgkmcnt(8)
v_mfma_f32_16x16x32_bf16 v[100:103],a[196:199],a[12:15],v[100:103]
ds_read_b64_tr_b16 a[216:217],v19 offset:49408
v_mfma_f32_16x16x32_bf16 v[164:167],a[196:199],a[16:19],v[164:167]
s_waitcnt vmcnt(18)
ds_read_b128 a[0:3],v44 offset:0
v_mfma_f32_16x16x32_bf16 v[228:231],a[196:199],a[20:23],v[228:231]
ds_read_b64_tr_b16 a[218:219],v19 offset:57600
s_waitcnt lgkmcnt(9)
v_mfma_f32_16x16x32_bf16 v[104:107],a[200:203],a[12:15],v[104:107]
ds_read_b64_tr_b16 a[220:221],v19 offset:49416
v_mfma_f32_16x16x32_bf16 v[168:171],a[200:203],a[16:19],v[168:171]
ds_read_b128 a[4:7],v44 offset:2048
ds_read_b128 a[8:11],v44 offset:4096
v_mfma_f32_16x16x32_bf16 v[232:235],a[200:203],a[20:23],v[232:235]
ds_read_b64_tr_b16 a[222:223],v19 offset:57608
s_waitcnt lgkmcnt(11)
v_mfma_f32_16x16x32_bf16 v[108:111],a[204:207],a[12:15],v[108:111]
ds_read_b64_tr_b16 a[192:193],v16 offset:0
v_mfma_f32_16x16x32_bf16 v[172:175],a[204:207],a[16:19],v[172:175]
v_subrev_u32 v44,s45,v44
v_mfma_f32_16x16x32_bf16 v[236:239],a[204:207],a[20:23],v[236:239]
ds_read_b64_tr_b16 a[194:195],v16 offset:8192
s_waitcnt lgkmcnt(11)
v_mfma_f32_16x16x32_bf16 v[112:115],a[208:211],a[12:15],v[112:115]
ds_read_b64_tr_b16 a[196:197],v16 offset:8
v_mfma_f32_16x16x32_bf16 v[176:179],a[208:211],a[16:19],v[176:179]
s_sub_u32 s45,0,s45
v_add_u32 v18,s44,v18
v_mfma_f32_16x16x32_bf16 v[240:243],a[208:211],a[20:23],v[240:243]
ds_read_b64_tr_b16 a[198:199],v16 offset:8200
s_waitcnt lgkmcnt(11)
v_mfma_f32_16x16x32_bf16 v[116:119],a[212:215],a[12:15],v[116:119]
ds_read_b64_tr_b16 a[200:201],v17 offset:0
v_mfma_f32_16x16x32_bf16 v[180:183],a[212:215],a[16:19],v[180:183]
v_add_u32 v19,s44,v19
v_mfma_f32_16x16x32_bf16 v[244:247],a[212:215],a[20:23],v[244:247]
ds_read_b64_tr_b16 a[202:203],v17 offset:8192
s_waitcnt lgkmcnt(10)
v_mfma_f32_16x16x32_bf16 v[120:123],a[216:219],a[12:15],v[120:123]
ds_read_b64_tr_b16 a[204:205],v17 offset:8
v_mfma_f32_16x16x32_bf16 v[184:187],a[216:219],a[16:19],v[184:187]
v_mfma_f32_16x16x32_bf16 v[248:251],a[216:219],a[20:23],v[248:251]
ds_read_b64_tr_b16 a[206:207],v17 offset:8200
s_waitcnt lgkmcnt(8)
v_mfma_f32_16x16x32_bf16 v[124:127],a[220:223],a[12:15],v[124:127]
ds_read_b64_tr_b16 a[208:209],v18 offset:0
v_mfma_f32_16x16x32_bf16 v[188:191],a[220:223],a[16:19],v[188:191]
v_mfma_f32_16x16x32_bf16 v[252:255],a[220:223],a[20:23],v[252:255]
ds_read_b64_tr_b16 a[210:211],v18 offset:8192
s_waitcnt lgkmcnt(8)
s_cmp_lt_u32 s36,7
s_cbranch_scc1 QLOOP_A2
v_pk_mul_f32 v[64:65],s[60:61],v[64:65]
v_pk_mul_f32 v[66:67],s[60:61],v[66:67]
v_pk_mul_f32 v[68:69],s[60:61],v[68:69]
v_pk_mul_f32 v[70:71],s[60:61],v[70:71]
v_cvt_pk_bf16_f32 v16,v64,v65
v_cvt_pk_bf16_f32 v17,v66,v67
v_cvt_pk_bf16_f32 v18,v68,v69
v_cvt_pk_bf16_f32 v19,v70,v71
v_pk_mul_f32 v[72:73],s[60:61],v[72:73]
v_pk_mul_f32 v[74:75],s[60:61],v[74:75]
v_pk_mul_f32 v[76:77],s[60:61],v[76:77]
v_pk_mul_f32 v[78:79],s[60:61],v[78:79]
v_cvt_pk_bf16_f32 v20,v72,v73
v_cvt_pk_bf16_f32 v21,v74,v75
v_cvt_pk_bf16_f32 v22,v76,v77
v_cvt_pk_bf16_f32 v23,v78,v79
v_pk_mul_f32 v[80:81],s[60:61],v[80:81]
v_pk_mul_f32 v[82:83],s[60:61],v[82:83]
v_pk_mul_f32 v[84:85],s[60:61],v[84:85]
v_pk_mul_f32 v[86:87],s[60:61],v[86:87]
v_cvt_pk_bf16_f32 v24,v80,v81
v_cvt_pk_bf16_f32 v25,v82,v83
v_cvt_pk_bf16_f32 v26,v84,v85
v_cvt_pk_bf16_f32 v27,v86,v87
v_pk_mul_f32 v[88:89],s[60:61],v[88:89]
v_pk_mul_f32 v[90:91],s[60:61],v[90:91]
v_pk_mul_f32 v[92:93],s[60:61],v[92:93]
v_pk_mul_f32 v[94:95],s[60:61],v[94:95]
v_cvt_pk_bf16_f32 v28,v88,v89
v_cvt_pk_bf16_f32 v29,v90,v91
v_cvt_pk_bf16_f32 v30,v92,v93
v_cvt_pk_bf16_f32 v31,v94,v95
v_pk_mul_f32 v[96:97],s[60:61],v[96:97]
v_pk_mul_f32 v[98:99],s[60:61],v[98:99]
v_pk_mul_f32 v[100:101],s[60:61],v[100:101]
v_pk_mul_f32 v[102:103],s[60:61],v[102:103]
v_cvt_pk_bf16_f32 v32,v96,v97
v_cvt_pk_bf16_f32 v33,v98,v99
v_cvt_pk_bf16_f32 v34,v100,v101
v_cvt_pk_bf16_f32 v35,v102,v103
v_pk_mul_f32 v[104:105],s[60:61],v[104:105]
v_pk_mul_f32 v[106:107],s[60:61],v[106:107]
v_pk_mul_f32 v[108:109],s[60:61],v[108:109]
v_pk_mul_f32 v[110:111],s[60:61],v[110:111]
v_cvt_pk_bf16_f32 v36,v104,v105
v_cvt_pk_bf16_f32 v37,v106,v107
v_cvt_pk_bf16_f32 v38,v108,v109
v_cvt_pk_bf16_f32 v39,v110,v111
v_pk_mul_f32 v[112:113],s[60:61],v[112:113]
v_pk_mul_f32 v[114:115],s[60:61],v[114:115]
v_pk_mul_f32 v[116:117],s[60:61],v[116:117]
v_pk_mul_f32 v[118:119],s[60:61],v[118:119]
v_cvt_pk_bf16_f32 v40,v112,v113
v_cvt_pk_bf16_f32 v41,v114,v115
v_cvt_pk_bf16_f32 v42,v116,v117
v_cvt_pk_bf16_f32 v43,v118,v119
v_pk_mul_f32 v[120:121],s[60:61],v[120:121]
v_pk_mul_f32 v[122:123],s[60:61],v[122:123]
v_pk_mul_f32 v[124:125],s[60:61],v[124:125]
v_pk_mul_f32 v[126:127],s[60:61],v[126:127]
v_cvt_pk_bf16_f32 v44,v120,v121
v_cvt_pk_bf16_f32 v45,v122,v123
v_cvt_pk_bf16_f32 v46,v124,v125
v_cvt_pk_bf16_f32 v47,v126,v127
v_pk_mul_f32 v[128:129],s[60:61],v[128:129]
v_pk_mul_f32 v[130:131],s[60:61],v[130:131]
v_pk_mul_f32 v[132:133],s[60:61],v[132:133]
v_pk_mul_f32 v[134:135],s[60:61],v[134:135]
v_cvt_pk_bf16_f32 v48,v128,v129
v_cvt_pk_bf16_f32 v49,v130,v131
v_cvt_pk_bf16_f32 v50,v132,v133
v_cvt_pk_bf16_f32 v51,v134,v135
v_pk_mul_f32 v[136:137],s[60:61],v[136:137]
v_pk_mul_f32 v[138:139],s[60:61],v[138:139]
v_pk_mul_f32 v[140:141],s[60:61],v[140:141]
v_pk_mul_f32 v[142:143],s[60:61],v[142:143]
v_cvt_pk_bf16_f32 v52,v136,v137
v_cvt_pk_bf16_f32 v53,v138,v139
v_cvt_pk_bf16_f32 v54,v140,v141
v_cvt_pk_bf16_f32 v55,v142,v143
v_pk_mul_f32 v[144:145],s[60:61],v[144:145]
v_pk_mul_f32 v[146:147],s[60:61],v[146:147]
v_pk_mul_f32 v[148:149],s[60:61],v[148:149]
v_pk_mul_f32 v[150:151],s[60:61],v[150:151]
v_cvt_pk_bf16_f32 v56,v144,v145
v_cvt_pk_bf16_f32 v57,v146,v147
v_cvt_pk_bf16_f32 v58,v148,v149
v_cvt_pk_bf16_f32 v59,v150,v151
v_pk_mul_f32 v[152:153],s[60:61],v[152:153]
v_pk_mul_f32 v[154:155],s[60:61],v[154:155]
v_pk_mul_f32 v[156:157],s[60:61],v[156:157]
v_pk_mul_f32 v[158:159],s[60:61],v[158:159]
v_cvt_pk_bf16_f32 v60,v152,v153
v_cvt_pk_bf16_f32 v61,v154,v155
v_cvt_pk_bf16_f32 v62,v156,v157
v_cvt_pk_bf16_f32 v63,v158,v159
v_pk_mul_f32 v[160:161],s[60:61],v[160:161]
v_pk_mul_f32 v[162:163],s[60:61],v[162:163]
v_pk_mul_f32 v[164:165],s[60:61],v[164:165]
v_pk_mul_f32 v[166:167],s[60:61],v[166:167]
v_cvt_pk_bf16_f32 v64,v160,v161
v_cvt_pk_bf16_f32 v65,v162,v163
v_cvt_pk_bf16_f32 v66,v164,v165
v_cvt_pk_bf16_f32 v67,v166,v167
v_pk_mul_f32 v[168:169],s[60:61],v[168:169]
v_pk_mul_f32 v[170:171],s[60:61],v[170:171]
v_pk_mul_f32 v[172:173],s[60:61],v[172:173]
v_pk_mul_f32 v[174:175],s[60:61],v[174:175]
v_cvt_pk_bf16_f32 v68,v168,v169
v_cvt_pk_bf16_f32 v69,v170,v171
v_cvt_pk_bf16_f32 v70,v172,v173
v_cvt_pk_bf16_f32 v71,v174,v175
v_pk_mul_f32 v[176:177],s[60:61],v[176:177]
v_pk_mul_f32 v[178:179],s[60:61],v[178:179]
v_pk_mul_f32 v[180:181],s[60:61],v[180:181]
v_pk_mul_f32 v[182:183],s[60:61],v[182:183]
v_cvt_pk_bf16_f32 v72,v176,v177
v_cvt_pk_bf16_f32 v73,v178,v179
v_cvt_pk_bf16_f32 v74,v180,v181
v_cvt_pk_bf16_f32 v75,v182,v183
v_pk_mul_f32 v[184:185],s[60:61],v[184:185]
v_pk_mul_f32 v[186:187],s[60:61],v[186:187]
v_pk_mul_f32 v[188:189],s[60:61],v[188:189]
v_pk_mul_f32 v[190:191],s[60:61],v[190:191]
v_cvt_pk_bf16_f32 v76,v184,v185
v_cvt_pk_bf16_f32 v77,v186,v187
v_cvt_pk_bf16_f32 v78,v188,v189
v_cvt_pk_bf16_f32 v79,v190,v191
v_pk_mul_f32 v[192:193],s[60:61],v[192:193]
v_pk_mul_f32 v[194:195],s[60:61],v[194:195]
v_pk_mul_f32 v[196:197],s[60:61],v[196:197]
v_pk_mul_f32 v[198:199],s[60:61],v[198:199]
v_cvt_pk_bf16_f32 v80,v192,v193
v_cvt_pk_bf16_f32 v81,v194,v195
v_cvt_pk_bf16_f32 v82,v196,v197
v_cvt_pk_bf16_f32 v83,v198,v199
v_pk_mul_f32 v[200:201],s[60:61],v[200:201]
v_pk_mul_f32 v[202:203],s[60:61],v[202:203]
v_pk_mul_f32 v[204:205],s[60:61],v[204:205]
v_pk_mul_f32 v[206:207],s[60:61],v[206:207]
v_cvt_pk_bf16_f32 v84,v200,v201
v_cvt_pk_bf16_f32 v85,v202,v203
v_cvt_pk_bf16_f32 v86,v204,v205
v_cvt_pk_bf16_f32 v87,v206,v207
v_pk_mul_f32 v[208:209],s[60:61],v[208:209]
v_pk_mul_f32 v[210:211],s[60:61],v[210:211]
v_pk_mul_f32 v[212:213],s[60:61],v[212:213]
v_pk_mul_f32 v[214:215],s[60:61],v[214:215]
v_cvt_pk_bf16_f32 v88,v208,v209
v_cvt_pk_bf16_f32 v89,v210,v211
v_cvt_pk_bf16_f32 v90,v212,v213
v_cvt_pk_bf16_f32 v91,v214,v215
s_waitcnt lgkmcnt(0)
ds_read_b128 a[192:195],v0 offset:0
ds_read_b128 a[196:199],v1 offset:0
ds_read_b128 a[200:203],v2 offset:0
ds_read_b128 a[204:207],v3 offset:0
ds_read_b128 a[208:211],v0 offset:256
ds_read_b128 a[212:215],v1 offset:256
ds_read_b128 a[216:219],v2 offset:256
ds_read_b128 a[220:223],v3 offset:256
v_pk_mul_f32 v[216:217],s[60:61],v[216:217]
v_pk_mul_f32 v[218:219],s[60:61],v[218:219]
v_pk_mul_f32 v[220:221],s[60:61],v[220:221]
v_pk_mul_f32 v[222:223],s[60:61],v[222:223]
v_cvt_pk_bf16_f32 v92,v216,v217
v_cvt_pk_bf16_f32 v93,v218,v219
v_cvt_pk_bf16_f32 v94,v220,v221
v_cvt_pk_bf16_f32 v95,v222,v223
v_pk_mul_f32 v[224:225],s[60:61],v[224:225]
v_pk_mul_f32 v[226:227],s[60:61],v[226:227]
v_pk_mul_f32 v[228:229],s[60:61],v[228:229]
v_pk_mul_f32 v[230:231],s[60:61],v[230:231]
v_cvt_pk_bf16_f32 v96,v224,v225
v_cvt_pk_bf16_f32 v97,v226,v227
v_cvt_pk_bf16_f32 v98,v228,v229
v_cvt_pk_bf16_f32 v99,v230,v231
v_pk_mul_f32 v[232:233],s[60:61],v[232:233]
v_pk_mul_f32 v[234:235],s[60:61],v[234:235]
v_pk_mul_f32 v[236:237],s[60:61],v[236:237]
v_pk_mul_f32 v[238:239],s[60:61],v[238:239]
v_cvt_pk_bf16_f32 v100,v232,v233
v_cvt_pk_bf16_f32 v101,v234,v235
v_cvt_pk_bf16_f32 v102,v236,v237
v_cvt_pk_bf16_f32 v103,v238,v239
v_pk_mul_f32 v[240:241],s[60:61],v[240:241]
v_pk_mul_f32 v[242:243],s[60:61],v[242:243]
v_pk_mul_f32 v[244:245],s[60:61],v[244:245]
v_pk_mul_f32 v[246:247],s[60:61],v[246:247]
v_cvt_pk_bf16_f32 v104,v240,v241
v_cvt_pk_bf16_f32 v105,v242,v243
v_cvt_pk_bf16_f32 v106,v244,v245
v_cvt_pk_bf16_f32 v107,v246,v247
v_pk_mul_f32 v[248:249],s[60:61],v[248:249]
v_pk_mul_f32 v[250:251],s[60:61],v[250:251]
v_pk_mul_f32 v[252:253],s[60:61],v[252:253]
v_pk_mul_f32 v[254:255],s[60:61],v[254:255]
v_cvt_pk_bf16_f32 v108,v248,v249
v_cvt_pk_bf16_f32 v109,v250,v251
v_cvt_pk_bf16_f32 v110,v252,v253
v_cvt_pk_bf16_f32 v111,v254,v255
v_mov_b32 v208,0x7f800000
v_mov_b32 v212,0x7f800000
v_mov_b32 v216,0x7f800000
PRE_A2:
s_waitcnt lgkmcnt(3)
v_mfma_f32_16x16x32_bf16 v[112:115],a[192:195],v[16:19],0
ds_read_b128 a[224:227],v0 offset:8192
v_mov_b32 v232,0x3f803f80
v_mfma_f32_16x16x32_bf16 v[112:115],a[196:199],v[20:23],v[112:115]
v_mov_b32 v233,0x3f803f80
v_mov_b32 v234,0x3f803f80
v_mfma_f32_16x16x32_bf16 v[112:115],a[200:203],v[24:27],v[112:115]
v_mov_b32 v235,0x3f803f80
v_mbcnt_lo_u32_b32 v253,-1,0
v_mfma_f32_16x16x32_bf16 v[112:115],a[204:207],v[28:31],v[112:115]
ds_read_b128 a[228:231],v1 offset:8192
v_mbcnt_hi_u32_b32 v253,-1,v253
v_mfma_f32_16x16x32_bf16 v[112:115],a[208:211],v[32:35],v[112:115]
s_lshl_b32 s31,s24,11
s_waitcnt lgkmcnt(2)
v_mfma_f32_16x16x32_bf16 v[112:115],a[212:215],v[36:39],v[112:115]
s_add_u32 s31,s31,147456
v_lshl_add_u32 v250,v253,4,s31
v_mfma_f32_16x16x32_bf16 v[112:115],a[216:219],v[40:43],v[112:115]
ds_read_b128 a[232:235],v2 offset:8192
s_add_u32 s26,s25,32768
v_mfma_f32_16x16x32_bf16 v[112:115],a[220:223],v[44:47],v[112:115]
v_mfma_f32_16x16x32_bf16 v[128:131],a[192:195],v[48:51],0
v_mfma_f32_16x16x32_bf16 v[128:131],a[196:199],v[52:55],v[128:131]
ds_read_b128 a[236:239],v3 offset:8192
v_mfma_f32_16x16x32_bf16 v[128:131],a[200:203],v[56:59],v[128:131]
v_mfma_f32_16x16x32_bf16 v[128:131],a[204:207],v[60:63],v[128:131]
v_mfma_f32_16x16x32_bf16 v[128:131],a[208:211],v[64:67],v[128:131]
ds_read_b128 a[240:243],v0 offset:8448
v_mfma_f32_16x16x32_bf16 v[128:131],a[212:215],v[68:71],v[128:131]
v_mfma_f32_16x16x32_bf16 v[128:131],a[216:219],v[72:75],v[128:131]
v_max3_f32 v184,-v208,v112,v113
v_max3_f32 v184,v184,v114,v115
v_mfma_f32_16x16x32_bf16 v[128:131],a[220:223],v[76:79],v[128:131]
ds_read_b128 a[244:247],v1 offset:8448
v_mov_b32 v188,v184
v_mfma_f32_16x16x32_bf16 v[144:147],a[192:195],v[80:83],0
v_mfma_f32_16x16x32_bf16 v[144:147],a[196:199],v[84:87],v[144:147]
v_permlane32_swap_b32 v184,v188
v_mfma_f32_16x16x32_bf16 v[144:147],a[200:203],v[88:91],v[144:147]
ds_read_b128 a[248:251],v2 offset:8448
v_mfma_f32_16x16x32_bf16 v[144:147],a[204:207],v[92:95],v[144:147]
v_max_f32 v184,v184,v188
v_mov_b32 v188,v184
v_mfma_f32_16x16x32_bf16 v[144:147],a[208:211],v[96:99],v[144:147]
v_mfma_f32_16x16x32_bf16 v[144:147],a[212:215],v[100:103],v[144:147]
ds_read_b128 a[252:255],v3 offset:8448
v_permlane16_swap_b32 v184,v188
v_mfma_f32_16x16x32_bf16 v[144:147],a[216:219],v[104:107],v[144:147]
v_max3_f32 v185,-v212,v128,v129
v_max3_f32 v185,v185,v130,v131
v_mfma_f32_16x16x32_bf16 v[144:147],a[220:223],v[108:111],v[144:147]
v_max_f32 v184,v184,v188
s_waitcnt lgkmcnt(2)
v_mfma_f32_16x16x32_bf16 v[116:119],a[224:227],v[16:19],0
ds_read_b128 a[192:195],v0 offset:16384
v_sub_f32 v208,0,v184
v_mfma_f32_16x16x32_bf16 v[116:119],a[228:231],v[20:23],v[116:119]
v_sub_f32 v209,0,v184
v_sub_f32 v210,0,v184
v_mfma_f32_16x16x32_bf16 v[116:119],a[232:235],v[24:27],v[116:119]
v_sub_f32 v211,0,v184
v_mov_b32 v189,v185
v_mfma_f32_16x16x32_bf16 v[116:119],a[236:239],v[28:31],v[116:119]
ds_read_b128 a[196:199],v1 offset:16384
v_add_f32 v112,v112,v208
v_mfma_f32_16x16x32_bf16 v[116:119],a[240:243],v[32:35],v[116:119]
v_permlane32_swap_b32 v185,v189
v_mfma_f32_16x16x32_bf16 v[116:119],a[244:247],v[36:39],v[116:119]
s_waitcnt lgkmcnt(2)
v_mfma_f32_16x16x32_bf16 v[116:119],a[248:251],v[40:43],v[116:119]
ds_read_b128 a[200:203],v2 offset:16384
v_max_f32 v185,v185,v189
v_mfma_f32_16x16x32_bf16 v[116:119],a[252:255],v[44:47],v[116:119]
v_mov_b32 v189,v185
v_max3_f32 v186,-v216,v144,v145
v_mfma_f32_16x16x32_bf16 v[132:135],a[224:227],v[48:51],0
v_max3_f32 v186,v186,v146,v147
v_mov_b32 v190,v186
v_mfma_f32_16x16x32_bf16 v[132:135],a[228:231],v[52:55],v[132:135]
ds_read_b128 a[204:207],v3 offset:16384
v_permlane16_swap_b32 v185,v189
v_mfma_f32_16x16x32_bf16 v[132:135],a[232:235],v[56:59],v[132:135]
v_permlane32_swap_b32 v186,v190
v_add_f32 v113,v113,v208
v_mfma_f32_16x16x32_bf16 v[132:135],a[236:239],v[60:63],v[132:135]
v_max_f32 v185,v185,v189
v_sub_f32 v212,0,v185
v_mfma_f32_16x16x32_bf16 v[132:135],a[240:243],v[64:67],v[132:135]
ds_read_b128 a[208:211],v0 offset:16640
v_sub_f32 v213,0,v185
v_mfma_f32_16x16x32_bf16 v[132:135],a[244:247],v[68:71],v[132:135]
v_sub_f32 v214,0,v185
v_sub_f32 v215,0,v185
v_mfma_f32_16x16x32_bf16 v[132:135],a[248:251],v[72:75],v[132:135]
v_max_f32 v186,v186,v190
v_mov_b32 v190,v186
v_mfma_f32_16x16x32_bf16 v[132:135],a[252:255],v[76:79],v[132:135]
ds_read_b128 a[212:215],v1 offset:16640
v_add_f32 v114,v114,v208
v_mfma_f32_16x16x32_bf16 v[148:151],a[224:227],v[80:83],0
v_permlane16_swap_b32 v186,v190
v_add_f32 v115,v115,v208
v_mfma_f32_16x16x32_bf16 v[148:151],a[228:231],v[84:87],v[148:151]
v_exp_f32 v112,v112
v_mfma_f32_16x16x32_bf16 v[148:151],a[232:235],v[88:91],v[148:151]
ds_read_b128 a[216:219],v2 offset:16640
v_max_f32 v186,v186,v190
v_mfma_f32_16x16x32_bf16 v[148:151],a[236:239],v[92:95],v[148:151]
v_sub_f32 v216,0,v186
v_sub_f32 v217,0,v186
v_mfma_f32_16x16x32_bf16 v[148:151],a[240:243],v[96:99],v[148:151]
ds_read_b128 a[220:223],v3 offset:16640
v_sub_f32 v218,0,v186
v_mfma_f32_16x16x32_bf16 v[148:151],a[244:247],v[100:103],v[148:151]
v_sub_f32 v219,0,v186
v_mfma_f32_16x16x32_bf16 v[148:151],a[248:251],v[104:107],v[148:151]
v_exp_f32 v113,v113
v_mfma_f32_16x16x32_bf16 v[148:151],a[252:255],v[108:111],v[148:151]
ds_read_b128 a[224:227],v0 offset:24576
s_waitcnt lgkmcnt(3)
v_mfma_f32_16x16x32_bf16 v[120:123],a[192:195],v[16:19],v[208:211]
v_cvt_pk_bf16_f32 v160,v112,v113
v_add_f32 v128,v128,v212
v_mfma_f32_16x16x32_bf16 v[120:123],a[196:199],v[20:23],v[120:123]
v_exp_f32 v114,v114
v_mfma_f32_16x16x32_bf16 v[120:123],a[200:203],v[24:27],v[120:123]
ds_read_b128 a[228:231],v1 offset:24576
v_add_f32 v129,v129,v212
v_mfma_f32_16x16x32_bf16 v[120:123],a[204:207],v[28:31],v[120:123]
v_exp_f32 v115,v115
v_mfma_f32_16x16x32_bf16 v[120:123],a[208:211],v[32:35],v[120:123]
v_cvt_pk_bf16_f32 v161,v114,v115
v_add_f32 v130,v130,v212
v_mfma_f32_16x16x32_bf16 v[120:123],a[212:215],v[36:39],v[120:123]
ds_read_b128 a[232:235],v2 offset:24576
s_waitcnt lgkmcnt(3)
v_mfma_f32_16x16x32_bf16 v[120:123],a[216:219],v[40:43],v[120:123]
v_exp_f32 v128,v128
v_mfma_f32_16x16x32_bf16 v[120:123],a[220:223],v[44:47],v[120:123]
v_exp_f32 v129,v129
v_mfma_f32_16x16x32_bf16 v[136:139],a[192:195],v[48:51],v[212:215]
ds_read_b128 a[236:239],v3 offset:24576
v_cvt_pk_bf16_f32 v176,v128,v129
v_mfma_f32_16x16x32_bf16 v[136:139],a[196:199],v[52:55],v[136:139]
v_exp_f32 v130,v130
v_mfma_f32_16x16x32_bf16 v[136:139],a[200:203],v[56:59],v[136:139]
v_add_f32 v131,v131,v212
v_add_f32 v149,v149,v216
v_mfma_f32_16x16x32_bf16 v[136:139],a[204:207],v[60:63],v[136:139]
ds_read_b128 a[240:243],v0 offset:24832
v_add_f32 v144,v144,v216
v_mfma_f32_16x16x32_bf16 v[136:139],a[208:211],v[64:67],v[136:139]
v_exp_f32 v131,v131
v_mfma_f32_16x16x32_bf16 v[136:139],a[212:215],v[68:71],v[136:139]
v_cvt_pk_bf16_f32 v177,v130,v131
v_add_f32 v145,v145,v216
v_mfma_f32_16x16x32_bf16 v[136:139],a[216:219],v[72:75],v[136:139]
ds_read_b128 a[244:247],v1 offset:24832
v_add_f32 v146,v146,v216
v_mfma_f32_16x16x32_bf16 v[136:139],a[220:223],v[76:79],v[136:139]
v_exp_f32 v144,v144
v_mfma_f32_16x16x32_bf16 v[152:155],a[192:195],v[80:83],v[216:219]
v_exp_f32 v145,v145
v_mfma_f32_16x16x32_bf16 v[152:155],a[196:199],v[84:87],v[152:155]
ds_read_b128 a[248:251],v2 offset:24832
v_cvt_pk_bf16_f32 v192,v144,v145
v_mfma_f32_16x16x32_bf16 v[152:155],a[200:203],v[88:91],v[152:155]
v_exp_f32 v146,v146
v_mfma_f32_16x16x32_bf16 v[152:155],a[204:207],v[92:95],v[152:155]
v_add_f32 v147,v147,v216
v_add_f32 v116,v116,v208
v_mfma_f32_16x16x32_bf16 v[152:155],a[208:211],v[96:99],v[152:155]
ds_read_b128 a[252:255],v3 offset:24832
v_add_f32 v148,v148,v216
v_mfma_f32_16x16x32_bf16 v[152:155],a[212:215],v[100:103],v[152:155]
v_exp_f32 v147,v147
v_mfma_f32_16x16x32_bf16 v[152:155],a[216:219],v[104:107],v[152:155]
v_cvt_pk_bf16_f32 v193,v146,v147
v_add_f32 v117,v117,v208
v_mfma_f32_16x16x32_bf16 v[152:155],a[220:223],v[108:111],v[152:155]
v_add_f32 v118,v118,v208
s_waitcnt lgkmcnt(2)
v_mfma_f32_16x16x32_bf16 v[124:127],a[224:227],v[16:19],v[208:211]
v_exp_f32 v116,v116
v_mfma_f32_16x16x32_bf16 v[124:127],a[228:231],v[20:23],v[124:127]
v_exp_f32 v117,v117
v_mfma_f32_16x16x32_bf16 v[124:127],a[232:235],v[24:27],v[124:127]
s_waitcnt lgkmcnt(0)
s_waitcnt vmcnt(0)
s_barrier
v_mfma_f32_16x16x32_bf16 v[124:127],a[236:239],v[28:31],v[124:127]
ds_read_b128 a[192:195],v0 offset:32768
s_add_u32 m0,s25,0
v_mfma_f32_16x16x32_bf16 v[124:127],a[240:243],v[32:35],v[124:127]
s_add_u32 s28,s25,65536
v_cvt_pk_bf16_f32 v162,v116,v117
v_mfma_f32_16x16x32_bf16 v[124:127],a[244:247],v[36:39],v[124:127]
v_add_f32 v119,v119,v208
s_waitcnt lgkmcnt(1)
v_mfma_f32_16x16x32_bf16 v[124:127],a[248:251],v[40:43],v[124:127]
ds_read_b128 a[196:199],v1 offset:32768
v_add_f32 v132,v132,v212
v_mfma_f32_16x16x32_bf16 v[124:127],a[252:255],v[44:47],v[124:127]
buffer_load_dwordx4 v12,s[4:7],s28 offen nt lds
v_mfma_f32_16x16x32_bf16 v[140:143],a[224:227],v[48:51],v[212:215]
ds_read_b128 a[200:203],v2 offset:32768
v_add_f32 v133,v133,v212
v_mfma_f32_16x16x32_bf16 v[140:143],a[228:231],v[52:55],v[140:143]
buffer_load_dwordx4 v13,s[4:7],s28 offen offset:1024 nt lds
v_mfma_f32_16x16x32_bf16 v[140:143],a[232:235],v[56:59],v[140:143]
buffer_load_dwordx4 v14,s[4:7],s28 offen offset:2048 nt lds
v_mfma_f32_16x16x32_bf16 v[140:143],a[236:239],v[60:63],v[140:143]
ds_read_b128 a[204:207],v3 offset:32768
v_add_f32 v134,v134,v212
v_mfma_f32_16x16x32_bf16 v[140:143],a[240:243],v[64:67],v[140:143]
buffer_load_dwordx4 v15,s[4:7],s28 offen offset:3072 nt lds
v_mfma_f32_16x16x32_bf16 v[140:143],a[244:247],v[68:71],v[140:143]
v_exp_f32 v118,v118
v_mfma_f32_16x16x32_bf16 v[140:143],a[248:251],v[72:75],v[140:143]
ds_read_b128 a[208:211],v0 offset:33024
v_add_f32 v135,v135,v212
v_mfma_f32_16x16x32_bf16 v[140:143],a[252:255],v[76:79],v[140:143]
v_exp_f32 v119,v119
v_mfma_f32_16x16x32_bf16 v[156:159],a[224:227],v[80:83],v[216:219]
ds_read_b128 a[212:215],v1 offset:33024
v_cvt_pk_bf16_f32 v163,v118,v119
v_mfma_f32_16x16x32_bf16 v[156:159],a[228:231],v[84:87],v[156:159]
v_exp_f32 v132,v132
v_mfma_f32_16x16x32_bf16 v[156:159],a[232:235],v[88:91],v[156:159]
v_exp_f32 v133,v133
v_add_f32 v151,v151,v216
v_mfma_f32_16x16x32_bf16 v[156:159],a[236:239],v[92:95],v[156:159]
ds_read_b128 a[216:219],v2 offset:33024
v_cvt_pk_bf16_f32 v178,v132,v133
v_exp_f32 v148,v148
v_mfma_f32_16x16x32_bf16 v[156:159],a[240:243],v[96:99],v[156:159]
v_exp_f32 v134,v134
v_exp_f32 v149,v149
v_mfma_f32_16x16x32_bf16 v[156:159],a[244:247],v[100:103],v[156:159]
v_exp_f32 v135,v135
v_add_f32 v150,v150,v216
v_exp_f32 v151,v151
v_mfma_f32_16x16x32_bf16 v[156:159],a[248:251],v[104:107],v[156:159]
ds_read_b128 a[220:223],v3 offset:33024
v_cvt_pk_bf16_f32 v179,v134,v135
v_exp_f32 v150,v150
v_mfma_f32_16x16x32_bf16 v[156:159],a[252:255],v[108:111],v[156:159]
v_cvt_pk_bf16_f32 v194,v148,v149
v_cvt_pk_bf16_f32 v195,v150,v151
M0_A2:
s_waitcnt lgkmcnt(2)
v_mfma_f32_16x16x32_bf16 v[112:115],a[192:195],v[16:19],v[208:211]
ds_read_b128 a[224:227],v0 offset:40960
v_mfma_f32_16x16x32_bf16 v[112:115],a[196:199],v[20:23],v[112:115]
v_exp_f32 v120,v120
v_mfma_f32_16x16x32_bf16 v[112:115],a[200:203],v[24:27],v[112:115]
v_exp_f32 v121,v121
v_mfma_f32_16x16x32_bf16 v[112:115],a[204:207],v[28:31],v[112:115]
ds_read_b128 a[228:231],v1 offset:40960
v_cvt_pk_bf16_f32 v164,v120,v121
v_mfma_f32_16x16x32_bf16 v[112:115],a[208:211],v[32:35],v[112:115]
v_exp_f32 v122,v122
v_mfma_f32_16x16x32_bf16 v[112:115],a[212:215],v[36:39],v[112:115]
s_waitcnt lgkmcnt(2)
v_mfma_f32_16x16x32_bf16 v[112:115],a[216:219],v[40:43],v[112:115]
ds_read_b128 a[232:235],v2 offset:40960
v_mfma_f32_16x16x32_bf16 v[112:115],a[220:223],v[44:47],v[112:115]
v_exp_f32 v123,v123
v_mfma_f32_16x16x32_bf16 v[128:131],a[192:195],v[48:51],v[212:215]
v_cvt_pk_bf16_f32 v165,v122,v123
v_mfma_f32_16x16x32_bf16 v[128:131],a[196:199],v[52:55],v[128:131]
ds_read_b128 a[236:239],v3 offset:40960
v_mfma_f32_16x16x32_bf16 v[128:131],a[200:203],v[56:59],v[128:131]
v_exp_f32 v136,v136
v_mfma_f32_16x16x32_bf16 v[128:131],a[204:207],v[60:63],v[128:131]
v_mfma_f32_16x16x32_bf16 v[128:131],a[208:211],v[64:67],v[128:131]
ds_read_b128 a[240:243],v0 offset:41216
v_mfma_f32_16x16x32_bf16 v[128:131],a[212:215],v[68:71],v[128:131]
v_exp_f32 v137,v137
v_mfma_f32_16x16x32_bf16 v[128:131],a[216:219],v[72:75],v[128:131]
v_cvt_pk_bf16_f32 v180,v136,v137
v_mfma_f32_16x16x32_bf16 v[128:131],a[220:223],v[76:79],v[128:131]
ds_read_b128 a[244:247],v1 offset:41216
v_mfma_f32_16x16x32_bf16 v[144:147],a[192:195],v[80:83],v[216:219]
v_exp_f32 v138,v138
v_mfma_f32_16x16x32_bf16 v[144:147],a[196:199],v[84:87],v[144:147]
v_exp_f32 v139,v139
v_mfma_f32_16x16x32_bf16 v[144:147],a[200:203],v[88:91],v[144:147]
ds_read_b128 a[248:251],v2 offset:41216
v_cvt_pk_bf16_f32 v181,v138,v139
v_mfma_f32_16x16x32_bf16 v[144:147],a[204:207],v[92:95],v[144:147]
v_exp_f32 v152,v152
v_mfma_f32_16x16x32_bf16 v[144:147],a[208:211],v[96:99],v[144:147]
v_mfma_f32_16x16x32_bf16 v[144:147],a[212:215],v[100:103],v[144:147]
ds_read_b128 a[252:255],v3 offset:41216
v_mfma_f32_16x16x32_bf16 v[144:147],a[216:219],v[104:107],v[144:147]
v_exp_f32 v153,v153
v_mfma_f32_16x16x32_bf16 v[144:147],a[220:223],v[108:111],v[144:147]
v_cvt_pk_bf16_f32 v196,v152,v153
s_waitcnt lgkmcnt(2)
v_mfma_f32_16x16x32_bf16 v[116:119],a[224:227],v[16:19],v[208:211]
ds_read_b128 a[192:195],v0 offset:49152
v_mfma_f32_16x16x32_bf16 v[116:119],a[228:231],v[20:23],v[116:119]
v_exp_f32 v154,v154
v_mfma_f32_16x16x32_bf16 v[116:119],a[232:235],v[24:27],v[116:119]
v_exp_f32 v155,v155
v_mfma_f32_16x16x32_bf16 v[116:119],a[236:239],v[28:31],v[116:119]
ds_read_b128 a[196:199],v1 offset:49152
v_cvt_pk_bf16_f32 v197,v154,v155
v_mfma_f32_16x16x32_bf16 v[116:119],a[240:243],v[32:35],v[116:119]
v_exp_f32 v124,v124
v_mfma_f32_16x16x32_bf16 v[116:119],a[244:247],v[36:39],v[116:119]
s_waitcnt lgkmcnt(2)
v_mfma_f32_16x16x32_bf16 v[116:119],a[248:251],v[40:43],v[116:119]
ds_read_b128 a[200:203],v2 offset:49152
v_mfma_f32_16x16x32_bf16 v[116:119],a[252:255],v[44:47],v[116:119]
v_exp_f32 v125,v125
v_mfma_f32_16x16x32_bf16 v[132:135],a[224:227],v[48:51],v[212:215]
v_cvt_pk_bf16_f32 v166,v124,v125
v_mfma_f32_16x16x32_bf16 v[132:135],a[228:231],v[52:55],v[132:135]
ds_read_b128 a[204:207],v3 offset:49152
v_mfma_f32_16x16x32_bf16 v[132:135],a[232:235],v[56:59],v[132:135]
v_exp_f32 v126,v126
v_mfma_f32_16x16x32_bf16 v[132:135],a[236:239],v[60:63],v[132:135]
v_mfma_f32_16x16x32_bf16 v[132:135],a[240:243],v[64:67],v[132:135]
ds_read_b128 a[208:211],v0 offset:49408
v_mfma_f32_16x16x32_bf16 v[132:135],a[244:247],v[68:71],v[132:135]
v_exp_f32 v127,v127
v_mfma_f32_16x16x32_bf16 v[132:135],a[248:251],v[72:75],v[132:135]
v_cvt_pk_bf16_f32 v167,v126,v127
v_mfma_f32_16x16x32_bf16 v[132:135],a[252:255],v[76:79],v[132:135]
ds_read_b128 a[212:215],v1 offset:49408
v_mfma_f32_16x16x32_bf16 v[148:151],a[224:227],v[80:83],v[216:219]
v_exp_f32 v140,v140
v_mfma_f32_16x16x32_bf16 v[148:151],a[228:231],v[84:87],v[148:151]
v_exp_f32 v141,v141
v_mfma_f32_16x16x32_bf16 v[148:151],a[232:235],v[88:91],v[148:151]
ds_read_b128 a[216:219],v2 offset:49408
v_cvt_pk_bf16_f32 v182,v140,v141
v_mfma_f32_16x16x32_bf16 v[148:151],a[236:239],v[92:95],v[148:151]
v_mfma_f32_16x16x32_bf16 v[148:151],a[240:243],v[96:99],v[148:151]
ds_read_b128 a[220:223],v3 offset:49408
v_mfma_f32_16x16x32_bf16 v[148:151],a[244:247],v[100:103],v[148:151]
v_exp_f32 v142,v142
v_mfma_f32_16x16x32_bf16 v[148:151],a[248:251],v[104:107],v[148:151]
v_mfma_f32_16x16x32_bf16 v[148:151],a[252:255],v[108:111],v[148:151]
ds_read_b128 a[224:227],v0 offset:57344
s_waitcnt lgkmcnt(3)
v_mfma_f32_16x16x32_bf16 v[120:123],a[192:195],v[16:19],v[208:211]
v_exp_f32 v143,v143
v_mfma_f32_16x16x32_bf16 v[120:123],a[196:199],v[20:23],v[120:123]
v_cvt_pk_bf16_f32 v183,v142,v143
v_mfma_f32_16x16x32_bf16 v[120:123],a[200:203],v[24:27],v[120:123]
ds_read_b128 a[228:231],v1 offset:57344
v_mfma_f32_16x16x32_bf16 v[120:123],a[204:207],v[28:31],v[120:123]
v_exp_f32 v156,v156
v_mfma_f32_16x16x32_bf16 v[120:123],a[208:211],v[32:35],v[120:123]
v_exp_f32 v157,v157
v_mfma_f32_16x16x32_bf16 v[120:123],a[212:215],v[36:39],v[120:123]
ds_read_b128 a[232:235],v2 offset:57344
s_waitcnt lgkmcnt(3)
v_mfma_f32_16x16x32_bf16 v[120:123],a[216:219],v[40:43],v[120:123]
v_cvt_pk_bf16_f32 v198,v156,v157
v_mfma_f32_16x16x32_bf16 v[120:123],a[220:223],v[44:47],v[120:123]
v_exp_f32 v158,v158
v_mfma_f32_16x16x32_bf16 v[136:139],a[192:195],v[48:51],v[212:215]
ds_read_b128 a[236:239],v3 offset:57344
v_mfma_f32_16x16x32_bf16 v[136:139],a[196:199],v[52:55],v[136:139]
v_mfma_f32_16x16x32_bf16 v[136:139],a[200:203],v[56:59],v[136:139]
v_exp_f32 v159,v159
v_mfma_f32_16x16x32_bf16 v[136:139],a[204:207],v[60:63],v[136:139]
ds_read_b128 a[240:243],v0 offset:57600
v_cvt_pk_bf16_f32 v199,v158,v159
v_mfma_f32_16x16x32_bf16 v[136:139],a[208:211],v[64:67],v[136:139]
v_mfma_f32_16x16x32_bf16 v[136:139],a[212:215],v[68:71],v[136:139]
v_exp_f32 v112,v112
v_mfma_f32_16x16x32_bf16 v[136:139],a[216:219],v[72:75],v[136:139]
ds_read_b128 a[244:247],v1 offset:57600
v_mfma_f32_16x16x32_bf16 v[136:139],a[220:223],v[76:79],v[136:139]
v_exp_f32 v113,v113
v_mfma_f32_16x16x32_bf16 v[152:155],a[192:195],v[80:83],v[216:219]
v_cvt_pk_bf16_f32 v168,v112,v113
v_mfma_f32_16x16x32_bf16 v[152:155],a[196:199],v[84:87],v[152:155]
ds_read_b128 a[248:251],v2 offset:57600
v_mfma_f32_16x16x32_bf16 v[152:155],a[200:203],v[88:91],v[152:155]
v_exp_f32 v114,v114
v_mfma_f32_16x16x32_bf16 v[152:155],a[204:207],v[92:95],v[152:155]
v_mfma_f32_16x16x32_bf16 v[152:155],a[208:211],v[96:99],v[152:155]
ds_read_b128 a[252:255],v3 offset:57600
v_mfma_f32_16x16x32_bf16 v[152:155],a[212:215],v[100:103],v[152:155]
v_exp_f32 v115,v115
v_mfma_f32_16x16x32_bf16 v[152:155],a[216:219],v[104:107],v[152:155]
v_cvt_pk_bf16_f32 v169,v114,v115
v_mfma_f32_16x16x32_bf16 v[152:155],a[220:223],v[108:111],v[152:155]
s_waitcnt lgkmcnt(2)
v_mfma_f32_16x16x32_bf16 v[124:127],a[224:227],v[16:19],v[208:211]
v_exp_f32 v128,v128
v_mfma_f32_16x16x32_bf16 v[124:127],a[228:231],v[20:23],v[124:127]
v_exp_f32 v129,v129
v_mfma_f32_16x16x32_bf16 v[124:127],a[232:235],v[24:27],v[124:127]
s_waitcnt lgkmcnt(0)
s_waitcnt vmcnt(14)
s_barrier
v_mfma_f32_16x16x32_bf16 v[124:127],a[236:239],v[28:31],v[124:127]
ds_read_b64_tr_b16 a[192:193],v4 offset:0
ds_read_b64_tr_b16 a[194:195],v4 offset:8192
s_add_u32 m0,s25,32768
s_add_u32 s28,s25,98304
buffer_load_dwordx4 v12,s[4:7],s28 offen nt lds
buffer_load_dwordx4 v13,s[4:7],s28 offen offset:1024 nt lds
buffer_load_dwordx4 v14,s[4:7],s28 offen offset:2048 nt lds
buffer_load_dwordx4 v15,s[4:7],s28 offen offset:3072 nt lds
s_add_u32 m0,s25,49152
s_add_u32 s28,s25,114688
buffer_load_dwordx4 v12,s[4:7],s28 offen nt lds
buffer_load_dwordx4 v13,s[4:7],s28 offen offset:1024 nt lds
buffer_load_dwordx4 v14,s[4:7],s28 offen offset:2048 nt lds
buffer_load_dwordx4 v15,s[4:7],s28 offen offset:3072 nt lds
v_mfma_f32_16x16x32_bf16 v[124:127],a[240:243],v[32:35],v[124:127]
v_cvt_pk_bf16_f32 v184,v128,v129
v_mfma_f32_16x16x32_bf16 v[124:127],a[244:247],v[36:39],v[124:127]
s_waitcnt lgkmcnt(2)
v_mfma_f32_16x16x32_bf16 v[124:127],a[248:251],v[40:43],v[124:127]
ds_read_b64_tr_b16 a[196:197],v4 offset:16384
ds_read_b64_tr_b16 a[198:199],v4 offset:24576
v_mfma_f32_16x16x32_bf16 v[124:127],a[252:255],v[44:47],v[124:127]
v_exp_f32 v130,v130
v_mfma_f32_16x16x32_bf16 v[140:143],a[224:227],v[48:51],v[212:215]
v_mfma_f32_16x16x32_bf16 v[140:143],a[228:231],v[52:55],v[140:143]
ds_read_b64_tr_b16 a[200:201],v5 offset:0
ds_read_b64_tr_b16 a[202:203],v5 offset:8192
v_mfma_f32_16x16x32_bf16 v[140:143],a[232:235],v[56:59],v[140:143]
v_exp_f32 v131,v131
v_mfma_f32_16x16x32_bf16 v[140:143],a[236:239],v[60:63],v[140:143]
v_cvt_pk_bf16_f32 v185,v130,v131
v_mfma_f32_16x16x32_bf16 v[140:143],a[240:243],v[64:67],v[140:143]
ds_read_b64_tr_b16 a[204:205],v5 offset:16384
ds_read_b64_tr_b16 a[206:207],v5 offset:24576
v_mfma_f32_16x16x32_bf16 v[140:143],a[244:247],v[68:71],v[140:143]
v_exp_f32 v144,v144
v_mfma_f32_16x16x32_bf16 v[140:143],a[248:251],v[72:75],v[140:143]
v_mfma_f32_16x16x32_bf16 v[140:143],a[252:255],v[76:79],v[140:143]
ds_read_b64_tr_b16 a[208:209],v6 offset:0
ds_read_b64_tr_b16 a[210:211],v6 offset:8192
v_mfma_f32_16x16x32_bf16 v[156:159],a[224:227],v[80:83],v[216:219]
v_exp_f32 v145,v145
v_mfma_f32_16x16x32_bf16 v[156:159],a[228:231],v[84:87],v[156:159]
v_cvt_pk_bf16_f32 v200,v144,v145
v_mfma_f32_16x16x32_bf16 v[156:159],a[232:235],v[88:91],v[156:159]
ds_read_b64_tr_b16 a[212:213],v6 offset:16384
ds_read_b64_tr_b16 a[214:215],v6 offset:24576
v_mfma_f32_16x16x32_bf16 v[156:159],a[236:239],v[92:95],v[156:159]
v_exp_f32 v146,v146
v_mfma_f32_16x16x32_bf16 v[156:159],a[240:243],v[96:99],v[156:159]
v_mfma_f32_16x16x32_bf16 v[156:159],a[244:247],v[100:103],v[156:159]
ds_read_b64_tr_b16 a[216:217],v7 offset:0
ds_read_b64_tr_b16 a[218:219],v7 offset:8192
v_mfma_f32_16x16x32_bf16 v[156:159],a[248:251],v[104:107],v[156:159]
v_exp_f32 v147,v147
v_mfma_f32_16x16x32_bf16 v[156:159],a[252:255],v[108:111],v[156:159]
v_cvt_pk_bf16_f32 v201,v146,v147
v_mfma_f32_16x16x32_bf16 v[220:223],v[232:235],v[160:163],0
ds_read_b64_tr_b16 a[220:221],v7 offset:16384
ds_read_b64_tr_b16 a[222:223],v7 offset:24576
v_mfma_f32_16x16x32_bf16 v[220:223],v[232:235],v[164:167],v[220:223]
v_exp_f32 v116,v116
v_mfma_f32_16x16x32_bf16 v[224:227],v[232:235],v[176:179],0
v_mfma_f32_16x16x32_bf16 v[224:227],v[232:235],v[180:183],v[224:227]
ds_read_b64_tr_b16 a[224:225],v8 offset:0
ds_read_b64_tr_b16 a[226:227],v8 offset:8192
v_mfma_f32_16x16x32_bf16 v[228:231],v[232:235],v[192:195],0
v_exp_f32 v117,v117
v_mfma_f32_16x16x32_bf16 v[228:231],v[232:235],v[196:199],v[228:231]
v_cvt_pk_bf16_f32 v170,v116,v117
s_waitcnt lgkmcnt(4)
v_mfma_f32_16x16x32_bf16 a[0:3],a[192:195],v[160:163],0
ds_read_b64_tr_b16 a[228:229],v8 offset:16384
ds_read_b64_tr_b16 a[230:231],v8 offset:24576
v_mfma_f32_16x16x32_bf16 a[0:3],a[196:199],v[164:167],a[0:3]
v_exp_f32 v118,v118
v_mfma_f32_16x16x32_bf16 a[64:67],a[192:195],v[176:179],0
v_mfma_f32_16x16x32_bf16 a[64:67],a[196:199],v[180:183],a[64:67]
ds_read_b64_tr_b16 a[232:233],v9 offset:0
ds_read_b64_tr_b16 a[234:235],v9 offset:8192
v_mfma_f32_16x16x32_bf16 a[128:131],a[192:195],v[192:195],0
v_exp_f32 v119,v119
v_mfma_f32_16x16x32_bf16 a[128:131],a[196:199],v[196:199],a[128:131]
v_cvt_pk_bf16_f32 v171,v118,v119
v_mfma_f32_16x16x32_bf16 a[4:7],a[200:203],v[160:163],0
ds_read_b64_tr_b16 a[236:237],v9 offset:16384
ds_read_b64_tr_b16 a[238:239],v9 offset:24576
v_mfma_f32_16x16x32_bf16 a[4:7],a[204:207],v[164:167],a[4:7]
v_mfma_f32_16x16x32_bf16 a[68:71],a[200:203],v[176:179],0
v_exp_f32 v132,v132
v_mfma_f32_16x16x32_bf16 a[68:71],a[204:207],v[180:183],a[68:71]
ds_read_b64_tr_b16 a[240:241],v10 offset:0
ds_read_b64_tr_b16 a[242:243],v10 offset:8192
v_mfma_f32_16x16x32_bf16 a[132:135],a[200:203],v[192:195],0
v_mfma_f32_16x16x32_bf16 a[132:135],a[204:207],v[196:199],a[132:135]
v_exp_f32 v133,v133
v_mfma_f32_16x16x32_bf16 a[8:11],a[208:211],v[160:163],0
ds_read_b64_tr_b16 a[244:245],v10 offset:16384
ds_read_b64_tr_b16 a[246:247],v10 offset:24576
v_mfma_f32_16x16x32_bf16 a[8:11],a[212:215],v[164:167],a[8:11]
v_cvt_pk_bf16_f32 v186,v132,v133
v_mfma_f32_16x16x32_bf16 a[72:75],a[208:211],v[176:179],0
v_exp_f32 v134,v134
v_mfma_f32_16x16x32_bf16 a[72:75],a[212:215],v[180:183],a[72:75]
ds_read_b64_tr_b16 a[248:249],v11 offset:0
ds_read_b64_tr_b16 a[250:251],v11 offset:8192
v_mfma_f32_16x16x32_bf16 a[136:139],a[208:211],v[192:195],0
v_mfma_f32_16x16x32_bf16 a[136:139],a[212:215],v[196:199],a[136:139]
v_exp_f32 v135,v135
v_mfma_f32_16x16x32_bf16 a[12:15],a[216:219],v[160:163],0
ds_read_b64_tr_b16 a[252:253],v11 offset:16384
ds_read_b64_tr_b16 a[254:255],v11 offset:24576
s_waitcnt lgkmcnt(6)
v_mfma_f32_16x16x32_bf16 a[12:15],a[220:223],v[164:167],a[12:15]
v_cvt_pk_bf16_f32 v187,v134,v135
v_mfma_f32_16x16x32_bf16 a[76:79],a[216:219],v[176:179],0
v_exp_f32 v148,v148
v_mfma_f32_16x16x32_bf16 a[76:79],a[220:223],v[180:183],a[76:79]
ds_read_b64_tr_b16 a[192:193],v4 offset:256
ds_read_b64_tr_b16 a[194:195],v4 offset:8448
v_mfma_f32_16x16x32_bf16 a[140:143],a[216:219],v[192:195],0
v_mfma_f32_16x16x32_bf16 a[140:143],a[220:223],v[196:199],a[140:143]
v_exp_f32 v149,v149
v_mfma_f32_16x16x32_bf16 a[16:19],a[224:227],v[160:163],0
ds_read_b64_tr_b16 a[196:197],v4 offset:16640
ds_read_b64_tr_b16 a[198:199],v4 offset:24832
v_mfma_f32_16x16x32_bf16 a[16:19],a[228:231],v[164:167],a[16:19]
v_cvt_pk_bf16_f32 v202,v148,v149
v_mfma_f32_16x16x32_bf16 a[80:83],a[224:227],v[176:179],0
v_exp_f32 v150,v150
v_mfma_f32_16x16x32_bf16 a[80:83],a[228:231],v[180:183],a[80:83]
ds_read_b64_tr_b16 a[200:201],v5 offset:256
ds_read_b64_tr_b16 a[202:203],v5 offset:8448
v_mfma_f32_16x16x32_bf16 a[144:147],a[224:227],v[192:195],0
v_mfma_f32_16x16x32_bf16 a[144:147],a[228:231],v[196:199],a[144:147]
v_exp_f32 v151,v151
v_mfma_f32_16x16x32_bf16 a[20:23],a[232:235],v[160:163],0
ds_read_b64_tr_b16 a[204:205],v5 offset:16640
ds_read_b64_tr_b16 a[206:207],v5 offset:24832
v_mfma_f32_16x16x32_bf16 a[20:23],a[236:239],v[164:167],a[20:23]
v_cvt_pk_bf16_f32 v203,v150,v151
v_mfma_f32_16x16x32_bf16 a[84:87],a[232:235],v[176:179],0
v_exp_f32 v120,v120
v_mfma_f32_16x16x32_bf16 a[84:87],a[236:239],v[180:183],a[84:87]
ds_read_b64_tr_b16 a[208:209],v6 offset:256
ds_read_b64_tr_b16 a[210:211],v6 offset:8448
v_mfma_f32_16x16x32_bf16 a[148:151],a[232:235],v[192:195],0
v_mfma_f32_16x16x32_bf16 a[148:151],a[236:239],v[196:199],a[148:151]
v_exp_f32 v121,v121
v_mfma_f32_16x16x32_bf16 a[24:27],a[240:243],v[160:163],0
ds_read_b64_tr_b16 a[212:213],v6 offset:16640
ds_read_b64_tr_b16 a[214:215],v6 offset:24832
s_waitcnt lgkmcnt(6)
v_mfma_f32_16x16x32_bf16 a[24:27],a[244:247],v[164:167],a[24:27]
v_cvt_pk_bf16_f32 v172,v120,v121
v_mfma_f32_16x16x32_bf16 a[88:91],a[240:243],v[176:179],0
v_exp_f32 v122,v122
v_mfma_f32_16x16x32_bf16 a[88:91],a[244:247],v[180:183],a[88:91]
ds_read_b64_tr_b16 a[216:217],v7 offset:256
ds_read_b64_tr_b16 a[218:219],v7 offset:8448
v_mfma_f32_16x16x32_bf16 a[152:155],a[240:243],v[192:195],0
v_mfma_f32_16x16x32_bf16 a[152:155],a[244:247],v[196:199],a[152:155]
v_exp_f32 v123,v123
v_mfma_f32_16x16x32_bf16 a[28:31],a[248:251],v[160:163],0
ds_read_b64_tr_b16 a[220:221],v7 offset:16640
ds_read_b64_tr_b16 a[222:223],v7 offset:24832
v_mfma_f32_16x16x32_bf16 a[28:31],a[252:255],v[164:167],a[28:31]
v_cvt_pk_bf16_f32 v173,v122,v123
v_mfma_f32_16x16x32_bf16 a[92:95],a[248:251],v[176:179],0
v_exp_f32 v136,v136
v_mfma_f32_16x16x32_bf16 a[92:95],a[252:255],v[180:183],a[92:95]
ds_read_b64_tr_b16 a[224:225],v8 offset:256
ds_read_b64_tr_b16 a[226:227],v8 offset:8448
v_mfma_f32_16x16x32_bf16 a[156:159],a[248:251],v[192:195],0
v_mfma_f32_16x16x32_bf16 a[156:159],a[252:255],v[196:199],a[156:159]
v_exp_f32 v137,v137
v_mfma_f32_16x16x32_bf16 a[32:35],a[192:195],v[160:163],0
ds_read_b64_tr_b16 a[228:229],v8 offset:16640
ds_read_b64_tr_b16 a[230:231],v8 offset:24832
v_mfma_f32_16x16x32_bf16 a[32:35],a[196:199],v[164:167],a[32:35]
v_cvt_pk_bf16_f32 v188,v136,v137
v_mfma_f32_16x16x32_bf16 a[96:99],a[192:195],v[176:179],0
v_mfma_f32_16x16x32_bf16 a[96:99],a[196:199],v[180:183],a[96:99]
ds_read_b64_tr_b16 a[232:233],v9 offset:256
ds_read_b64_tr_b16 a[234:235],v9 offset:8448
v_mfma_f32_16x16x32_bf16 a[160:163],a[192:195],v[192:195],0
v_exp_f32 v138,v138
v_mfma_f32_16x16x32_bf16 a[160:163],a[196:199],v[196:199],a[160:163]
v_mfma_f32_16x16x32_bf16 a[36:39],a[200:203],v[160:163],0
ds_read_b64_tr_b16 a[236:237],v9 offset:16640
ds_read_b64_tr_b16 a[238:239],v9 offset:24832
s_waitcnt lgkmcnt(6)
v_mfma_f32_16x16x32_bf16 a[36:39],a[204:207],v[164:167],a[36:39]
v_exp_f32 v139,v139
v_mfma_f32_16x16x32_bf16 a[100:103],a[200:203],v[176:179],0
v_cvt_pk_bf16_f32 v189,v138,v139
v_mfma_f32_16x16x32_bf16 a[100:103],a[204:207],v[180:183],a[100:103]
ds_read_b64_tr_b16 a[240:241],v10 offset:256
ds_read_b64_tr_b16 a[242:243],v10 offset:8448
v_mfma_f32_16x16x32_bf16 a[164:167],a[200:203],v[192:195],0
v_exp_f32 v152,v152
v_mfma_f32_16x16x32_bf16 a[164:167],a[204:207],v[196:199],a[164:167]
v_mfma_f32_16x16x32_bf16 a[40:43],a[208:211],v[160:163],0
ds_read_b64_tr_b16 a[244:245],v10 offset:16640
ds_read_b64_tr_b16 a[246:247],v10 offset:24832
v_mfma_f32_16x16x32_bf16 a[40:43],a[212:215],v[164:167],a[40:43]
v_exp_f32 v153,v153
v_mfma_f32_16x16x32_bf16 a[104:107],a[208:211],v[176:179],0
v_cvt_pk_bf16_f32 v204,v152,v153
v_mfma_f32_16x16x32_bf16 a[104:107],a[212:215],v[180:183],a[104:107]
ds_read_b64_tr_b16 a[248:249],v11 offset:256
ds_read_b64_tr_b16 a[250:251],v11 offset:8448
v_mfma_f32_16x16x32_bf16 a[168:171],a[208:211],v[192:195],0
v_exp_f32 v154,v154
v_mfma_f32_16x16x32_bf16 a[168:171],a[212:215],v[196:199],a[168:171]
v_mfma_f32_16x16x32_bf16 a[44:47],a[216:219],v[160:163],0
ds_read_b64_tr_b16 a[252:253],v11 offset:16640
ds_read_b64_tr_b16 a[254:255],v11 offset:24832
v_mfma_f32_16x16x32_bf16 a[44:47],a[220:223],v[164:167],a[44:47]
v_exp_f32 v155,v155
v_mfma_f32_16x16x32_bf16 a[108:111],a[216:219],v[176:179],0
v_cvt_pk_bf16_f32 v205,v154,v155
v_mfma_f32_16x16x32_bf16 a[108:111],a[220:223],v[180:183],a[108:111]
v_mfma_f32_16x16x32_bf16 a[172:175],a[216:219],v[192:195],0
v_exp_f32 v124,v124
v_mfma_f32_16x16x32_bf16 a[172:175],a[220:223],v[196:199],a[172:175]
v_mfma_f32_16x16x32_bf16 a[48:51],a[224:227],v[160:163],0
s_waitcnt lgkmcnt(0)
s_waitcnt vmcnt(8)
s_barrier
s_waitcnt lgkmcnt(2)
v_mfma_f32_16x16x32_bf16 a[48:51],a[228:231],v[164:167],a[48:51]
ds_read_b128 a[192:195],v0 offset:0
s_add_u32 m0,s25,65536
s_add_u32 s28,s25,65536
buffer_load_dwordx4 v12,s[8:11],s28 offen nt lds
buffer_load_dwordx4 v13,s[8:11],s28 offen offset:1024 nt lds
buffer_load_dwordx4 v14,s[8:11],s28 offen offset:2048 nt lds
buffer_load_dwordx4 v15,s[8:11],s28 offen offset:3072 nt lds
s_add_u32 m0,s25,81920
s_add_u32 s28,s25,81920
buffer_load_dwordx4 v12,s[8:11],s28 offen nt lds
buffer_load_dwordx4 v13,s[8:11],s28 offen offset:1024 nt lds
buffer_load_dwordx4 v14,s[8:11],s28 offen offset:2048 nt lds
buffer_load_dwordx4 v15,s[8:11],s28 offen offset:3072 nt lds
v_mfma_f32_16x16x32_bf16 a[112:115],a[224:227],v[176:179],0
v_exp_f32 v125,v125
v_mfma_f32_16x16x32_bf16 a[112:115],a[228:231],v[180:183],a[112:115]
v_cvt_pk_bf16_f32 v174,v124,v125
v_mfma_f32_16x16x32_bf16 a[176:179],a[224:227],v[192:195],0
ds_read_b128 a[196:199],v1 offset:0
v_mfma_f32_16x16x32_bf16 a[176:179],a[228:231],v[196:199],a[176:179]
v_exp_f32 v126,v126
v_mfma_f32_16x16x32_bf16 a[52:55],a[232:235],v[160:163],0
v_mfma_f32_16x16x32_bf16 a[52:55],a[236:239],v[164:167],a[52:55]
ds_read_b128 a[200:203],v2 offset:0
v_mfma_f32_16x16x32_bf16 a[116:119],a[232:235],v[176:179],0
v_exp_f32 v127,v127
v_mfma_f32_16x16x32_bf16 a[116:119],a[236:239],v[180:183],a[116:119]
v_cvt_pk_bf16_f32 v175,v126,v127
v_mfma_f32_16x16x32_bf16 a[180:183],a[232:235],v[192:195],0
ds_read_b128 a[204:207],v3 offset:0
v_mfma_f32_16x16x32_bf16 a[180:183],a[236:239],v[196:199],a[180:183]
v_exp_f32 v140,v140
v_mfma_f32_16x16x32_bf16 a[56:59],a[240:243],v[160:163],0
v_exp_f32 v141,v141
v_mfma_f32_16x16x32_bf16 a[56:59],a[244:247],v[164:167],a[56:59]
ds_read_b128 a[208:211],v0 offset:256
v_cvt_pk_bf16_f32 v190,v140,v141
v_mfma_f32_16x16x32_bf16 a[120:123],a[240:243],v[176:179],0
v_mfma_f32_16x16x32_bf16 a[120:123],a[244:247],v[180:183],a[120:123]
v_exp_f32 v142,v142
v_mfma_f32_16x16x32_bf16 a[184:187],a[240:243],v[192:195],0
ds_read_b128 a[212:215],v1 offset:256
v_mfma_f32_16x16x32_bf16 a[184:187],a[244:247],v[196:199],a[184:187]
v_exp_f32 v143,v143
v_mfma_f32_16x16x32_bf16 a[60:63],a[248:251],v[160:163],0
v_cvt_pk_bf16_f32 v191,v142,v143
s_waitcnt lgkmcnt(6)
v_mfma_f32_16x16x32_bf16 a[60:63],a[252:255],v[164:167],a[60:63]
ds_read_b128 a[216:219],v2 offset:256
v_mfma_f32_16x16x32_bf16 a[124:127],a[248:251],v[176:179],0
v_mfma_f32_16x16x32_bf16 a[124:127],a[252:255],v[180:183],a[124:127]
v_mfma_f32_16x16x32_bf16 a[188:191],a[248:251],v[192:195],0
ds_read_b128 a[220:223],v3 offset:256
v_mfma_f32_16x16x32_bf16 a[188:191],a[252:255],v[196:199],a[188:191]
LOOP_A2:
s_waitcnt lgkmcnt(2)
v_mfma_f32_16x16x32_bf16 v[112:115],a[192:195],v[16:19],v[208:211]
ds_read_b128 a[224:227],v0 offset:8192
v_mfma_f32_16x16x32_bf16 v[112:115],a[196:199],v[20:23],v[112:115]
v_exp_f32 v156,v156
v_mfma_f32_16x16x32_bf16 v[112:115],a[200:203],v[24:27],v[112:115]
v_mfma_f32_16x16x32_bf16 v[112:115],a[204:207],v[28:31],v[112:115]
ds_read_b128 a[228:231],v1 offset:8192
v_mfma_f32_16x16x32_bf16 v[112:115],a[208:211],v[32:35],v[112:115]
v_exp_f32 v157,v157
v_mfma_f32_16x16x32_bf16 v[112:115],a[212:215],v[36:39],v[112:115]
v_cvt_pk_bf16_f32 v206,v156,v157
s_waitcnt lgkmcnt(2)
v_mfma_f32_16x16x32_bf16 v[112:115],a[216:219],v[40:43],v[112:115]
ds_read_b128 a[232:235],v2 offset:8192
v_mfma_f32_16x16x32_bf16 v[112:115],a[220:223],v[44:47],v[112:115]
v_exp_f32 v158,v158
v_mfma_f32_16x16x32_bf16 v[128:131],a[192:195],v[48:51],v[212:215]
v_mfma_f32_16x16x32_bf16 v[128:131],a[196:199],v[52:55],v[128:131]
ds_read_b128 a[236:239],v3 offset:8192
v_mfma_f32_16x16x32_bf16 v[128:131],a[200:203],v[56:59],v[128:131]
v_exp_f32 v159,v159
v_mfma_f32_16x16x32_bf16 v[128:131],a[204:207],v[60:63],v[128:131]
v_cvt_pk_bf16_f32 v207,v158,v159
v_mfma_f32_16x16x32_bf16 v[128:131],a[208:211],v[64:67],v[128:131]
ds_read_b128 a[240:243],v0 offset:8448
v_mfma_f32_16x16x32_bf16 v[128:131],a[212:215],v[68:71],v[128:131]
v_mfma_f32_16x16x32_bf16 v[128:131],a[216:219],v[72:75],v[128:131]
v_exp_f32 v112,v112
v_mfma_f32_16x16x32_bf16 v[128:131],a[220:223],v[76:79],v[128:131]
ds_read_b128 a[244:247],v1 offset:8448
v_mfma_f32_16x16x32_bf16 v[144:147],a[192:195],v[80:83],v[216:219]
v_mfma_f32_16x16x32_bf16 v[144:147],a[196:199],v[84:87],v[144:147]
v_exp_f32 v113,v113
v_mfma_f32_16x16x32_bf16 v[144:147],a[200:203],v[88:91],v[144:147]
ds_read_b128 a[248:251],v2 offset:8448
v_cvt_pk_bf16_f32 v160,v112,v113
v_mfma_f32_16x16x32_bf16 v[144:147],a[204:207],v[92:95],v[144:147]
v_mfma_f32_16x16x32_bf16 v[144:147],a[208:211],v[96:99],v[144:147]
v_mfma_f32_16x16x32_bf16 v[144:147],a[212:215],v[100:103],v[144:147]
ds_read_b128 a[252:255],v3 offset:8448
v_mfma_f32_16x16x32_bf16 v[144:147],a[216:219],v[104:107],v[144:147]
v_exp_f32 v114,v114
v_mfma_f32_16x16x32_bf16 v[144:147],a[220:223],v[108:111],v[144:147]
s_waitcnt lgkmcnt(2)
v_mfma_f32_16x16x32_bf16 v[116:119],a[224:227],v[16:19],v[208:211]
ds_read_b128 a[192:195],v0 offset:16384
v_mfma_f32_16x16x32_bf16 v[116:119],a[228:231],v[20:23],v[116:119]
v_exp_f32 v115,v115
v_mfma_f32_16x16x32_bf16 v[116:119],a[232:235],v[24:27],v[116:119]
v_cvt_pk_bf16_f32 v161,v114,v115
v_mfma_f32_16x16x32_bf16 v[116:119],a[236:239],v[28:31],v[116:119]
ds_read_b128 a[196:199],v1 offset:16384
v_mfma_f32_16x16x32_bf16 v[116:119],a[240:243],v[32:35],v[116:119]
v_exp_f32 v128,v128
v_mfma_f32_16x16x32_bf16 v[116:119],a[244:247],v[36:39],v[116:119]
s_waitcnt lgkmcnt(2)
v_mfma_f32_16x16x32_bf16 v[116:119],a[248:251],v[40:43],v[116:119]
ds_read_b128 a[200:203],v2 offset:16384
v_mfma_f32_16x16x32_bf16 v[116:119],a[252:255],v[44:47],v[116:119]
v_exp_f32 v129,v129
v_mfma_f32_16x16x32_bf16 v[132:135],a[224:227],v[48:51],v[212:215]
v_cvt_pk_bf16_f32 v176,v128,v129
v_mfma_f32_16x16x32_bf16 v[132:135],a[228:231],v[52:55],v[132:135]
ds_read_b128 a[204:207],v3 offset:16384
v_mfma_f32_16x16x32_bf16 v[132:135],a[232:235],v[56:59],v[132:135]
v_mfma_f32_16x16x32_bf16 v[132:135],a[236:239],v[60:63],v[132:135]
v_exp_f32 v130,v130
v_mfma_f32_16x16x32_bf16 v[132:135],a[240:243],v[64:67],v[132:135]
ds_read_b128 a[208:211],v0 offset:16640
v_mfma_f32_16x16x32_bf16 v[132:135],a[244:247],v[68:71],v[132:135]
v_mfma_f32_16x16x32_bf16 v[132:135],a[248:251],v[72:75],v[132:135]
v_exp_f32 v131,v131
v_mfma_f32_16x16x32_bf16 v[132:135],a[252:255],v[76:79],v[132:135]
ds_read_b128 a[212:215],v1 offset:16640
v_cvt_pk_bf16_f32 v177,v130,v131
v_mfma_f32_16x16x32_bf16 v[148:151],a[224:227],v[80:83],v[216:219]
v_mfma_f32_16x16x32_bf16 v[148:151],a[228:231],v[84:87],v[148:151]
v_mfma_f32_16x16x32_bf16 v[148:151],a[232:235],v[88:91],v[148:151]
ds_read_b128 a[216:219],v2 offset:16640
v_mfma_f32_16x16x32_bf16 v[148:151],a[236:239],v[92:95],v[148:151]
v_exp_f32 v144,v144
v_mfma_f32_16x16x32_bf16 v[148:151],a[240:243],v[96:99],v[148:151]
ds_read_b128 a[220:223],v3 offset:16640
v_mfma_f32_16x16x32_bf16 v[148:151],a[244:247],v[100:103],v[148:151]
v_mfma_f32_16x16x32_bf16 v[148:151],a[248:251],v[104:107],v[148:151]
v_exp_f32 v145,v145
v_mfma_f32_16x16x32_bf16 v[148:151],a[252:255],v[108:111],v[148:151]
ds_read_b128 a[224:227],v0 offset:24576
s_waitcnt lgkmcnt(3)
v_mfma_f32_16x16x32_bf16 v[120:123],a[192:195],v[16:19],v[208:211]
v_cvt_pk_bf16_f32 v192,v144,v145
v_mfma_f32_16x16x32_bf16 v[120:123],a[196:199],v[20:23],v[120:123]
v_mfma_f32_16x16x32_bf16 v[120:123],a[200:203],v[24:27],v[120:123]
ds_read_b128 a[228:231],v1 offset:24576
v_mfma_f32_16x16x32_bf16 v[120:123],a[204:207],v[28:31],v[120:123]
v_exp_f32 v146,v146
v_mfma_f32_16x16x32_bf16 v[120:123],a[208:211],v[32:35],v[120:123]
v_mfma_f32_16x16x32_bf16 v[120:123],a[212:215],v[36:39],v[120:123]
ds_read_b128 a[232:235],v2 offset:24576
s_waitcnt lgkmcnt(3)
v_mfma_f32_16x16x32_bf16 v[120:123],a[216:219],v[40:43],v[120:123]
v_exp_f32 v147,v147
v_mfma_f32_16x16x32_bf16 v[120:123],a[220:223],v[44:47],v[120:123]
v_cvt_pk_bf16_f32 v193,v146,v147
v_mfma_f32_16x16x32_bf16 v[136:139],a[192:195],v[48:51],v[212:215]
ds_read_b128 a[236:239],v3 offset:24576
v_mfma_f32_16x16x32_bf16 v[136:139],a[196:199],v[52:55],v[136:139]
v_mfma_f32_16x16x32_bf16 v[136:139],a[200:203],v[56:59],v[136:139]
v_exp_f32 v116,v116
v_mfma_f32_16x16x32_bf16 v[136:139],a[204:207],v[60:63],v[136:139]
ds_read_b128 a[240:243],v0 offset:24832
v_mfma_f32_16x16x32_bf16 v[136:139],a[208:211],v[64:67],v[136:139]
v_mfma_f32_16x16x32_bf16 v[136:139],a[212:215],v[68:71],v[136:139]
v_exp_f32 v117,v117
v_mfma_f32_16x16x32_bf16 v[136:139],a[216:219],v[72:75],v[136:139]
ds_read_b128 a[244:247],v1 offset:24832
v_cvt_pk_bf16_f32 v162,v116,v117
v_mfma_f32_16x16x32_bf16 v[136:139],a[220:223],v[76:79],v[136:139]
v_mfma_f32_16x16x32_bf16 v[152:155],a[192:195],v[80:83],v[216:219]
v_mfma_f32_16x16x32_bf16 v[152:155],a[196:199],v[84:87],v[152:155]
ds_read_b128 a[248:251],v2 offset:24832
v_mfma_f32_16x16x32_bf16 v[152:155],a[200:203],v[88:91],v[152:155]
v_exp_f32 v118,v118
v_mfma_f32_16x16x32_bf16 v[152:155],a[204:207],v[92:95],v[152:155]
v_mfma_f32_16x16x32_bf16 v[152:155],a[208:211],v[96:99],v[152:155]
ds_read_b128 a[252:255],v3 offset:24832
v_mfma_f32_16x16x32_bf16 v[152:155],a[212:215],v[100:103],v[152:155]
v_exp_f32 v119,v119
v_mfma_f32_16x16x32_bf16 v[152:155],a[216:219],v[104:107],v[152:155]
v_cvt_pk_bf16_f32 v163,v118,v119
v_mfma_f32_16x16x32_bf16 v[152:155],a[220:223],v[108:111],v[152:155]
s_waitcnt lgkmcnt(2)
v_mfma_f32_16x16x32_bf16 v[124:127],a[224:227],v[16:19],v[208:211]
v_exp_f32 v132,v132
v_mfma_f32_16x16x32_bf16 v[124:127],a[228:231],v[20:23],v[124:127]
v_mfma_f32_16x16x32_bf16 v[124:127],a[232:235],v[24:27],v[124:127]
s_waitcnt lgkmcnt(0)
s_waitcnt vmcnt(12)
s_barrier
v_mfma_f32_16x16x32_bf16 v[124:127],a[236:239],v[28:31],v[124:127]
ds_read_b64_tr_b16 a[192:193],v4 offset:32768
ds_read_b64_tr_b16 a[194:195],v4 offset:40960
s_add_u32 m0,s25,0
s_add_u32 s28,s26,98304
buffer_load_dwordx4 v12,s[4:7],s28 offen nt lds
buffer_load_dwordx4 v13,s[4:7],s28 offen offset:1024 nt lds
buffer_load_dwordx4 v14,s[4:7],s28 offen offset:2048 nt lds
buffer_load_dwordx4 v15,s[4:7],s28 offen offset:3072 nt lds
s_add_u32 m0,s25,16384
s_add_u32 s28,s26,114688
buffer_load_dwordx4 v12,s[4:7],s28 offen nt lds
buffer_load_dwordx4 v13,s[4:7],s28 offen offset:1024 nt lds
buffer_load_dwordx4 v14,s[4:7],s28 offen offset:2048 nt lds
buffer_load_dwordx4 v15,s[4:7],s28 offen offset:3072 nt lds
v_mfma_f32_16x16x32_bf16 v[124:127],a[240:243],v[32:35],v[124:127]
v_exp_f32 v133,v133
v_mfma_f32_16x16x32_bf16 v[124:127],a[244:247],v[36:39],v[124:127]
v_cvt_pk_bf16_f32 v178,v132,v133
s_waitcnt lgkmcnt(2)
v_mfma_f32_16x16x32_bf16 v[124:127],a[248:251],v[40:43],v[124:127]
ds_read_b64_tr_b16 a[196:197],v4 offset:49152
ds_read_b64_tr_b16 a[198:199],v4 offset:57344
v_mfma_f32_16x16x32_bf16 v[124:127],a[252:255],v[44:47],v[124:127]
v_mfma_f32_16x16x32_bf16 v[140:143],a[224:227],v[48:51],v[212:215]
v_mfma_f32_16x16x32_bf16 v[140:143],a[228:231],v[52:55],v[140:143]
ds_read_b64_tr_b16 a[200:201],v5 offset:32768
ds_read_b64_tr_b16 a[202:203],v5 offset:40960
v_mfma_f32_16x16x32_bf16 v[140:143],a[232:235],v[56:59],v[140:143]
v_exp_f32 v134,v134
v_mfma_f32_16x16x32_bf16 v[140:143],a[236:239],v[60:63],v[140:143]
v_mfma_f32_16x16x32_bf16 v[140:143],a[240:243],v[64:67],v[140:143]
ds_read_b64_tr_b16 a[204:205],v5 offset:49152
ds_read_b64_tr_b16 a[206:207],v5 offset:57344
v_mfma_f32_16x16x32_bf16 v[140:143],a[244:247],v[68:71],v[140:143]
v_mfma_f32_16x16x32_bf16 v[140:143],a[248:251],v[72:75],v[140:143]
v_exp_f32 v135,v135
v_mfma_f32_16x16x32_bf16 v[140:143],a[252:255],v[76:79],v[140:143]
ds_read_b64_tr_b16 a[208:209],v6 offset:32768
ds_read_b64_tr_b16 a[210:211],v6 offset:40960
v_mfma_f32_16x16x32_bf16 v[156:159],a[224:227],v[80:83],v[216:219]
v_cvt_pk_bf16_f32 v179,v134,v135
v_mfma_f32_16x16x32_bf16 v[156:159],a[228:231],v[84:87],v[156:159]
v_mfma_f32_16x16x32_bf16 v[156:159],a[232:235],v[88:91],v[156:159]
ds_read_b64_tr_b16 a[212:213],v6 offset:49152
ds_read_b64_tr_b16 a[214:215],v6 offset:57344
v_mfma_f32_16x16x32_bf16 v[156:159],a[236:239],v[92:95],v[156:159]
v_exp_f32 v148,v148
v_mfma_f32_16x16x32_bf16 v[156:159],a[240:243],v[96:99],v[156:159]
v_mfma_f32_16x16x32_bf16 v[156:159],a[244:247],v[100:103],v[156:159]
ds_read_b64_tr_b16 a[216:217],v7 offset:32768
ds_read_b64_tr_b16 a[218:219],v7 offset:40960
v_mfma_f32_16x16x32_bf16 v[156:159],a[248:251],v[104:107],v[156:159]
v_mfma_f32_16x16x32_bf16 v[156:159],a[252:255],v[108:111],v[156:159]
v_exp_f32 v149,v149
v_mfma_f32_16x16x32_bf16 v[220:223],v[232:235],v[168:171],v[220:223]
ds_read_b64_tr_b16 a[220:221],v7 offset:49152
ds_read_b64_tr_b16 a[222:223],v7 offset:57344
v_mfma_f32_16x16x32_bf16 v[220:223],v[232:235],v[172:175],v[220:223]
v_cvt_pk_bf16_f32 v194,v148,v149
v_mfma_f32_16x16x32_bf16 v[224:227],v[232:235],v[184:187],v[224:227]
v_mfma_f32_16x16x32_bf16 v[224:227],v[232:235],v[188:191],v[224:227]
ds_read_b64_tr_b16 a[224:225],v8 offset:32768
ds_read_b64_tr_b16 a[226:227],v8 offset:40960
v_mfma_f32_16x16x32_bf16 v[228:231],v[232:235],v[200:203],v[228:231]
v_exp_f32 v150,v150
v_mfma_f32_16x16x32_bf16 v[228:231],v[232:235],v[204:207],v[228:231]
s_waitcnt lgkmcnt(4)
v_mfma_f32_16x16x32_bf16 a[0:3],a[192:195],v[168:171],a[0:3]
ds_read_b64_tr_b16 a[228:229],v8 offset:49152
ds_read_b64_tr_b16 a[230:231],v8 offset:57344
v_mfma_f32_16x16x32_bf16 a[0:3],a[196:199],v[172:175],a[0:3]
v_mfma_f32_16x16x32_bf16 a[64:67],a[192:195],v[184:187],a[64:67]
v_exp_f32 v151,v151
v_mfma_f32_16x16x32_bf16 a[64:67],a[196:199],v[188:191],a[64:67]
ds_read_b64_tr_b16 a[232:233],v9 offset:32768
ds_read_b64_tr_b16 a[234:235],v9 offset:40960
v_mfma_f32_16x16x32_bf16 a[128:131],a[192:195],v[200:203],a[128:131]
v_cvt_pk_bf16_f32 v195,v150,v151
v_mfma_f32_16x16x32_bf16 a[128:131],a[196:199],v[204:207],a[128:131]
v_mfma_f32_16x16x32_bf16 a[4:7],a[200:203],v[168:171],a[4:7]
ds_read_b64_tr_b16 a[236:237],v9 offset:49152
ds_read_b64_tr_b16 a[238:239],v9 offset:57344
v_mfma_f32_16x16x32_bf16 a[4:7],a[204:207],v[172:175],a[4:7]
v_exp_f32 v120,v120
v_mfma_f32_16x16x32_bf16 a[68:71],a[200:203],v[184:187],a[68:71]
v_mfma_f32_16x16x32_bf16 a[68:71],a[204:207],v[188:191],a[68:71]
ds_read_b64_tr_b16 a[240:241],v10 offset:32768
ds_read_b64_tr_b16 a[242:243],v10 offset:40960
v_mfma_f32_16x16x32_bf16 a[132:135],a[200:203],v[200:203],a[132:135]
v_mfma_f32_16x16x32_bf16 a[132:135],a[204:207],v[204:207],a[132:135]
v_exp_f32 v121,v121
v_mfma_f32_16x16x32_bf16 a[8:11],a[208:211],v[168:171],a[8:11]
ds_read_b64_tr_b16 a[244:245],v10 offset:49152
ds_read_b64_tr_b16 a[246:247],v10 offset:57344
v_mfma_f32_16x16x32_bf16 a[8:11],a[212:215],v[172:175],a[8:11]
v_cvt_pk_bf16_f32 v164,v120,v121
v_mfma_f32_16x16x32_bf16 a[72:75],a[208:211],v[184:187],a[72:75]
v_mfma_f32_16x16x32_bf16 a[72:75],a[212:215],v[188:191],a[72:75]
ds_read_b64_tr_b16 a[248:249],v11 offset:32768
ds_read_b64_tr_b16 a[250:251],v11 offset:40960
v_mfma_f32_16x16x32_bf16 a[136:139],a[208:211],v[200:203],a[136:139]
v_exp_f32 v122,v122
v_mfma_f32_16x16x32_bf16 a[136:139],a[212:215],v[204:207],a[136:139]
v_mfma_f32_16x16x32_bf16 a[12:15],a[216:219],v[168:171],a[12:15]
ds_read_b64_tr_b16 a[252:253],v11 offset:49152
ds_read_b64_tr_b16 a[254:255],v11 offset:57344
s_waitcnt lgkmcnt(6)
v_mfma_f32_16x16x32_bf16 a[12:15],a[220:223],v[172:175],a[12:15]
v_mfma_f32_16x16x32_bf16 a[76:79],a[216:219],v[184:187],a[76:79]
v_exp_f32 v123,v123
v_mfma_f32_16x16x32_bf16 a[76:79],a[220:223],v[188:191],a[76:79]
ds_read_b64_tr_b16 a[192:193],v4 offset:33024
ds_read_b64_tr_b16 a[194:195],v4 offset:41216
v_mfma_f32_16x16x32_bf16 a[140:143],a[216:219],v[200:203],a[140:143]
v_cvt_pk_bf16_f32 v165,v122,v123
v_mfma_f32_16x16x32_bf16 a[140:143],a[220:223],v[204:207],a[140:143]
v_mfma_f32_16x16x32_bf16 a[16:19],a[224:227],v[168:171],a[16:19]
ds_read_b64_tr_b16 a[196:197],v4 offset:49408
ds_read_b64_tr_b16 a[198:199],v4 offset:57600
v_mfma_f32_16x16x32_bf16 a[16:19],a[228:231],v[172:175],a[16:19]
v_exp_f32 v136,v136
v_mfma_f32_16x16x32_bf16 a[80:83],a[224:227],v[184:187],a[80:83]
v_mfma_f32_16x16x32_bf16 a[80:83],a[228:231],v[188:191],a[80:83]
ds_read_b64_tr_b16 a[200:201],v5 offset:33024
ds_read_b64_tr_b16 a[202:203],v5 offset:41216
v_mfma_f32_16x16x32_bf16 a[144:147],a[224:227],v[200:203],a[144:147]
v_mfma_f32_16x16x32_bf16 a[144:147],a[228:231],v[204:207],a[144:147]
v_exp_f32 v137,v137
v_mfma_f32_16x16x32_bf16 a[20:23],a[232:235],v[168:171],a[20:23]
ds_read_b64_tr_b16 a[204:205],v5 offset:49408
ds_read_b64_tr_b16 a[206:207],v5 offset:57600
v_mfma_f32_16x16x32_bf16 a[20:23],a[236:239],v[172:175],a[20:23]
v_cvt_pk_bf16_f32 v180,v136,v137
v_mfma_f32_16x16x32_bf16 a[84:87],a[232:235],v[184:187],a[84:87]
v_mfma_f32_16x16x32_bf16 a[84:87],a[236:239],v[188:191],a[84:87]
ds_read_b64_tr_b16 a[208:209],v6 offset:33024
ds_read_b64_tr_b16 a[210:211],v6 offset:41216
v_mfma_f32_16x16x32_bf16 a[148:151],a[232:235],v[200:203],a[148:151]
v_exp_f32 v138,v138
v_mfma_f32_16x16x32_bf16 a[148:151],a[236:239],v[204:207],a[148:151]
v_mfma_f32_16x16x32_bf16 a[24:27],a[240:243],v[168:171],a[24:27]
ds_read_b64_tr_b16 a[212:213],v6 offset:49408
ds_read_b64_tr_b16 a[214:215],v6 offset:57600
s_waitcnt lgkmcnt(6)
v_mfma_f32_16x16x32_bf16 a[24:27],a[244:247],v[172:175],a[24:27]
v_mfma_f32_16x16x32_bf16 a[88:91],a[240:243],v[184:187],a[88:91]
v_exp_f32 v139,v139
v_mfma_f32_16x16x32_bf16 a[88:91],a[244:247],v[188:191],a[88:91]
ds_read_b64_tr_b16 a[216:217],v7 offset:33024
ds_read_b64_tr_b16 a[218:219],v7 offset:41216
v_mfma_f32_16x16x32_bf16 a[152:155],a[240:243],v[200:203],a[152:155]
v_cvt_pk_bf16_f32 v181,v138,v139
v_mfma_f32_16x16x32_bf16 a[152:155],a[244:247],v[204:207],a[152:155]
v_mfma_f32_16x16x32_bf16 a[28:31],a[248:251],v[168:171],a[28:31]
ds_read_b64_tr_b16 a[220:221],v7 offset:49408
ds_read_b64_tr_b16 a[222:223],v7 offset:57600
v_mfma_f32_16x16x32_bf16 a[28:31],a[252:255],v[172:175],a[28:31]
v_exp_f32 v152,v152
v_mfma_f32_16x16x32_bf16 a[92:95],a[248:251],v[184:187],a[92:95]
v_mfma_f32_16x16x32_bf16 a[92:95],a[252:255],v[188:191],a[92:95]
ds_read_b64_tr_b16 a[224:225],v8 offset:33024
ds_read_b64_tr_b16 a[226:227],v8 offset:41216
v_mfma_f32_16x16x32_bf16 a[156:159],a[248:251],v[200:203],a[156:159]
v_mfma_f32_16x16x32_bf16 a[156:159],a[252:255],v[204:207],a[156:159]
v_exp_f32 v153,v153
v_mfma_f32_16x16x32_bf16 a[32:35],a[192:195],v[168:171],a[32:35]
ds_read_b64_tr_b16 a[228:229],v8 offset:49408
ds_read_b64_tr_b16 a[230:231],v8 offset:57600
v_mfma_f32_16x16x32_bf16 a[32:35],a[196:199],v[172:175],a[32:35]
v_cvt_pk_bf16_f32 v196,v152,v153
v_mfma_f32_16x16x32_bf16 a[96:99],a[192:195],v[184:187],a[96:99]
v_mfma_f32_16x16x32_bf16 a[96:99],a[196:199],v[188:191],a[96:99]
ds_read_b64_tr_b16 a[232:233],v9 offset:33024
ds_read_b64_tr_b16 a[234:235],v9 offset:41216
v_mfma_f32_16x16x32_bf16 a[160:163],a[192:195],v[200:203],a[160:163]
v_exp_f32 v154,v154
v_mfma_f32_16x16x32_bf16 a[160:163],a[196:199],v[204:207],a[160:163]
v_mfma_f32_16x16x32_bf16 a[36:39],a[200:203],v[168:171],a[36:39]
ds_read_b64_tr_b16 a[236:237],v9 offset:49408
ds_read_b64_tr_b16 a[238:239],v9 offset:57600
s_waitcnt lgkmcnt(6)
v_mfma_f32_16x16x32_bf16 a[36:39],a[204:207],v[172:175],a[36:39]
v_mfma_f32_16x16x32_bf16 a[100:103],a[200:203],v[184:187],a[100:103]
v_exp_f32 v155,v155
v_mfma_f32_16x16x32_bf16 a[100:103],a[204:207],v[188:191],a[100:103]
ds_read_b64_tr_b16 a[240:241],v10 offset:33024
ds_read_b64_tr_b16 a[242:243],v10 offset:41216
v_mfma_f32_16x16x32_bf16 a[164:167],a[200:203],v[200:203],a[164:167]
v_cvt_pk_bf16_f32 v197,v154,v155
v_mfma_f32_16x16x32_bf16 a[164:167],a[204:207],v[204:207],a[164:167]
v_mfma_f32_16x16x32_bf16 a[40:43],a[208:211],v[168:171],a[40:43]
ds_read_b64_tr_b16 a[244:245],v10 offset:49408
ds_read_b64_tr_b16 a[246:247],v10 offset:57600
v_mfma_f32_16x16x32_bf16 a[40:43],a[212:215],v[172:175],a[40:43]
v_exp_f32 v124,v124
v_mfma_f32_16x16x32_bf16 a[104:107],a[208:211],v[184:187],a[104:107]
v_mfma_f32_16x16x32_bf16 a[104:107],a[212:215],v[188:191],a[104:107]
ds_read_b64_tr_b16 a[248:249],v11 offset:33024
ds_read_b64_tr_b16 a[250:251],v11 offset:41216
v_mfma_f32_16x16x32_bf16 a[168:171],a[208:211],v[200:203],a[168:171]
v_mfma_f32_16x16x32_bf16 a[168:171],a[212:215],v[204:207],a[168:171]
v_exp_f32 v125,v125
v_mfma_f32_16x16x32_bf16 a[44:47],a[216:219],v[168:171],a[44:47]
ds_read_b64_tr_b16 a[252:253],v11 offset:49408
ds_read_b64_tr_b16 a[254:255],v11 offset:57600
v_mfma_f32_16x16x32_bf16 a[44:47],a[220:223],v[172:175],a[44:47]
v_cvt_pk_bf16_f32 v166,v124,v125
v_mfma_f32_16x16x32_bf16 a[108:111],a[216:219],v[184:187],a[108:111]
v_mfma_f32_16x16x32_bf16 a[108:111],a[220:223],v[188:191],a[108:111]
v_exp_f32 v126,v126
v_mfma_f32_16x16x32_bf16 a[172:175],a[216:219],v[200:203],a[172:175]
v_mfma_f32_16x16x32_bf16 a[172:175],a[220:223],v[204:207],a[172:175]
v_mfma_f32_16x16x32_bf16 a[48:51],a[224:227],v[168:171],a[48:51]
s_waitcnt lgkmcnt(0)
s_waitcnt vmcnt(12)
s_barrier
s_waitcnt lgkmcnt(2)
v_mfma_f32_16x16x32_bf16 a[48:51],a[228:231],v[172:175],a[48:51]
ds_read_b128 a[192:195],v0 offset:32768
s_add_u32 m0,s25,98304
s_add_u32 s28,s26,65536
buffer_load_dwordx4 v12,s[8:11],s28 offen nt lds
buffer_load_dwordx4 v13,s[8:11],s28 offen offset:1024 nt lds
buffer_load_dwordx4 v14,s[8:11],s28 offen offset:2048 nt lds
buffer_load_dwordx4 v15,s[8:11],s28 offen offset:3072 nt lds
v_mfma_f32_16x16x32_bf16 a[112:115],a[224:227],v[184:187],a[112:115]
v_exp_f32 v127,v127
v_mfma_f32_16x16x32_bf16 a[112:115],a[228:231],v[188:191],a[112:115]
v_cvt_pk_bf16_f32 v167,v126,v127
v_mfma_f32_16x16x32_bf16 a[176:179],a[224:227],v[200:203],a[176:179]
ds_read_b128 a[196:199],v1 offset:32768
v_mfma_f32_16x16x32_bf16 a[176:179],a[228:231],v[204:207],a[176:179]
v_mfma_f32_16x16x32_bf16 a[52:55],a[232:235],v[168:171],a[52:55]
v_exp_f32 v140,v140
v_mfma_f32_16x16x32_bf16 a[52:55],a[236:239],v[172:175],a[52:55]
ds_read_b128 a[200:203],v2 offset:32768
v_mfma_f32_16x16x32_bf16 a[116:119],a[232:235],v[184:187],a[116:119]
v_mfma_f32_16x16x32_bf16 a[116:119],a[236:239],v[188:191],a[116:119]
v_exp_f32 v141,v141
v_mfma_f32_16x16x32_bf16 a[180:183],a[232:235],v[200:203],a[180:183]
ds_read_b128 a[204:207],v3 offset:32768
v_cvt_pk_bf16_f32 v182,v140,v141
v_mfma_f32_16x16x32_bf16 a[180:183],a[236:239],v[204:207],a[180:183]
v_mfma_f32_16x16x32_bf16 a[56:59],a[240:243],v[168:171],a[56:59]
v_mfma_f32_16x16x32_bf16 a[56:59],a[244:247],v[172:175],a[56:59]
ds_read_b128 a[208:211],v0 offset:33024
v_mfma_f32_16x16x32_bf16 a[120:123],a[240:243],v[184:187],a[120:123]
v_exp_f32 v142,v142
v_mfma_f32_16x16x32_bf16 a[120:123],a[244:247],v[188:191],a[120:123]
v_mfma_f32_16x16x32_bf16 a[184:187],a[240:243],v[200:203],a[184:187]
ds_read_b128 a[212:215],v1 offset:33024
v_mfma_f32_16x16x32_bf16 a[184:187],a[244:247],v[204:207],a[184:187]
v_exp_f32 v143,v143
v_mfma_f32_16x16x32_bf16 a[60:63],a[248:251],v[168:171],a[60:63]
v_cvt_pk_bf16_f32 v183,v142,v143
s_waitcnt lgkmcnt(6)
v_mfma_f32_16x16x32_bf16 a[60:63],a[252:255],v[172:175],a[60:63]
ds_read_b128 a[216:219],v2 offset:33024
v_mfma_f32_16x16x32_bf16 a[124:127],a[248:251],v[184:187],a[124:127]
v_mfma_f32_16x16x32_bf16 a[124:127],a[252:255],v[188:191],a[124:127]
v_mfma_f32_16x16x32_bf16 a[188:191],a[248:251],v[200:203],a[188:191]
ds_read_b128 a[220:223],v3 offset:33024
v_mfma_f32_16x16x32_bf16 a[188:191],a[252:255],v[204:207],a[188:191]
s_waitcnt lgkmcnt(2)
v_mfma_f32_16x16x32_bf16 v[112:115],a[192:195],v[16:19],v[208:211]
ds_read_b128 a[224:227],v0 offset:40960
v_mfma_f32_16x16x32_bf16 v[112:115],a[196:199],v[20:23],v[112:115]
v_exp_f32 v156,v156
v_mfma_f32_16x16x32_bf16 v[112:115],a[200:203],v[24:27],v[112:115]
v_mfma_f32_16x16x32_bf16 v[112:115],a[204:207],v[28:31],v[112:115]
ds_read_b128 a[228:231],v1 offset:40960
v_mfma_f32_16x16x32_bf16 v[112:115],a[208:211],v[32:35],v[112:115]
v_exp_f32 v157,v157
v_mfma_f32_16x16x32_bf16 v[112:115],a[212:215],v[36:39],v[112:115]
v_cvt_pk_bf16_f32 v198,v156,v157
s_waitcnt lgkmcnt(2)
v_mfma_f32_16x16x32_bf16 v[112:115],a[216:219],v[40:43],v[112:115]
ds_read_b128 a[232:235],v2 offset:40960
v_mfma_f32_16x16x32_bf16 v[112:115],a[220:223],v[44:47],v[112:115]
v_exp_f32 v158,v158
v_mfma_f32_16x16x32_bf16 v[128:131],a[192:195],v[48:51],v[212:215]
v_mfma_f32_16x16x32_bf16 v[128:131],a[196:199],v[52:55],v[128:131]
ds_read_b128 a[236:239],v3 offset:40960
v_mfma_f32_16x16x32_bf16 v[128:131],a[200:203],v[56:59],v[128:131]
v_exp_f32 v159,v159
v_mfma_f32_16x16x32_bf16 v[128:131],a[204:207],v[60:63],v[128:131]
v_cvt_pk_bf16_f32 v199,v158,v159
v_mfma_f32_16x16x32_bf16 v[128:131],a[208:211],v[64:67],v[128:131]
ds_read_b128 a[240:243],v0 offset:41216
v_mfma_f32_16x16x32_bf16 v[128:131],a[212:215],v[68:71],v[128:131]
v_mfma_f32_16x16x32_bf16 v[128:131],a[216:219],v[72:75],v[128:131]
v_exp_f32 v112,v112
v_mfma_f32_16x16x32_bf16 v[128:131],a[220:223],v[76:79],v[128:131]
ds_read_b128 a[244:247],v1 offset:41216
v_mfma_f32_16x16x32_bf16 v[144:147],a[192:195],v[80:83],v[216:219]
v_mfma_f32_16x16x32_bf16 v[144:147],a[196:199],v[84:87],v[144:147]
v_exp_f32 v113,v113
v_mfma_f32_16x16x32_bf16 v[144:147],a[200:203],v[88:91],v[144:147]
ds_read_b128 a[248:251],v2 offset:41216
v_cvt_pk_bf16_f32 v168,v112,v113
v_mfma_f32_16x16x32_bf16 v[144:147],a[204:207],v[92:95],v[144:147]
v_mfma_f32_16x16x32_bf16 v[144:147],a[208:211],v[96:99],v[144:147]
v_mfma_f32_16x16x32_bf16 v[144:147],a[212:215],v[100:103],v[144:147]
ds_read_b128 a[252:255],v3 offset:41216
v_mfma_f32_16x16x32_bf16 v[144:147],a[216:219],v[104:107],v[144:147]
v_exp_f32 v114,v114
v_mfma_f32_16x16x32_bf16 v[144:147],a[220:223],v[108:111],v[144:147]
s_waitcnt lgkmcnt(2)
v_mfma_f32_16x16x32_bf16 v[116:119],a[224:227],v[16:19],v[208:211]
ds_read_b128 a[192:195],v0 offset:49152
v_mfma_f32_16x16x32_bf16 v[116:119],a[228:231],v[20:23],v[116:119]
v_exp_f32 v115,v115
v_mfma_f32_16x16x32_bf16 v[116:119],a[232:235],v[24:27],v[116:119]
v_cvt_pk_bf16_f32 v169,v114,v115
v_mfma_f32_16x16x32_bf16 v[116:119],a[236:239],v[28:31],v[116:119]
ds_read_b128 a[196:199],v1 offset:49152
v_mfma_f32_16x16x32_bf16 v[116:119],a[240:243],v[32:35],v[116:119]
v_exp_f32 v128,v128
v_mfma_f32_16x16x32_bf16 v[116:119],a[244:247],v[36:39],v[116:119]
s_waitcnt lgkmcnt(2)
v_mfma_f32_16x16x32_bf16 v[116:119],a[248:251],v[40:43],v[116:119]
ds_read_b128 a[200:203],v2 offset:49152
v_mfma_f32_16x16x32_bf16 v[116:119],a[252:255],v[44:47],v[116:119]
v_exp_f32 v129,v129
v_mfma_f32_16x16x32_bf16 v[132:135],a[224:227],v[48:51],v[212:215]
v_cvt_pk_bf16_f32 v184,v128,v129
v_mfma_f32_16x16x32_bf16 v[132:135],a[228:231],v[52:55],v[132:135]
ds_read_b128 a[204:207],v3 offset:49152
v_mfma_f32_16x16x32_bf16 v[132:135],a[232:235],v[56:59],v[132:135]
v_mfma_f32_16x16x32_bf16 v[132:135],a[236:239],v[60:63],v[132:135]
v_exp_f32 v130,v130
v_mfma_f32_16x16x32_bf16 v[132:135],a[240:243],v[64:67],v[132:135]
ds_read_b128 a[208:211],v0 offset:49408
v_mfma_f32_16x16x32_bf16 v[132:135],a[244:247],v[68:71],v[132:135]
v_mfma_f32_16x16x32_bf16 v[132:135],a[248:251],v[72:75],v[132:135]
v_exp_f32 v131,v131
v_mfma_f32_16x16x32_bf16 v[132:135],a[252:255],v[76:79],v[132:135]
ds_read_b128 a[212:215],v1 offset:49408
v_cvt_pk_bf16_f32 v185,v130,v131
v_mfma_f32_16x16x32_bf16 v[148:151],a[224:227],v[80:83],v[216:219]
v_mfma_f32_16x16x32_bf16 v[148:151],a[228:231],v[84:87],v[148:151]
v_mfma_f32_16x16x32_bf16 v[148:151],a[232:235],v[88:91],v[148:151]
ds_read_b128 a[216:219],v2 offset:49408
v_mfma_f32_16x16x32_bf16 v[148:151],a[236:239],v[92:95],v[148:151]
v_exp_f32 v144,v144
v_mfma_f32_16x16x32_bf16 v[148:151],a[240:243],v[96:99],v[148:151]
ds_read_b128 a[220:223],v3 offset:49408
v_mfma_f32_16x16x32_bf16 v[148:151],a[244:247],v[100:103],v[148:151]
v_mfma_f32_16x16x32_bf16 v[148:151],a[248:251],v[104:107],v[148:151]
v_exp_f32 v145,v145
v_mfma_f32_16x16x32_bf16 v[148:151],a[252:255],v[108:111],v[148:151]
ds_read_b128 a[224:227],v0 offset:57344
s_waitcnt lgkmcnt(3)
v_mfma_f32_16x16x32_bf16 v[120:123],a[192:195],v[16:19],v[208:211]
v_cvt_pk_bf16_f32 v200,v144,v145
v_mfma_f32_16x16x32_bf16 v[120:123],a[196:199],v[20:23],v[120:123]
v_mfma_f32_16x16x32_bf16 v[120:123],a[200:203],v[24:27],v[120:123]
ds_read_b128 a[228:231],v1 offset:57344
v_mfma_f32_16x16x32_bf16 v[120:123],a[204:207],v[28:31],v[120:123]
v_exp_f32 v146,v146
v_mfma_f32_16x16x32_bf16 v[120:123],a[208:211],v[32:35],v[120:123]
v_mfma_f32_16x16x32_bf16 v[120:123],a[212:215],v[36:39],v[120:123]
ds_read_b128 a[232:235],v2 offset:57344
s_waitcnt lgkmcnt(3)
v_mfma_f32_16x16x32_bf16 v[120:123],a[216:219],v[40:43],v[120:123]
v_exp_f32 v147,v147
v_mfma_f32_16x16x32_bf16 v[120:123],a[220:223],v[44:47],v[120:123]
v_cvt_pk_bf16_f32 v201,v146,v147
v_mfma_f32_16x16x32_bf16 v[136:139],a[192:195],v[48:51],v[212:215]
ds_read_b128 a[236:239],v3 offset:57344
v_mfma_f32_16x16x32_bf16 v[136:139],a[196:199],v[52:55],v[136:139]
v_mfma_f32_16x16x32_bf16 v[136:139],a[200:203],v[56:59],v[136:139]
v_exp_f32 v116,v116
v_mfma_f32_16x16x32_bf16 v[136:139],a[204:207],v[60:63],v[136:139]
ds_read_b128 a[240:243],v0 offset:57600
v_mfma_f32_16x16x32_bf16 v[136:139],a[208:211],v[64:67],v[136:139]
v_mfma_f32_16x16x32_bf16 v[136:139],a[212:215],v[68:71],v[136:139]
v_exp_f32 v117,v117
v_mfma_f32_16x16x32_bf16 v[136:139],a[216:219],v[72:75],v[136:139]
ds_read_b128 a[244:247],v1 offset:57600
v_cvt_pk_bf16_f32 v170,v116,v117
v_mfma_f32_16x16x32_bf16 v[136:139],a[220:223],v[76:79],v[136:139]
v_mfma_f32_16x16x32_bf16 v[152:155],a[192:195],v[80:83],v[216:219]
v_mfma_f32_16x16x32_bf16 v[152:155],a[196:199],v[84:87],v[152:155]
ds_read_b128 a[248:251],v2 offset:57600
v_mfma_f32_16x16x32_bf16 v[152:155],a[200:203],v[88:91],v[152:155]
v_exp_f32 v118,v118
v_mfma_f32_16x16x32_bf16 v[152:155],a[204:207],v[92:95],v[152:155]
v_mfma_f32_16x16x32_bf16 v[152:155],a[208:211],v[96:99],v[152:155]
ds_read_b128 a[252:255],v3 offset:57600
v_mfma_f32_16x16x32_bf16 v[152:155],a[212:215],v[100:103],v[152:155]
v_exp_f32 v119,v119
v_mfma_f32_16x16x32_bf16 v[152:155],a[216:219],v[104:107],v[152:155]
v_cvt_pk_bf16_f32 v171,v118,v119
v_mfma_f32_16x16x32_bf16 v[152:155],a[220:223],v[108:111],v[152:155]
s_waitcnt lgkmcnt(2)
v_mfma_f32_16x16x32_bf16 v[124:127],a[224:227],v[16:19],v[208:211]
v_exp_f32 v132,v132
v_mfma_f32_16x16x32_bf16 v[124:127],a[228:231],v[20:23],v[124:127]
v_mfma_f32_16x16x32_bf16 v[124:127],a[232:235],v[24:27],v[124:127]
s_waitcnt lgkmcnt(0)
s_waitcnt vmcnt(12)
s_barrier
v_mfma_f32_16x16x32_bf16 v[124:127],a[236:239],v[28:31],v[124:127]
ds_read_b64_tr_b16 a[192:193],v4 offset:0
ds_read_b64_tr_b16 a[194:195],v4 offset:8192
s_add_u32 m0,s25,32768
s_add_u32 s28,s26,131072
buffer_load_dwordx4 v12,s[4:7],s28 offen nt lds
buffer_load_dwordx4 v13,s[4:7],s28 offen offset:1024 nt lds
buffer_load_dwordx4 v14,s[4:7],s28 offen offset:2048 nt lds
buffer_load_dwordx4 v15,s[4:7],s28 offen offset:3072 nt lds
s_add_u32 m0,s25,49152
s_add_u32 s28,s26,147456
buffer_load_dwordx4 v12,s[4:7],s28 offen nt lds
buffer_load_dwordx4 v13,s[4:7],s28 offen offset:1024 nt lds
buffer_load_dwordx4 v14,s[4:7],s28 offen offset:2048 nt lds
buffer_load_dwordx4 v15,s[4:7],s28 offen offset:3072 nt lds
v_mfma_f32_16x16x32_bf16 v[124:127],a[240:243],v[32:35],v[124:127]
v_exp_f32 v133,v133
v_mfma_f32_16x16x32_bf16 v[124:127],a[244:247],v[36:39],v[124:127]
v_cvt_pk_bf16_f32 v186,v132,v133
s_waitcnt lgkmcnt(2)
v_mfma_f32_16x16x32_bf16 v[124:127],a[248:251],v[40:43],v[124:127]
ds_read_b64_tr_b16 a[196:197],v4 offset:16384
ds_read_b64_tr_b16 a[198:199],v4 offset:24576
v_mfma_f32_16x16x32_bf16 v[124:127],a[252:255],v[44:47],v[124:127]
v_mfma_f32_16x16x32_bf16 v[140:143],a[224:227],v[48:51],v[212:215]
v_mfma_f32_16x16x32_bf16 v[140:143],a[228:231],v[52:55],v[140:143]
ds_read_b64_tr_b16 a[200:201],v5 offset:0
ds_read_b64_tr_b16 a[202:203],v5 offset:8192
v_mfma_f32_16x16x32_bf16 v[140:143],a[232:235],v[56:59],v[140:143]
v_exp_f32 v134,v134
v_mfma_f32_16x16x32_bf16 v[140:143],a[236:239],v[60:63],v[140:143]
v_mfma_f32_16x16x32_bf16 v[140:143],a[240:243],v[64:67],v[140:143]
ds_read_b64_tr_b16 a[204:205],v5 offset:16384
ds_read_b64_tr_b16 a[206:207],v5 offset:24576
v_mfma_f32_16x16x32_bf16 v[140:143],a[244:247],v[68:71],v[140:143]
v_mfma_f32_16x16x32_bf16 v[140:143],a[248:251],v[72:75],v[140:143]
v_exp_f32 v135,v135
v_mfma_f32_16x16x32_bf16 v[140:143],a[252:255],v[76:79],v[140:143]
ds_read_b64_tr_b16 a[208:209],v6 offset:0
ds_read_b64_tr_b16 a[210:211],v6 offset:8192
v_mfma_f32_16x16x32_bf16 v[156:159],a[224:227],v[80:83],v[216:219]
v_cvt_pk_bf16_f32 v187,v134,v135
v_mfma_f32_16x16x32_bf16 v[156:159],a[228:231],v[84:87],v[156:159]
v_mfma_f32_16x16x32_bf16 v[156:159],a[232:235],v[88:91],v[156:159]
ds_read_b64_tr_b16 a[212:213],v6 offset:16384
ds_read_b64_tr_b16 a[214:215],v6 offset:24576
v_mfma_f32_16x16x32_bf16 v[156:159],a[236:239],v[92:95],v[156:159]
v_exp_f32 v148,v148
v_mfma_f32_16x16x32_bf16 v[156:159],a[240:243],v[96:99],v[156:159]
v_mfma_f32_16x16x32_bf16 v[156:159],a[244:247],v[100:103],v[156:159]
ds_read_b64_tr_b16 a[216:217],v7 offset:0
ds_read_b64_tr_b16 a[218:219],v7 offset:8192
v_mfma_f32_16x16x32_bf16 v[156:159],a[248:251],v[104:107],v[156:159]
v_mfma_f32_16x16x32_bf16 v[156:159],a[252:255],v[108:111],v[156:159]
v_exp_f32 v149,v149
v_mfma_f32_16x16x32_bf16 v[220:223],v[232:235],v[160:163],v[220:223]
ds_read_b64_tr_b16 a[220:221],v7 offset:16384
ds_read_b64_tr_b16 a[222:223],v7 offset:24576
v_mfma_f32_16x16x32_bf16 v[220:223],v[232:235],v[164:167],v[220:223]
v_cvt_pk_bf16_f32 v202,v148,v149
v_mfma_f32_16x16x32_bf16 v[224:227],v[232:235],v[176:179],v[224:227]
v_mfma_f32_16x16x32_bf16 v[224:227],v[232:235],v[180:183],v[224:227]
ds_read_b64_tr_b16 a[224:225],v8 offset:0
ds_read_b64_tr_b16 a[226:227],v8 offset:8192
v_mfma_f32_16x16x32_bf16 v[228:231],v[232:235],v[192:195],v[228:231]
v_exp_f32 v150,v150
v_mfma_f32_16x16x32_bf16 v[228:231],v[232:235],v[196:199],v[228:231]
s_waitcnt lgkmcnt(4)
v_mfma_f32_16x16x32_bf16 a[0:3],a[192:195],v[160:163],a[0:3]
ds_read_b64_tr_b16 a[228:229],v8 offset:16384
ds_read_b64_tr_b16 a[230:231],v8 offset:24576
v_mfma_f32_16x16x32_bf16 a[0:3],a[196:199],v[164:167],a[0:3]
v_mfma_f32_16x16x32_bf16 a[64:67],a[192:195],v[176:179],a[64:67]
v_exp_f32 v151,v151
v_mfma_f32_16x16x32_bf16 a[64:67],a[196:199],v[180:183],a[64:67]
ds_read_b64_tr_b16 a[232:233],v9 offset:0
ds_read_b64_tr_b16 a[234:235],v9 offset:8192
v_mfma_f32_16x16x32_bf16 a[128:131],a[192:195],v[192:195],a[128:131]
v_cvt_pk_bf16_f32 v203,v150,v151
v_mfma_f32_16x16x32_bf16 a[128:131],a[196:199],v[196:199],a[128:131]
v_mfma_f32_16x16x32_bf16 a[4:7],a[200:203],v[160:163],a[4:7]
ds_read_b64_tr_b16 a[236:237],v9 offset:16384
ds_read_b64_tr_b16 a[238:239],v9 offset:24576
v_mfma_f32_16x16x32_bf16 a[4:7],a[204:207],v[164:167],a[4:7]
v_exp_f32 v120,v120
v_mfma_f32_16x16x32_bf16 a[68:71],a[200:203],v[176:179],a[68:71]
v_mfma_f32_16x16x32_bf16 a[68:71],a[204:207],v[180:183],a[68:71]
ds_read_b64_tr_b16 a[240:241],v10 offset:0
ds_read_b64_tr_b16 a[242:243],v10 offset:8192
v_mfma_f32_16x16x32_bf16 a[132:135],a[200:203],v[192:195],a[132:135]
v_mfma_f32_16x16x32_bf16 a[132:135],a[204:207],v[196:199],a[132:135]
v_exp_f32 v121,v121
v_mfma_f32_16x16x32_bf16 a[8:11],a[208:211],v[160:163],a[8:11]
ds_read_b64_tr_b16 a[244:245],v10 offset:16384
ds_read_b64_tr_b16 a[246:247],v10 offset:24576
v_mfma_f32_16x16x32_bf16 a[8:11],a[212:215],v[164:167],a[8:11]
v_cvt_pk_bf16_f32 v172,v120,v121
v_mfma_f32_16x16x32_bf16 a[72:75],a[208:211],v[176:179],a[72:75]
v_mfma_f32_16x16x32_bf16 a[72:75],a[212:215],v[180:183],a[72:75]
ds_read_b64_tr_b16 a[248:249],v11 offset:0
ds_read_b64_tr_b16 a[250:251],v11 offset:8192
v_mfma_f32_16x16x32_bf16 a[136:139],a[208:211],v[192:195],a[136:139]
v_exp_f32 v122,v122
v_mfma_f32_16x16x32_bf16 a[136:139],a[212:215],v[196:199],a[136:139]
v_mfma_f32_16x16x32_bf16 a[12:15],a[216:219],v[160:163],a[12:15]
ds_read_b64_tr_b16 a[252:253],v11 offset:16384
ds_read_b64_tr_b16 a[254:255],v11 offset:24576
s_waitcnt lgkmcnt(6)
v_mfma_f32_16x16x32_bf16 a[12:15],a[220:223],v[164:167],a[12:15]
v_mfma_f32_16x16x32_bf16 a[76:79],a[216:219],v[176:179],a[76:79]
v_exp_f32 v123,v123
v_mfma_f32_16x16x32_bf16 a[76:79],a[220:223],v[180:183],a[76:79]
ds_read_b64_tr_b16 a[192:193],v4 offset:256
ds_read_b64_tr_b16 a[194:195],v4 offset:8448
v_mfma_f32_16x16x32_bf16 a[140:143],a[216:219],v[192:195],a[140:143]
v_cvt_pk_bf16_f32 v173,v122,v123
v_mfma_f32_16x16x32_bf16 a[140:143],a[220:223],v[196:199],a[140:143]
v_mfma_f32_16x16x32_bf16 a[16:19],a[224:227],v[160:163],a[16:19]
ds_read_b64_tr_b16 a[196:197],v4 offset:16640
ds_read_b64_tr_b16 a[198:199],v4 offset:24832
v_mfma_f32_16x16x32_bf16 a[16:19],a[228:231],v[164:167],a[16:19]
v_exp_f32 v136,v136
v_mfma_f32_16x16x32_bf16 a[80:83],a[224:227],v[176:179],a[80:83]
v_mfma_f32_16x16x32_bf16 a[80:83],a[228:231],v[180:183],a[80:83]
ds_read_b64_tr_b16 a[200:201],v5 offset:256
ds_read_b64_tr_b16 a[202:203],v5 offset:8448
v_mfma_f32_16x16x32_bf16 a[144:147],a[224:227],v[192:195],a[144:147]
v_mfma_f32_16x16x32_bf16 a[144:147],a[228:231],v[196:199],a[144:147]
v_exp_f32 v137,v137
v_mfma_f32_16x16x32_bf16 a[20:23],a[232:235],v[160:163],a[20:23]
ds_read_b64_tr_b16 a[204:205],v5 offset:16640
ds_read_b64_tr_b16 a[206:207],v5 offset:24832
v_mfma_f32_16x16x32_bf16 a[20:23],a[236:239],v[164:167],a[20:23]
v_cvt_pk_bf16_f32 v188,v136,v137
v_mfma_f32_16x16x32_bf16 a[84:87],a[232:235],v[176:179],a[84:87]
v_mfma_f32_16x16x32_bf16 a[84:87],a[236:239],v[180:183],a[84:87]
ds_read_b64_tr_b16 a[208:209],v6 offset:256
ds_read_b64_tr_b16 a[210:211],v6 offset:8448
v_mfma_f32_16x16x32_bf16 a[148:151],a[232:235],v[192:195],a[148:151]
v_exp_f32 v138,v138
v_mfma_f32_16x16x32_bf16 a[148:151],a[236:239],v[196:199],a[148:151]
v_mfma_f32_16x16x32_bf16 a[24:27],a[240:243],v[160:163],a[24:27]
ds_read_b64_tr_b16 a[212:213],v6 offset:16640
ds_read_b64_tr_b16 a[214:215],v6 offset:24832
s_waitcnt lgkmcnt(6)
v_mfma_f32_16x16x32_bf16 a[24:27],a[244:247],v[164:167],a[24:27]
v_mfma_f32_16x16x32_bf16 a[88:91],a[240:243],v[176:179],a[88:91]
v_exp_f32 v139,v139
v_mfma_f32_16x16x32_bf16 a[88:91],a[244:247],v[180:183],a[88:91]
ds_read_b64_tr_b16 a[216:217],v7 offset:256
ds_read_b64_tr_b16 a[218:219],v7 offset:8448
v_mfma_f32_16x16x32_bf16 a[152:155],a[240:243],v[192:195],a[152:155]
v_cvt_pk_bf16_f32 v189,v138,v139
v_mfma_f32_16x16x32_bf16 a[152:155],a[244:247],v[196:199],a[152:155]
v_mfma_f32_16x16x32_bf16 a[28:31],a[248:251],v[160:163],a[28:31]
ds_read_b64_tr_b16 a[220:221],v7 offset:16640
ds_read_b64_tr_b16 a[222:223],v7 offset:24832
v_mfma_f32_16x16x32_bf16 a[28:31],a[252:255],v[164:167],a[28:31]
v_exp_f32 v152,v152
v_mfma_f32_16x16x32_bf16 a[92:95],a[248:251],v[176:179],a[92:95]
v_mfma_f32_16x16x32_bf16 a[92:95],a[252:255],v[180:183],a[92:95]
ds_read_b64_tr_b16 a[224:225],v8 offset:256
ds_read_b64_tr_b16 a[226:227],v8 offset:8448
v_mfma_f32_16x16x32_bf16 a[156:159],a[248:251],v[192:195],a[156:159]
v_mfma_f32_16x16x32_bf16 a[156:159],a[252:255],v[196:199],a[156:159]
v_exp_f32 v153,v153
v_mfma_f32_16x16x32_bf16 a[32:35],a[192:195],v[160:163],a[32:35]
ds_read_b64_tr_b16 a[228:229],v8 offset:16640
ds_read_b64_tr_b16 a[230:231],v8 offset:24832
v_mfma_f32_16x16x32_bf16 a[32:35],a[196:199],v[164:167],a[32:35]
v_cvt_pk_bf16_f32 v204,v152,v153
v_mfma_f32_16x16x32_bf16 a[96:99],a[192:195],v[176:179],a[96:99]
v_mfma_f32_16x16x32_bf16 a[96:99],a[196:199],v[180:183],a[96:99]
ds_read_b64_tr_b16 a[232:233],v9 offset:256
ds_read_b64_tr_b16 a[234:235],v9 offset:8448
v_mfma_f32_16x16x32_bf16 a[160:163],a[192:195],v[192:195],a[160:163]
v_exp_f32 v154,v154
v_mfma_f32_16x16x32_bf16 a[160:163],a[196:199],v[196:199],a[160:163]
v_mfma_f32_16x16x32_bf16 a[36:39],a[200:203],v[160:163],a[36:39]
ds_read_b64_tr_b16 a[236:237],v9 offset:16640
ds_read_b64_tr_b16 a[238:239],v9 offset:24832
s_waitcnt lgkmcnt(6)
v_mfma_f32_16x16x32_bf16 a[36:39],a[204:207],v[164:167],a[36:39]
v_mfma_f32_16x16x32_bf16 a[100:103],a[200:203],v[176:179],a[100:103]
v_exp_f32 v155,v155
v_mfma_f32_16x16x32_bf16 a[100:103],a[204:207],v[180:183],a[100:103]
ds_read_b64_tr_b16 a[240:241],v10 offset:256
ds_read_b64_tr_b16 a[242:243],v10 offset:8448
v_mfma_f32_16x16x32_bf16 a[164:167],a[200:203],v[192:195],a[164:167]
v_cvt_pk_bf16_f32 v205,v154,v155
v_mfma_f32_16x16x32_bf16 a[164:167],a[204:207],v[196:199],a[164:167]
v_mfma_f32_16x16x32_bf16 a[40:43],a[208:211],v[160:163],a[40:43]
ds_read_b64_tr_b16 a[244:245],v10 offset:16640
ds_read_b64_tr_b16 a[246:247],v10 offset:24832
v_mfma_f32_16x16x32_bf16 a[40:43],a[212:215],v[164:167],a[40:43]
v_exp_f32 v124,v124
v_mfma_f32_16x16x32_bf16 a[104:107],a[208:211],v[176:179],a[104:107]
v_mfma_f32_16x16x32_bf16 a[104:107],a[212:215],v[180:183],a[104:107]
ds_read_b64_tr_b16 a[248:249],v11 offset:256
ds_read_b64_tr_b16 a[250:251],v11 offset:8448
v_mfma_f32_16x16x32_bf16 a[168:171],a[208:211],v[192:195],a[168:171]
v_mfma_f32_16x16x32_bf16 a[168:171],a[212:215],v[196:199],a[168:171]
v_exp_f32 v125,v125
v_mfma_f32_16x16x32_bf16 a[44:47],a[216:219],v[160:163],a[44:47]
ds_read_b64_tr_b16 a[252:253],v11 offset:16640
ds_read_b64_tr_b16 a[254:255],v11 offset:24832
v_mfma_f32_16x16x32_bf16 a[44:47],a[220:223],v[164:167],a[44:47]
v_cvt_pk_bf16_f32 v174,v124,v125
v_mfma_f32_16x16x32_bf16 a[108:111],a[216:219],v[176:179],a[108:111]
v_mfma_f32_16x16x32_bf16 a[108:111],a[220:223],v[180:183],a[108:111]
v_exp_f32 v126,v126
v_mfma_f32_16x16x32_bf16 a[172:175],a[216:219],v[192:195],a[172:175]
v_mfma_f32_16x16x32_bf16 a[172:175],a[220:223],v[196:199],a[172:175]
v_mfma_f32_16x16x32_bf16 a[48:51],a[224:227],v[160:163],a[48:51]
s_waitcnt lgkmcnt(0)
s_waitcnt vmcnt(12)
s_barrier
s_waitcnt lgkmcnt(2)
v_mfma_f32_16x16x32_bf16 a[48:51],a[228:231],v[164:167],a[48:51]
ds_read_b128 a[192:195],v0 offset:0
s_add_u32 m0,s25,65536
s_add_u32 s28,s26,98304
buffer_load_dwordx4 v12,s[8:11],s28 offen nt lds
buffer_load_dwordx4 v13,s[8:11],s28 offen offset:1024 nt lds
buffer_load_dwordx4 v14,s[8:11],s28 offen offset:2048 nt lds
buffer_load_dwordx4 v15,s[8:11],s28 offen offset:3072 nt lds
v_mfma_f32_16x16x32_bf16 a[112:115],a[224:227],v[176:179],a[112:115]
v_exp_f32 v127,v127
v_mfma_f32_16x16x32_bf16 a[112:115],a[228:231],v[180:183],a[112:115]
v_cvt_pk_bf16_f32 v175,v126,v127
v_mfma_f32_16x16x32_bf16 a[176:179],a[224:227],v[192:195],a[176:179]
ds_read_b128 a[196:199],v1 offset:0
v_mfma_f32_16x16x32_bf16 a[176:179],a[228:231],v[196:199],a[176:179]
v_mfma_f32_16x16x32_bf16 a[52:55],a[232:235],v[160:163],a[52:55]
v_exp_f32 v140,v140
v_mfma_f32_16x16x32_bf16 a[52:55],a[236:239],v[164:167],a[52:55]
ds_read_b128 a[200:203],v2 offset:0
v_mfma_f32_16x16x32_bf16 a[116:119],a[232:235],v[176:179],a[116:119]
v_mfma_f32_16x16x32_bf16 a[116:119],a[236:239],v[180:183],a[116:119]
v_exp_f32 v141,v141
v_mfma_f32_16x16x32_bf16 a[180:183],a[232:235],v[192:195],a[180:183]
ds_read_b128 a[204:207],v3 offset:0
v_cvt_pk_bf16_f32 v190,v140,v141
v_mfma_f32_16x16x32_bf16 a[180:183],a[236:239],v[196:199],a[180:183]
v_mfma_f32_16x16x32_bf16 a[56:59],a[240:243],v[160:163],a[56:59]
v_mfma_f32_16x16x32_bf16 a[56:59],a[244:247],v[164:167],a[56:59]
ds_read_b128 a[208:211],v0 offset:256
v_mfma_f32_16x16x32_bf16 a[120:123],a[240:243],v[176:179],a[120:123]
v_exp_f32 v142,v142
v_mfma_f32_16x16x32_bf16 a[120:123],a[244:247],v[180:183],a[120:123]
v_mfma_f32_16x16x32_bf16 a[184:187],a[240:243],v[192:195],a[184:187]
ds_read_b128 a[212:215],v1 offset:256
v_mfma_f32_16x16x32_bf16 a[184:187],a[244:247],v[196:199],a[184:187]
v_exp_f32 v143,v143
v_mfma_f32_16x16x32_bf16 a[60:63],a[248:251],v[160:163],a[60:63]
v_cvt_pk_bf16_f32 v191,v142,v143
s_waitcnt lgkmcnt(6)
v_mfma_f32_16x16x32_bf16 a[60:63],a[252:255],v[164:167],a[60:63]
ds_read_b128 a[216:219],v2 offset:256
v_mfma_f32_16x16x32_bf16 a[124:127],a[248:251],v[176:179],a[124:127]
v_mfma_f32_16x16x32_bf16 a[124:127],a[252:255],v[180:183],a[124:127]
v_mfma_f32_16x16x32_bf16 a[188:191],a[248:251],v[192:195],a[188:191]
ds_read_b128 a[220:223],v3 offset:256
v_mfma_f32_16x16x32_bf16 a[188:191],a[252:255],v[196:199],a[188:191]
s_add_u32 s26,s26,65536
s_cmp_lt_u32 s26,950272
s_cbranch_scc1 LOOP_A2
M29_A2:
s_waitcnt lgkmcnt(2)
v_mfma_f32_16x16x32_bf16 v[112:115],a[192:195],v[16:19],v[208:211]
ds_read_b128 a[224:227],v0 offset:8192
v_lshrrev_b32 v254,3,v253
v_mfma_f32_16x16x32_bf16 v[112:115],a[196:199],v[20:23],v[112:115]
v_and_b32 v255,7,v253
v_and_b32 v251,6,v254
v_mfma_f32_16x16x32_bf16 v[112:115],a[200:203],v[24:27],v[112:115]
v_xor_b32 v255,v255,v251
v_lshlrev_b32 v255,4,v255
v_mfma_f32_16x16x32_bf16 v[112:115],a[204:207],v[28:31],v[112:115]
ds_read_b128 a[228:231],v1 offset:8192
v_mul_u32_u24 v254,0x380,v254
v_mfma_f32_16x16x32_bf16 v[112:115],a[208:211],v[32:35],v[112:115]
v_add_u32 v236,v254,v255
v_add_u32 v237,6144,v236
v_mfma_f32_16x16x32_bf16 v[112:115],a[212:215],v[36:39],v[112:115]
v_add_u32 v238,12288,v236
s_waitcnt lgkmcnt(2)
v_mfma_f32_16x16x32_bf16 v[112:115],a[216:219],v[40:43],v[112:115]
ds_read_b128 a[232:235],v2 offset:8192
v_add_u32 v239,18432,v236
v_mfma_f32_16x16x32_bf16 v[112:115],a[220:223],v[44:47],v[112:115]
v_lshrrev_b32 v254,2,v253
v_and_b32 v255,3,v253
v_mfma_f32_16x16x32_bf16 v[128:131],a[192:195],v[48:51],v[212:215]
v_bfe_u32 v251,v253,3,2
v_lshlrev_b32 v254,7,v254
v_mfma_f32_16x16x32_bf16 v[128:131],a[196:199],v[52:55],v[128:131]
ds_read_b128 a[236:239],v3 offset:8192
v_lshl_add_u32 v254,v255,3,v254
v_mfma_f32_16x16x32_bf16 v[128:131],a[200:203],v[56:59],v[128:131]
v_xor_b32 v255,0,v251
v_lshl_add_u32 v244,v255,5,v254
v_mfma_f32_16x16x32_bf16 v[128:131],a[204:207],v[60:63],v[128:131]
v_add_u32 v240,81920,v244
v_xor_b32 v255,1,v251
v_mfma_f32_16x16x32_bf16 v[128:131],a[208:211],v[64:67],v[128:131]
ds_read_b128 a[240:243],v0 offset:8448
v_lshl_add_u32 v245,v255,5,v254
v_mfma_f32_16x16x32_bf16 v[128:131],a[212:215],v[68:71],v[128:131]
v_add_u32 v241,81920,v245
v_xor_b32 v255,2,v251
v_mfma_f32_16x16x32_bf16 v[128:131],a[216:219],v[72:75],v[128:131]
v_lshl_add_u32 v246,v255,5,v254
v_add_u32 v242,81920,v246
v_mfma_f32_16x16x32_bf16 v[128:131],a[220:223],v[76:79],v[128:131]
ds_read_b128 a[244:247],v1 offset:8448
v_xor_b32 v255,3,v251
v_mfma_f32_16x16x32_bf16 v[144:147],a[192:195],v[80:83],v[216:219]
v_lshl_add_u32 v247,v255,5,v254
v_add_u32 v243,81920,v247
v_mfma_f32_16x16x32_bf16 v[144:147],a[196:199],v[84:87],v[144:147]
v_lshlrev_b32 v248,4,v253
v_add_u32 v249,16384,v248
v_mfma_f32_16x16x32_bf16 v[144:147],a[200:203],v[88:91],v[144:147]
ds_read_b128 a[248:251],v2 offset:8448
s_mul_i32 s31,s24,5120
v_mfma_f32_16x16x32_bf16 v[144:147],a[204:207],v[92:95],v[144:147]
s_add_u32 s31,s31,65536
v_lshl_add_u32 v252,v253,3,s31
v_mfma_f32_16x16x32_bf16 v[144:147],a[208:211],v[96:99],v[144:147]
v_mov_b32 v251,v252
v_mfma_f32_16x16x32_bf16 v[144:147],a[212:215],v[100:103],v[144:147]
ds_read_b128 a[252:255],v3 offset:8448
v_mfma_f32_16x16x32_bf16 v[144:147],a[216:219],v[104:107],v[144:147]
v_exp_f32 v156,v156
v_mfma_f32_16x16x32_bf16 v[144:147],a[220:223],v[108:111],v[144:147]
s_waitcnt lgkmcnt(2)
v_mfma_f32_16x16x32_bf16 v[116:119],a[224:227],v[16:19],v[208:211]
ds_read_b128 a[192:195],v0 offset:16384
v_mfma_f32_16x16x32_bf16 v[116:119],a[228:231],v[20:23],v[116:119]
v_exp_f32 v157,v157
v_mfma_f32_16x16x32_bf16 v[116:119],a[232:235],v[24:27],v[116:119]
v_cvt_pk_bf16_f32 v206,v156,v157
v_mfma_f32_16x16x32_bf16 v[116:119],a[236:239],v[28:31],v[116:119]
ds_read_b128 a[196:199],v1 offset:16384
v_mfma_f32_16x16x32_bf16 v[116:119],a[240:243],v[32:35],v[116:119]
v_exp_f32 v158,v158
v_mfma_f32_16x16x32_bf16 v[116:119],a[244:247],v[36:39],v[116:119]
s_waitcnt lgkmcnt(2)
v_mfma_f32_16x16x32_bf16 v[116:119],a[248:251],v[40:43],v[116:119]
ds_read_b128 a[200:203],v2 offset:16384
v_mfma_f32_16x16x32_bf16 v[116:119],a[252:255],v[44:47],v[116:119]
v_exp_f32 v159,v159
v_mfma_f32_16x16x32_bf16 v[132:135],a[224:227],v[48:51],v[212:215]
v_cvt_pk_bf16_f32 v207,v158,v159
v_mfma_f32_16x16x32_bf16 v[132:135],a[228:231],v[52:55],v[132:135]
ds_read_b128 a[204:207],v3 offset:16384
v_mfma_f32_16x16x32_bf16 v[132:135],a[232:235],v[56:59],v[132:135]
v_exp_f32 v112,v112
v_mfma_f32_16x16x32_bf16 v[132:135],a[236:239],v[60:63],v[132:135]
v_exp_f32 v113,v113
v_mfma_f32_16x16x32_bf16 v[132:135],a[240:243],v[64:67],v[132:135]
ds_read_b128 a[208:211],v0 offset:16640
v_cvt_pk_bf16_f32 v160,v112,v113
v_mfma_f32_16x16x32_bf16 v[132:135],a[244:247],v[68:71],v[132:135]
v_exp_f32 v114,v114
v_mfma_f32_16x16x32_bf16 v[132:135],a[248:251],v[72:75],v[132:135]
v_mfma_f32_16x16x32_bf16 v[132:135],a[252:255],v[76:79],v[132:135]
ds_read_b128 a[212:215],v1 offset:16640
v_mfma_f32_16x16x32_bf16 v[148:151],a[224:227],v[80:83],v[216:219]
v_exp_f32 v115,v115
v_mfma_f32_16x16x32_bf16 v[148:151],a[228:231],v[84:87],v[148:151]
v_cvt_pk_bf16_f32 v161,v114,v115
v_mfma_f32_16x16x32_bf16 v[148:151],a[232:235],v[88:91],v[148:151]
ds_read_b128 a[216:219],v2 offset:16640
v_mfma_f32_16x16x32_bf16 v[148:151],a[236:239],v[92:95],v[148:151]
v_exp_f32 v128,v128
v_mfma_f32_16x16x32_bf16 v[148:151],a[240:243],v[96:99],v[148:151]
ds_read_b128 a[220:223],v3 offset:16640
v_mfma_f32_16x16x32_bf16 v[148:151],a[244:247],v[100:103],v[148:151]
v_exp_f32 v129,v129
v_mfma_f32_16x16x32_bf16 v[148:151],a[248:251],v[104:107],v[148:151]
v_cvt_pk_bf16_f32 v176,v128,v129
v_mfma_f32_16x16x32_bf16 v[148:151],a[252:255],v[108:111],v[148:151]
ds_read_b128 a[224:227],v0 offset:24576
s_waitcnt lgkmcnt(3)
v_mfma_f32_16x16x32_bf16 v[120:123],a[192:195],v[16:19],v[208:211]
v_exp_f32 v130,v130
v_mfma_f32_16x16x32_bf16 v[120:123],a[196:199],v[20:23],v[120:123]
v_mfma_f32_16x16x32_bf16 v[120:123],a[200:203],v[24:27],v[120:123]
ds_read_b128 a[228:231],v1 offset:24576
v_mfma_f32_16x16x32_bf16 v[120:123],a[204:207],v[28:31],v[120:123]
v_exp_f32 v131,v131
v_mfma_f32_16x16x32_bf16 v[120:123],a[208:211],v[32:35],v[120:123]
v_cvt_pk_bf16_f32 v177,v130,v131
v_mfma_f32_16x16x32_bf16 v[120:123],a[212:215],v[36:39],v[120:123]
ds_read_b128 a[232:235],v2 offset:24576
s_waitcnt lgkmcnt(3)
v_mfma_f32_16x16x32_bf16 v[120:123],a[216:219],v[40:43],v[120:123]
v_exp_f32 v144,v144
v_mfma_f32_16x16x32_bf16 v[120:123],a[220:223],v[44:47],v[120:123]
v_mfma_f32_16x16x32_bf16 v[136:139],a[192:195],v[48:51],v[212:215]
ds_read_b128 a[236:239],v3 offset:24576
v_mfma_f32_16x16x32_bf16 v[136:139],a[196:199],v[52:55],v[136:139]
v_exp_f32 v145,v145
v_mfma_f32_16x16x32_bf16 v[136:139],a[200:203],v[56:59],v[136:139]
v_cvt_pk_bf16_f32 v192,v144,v145
v_mfma_f32_16x16x32_bf16 v[136:139],a[204:207],v[60:63],v[136:139]
ds_read_b128 a[240:243],v0 offset:24832
v_mfma_f32_16x16x32_bf16 v[136:139],a[208:211],v[64:67],v[136:139]
v_exp_f32 v146,v146
v_mfma_f32_16x16x32_bf16 v[136:139],a[212:215],v[68:71],v[136:139]
v_exp_f32 v147,v147
v_mfma_f32_16x16x32_bf16 v[136:139],a[216:219],v[72:75],v[136:139]
ds_read_b128 a[244:247],v1 offset:24832
v_cvt_pk_bf16_f32 v193,v146,v147
v_mfma_f32_16x16x32_bf16 v[136:139],a[220:223],v[76:79],v[136:139]
v_mfma_f32_16x16x32_bf16 v[152:155],a[192:195],v[80:83],v[216:219]
v_exp_f32 v116,v116
v_mfma_f32_16x16x32_bf16 v[152:155],a[196:199],v[84:87],v[152:155]
ds_read_b128 a[248:251],v2 offset:24832
v_mfma_f32_16x16x32_bf16 v[152:155],a[200:203],v[88:91],v[152:155]
v_mfma_f32_16x16x32_bf16 v[152:155],a[204:207],v[92:95],v[152:155]
v_exp_f32 v117,v117
v_mfma_f32_16x16x32_bf16 v[152:155],a[208:211],v[96:99],v[152:155]
ds_read_b128 a[252:255],v3 offset:24832
v_cvt_pk_bf16_f32 v162,v116,v117
v_mfma_f32_16x16x32_bf16 v[152:155],a[212:215],v[100:103],v[152:155]
v_mfma_f32_16x16x32_bf16 v[152:155],a[216:219],v[104:107],v[152:155]
v_exp_f32 v118,v118
v_mfma_f32_16x16x32_bf16 v[152:155],a[220:223],v[108:111],v[152:155]
s_waitcnt lgkmcnt(2)
v_mfma_f32_16x16x32_bf16 v[124:127],a[224:227],v[16:19],v[208:211]
v_exp_f32 v132,v132
v_mfma_f32_16x16x32_bf16 v[124:127],a[228:231],v[20:23],v[124:127]
v_exp_f32 v119,v119
v_mfma_f32_16x16x32_bf16 v[124:127],a[232:235],v[24:27],v[124:127]
s_waitcnt lgkmcnt(0)
s_waitcnt vmcnt(12)
s_barrier
v_mfma_f32_16x16x32_bf16 v[124:127],a[236:239],v[28:31],v[124:127]
ds_read_b64_tr_b16 a[192:193],v4 offset:32768
ds_read_b64_tr_b16 a[194:195],v4 offset:40960
v_mfma_f32_16x16x32_bf16 v[124:127],a[240:243],v[32:35],v[124:127]
s_add_u32 m0,s25,131072
s_add_u32 s28,s67,0
v_mfma_f32_16x16x32_bf16 v[124:127],a[244:247],v[36:39],v[124:127]
v_cvt_pk_bf16_f32 v163,v118,v119
s_waitcnt lgkmcnt(2)
v_mfma_f32_16x16x32_bf16 v[124:127],a[248:251],v[40:43],v[124:127]
ds_read_b64_tr_b16 a[196:197],v4 offset:49152
ds_read_b64_tr_b16 a[198:199],v4 offset:57344
v_mfma_f32_16x16x32_bf16 v[124:127],a[252:255],v[44:47],v[124:127]
buffer_load_dwordx4 v236,s[96:99],s28 offen lds
v_mfma_f32_16x16x32_bf16 v[140:143],a[224:227],v[48:51],v[212:215]
buffer_load_dwordx4 v237,s[96:99],s28 offen offset:1024 lds
v_mfma_f32_16x16x32_bf16 v[140:143],a[228:231],v[52:55],v[140:143]
ds_read_b64_tr_b16 a[200:201],v5 offset:32768
ds_read_b64_tr_b16 a[202:203],v5 offset:40960
v_mfma_f32_16x16x32_bf16 v[140:143],a[232:235],v[56:59],v[140:143]
buffer_load_dwordx4 v238,s[96:99],s28 offen offset:2048 lds
v_mfma_f32_16x16x32_bf16 v[140:143],a[236:239],v[60:63],v[140:143]
buffer_load_dwordx4 v239,s[96:99],s28 offen offset:3072 lds
v_mfma_f32_16x16x32_bf16 v[140:143],a[240:243],v[64:67],v[140:143]
ds_read_b64_tr_b16 a[204:205],v5 offset:49152
ds_read_b64_tr_b16 a[206:207],v5 offset:57344
v_mfma_f32_16x16x32_bf16 v[140:143],a[244:247],v[68:71],v[140:143]
s_add_u32 m0,s25,0
s_add_u32 s28,s67,128
v_mfma_f32_16x16x32_bf16 v[140:143],a[248:251],v[72:75],v[140:143]
buffer_load_dwordx4 v236,s[96:99],s28 offen lds
v_mfma_f32_16x16x32_bf16 v[140:143],a[252:255],v[76:79],v[140:143]
ds_read_b64_tr_b16 a[208:209],v6 offset:32768
ds_read_b64_tr_b16 a[210:211],v6 offset:40960
v_mfma_f32_16x16x32_bf16 v[156:159],a[224:227],v[80:83],v[216:219]
buffer_load_dwordx4 v237,s[96:99],s28 offen offset:1024 lds
v_mfma_f32_16x16x32_bf16 v[156:159],a[228:231],v[84:87],v[156:159]
buffer_load_dwordx4 v238,s[96:99],s28 offen offset:2048 lds
v_mfma_f32_16x16x32_bf16 v[156:159],a[232:235],v[88:91],v[156:159]
ds_read_b64_tr_b16 a[212:213],v6 offset:49152
ds_read_b64_tr_b16 a[214:215],v6 offset:57344
v_mfma_f32_16x16x32_bf16 v[156:159],a[236:239],v[92:95],v[156:159]
buffer_load_dwordx4 v239,s[96:99],s28 offen offset:3072 lds
v_mfma_f32_16x16x32_bf16 v[156:159],a[240:243],v[96:99],v[156:159]
s_add_u32 m0,s25,16384
s_add_u32 s28,s67,114688
v_mfma_f32_16x16x32_bf16 v[156:159],a[244:247],v[100:103],v[156:159]
ds_read_b64_tr_b16 a[216:217],v7 offset:32768
ds_read_b64_tr_b16 a[218:219],v7 offset:40960
v_mfma_f32_16x16x32_bf16 v[156:159],a[248:251],v[104:107],v[156:159]
buffer_load_dwordx4 v236,s[96:99],s28 offen lds
v_mfma_f32_16x16x32_bf16 v[156:159],a[252:255],v[108:111],v[156:159]
buffer_load_dwordx4 v237,s[96:99],s28 offen offset:1024 lds
v_mfma_f32_16x16x32_bf16 v[220:223],v[232:235],v[168:171],v[220:223]
ds_read_b64_tr_b16 a[220:221],v7 offset:49152
ds_read_b64_tr_b16 a[222:223],v7 offset:57344
v_mfma_f32_16x16x32_bf16 v[220:223],v[232:235],v[172:175],v[220:223]
buffer_load_dwordx4 v238,s[96:99],s28 offen offset:2048 lds
v_mfma_f32_16x16x32_bf16 v[224:227],v[232:235],v[184:187],v[224:227]
buffer_load_dwordx4 v239,s[96:99],s28 offen offset:3072 lds
v_mfma_f32_16x16x32_bf16 v[224:227],v[232:235],v[188:191],v[224:227]
ds_read_b64_tr_b16 a[224:225],v8 offset:32768
ds_read_b64_tr_b16 a[226:227],v8 offset:40960
v_mfma_f32_16x16x32_bf16 v[228:231],v[232:235],v[200:203],v[228:231]
v_exp_f32 v133,v133
v_mfma_f32_16x16x32_bf16 v[228:231],v[232:235],v[204:207],v[228:231]
v_cvt_pk_bf16_f32 v178,v132,v133
s_waitcnt lgkmcnt(4)
v_mfma_f32_16x16x32_bf16 a[0:3],a[192:195],v[168:171],a[0:3]
ds_read_b64_tr_b16 a[228:229],v8 offset:49152
ds_read_b64_tr_b16 a[230:231],v8 offset:57344
v_mfma_f32_16x16x32_bf16 a[0:3],a[196:199],v[172:175],a[0:3]
v_exp_f32 v134,v134
v_mfma_f32_16x16x32_bf16 a[64:67],a[192:195],v[184:187],a[64:67]
v_exp_f32 v135,v135
v_mfma_f32_16x16x32_bf16 a[64:67],a[196:199],v[188:191],a[64:67]
ds_read_b64_tr_b16 a[232:233],v9 offset:32768
ds_read_b64_tr_b16 a[234:235],v9 offset:40960
v_mfma_f32_16x16x32_bf16 a[128:131],a[192:195],v[200:203],a[128:131]
v_cvt_pk_bf16_f32 v179,v134,v135
v_mfma_f32_16x16x32_bf16 a[128:131],a[196:199],v[204:207],a[128:131]
v_mfma_f32_16x16x32_bf16 a[4:7],a[200:203],v[168:171],a[4:7]
ds_read_b64_tr_b16 a[236:237],v9 offset:49152
ds_read_b64_tr_b16 a[238:239],v9 offset:57344
v_mfma_f32_16x16x32_bf16 a[4:7],a[204:207],v[172:175],a[4:7]
v_mfma_f32_16x16x32_bf16 a[68:71],a[200:203],v[184:187],a[68:71]
v_mfma_f32_16x16x32_bf16 a[68:71],a[204:207],v[188:191],a[68:71]
ds_read_b64_tr_b16 a[240:241],v10 offset:32768
ds_read_b64_tr_b16 a[242:243],v10 offset:40960
v_mfma_f32_16x16x32_bf16 a[132:135],a[200:203],v[200:203],a[132:135]
v_mfma_f32_16x16x32_bf16 a[132:135],a[204:207],v[204:207],a[132:135]
v_exp_f32 v148,v148
v_mfma_f32_16x16x32_bf16 a[8:11],a[208:211],v[168:171],a[8:11]
ds_read_b64_tr_b16 a[244:245],v10 offset:49152
ds_read_b64_tr_b16 a[246:247],v10 offset:57344
v_mfma_f32_16x16x32_bf16 a[8:11],a[212:215],v[172:175],a[8:11]
v_mfma_f32_16x16x32_bf16 a[72:75],a[208:211],v[184:187],a[72:75]
v_exp_f32 v149,v149
v_mfma_f32_16x16x32_bf16 a[72:75],a[212:215],v[188:191],a[72:75]
ds_read_b64_tr_b16 a[248:249],v11 offset:32768
ds_read_b64_tr_b16 a[250:251],v11 offset:40960
v_mfma_f32_16x16x32_bf16 a[136:139],a[208:211],v[200:203],a[136:139]
v_cvt_pk_bf16_f32 v194,v148,v149
v_mfma_f32_16x16x32_bf16 a[136:139],a[212:215],v[204:207],a[136:139]
v_mfma_f32_16x16x32_bf16 a[12:15],a[216:219],v[168:171],a[12:15]
ds_read_b64_tr_b16 a[252:253],v11 offset:49152
ds_read_b64_tr_b16 a[254:255],v11 offset:57344
s_waitcnt lgkmcnt(6)
v_mfma_f32_16x16x32_bf16 a[12:15],a[220:223],v[172:175],a[12:15]
v_exp_f32 v150,v150
v_mfma_f32_16x16x32_bf16 a[76:79],a[216:219],v[184:187],a[76:79]
v_mfma_f32_16x16x32_bf16 a[76:79],a[220:223],v[188:191],a[76:79]
ds_read_b64_tr_b16 a[192:193],v4 offset:33024
ds_read_b64_tr_b16 a[194:195],v4 offset:41216
v_mfma_f32_16x16x32_bf16 a[140:143],a[216:219],v[200:203],a[140:143]
v_exp_f32 v151,v151
v_mfma_f32_16x16x32_bf16 a[140:143],a[220:223],v[204:207],a[140:143]
v_cvt_pk_bf16_f32 v195,v150,v151
v_mfma_f32_16x16x32_bf16 a[16:19],a[224:227],v[168:171],a[16:19]
ds_read_b64_tr_b16 a[196:197],v4 offset:49408
ds_read_b64_tr_b16 a[198:199],v4 offset:57600
v_mfma_f32_16x16x32_bf16 a[16:19],a[228:231],v[172:175],a[16:19]
v_exp_f32 v120,v120
v_mfma_f32_16x16x32_bf16 a[80:83],a[224:227],v[184:187],a[80:83]
v_mfma_f32_16x16x32_bf16 a[80:83],a[228:231],v[188:191],a[80:83]
ds_read_b64_tr_b16 a[200:201],v5 offset:33024
ds_read_b64_tr_b16 a[202:203],v5 offset:41216
v_mfma_f32_16x16x32_bf16 a[144:147],a[224:227],v[200:203],a[144:147]
v_exp_f32 v121,v121
v_mfma_f32_16x16x32_bf16 a[144:147],a[228:231],v[204:207],a[144:147]
v_cvt_pk_bf16_f32 v164,v120,v121
v_mfma_f32_16x16x32_bf16 a[20:23],a[232:235],v[168:171],a[20:23]
ds_read_b64_tr_b16 a[204:205],v5 offset:49408
ds_read_b64_tr_b16 a[206:207],v5 offset:57600
v_mfma_f32_16x16x32_bf16 a[20:23],a[236:239],v[172:175],a[20:23]
v_exp_f32 v122,v122
v_mfma_f32_16x16x32_bf16 a[84:87],a[232:235],v[184:187],a[84:87]
v_mfma_f32_16x16x32_bf16 a[84:87],a[236:239],v[188:191],a[84:87]
ds_read_b64_tr_b16 a[208:209],v6 offset:33024
ds_read_b64_tr_b16 a[210:211],v6 offset:41216
v_mfma_f32_16x16x32_bf16 a[148:151],a[232:235],v[200:203],a[148:151]
v_exp_f32 v123,v123
v_mfma_f32_16x16x32_bf16 a[148:151],a[236:239],v[204:207],a[148:151]
v_cvt_pk_bf16_f32 v165,v122,v123
v_mfma_f32_16x16x32_bf16 a[24:27],a[240:243],v[168:171],a[24:27]
ds_read_b64_tr_b16 a[212:213],v6 offset:49408
ds_read_b64_tr_b16 a[214:215],v6 offset:57600
s_waitcnt lgkmcnt(6)
v_mfma_f32_16x16x32_bf16 a[24:27],a[244:247],v[172:175],a[24:27]
v_mfma_f32_16x16x32_bf16 a[88:91],a[240:243],v[184:187],a[88:91]
v_exp_f32 v136,v136
v_mfma_f32_16x16x32_bf16 a[88:91],a[244:247],v[188:191],a[88:91]
ds_read_b64_tr_b16 a[216:217],v7 offset:33024
ds_read_b64_tr_b16 a[218:219],v7 offset:41216
v_mfma_f32_16x16x32_bf16 a[152:155],a[240:243],v[200:203],a[152:155]
v_mfma_f32_16x16x32_bf16 a[152:155],a[244:247],v[204:207],a[152:155]
v_exp_f32 v137,v137
v_mfma_f32_16x16x32_bf16 a[28:31],a[248:251],v[168:171],a[28:31]
ds_read_b64_tr_b16 a[220:221],v7 offset:49408
ds_read_b64_tr_b16 a[222:223],v7 offset:57600
v_mfma_f32_16x16x32_bf16 a[28:31],a[252:255],v[172:175],a[28:31]
v_cvt_pk_bf16_f32 v180,v136,v137
v_mfma_f32_16x16x32_bf16 a[92:95],a[248:251],v[184:187],a[92:95]
v_mfma_f32_16x16x32_bf16 a[92:95],a[252:255],v[188:191],a[92:95]
ds_read_b64_tr_b16 a[224:225],v8 offset:33024
ds_read_b64_tr_b16 a[226:227],v8 offset:41216
v_mfma_f32_16x16x32_bf16 a[156:159],a[248:251],v[200:203],a[156:159]
v_exp_f32 v138,v138
v_mfma_f32_16x16x32_bf16 a[156:159],a[252:255],v[204:207],a[156:159]
v_mfma_f32_16x16x32_bf16 a[32:35],a[192:195],v[168:171],a[32:35]
ds_read_b64_tr_b16 a[228:229],v8 offset:49408
ds_read_b64_tr_b16 a[230:231],v8 offset:57600
v_mfma_f32_16x16x32_bf16 a[32:35],a[196:199],v[172:175],a[32:35]
v_exp_f32 v139,v139
v_mfma_f32_16x16x32_bf16 a[96:99],a[192:195],v[184:187],a[96:99]
v_cvt_pk_bf16_f32 v181,v138,v139
v_mfma_f32_16x16x32_bf16 a[96:99],a[196:199],v[188:191],a[96:99]
ds_read_b64_tr_b16 a[232:233],v9 offset:33024
ds_read_b64_tr_b16 a[234:235],v9 offset:41216
v_mfma_f32_16x16x32_bf16 a[160:163],a[192:195],v[200:203],a[160:163]
v_exp_f32 v152,v152
v_mfma_f32_16x16x32_bf16 a[160:163],a[196:199],v[204:207],a[160:163]
v_mfma_f32_16x16x32_bf16 a[36:39],a[200:203],v[168:171],a[36:39]
ds_read_b64_tr_b16 a[236:237],v9 offset:49408
ds_read_b64_tr_b16 a[238:239],v9 offset:57600
s_waitcnt lgkmcnt(6)
v_mfma_f32_16x16x32_bf16 a[36:39],a[204:207],v[172:175],a[36:39]
v_exp_f32 v153,v153
v_mfma_f32_16x16x32_bf16 a[100:103],a[200:203],v[184:187],a[100:103]
v_cvt_pk_bf16_f32 v196,v152,v153
v_mfma_f32_16x16x32_bf16 a[100:103],a[204:207],v[188:191],a[100:103]
ds_read_b64_tr_b16 a[240:241],v10 offset:33024
ds_read_b64_tr_b16 a[242:243],v10 offset:41216
v_mfma_f32_16x16x32_bf16 a[164:167],a[200:203],v[200:203],a[164:167]
v_exp_f32 v154,v154
v_mfma_f32_16x16x32_bf16 a[164:167],a[204:207],v[204:207],a[164:167]
v_mfma_f32_16x16x32_bf16 a[40:43],a[208:211],v[168:171],a[40:43]
ds_read_b64_tr_b16 a[244:245],v10 offset:49408
ds_read_b64_tr_b16 a[246:247],v10 offset:57600
v_mfma_f32_16x16x32_bf16 a[40:43],a[212:215],v[172:175],a[40:43]
v_exp_f32 v155,v155
v_mfma_f32_16x16x32_bf16 a[104:107],a[208:211],v[184:187],a[104:107]
v_cvt_pk_bf16_f32 v197,v154,v155
v_mfma_f32_16x16x32_bf16 a[104:107],a[212:215],v[188:191],a[104:107]
ds_read_b64_tr_b16 a[248:249],v11 offset:33024
ds_read_b64_tr_b16 a[250:251],v11 offset:41216
v_mfma_f32_16x16x32_bf16 a[168:171],a[208:211],v[200:203],a[168:171]
v_mfma_f32_16x16x32_bf16 a[168:171],a[212:215],v[204:207],a[168:171]
v_exp_f32 v124,v124
v_mfma_f32_16x16x32_bf16 a[44:47],a[216:219],v[168:171],a[44:47]
ds_read_b64_tr_b16 a[252:253],v11 offset:49408
ds_read_b64_tr_b16 a[254:255],v11 offset:57600
v_mfma_f32_16x16x32_bf16 a[44:47],a[220:223],v[172:175],a[44:47]
v_mfma_f32_16x16x32_bf16 a[108:111],a[216:219],v[184:187],a[108:111]
v_mfma_f32_16x16x32_bf16 a[108:111],a[220:223],v[188:191],a[108:111]
v_exp_f32 v125,v125
v_mfma_f32_16x16x32_bf16 a[172:175],a[216:219],v[200:203],a[172:175]
v_cvt_pk_bf16_f32 v166,v124,v125
v_mfma_f32_16x16x32_bf16 a[172:175],a[220:223],v[204:207],a[172:175]
v_exp_f32 v126,v126
v_mfma_f32_16x16x32_bf16 a[48:51],a[224:227],v[168:171],a[48:51]
s_waitcnt lgkmcnt(0)
s_waitcnt vmcnt(16)
s_barrier
s_waitcnt lgkmcnt(2)
v_mfma_f32_16x16x32_bf16 a[48:51],a[228:231],v[172:175],a[48:51]
ds_read_b128 a[192:195],v0 offset:32768
s_add_u32 m0,s25,98304
v_mfma_f32_16x16x32_bf16 a[112:115],a[224:227],v[184:187],a[112:115]
s_add_u32 s28,s25,1015808
v_mfma_f32_16x16x32_bf16 a[112:115],a[228:231],v[188:191],a[112:115]
buffer_load_dwordx4 v12,s[8:11],s28 offen nt lds
v_mfma_f32_16x16x32_bf16 a[176:179],a[224:227],v[200:203],a[176:179]
ds_read_b128 a[196:199],v1 offset:32768
v_mfma_f32_16x16x32_bf16 a[176:179],a[228:231],v[204:207],a[176:179]
buffer_load_dwordx4 v13,s[8:11],s28 offen offset:1024 nt lds
v_mfma_f32_16x16x32_bf16 a[52:55],a[232:235],v[168:171],a[52:55]
buffer_load_dwordx4 v14,s[8:11],s28 offen offset:2048 nt lds
v_mfma_f32_16x16x32_bf16 a[52:55],a[236:239],v[172:175],a[52:55]
ds_read_b128 a[200:203],v2 offset:32768
v_mfma_f32_16x16x32_bf16 a[116:119],a[232:235],v[184:187],a[116:119]
buffer_load_dwordx4 v15,s[8:11],s28 offen offset:3072 nt lds
v_mfma_f32_16x16x32_bf16 a[116:119],a[236:239],v[188:191],a[116:119]
v_exp_f32 v127,v127
v_mfma_f32_16x16x32_bf16 a[180:183],a[232:235],v[200:203],a[180:183]
ds_read_b128 a[204:207],v3 offset:32768
v_cvt_pk_bf16_f32 v167,v126,v127
v_mfma_f32_16x16x32_bf16 a[180:183],a[236:239],v[204:207],a[180:183]
v_exp_f32 v140,v140
v_mfma_f32_16x16x32_bf16 a[56:59],a[240:243],v[168:171],a[56:59]
v_mfma_f32_16x16x32_bf16 a[56:59],a[244:247],v[172:175],a[56:59]
ds_read_b128 a[208:211],v0 offset:33024
v_mfma_f32_16x16x32_bf16 a[120:123],a[240:243],v[184:187],a[120:123]
v_exp_f32 v141,v141
v_mfma_f32_16x16x32_bf16 a[120:123],a[244:247],v[188:191],a[120:123]
v_cvt_pk_bf16_f32 v182,v140,v141
v_mfma_f32_16x16x32_bf16 a[184:187],a[240:243],v[200:203],a[184:187]
ds_read_b128 a[212:215],v1 offset:33024
v_mfma_f32_16x16x32_bf16 a[184:187],a[244:247],v[204:207],a[184:187]
v_exp_f32 v142,v142
v_mfma_f32_16x16x32_bf16 a[60:63],a[248:251],v[168:171],a[60:63]
s_waitcnt lgkmcnt(6)
v_mfma_f32_16x16x32_bf16 a[60:63],a[252:255],v[172:175],a[60:63]
ds_read_b128 a[216:219],v2 offset:33024
v_mfma_f32_16x16x32_bf16 a[124:127],a[248:251],v[184:187],a[124:127]
v_exp_f32 v143,v143
v_mfma_f32_16x16x32_bf16 a[124:127],a[252:255],v[188:191],a[124:127]
v_cvt_pk_bf16_f32 v183,v142,v143
v_mfma_f32_16x16x32_bf16 a[188:191],a[248:251],v[200:203],a[188:191]
ds_read_b128 a[220:223],v3 offset:33024
v_mfma_f32_16x16x32_bf16 a[188:191],a[252:255],v[204:207],a[188:191]
s_waitcnt lgkmcnt(2)
v_mfma_f32_16x16x32_bf16 v[112:115],a[192:195],v[16:19],v[208:211]
ds_read_b128 a[224:227],v0 offset:40960
v_mfma_f32_16x16x32_bf16 v[112:115],a[196:199],v[20:23],v[112:115]
v_exp_f32 v156,v156
v_mfma_f32_16x16x32_bf16 v[112:115],a[200:203],v[24:27],v[112:115]
v_mfma_f32_16x16x32_bf16 v[112:115],a[204:207],v[28:31],v[112:115]
ds_read_b128 a[228:231],v1 offset:40960
v_mfma_f32_16x16x32_bf16 v[112:115],a[208:211],v[32:35],v[112:115]
v_exp_f32 v157,v157
v_mfma_f32_16x16x32_bf16 v[112:115],a[212:215],v[36:39],v[112:115]
v_cvt_pk_bf16_f32 v198,v156,v157
s_waitcnt lgkmcnt(2)
v_mfma_f32_16x16x32_bf16 v[112:115],a[216:219],v[40:43],v[112:115]
ds_read_b128 a[232:235],v2 offset:40960
v_mfma_f32_16x16x32_bf16 v[112:115],a[220:223],v[44:47],v[112:115]
v_exp_f32 v158,v158
v_mfma_f32_16x16x32_bf16 v[128:131],a[192:195],v[48:51],v[212:215]
v_mfma_f32_16x16x32_bf16 v[128:131],a[196:199],v[52:55],v[128:131]
ds_read_b128 a[236:239],v3 offset:40960
v_mfma_f32_16x16x32_bf16 v[128:131],a[200:203],v[56:59],v[128:131]
v_exp_f32 v159,v159
v_mfma_f32_16x16x32_bf16 v[128:131],a[204:207],v[60:63],v[128:131]
v_cvt_pk_bf16_f32 v199,v158,v159
v_mfma_f32_16x16x32_bf16 v[128:131],a[208:211],v[64:67],v[128:131]
ds_read_b128 a[240:243],v0 offset:41216
v_mfma_f32_16x16x32_bf16 v[128:131],a[212:215],v[68:71],v[128:131]
v_mfma_f32_16x16x32_bf16 v[128:131],a[216:219],v[72:75],v[128:131]
v_exp_f32 v112,v112
v_mfma_f32_16x16x32_bf16 v[128:131],a[220:223],v[76:79],v[128:131]
ds_read_b128 a[244:247],v1 offset:41216
v_mfma_f32_16x16x32_bf16 v[144:147],a[192:195],v[80:83],v[216:219]
v_exp_f32 v113,v113
v_mfma_f32_16x16x32_bf16 v[144:147],a[196:199],v[84:87],v[144:147]
v_cvt_pk_bf16_f32 v168,v112,v113
v_mfma_f32_16x16x32_bf16 v[144:147],a[200:203],v[88:91],v[144:147]
ds_read_b128 a[248:251],v2 offset:41216
v_mfma_f32_16x16x32_bf16 v[144:147],a[204:207],v[92:95],v[144:147]
v_exp_f32 v114,v114
v_mfma_f32_16x16x32_bf16 v[144:147],a[208:211],v[96:99],v[144:147]
v_mfma_f32_16x16x32_bf16 v[144:147],a[212:215],v[100:103],v[144:147]
ds_read_b128 a[252:255],v3 offset:41216
v_mfma_f32_16x16x32_bf16 v[144:147],a[216:219],v[104:107],v[144:147]
v_exp_f32 v115,v115
v_mfma_f32_16x16x32_bf16 v[144:147],a[220:223],v[108:111],v[144:147]
v_cvt_pk_bf16_f32 v169,v114,v115
s_waitcnt lgkmcnt(2)
v_mfma_f32_16x16x32_bf16 v[116:119],a[224:227],v[16:19],v[208:211]
ds_read_b128 a[192:195],v0 offset:49152
v_mfma_f32_16x16x32_bf16 v[116:119],a[228:231],v[20:23],v[116:119]
v_exp_f32 v128,v128
v_mfma_f32_16x16x32_bf16 v[116:119],a[232:235],v[24:27],v[116:119]
v_mfma_f32_16x16x32_bf16 v[116:119],a[236:239],v[28:31],v[116:119]
ds_read_b128 a[196:199],v1 offset:49152
v_mfma_f32_16x16x32_bf16 v[116:119],a[240:243],v[32:35],v[116:119]
v_exp_f32 v129,v129
v_mfma_f32_16x16x32_bf16 v[116:119],a[244:247],v[36:39],v[116:119]
v_cvt_pk_bf16_f32 v184,v128,v129
s_waitcnt lgkmcnt(2)
v_mfma_f32_16x16x32_bf16 v[116:119],a[248:251],v[40:43],v[116:119]
ds_read_b128 a[200:203],v2 offset:49152
v_mfma_f32_16x16x32_bf16 v[116:119],a[252:255],v[44:47],v[116:119]
v_exp_f32 v130,v130
v_mfma_f32_16x16x32_bf16 v[132:135],a[224:227],v[48:51],v[212:215]
v_mfma_f32_16x16x32_bf16 v[132:135],a[228:231],v[52:55],v[132:135]
ds_read_b128 a[204:207],v3 offset:49152
v_mfma_f32_16x16x32_bf16 v[132:135],a[232:235],v[56:59],v[132:135]
v_exp_f32 v131,v131
v_mfma_f32_16x16x32_bf16 v[132:135],a[236:239],v[60:63],v[132:135]
v_cvt_pk_bf16_f32 v185,v130,v131
v_mfma_f32_16x16x32_bf16 v[132:135],a[240:243],v[64:67],v[132:135]
ds_read_b128 a[208:211],v0 offset:49408
v_mfma_f32_16x16x32_bf16 v[132:135],a[244:247],v[68:71],v[132:135]
v_exp_f32 v144,v144
v_mfma_f32_16x16x32_bf16 v[132:135],a[248:251],v[72:75],v[132:135]
v_mfma_f32_16x16x32_bf16 v[132:135],a[252:255],v[76:79],v[132:135]
ds_read_b128 a[212:215],v1 offset:49408
v_mfma_f32_16x16x32_bf16 v[148:151],a[224:227],v[80:83],v[216:219]
v_exp_f32 v145,v145
v_mfma_f32_16x16x32_bf16 v[148:151],a[228:231],v[84:87],v[148:151]
v_cvt_pk_bf16_f32 v200,v144,v145
v_mfma_f32_16x16x32_bf16 v[148:151],a[232:235],v[88:91],v[148:151]
ds_read_b128 a[216:219],v2 offset:49408
v_mfma_f32_16x16x32_bf16 v[148:151],a[236:239],v[92:95],v[148:151]
v_exp_f32 v146,v146
v_mfma_f32_16x16x32_bf16 v[148:151],a[240:243],v[96:99],v[148:151]
ds_read_b128 a[220:223],v3 offset:49408
v_mfma_f32_16x16x32_bf16 v[148:151],a[244:247],v[100:103],v[148:151]
v_exp_f32 v147,v147
v_mfma_f32_16x16x32_bf16 v[148:151],a[248:251],v[104:107],v[148:151]
v_cvt_pk_bf16_f32 v201,v146,v147
v_mfma_f32_16x16x32_bf16 v[148:151],a[252:255],v[108:111],v[148:151]
ds_read_b128 a[224:227],v0 offset:57344
s_waitcnt lgkmcnt(3)
v_mfma_f32_16x16x32_bf16 v[120:123],a[192:195],v[16:19],v[208:211]
v_exp_f32 v116,v116
v_mfma_f32_16x16x32_bf16 v[120:123],a[196:199],v[20:23],v[120:123]
v_mfma_f32_16x16x32_bf16 v[120:123],a[200:203],v[24:27],v[120:123]
ds_read_b128 a[228:231],v1 offset:57344
v_mfma_f32_16x16x32_bf16 v[120:123],a[204:207],v[28:31],v[120:123]
v_exp_f32 v117,v117
v_mfma_f32_16x16x32_bf16 v[120:123],a[208:211],v[32:35],v[120:123]
v_cvt_pk_bf16_f32 v170,v116,v117
v_mfma_f32_16x16x32_bf16 v[120:123],a[212:215],v[36:39],v[120:123]
ds_read_b128 a[232:235],v2 offset:57344
s_waitcnt lgkmcnt(3)
v_mfma_f32_16x16x32_bf16 v[120:123],a[216:219],v[40:43],v[120:123]
v_exp_f32 v118,v118
v_mfma_f32_16x16x32_bf16 v[120:123],a[220:223],v[44:47],v[120:123]
v_mfma_f32_16x16x32_bf16 v[136:139],a[192:195],v[48:51],v[212:215]
ds_read_b128 a[236:239],v3 offset:57344
v_mfma_f32_16x16x32_bf16 v[136:139],a[196:199],v[52:55],v[136:139]
v_exp_f32 v119,v119
v_mfma_f32_16x16x32_bf16 v[136:139],a[200:203],v[56:59],v[136:139]
v_cvt_pk_bf16_f32 v171,v118,v119
v_mfma_f32_16x16x32_bf16 v[136:139],a[204:207],v[60:63],v[136:139]
ds_read_b128 a[240:243],v0 offset:57600
v_mfma_f32_16x16x32_bf16 v[136:139],a[208:211],v[64:67],v[136:139]
v_exp_f32 v132,v132
v_mfma_f32_16x16x32_bf16 v[136:139],a[212:215],v[68:71],v[136:139]
v_mfma_f32_16x16x32_bf16 v[136:139],a[216:219],v[72:75],v[136:139]
ds_read_b128 a[244:247],v1 offset:57600
v_mfma_f32_16x16x32_bf16 v[136:139],a[220:223],v[76:79],v[136:139]
v_exp_f32 v133,v133
v_mfma_f32_16x16x32_bf16 v[152:155],a[192:195],v[80:83],v[216:219]
v_cvt_pk_bf16_f32 v186,v132,v133
v_mfma_f32_16x16x32_bf16 v[152:155],a[196:199],v[84:87],v[152:155]
ds_read_b128 a[248:251],v2 offset:57600
v_mfma_f32_16x16x32_bf16 v[152:155],a[200:203],v[88:91],v[152:155]
v_exp_f32 v134,v134
v_mfma_f32_16x16x32_bf16 v[152:155],a[204:207],v[92:95],v[152:155]
v_mfma_f32_16x16x32_bf16 v[152:155],a[208:211],v[96:99],v[152:155]
ds_read_b128 a[252:255],v3 offset:57600
v_mfma_f32_16x16x32_bf16 v[152:155],a[212:215],v[100:103],v[152:155]
v_exp_f32 v135,v135
v_mfma_f32_16x16x32_bf16 v[152:155],a[216:219],v[104:107],v[152:155]
v_cvt_pk_bf16_f32 v187,v134,v135
v_mfma_f32_16x16x32_bf16 v[152:155],a[220:223],v[108:111],v[152:155]
s_waitcnt lgkmcnt(2)
v_mfma_f32_16x16x32_bf16 v[124:127],a[224:227],v[16:19],v[208:211]
v_exp_f32 v148,v148
v_mfma_f32_16x16x32_bf16 v[124:127],a[228:231],v[20:23],v[124:127]
v_exp_f32 v149,v149
v_mfma_f32_16x16x32_bf16 v[124:127],a[232:235],v[24:27],v[124:127]
s_waitcnt lgkmcnt(0)
s_waitcnt vmcnt(16)
s_barrier
v_mfma_f32_16x16x32_bf16 v[124:127],a[236:239],v[28:31],v[124:127]
ds_read_b64_tr_b16 a[192:193],v4 offset:0
ds_read_b64_tr_b16 a[194:195],v4 offset:8192
v_mfma_f32_16x16x32_bf16 v[124:127],a[240:243],v[32:35],v[124:127]
s_add_u32 m0,s25,32768
s_add_u32 s28,s67,114816
v_mfma_f32_16x16x32_bf16 v[124:127],a[244:247],v[36:39],v[124:127]
v_cvt_pk_bf16_f32 v202,v148,v149
s_waitcnt lgkmcnt(2)
v_mfma_f32_16x16x32_bf16 v[124:127],a[248:251],v[40:43],v[124:127]
ds_read_b64_tr_b16 a[196:197],v4 offset:16384
ds_read_b64_tr_b16 a[198:199],v4 offset:24576
v_mfma_f32_16x16x32_bf16 v[124:127],a[252:255],v[44:47],v[124:127]
buffer_load_dwordx4 v236,s[96:99],s28 offen lds
v_mfma_f32_16x16x32_bf16 v[140:143],a[224:227],v[48:51],v[212:215]
buffer_load_dwordx4 v237,s[96:99],s28 offen offset:1024 lds
v_mfma_f32_16x16x32_bf16 v[140:143],a[228:231],v[52:55],v[140:143]
ds_read_b64_tr_b16 a[200:201],v5 offset:0
ds_read_b64_tr_b16 a[202:203],v5 offset:8192
v_mfma_f32_16x16x32_bf16 v[140:143],a[232:235],v[56:59],v[140:143]
buffer_load_dwordx4 v238,s[96:99],s28 offen offset:2048 lds
v_mfma_f32_16x16x32_bf16 v[140:143],a[236:239],v[60:63],v[140:143]
buffer_load_dwordx4 v239,s[96:99],s28 offen offset:3072 lds
v_mfma_f32_16x16x32_bf16 v[140:143],a[240:243],v[64:67],v[140:143]
ds_read_b64_tr_b16 a[204:205],v5 offset:16384
ds_read_b64_tr_b16 a[206:207],v5 offset:24576
v_mfma_f32_16x16x32_bf16 v[140:143],a[244:247],v[68:71],v[140:143]
s_add_u32 m0,s25,49152
s_add_u32 s28,s67,256
v_mfma_f32_16x16x32_bf16 v[140:143],a[248:251],v[72:75],v[140:143]
buffer_load_dwordx4 v236,s[96:99],s28 offen lds
v_mfma_f32_16x16x32_bf16 v[140:143],a[252:255],v[76:79],v[140:143]
ds_read_b64_tr_b16 a[208:209],v6 offset:0
ds_read_b64_tr_b16 a[210:211],v6 offset:8192
v_mfma_f32_16x16x32_bf16 v[156:159],a[224:227],v[80:83],v[216:219]
buffer_load_dwordx4 v237,s[96:99],s28 offen offset:1024 lds
v_mfma_f32_16x16x32_bf16 v[156:159],a[228:231],v[84:87],v[156:159]
buffer_load_dwordx4 v238,s[96:99],s28 offen offset:2048 lds
v_mfma_f32_16x16x32_bf16 v[156:159],a[232:235],v[88:91],v[156:159]
ds_read_b64_tr_b16 a[212:213],v6 offset:16384
ds_read_b64_tr_b16 a[214:215],v6 offset:24576
v_mfma_f32_16x16x32_bf16 v[156:159],a[236:239],v[92:95],v[156:159]
buffer_load_dwordx4 v239,s[96:99],s28 offen offset:3072 lds
v_mfma_f32_16x16x32_bf16 v[156:159],a[240:243],v[96:99],v[156:159]
v_exp_f32 v150,v150
v_mfma_f32_16x16x32_bf16 v[156:159],a[244:247],v[100:103],v[156:159]
ds_read_b64_tr_b16 a[216:217],v7 offset:0
ds_read_b64_tr_b16 a[218:219],v7 offset:8192
v_mfma_f32_16x16x32_bf16 v[156:159],a[248:251],v[104:107],v[156:159]
v_mfma_f32_16x16x32_bf16 v[156:159],a[252:255],v[108:111],v[156:159]
v_exp_f32 v151,v151
v_mfma_f32_16x16x32_bf16 v[220:223],v[232:235],v[160:163],v[220:223]
ds_read_b64_tr_b16 a[220:221],v7 offset:16384
ds_read_b64_tr_b16 a[222:223],v7 offset:24576
v_mfma_f32_16x16x32_bf16 v[220:223],v[232:235],v[164:167],v[220:223]
v_cvt_pk_bf16_f32 v203,v150,v151
v_mfma_f32_16x16x32_bf16 v[224:227],v[232:235],v[176:179],v[224:227]
v_mfma_f32_16x16x32_bf16 v[224:227],v[232:235],v[180:183],v[224:227]
ds_read_b64_tr_b16 a[224:225],v8 offset:0
ds_read_b64_tr_b16 a[226:227],v8 offset:8192
v_mfma_f32_16x16x32_bf16 v[228:231],v[232:235],v[192:195],v[228:231]
v_mfma_f32_16x16x32_bf16 v[228:231],v[232:235],v[196:199],v[228:231]
s_waitcnt lgkmcnt(4)
v_mfma_f32_16x16x32_bf16 a[0:3],a[192:195],v[160:163],a[0:3]
ds_read_b64_tr_b16 a[228:229],v8 offset:16384
ds_read_b64_tr_b16 a[230:231],v8 offset:24576
v_mfma_f32_16x16x32_bf16 a[0:3],a[196:199],v[164:167],a[0:3]
v_exp_f32 v120,v120
v_mfma_f32_16x16x32_bf16 a[64:67],a[192:195],v[176:179],a[64:67]
v_mfma_f32_16x16x32_bf16 a[64:67],a[196:199],v[180:183],a[64:67]
ds_read_b64_tr_b16 a[232:233],v9 offset:0
ds_read_b64_tr_b16 a[234:235],v9 offset:8192
v_mfma_f32_16x16x32_bf16 a[128:131],a[192:195],v[192:195],a[128:131]
v_exp_f32 v121,v121
v_mfma_f32_16x16x32_bf16 a[128:131],a[196:199],v[196:199],a[128:131]
v_cvt_pk_bf16_f32 v172,v120,v121
v_mfma_f32_16x16x32_bf16 a[4:7],a[200:203],v[160:163],a[4:7]
ds_read_b64_tr_b16 a[236:237],v9 offset:16384
ds_read_b64_tr_b16 a[238:239],v9 offset:24576
v_mfma_f32_16x16x32_bf16 a[4:7],a[204:207],v[164:167],a[4:7]
v_exp_f32 v122,v122
v_mfma_f32_16x16x32_bf16 a[68:71],a[200:203],v[176:179],a[68:71]
v_mfma_f32_16x16x32_bf16 a[68:71],a[204:207],v[180:183],a[68:71]
ds_read_b64_tr_b16 a[240:241],v10 offset:0
ds_read_b64_tr_b16 a[242:243],v10 offset:8192
v_mfma_f32_16x16x32_bf16 a[132:135],a[200:203],v[192:195],a[132:135]
v_exp_f32 v123,v123
v_mfma_f32_16x16x32_bf16 a[132:135],a[204:207],v[196:199],a[132:135]
v_cvt_pk_bf16_f32 v173,v122,v123
v_mfma_f32_16x16x32_bf16 a[8:11],a[208:211],v[160:163],a[8:11]
ds_read_b64_tr_b16 a[244:245],v10 offset:16384
ds_read_b64_tr_b16 a[246:247],v10 offset:24576
v_mfma_f32_16x16x32_bf16 a[8:11],a[212:215],v[164:167],a[8:11]
v_mfma_f32_16x16x32_bf16 a[72:75],a[208:211],v[176:179],a[72:75]
v_exp_f32 v136,v136
v_mfma_f32_16x16x32_bf16 a[72:75],a[212:215],v[180:183],a[72:75]
ds_read_b64_tr_b16 a[248:249],v11 offset:0
ds_read_b64_tr_b16 a[250:251],v11 offset:8192
v_mfma_f32_16x16x32_bf16 a[136:139],a[208:211],v[192:195],a[136:139]
v_mfma_f32_16x16x32_bf16 a[136:139],a[212:215],v[196:199],a[136:139]
v_exp_f32 v137,v137
v_mfma_f32_16x16x32_bf16 a[12:15],a[216:219],v[160:163],a[12:15]
ds_read_b64_tr_b16 a[252:253],v11 offset:16384
ds_read_b64_tr_b16 a[254:255],v11 offset:24576
s_waitcnt lgkmcnt(6)
v_mfma_f32_16x16x32_bf16 a[12:15],a[220:223],v[164:167],a[12:15]
v_cvt_pk_bf16_f32 v188,v136,v137
v_mfma_f32_16x16x32_bf16 a[76:79],a[216:219],v[176:179],a[76:79]
v_mfma_f32_16x16x32_bf16 a[76:79],a[220:223],v[180:183],a[76:79]
ds_read_b64_tr_b16 a[192:193],v4 offset:256
ds_read_b64_tr_b16 a[194:195],v4 offset:8448
v_mfma_f32_16x16x32_bf16 a[140:143],a[216:219],v[192:195],a[140:143]
v_exp_f32 v138,v138
v_mfma_f32_16x16x32_bf16 a[140:143],a[220:223],v[196:199],a[140:143]
v_mfma_f32_16x16x32_bf16 a[16:19],a[224:227],v[160:163],a[16:19]
ds_read_b64_tr_b16 a[196:197],v4 offset:16640
ds_read_b64_tr_b16 a[198:199],v4 offset:24832
v_mfma_f32_16x16x32_bf16 a[16:19],a[228:231],v[164:167],a[16:19]
v_exp_f32 v139,v139
v_mfma_f32_16x16x32_bf16 a[80:83],a[224:227],v[176:179],a[80:83]
v_cvt_pk_bf16_f32 v189,v138,v139
v_mfma_f32_16x16x32_bf16 a[80:83],a[228:231],v[180:183],a[80:83]
ds_read_b64_tr_b16 a[200:201],v5 offset:256
ds_read_b64_tr_b16 a[202:203],v5 offset:8448
v_mfma_f32_16x16x32_bf16 a[144:147],a[224:227],v[192:195],a[144:147]
v_exp_f32 v152,v152
v_mfma_f32_16x16x32_bf16 a[144:147],a[228:231],v[196:199],a[144:147]
v_mfma_f32_16x16x32_bf16 a[20:23],a[232:235],v[160:163],a[20:23]
ds_read_b64_tr_b16 a[204:205],v5 offset:16640
ds_read_b64_tr_b16 a[206:207],v5 offset:24832
v_mfma_f32_16x16x32_bf16 a[20:23],a[236:239],v[164:167],a[20:23]
v_exp_f32 v153,v153
v_mfma_f32_16x16x32_bf16 a[84:87],a[232:235],v[176:179],a[84:87]
v_cvt_pk_bf16_f32 v204,v152,v153
v_mfma_f32_16x16x32_bf16 a[84:87],a[236:239],v[180:183],a[84:87]
ds_read_b64_tr_b16 a[208:209],v6 offset:256
ds_read_b64_tr_b16 a[210:211],v6 offset:8448
v_mfma_f32_16x16x32_bf16 a[148:151],a[232:235],v[192:195],a[148:151]
v_exp_f32 v154,v154
v_mfma_f32_16x16x32_bf16 a[148:151],a[236:239],v[196:199],a[148:151]
v_mfma_f32_16x16x32_bf16 a[24:27],a[240:243],v[160:163],a[24:27]
ds_read_b64_tr_b16 a[212:213],v6 offset:16640
ds_read_b64_tr_b16 a[214:215],v6 offset:24832
s_waitcnt lgkmcnt(6)
v_mfma_f32_16x16x32_bf16 a[24:27],a[244:247],v[164:167],a[24:27]
v_exp_f32 v155,v155
v_mfma_f32_16x16x32_bf16 a[88:91],a[240:243],v[176:179],a[88:91]
v_cvt_pk_bf16_f32 v205,v154,v155
v_mfma_f32_16x16x32_bf16 a[88:91],a[244:247],v[180:183],a[88:91]
ds_read_b64_tr_b16 a[216:217],v7 offset:256
ds_read_b64_tr_b16 a[218:219],v7 offset:8448
v_mfma_f32_16x16x32_bf16 a[152:155],a[240:243],v[192:195],a[152:155]
v_mfma_f32_16x16x32_bf16 a[152:155],a[244:247],v[196:199],a[152:155]
v_exp_f32 v124,v124
v_mfma_f32_16x16x32_bf16 a[28:31],a[248:251],v[160:163],a[28:31]
ds_read_b64_tr_b16 a[220:221],v7 offset:16640
ds_read_b64_tr_b16 a[222:223],v7 offset:24832
v_mfma_f32_16x16x32_bf16 a[28:31],a[252:255],v[164:167],a[28:31]
v_mfma_f32_16x16x32_bf16 a[92:95],a[248:251],v[176:179],a[92:95]
v_exp_f32 v125,v125
v_mfma_f32_16x16x32_bf16 a[92:95],a[252:255],v[180:183],a[92:95]
ds_read_b64_tr_b16 a[224:225],v8 offset:256
ds_read_b64_tr_b16 a[226:227],v8 offset:8448
v_mfma_f32_16x16x32_bf16 a[156:159],a[248:251],v[192:195],a[156:159]
v_cvt_pk_bf16_f32 v174,v124,v125
v_mfma_f32_16x16x32_bf16 a[156:159],a[252:255],v[196:199],a[156:159]
v_mfma_f32_16x16x32_bf16 a[32:35],a[192:195],v[160:163],a[32:35]
ds_read_b64_tr_b16 a[228:229],v8 offset:16640
ds_read_b64_tr_b16 a[230:231],v8 offset:24832
v_mfma_f32_16x16x32_bf16 a[32:35],a[196:199],v[164:167],a[32:35]
v_exp_f32 v126,v126
v_mfma_f32_16x16x32_bf16 a[96:99],a[192:195],v[176:179],a[96:99]
v_mfma_f32_16x16x32_bf16 a[96:99],a[196:199],v[180:183],a[96:99]
ds_read_b64_tr_b16 a[232:233],v9 offset:256
ds_read_b64_tr_b16 a[234:235],v9 offset:8448
v_mfma_f32_16x16x32_bf16 a[160:163],a[192:195],v[192:195],a[160:163]
v_exp_f32 v127,v127
v_mfma_f32_16x16x32_bf16 a[160:163],a[196:199],v[196:199],a[160:163]
v_cvt_pk_bf16_f32 v175,v126,v127
v_mfma_f32_16x16x32_bf16 a[36:39],a[200:203],v[160:163],a[36:39]
ds_read_b64_tr_b16 a[236:237],v9 offset:16640
ds_read_b64_tr_b16 a[238:239],v9 offset:24832
s_waitcnt lgkmcnt(6)
v_mfma_f32_16x16x32_bf16 a[36:39],a[204:207],v[164:167],a[36:39]
v_mfma_f32_16x16x32_bf16 a[100:103],a[200:203],v[176:179],a[100:103]
v_exp_f32 v140,v140
v_mfma_f32_16x16x32_bf16 a[100:103],a[204:207],v[180:183],a[100:103]
ds_read_b64_tr_b16 a[240:241],v10 offset:256
ds_read_b64_tr_b16 a[242:243],v10 offset:8448
v_mfma_f32_16x16x32_bf16 a[164:167],a[200:203],v[192:195],a[164:167]
v_mfma_f32_16x16x32_bf16 a[164:167],a[204:207],v[196:199],a[164:167]
v_exp_f32 v141,v141
v_mfma_f32_16x16x32_bf16 a[40:43],a[208:211],v[160:163],a[40:43]
ds_read_b64_tr_b16 a[244:245],v10 offset:16640
ds_read_b64_tr_b16 a[246:247],v10 offset:24832
v_mfma_f32_16x16x32_bf16 a[40:43],a[212:215],v[164:167],a[40:43]
v_cvt_pk_bf16_f32 v190,v140,v141
v_mfma_f32_16x16x32_bf16 a[104:107],a[208:211],v[176:179],a[104:107]
v_mfma_f32_16x16x32_bf16 a[104:107],a[212:215],v[180:183],a[104:107]
ds_read_b64_tr_b16 a[248:249],v11 offset:256
ds_read_b64_tr_b16 a[250:251],v11 offset:8448
v_mfma_f32_16x16x32_bf16 a[168:171],a[208:211],v[192:195],a[168:171]
v_exp_f32 v142,v142
v_mfma_f32_16x16x32_bf16 a[168:171],a[212:215],v[196:199],a[168:171]
v_mfma_f32_16x16x32_bf16 a[44:47],a[216:219],v[160:163],a[44:47]
ds_read_b64_tr_b16 a[252:253],v11 offset:16640
ds_read_b64_tr_b16 a[254:255],v11 offset:24832
v_mfma_f32_16x16x32_bf16 a[44:47],a[220:223],v[164:167],a[44:47]
v_exp_f32 v143,v143
v_mfma_f32_16x16x32_bf16 a[108:111],a[216:219],v[176:179],a[108:111]
v_cvt_pk_bf16_f32 v191,v142,v143
v_mfma_f32_16x16x32_bf16 a[108:111],a[220:223],v[180:183],a[108:111]
v_mfma_f32_16x16x32_bf16 a[172:175],a[216:219],v[192:195],a[172:175]
v_exp_f32 v156,v156
v_mfma_f32_16x16x32_bf16 a[172:175],a[220:223],v[196:199],a[172:175]
v_exp_f32 v157,v157
v_mfma_f32_16x16x32_bf16 a[48:51],a[224:227],v[160:163],a[48:51]
s_waitcnt lgkmcnt(0)
s_waitcnt vmcnt(8)
s_barrier
s_waitcnt lgkmcnt(2)
v_mfma_f32_16x16x32_bf16 a[48:51],a[228:231],v[164:167],a[48:51]
ds_read_b64_tr_b16 a[192:193],v4 offset:32768
ds_read_b64_tr_b16 a[194:195],v4 offset:40960
v_mfma_f32_16x16x32_bf16 a[112:115],a[224:227],v[176:179],a[112:115]
s_add_u32 m0,s25,81920
s_add_u32 s28,s67,114944
v_mfma_f32_16x16x32_bf16 a[112:115],a[228:231],v[180:183],a[112:115]
buffer_load_dwordx4 v236,s[96:99],s28 offen lds
v_mfma_f32_16x16x32_bf16 a[176:179],a[224:227],v[192:195],a[176:179]
ds_read_b64_tr_b16 a[196:197],v4 offset:49152
ds_read_b64_tr_b16 a[198:199],v4 offset:57344
v_mfma_f32_16x16x32_bf16 a[176:179],a[228:231],v[196:199],a[176:179]
buffer_load_dwordx4 v237,s[96:99],s28 offen offset:1024 lds
v_mfma_f32_16x16x32_bf16 a[52:55],a[232:235],v[160:163],a[52:55]
buffer_load_dwordx4 v238,s[96:99],s28 offen offset:2048 lds
v_mfma_f32_16x16x32_bf16 a[52:55],a[236:239],v[164:167],a[52:55]
ds_read_b64_tr_b16 a[200:201],v5 offset:32768
ds_read_b64_tr_b16 a[202:203],v5 offset:40960
v_mfma_f32_16x16x32_bf16 a[116:119],a[232:235],v[176:179],a[116:119]
buffer_load_dwordx4 v239,s[96:99],s28 offen offset:3072 lds
v_mfma_f32_16x16x32_bf16 a[116:119],a[236:239],v[180:183],a[116:119]
v_cvt_pk_bf16_f32 v206,v156,v157
v_mfma_f32_16x16x32_bf16 a[180:183],a[232:235],v[192:195],a[180:183]
ds_read_b64_tr_b16 a[204:205],v5 offset:49152
ds_read_b64_tr_b16 a[206:207],v5 offset:57344
v_mfma_f32_16x16x32_bf16 a[180:183],a[236:239],v[196:199],a[180:183]
v_exp_f32 v158,v158
v_mfma_f32_16x16x32_bf16 a[56:59],a[240:243],v[160:163],a[56:59]
v_mfma_f32_16x16x32_bf16 a[56:59],a[244:247],v[164:167],a[56:59]
ds_read_b64_tr_b16 a[208:209],v6 offset:32768
ds_read_b64_tr_b16 a[210:211],v6 offset:40960
v_mfma_f32_16x16x32_bf16 a[120:123],a[240:243],v[176:179],a[120:123]
v_mfma_f32_16x16x32_bf16 a[120:123],a[244:247],v[180:183],a[120:123]
v_exp_f32 v159,v159
v_mfma_f32_16x16x32_bf16 a[184:187],a[240:243],v[192:195],a[184:187]
ds_read_b64_tr_b16 a[212:213],v6 offset:49152
ds_read_b64_tr_b16 a[214:215],v6 offset:57344
v_mfma_f32_16x16x32_bf16 a[184:187],a[244:247],v[196:199],a[184:187]
v_cvt_pk_bf16_f32 v207,v158,v159
v_mfma_f32_16x16x32_bf16 a[60:63],a[248:251],v[160:163],a[60:63]
s_waitcnt lgkmcnt(12)
v_mfma_f32_16x16x32_bf16 a[60:63],a[252:255],v[164:167],a[60:63]
ds_read_b64_tr_b16 a[216:217],v7 offset:32768
ds_read_b64_tr_b16 a[218:219],v7 offset:40960
v_mfma_f32_16x16x32_bf16 a[124:127],a[248:251],v[176:179],a[124:127]
v_mfma_f32_16x16x32_bf16 a[124:127],a[252:255],v[180:183],a[124:127]
v_mfma_f32_16x16x32_bf16 a[188:191],a[248:251],v[192:195],a[188:191]
ds_read_b64_tr_b16 a[220:221],v7 offset:49152
ds_read_b64_tr_b16 a[222:223],v7 offset:57344
v_mfma_f32_16x16x32_bf16 a[188:191],a[252:255],v[196:199],a[188:191]
v_mfma_f32_16x16x32_bf16 v[220:223],v[232:235],v[168:171],v[220:223]
v_mfma_f32_16x16x32_bf16 v[220:223],v[232:235],v[172:175],v[220:223]
ds_read_b64_tr_b16 a[224:225],v8 offset:32768
ds_read_b64_tr_b16 a[226:227],v8 offset:40960
v_mfma_f32_16x16x32_bf16 v[224:227],v[232:235],v[184:187],v[224:227]
v_mfma_f32_16x16x32_bf16 v[224:227],v[232:235],v[188:191],v[224:227]
v_mfma_f32_16x16x32_bf16 v[228:231],v[232:235],v[200:203],v[228:231]
ds_read_b64_tr_b16 a[228:229],v8 offset:49152
ds_read_b64_tr_b16 a[230:231],v8 offset:57344
v_mfma_f32_16x16x32_bf16 v[228:231],v[232:235],v[204:207],v[228:231]
s_waitcnt lgkmcnt(4)
v_mfma_f32_16x16x32_bf16 a[0:3],a[192:195],v[168:171],a[0:3]
v_mfma_f32_16x16x32_bf16 a[0:3],a[196:199],v[172:175],a[0:3]
ds_read_b64_tr_b16 a[232:233],v9 offset:32768
ds_read_b64_tr_b16 a[234:235],v9 offset:40960
v_mfma_f32_16x16x32_bf16 a[64:67],a[192:195],v[184:187],a[64:67]
v_mfma_f32_16x16x32_bf16 a[64:67],a[196:199],v[188:191],a[64:67]
s_mov_b32 s28,0x4e800000
s_mov_b32 s66,0
v_cmp_ngt_f32 vcc,s28,v220
s_cmp_lg_u64 vcc,0
v_mfma_f32_16x16x32_bf16 a[128:131],a[192:195],v[200:203],a[128:131]
ds_read_b64_tr_b16 a[236:237],v9 offset:49152
ds_read_b64_tr_b16 a[238:239],v9 offset:57344
s_cselect_b32 s66,1,s66
v_cmp_ngt_f32 vcc,s28,v224
v_mfma_f32_16x16x32_bf16 a[128:131],a[196:199],v[204:207],a[128:131]
s_cmp_lg_u64 vcc,0
s_cselect_b32 s66,1,s66
v_cmp_ngt_f32 vcc,s28,v228
s_cmp_lg_u64 vcc,0
v_mfma_f32_16x16x32_bf16 a[4:7],a[200:203],v[168:171],a[4:7]
s_cselect_b32 s66,1,s66
s_lshl_b32 s28,s24,2
s_add_u32 s28,s28,155648
v_mov_b32 v221,s28
v_mfma_f32_16x16x32_bf16 a[4:7],a[204:207],v[172:175],a[4:7]
ds_read_b64_tr_b16 a[240:241],v10 offset:32768
ds_read_b64_tr_b16 a[242:243],v10 offset:40960
v_mov_b32 v222,s66
v_mov_b32 v223,155648
v_mfma_f32_16x16x32_bf16 a[68:71],a[200:203],v[184:187],a[68:71]
ds_write_b32 v221,v222
v_rcp_f32 v220,v220
v_mfma_f32_16x16x32_bf16 a[68:71],a[204:207],v[188:191],a[68:71]
v_rcp_f32 v224,v224
v_rcp_f32 v228,v228
v_mfma_f32_16x16x32_bf16 a[132:135],a[200:203],v[200:203],a[132:135]
ds_read_b64_tr_b16 a[244:245],v10 offset:49152
ds_read_b64_tr_b16 a[246:247],v10 offset:57344
v_lshrrev_b32 v226,2,v248
v_and_b32 v226,60,v226
v_mfma_f32_16x16x32_bf16 a[132:135],a[204:207],v[204:207],a[132:135]
buffer_store_dword v220,v226,s[20:23],s68 offen offset:0
buffer_store_dword v224,v226,s[20:23],s68 offen offset:64
buffer_store_dword v228,v226,s[20:23],s68 offen offset:128
v_accvgpr_read_b32 v208,a0
v_mfma_f32_16x16x32_bf16 a[8:11],a[208:211],v[168:171],a[8:11]
v_accvgpr_read_b32 v209,a1
v_accvgpr_read_b32 v210,a2
v_accvgpr_read_b32 v211,a3
v_cvt_pk_bf16_f32 v112,v208,v209
v_mfma_f32_16x16x32_bf16 a[8:11],a[212:215],v[172:175],a[8:11]
ds_read_b64_tr_b16 a[248:249],v11 offset:32768
ds_read_b64_tr_b16 a[250:251],v11 offset:40960
v_cvt_pk_bf16_f32 v113,v210,v211
v_accvgpr_read_b32 v212,a64
v_mfma_f32_16x16x32_bf16 a[72:75],a[208:211],v[184:187],a[72:75]
v_accvgpr_read_b32 v213,a65
v_accvgpr_read_b32 v214,a66
v_accvgpr_read_b32 v215,a67
v_cvt_pk_bf16_f32 v128,v212,v213
v_mfma_f32_16x16x32_bf16 a[72:75],a[212:215],v[188:191],a[72:75]
v_cvt_pk_bf16_f32 v129,v214,v215
v_accvgpr_read_b32 v208,a128
v_accvgpr_read_b32 v209,a129
v_accvgpr_read_b32 v210,a130
v_mfma_f32_16x16x32_bf16 a[136:139],a[208:211],v[200:203],a[136:139]
ds_read_b64_tr_b16 a[252:253],v11 offset:49152
ds_read_b64_tr_b16 a[254:255],v11 offset:57344
v_accvgpr_read_b32 v211,a131
v_cvt_pk_bf16_f32 v144,v208,v209
v_mfma_f32_16x16x32_bf16 a[136:139],a[212:215],v[204:207],a[136:139]
v_cvt_pk_bf16_f32 v145,v210,v211
v_accvgpr_read_b32 v212,a4
v_accvgpr_read_b32 v213,a5
v_accvgpr_read_b32 v214,a6
v_mfma_f32_16x16x32_bf16 a[12:15],a[216:219],v[168:171],a[12:15]
v_accvgpr_read_b32 v215,a7
v_cvt_pk_bf16_f32 v114,v212,v213
v_cvt_pk_bf16_f32 v115,v214,v215
v_accvgpr_read_b32 v208,a68
v_mfma_f32_16x16x32_bf16 a[12:15],a[220:223],v[172:175],a[12:15]
ds_read_b64_tr_b16 a[192:193],v4 offset:33024
ds_read_b64_tr_b16 a[194:195],v4 offset:41216
v_accvgpr_read_b32 v209,a69
v_accvgpr_read_b32 v210,a70
v_mfma_f32_16x16x32_bf16 a[76:79],a[216:219],v[184:187],a[76:79]
v_accvgpr_read_b32 v211,a71
v_cvt_pk_bf16_f32 v130,v208,v209
v_cvt_pk_bf16_f32 v131,v210,v211
v_accvgpr_read_b32 v212,a132
v_mfma_f32_16x16x32_bf16 a[76:79],a[220:223],v[188:191],a[76:79]
v_accvgpr_read_b32 v213,a133
v_accvgpr_read_b32 v214,a134
v_accvgpr_read_b32 v215,a135
v_cvt_pk_bf16_f32 v146,v212,v213
v_mfma_f32_16x16x32_bf16 a[140:143],a[216:219],v[200:203],a[140:143]
ds_read_b64_tr_b16 a[196:197],v4 offset:49408
ds_read_b64_tr_b16 a[198:199],v4 offset:57600
v_cvt_pk_bf16_f32 v147,v214,v215
v_accvgpr_read_b32 v208,a8
v_mfma_f32_16x16x32_bf16 a[140:143],a[220:223],v[204:207],a[140:143]
v_accvgpr_read_b32 v209,a9
v_accvgpr_read_b32 v210,a10
v_accvgpr_read_b32 v211,a11
s_waitcnt lgkmcnt(4)
v_mfma_f32_16x16x32_bf16 a[16:19],a[224:227],v[168:171],a[16:19]
v_cvt_pk_bf16_f32 v116,v208,v209
v_cvt_pk_bf16_f32 v117,v210,v211
v_accvgpr_read_b32 v212,a72
v_accvgpr_read_b32 v213,a73
v_mfma_f32_16x16x32_bf16 a[16:19],a[228:231],v[172:175],a[16:19]
v_accvgpr_read_b32 v214,a74
v_accvgpr_read_b32 v215,a75
v_cvt_pk_bf16_f32 v132,v212,v213
v_cvt_pk_bf16_f32 v133,v214,v215
v_mfma_f32_16x16x32_bf16 a[80:83],a[224:227],v[184:187],a[80:83]
ds_read_b64_tr_b16 a[200:201],v5 offset:33024
ds_read_b64_tr_b16 a[202:203],v5 offset:41216
v_accvgpr_read_b32 v208,a136
v_accvgpr_read_b32 v209,a137
v_mfma_f32_16x16x32_bf16 a[80:83],a[228:231],v[188:191],a[80:83]
v_accvgpr_read_b32 v210,a138
v_accvgpr_read_b32 v211,a139
v_cvt_pk_bf16_f32 v148,v208,v209
v_cvt_pk_bf16_f32 v149,v210,v211
v_mfma_f32_16x16x32_bf16 a[144:147],a[224:227],v[200:203],a[144:147]
v_accvgpr_read_b32 v212,a12
v_accvgpr_read_b32 v213,a13
v_accvgpr_read_b32 v214,a14
v_accvgpr_read_b32 v215,a15
v_mfma_f32_16x16x32_bf16 a[144:147],a[228:231],v[204:207],a[144:147]
ds_read_b64_tr_b16 a[204:205],v5 offset:49408
ds_read_b64_tr_b16 a[206:207],v5 offset:57600
v_cvt_pk_bf16_f32 v118,v212,v213
v_cvt_pk_bf16_f32 v119,v214,v215
v_mfma_f32_16x16x32_bf16 a[20:23],a[232:235],v[168:171],a[20:23]
v_accvgpr_read_b32 v208,a76
v_accvgpr_read_b32 v209,a77
v_accvgpr_read_b32 v210,a78
v_accvgpr_read_b32 v211,a79
v_mfma_f32_16x16x32_bf16 a[20:23],a[236:239],v[172:175],a[20:23]
v_cvt_pk_bf16_f32 v134,v208,v209
v_cvt_pk_bf16_f32 v135,v210,v211
v_accvgpr_read_b32 v212,a140
v_accvgpr_read_b32 v213,a141
v_mfma_f32_16x16x32_bf16 a[84:87],a[232:235],v[184:187],a[84:87]
ds_read_b64_tr_b16 a[208:209],v6 offset:33024
ds_read_b64_tr_b16 a[210:211],v6 offset:41216
v_accvgpr_read_b32 v214,a142
v_accvgpr_read_b32 v215,a143
v_mfma_f32_16x16x32_bf16 a[84:87],a[236:239],v[188:191],a[84:87]
v_cvt_pk_bf16_f32 v150,v212,v213
v_cvt_pk_bf16_f32 v151,v214,v215
v_accvgpr_read_b32 v208,a16
v_accvgpr_read_b32 v209,a17
v_mfma_f32_16x16x32_bf16 a[148:151],a[232:235],v[200:203],a[148:151]
v_accvgpr_read_b32 v210,a18
v_accvgpr_read_b32 v211,a19
v_cvt_pk_bf16_f32 v120,v208,v209
v_cvt_pk_bf16_f32 v121,v210,v211
v_mfma_f32_16x16x32_bf16 a[148:151],a[236:239],v[204:207],a[148:151]
ds_read_b64_tr_b16 a[212:213],v6 offset:49408
ds_read_b64_tr_b16 a[214:215],v6 offset:57600
v_accvgpr_read_b32 v212,a80
v_accvgpr_read_b32 v213,a81
v_mfma_f32_16x16x32_bf16 a[24:27],a[240:243],v[168:171],a[24:27]
v_accvgpr_read_b32 v214,a82
v_accvgpr_read_b32 v215,a83
v_cvt_pk_bf16_f32 v136,v212,v213
v_cvt_pk_bf16_f32 v137,v214,v215
v_mfma_f32_16x16x32_bf16 a[24:27],a[244:247],v[172:175],a[24:27]
v_accvgpr_read_b32 v208,a144
v_accvgpr_read_b32 v209,a145
v_accvgpr_read_b32 v210,a146
v_accvgpr_read_b32 v211,a147
v_mfma_f32_16x16x32_bf16 a[88:91],a[240:243],v[184:187],a[88:91]
ds_read_b64_tr_b16 a[216:217],v7 offset:33024
ds_read_b64_tr_b16 a[218:219],v7 offset:41216
v_cvt_pk_bf16_f32 v152,v208,v209
v_cvt_pk_bf16_f32 v153,v210,v211
v_mfma_f32_16x16x32_bf16 a[88:91],a[244:247],v[188:191],a[88:91]
v_accvgpr_read_b32 v212,a20
v_accvgpr_read_b32 v213,a21
v_accvgpr_read_b32 v214,a22
v_accvgpr_read_b32 v215,a23
v_mfma_f32_16x16x32_bf16 a[152:155],a[240:243],v[200:203],a[152:155]
v_cvt_pk_bf16_f32 v122,v212,v213
v_cvt_pk_bf16_f32 v123,v214,v215
v_accvgpr_read_b32 v208,a84
v_accvgpr_read_b32 v209,a85
v_mfma_f32_16x16x32_bf16 a[152:155],a[244:247],v[204:207],a[152:155]
ds_read_b64_tr_b16 a[220:221],v7 offset:49408
ds_read_b64_tr_b16 a[222:223],v7 offset:57600
v_accvgpr_read_b32 v210,a86
v_accvgpr_read_b32 v211,a87
v_mfma_f32_16x16x32_bf16 a[28:31],a[248:251],v[168:171],a[28:31]
v_cvt_pk_bf16_f32 v138,v208,v209
v_cvt_pk_bf16_f32 v139,v210,v211
v_accvgpr_read_b32 v212,a148
v_accvgpr_read_b32 v213,a149
v_mfma_f32_16x16x32_bf16 a[28:31],a[252:255],v[172:175],a[28:31]
v_accvgpr_read_b32 v214,a150
v_accvgpr_read_b32 v215,a151
v_cvt_pk_bf16_f32 v154,v212,v213
v_cvt_pk_bf16_f32 v155,v214,v215
v_mfma_f32_16x16x32_bf16 a[92:95],a[248:251],v[184:187],a[92:95]
ds_read_b64_tr_b16 a[224:225],v8 offset:33024
ds_read_b64_tr_b16 a[226:227],v8 offset:41216
v_accvgpr_read_b32 v208,a24
v_accvgpr_read_b32 v209,a25
v_mfma_f32_16x16x32_bf16 a[92:95],a[252:255],v[188:191],a[92:95]
v_accvgpr_read_b32 v210,a26
v_accvgpr_read_b32 v211,a27
v_cvt_pk_bf16_f32 v124,v208,v209
v_cvt_pk_bf16_f32 v125,v210,v211
v_mfma_f32_16x16x32_bf16 a[156:159],a[248:251],v[200:203],a[156:159]
v_accvgpr_read_b32 v212,a88
v_accvgpr_read_b32 v213,a89
v_accvgpr_read_b32 v214,a90
v_accvgpr_read_b32 v215,a91
v_mfma_f32_16x16x32_bf16 a[156:159],a[252:255],v[204:207],a[156:159]
ds_read_b64_tr_b16 a[228:229],v8 offset:49408
ds_read_b64_tr_b16 a[230:231],v8 offset:57600
v_cvt_pk_bf16_f32 v140,v212,v213
s_waitcnt lgkmcnt(6)
v_mfma_f32_16x16x32_bf16 a[32:35],a[192:195],v[168:171],a[32:35]
v_cvt_pk_bf16_f32 v141,v214,v215
v_accvgpr_read_b32 v208,a152
v_accvgpr_read_b32 v209,a153
v_accvgpr_read_b32 v210,a154
v_mfma_f32_16x16x32_bf16 a[32:35],a[196:199],v[172:175],a[32:35]
v_accvgpr_read_b32 v211,a155
v_cvt_pk_bf16_f32 v156,v208,v209
v_cvt_pk_bf16_f32 v157,v210,v211
v_accvgpr_read_b32 v212,a28
v_mfma_f32_16x16x32_bf16 a[96:99],a[192:195],v[184:187],a[96:99]
ds_read_b64_tr_b16 a[232:233],v9 offset:33024
ds_read_b64_tr_b16 a[234:235],v9 offset:41216
v_accvgpr_read_b32 v213,a29
v_accvgpr_read_b32 v214,a30
v_mfma_f32_16x16x32_bf16 a[96:99],a[196:199],v[188:191],a[96:99]
v_accvgpr_read_b32 v215,a31
v_cvt_pk_bf16_f32 v126,v212,v213
v_cvt_pk_bf16_f32 v127,v214,v215
v_accvgpr_read_b32 v208,a92
v_mfma_f32_16x16x32_bf16 a[160:163],a[192:195],v[200:203],a[160:163]
v_accvgpr_read_b32 v209,a93
v_accvgpr_read_b32 v210,a94
v_accvgpr_read_b32 v211,a95
v_cvt_pk_bf16_f32 v142,v208,v209
v_mfma_f32_16x16x32_bf16 a[160:163],a[196:199],v[204:207],a[160:163]
v_cvt_pk_bf16_f32 v143,v210,v211
v_accvgpr_read_b32 v212,a156
v_accvgpr_read_b32 v213,a157
v_accvgpr_read_b32 v214,a158
v_mfma_f32_16x16x32_bf16 a[36:39],a[200:203],v[168:171],a[36:39]
ds_read_b64_tr_b16 a[236:237],v9 offset:49408
ds_read_b64_tr_b16 a[238:239],v9 offset:57600
v_accvgpr_read_b32 v215,a159
v_cvt_pk_bf16_f32 v158,v212,v213
v_mfma_f32_16x16x32_bf16 a[36:39],a[204:207],v[172:175],a[36:39]
v_cvt_pk_bf16_f32 v159,v214,v215
v_accvgpr_read_b32 v208,a32
v_accvgpr_read_b32 v209,a33
v_accvgpr_read_b32 v210,a34
v_mfma_f32_16x16x32_bf16 a[100:103],a[200:203],v[184:187],a[100:103]
v_accvgpr_read_b32 v211,a35
v_cvt_pk_bf16_f32 v160,v208,v209
v_cvt_pk_bf16_f32 v161,v210,v211
v_accvgpr_read_b32 v212,a96
v_mfma_f32_16x16x32_bf16 a[100:103],a[204:207],v[188:191],a[100:103]
ds_read_b64_tr_b16 a[240:241],v10 offset:33024
ds_read_b64_tr_b16 a[242:243],v10 offset:41216
v_accvgpr_read_b32 v213,a97
v_accvgpr_read_b32 v214,a98
v_mfma_f32_16x16x32_bf16 a[164:167],a[200:203],v[200:203],a[164:167]
v_accvgpr_read_b32 v215,a99
v_cvt_pk_bf16_f32 v176,v212,v213
v_cvt_pk_bf16_f32 v177,v214,v215
v_accvgpr_read_b32 v208,a160
v_mfma_f32_16x16x32_bf16 a[164:167],a[204:207],v[204:207],a[164:167]
v_accvgpr_read_b32 v209,a161
v_accvgpr_read_b32 v210,a162
v_accvgpr_read_b32 v211,a163
v_cvt_pk_bf16_f32 v192,v208,v209
v_mfma_f32_16x16x32_bf16 a[40:43],a[208:211],v[168:171],a[40:43]
ds_read_b64_tr_b16 a[244:245],v10 offset:49408
ds_read_b64_tr_b16 a[246:247],v10 offset:57600
v_cvt_pk_bf16_f32 v193,v210,v211
v_accvgpr_read_b32 v212,a36
v_mfma_f32_16x16x32_bf16 a[40:43],a[212:215],v[172:175],a[40:43]
v_accvgpr_read_b32 v213,a37
v_accvgpr_read_b32 v214,a38
v_accvgpr_read_b32 v215,a39
v_cvt_pk_bf16_f32 v162,v212,v213
v_mfma_f32_16x16x32_bf16 a[104:107],a[208:211],v[184:187],a[104:107]
v_cvt_pk_bf16_f32 v163,v214,v215
v_accvgpr_read_b32 v208,a100
v_accvgpr_read_b32 v209,a101
v_accvgpr_read_b32 v210,a102
v_mfma_f32_16x16x32_bf16 a[104:107],a[212:215],v[188:191],a[104:107]
ds_read_b64_tr_b16 a[248:249],v11 offset:33024
ds_read_b64_tr_b16 a[250:251],v11 offset:41216
v_accvgpr_read_b32 v211,a103
v_cvt_pk_bf16_f32 v178,v208,v209
v_mfma_f32_16x16x32_bf16 a[168:171],a[208:211],v[200:203],a[168:171]
v_cvt_pk_bf16_f32 v179,v210,v211
v_accvgpr_read_b32 v212,a164
v_accvgpr_read_b32 v213,a165
v_accvgpr_read_b32 v214,a166
v_mfma_f32_16x16x32_bf16 a[168:171],a[212:215],v[204:207],a[168:171]
v_accvgpr_read_b32 v215,a167
v_cvt_pk_bf16_f32 v194,v212,v213
v_cvt_pk_bf16_f32 v195,v214,v215
v_accvgpr_read_b32 v208,a40
v_mfma_f32_16x16x32_bf16 a[44:47],a[216:219],v[168:171],a[44:47]
ds_read_b64_tr_b16 a[252:253],v11 offset:49408
ds_read_b64_tr_b16 a[254:255],v11 offset:57600
v_accvgpr_read_b32 v209,a41
s_waitcnt lgkmcnt(6)
v_mfma_f32_16x16x32_bf16 a[44:47],a[220:223],v[172:175],a[44:47]
v_accvgpr_read_b32 v210,a42
v_accvgpr_read_b32 v211,a43
v_cvt_pk_bf16_f32 v164,v208,v209
v_cvt_pk_bf16_f32 v165,v210,v211
v_mfma_f32_16x16x32_bf16 a[108:111],a[216:219],v[184:187],a[108:111]
v_accvgpr_read_b32 v212,a104
v_accvgpr_read_b32 v213,a105
v_accvgpr_read_b32 v214,a106
v_accvgpr_read_b32 v215,a107
v_mfma_f32_16x16x32_bf16 a[108:111],a[220:223],v[188:191],a[108:111]
v_cvt_pk_bf16_f32 v180,v212,v213
v_cvt_pk_bf16_f32 v181,v214,v215
v_accvgpr_read_b32 v208,a168
v_accvgpr_read_b32 v209,a169
v_mfma_f32_16x16x32_bf16 a[172:175],a[216:219],v[200:203],a[172:175]
v_accvgpr_read_b32 v210,a170
v_accvgpr_read_b32 v211,a171
v_cvt_pk_bf16_f32 v196,v208,v209
v_cvt_pk_bf16_f32 v197,v210,v211
v_mfma_f32_16x16x32_bf16 a[172:175],a[220:223],v[204:207],a[172:175]
v_accvgpr_read_b32 v212,a44
v_accvgpr_read_b32 v213,a45
v_accvgpr_read_b32 v214,a46
v_accvgpr_read_b32 v215,a47
v_mfma_f32_16x16x32_bf16 a[48:51],a[224:227],v[168:171],a[48:51]
v_cvt_pk_bf16_f32 v166,v212,v213
s_waitcnt lgkmcnt(0)
s_waitcnt vmcnt(23)
s_barrier
v_mfma_f32_16x16x32_bf16 a[48:51],a[228:231],v[172:175],a[48:51]
ds_read_b64_tr_b16 a[192:193],v240 offset:49152
ds_read_b64_tr_b16 a[194:195],v240 offset:51200
ds_read_b128 v[216:219],v223
v_cvt_pk_bf16_f32 v167,v214,v215
v_mfma_f32_16x16x32_bf16 a[112:115],a[224:227],v[184:187],a[112:115]
s_add_u32 m0,s25,98304
s_add_u32 s28,s67,384
v_accvgpr_read_b32 v208,a108
v_accvgpr_read_b32 v209,a109
v_mfma_f32_16x16x32_bf16 a[112:115],a[228:231],v[188:191],a[112:115]
buffer_load_dwordx4 v236,s[96:99],s28 offen lds
v_accvgpr_read_b32 v210,a110
v_accvgpr_read_b32 v211,a111
v_mfma_f32_16x16x32_bf16 a[176:179],a[224:227],v[200:203],a[176:179]
ds_read_b64_tr_b16 a[196:197],v240 offset:53248
ds_read_b64_tr_b16 a[198:199],v240 offset:55296
v_cvt_pk_bf16_f32 v182,v208,v209
v_cvt_pk_bf16_f32 v183,v210,v211
v_mfma_f32_16x16x32_bf16 a[176:179],a[228:231],v[204:207],a[176:179]
buffer_load_dwordx4 v237,s[96:99],s28 offen offset:1024 lds
v_accvgpr_read_b32 v212,a172
v_accvgpr_read_b32 v213,a173
v_mfma_f32_16x16x32_bf16 a[52:55],a[232:235],v[168:171],a[52:55]
buffer_load_dwordx4 v238,s[96:99],s28 offen offset:2048 lds
v_accvgpr_read_b32 v214,a174
v_accvgpr_read_b32 v215,a175
v_mfma_f32_16x16x32_bf16 a[52:55],a[236:239],v[172:175],a[52:55]
ds_read_b64_tr_b16 a[200:201],v240 offset:57344
ds_read_b64_tr_b16 a[202:203],v240 offset:59392
v_cvt_pk_bf16_f32 v198,v212,v213
v_cvt_pk_bf16_f32 v199,v214,v215
v_mfma_f32_16x16x32_bf16 a[116:119],a[232:235],v[184:187],a[116:119]
buffer_load_dwordx4 v239,s[96:99],s28 offen offset:3072 lds
s_add_u32 m0,s25,114688
v_mfma_f32_16x16x32_bf16 a[116:119],a[236:239],v[188:191],a[116:119]
s_add_u32 s28,s67,115072
buffer_load_dwordx4 v236,s[96:99],s28 offen lds
v_mfma_f32_16x16x32_bf16 a[180:183],a[232:235],v[200:203],a[180:183]
ds_read_b64_tr_b16 a[204:205],v240 offset:61440
ds_read_b64_tr_b16 a[206:207],v240 offset:63488
v_mfma_f32_16x16x32_bf16 a[180:183],a[236:239],v[204:207],a[180:183]
buffer_load_dwordx4 v237,s[96:99],s28 offen offset:1024 lds
v_mfma_f32_16x16x32_bf16 a[56:59],a[240:243],v[168:171],a[56:59]
buffer_load_dwordx4 v238,s[96:99],s28 offen offset:2048 lds
s_waitcnt lgkmcnt(9)
v_mfma_f32_16x16x32_bf16 a[56:59],a[244:247],v[172:175],a[56:59]
ds_read_b64_tr_b16 a[208:209],v241 offset:49152
ds_read_b64_tr_b16 a[210:211],v241 offset:51200
v_mfma_f32_16x16x32_bf16 a[120:123],a[240:243],v[184:187],a[120:123]
buffer_load_dwordx4 v239,s[96:99],s28 offen offset:3072 lds
v_mfma_f32_16x16x32_bf16 a[120:123],a[244:247],v[188:191],a[120:123]
v_mfma_f32_16x16x32_bf16 a[184:187],a[240:243],v[200:203],a[184:187]
ds_read_b64_tr_b16 a[212:213],v241 offset:53248
ds_read_b64_tr_b16 a[214:215],v241 offset:55296
v_mfma_f32_16x16x32_bf16 a[184:187],a[244:247],v[204:207],a[184:187]
v_mfma_f32_16x16x32_bf16 a[60:63],a[248:251],v[168:171],a[60:63]
v_mfma_f32_16x16x32_bf16 a[60:63],a[252:255],v[172:175],a[60:63]
ds_read_b64_tr_b16 a[216:217],v241 offset:57344
ds_read_b64_tr_b16 a[218:219],v241 offset:59392
v_mfma_f32_16x16x32_bf16 a[124:127],a[248:251],v[184:187],a[124:127]
v_mfma_f32_16x16x32_bf16 a[124:127],a[252:255],v[188:191],a[124:127]
s_waitcnt lgkmcnt(12)
v_or3_b32 v216,v216,v217,v218
v_or_b32 v216,v216,v219
v_mfma_f32_16x16x32_bf16 a[188:191],a[248:251],v[200:203],a[188:191]
ds_read_b64_tr_b16 a[220:221],v241 offset:61440
ds_read_b64_tr_b16 a[222:223],v241 offset:63488
v_mfma_f32_16x16x32_bf16 a[188:191],a[252:255],v[204:207],a[188:191]
v_readfirstlane_b32 s66,v216
s_andn2_b32 s66,s66,s30
s_cbranch_scc1 FALLBACK_A2
s_waitcnt lgkmcnt(4)
v_mfma_f32_16x16x32_bf16 v[16:19],a[192:195],v[112:115],0
ds_read_b64_tr_b16 a[224:225],v242 offset:49152
ds_read_b64_tr_b16 a[226:227],v242 offset:51200
v_mfma_f32_16x16x32_bf16 v[16:19],a[196:199],v[116:119],v[16:19]
v_mfma_f32_16x16x32_bf16 v[16:19],a[200:203],v[120:123],v[16:19]
v_mfma_f32_16x16x32_bf16 v[16:19],a[204:207],v[124:127],v[16:19]
ds_read_b64_tr_b16 a[228:229],v242 offset:53248
ds_read_b64_tr_b16 a[230:231],v242 offset:55296
v_accvgpr_read_b32 v208,a48
v_mfma_f32_16x16x32_bf16 v[20:23],a[192:195],v[128:131],0
v_accvgpr_read_b32 v209,a49
v_accvgpr_read_b32 v210,a50
v_accvgpr_read_b32 v211,a51
v_mfma_f32_16x16x32_bf16 v[20:23],a[196:199],v[132:135],v[20:23]
v_cvt_pk_bf16_f32 v168,v208,v209
v_cvt_pk_bf16_f32 v169,v210,v211
v_accvgpr_read_b32 v212,a112
v_mfma_f32_16x16x32_bf16 v[20:23],a[200:203],v[136:139],v[20:23]
ds_read_b64_tr_b16 a[232:233],v242 offset:57344
ds_read_b64_tr_b16 a[234:235],v242 offset:59392
v_accvgpr_read_b32 v213,a113
v_mfma_f32_16x16x32_bf16 v[20:23],a[204:207],v[140:143],v[20:23]
v_accvgpr_read_b32 v214,a114
v_accvgpr_read_b32 v215,a115
v_cvt_pk_bf16_f32 v184,v212,v213
v_mfma_f32_16x16x32_bf16 v[24:27],a[192:195],v[144:147],0
v_cvt_pk_bf16_f32 v185,v214,v215
v_accvgpr_read_b32 v208,a176
v_accvgpr_read_b32 v209,a177
v_mfma_f32_16x16x32_bf16 v[24:27],a[196:199],v[148:151],v[24:27]
ds_read_b64_tr_b16 a[236:237],v242 offset:61440
ds_read_b64_tr_b16 a[238:239],v242 offset:63488
v_accvgpr_read_b32 v210,a178
v_mfma_f32_16x16x32_bf16 v[24:27],a[200:203],v[152:155],v[24:27]
v_accvgpr_read_b32 v211,a179
v_cvt_pk_bf16_f32 v200,v208,v209
v_cvt_pk_bf16_f32 v201,v210,v211
v_mfma_f32_16x16x32_bf16 v[24:27],a[204:207],v[156:159],v[24:27]
v_accvgpr_read_b32 v212,a52
v_accvgpr_read_b32 v213,a53
v_accvgpr_read_b32 v214,a54
v_mfma_f32_16x16x32_bf16 v[28:31],a[208:211],v[112:115],0
ds_read_b64_tr_b16 a[240:241],v243 offset:49152
ds_read_b64_tr_b16 a[242:243],v243 offset:51200
v_accvgpr_read_b32 v215,a55
v_mfma_f32_16x16x32_bf16 v[28:31],a[212:215],v[116:119],v[28:31]
v_cvt_pk_bf16_f32 v170,v212,v213
v_cvt_pk_bf16_f32 v171,v214,v215
s_waitcnt lgkmcnt(4)
v_mfma_f32_16x16x32_bf16 v[28:31],a[216:219],v[120:123],v[28:31]
v_accvgpr_read_b32 v208,a116
v_accvgpr_read_b32 v209,a117
v_accvgpr_read_b32 v210,a118
v_mfma_f32_16x16x32_bf16 v[28:31],a[220:223],v[124:127],v[28:31]
ds_read_b64_tr_b16 a[244:245],v243 offset:53248
ds_read_b64_tr_b16 a[246:247],v243 offset:55296
v_accvgpr_read_b32 v211,a119
v_mfma_f32_16x16x32_bf16 v[32:35],a[208:211],v[128:131],0
v_cvt_pk_bf16_f32 v186,v208,v209
v_cvt_pk_bf16_f32 v187,v210,v211
v_accvgpr_read_b32 v212,a180
v_mfma_f32_16x16x32_bf16 v[32:35],a[212:215],v[132:135],v[32:35]
v_accvgpr_read_b32 v213,a181
v_accvgpr_read_b32 v214,a182
v_accvgpr_read_b32 v215,a183
v_mfma_f32_16x16x32_bf16 v[32:35],a[216:219],v[136:139],v[32:35]
ds_read_b64_tr_b16 a[248:249],v243 offset:57344
ds_read_b64_tr_b16 a[250:251],v243 offset:59392
v_cvt_pk_bf16_f32 v202,v212,v213
v_mfma_f32_16x16x32_bf16 v[32:35],a[220:223],v[140:143],v[32:35]
v_cvt_pk_bf16_f32 v203,v214,v215
v_mfma_f32_16x16x32_bf16 v[36:39],a[208:211],v[144:147],0
v_mfma_f32_16x16x32_bf16 v[36:39],a[212:215],v[148:151],v[36:39]
ds_read_b64_tr_b16 a[252:253],v243 offset:61440
ds_read_b64_tr_b16 a[254:255],v243 offset:63488
v_mfma_f32_16x16x32_bf16 v[36:39],a[216:219],v[152:155],v[36:39]
v_mfma_f32_16x16x32_bf16 v[36:39],a[220:223],v[156:159],v[36:39]
v_mfma_f32_16x16x32_bf16 v[40:43],a[224:227],v[112:115],0
ds_read_b64_tr_b16 a[192:193],v244 offset:0
ds_read_b64_tr_b16 a[194:195],v244 offset:2048
v_mfma_f32_16x16x32_bf16 v[40:43],a[228:231],v[116:119],v[40:43]
v_mfma_f32_16x16x32_bf16 v[40:43],a[232:235],v[120:123],v[40:43]
s_waitcnt lgkmcnt(4)
v_mfma_f32_16x16x32_bf16 v[40:43],a[236:239],v[124:127],v[40:43]
ds_read_b64_tr_b16 a[196:197],v244 offset:4096
ds_read_b64_tr_b16 a[198:199],v244 offset:6144
v_mfma_f32_16x16x32_bf16 v[44:47],a[224:227],v[128:131],0
v_mfma_f32_16x16x32_bf16 v[44:47],a[228:231],v[132:135],v[44:47]
v_mfma_f32_16x16x32_bf16 v[44:47],a[232:235],v[136:139],v[44:47]
ds_read_b64_tr_b16 a[200:201],v244 offset:8192
ds_read_b64_tr_b16 a[202:203],v244 offset:10240
v_mfma_f32_16x16x32_bf16 v[44:47],a[236:239],v[140:143],v[44:47]
v_mfma_f32_16x16x32_bf16 v[48:51],a[224:227],v[144:147],0
v_mfma_f32_16x16x32_bf16 v[48:51],a[228:231],v[148:151],v[48:51]
ds_read_b64_tr_b16 a[204:205],v244 offset:12288
ds_read_b64_tr_b16 a[206:207],v244 offset:14336
v_mfma_f32_16x16x32_bf16 v[48:51],a[232:235],v[152:155],v[48:51]
v_mfma_f32_16x16x32_bf16 v[48:51],a[236:239],v[156:159],v[48:51]
v_mfma_f32_16x16x32_bf16 v[52:55],a[240:243],v[112:115],0
ds_read_b64_tr_b16 a[208:209],v245 offset:0
ds_read_b64_tr_b16 a[210:211],v245 offset:2048
v_mfma_f32_16x16x32_bf16 v[52:55],a[244:247],v[116:119],v[52:55]
v_mfma_f32_16x16x32_bf16 v[52:55],a[248:251],v[120:123],v[52:55]
s_waitcnt lgkmcnt(10)
v_mfma_f32_16x16x32_bf16 v[52:55],a[252:255],v[124:127],v[52:55]
ds_read_b64_tr_b16 a[212:213],v245 offset:4096
ds_read_b64_tr_b16 a[214:215],v245 offset:6144
v_mfma_f32_16x16x32_bf16 v[56:59],a[240:243],v[128:131],0
v_mfma_f32_16x16x32_bf16 v[56:59],a[244:247],v[132:135],v[56:59]
v_mfma_f32_16x16x32_bf16 v[56:59],a[248:251],v[136:139],v[56:59]
ds_read_b64_tr_b16 a[216:217],v245 offset:8192
ds_read_b64_tr_b16 a[218:219],v245 offset:10240
v_mfma_f32_16x16x32_bf16 v[56:59],a[252:255],v[140:143],v[56:59]
v_mfma_f32_16x16x32_bf16 v[60:63],a[240:243],v[144:147],0
v_mfma_f32_16x16x32_bf16 v[60:63],a[244:247],v[148:151],v[60:63]
ds_read_b64_tr_b16 a[220:221],v245 offset:12288
ds_read_b64_tr_b16 a[222:223],v245 offset:14336
v_mfma_f32_16x16x32_bf16 v[60:63],a[248:251],v[152:155],v[60:63]
v_mfma_f32_16x16x32_bf16 v[60:63],a[252:255],v[156:159],v[60:63]
s_waitcnt vmcnt(27)
s_barrier
s_waitcnt lgkmcnt(4)
v_mfma_f32_16x16x32_bf16 v[64:67],a[192:195],v[112:115],0
ds_read_b64_tr_b16 a[224:225],v246 offset:0
ds_read_b64_tr_b16 a[226:227],v246 offset:2048
v_accvgpr_read_b32 v208,a56
v_mfma_f32_16x16x32_bf16 v[64:67],a[196:199],v[116:119],v[64:67]
s_add_u32 m0,s25,131072
s_add_u32 s28,s67,512
v_accvgpr_read_b32 v209,a57
v_mfma_f32_16x16x32_bf16 v[64:67],a[200:203],v[120:123],v[64:67]
buffer_load_dwordx4 v236,s[96:99],s28 offen lds
v_accvgpr_read_b32 v210,a58
v_mfma_f32_16x16x32_bf16 v[64:67],a[204:207],v[124:127],v[64:67]
ds_read_b64_tr_b16 a[228:229],v246 offset:4096
ds_read_b64_tr_b16 a[230:231],v246 offset:6144
v_accvgpr_read_b32 v211,a59
v_mfma_f32_16x16x32_bf16 v[68:71],a[192:195],v[128:131],0
buffer_load_dwordx4 v237,s[96:99],s28 offen offset:1024 lds
v_cvt_pk_bf16_f32 v172,v208,v209
v_mfma_f32_16x16x32_bf16 v[68:71],a[196:199],v[132:135],v[68:71]
buffer_load_dwordx4 v238,s[96:99],s28 offen offset:2048 lds
v_cvt_pk_bf16_f32 v173,v210,v211
v_mfma_f32_16x16x32_bf16 v[68:71],a[200:203],v[136:139],v[68:71]
ds_read_b64_tr_b16 a[232:233],v246 offset:8192
ds_read_b64_tr_b16 a[234:235],v246 offset:10240
v_accvgpr_read_b32 v212,a120
v_mfma_f32_16x16x32_bf16 v[68:71],a[204:207],v[140:143],v[68:71]
buffer_load_dwordx4 v239,s[96:99],s28 offen offset:3072 lds
v_accvgpr_read_b32 v213,a121
v_mfma_f32_16x16x32_bf16 v[72:75],a[192:195],v[144:147],0
v_accvgpr_read_b32 v214,a122
v_accvgpr_read_b32 v215,a123
v_cvt_pk_bf16_f32 v188,v212,v213
v_mfma_f32_16x16x32_bf16 v[72:75],a[196:199],v[148:151],v[72:75]
ds_read_b64_tr_b16 a[236:237],v246 offset:12288
ds_read_b64_tr_b16 a[238:239],v246 offset:14336
v_cvt_pk_bf16_f32 v189,v214,v215
v_mfma_f32_16x16x32_bf16 v[72:75],a[200:203],v[152:155],v[72:75]
v_accvgpr_read_b32 v208,a184
v_accvgpr_read_b32 v209,a185
v_accvgpr_read_b32 v210,a186
v_mfma_f32_16x16x32_bf16 v[72:75],a[204:207],v[156:159],v[72:75]
v_accvgpr_read_b32 v211,a187
v_cvt_pk_bf16_f32 v204,v208,v209
v_cvt_pk_bf16_f32 v205,v210,v211
v_mfma_f32_16x16x32_bf16 v[76:79],a[208:211],v[112:115],0
ds_read_b64_tr_b16 a[240:241],v247 offset:0
ds_read_b64_tr_b16 a[242:243],v247 offset:2048
v_accvgpr_read_b32 v212,a60
v_mfma_f32_16x16x32_bf16 v[76:79],a[212:215],v[116:119],v[76:79]
v_accvgpr_read_b32 v213,a61
v_accvgpr_read_b32 v214,a62
s_waitcnt lgkmcnt(4)
v_mfma_f32_16x16x32_bf16 v[76:79],a[216:219],v[120:123],v[76:79]
v_accvgpr_read_b32 v215,a63
v_cvt_pk_bf16_f32 v174,v212,v213
v_cvt_pk_bf16_f32 v175,v214,v215
v_mfma_f32_16x16x32_bf16 v[76:79],a[220:223],v[124:127],v[76:79]
ds_read_b64_tr_b16 a[244:245],v247 offset:4096
ds_read_b64_tr_b16 a[246:247],v247 offset:6144
v_accvgpr_read_b32 v208,a124
v_mfma_f32_16x16x32_bf16 v[80:83],a[208:211],v[128:131],0
v_accvgpr_read_b32 v209,a125
v_accvgpr_read_b32 v210,a126
v_accvgpr_read_b32 v211,a127
v_mfma_f32_16x16x32_bf16 v[80:83],a[212:215],v[132:135],v[80:83]
v_cvt_pk_bf16_f32 v190,v208,v209
v_cvt_pk_bf16_f32 v191,v210,v211
v_accvgpr_read_b32 v212,a188
v_mfma_f32_16x16x32_bf16 v[80:83],a[216:219],v[136:139],v[80:83]
ds_read_b64_tr_b16 a[248:249],v247 offset:8192
ds_read_b64_tr_b16 a[250:251],v247 offset:10240
v_accvgpr_read_b32 v213,a189
v_mfma_f32_16x16x32_bf16 v[80:83],a[220:223],v[140:143],v[80:83]
v_accvgpr_read_b32 v214,a190
v_accvgpr_read_b32 v215,a191
v_cvt_pk_bf16_f32 v206,v212,v213
v_mfma_f32_16x16x32_bf16 v[84:87],a[208:211],v[144:147],0
v_cvt_pk_bf16_f32 v207,v214,v215
v_mfma_f32_16x16x32_bf16 v[84:87],a[212:215],v[148:151],v[84:87]
ds_read_b64_tr_b16 a[252:253],v247 offset:12288
ds_read_b64_tr_b16 a[254:255],v247 offset:14336
v_mfma_f32_16x16x32_bf16 v[84:87],a[216:219],v[152:155],v[84:87]
v_mfma_f32_16x16x32_bf16 v[84:87],a[220:223],v[156:159],v[84:87]
v_mfma_f32_16x16x32_bf16 v[88:91],a[224:227],v[112:115],0
ds_read_b64_tr_b16 a[192:193],v244 offset:16384
ds_read_b64_tr_b16 a[194:195],v244 offset:18432
v_mfma_f32_16x16x32_bf16 v[88:91],a[228:231],v[116:119],v[88:91]
v_mfma_f32_16x16x32_bf16 v[88:91],a[232:235],v[120:123],v[88:91]
s_waitcnt lgkmcnt(4)
v_mfma_f32_16x16x32_bf16 v[88:91],a[236:239],v[124:127],v[88:91]
ds_read_b64_tr_b16 a[196:197],v244 offset:20480
ds_read_b64_tr_b16 a[198:199],v244 offset:22528
v_mfma_f32_16x16x32_bf16 v[92:95],a[224:227],v[128:131],0
v_mfma_f32_16x16x32_bf16 v[92:95],a[228:231],v[132:135],v[92:95]
v_mfma_f32_16x16x32_bf16 v[92:95],a[232:235],v[136:139],v[92:95]
ds_read_b64_tr_b16 a[200:201],v244 offset:24576
ds_read_b64_tr_b16 a[202:203],v244 offset:26624
v_mfma_f32_16x16x32_bf16 v[92:95],a[236:239],v[140:143],v[92:95]
v_mfma_f32_16x16x32_bf16 v[96:99],a[224:227],v[144:147],0
v_mfma_f32_16x16x32_bf16 v[96:99],a[228:231],v[148:151],v[96:99]
ds_read_b64_tr_b16 a[204:205],v244 offset:28672
ds_read_b64_tr_b16 a[206:207],v244 offset:30720
v_mfma_f32_16x16x32_bf16 v[96:99],a[232:235],v[152:155],v[96:99]
v_mfma_f32_16x16x32_bf16 v[96:99],a[236:239],v[156:159],v[96:99]
v_mfma_f32_16x16x32_bf16 v[100:103],a[240:243],v[112:115],0
ds_read_b64_tr_b16 a[208:209],v245 offset:16384
ds_read_b64_tr_b16 a[210:211],v245 offset:18432
v_mfma_f32_16x16x32_bf16 v[100:103],a[244:247],v[116:119],v[100:103]
v_mfma_f32_16x16x32_bf16 v[100:103],a[248:251],v[120:123],v[100:103]
s_waitcnt lgkmcnt(10)
v_mfma_f32_16x16x32_bf16 v[100:103],a[252:255],v[124:127],v[100:103]
ds_read_b64_tr_b16 a[212:213],v245 offset:20480
ds_read_b64_tr_b16 a[214:215],v245 offset:22528
v_mfma_f32_16x16x32_bf16 v[104:107],a[240:243],v[128:131],0
v_mfma_f32_16x16x32_bf16 v[104:107],a[244:247],v[132:135],v[104:107]
v_mfma_f32_16x16x32_bf16 v[104:107],a[248:251],v[136:139],v[104:107]
ds_read_b64_tr_b16 a[216:217],v245 offset:24576
ds_read_b64_tr_b16 a[218:219],v245 offset:26624
v_mfma_f32_16x16x32_bf16 v[104:107],a[252:255],v[140:143],v[104:107]
v_mfma_f32_16x16x32_bf16 v[108:111],a[240:243],v[144:147],0
v_mfma_f32_16x16x32_bf16 v[108:111],a[244:247],v[148:151],v[108:111]
ds_read_b64_tr_b16 a[220:221],v245 offset:28672
ds_read_b64_tr_b16 a[222:223],v245 offset:30720
v_mfma_f32_16x16x32_bf16 v[108:111],a[248:251],v[152:155],v[108:111]
v_mfma_f32_16x16x32_bf16 v[108:111],a[252:255],v[156:159],v[108:111]
s_waitcnt vmcnt(23)
s_barrier
s_waitcnt lgkmcnt(4)
v_mfma_f32_16x16x32_bf16 v[16:19],a[192:195],v[160:163],v[16:19]
ds_read_b64_tr_b16 a[224:225],v246 offset:16384
ds_read_b64_tr_b16 a[226:227],v246 offset:18432
v_mfma_f32_16x16x32_bf16 v[16:19],a[196:199],v[164:167],v[16:19]
s_add_u32 m0,s25,0
s_add_u32 s28,s67,115200
v_mfma_f32_16x16x32_bf16 v[16:19],a[200:203],v[168:171],v[16:19]
buffer_load_dwordx4 v236,s[96:99],s28 offen lds
v_mfma_f32_16x16x32_bf16 v[16:19],a[204:207],v[172:175],v[16:19]
ds_read_b64_tr_b16 a[228:229],v246 offset:20480
ds_read_b64_tr_b16 a[230:231],v246 offset:22528
v_mfma_f32_16x16x32_bf16 v[20:23],a[192:195],v[176:179],v[20:23]
buffer_load_dwordx4 v237,s[96:99],s28 offen offset:1024 lds
v_mfma_f32_16x16x32_bf16 v[20:23],a[196:199],v[180:183],v[20:23]
buffer_load_dwordx4 v238,s[96:99],s28 offen offset:2048 lds
v_mfma_f32_16x16x32_bf16 v[20:23],a[200:203],v[184:187],v[20:23]
ds_read_b64_tr_b16 a[232:233],v246 offset:24576
ds_read_b64_tr_b16 a[234:235],v246 offset:26624
v_mfma_f32_16x16x32_bf16 v[20:23],a[204:207],v[188:191],v[20:23]
buffer_load_dwordx4 v239,s[96:99],s28 offen offset:3072 lds
v_mfma_f32_16x16x32_bf16 v[24:27],a[192:195],v[192:195],v[24:27]
v_mfma_f32_16x16x32_bf16 v[24:27],a[196:199],v[196:199],v[24:27]
ds_read_b64_tr_b16 a[236:237],v246 offset:28672
ds_read_b64_tr_b16 a[238:239],v246 offset:30720
v_mfma_f32_16x16x32_bf16 v[24:27],a[200:203],v[200:203],v[24:27]
v_mfma_f32_16x16x32_bf16 v[24:27],a[204:207],v[204:207],v[24:27]
v_mfma_f32_16x16x32_bf16 v[28:31],a[208:211],v[160:163],v[28:31]
ds_read_b64_tr_b16 a[240:241],v247 offset:16384
ds_read_b64_tr_b16 a[242:243],v247 offset:18432
v_mfma_f32_16x16x32_bf16 v[28:31],a[212:215],v[164:167],v[28:31]
s_waitcnt lgkmcnt(4)
v_mfma_f32_16x16x32_bf16 v[28:31],a[216:219],v[168:171],v[28:31]
v_mfma_f32_16x16x32_bf16 v[28:31],a[220:223],v[172:175],v[28:31]
ds_read_b64_tr_b16 a[244:245],v247 offset:20480
ds_read_b64_tr_b16 a[246:247],v247 offset:22528
v_mfma_f32_16x16x32_bf16 v[32:35],a[208:211],v[176:179],v[32:35]
v_mfma_f32_16x16x32_bf16 v[32:35],a[212:215],v[180:183],v[32:35]
v_mfma_f32_16x16x32_bf16 v[32:35],a[216:219],v[184:187],v[32:35]
ds_read_b64_tr_b16 a[248:249],v247 offset:24576
ds_read_b64_tr_b16 a[250:251],v247 offset:26624
v_mfma_f32_16x16x32_bf16 v[32:35],a[220:223],v[188:191],v[32:35]
v_mfma_f32_16x16x32_bf16 v[36:39],a[208:211],v[192:195],v[36:39]
v_mfma_f32_16x16x32_bf16 v[36:39],a[212:215],v[196:199],v[36:39]
ds_read_b64_tr_b16 a[252:253],v247 offset:28672
ds_read_b64_tr_b16 a[254:255],v247 offset:30720
v_mfma_f32_16x16x32_bf16 v[36:39],a[216:219],v[200:203],v[36:39]
v_mfma_f32_16x16x32_bf16 v[36:39],a[220:223],v[204:207],v[36:39]
v_mfma_f32_16x16x32_bf16 v[40:43],a[224:227],v[160:163],v[40:43]
ds_read_b64_tr_b16 a[192:193],v244 offset:32768
ds_read_b64_tr_b16 a[194:195],v244 offset:34816
v_mfma_f32_16x16x32_bf16 v[40:43],a[228:231],v[164:167],v[40:43]
v_mfma_f32_16x16x32_bf16 v[40:43],a[232:235],v[168:171],v[40:43]
s_waitcnt lgkmcnt(4)
v_mfma_f32_16x16x32_bf16 v[40:43],a[236:239],v[172:175],v[40:43]
ds_read_b64_tr_b16 a[196:197],v244 offset:36864
ds_read_b64_tr_b16 a[198:199],v244 offset:38912
v_mfma_f32_16x16x32_bf16 v[44:47],a[224:227],v[176:179],v[44:47]
v_mfma_f32_16x16x32_bf16 v[44:47],a[228:231],v[180:183],v[44:47]
v_mfma_f32_16x16x32_bf16 v[44:47],a[232:235],v[184:187],v[44:47]
ds_read_b64_tr_b16 a[200:201],v244 offset:40960
ds_read_b64_tr_b16 a[202:203],v244 offset:43008
v_mfma_f32_16x16x32_bf16 v[44:47],a[236:239],v[188:191],v[44:47]
v_mfma_f32_16x16x32_bf16 v[48:51],a[224:227],v[192:195],v[48:51]
v_mfma_f32_16x16x32_bf16 v[48:51],a[228:231],v[196:199],v[48:51]
ds_read_b64_tr_b16 a[204:205],v244 offset:45056
ds_read_b64_tr_b16 a[206:207],v244 offset:47104
v_mfma_f32_16x16x32_bf16 v[48:51],a[232:235],v[200:203],v[48:51]
v_mfma_f32_16x16x32_bf16 v[48:51],a[236:239],v[204:207],v[48:51]
v_mfma_f32_16x16x32_bf16 v[52:55],a[240:243],v[160:163],v[52:55]
ds_read_b64_tr_b16 a[208:209],v245 offset:32768
ds_read_b64_tr_b16 a[210:211],v245 offset:34816
v_mfma_f32_16x16x32_bf16 v[52:55],a[244:247],v[164:167],v[52:55]
v_mfma_f32_16x16x32_bf16 v[52:55],a[248:251],v[168:171],v[52:55]
s_waitcnt lgkmcnt(10)
v_mfma_f32_16x16x32_bf16 v[52:55],a[252:255],v[172:175],v[52:55]
ds_read_b64_tr_b16 a[212:213],v245 offset:36864
ds_read_b64_tr_b16 a[214:215],v245 offset:38912
v_mfma_f32_16x16x32_bf16 v[56:59],a[240:243],v[176:179],v[56:59]
v_mfma_f32_16x16x32_bf16 v[56:59],a[244:247],v[180:183],v[56:59]
v_mfma_f32_16x16x32_bf16 v[56:59],a[248:251],v[184:187],v[56:59]
ds_read_b64_tr_b16 a[216:217],v245 offset:40960
ds_read_b64_tr_b16 a[218:219],v245 offset:43008
v_mfma_f32_16x16x32_bf16 v[56:59],a[252:255],v[188:191],v[56:59]
v_mfma_f32_16x16x32_bf16 v[60:63],a[240:243],v[192:195],v[60:63]
v_mfma_f32_16x16x32_bf16 v[60:63],a[244:247],v[196:199],v[60:63]
ds_read_b64_tr_b16 a[220:221],v245 offset:45056
ds_read_b64_tr_b16 a[222:223],v245 offset:47104
v_mfma_f32_16x16x32_bf16 v[60:63],a[248:251],v[200:203],v[60:63]
v_mfma_f32_16x16x32_bf16 v[60:63],a[252:255],v[204:207],v[60:63]
s_waitcnt vmcnt(23)
s_barrier
s_waitcnt lgkmcnt(4)
v_mfma_f32_16x16x32_bf16 v[64:67],a[192:195],v[160:163],v[64:67]
ds_read_b64_tr_b16 a[224:225],v246 offset:32768
ds_read_b64_tr_b16 a[226:227],v246 offset:34816
v_mfma_f32_16x16x32_bf16 v[64:67],a[196:199],v[164:167],v[64:67]
s_add_u32 m0,s25,16384
s_add_u32 s28,s67,640
v_mfma_f32_16x16x32_bf16 v[64:67],a[200:203],v[168:171],v[64:67]
buffer_load_dwordx4 v236,s[96:99],s28 offen lds
v_mfma_f32_16x16x32_bf16 v[64:67],a[204:207],v[172:175],v[64:67]
ds_read_b64_tr_b16 a[228:229],v246 offset:36864
ds_read_b64_tr_b16 a[230:231],v246 offset:38912
v_mfma_f32_16x16x32_bf16 v[68:71],a[192:195],v[176:179],v[68:71]
buffer_load_dwordx4 v237,s[96:99],s28 offen offset:1024 lds
v_mfma_f32_16x16x32_bf16 v[68:71],a[196:199],v[180:183],v[68:71]
buffer_load_dwordx4 v238,s[96:99],s28 offen offset:2048 lds
v_mfma_f32_16x16x32_bf16 v[68:71],a[200:203],v[184:187],v[68:71]
ds_read_b64_tr_b16 a[232:233],v246 offset:40960
ds_read_b64_tr_b16 a[234:235],v246 offset:43008
v_mfma_f32_16x16x32_bf16 v[68:71],a[204:207],v[188:191],v[68:71]
buffer_load_dwordx4 v239,s[96:99],s28 offen offset:3072 lds
v_mfma_f32_16x16x32_bf16 v[72:75],a[192:195],v[192:195],v[72:75]
v_cvt_pk_bf16_f32 v16,v16,v17
v_cvt_pk_bf16_f32 v17,v18,v19
v_mfma_f32_16x16x32_bf16 v[72:75],a[196:199],v[196:199],v[72:75]
ds_read_b64_tr_b16 a[236:237],v246 offset:45056
ds_read_b64_tr_b16 a[238:239],v246 offset:47104
v_mfma_f32_16x16x32_bf16 v[72:75],a[200:203],v[200:203],v[72:75]
v_cvt_pk_bf16_f32 v18,v28,v29
v_cvt_pk_bf16_f32 v19,v30,v31
v_mfma_f32_16x16x32_bf16 v[72:75],a[204:207],v[204:207],v[72:75]
buffer_store_dwordx4 v[16:19],v248,s[20:23],s62 offen sc0 sc1
v_mfma_f32_16x16x32_bf16 v[76:79],a[208:211],v[160:163],v[76:79]
ds_read_b64_tr_b16 a[240:241],v247 offset:32768
ds_read_b64_tr_b16 a[242:243],v247 offset:34816
v_mfma_f32_16x16x32_bf16 v[76:79],a[212:215],v[164:167],v[76:79]
v_cvt_pk_bf16_f32 v20,v20,v21
s_waitcnt lgkmcnt(4)
v_mfma_f32_16x16x32_bf16 v[76:79],a[216:219],v[168:171],v[76:79]
v_cvt_pk_bf16_f32 v21,v22,v23
v_cvt_pk_bf16_f32 v22,v32,v33
v_mfma_f32_16x16x32_bf16 v[76:79],a[220:223],v[172:175],v[76:79]
ds_read_b64_tr_b16 a[244:245],v247 offset:36864
ds_read_b64_tr_b16 a[246:247],v247 offset:38912
v_mfma_f32_16x16x32_bf16 v[80:83],a[208:211],v[176:179],v[80:83]
v_cvt_pk_bf16_f32 v23,v34,v35
v_mfma_f32_16x16x32_bf16 v[80:83],a[212:215],v[180:183],v[80:83]
buffer_store_dwordx4 v[20:23],v248,s[20:23],s63 offen sc0 sc1
v_mfma_f32_16x16x32_bf16 v[80:83],a[216:219],v[184:187],v[80:83]
ds_read_b64_tr_b16 a[248:249],v247 offset:40960
ds_read_b64_tr_b16 a[250:251],v247 offset:43008
v_mfma_f32_16x16x32_bf16 v[80:83],a[220:223],v[188:191],v[80:83]
v_cvt_pk_bf16_f32 v24,v24,v25
v_cvt_pk_bf16_f32 v25,v26,v27
v_mfma_f32_16x16x32_bf16 v[84:87],a[208:211],v[192:195],v[84:87]
v_cvt_pk_bf16_f32 v26,v36,v37
v_cvt_pk_bf16_f32 v27,v38,v39
v_mfma_f32_16x16x32_bf16 v[84:87],a[212:215],v[196:199],v[84:87]
ds_read_b64_tr_b16 a[252:253],v247 offset:45056
ds_read_b64_tr_b16 a[254:255],v247 offset:47104
v_mfma_f32_16x16x32_bf16 v[84:87],a[216:219],v[200:203],v[84:87]
buffer_store_dwordx4 v[24:27],v248,s[20:23],s64 offen sc0 sc1
v_mfma_f32_16x16x32_bf16 v[84:87],a[220:223],v[204:207],v[84:87]
v_cvt_pk_bf16_f32 v40,v40,v41
v_cvt_pk_bf16_f32 v41,v42,v43
v_mfma_f32_16x16x32_bf16 v[88:91],a[224:227],v[160:163],v[88:91]
ds_read_b64_tr_b16 a[192:193],v244 offset:49152
ds_read_b64_tr_b16 a[194:195],v244 offset:51200
v_mfma_f32_16x16x32_bf16 v[88:91],a[228:231],v[164:167],v[88:91]
v_cvt_pk_bf16_f32 v42,v52,v53
v_cvt_pk_bf16_f32 v43,v54,v55
v_mfma_f32_16x16x32_bf16 v[88:91],a[232:235],v[168:171],v[88:91]
s_waitcnt lgkmcnt(4)
v_mfma_f32_16x16x32_bf16 v[88:91],a[236:239],v[172:175],v[88:91]
ds_read_b64_tr_b16 a[196:197],v244 offset:53248
ds_read_b64_tr_b16 a[198:199],v244 offset:55296
v_mfma_f32_16x16x32_bf16 v[92:95],a[224:227],v[176:179],v[92:95]
buffer_store_dwordx4 v[40:43],v249,s[20:23],s62 offen sc0 sc1
v_mfma_f32_16x16x32_bf16 v[92:95],a[228:231],v[180:183],v[92:95]
s_add_u32 s62,s62,32768
v_cvt_pk_bf16_f32 v44,v44,v45
v_mfma_f32_16x16x32_bf16 v[92:95],a[232:235],v[184:187],v[92:95]
ds_read_b64_tr_b16 a[200:201],v244 offset:57344
ds_read_b64_tr_b16 a[202:203],v244 offset:59392
v_mfma_f32_16x16x32_bf16 v[92:95],a[236:239],v[188:191],v[92:95]
v_cvt_pk_bf16_f32 v45,v46,v47
v_cvt_pk_bf16_f32 v46,v56,v57
v_mfma_f32_16x16x32_bf16 v[96:99],a[224:227],v[192:195],v[96:99]
v_cvt_pk_bf16_f32 v47,v58,v59
v_mfma_f32_16x16x32_bf16 v[96:99],a[228:231],v[196:199],v[96:99]
ds_read_b64_tr_b16 a[204:205],v244 offset:61440
ds_read_b64_tr_b16 a[206:207],v244 offset:63488
v_mfma_f32_16x16x32_bf16 v[96:99],a[232:235],v[200:203],v[96:99]
buffer_store_dwordx4 v[44:47],v249,s[20:23],s63 offen sc0 sc1
v_mfma_f32_16x16x32_bf16 v[96:99],a[236:239],v[204:207],v[96:99]
s_add_u32 s63,s63,32768
v_cvt_pk_bf16_f32 v48,v48,v49
v_mfma_f32_16x16x32_bf16 v[100:103],a[240:243],v[160:163],v[100:103]
ds_read_b64_tr_b16 a[208:209],v245 offset:49152
ds_read_b64_tr_b16 a[210:211],v245 offset:51200
v_mfma_f32_16x16x32_bf16 v[100:103],a[244:247],v[164:167],v[100:103]
v_cvt_pk_bf16_f32 v49,v50,v51
v_cvt_pk_bf16_f32 v50,v60,v61
v_mfma_f32_16x16x32_bf16 v[100:103],a[248:251],v[168:171],v[100:103]
v_cvt_pk_bf16_f32 v51,v62,v63
s_waitcnt lgkmcnt(10)
v_mfma_f32_16x16x32_bf16 v[100:103],a[252:255],v[172:175],v[100:103]
ds_read_b64_tr_b16 a[212:213],v245 offset:53248
ds_read_b64_tr_b16 a[214:215],v245 offset:55296
v_mfma_f32_16x16x32_bf16 v[104:107],a[240:243],v[176:179],v[104:107]
buffer_store_dwordx4 v[48:51],v249,s[20:23],s64 offen sc0 sc1
v_mfma_f32_16x16x32_bf16 v[104:107],a[244:247],v[180:183],v[104:107]
s_add_u32 s64,s64,32768
v_mfma_f32_16x16x32_bf16 v[104:107],a[248:251],v[184:187],v[104:107]
ds_read_b64_tr_b16 a[216:217],v245 offset:57344
ds_read_b64_tr_b16 a[218:219],v245 offset:59392
v_mfma_f32_16x16x32_bf16 v[104:107],a[252:255],v[188:191],v[104:107]
v_mfma_f32_16x16x32_bf16 v[108:111],a[240:243],v[192:195],v[108:111]
v_mfma_f32_16x16x32_bf16 v[108:111],a[244:247],v[196:199],v[108:111]
ds_read_b64_tr_b16 a[220:221],v245 offset:61440
ds_read_b64_tr_b16 a[222:223],v245 offset:63488
v_mfma_f32_16x16x32_bf16 v[108:111],a[248:251],v[200:203],v[108:111]
v_mfma_f32_16x16x32_bf16 v[108:111],a[252:255],v[204:207],v[108:111]
s_waitcnt vmcnt(29)
s_barrier
s_waitcnt lgkmcnt(4)
v_mfma_f32_16x16x32_bf16 v[16:19],a[192:195],v[112:115],0
ds_read_b64_tr_b16 a[224:225],v246 offset:49152
ds_read_b64_tr_b16 a[226:227],v246 offset:51200
v_mfma_f32_16x16x32_bf16 v[16:19],a[196:199],v[116:119],v[16:19]
s_add_u32 m0,s25,32768
s_add_u32 s28,s67,115328
v_mfma_f32_16x16x32_bf16 v[16:19],a[200:203],v[120:123],v[16:19]
buffer_load_dwordx4 v236,s[96:99],s28 offen lds
v_mfma_f32_16x16x32_bf16 v[16:19],a[204:207],v[124:127],v[16:19]
ds_read_b64_tr_b16 a[228:229],v246 offset:53248
ds_read_b64_tr_b16 a[230:231],v246 offset:55296
v_mfma_f32_16x16x32_bf16 v[20:23],a[192:195],v[128:131],0
buffer_load_dwordx4 v237,s[96:99],s28 offen offset:1024 lds
v_mfma_f32_16x16x32_bf16 v[20:23],a[196:199],v[132:135],v[20:23]
buffer_load_dwordx4 v238,s[96:99],s28 offen offset:2048 lds
v_mfma_f32_16x16x32_bf16 v[20:23],a[200:203],v[136:139],v[20:23]
ds_read_b64_tr_b16 a[232:233],v246 offset:57344
ds_read_b64_tr_b16 a[234:235],v246 offset:59392
v_mfma_f32_16x16x32_bf16 v[20:23],a[204:207],v[140:143],v[20:23]
buffer_load_dwordx4 v239,s[96:99],s28 offen offset:3072 lds
v_mfma_f32_16x16x32_bf16 v[24:27],a[192:195],v[144:147],0
v_cvt_pk_bf16_f32 v64,v64,v65
v_cvt_pk_bf16_f32 v65,v66,v67
v_mfma_f32_16x16x32_bf16 v[24:27],a[196:199],v[148:151],v[24:27]
ds_read_b64_tr_b16 a[236:237],v246 offset:61440
ds_read_b64_tr_b16 a[238:239],v246 offset:63488
v_mfma_f32_16x16x32_bf16 v[24:27],a[200:203],v[152:155],v[24:27]
v_cvt_pk_bf16_f32 v66,v76,v77
v_cvt_pk_bf16_f32 v67,v78,v79
v_mfma_f32_16x16x32_bf16 v[24:27],a[204:207],v[156:159],v[24:27]
buffer_store_dwordx4 v[64:67],v248,s[20:23],s62 offen sc0 sc1
v_mfma_f32_16x16x32_bf16 v[28:31],a[208:211],v[112:115],0
ds_read_b64_tr_b16 a[240:241],v247 offset:49152
ds_read_b64_tr_b16 a[242:243],v247 offset:51200
v_mfma_f32_16x16x32_bf16 v[28:31],a[212:215],v[116:119],v[28:31]
v_cvt_pk_bf16_f32 v68,v68,v69
s_waitcnt lgkmcnt(4)
v_mfma_f32_16x16x32_bf16 v[28:31],a[216:219],v[120:123],v[28:31]
v_cvt_pk_bf16_f32 v69,v70,v71
v_cvt_pk_bf16_f32 v70,v80,v81
v_mfma_f32_16x16x32_bf16 v[28:31],a[220:223],v[124:127],v[28:31]
ds_read_b64_tr_b16 a[244:245],v247 offset:53248
ds_read_b64_tr_b16 a[246:247],v247 offset:55296
v_mfma_f32_16x16x32_bf16 v[32:35],a[208:211],v[128:131],0
v_cvt_pk_bf16_f32 v71,v82,v83
v_mfma_f32_16x16x32_bf16 v[32:35],a[212:215],v[132:135],v[32:35]
buffer_store_dwordx4 v[68:71],v248,s[20:23],s63 offen sc0 sc1
v_mfma_f32_16x16x32_bf16 v[32:35],a[216:219],v[136:139],v[32:35]
ds_read_b64_tr_b16 a[248:249],v247 offset:57344
ds_read_b64_tr_b16 a[250:251],v247 offset:59392
v_mfma_f32_16x16x32_bf16 v[32:35],a[220:223],v[140:143],v[32:35]
v_cvt_pk_bf16_f32 v72,v72,v73
v_cvt_pk_bf16_f32 v73,v74,v75
v_mfma_f32_16x16x32_bf16 v[36:39],a[208:211],v[144:147],0
v_cvt_pk_bf16_f32 v74,v84,v85
v_cvt_pk_bf16_f32 v75,v86,v87
v_mfma_f32_16x16x32_bf16 v[36:39],a[212:215],v[148:151],v[36:39]
ds_read_b64_tr_b16 a[252:253],v247 offset:61440
ds_read_b64_tr_b16 a[254:255],v247 offset:63488
v_mfma_f32_16x16x32_bf16 v[36:39],a[216:219],v[152:155],v[36:39]
buffer_store_dwordx4 v[72:75],v248,s[20:23],s64 offen sc0 sc1
v_mfma_f32_16x16x32_bf16 v[36:39],a[220:223],v[156:159],v[36:39]
v_mfma_f32_16x16x32_bf16 v[40:43],a[224:227],v[112:115],0
ds_read_b64_tr_b16 a[192:193],v240 offset:0
ds_read_b64_tr_b16 a[194:195],v240 offset:2048
v_mfma_f32_16x16x32_bf16 v[40:43],a[228:231],v[116:119],v[40:43]
v_mfma_f32_16x16x32_bf16 v[40:43],a[232:235],v[120:123],v[40:43]
s_waitcnt lgkmcnt(4)
v_mfma_f32_16x16x32_bf16 v[40:43],a[236:239],v[124:127],v[40:43]
ds_read_b64_tr_b16 a[196:197],v240 offset:4096
ds_read_b64_tr_b16 a[198:199],v240 offset:6144
v_mfma_f32_16x16x32_bf16 v[44:47],a[224:227],v[128:131],0
v_mfma_f32_16x16x32_bf16 v[44:47],a[228:231],v[132:135],v[44:47]
v_mfma_f32_16x16x32_bf16 v[44:47],a[232:235],v[136:139],v[44:47]
ds_read_b64_tr_b16 a[200:201],v240 offset:8192
ds_read_b64_tr_b16 a[202:203],v240 offset:10240
v_mfma_f32_16x16x32_bf16 v[44:47],a[236:239],v[140:143],v[44:47]
v_mfma_f32_16x16x32_bf16 v[48:51],a[224:227],v[144:147],0
v_mfma_f32_16x16x32_bf16 v[48:51],a[228:231],v[148:151],v[48:51]
ds_read_b64_tr_b16 a[204:205],v240 offset:12288
ds_read_b64_tr_b16 a[206:207],v240 offset:14336
v_mfma_f32_16x16x32_bf16 v[48:51],a[232:235],v[152:155],v[48:51]
v_mfma_f32_16x16x32_bf16 v[48:51],a[236:239],v[156:159],v[48:51]
v_mfma_f32_16x16x32_bf16 v[52:55],a[240:243],v[112:115],0
ds_read_b64_tr_b16 a[208:209],v241 offset:0
ds_read_b64_tr_b16 a[210:211],v241 offset:2048
v_mfma_f32_16x16x32_bf16 v[52:55],a[244:247],v[116:119],v[52:55]
v_mfma_f32_16x16x32_bf16 v[52:55],a[248:251],v[120:123],v[52:55]
s_waitcnt lgkmcnt(10)
v_mfma_f32_16x16x32_bf16 v[52:55],a[252:255],v[124:127],v[52:55]
ds_read_b64_tr_b16 a[212:213],v241 offset:4096
ds_read_b64_tr_b16 a[214:215],v241 offset:6144
v_mfma_f32_16x16x32_bf16 v[56:59],a[240:243],v[128:131],0
v_mfma_f32_16x16x32_bf16 v[56:59],a[244:247],v[132:135],v[56:59]
v_mfma_f32_16x16x32_bf16 v[56:59],a[248:251],v[136:139],v[56:59]
ds_read_b64_tr_b16 a[216:217],v241 offset:8192
ds_read_b64_tr_b16 a[218:219],v241 offset:10240
v_mfma_f32_16x16x32_bf16 v[56:59],a[252:255],v[140:143],v[56:59]
v_mfma_f32_16x16x32_bf16 v[60:63],a[240:243],v[144:147],0
v_mfma_f32_16x16x32_bf16 v[60:63],a[244:247],v[148:151],v[60:63]
ds_read_b64_tr_b16 a[220:221],v241 offset:12288
ds_read_b64_tr_b16 a[222:223],v241 offset:14336
v_mfma_f32_16x16x32_bf16 v[60:63],a[248:251],v[152:155],v[60:63]
v_mfma_f32_16x16x32_bf16 v[60:63],a[252:255],v[156:159],v[60:63]
s_waitcnt vmcnt(29)
s_barrier
s_waitcnt lgkmcnt(4)
v_mfma_f32_16x16x32_bf16 v[16:19],a[192:195],v[160:163],v[16:19]
ds_read_b64_tr_b16 a[224:225],v242 offset:0
ds_read_b64_tr_b16 a[226:227],v242 offset:2048
v_mfma_f32_16x16x32_bf16 v[16:19],a[196:199],v[164:167],v[16:19]
s_add_u32 m0,s25,49152
s_add_u32 s28,s67,768
v_mfma_f32_16x16x32_bf16 v[16:19],a[200:203],v[168:171],v[16:19]
buffer_load_dwordx4 v236,s[96:99],s28 offen lds
v_mfma_f32_16x16x32_bf16 v[16:19],a[204:207],v[172:175],v[16:19]
ds_read_b64_tr_b16 a[228:229],v242 offset:4096
ds_read_b64_tr_b16 a[230:231],v242 offset:6144
v_mfma_f32_16x16x32_bf16 v[20:23],a[192:195],v[176:179],v[20:23]
buffer_load_dwordx4 v237,s[96:99],s28 offen offset:1024 lds
v_mfma_f32_16x16x32_bf16 v[20:23],a[196:199],v[180:183],v[20:23]
buffer_load_dwordx4 v238,s[96:99],s28 offen offset:2048 lds
v_mfma_f32_16x16x32_bf16 v[20:23],a[200:203],v[184:187],v[20:23]
ds_read_b64_tr_b16 a[232:233],v242 offset:8192
ds_read_b64_tr_b16 a[234:235],v242 offset:10240
v_mfma_f32_16x16x32_bf16 v[20:23],a[204:207],v[188:191],v[20:23]
buffer_load_dwordx4 v239,s[96:99],s28 offen offset:3072 lds
v_mfma_f32_16x16x32_bf16 v[24:27],a[192:195],v[192:195],v[24:27]
v_cvt_pk_bf16_f32 v88,v88,v89
v_cvt_pk_bf16_f32 v89,v90,v91
v_mfma_f32_16x16x32_bf16 v[24:27],a[196:199],v[196:199],v[24:27]
ds_read_b64_tr_b16 a[236:237],v242 offset:12288
ds_read_b64_tr_b16 a[238:239],v242 offset:14336
v_mfma_f32_16x16x32_bf16 v[24:27],a[200:203],v[200:203],v[24:27]
v_cvt_pk_bf16_f32 v90,v100,v101
v_cvt_pk_bf16_f32 v91,v102,v103
v_mfma_f32_16x16x32_bf16 v[24:27],a[204:207],v[204:207],v[24:27]
buffer_store_dwordx4 v[88:91],v249,s[20:23],s62 offen sc0 sc1
v_mfma_f32_16x16x32_bf16 v[28:31],a[208:211],v[160:163],v[28:31]
ds_read_b64_tr_b16 a[240:241],v243 offset:0
ds_read_b64_tr_b16 a[242:243],v243 offset:2048
v_mfma_f32_16x16x32_bf16 v[28:31],a[212:215],v[164:167],v[28:31]
s_add_u32 s62,s62,32768
s_waitcnt lgkmcnt(4)
v_mfma_f32_16x16x32_bf16 v[28:31],a[216:219],v[168:171],v[28:31]
v_cvt_pk_bf16_f32 v92,v92,v93
v_cvt_pk_bf16_f32 v93,v94,v95
v_mfma_f32_16x16x32_bf16 v[28:31],a[220:223],v[172:175],v[28:31]
ds_read_b64_tr_b16 a[244:245],v243 offset:4096
ds_read_b64_tr_b16 a[246:247],v243 offset:6144
v_mfma_f32_16x16x32_bf16 v[32:35],a[208:211],v[176:179],v[32:35]
v_cvt_pk_bf16_f32 v94,v104,v105
v_cvt_pk_bf16_f32 v95,v106,v107
v_mfma_f32_16x16x32_bf16 v[32:35],a[212:215],v[180:183],v[32:35]
buffer_store_dwordx4 v[92:95],v249,s[20:23],s63 offen sc0 sc1
v_mfma_f32_16x16x32_bf16 v[32:35],a[216:219],v[184:187],v[32:35]
ds_read_b64_tr_b16 a[248:249],v243 offset:8192
ds_read_b64_tr_b16 a[250:251],v243 offset:10240
v_mfma_f32_16x16x32_bf16 v[32:35],a[220:223],v[188:191],v[32:35]
s_add_u32 s63,s63,32768
v_cvt_pk_bf16_f32 v96,v96,v97
v_mfma_f32_16x16x32_bf16 v[36:39],a[208:211],v[192:195],v[36:39]
v_cvt_pk_bf16_f32 v97,v98,v99
v_cvt_pk_bf16_f32 v98,v108,v109
v_mfma_f32_16x16x32_bf16 v[36:39],a[212:215],v[196:199],v[36:39]
ds_read_b64_tr_b16 a[252:253],v243 offset:12288
ds_read_b64_tr_b16 a[254:255],v243 offset:14336
v_mfma_f32_16x16x32_bf16 v[36:39],a[216:219],v[200:203],v[36:39]
v_cvt_pk_bf16_f32 v99,v110,v111
v_mfma_f32_16x16x32_bf16 v[36:39],a[220:223],v[204:207],v[36:39]
buffer_store_dwordx4 v[96:99],v249,s[20:23],s64 offen sc0 sc1
v_mfma_f32_16x16x32_bf16 v[40:43],a[224:227],v[160:163],v[40:43]
ds_read_b64_tr_b16 a[192:193],v240 offset:16384
ds_read_b64_tr_b16 a[194:195],v240 offset:18432
v_mfma_f32_16x16x32_bf16 v[40:43],a[228:231],v[164:167],v[40:43]
s_add_u32 s64,s64,32768
v_mfma_f32_16x16x32_bf16 v[40:43],a[232:235],v[168:171],v[40:43]
s_waitcnt lgkmcnt(4)
v_mfma_f32_16x16x32_bf16 v[40:43],a[236:239],v[172:175],v[40:43]
ds_read_b64_tr_b16 a[196:197],v240 offset:20480
ds_read_b64_tr_b16 a[198:199],v240 offset:22528
v_mfma_f32_16x16x32_bf16 v[44:47],a[224:227],v[176:179],v[44:47]
v_mfma_f32_16x16x32_bf16 v[44:47],a[228:231],v[180:183],v[44:47]
v_mfma_f32_16x16x32_bf16 v[44:47],a[232:235],v[184:187],v[44:47]
ds_read_b64_tr_b16 a[200:201],v240 offset:24576
ds_read_b64_tr_b16 a[202:203],v240 offset:26624
v_mfma_f32_16x16x32_bf16 v[44:47],a[236:239],v[188:191],v[44:47]
v_mfma_f32_16x16x32_bf16 v[48:51],a[224:227],v[192:195],v[48:51]
v_mfma_f32_16x16x32_bf16 v[48:51],a[228:231],v[196:199],v[48:51]
ds_read_b64_tr_b16 a[204:205],v240 offset:28672
ds_read_b64_tr_b16 a[206:207],v240 offset:30720
v_mfma_f32_16x16x32_bf16 v[48:51],a[232:235],v[200:203],v[48:51]
v_mfma_f32_16x16x32_bf16 v[48:51],a[236:239],v[204:207],v[48:51]
v_mfma_f32_16x16x32_bf16 v[52:55],a[240:243],v[160:163],v[52:55]
ds_read_b64_tr_b16 a[208:209],v241 offset:16384
ds_read_b64_tr_b16 a[210:211],v241 offset:18432
v_mfma_f32_16x16x32_bf16 v[52:55],a[244:247],v[164:167],v[52:55]
v_mfma_f32_16x16x32_bf16 v[52:55],a[248:251],v[168:171],v[52:55]
s_waitcnt lgkmcnt(10)
v_mfma_f32_16x16x32_bf16 v[52:55],a[252:255],v[172:175],v[52:55]
ds_read_b64_tr_b16 a[212:213],v241 offset:20480
ds_read_b64_tr_b16 a[214:215],v241 offset:22528
v_mfma_f32_16x16x32_bf16 v[56:59],a[240:243],v[176:179],v[56:59]
v_mfma_f32_16x16x32_bf16 v[56:59],a[244:247],v[180:183],v[56:59]
v_mfma_f32_16x16x32_bf16 v[56:59],a[248:251],v[184:187],v[56:59]
ds_read_b64_tr_b16 a[216:217],v241 offset:24576
ds_read_b64_tr_b16 a[218:219],v241 offset:26624
v_mfma_f32_16x16x32_bf16 v[56:59],a[252:255],v[188:191],v[56:59]
v_mfma_f32_16x16x32_bf16 v[60:63],a[240:243],v[192:195],v[60:63]
v_mfma_f32_16x16x32_bf16 v[60:63],a[244:247],v[196:199],v[60:63]
ds_read_b64_tr_b16 a[220:221],v241 offset:28672
ds_read_b64_tr_b16 a[222:223],v241 offset:30720
v_mfma_f32_16x16x32_bf16 v[60:63],a[248:251],v[200:203],v[60:63]
v_mfma_f32_16x16x32_bf16 v[60:63],a[252:255],v[204:207],v[60:63]
s_waitcnt vmcnt(32)
s_barrier
s_waitcnt lgkmcnt(4)
v_mfma_f32_16x16x32_bf16 v[64:67],a[192:195],v[112:115],0
ds_read_b64_tr_b16 a[224:225],v242 offset:16384
ds_read_b64_tr_b16 a[226:227],v242 offset:18432
v_mfma_f32_16x16x32_bf16 v[64:67],a[196:199],v[116:119],v[64:67]
s_add_u32 m0,s25,81920
s_add_u32 s28,s67,115456
v_mfma_f32_16x16x32_bf16 v[64:67],a[200:203],v[120:123],v[64:67]
buffer_load_dwordx4 v236,s[96:99],s28 offen lds
v_mfma_f32_16x16x32_bf16 v[64:67],a[204:207],v[124:127],v[64:67]
ds_read_b64_tr_b16 a[228:229],v242 offset:20480
ds_read_b64_tr_b16 a[230:231],v242 offset:22528
v_mfma_f32_16x16x32_bf16 v[68:71],a[192:195],v[128:131],0
buffer_load_dwordx4 v237,s[96:99],s28 offen offset:1024 lds
v_mfma_f32_16x16x32_bf16 v[68:71],a[196:199],v[132:135],v[68:71]
buffer_load_dwordx4 v238,s[96:99],s28 offen offset:2048 lds
v_mfma_f32_16x16x32_bf16 v[68:71],a[200:203],v[136:139],v[68:71]
ds_read_b64_tr_b16 a[232:233],v242 offset:24576
ds_read_b64_tr_b16 a[234:235],v242 offset:26624
v_mfma_f32_16x16x32_bf16 v[68:71],a[204:207],v[140:143],v[68:71]
buffer_load_dwordx4 v239,s[96:99],s28 offen offset:3072 lds
v_mfma_f32_16x16x32_bf16 v[72:75],a[192:195],v[144:147],0
v_cvt_pk_bf16_f32 v16,v16,v17
v_cvt_pk_bf16_f32 v17,v18,v19
v_mfma_f32_16x16x32_bf16 v[72:75],a[196:199],v[148:151],v[72:75]
ds_read_b64_tr_b16 a[236:237],v242 offset:28672
ds_read_b64_tr_b16 a[238:239],v242 offset:30720
v_mfma_f32_16x16x32_bf16 v[72:75],a[200:203],v[152:155],v[72:75]
v_cvt_pk_bf16_f32 v18,v28,v29
v_cvt_pk_bf16_f32 v19,v30,v31
v_mfma_f32_16x16x32_bf16 v[72:75],a[204:207],v[156:159],v[72:75]
buffer_store_dwordx4 v[16:19],v248,s[20:23],s62 offen sc0 sc1
v_mfma_f32_16x16x32_bf16 v[76:79],a[208:211],v[112:115],0
ds_read_b64_tr_b16 a[240:241],v243 offset:16384
ds_read_b64_tr_b16 a[242:243],v243 offset:18432
v_mfma_f32_16x16x32_bf16 v[76:79],a[212:215],v[116:119],v[76:79]
v_cvt_pk_bf16_f32 v20,v20,v21
s_waitcnt lgkmcnt(4)
v_mfma_f32_16x16x32_bf16 v[76:79],a[216:219],v[120:123],v[76:79]
v_cvt_pk_bf16_f32 v21,v22,v23
v_cvt_pk_bf16_f32 v22,v32,v33
v_mfma_f32_16x16x32_bf16 v[76:79],a[220:223],v[124:127],v[76:79]
ds_read_b64_tr_b16 a[244:245],v243 offset:20480
ds_read_b64_tr_b16 a[246:247],v243 offset:22528
v_mfma_f32_16x16x32_bf16 v[80:83],a[208:211],v[128:131],0
v_cvt_pk_bf16_f32 v23,v34,v35
v_mfma_f32_16x16x32_bf16 v[80:83],a[212:215],v[132:135],v[80:83]
buffer_store_dwordx4 v[20:23],v248,s[20:23],s63 offen sc0 sc1
v_mfma_f32_16x16x32_bf16 v[80:83],a[216:219],v[136:139],v[80:83]
ds_read_b64_tr_b16 a[248:249],v243 offset:24576
ds_read_b64_tr_b16 a[250:251],v243 offset:26624
v_mfma_f32_16x16x32_bf16 v[80:83],a[220:223],v[140:143],v[80:83]
v_cvt_pk_bf16_f32 v24,v24,v25
v_cvt_pk_bf16_f32 v25,v26,v27
v_mfma_f32_16x16x32_bf16 v[84:87],a[208:211],v[144:147],0
v_cvt_pk_bf16_f32 v26,v36,v37
v_cvt_pk_bf16_f32 v27,v38,v39
v_mfma_f32_16x16x32_bf16 v[84:87],a[212:215],v[148:151],v[84:87]
ds_read_b64_tr_b16 a[252:253],v243 offset:28672
ds_read_b64_tr_b16 a[254:255],v243 offset:30720
v_mfma_f32_16x16x32_bf16 v[84:87],a[216:219],v[152:155],v[84:87]
buffer_store_dwordx4 v[24:27],v248,s[20:23],s64 offen sc0 sc1
v_mfma_f32_16x16x32_bf16 v[84:87],a[220:223],v[156:159],v[84:87]
v_mfma_f32_16x16x32_bf16 v[88:91],a[224:227],v[112:115],0
ds_read_b64_tr_b16 a[192:193],v240 offset:32768
ds_read_b64_tr_b16 a[194:195],v240 offset:34816
v_mfma_f32_16x16x32_bf16 v[88:91],a[228:231],v[116:119],v[88:91]
v_mfma_f32_16x16x32_bf16 v[88:91],a[232:235],v[120:123],v[88:91]
s_waitcnt lgkmcnt(4)
v_mfma_f32_16x16x32_bf16 v[88:91],a[236:239],v[124:127],v[88:91]
ds_read_b64_tr_b16 a[196:197],v240 offset:36864
ds_read_b64_tr_b16 a[198:199],v240 offset:38912
v_mfma_f32_16x16x32_bf16 v[92:95],a[224:227],v[128:131],0
v_mfma_f32_16x16x32_bf16 v[92:95],a[228:231],v[132:135],v[92:95]
v_mfma_f32_16x16x32_bf16 v[92:95],a[232:235],v[136:139],v[92:95]
ds_read_b64_tr_b16 a[200:201],v240 offset:40960
ds_read_b64_tr_b16 a[202:203],v240 offset:43008
v_mfma_f32_16x16x32_bf16 v[92:95],a[236:239],v[140:143],v[92:95]
v_mfma_f32_16x16x32_bf16 v[96:99],a[224:227],v[144:147],0
v_mfma_f32_16x16x32_bf16 v[96:99],a[228:231],v[148:151],v[96:99]
ds_read_b64_tr_b16 a[204:205],v240 offset:45056
ds_read_b64_tr_b16 a[206:207],v240 offset:47104
v_mfma_f32_16x16x32_bf16 v[96:99],a[232:235],v[152:155],v[96:99]
v_mfma_f32_16x16x32_bf16 v[96:99],a[236:239],v[156:159],v[96:99]
v_mfma_f32_16x16x32_bf16 v[100:103],a[240:243],v[112:115],0
ds_read_b64_tr_b16 a[208:209],v241 offset:32768
ds_read_b64_tr_b16 a[210:211],v241 offset:34816
v_mfma_f32_16x16x32_bf16 v[100:103],a[244:247],v[116:119],v[100:103]
v_mfma_f32_16x16x32_bf16 v[100:103],a[248:251],v[120:123],v[100:103]
s_waitcnt lgkmcnt(10)
v_mfma_f32_16x16x32_bf16 v[100:103],a[252:255],v[124:127],v[100:103]
ds_read_b64_tr_b16 a[212:213],v241 offset:36864
ds_read_b64_tr_b16 a[214:215],v241 offset:38912
v_mfma_f32_16x16x32_bf16 v[104:107],a[240:243],v[128:131],0
v_mfma_f32_16x16x32_bf16 v[104:107],a[244:247],v[132:135],v[104:107]
v_mfma_f32_16x16x32_bf16 v[104:107],a[248:251],v[136:139],v[104:107]
ds_read_b64_tr_b16 a[216:217],v241 offset:40960
ds_read_b64_tr_b16 a[218:219],v241 offset:43008
v_mfma_f32_16x16x32_bf16 v[104:107],a[252:255],v[140:143],v[104:107]
v_mfma_f32_16x16x32_bf16 v[108:111],a[240:243],v[144:147],0
v_mfma_f32_16x16x32_bf16 v[108:111],a[244:247],v[148:151],v[108:111]
ds_read_b64_tr_b16 a[220:221],v241 offset:45056
ds_read_b64_tr_b16 a[222:223],v241 offset:47104
v_mfma_f32_16x16x32_bf16 v[108:111],a[248:251],v[152:155],v[108:111]
v_mfma_f32_16x16x32_bf16 v[108:111],a[252:255],v[156:159],v[108:111]
s_waitcnt vmcnt(35)
s_barrier
s_waitcnt lgkmcnt(4)
v_mfma_f32_16x16x32_bf16 v[64:67],a[192:195],v[160:163],v[64:67]
ds_read_b64_tr_b16 a[224:225],v242 offset:32768
ds_read_b64_tr_b16 a[226:227],v242 offset:34816
v_mfma_f32_16x16x32_bf16 v[64:67],a[196:199],v[164:167],v[64:67]
v_mfma_f32_16x16x32_bf16 v[64:67],a[200:203],v[168:171],v[64:67]
v_mfma_f32_16x16x32_bf16 v[64:67],a[204:207],v[172:175],v[64:67]
ds_read_b64_tr_b16 a[228:229],v242 offset:36864
ds_read_b64_tr_b16 a[230:231],v242 offset:38912
v_mfma_f32_16x16x32_bf16 v[68:71],a[192:195],v[176:179],v[68:71]
v_cvt_pk_bf16_f32 v40,v40,v41
v_cvt_pk_bf16_f32 v41,v42,v43
v_mfma_f32_16x16x32_bf16 v[68:71],a[196:199],v[180:183],v[68:71]
v_cvt_pk_bf16_f32 v42,v52,v53
v_cvt_pk_bf16_f32 v43,v54,v55
v_mfma_f32_16x16x32_bf16 v[68:71],a[200:203],v[184:187],v[68:71]
ds_read_b64_tr_b16 a[232:233],v242 offset:40960
ds_read_b64_tr_b16 a[234:235],v242 offset:43008
v_mfma_f32_16x16x32_bf16 v[68:71],a[204:207],v[188:191],v[68:71]
buffer_store_dwordx4 v[40:43],v249,s[20:23],s62 offen sc0 sc1
v_mfma_f32_16x16x32_bf16 v[72:75],a[192:195],v[192:195],v[72:75]
s_add_u32 s62,s62,32768
v_cvt_pk_bf16_f32 v44,v44,v45
v_mfma_f32_16x16x32_bf16 v[72:75],a[196:199],v[196:199],v[72:75]
ds_read_b64_tr_b16 a[236:237],v242 offset:45056
ds_read_b64_tr_b16 a[238:239],v242 offset:47104
v_mfma_f32_16x16x32_bf16 v[72:75],a[200:203],v[200:203],v[72:75]
v_cvt_pk_bf16_f32 v45,v46,v47
v_cvt_pk_bf16_f32 v46,v56,v57
v_mfma_f32_16x16x32_bf16 v[72:75],a[204:207],v[204:207],v[72:75]
v_cvt_pk_bf16_f32 v47,v58,v59
v_mfma_f32_16x16x32_bf16 v[76:79],a[208:211],v[160:163],v[76:79]
ds_read_b64_tr_b16 a[240:241],v243 offset:32768
ds_read_b64_tr_b16 a[242:243],v243 offset:34816
v_mfma_f32_16x16x32_bf16 v[76:79],a[212:215],v[164:167],v[76:79]
s_waitcnt lgkmcnt(4)
v_mfma_f32_16x16x32_bf16 v[76:79],a[216:219],v[168:171],v[76:79]
buffer_store_dwordx4 v[44:47],v249,s[20:23],s63 offen sc0 sc1
v_mfma_f32_16x16x32_bf16 v[76:79],a[220:223],v[172:175],v[76:79]
ds_read_b64_tr_b16 a[244:245],v243 offset:36864
ds_read_b64_tr_b16 a[246:247],v243 offset:38912
v_mfma_f32_16x16x32_bf16 v[80:83],a[208:211],v[176:179],v[80:83]
s_add_u32 s63,s63,32768
v_cvt_pk_bf16_f32 v48,v48,v49
v_mfma_f32_16x16x32_bf16 v[80:83],a[212:215],v[180:183],v[80:83]
v_cvt_pk_bf16_f32 v49,v50,v51
v_cvt_pk_bf16_f32 v50,v60,v61
v_mfma_f32_16x16x32_bf16 v[80:83],a[216:219],v[184:187],v[80:83]
ds_read_b64_tr_b16 a[248:249],v243 offset:40960
ds_read_b64_tr_b16 a[250:251],v243 offset:43008
v_mfma_f32_16x16x32_bf16 v[80:83],a[220:223],v[188:191],v[80:83]
v_cvt_pk_bf16_f32 v51,v62,v63
v_mfma_f32_16x16x32_bf16 v[84:87],a[208:211],v[192:195],v[84:87]
buffer_store_dwordx4 v[48:51],v249,s[20:23],s64 offen sc0 sc1
v_mfma_f32_16x16x32_bf16 v[84:87],a[212:215],v[196:199],v[84:87]
ds_read_b64_tr_b16 a[252:253],v243 offset:45056
ds_read_b64_tr_b16 a[254:255],v243 offset:47104
v_mfma_f32_16x16x32_bf16 v[84:87],a[216:219],v[200:203],v[84:87]
s_add_u32 s64,s64,32768
v_mfma_f32_16x16x32_bf16 v[84:87],a[220:223],v[204:207],v[84:87]
v_mfma_f32_16x16x32_bf16 v[88:91],a[224:227],v[160:163],v[88:91]
ds_read_b64_tr_b16 a[192:193],v240 offset:49152
ds_read_b64_tr_b16 a[194:195],v240 offset:51200
v_mfma_f32_16x16x32_bf16 v[88:91],a[228:231],v[164:167],v[88:91]
v_mfma_f32_16x16x32_bf16 v[88:91],a[232:235],v[168:171],v[88:91]
s_waitcnt lgkmcnt(4)
v_mfma_f32_16x16x32_bf16 v[88:91],a[236:239],v[172:175],v[88:91]
ds_read_b64_tr_b16 a[196:197],v240 offset:53248
ds_read_b64_tr_b16 a[198:199],v240 offset:55296
v_mfma_f32_16x16x32_bf16 v[92:95],a[224:227],v[176:179],v[92:95]
v_mfma_f32_16x16x32_bf16 v[92:95],a[228:231],v[180:183],v[92:95]
v_mfma_f32_16x16x32_bf16 v[92:95],a[232:235],v[184:187],v[92:95]
ds_read_b64_tr_b16 a[200:201],v240 offset:57344
ds_read_b64_tr_b16 a[202:203],v240 offset:59392
v_mfma_f32_16x16x32_bf16 v[92:95],a[236:239],v[188:191],v[92:95]
v_mfma_f32_16x16x32_bf16 v[96:99],a[224:227],v[192:195],v[96:99]
v_mfma_f32_16x16x32_bf16 v[96:99],a[228:231],v[196:199],v[96:99]
ds_read_b64_tr_b16 a[204:205],v240 offset:61440
ds_read_b64_tr_b16 a[206:207],v240 offset:63488
v_mfma_f32_16x16x32_bf16 v[96:99],a[232:235],v[200:203],v[96:99]
v_mfma_f32_16x16x32_bf16 v[96:99],a[236:239],v[204:207],v[96:99]
v_mfma_f32_16x16x32_bf16 v[100:103],a[240:243],v[160:163],v[100:103]
ds_read_b64_tr_b16 a[208:209],v241 offset:49152
ds_read_b64_tr_b16 a[210:211],v241 offset:51200
v_mfma_f32_16x16x32_bf16 v[100:103],a[244:247],v[164:167],v[100:103]
v_mfma_f32_16x16x32_bf16 v[100:103],a[248:251],v[168:171],v[100:103]
s_waitcnt lgkmcnt(10)
v_mfma_f32_16x16x32_bf16 v[100:103],a[252:255],v[172:175],v[100:103]
ds_read_b64_tr_b16 a[212:213],v241 offset:53248
ds_read_b64_tr_b16 a[214:215],v241 offset:55296
v_mfma_f32_16x16x32_bf16 v[104:107],a[240:243],v[176:179],v[104:107]
v_mfma_f32_16x16x32_bf16 v[104:107],a[244:247],v[180:183],v[104:107]
v_mfma_f32_16x16x32_bf16 v[104:107],a[248:251],v[184:187],v[104:107]
ds_read_b64_tr_b16 a[216:217],v241 offset:57344
ds_read_b64_tr_b16 a[218:219],v241 offset:59392
v_mfma_f32_16x16x32_bf16 v[104:107],a[252:255],v[188:191],v[104:107]
v_mfma_f32_16x16x32_bf16 v[108:111],a[240:243],v[192:195],v[108:111]
v_mfma_f32_16x16x32_bf16 v[108:111],a[244:247],v[196:199],v[108:111]
ds_read_b64_tr_b16 a[220:221],v241 offset:61440
ds_read_b64_tr_b16 a[222:223],v241 offset:63488
v_mfma_f32_16x16x32_bf16 v[108:111],a[248:251],v[200:203],v[108:111]
v_mfma_f32_16x16x32_bf16 v[108:111],a[252:255],v[204:207],v[108:111]
s_waitcnt vmcnt(34)
s_barrier
s_waitcnt lgkmcnt(4)
v_mfma_f32_16x16x32_bf16 v[16:19],a[192:195],v[112:115],0
ds_read_b64_tr_b16 a[224:225],v242 offset:49152
ds_read_b64_tr_b16 a[226:227],v242 offset:51200
v_mfma_f32_16x16x32_bf16 v[16:19],a[196:199],v[116:119],v[16:19]
v_mfma_f32_16x16x32_bf16 v[16:19],a[200:203],v[120:123],v[16:19]
v_mfma_f32_16x16x32_bf16 v[16:19],a[204:207],v[124:127],v[16:19]
ds_read_b64_tr_b16 a[228:229],v242 offset:53248
ds_read_b64_tr_b16 a[230:231],v242 offset:55296
v_mfma_f32_16x16x32_bf16 v[20:23],a[192:195],v[128:131],0
v_cvt_pk_bf16_f32 v64,v64,v65
v_cvt_pk_bf16_f32 v65,v66,v67
v_mfma_f32_16x16x32_bf16 v[20:23],a[196:199],v[132:135],v[20:23]
v_cvt_pk_bf16_f32 v66,v76,v77
v_cvt_pk_bf16_f32 v67,v78,v79
v_mfma_f32_16x16x32_bf16 v[20:23],a[200:203],v[136:139],v[20:23]
ds_read_b64_tr_b16 a[232:233],v242 offset:57344
ds_read_b64_tr_b16 a[234:235],v242 offset:59392
v_mfma_f32_16x16x32_bf16 v[20:23],a[204:207],v[140:143],v[20:23]
buffer_store_dwordx4 v[64:67],v248,s[20:23],s62 offen sc0 sc1
v_mfma_f32_16x16x32_bf16 v[24:27],a[192:195],v[144:147],0
v_cvt_pk_bf16_f32 v68,v68,v69
v_cvt_pk_bf16_f32 v69,v70,v71
v_mfma_f32_16x16x32_bf16 v[24:27],a[196:199],v[148:151],v[24:27]
ds_read_b64_tr_b16 a[236:237],v242 offset:61440
ds_read_b64_tr_b16 a[238:239],v242 offset:63488
v_mfma_f32_16x16x32_bf16 v[24:27],a[200:203],v[152:155],v[24:27]
v_cvt_pk_bf16_f32 v70,v80,v81
v_cvt_pk_bf16_f32 v71,v82,v83
v_mfma_f32_16x16x32_bf16 v[24:27],a[204:207],v[156:159],v[24:27]
buffer_store_dwordx4 v[68:71],v248,s[20:23],s63 offen sc0 sc1
v_mfma_f32_16x16x32_bf16 v[28:31],a[208:211],v[112:115],0
ds_read_b64_tr_b16 a[240:241],v243 offset:49152
ds_read_b64_tr_b16 a[242:243],v243 offset:51200
v_mfma_f32_16x16x32_bf16 v[28:31],a[212:215],v[116:119],v[28:31]
v_cvt_pk_bf16_f32 v72,v72,v73
s_waitcnt lgkmcnt(4)
v_mfma_f32_16x16x32_bf16 v[28:31],a[216:219],v[120:123],v[28:31]
v_cvt_pk_bf16_f32 v73,v74,v75
v_cvt_pk_bf16_f32 v74,v84,v85
v_mfma_f32_16x16x32_bf16 v[28:31],a[220:223],v[124:127],v[28:31]
ds_read_b64_tr_b16 a[244:245],v243 offset:53248
ds_read_b64_tr_b16 a[246:247],v243 offset:55296
v_mfma_f32_16x16x32_bf16 v[32:35],a[208:211],v[128:131],0
v_cvt_pk_bf16_f32 v75,v86,v87
v_mfma_f32_16x16x32_bf16 v[32:35],a[212:215],v[132:135],v[32:35]
buffer_store_dwordx4 v[72:75],v248,s[20:23],s64 offen sc0 sc1
v_mfma_f32_16x16x32_bf16 v[32:35],a[216:219],v[136:139],v[32:35]
ds_read_b64_tr_b16 a[248:249],v243 offset:57344
ds_read_b64_tr_b16 a[250:251],v243 offset:59392
v_mfma_f32_16x16x32_bf16 v[32:35],a[220:223],v[140:143],v[32:35]
v_mfma_f32_16x16x32_bf16 v[36:39],a[208:211],v[144:147],0
v_mfma_f32_16x16x32_bf16 v[36:39],a[212:215],v[148:151],v[36:39]
ds_read_b64_tr_b16 a[252:253],v243 offset:61440
ds_read_b64_tr_b16 a[254:255],v243 offset:63488
v_mfma_f32_16x16x32_bf16 v[36:39],a[216:219],v[152:155],v[36:39]
v_mfma_f32_16x16x32_bf16 v[36:39],a[220:223],v[156:159],v[36:39]
v_mfma_f32_16x16x32_bf16 v[40:43],a[224:227],v[112:115],0
ds_read_b64_tr_b16 a[192:193],v244 offset:0
ds_read_b64_tr_b16 a[194:195],v244 offset:2048
v_mfma_f32_16x16x32_bf16 v[40:43],a[228:231],v[116:119],v[40:43]
v_mfma_f32_16x16x32_bf16 v[40:43],a[232:235],v[120:123],v[40:43]
s_waitcnt lgkmcnt(4)
v_mfma_f32_16x16x32_bf16 v[40:43],a[236:239],v[124:127],v[40:43]
ds_read_b64_tr_b16 a[196:197],v244 offset:4096
ds_read_b64_tr_b16 a[198:199],v244 offset:6144
v_mfma_f32_16x16x32_bf16 v[44:47],a[224:227],v[128:131],0
v_mfma_f32_16x16x32_bf16 v[44:47],a[228:231],v[132:135],v[44:47]
v_mfma_f32_16x16x32_bf16 v[44:47],a[232:235],v[136:139],v[44:47]
ds_read_b64_tr_b16 a[200:201],v244 offset:8192
ds_read_b64_tr_b16 a[202:203],v244 offset:10240
v_mfma_f32_16x16x32_bf16 v[44:47],a[236:239],v[140:143],v[44:47]
v_mfma_f32_16x16x32_bf16 v[48:51],a[224:227],v[144:147],0
v_mfma_f32_16x16x32_bf16 v[48:51],a[228:231],v[148:151],v[48:51]
ds_read_b64_tr_b16 a[204:205],v244 offset:12288
ds_read_b64_tr_b16 a[206:207],v244 offset:14336
v_mfma_f32_16x16x32_bf16 v[48:51],a[232:235],v[152:155],v[48:51]
v_mfma_f32_16x16x32_bf16 v[48:51],a[236:239],v[156:159],v[48:51]
v_mfma_f32_16x16x32_bf16 v[52:55],a[240:243],v[112:115],0
ds_read_b64_tr_b16 a[208:209],v245 offset:0
ds_read_b64_tr_b16 a[210:211],v245 offset:2048
v_mfma_f32_16x16x32_bf16 v[52:55],a[244:247],v[116:119],v[52:55]
v_mfma_f32_16x16x32_bf16 v[52:55],a[248:251],v[120:123],v[52:55]
s_waitcnt lgkmcnt(10)
v_mfma_f32_16x16x32_bf16 v[52:55],a[252:255],v[124:127],v[52:55]
ds_read_b64_tr_b16 a[212:213],v245 offset:4096
ds_read_b64_tr_b16 a[214:215],v245 offset:6144
v_mfma_f32_16x16x32_bf16 v[56:59],a[240:243],v[128:131],0
v_mfma_f32_16x16x32_bf16 v[56:59],a[244:247],v[132:135],v[56:59]
v_mfma_f32_16x16x32_bf16 v[56:59],a[248:251],v[136:139],v[56:59]
ds_read_b64_tr_b16 a[216:217],v245 offset:8192
ds_read_b64_tr_b16 a[218:219],v245 offset:10240
v_mfma_f32_16x16x32_bf16 v[56:59],a[252:255],v[140:143],v[56:59]
v_mfma_f32_16x16x32_bf16 v[60:63],a[240:243],v[144:147],0
v_mfma_f32_16x16x32_bf16 v[60:63],a[244:247],v[148:151],v[60:63]
ds_read_b64_tr_b16 a[220:221],v245 offset:12288
ds_read_b64_tr_b16 a[222:223],v245 offset:14336
v_mfma_f32_16x16x32_bf16 v[60:63],a[248:251],v[152:155],v[60:63]
v_mfma_f32_16x16x32_bf16 v[60:63],a[252:255],v[156:159],v[60:63]
s_waitcnt vmcnt(33)
s_barrier
s_waitcnt lgkmcnt(4)
v_mfma_f32_16x16x32_bf16 v[16:19],a[192:195],v[160:163],v[16:19]
ds_read_b64_tr_b16 a[224:225],v246 offset:0
ds_read_b64_tr_b16 a[226:227],v246 offset:2048
v_mfma_f32_16x16x32_bf16 v[16:19],a[196:199],v[164:167],v[16:19]
v_mfma_f32_16x16x32_bf16 v[16:19],a[200:203],v[168:171],v[16:19]
v_mfma_f32_16x16x32_bf16 v[16:19],a[204:207],v[172:175],v[16:19]
ds_read_b64_tr_b16 a[228:229],v246 offset:4096
ds_read_b64_tr_b16 a[230:231],v246 offset:6144
v_mfma_f32_16x16x32_bf16 v[20:23],a[192:195],v[176:179],v[20:23]
v_cvt_pk_bf16_f32 v88,v88,v89
v_cvt_pk_bf16_f32 v89,v90,v91
v_mfma_f32_16x16x32_bf16 v[20:23],a[196:199],v[180:183],v[20:23]
v_cvt_pk_bf16_f32 v90,v100,v101
v_cvt_pk_bf16_f32 v91,v102,v103
v_mfma_f32_16x16x32_bf16 v[20:23],a[200:203],v[184:187],v[20:23]
ds_read_b64_tr_b16 a[232:233],v246 offset:8192
ds_read_b64_tr_b16 a[234:235],v246 offset:10240
v_mfma_f32_16x16x32_bf16 v[20:23],a[204:207],v[188:191],v[20:23]
buffer_store_dwordx4 v[88:91],v249,s[20:23],s62 offen sc0 sc1
v_mfma_f32_16x16x32_bf16 v[24:27],a[192:195],v[192:195],v[24:27]
s_add_u32 s62,s62,32768
v_cvt_pk_bf16_f32 v92,v92,v93
v_mfma_f32_16x16x32_bf16 v[24:27],a[196:199],v[196:199],v[24:27]
ds_read_b64_tr_b16 a[236:237],v246 offset:12288
ds_read_b64_tr_b16 a[238:239],v246 offset:14336
v_mfma_f32_16x16x32_bf16 v[24:27],a[200:203],v[200:203],v[24:27]
v_cvt_pk_bf16_f32 v93,v94,v95
v_cvt_pk_bf16_f32 v94,v104,v105
v_mfma_f32_16x16x32_bf16 v[24:27],a[204:207],v[204:207],v[24:27]
v_cvt_pk_bf16_f32 v95,v106,v107
v_mfma_f32_16x16x32_bf16 v[28:31],a[208:211],v[160:163],v[28:31]
ds_read_b64_tr_b16 a[240:241],v247 offset:0
ds_read_b64_tr_b16 a[242:243],v247 offset:2048
v_mfma_f32_16x16x32_bf16 v[28:31],a[212:215],v[164:167],v[28:31]
s_waitcnt lgkmcnt(4)
v_mfma_f32_16x16x32_bf16 v[28:31],a[216:219],v[168:171],v[28:31]
buffer_store_dwordx4 v[92:95],v249,s[20:23],s63 offen sc0 sc1
v_mfma_f32_16x16x32_bf16 v[28:31],a[220:223],v[172:175],v[28:31]
ds_read_b64_tr_b16 a[244:245],v247 offset:4096
ds_read_b64_tr_b16 a[246:247],v247 offset:6144
v_mfma_f32_16x16x32_bf16 v[32:35],a[208:211],v[176:179],v[32:35]
s_add_u32 s63,s63,32768
v_cvt_pk_bf16_f32 v96,v96,v97
v_mfma_f32_16x16x32_bf16 v[32:35],a[212:215],v[180:183],v[32:35]
v_cvt_pk_bf16_f32 v97,v98,v99
v_cvt_pk_bf16_f32 v98,v108,v109
v_mfma_f32_16x16x32_bf16 v[32:35],a[216:219],v[184:187],v[32:35]
ds_read_b64_tr_b16 a[248:249],v247 offset:8192
ds_read_b64_tr_b16 a[250:251],v247 offset:10240
v_mfma_f32_16x16x32_bf16 v[32:35],a[220:223],v[188:191],v[32:35]
v_cvt_pk_bf16_f32 v99,v110,v111
v_mfma_f32_16x16x32_bf16 v[36:39],a[208:211],v[192:195],v[36:39]
buffer_store_dwordx4 v[96:99],v249,s[20:23],s64 offen sc0 sc1
v_mfma_f32_16x16x32_bf16 v[36:39],a[212:215],v[196:199],v[36:39]
ds_read_b64_tr_b16 a[252:253],v247 offset:12288
ds_read_b64_tr_b16 a[254:255],v247 offset:14336
v_mfma_f32_16x16x32_bf16 v[36:39],a[216:219],v[200:203],v[36:39]
s_add_u32 s64,s64,32768
v_mfma_f32_16x16x32_bf16 v[36:39],a[220:223],v[204:207],v[36:39]
v_mfma_f32_16x16x32_bf16 v[40:43],a[224:227],v[160:163],v[40:43]
ds_read_b64_tr_b16 a[192:193],v244 offset:16384
ds_read_b64_tr_b16 a[194:195],v244 offset:18432
v_mfma_f32_16x16x32_bf16 v[40:43],a[228:231],v[164:167],v[40:43]
v_mfma_f32_16x16x32_bf16 v[40:43],a[232:235],v[168:171],v[40:43]
s_waitcnt lgkmcnt(4)
v_mfma_f32_16x16x32_bf16 v[40:43],a[236:239],v[172:175],v[40:43]
ds_read_b64_tr_b16 a[196:197],v244 offset:20480
ds_read_b64_tr_b16 a[198:199],v244 offset:22528
v_mfma_f32_16x16x32_bf16 v[44:47],a[224:227],v[176:179],v[44:47]
v_mfma_f32_16x16x32_bf16 v[44:47],a[228:231],v[180:183],v[44:47]
v_mfma_f32_16x16x32_bf16 v[44:47],a[232:235],v[184:187],v[44:47]
ds_read_b64_tr_b16 a[200:201],v244 offset:24576
ds_read_b64_tr_b16 a[202:203],v244 offset:26624
v_mfma_f32_16x16x32_bf16 v[44:47],a[236:239],v[188:191],v[44:47]
v_mfma_f32_16x16x32_bf16 v[48:51],a[224:227],v[192:195],v[48:51]
v_mfma_f32_16x16x32_bf16 v[48:51],a[228:231],v[196:199],v[48:51]
ds_read_b64_tr_b16 a[204:205],v244 offset:28672
ds_read_b64_tr_b16 a[206:207],v244 offset:30720
v_mfma_f32_16x16x32_bf16 v[48:51],a[232:235],v[200:203],v[48:51]
v_mfma_f32_16x16x32_bf16 v[48:51],a[236:239],v[204:207],v[48:51]
v_mfma_f32_16x16x32_bf16 v[52:55],a[240:243],v[160:163],v[52:55]
ds_read_b64_tr_b16 a[208:209],v245 offset:16384
ds_read_b64_tr_b16 a[210:211],v245 offset:18432
v_mfma_f32_16x16x32_bf16 v[52:55],a[244:247],v[164:167],v[52:55]
v_mfma_f32_16x16x32_bf16 v[52:55],a[248:251],v[168:171],v[52:55]
s_waitcnt lgkmcnt(10)
v_mfma_f32_16x16x32_bf16 v[52:55],a[252:255],v[172:175],v[52:55]
ds_read_b64_tr_b16 a[212:213],v245 offset:20480
ds_read_b64_tr_b16 a[214:215],v245 offset:22528
v_mfma_f32_16x16x32_bf16 v[56:59],a[240:243],v[176:179],v[56:59]
v_mfma_f32_16x16x32_bf16 v[56:59],a[244:247],v[180:183],v[56:59]
v_mfma_f32_16x16x32_bf16 v[56:59],a[248:251],v[184:187],v[56:59]
ds_read_b64_tr_b16 a[216:217],v245 offset:24576
ds_read_b64_tr_b16 a[218:219],v245 offset:26624
v_mfma_f32_16x16x32_bf16 v[56:59],a[252:255],v[188:191],v[56:59]
v_mfma_f32_16x16x32_bf16 v[60:63],a[240:243],v[192:195],v[60:63]
v_mfma_f32_16x16x32_bf16 v[60:63],a[244:247],v[196:199],v[60:63]
ds_read_b64_tr_b16 a[220:221],v245 offset:28672
ds_read_b64_tr_b16 a[222:223],v245 offset:30720
v_mfma_f32_16x16x32_bf16 v[60:63],a[248:251],v[200:203],v[60:63]
v_mfma_f32_16x16x32_bf16 v[60:63],a[252:255],v[204:207],v[60:63]
s_waitcnt vmcnt(26)
s_barrier
s_waitcnt lgkmcnt(4)
v_mfma_f32_16x16x32_bf16 v[64:67],a[192:195],v[112:115],0
ds_read_b64_tr_b16 a[224:225],v246 offset:16384
ds_read_b64_tr_b16 a[226:227],v246 offset:18432
v_mfma_f32_16x16x32_bf16 v[64:67],a[196:199],v[116:119],v[64:67]
v_mfma_f32_16x16x32_bf16 v[64:67],a[200:203],v[120:123],v[64:67]
v_mfma_f32_16x16x32_bf16 v[64:67],a[204:207],v[124:127],v[64:67]
ds_read_b64_tr_b16 a[228:229],v246 offset:20480
ds_read_b64_tr_b16 a[230:231],v246 offset:22528
v_mfma_f32_16x16x32_bf16 v[68:71],a[192:195],v[128:131],0
v_cvt_pk_bf16_f32 v16,v16,v17
v_cvt_pk_bf16_f32 v17,v18,v19
v_mfma_f32_16x16x32_bf16 v[68:71],a[196:199],v[132:135],v[68:71]
v_cvt_pk_bf16_f32 v18,v28,v29
v_cvt_pk_bf16_f32 v19,v30,v31
v_mfma_f32_16x16x32_bf16 v[68:71],a[200:203],v[136:139],v[68:71]
ds_read_b64_tr_b16 a[232:233],v246 offset:24576
ds_read_b64_tr_b16 a[234:235],v246 offset:26624
v_mfma_f32_16x16x32_bf16 v[68:71],a[204:207],v[140:143],v[68:71]
buffer_store_dwordx4 v[16:19],v248,s[20:23],s62 offen sc0 sc1
v_mfma_f32_16x16x32_bf16 v[72:75],a[192:195],v[144:147],0
v_cvt_pk_bf16_f32 v20,v20,v21
v_cvt_pk_bf16_f32 v21,v22,v23
v_mfma_f32_16x16x32_bf16 v[72:75],a[196:199],v[148:151],v[72:75]
ds_read_b64_tr_b16 a[236:237],v246 offset:28672
ds_read_b64_tr_b16 a[238:239],v246 offset:30720
v_mfma_f32_16x16x32_bf16 v[72:75],a[200:203],v[152:155],v[72:75]
v_cvt_pk_bf16_f32 v22,v32,v33
v_cvt_pk_bf16_f32 v23,v34,v35
v_mfma_f32_16x16x32_bf16 v[72:75],a[204:207],v[156:159],v[72:75]
buffer_store_dwordx4 v[20:23],v248,s[20:23],s63 offen sc0 sc1
v_mfma_f32_16x16x32_bf16 v[76:79],a[208:211],v[112:115],0
ds_read_b64_tr_b16 a[240:241],v247 offset:16384
ds_read_b64_tr_b16 a[242:243],v247 offset:18432
v_mfma_f32_16x16x32_bf16 v[76:79],a[212:215],v[116:119],v[76:79]
v_cvt_pk_bf16_f32 v24,v24,v25
s_waitcnt lgkmcnt(4)
v_mfma_f32_16x16x32_bf16 v[76:79],a[216:219],v[120:123],v[76:79]
v_cvt_pk_bf16_f32 v25,v26,v27
v_cvt_pk_bf16_f32 v26,v36,v37
v_mfma_f32_16x16x32_bf16 v[76:79],a[220:223],v[124:127],v[76:79]
ds_read_b64_tr_b16 a[244:245],v247 offset:20480
ds_read_b64_tr_b16 a[246:247],v247 offset:22528
v_mfma_f32_16x16x32_bf16 v[80:83],a[208:211],v[128:131],0
v_cvt_pk_bf16_f32 v27,v38,v39
v_mfma_f32_16x16x32_bf16 v[80:83],a[212:215],v[132:135],v[80:83]
buffer_store_dwordx4 v[24:27],v248,s[20:23],s64 offen sc0 sc1
v_mfma_f32_16x16x32_bf16 v[80:83],a[216:219],v[136:139],v[80:83]
ds_read_b64_tr_b16 a[248:249],v247 offset:24576
ds_read_b64_tr_b16 a[250:251],v247 offset:26624
v_mfma_f32_16x16x32_bf16 v[80:83],a[220:223],v[140:143],v[80:83]
v_mfma_f32_16x16x32_bf16 v[84:87],a[208:211],v[144:147],0
v_mfma_f32_16x16x32_bf16 v[84:87],a[212:215],v[148:151],v[84:87]
ds_read_b64_tr_b16 a[252:253],v247 offset:28672
ds_read_b64_tr_b16 a[254:255],v247 offset:30720
v_mfma_f32_16x16x32_bf16 v[84:87],a[216:219],v[152:155],v[84:87]
v_mfma_f32_16x16x32_bf16 v[84:87],a[220:223],v[156:159],v[84:87]
v_mfma_f32_16x16x32_bf16 v[88:91],a[224:227],v[112:115],0
ds_read_b64_tr_b16 a[192:193],v244 offset:32768
ds_read_b64_tr_b16 a[194:195],v244 offset:34816
v_mfma_f32_16x16x32_bf16 v[88:91],a[228:231],v[116:119],v[88:91]
v_mfma_f32_16x16x32_bf16 v[88:91],a[232:235],v[120:123],v[88:91]
s_waitcnt lgkmcnt(4)
v_mfma_f32_16x16x32_bf16 v[88:91],a[236:239],v[124:127],v[88:91]
ds_read_b64_tr_b16 a[196:197],v244 offset:36864
ds_read_b64_tr_b16 a[198:199],v244 offset:38912
v_mfma_f32_16x16x32_bf16 v[92:95],a[224:227],v[128:131],0
v_mfma_f32_16x16x32_bf16 v[92:95],a[228:231],v[132:135],v[92:95]
v_mfma_f32_16x16x32_bf16 v[92:95],a[232:235],v[136:139],v[92:95]
ds_read_b64_tr_b16 a[200:201],v244 offset:40960
ds_read_b64_tr_b16 a[202:203],v244 offset:43008
v_mfma_f32_16x16x32_bf16 v[92:95],a[236:239],v[140:143],v[92:95]
v_mfma_f32_16x16x32_bf16 v[96:99],a[224:227],v[144:147],0
v_mfma_f32_16x16x32_bf16 v[96:99],a[228:231],v[148:151],v[96:99]
ds_read_b64_tr_b16 a[204:205],v244 offset:45056
ds_read_b64_tr_b16 a[206:207],v244 offset:47104
v_mfma_f32_16x16x32_bf16 v[96:99],a[232:235],v[152:155],v[96:99]
v_mfma_f32_16x16x32_bf16 v[96:99],a[236:239],v[156:159],v[96:99]
v_mfma_f32_16x16x32_bf16 v[100:103],a[240:243],v[112:115],0
ds_read_b64_tr_b16 a[208:209],v245 offset:32768
ds_read_b64_tr_b16 a[210:211],v245 offset:34816
v_mfma_f32_16x16x32_bf16 v[100:103],a[244:247],v[116:119],v[100:103]
v_mfma_f32_16x16x32_bf16 v[100:103],a[248:251],v[120:123],v[100:103]
s_waitcnt lgkmcnt(10)
v_mfma_f32_16x16x32_bf16 v[100:103],a[252:255],v[124:127],v[100:103]
ds_read_b64_tr_b16 a[212:213],v245 offset:36864
ds_read_b64_tr_b16 a[214:215],v245 offset:38912
v_mfma_f32_16x16x32_bf16 v[104:107],a[240:243],v[128:131],0
v_mfma_f32_16x16x32_bf16 v[104:107],a[244:247],v[132:135],v[104:107]
v_mfma_f32_16x16x32_bf16 v[104:107],a[248:251],v[136:139],v[104:107]
ds_read_b64_tr_b16 a[216:217],v245 offset:40960
ds_read_b64_tr_b16 a[218:219],v245 offset:43008
v_mfma_f32_16x16x32_bf16 v[104:107],a[252:255],v[140:143],v[104:107]
v_mfma_f32_16x16x32_bf16 v[108:111],a[240:243],v[144:147],0
v_mfma_f32_16x16x32_bf16 v[108:111],a[244:247],v[148:151],v[108:111]
ds_read_b64_tr_b16 a[220:221],v245 offset:45056
ds_read_b64_tr_b16 a[222:223],v245 offset:47104
v_mfma_f32_16x16x32_bf16 v[108:111],a[248:251],v[152:155],v[108:111]
v_mfma_f32_16x16x32_bf16 v[108:111],a[252:255],v[156:159],v[108:111]
s_waitcnt vmcnt(22)
s_barrier
s_waitcnt lgkmcnt(4)
v_mfma_f32_16x16x32_bf16 v[64:67],a[192:195],v[160:163],v[64:67]
ds_read_b64_tr_b16 a[224:225],v246 offset:32768
ds_read_b64_tr_b16 a[226:227],v246 offset:34816
v_mfma_f32_16x16x32_bf16 v[64:67],a[196:199],v[164:167],v[64:67]
v_mfma_f32_16x16x32_bf16 v[64:67],a[200:203],v[168:171],v[64:67]
v_mfma_f32_16x16x32_bf16 v[64:67],a[204:207],v[172:175],v[64:67]
ds_read_b64_tr_b16 a[228:229],v246 offset:36864
ds_read_b64_tr_b16 a[230:231],v246 offset:38912
v_mfma_f32_16x16x32_bf16 v[68:71],a[192:195],v[176:179],v[68:71]
v_cvt_pk_bf16_f32 v40,v40,v41
v_cvt_pk_bf16_f32 v41,v42,v43
v_mfma_f32_16x16x32_bf16 v[68:71],a[196:199],v[180:183],v[68:71]
v_cvt_pk_bf16_f32 v42,v52,v53
v_cvt_pk_bf16_f32 v43,v54,v55
v_mfma_f32_16x16x32_bf16 v[68:71],a[200:203],v[184:187],v[68:71]
ds_read_b64_tr_b16 a[232:233],v246 offset:40960
ds_read_b64_tr_b16 a[234:235],v246 offset:43008
v_mfma_f32_16x16x32_bf16 v[68:71],a[204:207],v[188:191],v[68:71]
buffer_store_dwordx4 v[40:43],v249,s[20:23],s62 offen sc0 sc1
v_mfma_f32_16x16x32_bf16 v[72:75],a[192:195],v[192:195],v[72:75]
s_add_u32 s62,s62,32768
v_cvt_pk_bf16_f32 v44,v44,v45
v_mfma_f32_16x16x32_bf16 v[72:75],a[196:199],v[196:199],v[72:75]
ds_read_b64_tr_b16 a[236:237],v246 offset:45056
ds_read_b64_tr_b16 a[238:239],v246 offset:47104
v_mfma_f32_16x16x32_bf16 v[72:75],a[200:203],v[200:203],v[72:75]
v_cvt_pk_bf16_f32 v45,v46,v47
v_cvt_pk_bf16_f32 v46,v56,v57
v_mfma_f32_16x16x32_bf16 v[72:75],a[204:207],v[204:207],v[72:75]
v_cvt_pk_bf16_f32 v47,v58,v59
v_mfma_f32_16x16x32_bf16 v[76:79],a[208:211],v[160:163],v[76:79]
ds_read_b64_tr_b16 a[240:241],v247 offset:32768
ds_read_b64_tr_b16 a[242:243],v247 offset:34816
v_mfma_f32_16x16x32_bf16 v[76:79],a[212:215],v[164:167],v[76:79]
s_waitcnt lgkmcnt(4)
v_mfma_f32_16x16x32_bf16 v[76:79],a[216:219],v[168:171],v[76:79]
buffer_store_dwordx4 v[44:47],v249,s[20:23],s63 offen sc0 sc1
v_mfma_f32_16x16x32_bf16 v[76:79],a[220:223],v[172:175],v[76:79]
ds_read_b64_tr_b16 a[244:245],v247 offset:36864
ds_read_b64_tr_b16 a[246:247],v247 offset:38912
v_mfma_f32_16x16x32_bf16 v[80:83],a[208:211],v[176:179],v[80:83]
s_add_u32 s63,s63,32768
v_cvt_pk_bf16_f32 v48,v48,v49
v_mfma_f32_16x16x32_bf16 v[80:83],a[212:215],v[180:183],v[80:83]
v_cvt_pk_bf16_f32 v49,v50,v51
v_cvt_pk_bf16_f32 v50,v60,v61
v_mfma_f32_16x16x32_bf16 v[80:83],a[216:219],v[184:187],v[80:83]
ds_read_b64_tr_b16 a[248:249],v247 offset:40960
ds_read_b64_tr_b16 a[250:251],v247 offset:43008
v_mfma_f32_16x16x32_bf16 v[80:83],a[220:223],v[188:191],v[80:83]
v_cvt_pk_bf16_f32 v51,v62,v63
v_mfma_f32_16x16x32_bf16 v[84:87],a[208:211],v[192:195],v[84:87]
buffer_store_dwordx4 v[48:51],v249,s[20:23],s64 offen sc0 sc1
v_mfma_f32_16x16x32_bf16 v[84:87],a[212:215],v[196:199],v[84:87]
ds_read_b64_tr_b16 a[252:253],v247 offset:45056
ds_read_b64_tr_b16 a[254:255],v247 offset:47104
v_mfma_f32_16x16x32_bf16 v[84:87],a[216:219],v[200:203],v[84:87]
s_add_u32 s64,s64,32768
v_mfma_f32_16x16x32_bf16 v[84:87],a[220:223],v[204:207],v[84:87]
v_mfma_f32_16x16x32_bf16 v[88:91],a[224:227],v[160:163],v[88:91]
ds_read_b64_tr_b16 a[192:193],v244 offset:49152
ds_read_b64_tr_b16 a[194:195],v244 offset:51200
v_mfma_f32_16x16x32_bf16 v[88:91],a[228:231],v[164:167],v[88:91]
v_mfma_f32_16x16x32_bf16 v[88:91],a[232:235],v[168:171],v[88:91]
s_waitcnt lgkmcnt(4)
v_mfma_f32_16x16x32_bf16 v[88:91],a[236:239],v[172:175],v[88:91]
ds_read_b64_tr_b16 a[196:197],v244 offset:53248
ds_read_b64_tr_b16 a[198:199],v244 offset:55296
v_mfma_f32_16x16x32_bf16 v[92:95],a[224:227],v[176:179],v[92:95]
v_mfma_f32_16x16x32_bf16 v[92:95],a[228:231],v[180:183],v[92:95]
v_mfma_f32_16x16x32_bf16 v[92:95],a[232:235],v[184:187],v[92:95]
ds_read_b64_tr_b16 a[200:201],v244 offset:57344
ds_read_b64_tr_b16 a[202:203],v244 offset:59392
v_mfma_f32_16x16x32_bf16 v[92:95],a[236:239],v[188:191],v[92:95]
v_mfma_f32_16x16x32_bf16 v[96:99],a[224:227],v[192:195],v[96:99]
v_mfma_f32_16x16x32_bf16 v[96:99],a[228:231],v[196:199],v[96:99]
ds_read_b64_tr_b16 a[204:205],v244 offset:61440
ds_read_b64_tr_b16 a[206:207],v244 offset:63488
v_mfma_f32_16x16x32_bf16 v[96:99],a[232:235],v[200:203],v[96:99]
v_mfma_f32_16x16x32_bf16 v[96:99],a[236:239],v[204:207],v[96:99]
v_mfma_f32_16x16x32_bf16 v[100:103],a[240:243],v[160:163],v[100:103]
ds_read_b64_tr_b16 a[208:209],v245 offset:49152
ds_read_b64_tr_b16 a[210:211],v245 offset:51200
v_mfma_f32_16x16x32_bf16 v[100:103],a[244:247],v[164:167],v[100:103]
v_mfma_f32_16x16x32_bf16 v[100:103],a[248:251],v[168:171],v[100:103]
s_waitcnt lgkmcnt(10)
v_mfma_f32_16x16x32_bf16 v[100:103],a[252:255],v[172:175],v[100:103]
ds_read_b64_tr_b16 a[212:213],v245 offset:53248
ds_read_b64_tr_b16 a[214:215],v245 offset:55296
v_mfma_f32_16x16x32_bf16 v[104:107],a[240:243],v[176:179],v[104:107]
v_mfma_f32_16x16x32_bf16 v[104:107],a[244:247],v[180:183],v[104:107]
v_mfma_f32_16x16x32_bf16 v[104:107],a[248:251],v[184:187],v[104:107]
ds_read_b64_tr_b16 a[216:217],v245 offset:57344
ds_read_b64_tr_b16 a[218:219],v245 offset:59392
v_mfma_f32_16x16x32_bf16 v[104:107],a[252:255],v[188:191],v[104:107]
v_mfma_f32_16x16x32_bf16 v[108:111],a[240:243],v[192:195],v[108:111]
v_mfma_f32_16x16x32_bf16 v[108:111],a[244:247],v[196:199],v[108:111]
ds_read_b64_tr_b16 a[220:221],v245 offset:61440
ds_read_b64_tr_b16 a[222:223],v245 offset:63488
v_mfma_f32_16x16x32_bf16 v[108:111],a[248:251],v[200:203],v[108:111]
v_mfma_f32_16x16x32_bf16 v[108:111],a[252:255],v[204:207],v[108:111]
s_waitcnt vmcnt(18)
s_barrier
s_waitcnt lgkmcnt(4)
v_mfma_f32_16x16x32_bf16 v[16:19],a[192:195],v[112:115],0
ds_read_b64_tr_b16 a[224:225],v246 offset:49152
ds_read_b64_tr_b16 a[226:227],v246 offset:51200
v_mfma_f32_16x16x32_bf16 v[16:19],a[196:199],v[116:119],v[16:19]
v_mfma_f32_16x16x32_bf16 v[16:19],a[200:203],v[120:123],v[16:19]
v_mfma_f32_16x16x32_bf16 v[16:19],a[204:207],v[124:127],v[16:19]
ds_read_b64_tr_b16 a[228:229],v246 offset:53248
ds_read_b64_tr_b16 a[230:231],v246 offset:55296
v_mfma_f32_16x16x32_bf16 v[20:23],a[192:195],v[128:131],0
v_cvt_pk_bf16_f32 v64,v64,v65
v_cvt_pk_bf16_f32 v65,v66,v67
v_mfma_f32_16x16x32_bf16 v[20:23],a[196:199],v[132:135],v[20:23]
v_cvt_pk_bf16_f32 v66,v76,v77
v_cvt_pk_bf16_f32 v67,v78,v79
v_mfma_f32_16x16x32_bf16 v[20:23],a[200:203],v[136:139],v[20:23]
ds_read_b64_tr_b16 a[232:233],v246 offset:57344
ds_read_b64_tr_b16 a[234:235],v246 offset:59392
v_mfma_f32_16x16x32_bf16 v[20:23],a[204:207],v[140:143],v[20:23]
buffer_store_dwordx4 v[64:67],v248,s[20:23],s62 offen sc0 sc1
v_mfma_f32_16x16x32_bf16 v[24:27],a[192:195],v[144:147],0
v_cvt_pk_bf16_f32 v68,v68,v69
v_cvt_pk_bf16_f32 v69,v70,v71
v_mfma_f32_16x16x32_bf16 v[24:27],a[196:199],v[148:151],v[24:27]
ds_read_b64_tr_b16 a[236:237],v246 offset:61440
ds_read_b64_tr_b16 a[238:239],v246 offset:63488
v_mfma_f32_16x16x32_bf16 v[24:27],a[200:203],v[152:155],v[24:27]
v_cvt_pk_bf16_f32 v70,v80,v81
v_cvt_pk_bf16_f32 v71,v82,v83
v_mfma_f32_16x16x32_bf16 v[24:27],a[204:207],v[156:159],v[24:27]
buffer_store_dwordx4 v[68:71],v248,s[20:23],s63 offen sc0 sc1
v_mfma_f32_16x16x32_bf16 v[28:31],a[208:211],v[112:115],0
ds_read_b64_tr_b16 a[240:241],v247 offset:49152
ds_read_b64_tr_b16 a[242:243],v247 offset:51200
v_mfma_f32_16x16x32_bf16 v[28:31],a[212:215],v[116:119],v[28:31]
v_cvt_pk_bf16_f32 v72,v72,v73
s_waitcnt lgkmcnt(4)
v_mfma_f32_16x16x32_bf16 v[28:31],a[216:219],v[120:123],v[28:31]
v_cvt_pk_bf16_f32 v73,v74,v75
v_cvt_pk_bf16_f32 v74,v84,v85
v_mfma_f32_16x16x32_bf16 v[28:31],a[220:223],v[124:127],v[28:31]
ds_read_b64_tr_b16 a[244:245],v247 offset:53248
ds_read_b64_tr_b16 a[246:247],v247 offset:55296
v_mfma_f32_16x16x32_bf16 v[32:35],a[208:211],v[128:131],0
v_cvt_pk_bf16_f32 v75,v86,v87
v_mfma_f32_16x16x32_bf16 v[32:35],a[212:215],v[132:135],v[32:35]
buffer_store_dwordx4 v[72:75],v248,s[20:23],s64 offen sc0 sc1
v_mfma_f32_16x16x32_bf16 v[32:35],a[216:219],v[136:139],v[32:35]
ds_read_b64_tr_b16 a[248:249],v247 offset:57344
ds_read_b64_tr_b16 a[250:251],v247 offset:59392
v_mfma_f32_16x16x32_bf16 v[32:35],a[220:223],v[140:143],v[32:35]
v_mfma_f32_16x16x32_bf16 v[36:39],a[208:211],v[144:147],0
v_mfma_f32_16x16x32_bf16 v[36:39],a[212:215],v[148:151],v[36:39]
ds_read_b64_tr_b16 a[252:253],v247 offset:61440
ds_read_b64_tr_b16 a[254:255],v247 offset:63488
v_mfma_f32_16x16x32_bf16 v[36:39],a[216:219],v[152:155],v[36:39]
v_mfma_f32_16x16x32_bf16 v[36:39],a[220:223],v[156:159],v[36:39]
v_mfma_f32_16x16x32_bf16 v[40:43],a[224:227],v[112:115],0
ds_read_b64_tr_b16 a[192:193],v240 offset:0
ds_read_b64_tr_b16 a[194:195],v240 offset:2048
v_mfma_f32_16x16x32_bf16 v[40:43],a[228:231],v[116:119],v[40:43]
v_mfma_f32_16x16x32_bf16 v[40:43],a[232:235],v[120:123],v[40:43]
s_waitcnt lgkmcnt(4)
v_mfma_f32_16x16x32_bf16 v[40:43],a[236:239],v[124:127],v[40:43]
ds_read_b64_tr_b16 a[196:197],v240 offset:4096
ds_read_b64_tr_b16 a[198:199],v240 offset:6144
v_mfma_f32_16x16x32_bf16 v[44:47],a[224:227],v[128:131],0
v_mfma_f32_16x16x32_bf16 v[44:47],a[228:231],v[132:135],v[44:47]
v_mfma_f32_16x16x32_bf16 v[44:47],a[232:235],v[136:139],v[44:47]
ds_read_b64_tr_b16 a[200:201],v240 offset:8192
ds_read_b64_tr_b16 a[202:203],v240 offset:10240
v_mfma_f32_16x16x32_bf16 v[44:47],a[236:239],v[140:143],v[44:47]
v_mfma_f32_16x16x32_bf16 v[48:51],a[224:227],v[144:147],0
v_mfma_f32_16x16x32_bf16 v[48:51],a[228:231],v[148:151],v[48:51]
ds_read_b64_tr_b16 a[204:205],v240 offset:12288
ds_read_b64_tr_b16 a[206:207],v240 offset:14336
v_mfma_f32_16x16x32_bf16 v[48:51],a[232:235],v[152:155],v[48:51]
v_mfma_f32_16x16x32_bf16 v[48:51],a[236:239],v[156:159],v[48:51]
v_mfma_f32_16x16x32_bf16 v[52:55],a[240:243],v[112:115],0
ds_read_b64_tr_b16 a[208:209],v241 offset:0
ds_read_b64_tr_b16 a[210:211],v241 offset:2048
v_mfma_f32_16x16x32_bf16 v[52:55],a[244:247],v[116:119],v[52:55]
v_mfma_f32_16x16x32_bf16 v[52:55],a[248:251],v[120:123],v[52:55]
s_waitcnt lgkmcnt(10)
v_mfma_f32_16x16x32_bf16 v[52:55],a[252:255],v[124:127],v[52:55]
ds_read_b64_tr_b16 a[212:213],v241 offset:4096
ds_read_b64_tr_b16 a[214:215],v241 offset:6144
v_mfma_f32_16x16x32_bf16 v[56:59],a[240:243],v[128:131],0
v_mfma_f32_16x16x32_bf16 v[56:59],a[244:247],v[132:135],v[56:59]
v_mfma_f32_16x16x32_bf16 v[56:59],a[248:251],v[136:139],v[56:59]
ds_read_b64_tr_b16 a[216:217],v241 offset:8192
ds_read_b64_tr_b16 a[218:219],v241 offset:10240
v_mfma_f32_16x16x32_bf16 v[56:59],a[252:255],v[140:143],v[56:59]
v_mfma_f32_16x16x32_bf16 v[60:63],a[240:243],v[144:147],0
v_mfma_f32_16x16x32_bf16 v[60:63],a[244:247],v[148:151],v[60:63]
ds_read_b64_tr_b16 a[220:221],v241 offset:12288
ds_read_b64_tr_b16 a[222:223],v241 offset:14336
v_mfma_f32_16x16x32_bf16 v[60:63],a[248:251],v[152:155],v[60:63]
v_mfma_f32_16x16x32_bf16 v[60:63],a[252:255],v[156:159],v[60:63]
s_waitcnt lgkmcnt(4)
v_mfma_f32_16x16x32_bf16 v[16:19],a[192:195],v[160:163],v[16:19]
ds_read_b64_tr_b16 a[224:225],v242 offset:0
ds_read_b64_tr_b16 a[226:227],v242 offset:2048
v_mfma_f32_16x16x32_bf16 v[16:19],a[196:199],v[164:167],v[16:19]
v_mfma_f32_16x16x32_bf16 v[16:19],a[200:203],v[168:171],v[16:19]
v_mfma_f32_16x16x32_bf16 v[16:19],a[204:207],v[172:175],v[16:19]
v_mfma_f32_16x16x32_bf16 v[20:23],a[192:195],v[176:179],v[20:23]
v_cvt_pk_bf16_f32 v88,v88,v89
v_cvt_pk_bf16_f32 v89,v90,v91
v_mfma_f32_16x16x32_bf16 v[20:23],a[196:199],v[180:183],v[20:23]
ds_read_b64_tr_b16 a[228:229],v242 offset:4096
ds_read_b64_tr_b16 a[230:231],v242 offset:6144
v_mfma_f32_16x16x32_bf16 v[20:23],a[200:203],v[184:187],v[20:23]
v_cvt_pk_bf16_f32 v90,v100,v101
v_cvt_pk_bf16_f32 v91,v102,v103
v_mfma_f32_16x16x32_bf16 v[20:23],a[204:207],v[188:191],v[20:23]
buffer_store_dwordx4 v[88:91],v249,s[20:23],s62 offen sc0 sc1
v_mfma_f32_16x16x32_bf16 v[24:27],a[192:195],v[192:195],v[24:27]
s_add_u32 s62,s62,32768
v_cvt_pk_bf16_f32 v92,v92,v93
v_mfma_f32_16x16x32_bf16 v[24:27],a[196:199],v[196:199],v[24:27]
ds_read_b64_tr_b16 a[232:233],v242 offset:8192
ds_read_b64_tr_b16 a[234:235],v242 offset:10240
v_mfma_f32_16x16x32_bf16 v[24:27],a[200:203],v[200:203],v[24:27]
v_cvt_pk_bf16_f32 v93,v94,v95
v_cvt_pk_bf16_f32 v94,v104,v105
v_mfma_f32_16x16x32_bf16 v[24:27],a[204:207],v[204:207],v[24:27]
v_cvt_pk_bf16_f32 v95,v106,v107
v_mfma_f32_16x16x32_bf16 v[28:31],a[208:211],v[160:163],v[28:31]
buffer_store_dwordx4 v[92:95],v249,s[20:23],s63 offen sc0 sc1
v_mfma_f32_16x16x32_bf16 v[28:31],a[212:215],v[164:167],v[28:31]
ds_read_b64_tr_b16 a[236:237],v242 offset:12288
ds_read_b64_tr_b16 a[238:239],v242 offset:14336
s_waitcnt lgkmcnt(4)
v_mfma_f32_16x16x32_bf16 v[28:31],a[216:219],v[168:171],v[28:31]
s_add_u32 s63,s63,32768
v_cvt_pk_bf16_f32 v96,v96,v97
v_mfma_f32_16x16x32_bf16 v[28:31],a[220:223],v[172:175],v[28:31]
v_cvt_pk_bf16_f32 v97,v98,v99
v_cvt_pk_bf16_f32 v98,v108,v109
v_mfma_f32_16x16x32_bf16 v[32:35],a[208:211],v[176:179],v[32:35]
v_cvt_pk_bf16_f32 v99,v110,v111
v_mfma_f32_16x16x32_bf16 v[32:35],a[212:215],v[180:183],v[32:35]
buffer_store_dwordx4 v[96:99],v249,s[20:23],s64 offen sc0 sc1
v_mfma_f32_16x16x32_bf16 v[32:35],a[216:219],v[184:187],v[32:35]
ds_read_b64_tr_b16 a[240:241],v243 offset:0
ds_read_b64_tr_b16 a[242:243],v243 offset:2048
v_mfma_f32_16x16x32_bf16 v[32:35],a[220:223],v[188:191],v[32:35]
s_add_u32 s64,s64,32768
v_mfma_f32_16x16x32_bf16 v[36:39],a[208:211],v[192:195],v[36:39]
v_mfma_f32_16x16x32_bf16 v[36:39],a[212:215],v[196:199],v[36:39]
v_mfma_f32_16x16x32_bf16 v[36:39],a[216:219],v[200:203],v[36:39]
ds_read_b64_tr_b16 a[244:245],v243 offset:4096
ds_read_b64_tr_b16 a[246:247],v243 offset:6144
v_mfma_f32_16x16x32_bf16 v[36:39],a[220:223],v[204:207],v[36:39]
v_mfma_f32_16x16x32_bf16 v[40:43],a[224:227],v[160:163],v[40:43]
v_mfma_f32_16x16x32_bf16 v[40:43],a[228:231],v[164:167],v[40:43]
s_waitcnt lgkmcnt(2)
v_mfma_f32_16x16x32_bf16 v[40:43],a[232:235],v[168:171],v[40:43]
v_mfma_f32_16x16x32_bf16 v[40:43],a[236:239],v[172:175],v[40:43]
ds_read_b64_tr_b16 a[248:249],v243 offset:8192
ds_read_b64_tr_b16 a[250:251],v243 offset:10240
v_mfma_f32_16x16x32_bf16 v[44:47],a[224:227],v[176:179],v[44:47]
v_mfma_f32_16x16x32_bf16 v[44:47],a[228:231],v[180:183],v[44:47]
v_mfma_f32_16x16x32_bf16 v[44:47],a[232:235],v[184:187],v[44:47]
v_mfma_f32_16x16x32_bf16 v[44:47],a[236:239],v[188:191],v[44:47]
ds_read_b64_tr_b16 a[252:253],v243 offset:12288
ds_read_b64_tr_b16 a[254:255],v243 offset:14336
v_mfma_f32_16x16x32_bf16 v[48:51],a[224:227],v[192:195],v[48:51]
v_mfma_f32_16x16x32_bf16 v[48:51],a[228:231],v[196:199],v[48:51]
v_mfma_f32_16x16x32_bf16 v[48:51],a[232:235],v[200:203],v[48:51]
v_mfma_f32_16x16x32_bf16 v[48:51],a[236:239],v[204:207],v[48:51]
v_mfma_f32_16x16x32_bf16 v[52:55],a[240:243],v[160:163],v[52:55]
s_waitcnt lgkmcnt(2)
v_mfma_f32_16x16x32_bf16 v[52:55],a[244:247],v[164:167],v[52:55]
v_mfma_f32_16x16x32_bf16 v[52:55],a[248:251],v[168:171],v[52:55]
s_waitcnt lgkmcnt(0)
v_mfma_f32_16x16x32_bf16 v[52:55],a[252:255],v[172:175],v[52:55]
v_mfma_f32_16x16x32_bf16 v[56:59],a[240:243],v[176:179],v[56:59]
v_mfma_f32_16x16x32_bf16 v[56:59],a[244:247],v[180:183],v[56:59]
v_mfma_f32_16x16x32_bf16 v[56:59],a[248:251],v[184:187],v[56:59]
v_mfma_f32_16x16x32_bf16 v[56:59],a[252:255],v[188:191],v[56:59]
v_mfma_f32_16x16x32_bf16 v[60:63],a[240:243],v[192:195],v[60:63]
v_mfma_f32_16x16x32_bf16 v[60:63],a[244:247],v[196:199],v[60:63]
v_mfma_f32_16x16x32_bf16 v[60:63],a[248:251],v[200:203],v[60:63]
v_mfma_f32_16x16x32_bf16 v[60:63],a[252:255],v[204:207],v[60:63]
s_nop 5
v_cvt_pk_bf16_f32 v16,v16,v17
v_cvt_pk_bf16_f32 v17,v18,v19
v_cvt_pk_bf16_f32 v18,v28,v29
v_cvt_pk_bf16_f32 v19,v30,v31
buffer_store_dwordx4 v[16:19],v248,s[20:23],s62 offen sc0 sc1
v_cvt_pk_bf16_f32 v20,v20,v21
v_cvt_pk_bf16_f32 v21,v22,v23
v_cvt_pk_bf16_f32 v22,v32,v33
v_cvt_pk_bf16_f32 v23,v34,v35
buffer_store_dwordx4 v[20:23],v248,s[20:23],s63 offen sc0 sc1
v_cvt_pk_bf16_f32 v24,v24,v25
v_cvt_pk_bf16_f32 v25,v26,v27
v_cvt_pk_bf16_f32 v26,v36,v37
v_cvt_pk_bf16_f32 v27,v38,v39
buffer_store_dwordx4 v[24:27],v248,s[20:23],s64 offen sc0 sc1
v_cvt_pk_bf16_f32 v40,v40,v41
v_cvt_pk_bf16_f32 v41,v42,v43
v_cvt_pk_bf16_f32 v42,v52,v53
v_cvt_pk_bf16_f32 v43,v54,v55
buffer_store_dwordx4 v[40:43],v249,s[20:23],s62 offen sc0 sc1
s_add_u32 s62,s62,32768
v_cvt_pk_bf16_f32 v44,v44,v45
v_cvt_pk_bf16_f32 v45,v46,v47
v_cvt_pk_bf16_f32 v46,v56,v57
v_cvt_pk_bf16_f32 v47,v58,v59
buffer_store_dwordx4 v[44:47],v249,s[20:23],s63 offen sc0 sc1
s_add_u32 s63,s63,32768
v_cvt_pk_bf16_f32 v48,v48,v49
v_cvt_pk_bf16_f32 v49,v50,v51
v_cvt_pk_bf16_f32 v50,v60,v61
v_cvt_pk_bf16_f32 v51,v62,v63
buffer_store_dwordx4 v[48:51],v249,s[20:23],s64 offen sc0 sc1
s_add_u32 s64,s64,32768
s_endpgm
FALLBACK_A2:
s_waitcnt vmcnt(0) lgkmcnt(0)
s_mov_b32 s30,1
s_mov_b32 s65,0
v_mov_b32 v168,0xff800000
v_mov_b32 v169,0xff800000
v_mov_b32 v170,0xff800000
FBLOOP_A2:
s_barrier
s_mov_b32 m0,s25
s_add_u32 s28,s25,s65
buffer_load_dwordx4 v12,s[4:7],s28 offen lds
buffer_load_dwordx4 v13,s[4:7],s28 offen offset:1024 lds
buffer_load_dwordx4 v14,s[4:7],s28 offen offset:2048 lds
buffer_load_dwordx4 v15,s[4:7],s28 offen offset:3072 lds
s_waitcnt vmcnt(0)
s_barrier
ds_read_b128 a[192:195],v0 offset:0
ds_read_b128 a[196:199],v1 offset:0
ds_read_b128 a[200:203],v2 offset:0
ds_read_b128 a[204:207],v3 offset:0
ds_read_b128 a[208:211],v0 offset:256
ds_read_b128 a[212:215],v1 offset:256
ds_read_b128 a[216:219],v2 offset:256
ds_read_b128 a[220:223],v3 offset:256
ds_read_b128 a[224:227],v0 offset:8192
ds_read_b128 a[228:231],v1 offset:8192
ds_read_b128 a[232:235],v2 offset:8192
ds_read_b128 a[236:239],v3 offset:8192
ds_read_b128 a[240:243],v0 offset:8448
ds_read_b128 a[244:247],v1 offset:8448
ds_read_b128 a[248:251],v2 offset:8448
ds_read_b128 a[252:255],v3 offset:8448
s_waitcnt lgkmcnt(0)
v_mfma_f32_16x16x32_bf16 v[112:115],a[192:195],v[16:19],0
v_mfma_f32_16x16x32_bf16 v[112:115],a[196:199],v[20:23],v[112:115]
v_mfma_f32_16x16x32_bf16 v[112:115],a[200:203],v[24:27],v[112:115]
v_mfma_f32_16x16x32_bf16 v[112:115],a[204:207],v[28:31],v[112:115]
v_mfma_f32_16x16x32_bf16 v[112:115],a[208:211],v[32:35],v[112:115]
v_mfma_f32_16x16x32_bf16 v[112:115],a[212:215],v[36:39],v[112:115]
v_mfma_f32_16x16x32_bf16 v[112:115],a[216:219],v[40:43],v[112:115]
v_mfma_f32_16x16x32_bf16 v[112:115],a[220:223],v[44:47],v[112:115]
v_mfma_f32_16x16x32_bf16 v[128:131],a[192:195],v[48:51],0
v_mfma_f32_16x16x32_bf16 v[128:131],a[196:199],v[52:55],v[128:131]
v_mfma_f32_16x16x32_bf16 v[128:131],a[200:203],v[56:59],v[128:131]
v_mfma_f32_16x16x32_bf16 v[128:131],a[204:207],v[60:63],v[128:131]
v_mfma_f32_16x16x32_bf16 v[128:131],a[208:211],v[64:67],v[128:131]
v_mfma_f32_16x16x32_bf16 v[128:131],a[212:215],v[68:71],v[128:131]
v_mfma_f32_16x16x32_bf16 v[128:131],a[216:219],v[72:75],v[128:131]
v_mfma_f32_16x16x32_bf16 v[128:131],a[220:223],v[76:79],v[128:131]
v_mfma_f32_16x16x32_bf16 v[144:147],a[192:195],v[80:83],0
v_mfma_f32_16x16x32_bf16 v[144:147],a[196:199],v[84:87],v[144:147]
v_mfma_f32_16x16x32_bf16 v[144:147],a[200:203],v[88:91],v[144:147]
v_mfma_f32_16x16x32_bf16 v[144:147],a[204:207],v[92:95],v[144:147]
v_mfma_f32_16x16x32_bf16 v[144:147],a[208:211],v[96:99],v[144:147]
v_mfma_f32_16x16x32_bf16 v[144:147],a[212:215],v[100:103],v[144:147]
v_mfma_f32_16x16x32_bf16 v[144:147],a[216:219],v[104:107],v[144:147]
v_mfma_f32_16x16x32_bf16 v[144:147],a[220:223],v[108:111],v[144:147]
v_mfma_f32_16x16x32_bf16 v[116:119],a[224:227],v[16:19],0
v_mfma_f32_16x16x32_bf16 v[116:119],a[228:231],v[20:23],v[116:119]
v_mfma_f32_16x16x32_bf16 v[116:119],a[232:235],v[24:27],v[116:119]
v_mfma_f32_16x16x32_bf16 v[116:119],a[236:239],v[28:31],v[116:119]
v_mfma_f32_16x16x32_bf16 v[116:119],a[240:243],v[32:35],v[116:119]
v_mfma_f32_16x16x32_bf16 v[116:119],a[244:247],v[36:39],v[116:119]
v_mfma_f32_16x16x32_bf16 v[116:119],a[248:251],v[40:43],v[116:119]
v_mfma_f32_16x16x32_bf16 v[116:119],a[252:255],v[44:47],v[116:119]
v_mfma_f32_16x16x32_bf16 v[132:135],a[224:227],v[48:51],0
v_mfma_f32_16x16x32_bf16 v[132:135],a[228:231],v[52:55],v[132:135]
v_mfma_f32_16x16x32_bf16 v[132:135],a[232:235],v[56:59],v[132:135]
v_mfma_f32_16x16x32_bf16 v[132:135],a[236:239],v[60:63],v[132:135]
v_mfma_f32_16x16x32_bf16 v[132:135],a[240:243],v[64:67],v[132:135]
v_mfma_f32_16x16x32_bf16 v[132:135],a[244:247],v[68:71],v[132:135]
v_mfma_f32_16x16x32_bf16 v[132:135],a[248:251],v[72:75],v[132:135]
v_mfma_f32_16x16x32_bf16 v[132:135],a[252:255],v[76:79],v[132:135]
v_mfma_f32_16x16x32_bf16 v[148:151],a[224:227],v[80:83],0
v_mfma_f32_16x16x32_bf16 v[148:151],a[228:231],v[84:87],v[148:151]
v_mfma_f32_16x16x32_bf16 v[148:151],a[232:235],v[88:91],v[148:151]
v_mfma_f32_16x16x32_bf16 v[148:151],a[236:239],v[92:95],v[148:151]
v_mfma_f32_16x16x32_bf16 v[148:151],a[240:243],v[96:99],v[148:151]
v_mfma_f32_16x16x32_bf16 v[148:151],a[244:247],v[100:103],v[148:151]
v_mfma_f32_16x16x32_bf16 v[148:151],a[248:251],v[104:107],v[148:151]
v_mfma_f32_16x16x32_bf16 v[148:151],a[252:255],v[108:111],v[148:151]
s_nop 7
v_max3_f32 v168,v168,v112,v113
v_max3_f32 v168,v168,v114,v115
v_max3_f32 v168,v168,v116,v117
v_max3_f32 v168,v168,v118,v119
v_max3_f32 v169,v169,v128,v129
v_max3_f32 v169,v169,v130,v131
v_max3_f32 v169,v169,v132,v133
v_max3_f32 v169,v169,v134,v135
v_max3_f32 v170,v170,v144,v145
v_max3_f32 v170,v170,v146,v147
v_max3_f32 v170,v170,v148,v149
v_max3_f32 v170,v170,v150,v151
s_add_u32 s65,s65,16384
s_cmp_lt_u32 s65,1048576
s_cbranch_scc1 FBLOOP_A2
v_mov_b32 v172,v168
v_mov_b32 v173,v169
v_mov_b32 v174,v170
s_nop 1
v_permlane32_swap_b32 v168,v172
v_permlane32_swap_b32 v169,v173
v_permlane32_swap_b32 v170,v174
s_nop 1
v_max_f32 v168,v168,v172
v_max_f32 v169,v169,v173
v_max_f32 v170,v170,v174
v_mov_b32 v172,v168
v_mov_b32 v173,v169
v_mov_b32 v174,v170
s_nop 1
v_permlane16_swap_b32 v168,v172
v_permlane16_swap_b32 v169,v173
v_permlane16_swap_b32 v170,v174
s_nop 1
v_max_f32 v168,v168,v172
v_max_f32 v169,v169,v173
v_max_f32 v170,v170,v174
v_sub_f32 v208,0,v168
v_sub_f32 v212,0,v169
v_sub_f32 v216,0,v170
s_barrier
s_add_u32 m0,s25,0
s_add_u32 s28,s25,0
buffer_load_dwordx4 v12,s[4:7],s28 offen nt lds
buffer_load_dwordx4 v13,s[4:7],s28 offen offset:1024 nt lds
buffer_load_dwordx4 v14,s[4:7],s28 offen offset:2048 nt lds
buffer_load_dwordx4 v15,s[4:7],s28 offen offset:3072 nt lds
s_add_u32 m0,s25,16384
s_add_u32 s28,s25,16384
buffer_load_dwordx4 v12,s[4:7],s28 offen nt lds
buffer_load_dwordx4 v13,s[4:7],s28 offen offset:1024 nt lds
buffer_load_dwordx4 v14,s[4:7],s28 offen offset:2048 nt lds
buffer_load_dwordx4 v15,s[4:7],s28 offen offset:3072 nt lds
s_add_u32 m0,s25,32768
s_add_u32 s28,s25,32768
buffer_load_dwordx4 v12,s[4:7],s28 offen nt lds
buffer_load_dwordx4 v13,s[4:7],s28 offen offset:1024 nt lds
buffer_load_dwordx4 v14,s[4:7],s28 offen offset:2048 nt lds
buffer_load_dwordx4 v15,s[4:7],s28 offen offset:3072 nt lds
s_add_u32 m0,s25,49152
s_add_u32 s28,s25,49152
buffer_load_dwordx4 v12,s[4:7],s28 offen nt lds
buffer_load_dwordx4 v13,s[4:7],s28 offen offset:1024 nt lds
buffer_load_dwordx4 v14,s[4:7],s28 offen offset:2048 nt lds
buffer_load_dwordx4 v15,s[4:7],s28 offen offset:3072 nt lds
s_add_u32 m0,s25,65536
s_add_u32 s28,s25,0
buffer_load_dwordx4 v12,s[8:11],s28 offen nt lds
buffer_load_dwordx4 v13,s[8:11],s28 offen offset:1024 nt lds
buffer_load_dwordx4 v14,s[8:11],s28 offen offset:2048 nt lds
buffer_load_dwordx4 v15,s[8:11],s28 offen offset:3072 nt lds
s_waitcnt vmcnt(0)
s_barrier
ds_read_b128 a[192:195],v0 offset:0
ds_read_b128 a[196:199],v1 offset:0
ds_read_b128 a[200:203],v2 offset:0
ds_read_b128 a[204:207],v3 offset:0
ds_read_b128 a[208:211],v0 offset:256
ds_read_b128 a[212:215],v1 offset:256
ds_read_b128 a[216:219],v2 offset:256
ds_read_b128 a[220:223],v3 offset:256
s_branch PRE_A2
START_B2:
s_add_u32 m0,s25,49152
s_add_u32 s28,s29,0
buffer_load_dwordx4 v20,s[12:15],s28 offen lds
buffer_load_dwordx4 v21,s[12:15],s28 offen offset:1024 lds
buffer_load_dwordx4 v22,s[12:15],s28 offen offset:2048 lds
buffer_load_dwordx4 v23,s[12:15],s28 offen offset:3072 lds
s_add_u32 m0,s69,0
s_mov_b32 s28,0
buffer_load_dwordx4 v24,s[16:19],s28 offen lds
buffer_load_dwordx4 v25,s[16:19],s28 offen offset:1024 lds
buffer_load_dwordx4 v26,s[16:19],s28 offen offset:2048 lds
buffer_load_dwordx4 v27,s[16:19],s28 offen offset:3072 lds
s_add_u32 m0,s25,98304
s_add_u32 s28,s29,262144
buffer_load_dwordx4 v20,s[12:15],s28 offen lds
v_lshl_add_u32 v12,v34,9,v12
v_lshl_add_u32 v13,v34,9,v13
v_lshl_add_u32 v14,v34,9,v14
v_lshl_add_u32 v15,v34,9,v15
s_lshl_b32 s59,s57,4
s_add_u32 s59,s59,s56
s_sub_u32 s54,1,s58
s_lshr_b32 s59,s59,s54
buffer_load_dwordx4 v21,s[12:15],s28 offen offset:1024 lds
s_lshl_b32 s59,s59,20
s_cmp_eq_u32 s58,0
s_cselect_b64 s[4:5],s[34:35],s[44:45]
s_cselect_b64 s[8:9],s[36:37],s[46:47]
s_cselect_b64 s[96:97],s[40:41],s[50:51]
s_add_u32 s4,s4,s59
s_addc_u32 s5,s5,0
s_mov_b32 s6,0x100000
s_mov_b32 s7,0x20000
s_add_u32 s8,s8,s59
s_addc_u32 s9,s9,0
s_mov_b32 s10,0x100000
s_mov_b32 s11,0x20000
buffer_load_dwordx4 v22,s[12:15],s28 offen offset:2048 lds
v_lshrrev_b32 v36,2,v33
v_lshl_add_u32 v36,v32,2,v36
v_and_b32 v38,3,v33
v_and_b32 v39,7,v36
v_lshlrev_b32 v36,9,v36
v_xor_b32 v37,0,v39
v_lshlrev_b32 v37,5,v37
v_lshl_add_u32 v37,v38,3,v37
buffer_load_dwordx4 v23,s[12:15],s28 offen offset:3072 lds
v_add_u32 v37,v37,v36
v_add_u32 v4,65536,v37
v_xor_b32 v37,1,v39
v_lshlrev_b32 v37,5,v37
v_lshl_add_u32 v37,v38,3,v37
v_add_u32 v37,v37,v36
v_add_u32 v5,65536,v37
v_xor_b32 v37,2,v39
s_add_u32 m0,s25,16384
s_add_u32 s28,s29,524288
buffer_load_dwordx4 v20,s[12:15],s28 offen lds
v_lshlrev_b32 v37,5,v37
v_lshl_add_u32 v37,v38,3,v37
v_add_u32 v37,v37,v36
v_add_u32 v6,65536,v37
v_xor_b32 v37,3,v39
v_lshlrev_b32 v37,5,v37
v_lshl_add_u32 v37,v38,3,v37
v_add_u32 v37,v37,v36
buffer_load_dwordx4 v21,s[12:15],s28 offen offset:1024 lds
v_add_u32 v7,65536,v37
v_xor_b32 v37,4,v39
v_lshlrev_b32 v37,5,v37
v_lshl_add_u32 v37,v38,3,v37
v_add_u32 v37,v37,v36
v_add_u32 v8,65536,v37
v_xor_b32 v37,5,v39
v_lshlrev_b32 v37,5,v37
buffer_load_dwordx4 v22,s[12:15],s28 offen offset:2048 lds
v_lshl_add_u32 v37,v38,3,v37
v_add_u32 v37,v37,v36
v_add_u32 v9,65536,v37
v_xor_b32 v37,6,v39
v_lshlrev_b32 v37,5,v37
v_lshl_add_u32 v37,v38,3,v37
v_add_u32 v37,v37,v36
v_add_u32 v10,65536,v37
buffer_load_dwordx4 v23,s[12:15],s28 offen offset:3072 lds
v_xor_b32 v37,7,v39
v_lshlrev_b32 v37,5,v37
v_lshl_add_u32 v37,v38,3,v37
v_add_u32 v37,v37,v36
v_add_u32 v11,65536,v37
v_lshlrev_b32 v39,1,v39
v_add_u32 v36,49152,v36
v_add_u32 v37,0,v38
s_add_u32 m0,s69,24576
s_mov_b32 s28,128
buffer_load_dwordx4 v24,s[16:19],s28 offen lds
v_xor_b32 v37,v37,v39
v_lshl_add_u32 v16,v37,4,v36
v_add_u32 v37,4,v38
v_xor_b32 v37,v37,v39
v_lshl_add_u32 v17,v37,4,v36
v_add_u32 v37,8,v38
v_xor_b32 v37,v37,v39
v_lshl_add_u32 v18,v37,4,v36
buffer_load_dwordx4 v25,s[16:19],s28 offen offset:1024 lds
v_add_u32 v37,12,v38
v_xor_b32 v37,v37,v39
v_lshl_add_u32 v19,v37,4,v36
v_lshrrev_b32 v37,1,v33
v_xor_b32 v37,v37,v32
v_lshlrev_b32 v36,7,v33
v_add_u32 v36,s69,v36
v_lshl_add_u32 v44,v37,4,v36
buffer_load_dwordx4 v26,s[16:19],s28 offen offset:2048 lds
v_xor_b32 v37,4,v37
v_lshl_add_u32 v45,v37,4,v36
v_and_b32 v36,7,v33
v_lshlrev_b32 v36,1,v36
v_add_u32 v37,0,v32
v_xor_b32 v37,v37,v36
v_lshlrev_b32 v37,4,v37
v_lshl_add_u32 v0,v33,9,v37
buffer_load_dwordx4 v27,s[16:19],s28 offen offset:3072 lds
v_add_u32 v37,4,v32
v_xor_b32 v37,v37,v36
v_lshlrev_b32 v37,4,v37
v_lshl_add_u32 v1,v33,9,v37
v_add_u32 v37,8,v32
v_xor_b32 v37,v37,v36
v_lshlrev_b32 v37,4,v37
v_lshl_add_u32 v2,v33,9,v37
s_add_u32 m0,s25,65536
s_add_u32 s28,s29,786432
buffer_load_dwordx4 v20,s[12:15],s28 offen lds
v_add_u32 v37,12,v32
v_xor_b32 v37,v37,v36
v_lshlrev_b32 v37,4,v37
v_lshl_add_u32 v3,v33,9,v37
s_mov_b32 s30,0
s_mov_b32 s60,0x3db8aa3b
s_mov_b32 s61,s60
s_mul_i32 s62,s24,688128
buffer_load_dwordx4 v21,s[12:15],s28 offen offset:1024 lds
s_add_u32 s63,s62,229376
s_add_u32 s64,s62,458752
s_mul_i32 s67,s24,28672
s_lshl_b32 s54,s58,3
s_add_u32 s54,s54,s57
s_lshl_b32 s68,s54,4
s_add_u32 s68,s68,s56
s_lshl_b32 s68,s68,10
buffer_load_dwordx4 v22,s[12:15],s28 offen offset:2048 lds
s_add_u32 s68,50331648,s68
s_mul_i32 s55,s24,192
s_add_u32 s68,s68,s55
s_mul_i32 s54,s54,2523136
s_mul_i32 s55,s56,1024
s_add_u32 s54,s54,s55
s_sub_u32 s68,s68,s54
s_add_u32 s20,s52,s54
s_addc_u32 s21,s53,0
buffer_load_dwordx4 v23,s[12:15],s28 offen offset:3072 lds
s_mov_b32 s22,67108864
s_mov_b32 s23,0x20000
s_mul_i32 s54,s56,229376
s_add_u32 s96,s96,s54
s_addc_u32 s97,s97,0
s_mov_b32 s98,229376
s_mov_b32 s99,0x20000
s_mov_b64 s[32:33],s[12:13]
s_mov_b64 s[34:35],s[14:15]
s_add_u32 m0,s25,32768
s_add_u32 s28,s29,1048576
buffer_load_dwordx4 v20,s[12:15],s28 offen lds
s_mov_b32 s36,0
s_add_u32 s37,s25,49152
s_add_u32 s38,s25,81920
s_add_u32 s40,s29,1310720
s_add_u32 s39,s29,1572864
s_mov_b32 s41,524288
s_mov_b32 s42,256
s_mov_b32 s43,s69
buffer_load_dwordx4 v21,s[12:15],s28 offen offset:1024 lds
s_mov_b32 s45,24576
s_mov_b32 s46,16384
v_mov_b64 v[64:65],0
v_mov_b64 v[66:67],0
v_mov_b64 v[68:69],0
v_mov_b64 v[70:71],0
v_mov_b64 v[72:73],0
v_mov_b64 v[74:75],0
buffer_load_dwordx4 v22,s[12:15],s28 offen offset:2048 lds
v_mov_b64 v[76:77],0
v_mov_b64 v[78:79],0
v_mov_b64 v[80:81],0
v_mov_b64 v[82:83],0
v_mov_b64 v[84:85],0
v_mov_b64 v[86:87],0
v_mov_b64 v[88:89],0
v_mov_b64 v[90:91],0
buffer_load_dwordx4 v23,s[12:15],s28 offen offset:3072 lds
v_mov_b64 v[92:93],0
v_mov_b64 v[94:95],0
v_mov_b64 v[96:97],0
v_mov_b64 v[98:99],0
v_mov_b64 v[100:101],0
v_mov_b64 v[102:103],0
v_mov_b64 v[104:105],0
v_mov_b64 v[106:107],0
s_mov_b32 m0,s25
s_nop 0
buffer_load_dwordx4 v12,s[4:7],s25 offen nt lds
v_mov_b64 v[108:109],0
v_mov_b64 v[110:111],0
v_mov_b64 v[112:113],0
v_mov_b64 v[114:115],0
v_mov_b64 v[116:117],0
v_mov_b64 v[118:119],0
v_mov_b64 v[120:121],0
v_mov_b64 v[122:123],0
buffer_load_dwordx4 v13,s[4:7],s25 offen offset:1024 nt lds
v_mov_b64 v[124:125],0
v_mov_b64 v[126:127],0
v_mov_b64 v[128:129],0
v_mov_b64 v[130:131],0
v_mov_b64 v[132:133],0
v_mov_b64 v[134:135],0
v_mov_b64 v[136:137],0
v_mov_b64 v[138:139],0
buffer_load_dwordx4 v14,s[4:7],s25 offen offset:2048 nt lds
v_mov_b64 v[140:141],0
v_mov_b64 v[142:143],0
v_mov_b64 v[144:145],0
v_mov_b64 v[146:147],0
v_mov_b64 v[148:149],0
v_mov_b64 v[150:151],0
v_mov_b64 v[152:153],0
v_mov_b64 v[154:155],0
buffer_load_dwordx4 v15,s[4:7],s25 offen offset:3072 nt lds
v_mov_b64 v[156:157],0
v_mov_b64 v[158:159],0
v_mov_b64 v[160:161],0
v_mov_b64 v[162:163],0
v_mov_b64 v[164:165],0
v_mov_b64 v[166:167],0
v_mov_b64 v[168:169],0
v_mov_b64 v[170:171],0
v_mov_b64 v[172:173],0
v_mov_b64 v[174:175],0
v_mov_b64 v[176:177],0
v_mov_b64 v[178:179],0
v_mov_b64 v[180:181],0
v_mov_b64 v[182:183],0
v_mov_b64 v[184:185],0
v_mov_b64 v[186:187],0
v_mov_b64 v[188:189],0
v_mov_b64 v[190:191],0
s_waitcnt vmcnt(24)
s_barrier
ds_read_b128 a[0:3],v44 offset:0
ds_read_b128 a[4:7],v44 offset:2048
ds_read_b64_tr_b16 a[192:193],v16 offset:0
ds_read_b64_tr_b16 a[194:195],v16 offset:8192
ds_read_b64_tr_b16 a[196:197],v16 offset:8
ds_read_b64_tr_b16 a[198:199],v16 offset:8200
ds_read_b64_tr_b16 a[200:201],v17 offset:0
ds_read_b64_tr_b16 a[202:203],v17 offset:8192
ds_read_b64_tr_b16 a[204:205],v17 offset:8
ds_read_b64_tr_b16 a[206:207],v17 offset:8200
ds_read_b64_tr_b16 a[208:209],v18 offset:0
ds_read_b64_tr_b16 a[210:211],v18 offset:8192
s_waitcnt lgkmcnt(8)
v_add_u32 v44,24576,v44
QLOOP_B2:
s_waitcnt vmcnt(20)
s_barrier
s_mov_b32 m0,s38
v_mfma_f32_16x16x32_bf16 v[64:67],a[192:195],a[0:3],v[64:67]
ds_read_b128 a[12:15],v45 offset:0
ds_read_b64_tr_b16 a[212:213],v18 offset:8
ds_read_b64_tr_b16 a[214:215],v18 offset:8200
v_mfma_f32_16x16x32_bf16 v[128:131],a[192:195],a[4:7],v[128:131]
buffer_load_dwordx4 v20,s[32:35],s40 offen lds
s_waitcnt lgkmcnt(9)
v_mfma_f32_16x16x32_bf16 v[68:71],a[196:199],a[0:3],v[68:71]
ds_read_b128 a[16:19],v45 offset:2048
ds_read_b64_tr_b16 a[216:217],v19 offset:0
ds_read_b64_tr_b16 a[218:219],v19 offset:8192
v_mfma_f32_16x16x32_bf16 v[132:135],a[196:199],a[4:7],v[132:135]
buffer_load_dwordx4 v21,s[32:35],s40 offen offset:1024 lds
s_waitcnt lgkmcnt(10)
v_mfma_f32_16x16x32_bf16 v[72:75],a[200:203],a[0:3],v[72:75]
ds_read_b64_tr_b16 a[220:221],v19 offset:8
ds_read_b64_tr_b16 a[222:223],v19 offset:8200
v_mfma_f32_16x16x32_bf16 v[136:139],a[200:203],a[4:7],v[136:139]
buffer_load_dwordx4 v22,s[32:35],s40 offen offset:2048 lds
s_waitcnt lgkmcnt(10)
v_mfma_f32_16x16x32_bf16 v[76:79],a[204:207],a[0:3],v[76:79]
v_add_u32 v45,s45,v45
ds_read_b64_tr_b16 a[192:193],v16 offset:256
ds_read_b64_tr_b16 a[194:195],v16 offset:8448
v_mfma_f32_16x16x32_bf16 v[140:143],a[204:207],a[4:7],v[140:143]
buffer_load_dwordx4 v23,s[32:35],s40 offen offset:3072 lds
s_waitcnt lgkmcnt(10)
v_mfma_f32_16x16x32_bf16 v[80:83],a[208:211],a[0:3],v[80:83]
s_mov_b32 m0,s43
ds_read_b64_tr_b16 a[196:197],v16 offset:264
ds_read_b64_tr_b16 a[198:199],v16 offset:8456
v_mfma_f32_16x16x32_bf16 v[144:147],a[208:211],a[4:7],v[144:147]
s_waitcnt lgkmcnt(9)
v_mfma_f32_16x16x32_bf16 v[84:87],a[212:215],a[0:3],v[84:87]
ds_read_b64_tr_b16 a[200:201],v17 offset:256
ds_read_b64_tr_b16 a[202:203],v17 offset:8448
v_mfma_f32_16x16x32_bf16 v[148:151],a[212:215],a[4:7],v[148:151]
s_waitcnt lgkmcnt(8)
v_mfma_f32_16x16x32_bf16 v[88:91],a[216:219],a[0:3],v[88:91]
ds_read_b64_tr_b16 a[204:205],v17 offset:264
ds_read_b64_tr_b16 a[206:207],v17 offset:8456
v_mfma_f32_16x16x32_bf16 v[152:155],a[216:219],a[4:7],v[152:155]
s_waitcnt lgkmcnt(8)
v_mfma_f32_16x16x32_bf16 v[92:95],a[220:223],a[0:3],v[92:95]
s_waitcnt lgkmcnt(12)
ds_read_b64_tr_b16 a[208:209],v18 offset:256
ds_read_b64_tr_b16 a[210:211],v18 offset:8448
v_mfma_f32_16x16x32_bf16 v[156:159],a[220:223],a[4:7],v[156:159]
buffer_load_dwordx4 v24,s[16:19],s42 offen lds
s_waitcnt lgkmcnt(8)
v_mfma_f32_16x16x32_bf16 v[96:99],a[192:195],a[0:3],v[96:99]
ds_read_b64_tr_b16 a[212:213],v18 offset:264
ds_read_b64_tr_b16 a[214:215],v18 offset:8456
v_mfma_f32_16x16x32_bf16 v[160:163],a[192:195],a[4:7],v[160:163]
buffer_load_dwordx4 v25,s[16:19],s42 offen offset:1024 lds
s_waitcnt lgkmcnt(8)
v_mfma_f32_16x16x32_bf16 v[100:103],a[196:199],a[0:3],v[100:103]
ds_read_b64_tr_b16 a[216:217],v19 offset:256
ds_read_b64_tr_b16 a[218:219],v19 offset:8448
v_mfma_f32_16x16x32_bf16 v[164:167],a[196:199],a[4:7],v[164:167]
buffer_load_dwordx4 v26,s[16:19],s42 offen offset:2048 lds
s_waitcnt lgkmcnt(8)
v_mfma_f32_16x16x32_bf16 v[104:107],a[200:203],a[0:3],v[104:107]
ds_read_b64_tr_b16 a[220:221],v19 offset:264
ds_read_b64_tr_b16 a[222:223],v19 offset:8456
v_mfma_f32_16x16x32_bf16 v[168:171],a[200:203],a[4:7],v[168:171]
buffer_load_dwordx4 v27,s[16:19],s42 offen offset:3072 lds
s_waitcnt lgkmcnt(8)
v_mfma_f32_16x16x32_bf16 v[108:111],a[204:207],a[0:3],v[108:111]
ds_read_b64_tr_b16 a[192:193],v16 offset:49152
ds_read_b64_tr_b16 a[194:195],v16 offset:57344
v_mfma_f32_16x16x32_bf16 v[172:175],a[204:207],a[4:7],v[172:175]
s_waitcnt lgkmcnt(8)
v_mfma_f32_16x16x32_bf16 v[112:115],a[208:211],a[0:3],v[112:115]
ds_read_b64_tr_b16 a[196:197],v16 offset:49160
ds_read_b64_tr_b16 a[198:199],v16 offset:57352
v_mfma_f32_16x16x32_bf16 v[176:179],a[208:211],a[4:7],v[176:179]
s_waitcnt lgkmcnt(8)
v_mfma_f32_16x16x32_bf16 v[116:119],a[212:215],a[0:3],v[116:119]
ds_read_b64_tr_b16 a[200:201],v17 offset:49152
ds_read_b64_tr_b16 a[202:203],v17 offset:57344
v_mfma_f32_16x16x32_bf16 v[180:183],a[212:215],a[4:7],v[180:183]
s_waitcnt lgkmcnt(8)
v_mfma_f32_16x16x32_bf16 v[120:123],a[216:219],a[0:3],v[120:123]
ds_read_b64_tr_b16 a[204:205],v17 offset:49160
ds_read_b64_tr_b16 a[206:207],v17 offset:57352
v_mfma_f32_16x16x32_bf16 v[184:187],a[216:219],a[4:7],v[184:187]
s_waitcnt lgkmcnt(8)
v_mfma_f32_16x16x32_bf16 v[124:127],a[220:223],a[0:3],v[124:127]
ds_read_b64_tr_b16 a[208:209],v18 offset:49152
ds_read_b64_tr_b16 a[210:211],v18 offset:57344
v_mfma_f32_16x16x32_bf16 v[188:191],a[220:223],a[4:7],v[188:191]
s_waitcnt lgkmcnt(8)
s_cmp_eq_u32 s36,4
s_cbranch_scc0 QSW_B2
s_mov_b64 s[12:13],s[4:5]
s_mov_b32 s14,s6
s_mov_b64 s[32:33],s[8:9]
s_mov_b32 s34,s10
s_mov_b32 s41,16384
s_add_u32 s39,s25,16384
s_sub_u32 s40,s25,16384
s_mov_b32 s18,0
v_mov_b32 v20,v12
v_mov_b32 v21,v13
v_mov_b32 v22,v14
v_mov_b32 v23,v15
QSW_B2:
s_waitcnt vmcnt(20)
s_barrier
s_mov_b32 m0,s37
v_mfma_f32_16x16x32_bf16 v[64:67],a[192:195],a[12:15],v[64:67]
s_cmp_ge_u32 s37,49152
ds_read_b64_tr_b16 a[212:213],v18 offset:49160
ds_read_b64_tr_b16 a[214:215],v18 offset:57352
v_mfma_f32_16x16x32_bf16 v[128:131],a[192:195],a[16:19],v[128:131]
buffer_load_dwordx4 v20,s[12:15],s39 offen lds
s_waitcnt lgkmcnt(8)
v_mfma_f32_16x16x32_bf16 v[68:71],a[196:199],a[12:15],v[68:71]
s_cselect_b32 s44,0xffff8000,s46
ds_read_b64_tr_b16 a[216:217],v19 offset:49152
ds_read_b64_tr_b16 a[218:219],v19 offset:57344
v_mfma_f32_16x16x32_bf16 v[132:135],a[196:199],a[16:19],v[132:135]
buffer_load_dwordx4 v21,s[12:15],s39 offen offset:1024 lds
s_waitcnt lgkmcnt(8)
v_mfma_f32_16x16x32_bf16 v[72:75],a[200:203],a[12:15],v[72:75]
s_add_u32 s38,s37,49152
ds_read_b64_tr_b16 a[220:221],v19 offset:49160
ds_read_b64_tr_b16 a[222:223],v19 offset:57352
v_mfma_f32_16x16x32_bf16 v[136:139],a[200:203],a[16:19],v[136:139]
buffer_load_dwordx4 v22,s[12:15],s39 offen offset:2048 lds
s_waitcnt lgkmcnt(8)
v_mfma_f32_16x16x32_bf16 v[76:79],a[204:207],a[12:15],v[76:79]
s_add_u32 s37,s37,s44
ds_read_b64_tr_b16 a[192:193],v16 offset:49408
ds_read_b64_tr_b16 a[194:195],v16 offset:57600
v_mfma_f32_16x16x32_bf16 v[140:143],a[204:207],a[16:19],v[140:143]
buffer_load_dwordx4 v23,s[12:15],s39 offen offset:3072 lds
s_waitcnt lgkmcnt(8)
v_mfma_f32_16x16x32_bf16 v[80:83],a[208:211],a[12:15],v[80:83]
s_add_u32 s39,s39,s41
ds_read_b64_tr_b16 a[196:197],v16 offset:49416
ds_read_b64_tr_b16 a[198:199],v16 offset:57608
v_mfma_f32_16x16x32_bf16 v[144:147],a[208:211],a[16:19],v[144:147]
s_waitcnt lgkmcnt(8)
v_mfma_f32_16x16x32_bf16 v[84:87],a[212:215],a[12:15],v[84:87]
s_add_u32 s40,s40,s41
ds_read_b64_tr_b16 a[200:201],v17 offset:49408
ds_read_b64_tr_b16 a[202:203],v17 offset:57600
v_mfma_f32_16x16x32_bf16 v[148:151],a[212:215],a[16:19],v[148:151]
v_add_u32 v16,s44,v16
s_waitcnt lgkmcnt(8)
v_mfma_f32_16x16x32_bf16 v[88:91],a[216:219],a[12:15],v[88:91]
s_add_u32 s42,s42,128
ds_read_b64_tr_b16 a[204:205],v17 offset:49416
ds_read_b64_tr_b16 a[206:207],v17 offset:57608
v_mfma_f32_16x16x32_bf16 v[152:155],a[216:219],a[16:19],v[152:155]
s_waitcnt lgkmcnt(8)
v_mfma_f32_16x16x32_bf16 v[92:95],a[220:223],a[12:15],v[92:95]
s_add_u32 s43,s43,s45
ds_read_b64_tr_b16 a[208:209],v18 offset:49408
ds_read_b64_tr_b16 a[210:211],v18 offset:57600
v_mfma_f32_16x16x32_bf16 v[156:159],a[220:223],a[16:19],v[156:159]
v_add_u32 v17,s44,v17
s_waitcnt lgkmcnt(8)
v_mfma_f32_16x16x32_bf16 v[96:99],a[192:195],a[12:15],v[96:99]
s_add_u32 s36,s36,1
ds_read_b64_tr_b16 a[212:213],v18 offset:49416
ds_read_b64_tr_b16 a[214:215],v18 offset:57608
v_mfma_f32_16x16x32_bf16 v[160:163],a[192:195],a[16:19],v[160:163]
s_waitcnt lgkmcnt(8)
v_mfma_f32_16x16x32_bf16 v[100:103],a[196:199],a[12:15],v[100:103]
ds_read_b64_tr_b16 a[216:217],v19 offset:49408
ds_read_b64_tr_b16 a[218:219],v19 offset:57600
v_mfma_f32_16x16x32_bf16 v[164:167],a[196:199],a[16:19],v[164:167]
s_waitcnt vmcnt(16)
ds_read_b128 a[0:3],v44 offset:0
s_waitcnt lgkmcnt(9)
v_mfma_f32_16x16x32_bf16 v[104:107],a[200:203],a[12:15],v[104:107]
ds_read_b64_tr_b16 a[220:221],v19 offset:49416
ds_read_b64_tr_b16 a[222:223],v19 offset:57608
v_mfma_f32_16x16x32_bf16 v[168:171],a[200:203],a[16:19],v[168:171]
ds_read_b128 a[4:7],v44 offset:2048
s_waitcnt lgkmcnt(10)
v_mfma_f32_16x16x32_bf16 v[108:111],a[204:207],a[12:15],v[108:111]
ds_read_b64_tr_b16 a[192:193],v16 offset:0
ds_read_b64_tr_b16 a[194:195],v16 offset:8192
v_mfma_f32_16x16x32_bf16 v[172:175],a[204:207],a[16:19],v[172:175]
v_subrev_u32 v44,s45,v44
s_waitcnt lgkmcnt(10)
v_mfma_f32_16x16x32_bf16 v[112:115],a[208:211],a[12:15],v[112:115]
ds_read_b64_tr_b16 a[196:197],v16 offset:8
ds_read_b64_tr_b16 a[198:199],v16 offset:8200
v_mfma_f32_16x16x32_bf16 v[176:179],a[208:211],a[16:19],v[176:179]
s_sub_u32 s45,0,s45
v_add_u32 v18,s44,v18
s_waitcnt lgkmcnt(10)
v_mfma_f32_16x16x32_bf16 v[116:119],a[212:215],a[12:15],v[116:119]
ds_read_b64_tr_b16 a[200:201],v17 offset:0
ds_read_b64_tr_b16 a[202:203],v17 offset:8192
v_mfma_f32_16x16x32_bf16 v[180:183],a[212:215],a[16:19],v[180:183]
v_add_u32 v19,s44,v19
s_waitcnt lgkmcnt(10)
v_mfma_f32_16x16x32_bf16 v[120:123],a[216:219],a[12:15],v[120:123]
ds_read_b64_tr_b16 a[204:205],v17 offset:8
ds_read_b64_tr_b16 a[206:207],v17 offset:8200
v_mfma_f32_16x16x32_bf16 v[184:187],a[216:219],a[16:19],v[184:187]
s_waitcnt lgkmcnt(9)
v_mfma_f32_16x16x32_bf16 v[124:127],a[220:223],a[12:15],v[124:127]
ds_read_b64_tr_b16 a[208:209],v18 offset:0
ds_read_b64_tr_b16 a[210:211],v18 offset:8192
v_mfma_f32_16x16x32_bf16 v[188:191],a[220:223],a[16:19],v[188:191]
s_waitcnt lgkmcnt(8)
s_cmp_lt_u32 s36,7
s_cbranch_scc1 QLOOP_B2
v_pk_mul_f32 v[64:65],s[60:61],v[64:65]
v_pk_mul_f32 v[66:67],s[60:61],v[66:67]
v_pk_mul_f32 v[68:69],s[60:61],v[68:69]
v_pk_mul_f32 v[70:71],s[60:61],v[70:71]
v_cvt_pk_bf16_f32 v16,v64,v65
v_cvt_pk_bf16_f32 v17,v66,v67
v_cvt_pk_bf16_f32 v18,v68,v69
v_cvt_pk_bf16_f32 v19,v70,v71
v_pk_mul_f32 v[72:73],s[60:61],v[72:73]
v_pk_mul_f32 v[74:75],s[60:61],v[74:75]
v_pk_mul_f32 v[76:77],s[60:61],v[76:77]
v_pk_mul_f32 v[78:79],s[60:61],v[78:79]
v_cvt_pk_bf16_f32 v20,v72,v73
v_cvt_pk_bf16_f32 v21,v74,v75
v_cvt_pk_bf16_f32 v22,v76,v77
v_cvt_pk_bf16_f32 v23,v78,v79
v_pk_mul_f32 v[80:81],s[60:61],v[80:81]
v_pk_mul_f32 v[82:83],s[60:61],v[82:83]
v_pk_mul_f32 v[84:85],s[60:61],v[84:85]
v_pk_mul_f32 v[86:87],s[60:61],v[86:87]
v_cvt_pk_bf16_f32 v24,v80,v81
v_cvt_pk_bf16_f32 v25,v82,v83
v_cvt_pk_bf16_f32 v26,v84,v85
v_cvt_pk_bf16_f32 v27,v86,v87
v_pk_mul_f32 v[88:89],s[60:61],v[88:89]
v_pk_mul_f32 v[90:91],s[60:61],v[90:91]
v_pk_mul_f32 v[92:93],s[60:61],v[92:93]
v_pk_mul_f32 v[94:95],s[60:61],v[94:95]
v_cvt_pk_bf16_f32 v28,v88,v89
v_cvt_pk_bf16_f32 v29,v90,v91
v_cvt_pk_bf16_f32 v30,v92,v93
v_cvt_pk_bf16_f32 v31,v94,v95
v_pk_mul_f32 v[96:97],s[60:61],v[96:97]
v_pk_mul_f32 v[98:99],s[60:61],v[98:99]
v_pk_mul_f32 v[100:101],s[60:61],v[100:101]
v_pk_mul_f32 v[102:103],s[60:61],v[102:103]
v_cvt_pk_bf16_f32 v32,v96,v97
v_cvt_pk_bf16_f32 v33,v98,v99
v_cvt_pk_bf16_f32 v34,v100,v101
v_cvt_pk_bf16_f32 v35,v102,v103
v_pk_mul_f32 v[104:105],s[60:61],v[104:105]
v_pk_mul_f32 v[106:107],s[60:61],v[106:107]
v_pk_mul_f32 v[108:109],s[60:61],v[108:109]
v_pk_mul_f32 v[110:111],s[60:61],v[110:111]
v_cvt_pk_bf16_f32 v36,v104,v105
v_cvt_pk_bf16_f32 v37,v106,v107
v_cvt_pk_bf16_f32 v38,v108,v109
v_cvt_pk_bf16_f32 v39,v110,v111
v_pk_mul_f32 v[112:113],s[60:61],v[112:113]
v_pk_mul_f32 v[114:115],s[60:61],v[114:115]
v_pk_mul_f32 v[116:117],s[60:61],v[116:117]
v_pk_mul_f32 v[118:119],s[60:61],v[118:119]
v_cvt_pk_bf16_f32 v40,v112,v113
v_cvt_pk_bf16_f32 v41,v114,v115
v_cvt_pk_bf16_f32 v42,v116,v117
v_cvt_pk_bf16_f32 v43,v118,v119
v_pk_mul_f32 v[120:121],s[60:61],v[120:121]
v_pk_mul_f32 v[122:123],s[60:61],v[122:123]
v_pk_mul_f32 v[124:125],s[60:61],v[124:125]
v_pk_mul_f32 v[126:127],s[60:61],v[126:127]
v_cvt_pk_bf16_f32 v44,v120,v121
v_cvt_pk_bf16_f32 v45,v122,v123
v_cvt_pk_bf16_f32 v46,v124,v125
v_cvt_pk_bf16_f32 v47,v126,v127
v_pk_mul_f32 v[128:129],s[60:61],v[128:129]
v_pk_mul_f32 v[130:131],s[60:61],v[130:131]
v_pk_mul_f32 v[132:133],s[60:61],v[132:133]
v_pk_mul_f32 v[134:135],s[60:61],v[134:135]
v_cvt_pk_bf16_f32 v48,v128,v129
v_cvt_pk_bf16_f32 v49,v130,v131
v_cvt_pk_bf16_f32 v50,v132,v133
v_cvt_pk_bf16_f32 v51,v134,v135
v_pk_mul_f32 v[136:137],s[60:61],v[136:137]
v_pk_mul_f32 v[138:139],s[60:61],v[138:139]
v_pk_mul_f32 v[140:141],s[60:61],v[140:141]
v_pk_mul_f32 v[142:143],s[60:61],v[142:143]
v_cvt_pk_bf16_f32 v52,v136,v137
v_cvt_pk_bf16_f32 v53,v138,v139
v_cvt_pk_bf16_f32 v54,v140,v141
v_cvt_pk_bf16_f32 v55,v142,v143
v_pk_mul_f32 v[144:145],s[60:61],v[144:145]
v_pk_mul_f32 v[146:147],s[60:61],v[146:147]
v_pk_mul_f32 v[148:149],s[60:61],v[148:149]
v_pk_mul_f32 v[150:151],s[60:61],v[150:151]
v_cvt_pk_bf16_f32 v56,v144,v145
v_cvt_pk_bf16_f32 v57,v146,v147
v_cvt_pk_bf16_f32 v58,v148,v149
v_cvt_pk_bf16_f32 v59,v150,v151
s_waitcnt lgkmcnt(0)
ds_read_b128 a[192:195],v0 offset:0
ds_read_b128 a[196:199],v1 offset:0
ds_read_b128 a[200:203],v2 offset:0
ds_read_b128 a[204:207],v3 offset:0
ds_read_b128 a[208:211],v0 offset:256
ds_read_b128 a[212:215],v1 offset:256
ds_read_b128 a[216:219],v2 offset:256
ds_read_b128 a[220:223],v3 offset:256
v_pk_mul_f32 v[152:153],s[60:61],v[152:153]
v_pk_mul_f32 v[154:155],s[60:61],v[154:155]
v_pk_mul_f32 v[156:157],s[60:61],v[156:157]
v_pk_mul_f32 v[158:159],s[60:61],v[158:159]
v_cvt_pk_bf16_f32 v60,v152,v153
v_cvt_pk_bf16_f32 v61,v154,v155
v_cvt_pk_bf16_f32 v62,v156,v157
v_cvt_pk_bf16_f32 v63,v158,v159
v_pk_mul_f32 v[160:161],s[60:61],v[160:161]
v_pk_mul_f32 v[162:163],s[60:61],v[162:163]
v_pk_mul_f32 v[164:165],s[60:61],v[164:165]
v_pk_mul_f32 v[166:167],s[60:61],v[166:167]
v_cvt_pk_bf16_f32 v64,v160,v161
v_cvt_pk_bf16_f32 v65,v162,v163
v_cvt_pk_bf16_f32 v66,v164,v165
v_cvt_pk_bf16_f32 v67,v166,v167
v_pk_mul_f32 v[168:169],s[60:61],v[168:169]
v_pk_mul_f32 v[170:171],s[60:61],v[170:171]
v_pk_mul_f32 v[172:173],s[60:61],v[172:173]
v_pk_mul_f32 v[174:175],s[60:61],v[174:175]
v_cvt_pk_bf16_f32 v68,v168,v169
v_cvt_pk_bf16_f32 v69,v170,v171
v_cvt_pk_bf16_f32 v70,v172,v173
v_cvt_pk_bf16_f32 v71,v174,v175
v_pk_mul_f32 v[176:177],s[60:61],v[176:177]
v_pk_mul_f32 v[178:179],s[60:61],v[178:179]
v_pk_mul_f32 v[180:181],s[60:61],v[180:181]
v_pk_mul_f32 v[182:183],s[60:61],v[182:183]
v_cvt_pk_bf16_f32 v72,v176,v177
v_cvt_pk_bf16_f32 v73,v178,v179
v_cvt_pk_bf16_f32 v74,v180,v181
v_cvt_pk_bf16_f32 v75,v182,v183
v_pk_mul_f32 v[184:185],s[60:61],v[184:185]
v_pk_mul_f32 v[186:187],s[60:61],v[186:187]
v_pk_mul_f32 v[188:189],s[60:61],v[188:189]
v_pk_mul_f32 v[190:191],s[60:61],v[190:191]
v_cvt_pk_bf16_f32 v76,v184,v185
v_cvt_pk_bf16_f32 v77,v186,v187
v_cvt_pk_bf16_f32 v78,v188,v189
v_cvt_pk_bf16_f32 v79,v190,v191
v_mov_b32 v208,0x7f800000
v_mov_b32 v212,0x7f800000
v_mbcnt_lo_u32_b32 v253,-1,0
v_mbcnt_hi_u32_b32 v253,-1,v253
s_getpc_b64 s[38:39]
CW02:
s_lshr_b32 s40,s2,3
s_mul_i32 s40,s40,1536
s_add_u32 s38,s38,(M29_A2-CW02)&0xffffffff
s_addc_u32 s39,s39,((M29_A2-CW02)>>32)&0xffffffff
s_cmp_ge_u32 s40,(M29_A2-M29_A2+(FALLBACK_A2-M29_A2+1535)/1536*1536)
s_cselect_b32 s41,M29_B2-M29_A2-(M29_A2-M29_A2+(FALLBACK_A2-M29_A2+1535)/1536*1536),0
s_add_u32 s40,s40,s41
v_min_u32 v80,11,v253
v_lshl_add_u32 v80,v80,7,s40
v_min_u32 v80,K2_END-M29_A2-4,v80
v_mov_b32 v81,0
v_lshl_add_u64 v[82:83],v[80:81],0,s[38:39]
global_load_dword v111,v[82:83],off
PRE_B2:
s_waitcnt lgkmcnt(3)
v_mfma_f32_16x16x32_bf16 v[112:115],a[192:195],v[16:19],0
ds_read_b128 a[224:227],v0 offset:8192
v_mov_b32 v232,0x3f803f80
v_mov_b32 v233,0x3f803f80
v_mov_b32 v234,0x3f803f80
v_mfma_f32_16x16x32_bf16 v[112:115],a[196:199],v[20:23],v[112:115]
ds_read_b128 a[228:231],v1 offset:8192
v_mov_b32 v235,0x3f803f80
v_mbcnt_lo_u32_b32 v253,-1,0
v_mbcnt_hi_u32_b32 v253,-1,v253
v_mfma_f32_16x16x32_bf16 v[112:115],a[200:203],v[24:27],v[112:115]
s_mov_b32 s31,147456
v_lshl_add_u32 v250,v253,4,s31
s_mov_b32 s26,32768
v_mfma_f32_16x16x32_bf16 v[112:115],a[204:207],v[28:31],v[112:115]
ds_read_b128 a[232:235],v2 offset:8192
v_mfma_f32_16x16x32_bf16 v[112:115],a[208:211],v[32:35],v[112:115]
s_waitcnt lgkmcnt(3)
v_mfma_f32_16x16x32_bf16 v[112:115],a[212:215],v[36:39],v[112:115]
ds_read_b128 a[236:239],v3 offset:8192
v_mfma_f32_16x16x32_bf16 v[112:115],a[216:219],v[40:43],v[112:115]
v_mfma_f32_16x16x32_bf16 v[112:115],a[220:223],v[44:47],v[112:115]
ds_read_b128 a[240:243],v0 offset:8448
v_mfma_f32_16x16x32_bf16 v[128:131],a[192:195],v[48:51],0
ds_read_b128 a[244:247],v1 offset:8448
v_mfma_f32_16x16x32_bf16 v[128:131],a[196:199],v[52:55],v[128:131]
v_mfma_f32_16x16x32_bf16 v[128:131],a[200:203],v[56:59],v[128:131]
ds_read_b128 a[248:251],v2 offset:8448
v_mfma_f32_16x16x32_bf16 v[128:131],a[204:207],v[60:63],v[128:131]
v_mfma_f32_16x16x32_bf16 v[128:131],a[208:211],v[64:67],v[128:131]
ds_read_b128 a[252:255],v3 offset:8448
v_mfma_f32_16x16x32_bf16 v[128:131],a[212:215],v[68:71],v[128:131]
v_mfma_f32_16x16x32_bf16 v[128:131],a[216:219],v[72:75],v[128:131]
ds_read_b128 a[192:195],v0 offset:16384
v_max3_f32 v184,-v208,v112,v113
v_max3_f32 v184,v184,v114,v115
v_mov_b32 v188,v184
v_mfma_f32_16x16x32_bf16 v[128:131],a[220:223],v[76:79],v[128:131]
ds_read_b128 a[196:199],v1 offset:16384
s_waitcnt lgkmcnt(4)
v_mfma_f32_16x16x32_bf16 v[116:119],a[224:227],v[16:19],0
v_permlane32_swap_b32 v184,v188
v_mfma_f32_16x16x32_bf16 v[116:119],a[228:231],v[20:23],v[116:119]
ds_read_b128 a[200:203],v2 offset:16384
v_mfma_f32_16x16x32_bf16 v[116:119],a[232:235],v[24:27],v[116:119]
v_max_f32 v184,v184,v188
v_mov_b32 v188,v184
v_mfma_f32_16x16x32_bf16 v[116:119],a[236:239],v[28:31],v[116:119]
ds_read_b128 a[204:207],v3 offset:16384
v_mfma_f32_16x16x32_bf16 v[116:119],a[240:243],v[32:35],v[116:119]
v_permlane16_swap_b32 v184,v188
v_mfma_f32_16x16x32_bf16 v[116:119],a[244:247],v[36:39],v[116:119]
ds_read_b128 a[208:211],v0 offset:16640
s_waitcnt lgkmcnt(4)
v_mfma_f32_16x16x32_bf16 v[116:119],a[248:251],v[40:43],v[116:119]
ds_read_b128 a[212:215],v1 offset:16640
v_max_f32 v184,v184,v188
v_sub_f32 v208,0,v184
v_sub_f32 v209,0,v184
v_mfma_f32_16x16x32_bf16 v[116:119],a[252:255],v[44:47],v[116:119]
v_sub_f32 v210,0,v184
v_sub_f32 v211,0,v184
v_max3_f32 v185,-v212,v128,v129
v_max3_f32 v185,v185,v130,v131
v_mfma_f32_16x16x32_bf16 v[132:135],a[224:227],v[48:51],0
ds_read_b128 a[216:219],v2 offset:16640
v_mov_b32 v189,v185
v_add_f32 v112,v112,v208
v_mfma_f32_16x16x32_bf16 v[132:135],a[228:231],v[52:55],v[132:135]
v_exp_f32 v112,v112
v_add_f32 v113,v113,v208
v_mfma_f32_16x16x32_bf16 v[132:135],a[232:235],v[56:59],v[132:135]
ds_read_b128 a[220:223],v3 offset:16640
v_permlane32_swap_b32 v185,v189
v_exp_f32 v113,v113
v_mfma_f32_16x16x32_bf16 v[132:135],a[236:239],v[60:63],v[132:135]
v_cvt_pk_bf16_f32 v160,v112,v113
v_add_f32 v114,v114,v208
v_exp_f32 v114,v114
v_mfma_f32_16x16x32_bf16 v[132:135],a[240:243],v[64:67],v[132:135]
ds_read_b128 a[224:227],v0 offset:24576
v_max_f32 v185,v185,v189
v_mov_b32 v189,v185
v_mfma_f32_16x16x32_bf16 v[132:135],a[244:247],v[68:71],v[132:135]
ds_read_b128 a[228:231],v1 offset:24576
v_add_f32 v115,v115,v208
v_exp_f32 v115,v115
v_mfma_f32_16x16x32_bf16 v[132:135],a[248:251],v[72:75],v[132:135]
v_permlane16_swap_b32 v185,v189
v_cvt_pk_bf16_f32 v161,v114,v115
v_mfma_f32_16x16x32_bf16 v[132:135],a[252:255],v[76:79],v[132:135]
ds_read_b128 a[232:235],v2 offset:24576
v_mfma_f32_16x16x32_bf16 v[120:123],a[192:195],v[16:19],v[208:211]
v_max_f32 v185,v185,v189
v_sub_f32 v212,0,v185
v_sub_f32 v213,0,v185
s_waitcnt lgkmcnt(4)
v_mfma_f32_16x16x32_bf16 v[120:123],a[196:199],v[20:23],v[120:123]
ds_read_b128 a[236:239],v3 offset:24576
v_sub_f32 v214,0,v185
v_sub_f32 v215,0,v185
v_mfma_f32_16x16x32_bf16 v[120:123],a[200:203],v[24:27],v[120:123]
v_add_f32 v128,v128,v212
v_exp_f32 v128,v128
v_mfma_f32_16x16x32_bf16 v[120:123],a[204:207],v[28:31],v[120:123]
ds_read_b128 a[240:243],v0 offset:24832
v_add_f32 v129,v129,v212
v_exp_f32 v129,v129
v_mfma_f32_16x16x32_bf16 v[120:123],a[208:211],v[32:35],v[120:123]
ds_read_b128 a[244:247],v1 offset:24832
v_cvt_pk_bf16_f32 v176,v128,v129
v_add_f32 v130,v130,v212
v_mfma_f32_16x16x32_bf16 v[120:123],a[212:215],v[36:39],v[120:123]
v_exp_f32 v130,v130
v_add_f32 v131,v131,v212
v_mfma_f32_16x16x32_bf16 v[120:123],a[216:219],v[40:43],v[120:123]
ds_read_b128 a[248:251],v2 offset:24832
v_exp_f32 v131,v131
s_waitcnt lgkmcnt(4)
v_mfma_f32_16x16x32_bf16 v[120:123],a[220:223],v[44:47],v[120:123]
v_cvt_pk_bf16_f32 v177,v130,v131
v_add_f32 v116,v116,v208
v_exp_f32 v116,v116
v_mfma_f32_16x16x32_bf16 v[136:139],a[192:195],v[48:51],v[212:215]
ds_read_b128 a[252:255],v3 offset:24832
v_add_f32 v117,v117,v208
v_exp_f32 v117,v117
v_mfma_f32_16x16x32_bf16 v[136:139],a[196:199],v[52:55],v[136:139]
v_cvt_pk_bf16_f32 v162,v116,v117
v_add_f32 v118,v118,v208
v_exp_f32 v118,v118
v_mfma_f32_16x16x32_bf16 v[136:139],a[200:203],v[56:59],v[136:139]
v_add_f32 v119,v119,v208
v_exp_f32 v119,v119
v_mfma_f32_16x16x32_bf16 v[136:139],a[204:207],v[60:63],v[136:139]
v_cvt_pk_bf16_f32 v163,v118,v119
v_mfma_f32_16x16x32_bf16 v[136:139],a[208:211],v[64:67],v[136:139]
v_add_f32 v132,v132,v212
v_exp_f32 v132,v132
v_mfma_f32_16x16x32_bf16 v[136:139],a[212:215],v[68:71],v[136:139]
v_mfma_f32_16x16x32_bf16 v[136:139],a[216:219],v[72:75],v[136:139]
s_waitcnt lgkmcnt(0)
s_waitcnt vmcnt(1)
s_barrier
v_mfma_f32_16x16x32_bf16 v[136:139],a[220:223],v[76:79],v[136:139]
ds_read_b128 a[192:195],v0 offset:32768
s_mov_b32 m0,12288
s_mov_b32 s28,77824
v_mfma_f32_16x16x32_bf16 v[124:127],a[224:227],v[16:19],v[208:211]
buffer_load_dwordx4 v12,s[4:7],s28 offen nt lds
buffer_load_dwordx4 v13,s[4:7],s28 offen offset:1024 nt lds
v_mfma_f32_16x16x32_bf16 v[124:127],a[228:231],v[20:23],v[124:127]
ds_read_b128 a[196:199],v1 offset:32768
buffer_load_dwordx4 v14,s[4:7],s28 offen offset:2048 nt lds
v_add_f32 v133,v133,v212
v_mfma_f32_16x16x32_bf16 v[124:127],a[232:235],v[24:27],v[124:127]
buffer_load_dwordx4 v15,s[4:7],s28 offen offset:3072 nt lds
s_mov_b32 m0,16384
s_waitcnt lgkmcnt(2)
v_mfma_f32_16x16x32_bf16 v[124:127],a[236:239],v[28:31],v[124:127]
ds_read_b128 a[200:203],v2 offset:32768
s_mov_b32 s28,81920
buffer_load_dwordx4 v12,s[4:7],s28 offen nt lds
v_mfma_f32_16x16x32_bf16 v[124:127],a[240:243],v[32:35],v[124:127]
buffer_load_dwordx4 v13,s[4:7],s28 offen offset:1024 nt lds
buffer_load_dwordx4 v14,s[4:7],s28 offen offset:2048 nt lds
v_mfma_f32_16x16x32_bf16 v[124:127],a[244:247],v[36:39],v[124:127]
ds_read_b128 a[204:207],v3 offset:32768
buffer_load_dwordx4 v15,s[4:7],s28 offen offset:3072 nt lds
s_mov_b32 m0,20480
v_mfma_f32_16x16x32_bf16 v[124:127],a[248:251],v[40:43],v[124:127]
s_mov_b32 s28,86016
buffer_load_dwordx4 v12,s[4:7],s28 offen nt lds
v_exp_f32 v133,v133
v_mfma_f32_16x16x32_bf16 v[124:127],a[252:255],v[44:47],v[124:127]
ds_read_b128 a[208:211],v0 offset:33024
buffer_load_dwordx4 v13,s[4:7],s28 offen offset:1024 nt lds
v_cvt_pk_bf16_f32 v178,v132,v133
v_mfma_f32_16x16x32_bf16 v[140:143],a[224:227],v[48:51],v[212:215]
buffer_load_dwordx4 v14,s[4:7],s28 offen offset:2048 nt lds
buffer_load_dwordx4 v15,s[4:7],s28 offen offset:3072 nt lds
v_mfma_f32_16x16x32_bf16 v[140:143],a[228:231],v[52:55],v[140:143]
s_mov_b32 m0,24576
s_mov_b32 s28,90112
buffer_load_dwordx4 v12,s[4:7],s28 offen nt lds
v_mfma_f32_16x16x32_bf16 v[140:143],a[232:235],v[56:59],v[140:143]
ds_read_b128 a[212:215],v1 offset:33024
buffer_load_dwordx4 v13,s[4:7],s28 offen offset:1024 nt lds
v_add_f32 v134,v134,v212
v_mfma_f32_16x16x32_bf16 v[140:143],a[236:239],v[60:63],v[140:143]
buffer_load_dwordx4 v14,s[4:7],s28 offen offset:2048 nt lds
buffer_load_dwordx4 v15,s[4:7],s28 offen offset:3072 nt lds
v_mfma_f32_16x16x32_bf16 v[140:143],a[240:243],v[64:67],v[140:143]
ds_read_b128 a[216:219],v2 offset:33024
s_mov_b32 m0,28672
s_mov_b32 s28,94208
v_exp_f32 v134,v134
v_mfma_f32_16x16x32_bf16 v[140:143],a[244:247],v[68:71],v[140:143]
buffer_load_dwordx4 v12,s[4:7],s28 offen nt lds
buffer_load_dwordx4 v13,s[4:7],s28 offen offset:1024 nt lds
v_mfma_f32_16x16x32_bf16 v[140:143],a[248:251],v[72:75],v[140:143]
ds_read_b128 a[220:223],v3 offset:33024
buffer_load_dwordx4 v14,s[4:7],s28 offen offset:2048 nt lds
v_add_f32 v135,v135,v212
v_exp_f32 v135,v135
v_mfma_f32_16x16x32_bf16 v[140:143],a[252:255],v[76:79],v[140:143]
buffer_load_dwordx4 v15,s[4:7],s28 offen offset:3072 nt lds
v_cvt_pk_bf16_f32 v179,v134,v135
M0_B2:
s_waitcnt lgkmcnt(3)
v_mfma_f32_16x16x32_bf16 v[112:115],a[192:195],v[16:19],v[208:211]
ds_read_b128 a[224:227],v0 offset:40960
s_mov_b32 m0,98304
s_mov_b32 s28,32768
v_mfma_f32_16x16x32_bf16 v[112:115],a[196:199],v[20:23],v[112:115]
ds_read_b128 a[228:231],v1 offset:40960
buffer_load_dwordx4 v12,s[8:11],s28 offen nt lds
v_mfma_f32_16x16x32_bf16 v[112:115],a[200:203],v[24:27],v[112:115]
buffer_load_dwordx4 v13,s[8:11],s28 offen offset:1024 nt lds
buffer_load_dwordx4 v14,s[8:11],s28 offen offset:2048 nt lds
v_mfma_f32_16x16x32_bf16 v[112:115],a[204:207],v[28:31],v[112:115]
ds_read_b128 a[232:235],v2 offset:40960
buffer_load_dwordx4 v15,s[8:11],s28 offen offset:3072 nt lds
s_mov_b32 m0,102400
v_mfma_f32_16x16x32_bf16 v[112:115],a[208:211],v[32:35],v[112:115]
s_mov_b32 s28,36864
buffer_load_dwordx4 v12,s[8:11],s28 offen nt lds
s_waitcnt lgkmcnt(4)
v_mfma_f32_16x16x32_bf16 v[112:115],a[212:215],v[36:39],v[112:115]
ds_read_b128 a[236:239],v3 offset:40960
buffer_load_dwordx4 v13,s[8:11],s28 offen offset:1024 nt lds
v_mfma_f32_16x16x32_bf16 v[112:115],a[216:219],v[40:43],v[112:115]
buffer_load_dwordx4 v14,s[8:11],s28 offen offset:2048 nt lds
s_waitcnt lgkmcnt(4)
v_mfma_f32_16x16x32_bf16 v[112:115],a[220:223],v[44:47],v[112:115]
ds_read_b128 a[240:243],v0 offset:41216
buffer_load_dwordx4 v15,s[8:11],s28 offen offset:3072 nt lds
s_mov_b32 m0,106496
v_mfma_f32_16x16x32_bf16 v[128:131],a[192:195],v[48:51],v[212:215]
ds_read_b128 a[244:247],v1 offset:41216
s_mov_b32 s28,40960
buffer_load_dwordx4 v12,s[8:11],s28 offen nt lds
v_mfma_f32_16x16x32_bf16 v[128:131],a[196:199],v[52:55],v[128:131]
buffer_load_dwordx4 v13,s[8:11],s28 offen offset:1024 nt lds
buffer_load_dwordx4 v14,s[8:11],s28 offen offset:2048 nt lds
v_mfma_f32_16x16x32_bf16 v[128:131],a[200:203],v[56:59],v[128:131]
ds_read_b128 a[248:251],v2 offset:41216
buffer_load_dwordx4 v15,s[8:11],s28 offen offset:3072 nt lds
s_mov_b32 m0,110592
v_mfma_f32_16x16x32_bf16 v[128:131],a[204:207],v[60:63],v[128:131]
s_mov_b32 s28,45056
buffer_load_dwordx4 v12,s[8:11],s28 offen nt lds
v_mfma_f32_16x16x32_bf16 v[128:131],a[208:211],v[64:67],v[128:131]
ds_read_b128 a[252:255],v3 offset:41216
buffer_load_dwordx4 v13,s[8:11],s28 offen offset:1024 nt lds
v_mfma_f32_16x16x32_bf16 v[128:131],a[212:215],v[68:71],v[128:131]
buffer_load_dwordx4 v14,s[8:11],s28 offen offset:2048 nt lds
buffer_load_dwordx4 v15,s[8:11],s28 offen offset:3072 nt lds
v_mfma_f32_16x16x32_bf16 v[128:131],a[216:219],v[72:75],v[128:131]
ds_read_b128 a[192:195],v0 offset:49152
s_mov_b32 m0,114688
s_mov_b32 s28,49152
v_mfma_f32_16x16x32_bf16 v[128:131],a[220:223],v[76:79],v[128:131]
ds_read_b128 a[196:199],v1 offset:49152
buffer_load_dwordx4 v12,s[8:11],s28 offen nt lds
s_waitcnt lgkmcnt(4)
v_mfma_f32_16x16x32_bf16 v[116:119],a[224:227],v[16:19],v[208:211]
buffer_load_dwordx4 v13,s[8:11],s28 offen offset:1024 nt lds
buffer_load_dwordx4 v14,s[8:11],s28 offen offset:2048 nt lds
v_mfma_f32_16x16x32_bf16 v[116:119],a[228:231],v[20:23],v[116:119]
ds_read_b128 a[200:203],v2 offset:49152
buffer_load_dwordx4 v15,s[8:11],s28 offen offset:3072 nt lds
s_mov_b32 m0,118784
v_mfma_f32_16x16x32_bf16 v[116:119],a[232:235],v[24:27],v[116:119]
s_mov_b32 s28,53248
buffer_load_dwordx4 v12,s[8:11],s28 offen nt lds
v_mfma_f32_16x16x32_bf16 v[116:119],a[236:239],v[28:31],v[116:119]
ds_read_b128 a[204:207],v3 offset:49152
buffer_load_dwordx4 v13,s[8:11],s28 offen offset:1024 nt lds
v_exp_f32 v123,v123
v_mfma_f32_16x16x32_bf16 v[116:119],a[240:243],v[32:35],v[116:119]
buffer_load_dwordx4 v14,s[8:11],s28 offen offset:2048 nt lds
buffer_load_dwordx4 v15,s[8:11],s28 offen offset:3072 nt lds
v_mfma_f32_16x16x32_bf16 v[116:119],a[244:247],v[36:39],v[116:119]
ds_read_b128 a[208:211],v0 offset:49408
s_mov_b32 m0,122880
s_mov_b32 s28,57344
s_waitcnt lgkmcnt(4)
v_mfma_f32_16x16x32_bf16 v[116:119],a[248:251],v[40:43],v[116:119]
ds_read_b128 a[212:215],v1 offset:49408
buffer_load_dwordx4 v12,s[8:11],s28 offen nt lds
v_mfma_f32_16x16x32_bf16 v[116:119],a[252:255],v[44:47],v[116:119]
buffer_load_dwordx4 v13,s[8:11],s28 offen offset:1024 nt lds
buffer_load_dwordx4 v14,s[8:11],s28 offen offset:2048 nt lds
v_mfma_f32_16x16x32_bf16 v[132:135],a[224:227],v[48:51],v[212:215]
ds_read_b128 a[216:219],v2 offset:49408
buffer_load_dwordx4 v15,s[8:11],s28 offen offset:3072 nt lds
s_mov_b32 m0,126976
v_mfma_f32_16x16x32_bf16 v[132:135],a[228:231],v[52:55],v[132:135]
s_mov_b32 s28,61440
buffer_load_dwordx4 v12,s[8:11],s28 offen nt lds
v_mfma_f32_16x16x32_bf16 v[132:135],a[232:235],v[56:59],v[132:135]
ds_read_b128 a[220:223],v3 offset:49408
buffer_load_dwordx4 v13,s[8:11],s28 offen offset:1024 nt lds
v_exp_f32 v143,v143
v_mfma_f32_16x16x32_bf16 v[132:135],a[236:239],v[60:63],v[132:135]
buffer_load_dwordx4 v14,s[8:11],s28 offen offset:2048 nt lds
buffer_load_dwordx4 v15,s[8:11],s28 offen offset:3072 nt lds
v_mfma_f32_16x16x32_bf16 v[132:135],a[240:243],v[64:67],v[132:135]
ds_read_b128 a[224:227],v0 offset:57344
v_exp_f32 v120,v120
v_exp_f32 v142,v142
v_mfma_f32_16x16x32_bf16 v[132:135],a[244:247],v[68:71],v[132:135]
ds_read_b128 a[228:231],v1 offset:57344
v_exp_f32 v121,v121
v_exp_f32 v141,v141
v_mfma_f32_16x16x32_bf16 v[132:135],a[248:251],v[72:75],v[132:135]
v_cvt_pk_bf16_f32 v164,v120,v121
v_exp_f32 v122,v122
v_exp_f32 v140,v140
v_mfma_f32_16x16x32_bf16 v[132:135],a[252:255],v[76:79],v[132:135]
ds_read_b128 a[232:235],v2 offset:57344
v_cvt_pk_bf16_f32 v165,v122,v123
v_exp_f32 v136,v136
v_mfma_f32_16x16x32_bf16 v[120:123],a[192:195],v[16:19],v[208:211]
v_exp_f32 v137,v137
v_exp_f32 v127,v127
s_waitcnt lgkmcnt(4)
v_mfma_f32_16x16x32_bf16 v[120:123],a[196:199],v[20:23],v[120:123]
ds_read_b128 a[236:239],v3 offset:57344
v_cvt_pk_bf16_f32 v180,v136,v137
v_exp_f32 v138,v138
v_mfma_f32_16x16x32_bf16 v[120:123],a[200:203],v[24:27],v[120:123]
v_exp_f32 v139,v139
v_exp_f32 v124,v124
v_mfma_f32_16x16x32_bf16 v[120:123],a[204:207],v[28:31],v[120:123]
ds_read_b128 a[240:243],v0 offset:57600
v_cvt_pk_bf16_f32 v181,v138,v139
v_exp_f32 v125,v125
v_mfma_f32_16x16x32_bf16 v[120:123],a[208:211],v[32:35],v[120:123]
ds_read_b128 a[244:247],v1 offset:57600
v_cvt_pk_bf16_f32 v166,v124,v125
v_exp_f32 v126,v126
v_mfma_f32_16x16x32_bf16 v[120:123],a[212:215],v[36:39],v[120:123]
v_cvt_pk_bf16_f32 v167,v126,v127
v_cvt_pk_bf16_f32 v182,v140,v141
v_cvt_pk_bf16_f32 v183,v142,v143
v_mfma_f32_16x16x32_bf16 v[120:123],a[216:219],v[40:43],v[120:123]
ds_read_b128 a[248:251],v2 offset:57600
v_exp_f32 v112,v112
s_waitcnt lgkmcnt(4)
v_mfma_f32_16x16x32_bf16 v[120:123],a[220:223],v[44:47],v[120:123]
v_mfma_f32_16x16x32_bf16 v[136:139],a[192:195],v[48:51],v[212:215]
ds_read_b128 a[252:255],v3 offset:57600
v_mfma_f32_16x16x32_bf16 v[136:139],a[196:199],v[52:55],v[136:139]
v_exp_f32 v113,v113
v_mfma_f32_16x16x32_bf16 v[136:139],a[200:203],v[56:59],v[136:139]
v_cvt_pk_bf16_f32 v168,v112,v113
v_mfma_f32_16x16x32_bf16 v[136:139],a[204:207],v[60:63],v[136:139]
v_mfma_f32_16x16x32_bf16 v[136:139],a[208:211],v[64:67],v[136:139]
v_mfma_f32_16x16x32_bf16 v[136:139],a[212:215],v[68:71],v[136:139]
v_exp_f32 v114,v114
v_mfma_f32_16x16x32_bf16 v[136:139],a[216:219],v[72:75],v[136:139]
s_waitcnt lgkmcnt(0)
s_waitcnt vmcnt(61)
s_barrier
v_mfma_f32_16x16x32_bf16 v[136:139],a[220:223],v[76:79],v[136:139]
ds_read_b64_tr_b16 a[192:193],v4 offset:0
ds_read_b64_tr_b16 a[194:195],v4 offset:8192
s_mov_b32 m0,45056
s_mov_b32 s28,110592
v_mfma_f32_16x16x32_bf16 v[124:127],a[224:227],v[16:19],v[208:211]
buffer_load_dwordx4 v12,s[4:7],s28 offen nt lds
buffer_load_dwordx4 v13,s[4:7],s28 offen offset:1024 nt lds
v_mfma_f32_16x16x32_bf16 v[124:127],a[228:231],v[20:23],v[124:127]
ds_read_b64_tr_b16 a[196:197],v4 offset:16384
ds_read_b64_tr_b16 a[198:199],v4 offset:24576
buffer_load_dwordx4 v14,s[4:7],s28 offen offset:2048 nt lds
v_mfma_f32_16x16x32_bf16 v[124:127],a[232:235],v[24:27],v[124:127]
buffer_load_dwordx4 v15,s[4:7],s28 offen offset:3072 nt lds
s_mov_b32 m0,61440
s_waitcnt lgkmcnt(4)
v_mfma_f32_16x16x32_bf16 v[124:127],a[236:239],v[28:31],v[124:127]
ds_read_b64_tr_b16 a[200:201],v5 offset:0
ds_read_b64_tr_b16 a[202:203],v5 offset:8192
s_mov_b32 s28,126976
v_mfma_f32_16x16x32_bf16 v[124:127],a[240:243],v[32:35],v[124:127]
buffer_load_dwordx4 v12,s[4:7],s28 offen nt lds
buffer_load_dwordx4 v13,s[4:7],s28 offen offset:1024 nt lds
v_mfma_f32_16x16x32_bf16 v[124:127],a[244:247],v[36:39],v[124:127]
ds_read_b64_tr_b16 a[204:205],v5 offset:16384
ds_read_b64_tr_b16 a[206:207],v5 offset:24576
buffer_load_dwordx4 v14,s[4:7],s28 offen offset:2048 nt lds
v_mfma_f32_16x16x32_bf16 v[124:127],a[248:251],v[40:43],v[124:127]
buffer_load_dwordx4 v15,s[4:7],s28 offen offset:3072 nt lds
v_exp_f32 v115,v115
v_mfma_f32_16x16x32_bf16 v[124:127],a[252:255],v[44:47],v[124:127]
ds_read_b64_tr_b16 a[208:209],v6 offset:0
ds_read_b64_tr_b16 a[210:211],v6 offset:8192
v_cvt_pk_bf16_f32 v169,v114,v115
v_mfma_f32_16x16x32_bf16 v[140:143],a[224:227],v[48:51],v[212:215]
v_exp_f32 v128,v128
v_mfma_f32_16x16x32_bf16 v[140:143],a[228:231],v[52:55],v[140:143]
ds_read_b64_tr_b16 a[212:213],v6 offset:16384
ds_read_b64_tr_b16 a[214:215],v6 offset:24576
v_exp_f32 v129,v129
v_mfma_f32_16x16x32_bf16 v[140:143],a[232:235],v[56:59],v[140:143]
v_cvt_pk_bf16_f32 v184,v128,v129
v_mfma_f32_16x16x32_bf16 v[140:143],a[236:239],v[60:63],v[140:143]
ds_read_b64_tr_b16 a[216:217],v7 offset:0
ds_read_b64_tr_b16 a[218:219],v7 offset:8192
v_mfma_f32_16x16x32_bf16 v[140:143],a[240:243],v[64:67],v[140:143]
v_exp_f32 v130,v130
v_mfma_f32_16x16x32_bf16 v[140:143],a[244:247],v[68:71],v[140:143]
ds_read_b64_tr_b16 a[220:221],v7 offset:16384
ds_read_b64_tr_b16 a[222:223],v7 offset:24576
v_mfma_f32_16x16x32_bf16 v[140:143],a[248:251],v[72:75],v[140:143]
v_mfma_f32_16x16x32_bf16 v[140:143],a[252:255],v[76:79],v[140:143]
ds_read_b64_tr_b16 a[224:225],v8 offset:0
ds_read_b64_tr_b16 a[226:227],v8 offset:8192
v_exp_f32 v131,v131
v_mfma_f32_16x16x32_bf16 v[220:223],v[232:235],v[160:163],0
v_cvt_pk_bf16_f32 v185,v130,v131
v_mfma_f32_16x16x32_bf16 v[220:223],v[232:235],v[164:167],v[220:223]
ds_read_b64_tr_b16 a[228:229],v8 offset:16384
ds_read_b64_tr_b16 a[230:231],v8 offset:24576
v_mfma_f32_16x16x32_bf16 v[224:227],v[232:235],v[176:179],0
v_exp_f32 v116,v116
v_mfma_f32_16x16x32_bf16 v[224:227],v[232:235],v[180:183],v[224:227]
ds_read_b64_tr_b16 a[232:233],v9 offset:0
ds_read_b64_tr_b16 a[234:235],v9 offset:8192
s_waitcnt lgkmcnt(8)
v_mfma_f32_16x16x32_bf16 a[0:3],a[192:195],v[160:163],0
v_mfma_f32_16x16x32_bf16 a[0:3],a[196:199],v[164:167],a[0:3]
ds_read_b64_tr_b16 a[236:237],v9 offset:16384
ds_read_b64_tr_b16 a[238:239],v9 offset:24576
v_exp_f32 v117,v117
v_mfma_f32_16x16x32_bf16 a[64:67],a[192:195],v[176:179],0
v_cvt_pk_bf16_f32 v170,v116,v117
v_mfma_f32_16x16x32_bf16 a[64:67],a[196:199],v[180:183],a[64:67]
ds_read_b64_tr_b16 a[240:241],v10 offset:0
ds_read_b64_tr_b16 a[242:243],v10 offset:8192
v_mfma_f32_16x16x32_bf16 a[4:7],a[200:203],v[160:163],0
v_exp_f32 v118,v118
v_mfma_f32_16x16x32_bf16 a[4:7],a[204:207],v[164:167],a[4:7]
ds_read_b64_tr_b16 a[244:245],v10 offset:16384
ds_read_b64_tr_b16 a[246:247],v10 offset:24576
v_mfma_f32_16x16x32_bf16 a[68:71],a[200:203],v[176:179],0
v_mfma_f32_16x16x32_bf16 a[68:71],a[204:207],v[180:183],a[68:71]
ds_read_b64_tr_b16 a[248:249],v11 offset:0
ds_read_b64_tr_b16 a[250:251],v11 offset:8192
v_exp_f32 v119,v119
v_mfma_f32_16x16x32_bf16 a[8:11],a[208:211],v[160:163],0
v_cvt_pk_bf16_f32 v171,v118,v119
v_mfma_f32_16x16x32_bf16 a[8:11],a[212:215],v[164:167],a[8:11]
ds_read_b64_tr_b16 a[252:253],v11 offset:16384
ds_read_b64_tr_b16 a[254:255],v11 offset:24576
v_mfma_f32_16x16x32_bf16 a[72:75],a[208:211],v[176:179],0
ds_read_b64_tr_b16 a[192:193],v4 offset:256
ds_read_b64_tr_b16 a[194:195],v4 offset:8448
v_exp_f32 v132,v132
v_mfma_f32_16x16x32_bf16 a[72:75],a[212:215],v[180:183],a[72:75]
v_mfma_f32_16x16x32_bf16 a[12:15],a[216:219],v[160:163],0
ds_read_b64_tr_b16 a[196:197],v4 offset:16640
ds_read_b64_tr_b16 a[198:199],v4 offset:24832
s_waitcnt lgkmcnt(8)
v_mfma_f32_16x16x32_bf16 a[12:15],a[220:223],v[164:167],a[12:15]
v_exp_f32 v133,v133
v_mfma_f32_16x16x32_bf16 a[76:79],a[216:219],v[176:179],0
ds_read_b64_tr_b16 a[200:201],v5 offset:256
ds_read_b64_tr_b16 a[202:203],v5 offset:8448
v_cvt_pk_bf16_f32 v186,v132,v133
v_mfma_f32_16x16x32_bf16 a[76:79],a[220:223],v[180:183],a[76:79]
v_mfma_f32_16x16x32_bf16 a[16:19],a[224:227],v[160:163],0
ds_read_b64_tr_b16 a[204:205],v5 offset:16640
ds_read_b64_tr_b16 a[206:207],v5 offset:24832
v_exp_f32 v134,v134
v_mfma_f32_16x16x32_bf16 a[16:19],a[228:231],v[164:167],a[16:19]
v_mfma_f32_16x16x32_bf16 a[80:83],a[224:227],v[176:179],0
ds_read_b64_tr_b16 a[208:209],v6 offset:256
ds_read_b64_tr_b16 a[210:211],v6 offset:8448
v_mfma_f32_16x16x32_bf16 a[80:83],a[228:231],v[180:183],a[80:83]
v_exp_f32 v135,v135
v_mfma_f32_16x16x32_bf16 a[20:23],a[232:235],v[160:163],0
ds_read_b64_tr_b16 a[212:213],v6 offset:16640
ds_read_b64_tr_b16 a[214:215],v6 offset:24832
v_cvt_pk_bf16_f32 v187,v134,v135
v_mfma_f32_16x16x32_bf16 a[20:23],a[236:239],v[164:167],a[20:23]
v_mfma_f32_16x16x32_bf16 a[84:87],a[232:235],v[176:179],0
ds_read_b64_tr_b16 a[216:217],v7 offset:256
ds_read_b64_tr_b16 a[218:219],v7 offset:8448
v_exp_f32 v120,v120
v_mfma_f32_16x16x32_bf16 a[84:87],a[236:239],v[180:183],a[84:87]
v_mfma_f32_16x16x32_bf16 a[24:27],a[240:243],v[160:163],0
ds_read_b64_tr_b16 a[220:221],v7 offset:16640
ds_read_b64_tr_b16 a[222:223],v7 offset:24832
v_mfma_f32_16x16x32_bf16 a[24:27],a[244:247],v[164:167],a[24:27]
v_exp_f32 v121,v121
v_mfma_f32_16x16x32_bf16 a[88:91],a[240:243],v[176:179],0
ds_read_b64_tr_b16 a[224:225],v8 offset:256
ds_read_b64_tr_b16 a[226:227],v8 offset:8448
v_cvt_pk_bf16_f32 v172,v120,v121
v_mfma_f32_16x16x32_bf16 a[88:91],a[244:247],v[180:183],a[88:91]
s_waitcnt lgkmcnt(6)
v_mfma_f32_16x16x32_bf16 a[28:31],a[248:251],v[160:163],0
ds_read_b64_tr_b16 a[228:229],v8 offset:16640
ds_read_b64_tr_b16 a[230:231],v8 offset:24832
v_exp_f32 v122,v122
v_mfma_f32_16x16x32_bf16 a[28:31],a[252:255],v[164:167],a[28:31]
v_mfma_f32_16x16x32_bf16 a[92:95],a[248:251],v[176:179],0
ds_read_b64_tr_b16 a[232:233],v9 offset:256
ds_read_b64_tr_b16 a[234:235],v9 offset:8448
v_mfma_f32_16x16x32_bf16 a[92:95],a[252:255],v[180:183],a[92:95]
v_exp_f32 v123,v123
v_mfma_f32_16x16x32_bf16 a[32:35],a[192:195],v[160:163],0
ds_read_b64_tr_b16 a[236:237],v9 offset:16640
ds_read_b64_tr_b16 a[238:239],v9 offset:24832
v_cvt_pk_bf16_f32 v173,v122,v123
v_mfma_f32_16x16x32_bf16 a[32:35],a[196:199],v[164:167],a[32:35]
v_mfma_f32_16x16x32_bf16 a[96:99],a[192:195],v[176:179],0
ds_read_b64_tr_b16 a[240:241],v10 offset:256
ds_read_b64_tr_b16 a[242:243],v10 offset:8448
v_exp_f32 v136,v136
v_mfma_f32_16x16x32_bf16 a[96:99],a[196:199],v[180:183],a[96:99]
v_mfma_f32_16x16x32_bf16 a[36:39],a[200:203],v[160:163],0
ds_read_b64_tr_b16 a[244:245],v10 offset:16640
ds_read_b64_tr_b16 a[246:247],v10 offset:24832
v_exp_f32 v137,v137
v_mfma_f32_16x16x32_bf16 a[36:39],a[204:207],v[164:167],a[36:39]
v_cvt_pk_bf16_f32 v188,v136,v137
v_mfma_f32_16x16x32_bf16 a[100:103],a[200:203],v[176:179],0
ds_read_b64_tr_b16 a[248:249],v11 offset:256
ds_read_b64_tr_b16 a[250:251],v11 offset:8448
v_mfma_f32_16x16x32_bf16 a[100:103],a[204:207],v[180:183],a[100:103]
v_exp_f32 v138,v138
v_mfma_f32_16x16x32_bf16 a[40:43],a[208:211],v[160:163],0
ds_read_b64_tr_b16 a[252:253],v11 offset:16640
ds_read_b64_tr_b16 a[254:255],v11 offset:24832
v_mfma_f32_16x16x32_bf16 a[40:43],a[212:215],v[164:167],a[40:43]
v_mfma_f32_16x16x32_bf16 a[104:107],a[208:211],v[176:179],0
v_exp_f32 v139,v139
v_mfma_f32_16x16x32_bf16 a[104:107],a[212:215],v[180:183],a[104:107]
v_cvt_pk_bf16_f32 v189,v138,v139
s_waitcnt lgkmcnt(4)
v_mfma_f32_16x16x32_bf16 a[44:47],a[216:219],v[160:163],0
v_mfma_f32_16x16x32_bf16 a[44:47],a[220:223],v[164:167],a[44:47]
v_exp_f32 v124,v124
v_exp_f32 v125,v125
v_mfma_f32_16x16x32_bf16 a[108:111],a[216:219],v[176:179],0
v_cvt_pk_bf16_f32 v174,v124,v125
s_waitcnt lgkmcnt(0)
s_waitcnt vmcnt(40)
s_barrier
v_mfma_f32_16x16x32_bf16 a[108:111],a[220:223],v[180:183],a[108:111]
ds_read_b128 a[192:195],v0 offset:0
s_mov_b32 m0,77824
s_mov_b32 s28,77824
v_mfma_f32_16x16x32_bf16 a[48:51],a[224:227],v[160:163],0
buffer_load_dwordx4 v12,s[8:11],s28 offen nt lds
buffer_load_dwordx4 v13,s[8:11],s28 offen offset:1024 nt lds
v_mfma_f32_16x16x32_bf16 a[48:51],a[228:231],v[164:167],a[48:51]
ds_read_b128 a[196:199],v1 offset:0
buffer_load_dwordx4 v14,s[8:11],s28 offen offset:2048 nt lds
v_mfma_f32_16x16x32_bf16 a[112:115],a[224:227],v[176:179],0
buffer_load_dwordx4 v15,s[8:11],s28 offen offset:3072 nt lds
s_mov_b32 m0,94208
s_mov_b32 s28,94208
v_mfma_f32_16x16x32_bf16 a[112:115],a[228:231],v[180:183],a[112:115]
ds_read_b128 a[200:203],v2 offset:0
buffer_load_dwordx4 v12,s[8:11],s28 offen nt lds
v_mfma_f32_16x16x32_bf16 a[52:55],a[232:235],v[160:163],0
buffer_load_dwordx4 v13,s[8:11],s28 offen offset:1024 nt lds
buffer_load_dwordx4 v14,s[8:11],s28 offen offset:2048 nt lds
v_mfma_f32_16x16x32_bf16 a[52:55],a[236:239],v[164:167],a[52:55]
ds_read_b128 a[204:207],v3 offset:0
buffer_load_dwordx4 v15,s[8:11],s28 offen offset:3072 nt lds
v_mfma_f32_16x16x32_bf16 a[116:119],a[232:235],v[176:179],0
v_exp_f32 v126,v126
v_mfma_f32_16x16x32_bf16 a[116:119],a[236:239],v[180:183],a[116:119]
v_mfma_f32_16x16x32_bf16 a[56:59],a[240:243],v[160:163],0
ds_read_b128 a[208:211],v0 offset:256
v_mfma_f32_16x16x32_bf16 a[56:59],a[244:247],v[164:167],a[56:59]
v_exp_f32 v127,v127
v_mfma_f32_16x16x32_bf16 a[120:123],a[240:243],v[176:179],0
ds_read_b128 a[212:215],v1 offset:256
v_cvt_pk_bf16_f32 v175,v126,v127
v_mfma_f32_16x16x32_bf16 a[120:123],a[244:247],v[180:183],a[120:123]
s_waitcnt lgkmcnt(6)
v_mfma_f32_16x16x32_bf16 a[60:63],a[248:251],v[160:163],0
ds_read_b128 a[216:219],v2 offset:256
v_mfma_f32_16x16x32_bf16 a[60:63],a[252:255],v[164:167],a[60:63]
v_mfma_f32_16x16x32_bf16 a[124:127],a[248:251],v[176:179],0
ds_read_b128 a[220:223],v3 offset:256
v_mfma_f32_16x16x32_bf16 a[124:127],a[252:255],v[180:183],a[124:127]
LOOP_B2:
s_waitcnt lgkmcnt(3)
v_mfma_f32_16x16x32_bf16 v[112:115],a[192:195],v[16:19],v[208:211]
ds_read_b128 a[224:227],v0 offset:8192
v_exp_f32 v140,v140
v_mfma_f32_16x16x32_bf16 v[112:115],a[196:199],v[20:23],v[112:115]
ds_read_b128 a[228:231],v1 offset:8192
v_mfma_f32_16x16x32_bf16 v[112:115],a[200:203],v[24:27],v[112:115]
v_mfma_f32_16x16x32_bf16 v[112:115],a[204:207],v[28:31],v[112:115]
ds_read_b128 a[232:235],v2 offset:8192
v_exp_f32 v141,v141
v_mfma_f32_16x16x32_bf16 v[112:115],a[208:211],v[32:35],v[112:115]
v_cvt_pk_bf16_f32 v190,v140,v141
s_waitcnt lgkmcnt(4)
v_mfma_f32_16x16x32_bf16 v[112:115],a[212:215],v[36:39],v[112:115]
ds_read_b128 a[236:239],v3 offset:8192
v_mfma_f32_16x16x32_bf16 v[112:115],a[216:219],v[40:43],v[112:115]
v_exp_f32 v142,v142
s_waitcnt lgkmcnt(4)
v_mfma_f32_16x16x32_bf16 v[112:115],a[220:223],v[44:47],v[112:115]
ds_read_b128 a[240:243],v0 offset:8448
v_mfma_f32_16x16x32_bf16 v[128:131],a[192:195],v[48:51],v[212:215]
ds_read_b128 a[244:247],v1 offset:8448
v_mfma_f32_16x16x32_bf16 v[128:131],a[196:199],v[52:55],v[128:131]
v_exp_f32 v143,v143
v_mfma_f32_16x16x32_bf16 v[128:131],a[200:203],v[56:59],v[128:131]
ds_read_b128 a[248:251],v2 offset:8448
v_cvt_pk_bf16_f32 v191,v142,v143
v_mfma_f32_16x16x32_bf16 v[128:131],a[204:207],v[60:63],v[128:131]
v_mfma_f32_16x16x32_bf16 v[128:131],a[208:211],v[64:67],v[128:131]
ds_read_b128 a[252:255],v3 offset:8448
v_mfma_f32_16x16x32_bf16 v[128:131],a[212:215],v[68:71],v[128:131]
v_mfma_f32_16x16x32_bf16 v[128:131],a[216:219],v[72:75],v[128:131]
ds_read_b128 a[192:195],v0 offset:16384
v_exp_f32 v112,v112
v_mfma_f32_16x16x32_bf16 v[128:131],a[220:223],v[76:79],v[128:131]
ds_read_b128 a[196:199],v1 offset:16384
s_waitcnt lgkmcnt(4)
v_mfma_f32_16x16x32_bf16 v[116:119],a[224:227],v[16:19],v[208:211]
v_mfma_f32_16x16x32_bf16 v[116:119],a[228:231],v[20:23],v[116:119]
ds_read_b128 a[200:203],v2 offset:16384
v_exp_f32 v113,v113
v_mfma_f32_16x16x32_bf16 v[116:119],a[232:235],v[24:27],v[116:119]
v_cvt_pk_bf16_f32 v160,v112,v113
v_mfma_f32_16x16x32_bf16 v[116:119],a[236:239],v[28:31],v[116:119]
ds_read_b128 a[204:207],v3 offset:16384
v_mfma_f32_16x16x32_bf16 v[116:119],a[240:243],v[32:35],v[116:119]
v_exp_f32 v114,v114
v_mfma_f32_16x16x32_bf16 v[116:119],a[244:247],v[36:39],v[116:119]
ds_read_b128 a[208:211],v0 offset:16640
s_waitcnt lgkmcnt(4)
v_mfma_f32_16x16x32_bf16 v[116:119],a[248:251],v[40:43],v[116:119]
ds_read_b128 a[212:215],v1 offset:16640
v_mfma_f32_16x16x32_bf16 v[116:119],a[252:255],v[44:47],v[116:119]
v_exp_f32 v115,v115
v_mfma_f32_16x16x32_bf16 v[132:135],a[224:227],v[48:51],v[212:215]
ds_read_b128 a[216:219],v2 offset:16640
v_cvt_pk_bf16_f32 v161,v114,v115
v_mfma_f32_16x16x32_bf16 v[132:135],a[228:231],v[52:55],v[132:135]
v_mfma_f32_16x16x32_bf16 v[132:135],a[232:235],v[56:59],v[132:135]
ds_read_b128 a[220:223],v3 offset:16640
v_mfma_f32_16x16x32_bf16 v[132:135],a[236:239],v[60:63],v[132:135]
v_exp_f32 v128,v128
v_mfma_f32_16x16x32_bf16 v[132:135],a[240:243],v[64:67],v[132:135]
ds_read_b128 a[224:227],v0 offset:24576
v_mfma_f32_16x16x32_bf16 v[132:135],a[244:247],v[68:71],v[132:135]
ds_read_b128 a[228:231],v1 offset:24576
v_mfma_f32_16x16x32_bf16 v[132:135],a[248:251],v[72:75],v[132:135]
v_exp_f32 v129,v129
v_mfma_f32_16x16x32_bf16 v[132:135],a[252:255],v[76:79],v[132:135]
ds_read_b128 a[232:235],v2 offset:24576
v_cvt_pk_bf16_f32 v176,v128,v129
v_mfma_f32_16x16x32_bf16 v[120:123],a[192:195],v[16:19],v[208:211]
s_waitcnt lgkmcnt(4)
v_mfma_f32_16x16x32_bf16 v[120:123],a[196:199],v[20:23],v[120:123]
ds_read_b128 a[236:239],v3 offset:24576
v_exp_f32 v130,v130
v_mfma_f32_16x16x32_bf16 v[120:123],a[200:203],v[24:27],v[120:123]
v_mfma_f32_16x16x32_bf16 v[120:123],a[204:207],v[28:31],v[120:123]
ds_read_b128 a[240:243],v0 offset:24832
v_mfma_f32_16x16x32_bf16 v[120:123],a[208:211],v[32:35],v[120:123]
ds_read_b128 a[244:247],v1 offset:24832
v_exp_f32 v131,v131
v_mfma_f32_16x16x32_bf16 v[120:123],a[212:215],v[36:39],v[120:123]
v_cvt_pk_bf16_f32 v177,v130,v131
v_mfma_f32_16x16x32_bf16 v[120:123],a[216:219],v[40:43],v[120:123]
ds_read_b128 a[248:251],v2 offset:24832
s_waitcnt lgkmcnt(4)
v_mfma_f32_16x16x32_bf16 v[120:123],a[220:223],v[44:47],v[120:123]
v_exp_f32 v116,v116
v_mfma_f32_16x16x32_bf16 v[136:139],a[192:195],v[48:51],v[212:215]
ds_read_b128 a[252:255],v3 offset:24832
v_mfma_f32_16x16x32_bf16 v[136:139],a[196:199],v[52:55],v[136:139]
v_mfma_f32_16x16x32_bf16 v[136:139],a[200:203],v[56:59],v[136:139]
v_mfma_f32_16x16x32_bf16 v[136:139],a[204:207],v[60:63],v[136:139]
v_mfma_f32_16x16x32_bf16 v[136:139],a[208:211],v[64:67],v[136:139]
v_exp_f32 v117,v117
v_mfma_f32_16x16x32_bf16 v[136:139],a[212:215],v[68:71],v[136:139]
v_cvt_pk_bf16_f32 v162,v116,v117
v_exp_f32 v118,v118
v_mfma_f32_16x16x32_bf16 v[136:139],a[216:219],v[72:75],v[136:139]
s_waitcnt lgkmcnt(0)
s_waitcnt vmcnt(16)
s_barrier
v_mfma_f32_16x16x32_bf16 v[136:139],a[220:223],v[76:79],v[136:139]
ds_read_b64_tr_b16 a[192:193],v4 offset:32768
ds_read_b64_tr_b16 a[194:195],v4 offset:40960
s_mov_b32 m0,12288
s_add_u32 s28,s26,110592
v_mfma_f32_16x16x32_bf16 v[124:127],a[224:227],v[16:19],v[208:211]
buffer_load_dwordx4 v12,s[4:7],s28 offen nt lds
buffer_load_dwordx4 v13,s[4:7],s28 offen offset:1024 nt lds
v_mfma_f32_16x16x32_bf16 v[124:127],a[228:231],v[20:23],v[124:127]
ds_read_b64_tr_b16 a[196:197],v4 offset:49152
ds_read_b64_tr_b16 a[198:199],v4 offset:57344
buffer_load_dwordx4 v14,s[4:7],s28 offen offset:2048 nt lds
v_mfma_f32_16x16x32_bf16 v[124:127],a[232:235],v[24:27],v[124:127]
buffer_load_dwordx4 v15,s[4:7],s28 offen offset:3072 nt lds
s_mov_b32 m0,28672
s_waitcnt lgkmcnt(4)
v_mfma_f32_16x16x32_bf16 v[124:127],a[236:239],v[28:31],v[124:127]
ds_read_b64_tr_b16 a[200:201],v5 offset:32768
ds_read_b64_tr_b16 a[202:203],v5 offset:40960
s_add_u32 s28,s26,126976
v_mfma_f32_16x16x32_bf16 v[124:127],a[240:243],v[32:35],v[124:127]
buffer_load_dwordx4 v12,s[4:7],s28 offen nt lds
buffer_load_dwordx4 v13,s[4:7],s28 offen offset:1024 nt lds
v_mfma_f32_16x16x32_bf16 v[124:127],a[244:247],v[36:39],v[124:127]
ds_read_b64_tr_b16 a[204:205],v5 offset:49152
ds_read_b64_tr_b16 a[206:207],v5 offset:57344
buffer_load_dwordx4 v14,s[4:7],s28 offen offset:2048 nt lds
v_mfma_f32_16x16x32_bf16 v[124:127],a[248:251],v[40:43],v[124:127]
buffer_load_dwordx4 v15,s[4:7],s28 offen offset:3072 nt lds
v_exp_f32 v119,v119
v_mfma_f32_16x16x32_bf16 v[124:127],a[252:255],v[44:47],v[124:127]
ds_read_b64_tr_b16 a[208:209],v6 offset:32768
ds_read_b64_tr_b16 a[210:211],v6 offset:40960
v_cvt_pk_bf16_f32 v163,v118,v119
v_mfma_f32_16x16x32_bf16 v[140:143],a[224:227],v[48:51],v[212:215]
v_mfma_f32_16x16x32_bf16 v[140:143],a[228:231],v[52:55],v[140:143]
ds_read_b64_tr_b16 a[212:213],v6 offset:49152
ds_read_b64_tr_b16 a[214:215],v6 offset:57344
v_mfma_f32_16x16x32_bf16 v[140:143],a[232:235],v[56:59],v[140:143]
v_mfma_f32_16x16x32_bf16 v[140:143],a[236:239],v[60:63],v[140:143]
ds_read_b64_tr_b16 a[216:217],v7 offset:32768
ds_read_b64_tr_b16 a[218:219],v7 offset:40960
v_exp_f32 v132,v132
v_mfma_f32_16x16x32_bf16 v[140:143],a[240:243],v[64:67],v[140:143]
v_mfma_f32_16x16x32_bf16 v[140:143],a[244:247],v[68:71],v[140:143]
ds_read_b64_tr_b16 a[220:221],v7 offset:49152
ds_read_b64_tr_b16 a[222:223],v7 offset:57344
v_mfma_f32_16x16x32_bf16 v[140:143],a[248:251],v[72:75],v[140:143]
v_exp_f32 v133,v133
v_mfma_f32_16x16x32_bf16 v[140:143],a[252:255],v[76:79],v[140:143]
ds_read_b64_tr_b16 a[224:225],v8 offset:32768
ds_read_b64_tr_b16 a[226:227],v8 offset:40960
v_cvt_pk_bf16_f32 v178,v132,v133
v_mfma_f32_16x16x32_bf16 v[220:223],v[232:235],v[168:171],v[220:223]
v_mfma_f32_16x16x32_bf16 v[220:223],v[232:235],v[172:175],v[220:223]
ds_read_b64_tr_b16 a[228:229],v8 offset:49152
ds_read_b64_tr_b16 a[230:231],v8 offset:57344
v_mfma_f32_16x16x32_bf16 v[224:227],v[232:235],v[184:187],v[224:227]
v_exp_f32 v134,v134
v_mfma_f32_16x16x32_bf16 v[224:227],v[232:235],v[188:191],v[224:227]
ds_read_b64_tr_b16 a[232:233],v9 offset:32768
ds_read_b64_tr_b16 a[234:235],v9 offset:40960
s_waitcnt lgkmcnt(8)
v_mfma_f32_16x16x32_bf16 a[0:3],a[192:195],v[168:171],a[0:3]
v_mfma_f32_16x16x32_bf16 a[0:3],a[196:199],v[172:175],a[0:3]
ds_read_b64_tr_b16 a[236:237],v9 offset:49152
ds_read_b64_tr_b16 a[238:239],v9 offset:57344
v_mfma_f32_16x16x32_bf16 a[64:67],a[192:195],v[184:187],a[64:67]
v_exp_f32 v135,v135
v_mfma_f32_16x16x32_bf16 a[64:67],a[196:199],v[188:191],a[64:67]
ds_read_b64_tr_b16 a[240:241],v10 offset:32768
ds_read_b64_tr_b16 a[242:243],v10 offset:40960
v_cvt_pk_bf16_f32 v179,v134,v135
v_mfma_f32_16x16x32_bf16 a[4:7],a[200:203],v[168:171],a[4:7]
v_mfma_f32_16x16x32_bf16 a[4:7],a[204:207],v[172:175],a[4:7]
ds_read_b64_tr_b16 a[244:245],v10 offset:49152
ds_read_b64_tr_b16 a[246:247],v10 offset:57344
v_mfma_f32_16x16x32_bf16 a[68:71],a[200:203],v[184:187],a[68:71]
v_exp_f32 v120,v120
v_mfma_f32_16x16x32_bf16 a[68:71],a[204:207],v[188:191],a[68:71]
ds_read_b64_tr_b16 a[248:249],v11 offset:32768
ds_read_b64_tr_b16 a[250:251],v11 offset:40960
v_mfma_f32_16x16x32_bf16 a[8:11],a[208:211],v[168:171],a[8:11]
v_mfma_f32_16x16x32_bf16 a[8:11],a[212:215],v[172:175],a[8:11]
ds_read_b64_tr_b16 a[252:253],v11 offset:49152
ds_read_b64_tr_b16 a[254:255],v11 offset:57344
v_exp_f32 v121,v121
v_mfma_f32_16x16x32_bf16 a[72:75],a[208:211],v[184:187],a[72:75]
ds_read_b64_tr_b16 a[192:193],v4 offset:33024
ds_read_b64_tr_b16 a[194:195],v4 offset:41216
v_cvt_pk_bf16_f32 v164,v120,v121
v_mfma_f32_16x16x32_bf16 a[72:75],a[212:215],v[188:191],a[72:75]
v_mfma_f32_16x16x32_bf16 a[12:15],a[216:219],v[168:171],a[12:15]
ds_read_b64_tr_b16 a[196:197],v4 offset:49408
ds_read_b64_tr_b16 a[198:199],v4 offset:57600
s_waitcnt lgkmcnt(8)
v_mfma_f32_16x16x32_bf16 a[12:15],a[220:223],v[172:175],a[12:15]
v_exp_f32 v122,v122
v_mfma_f32_16x16x32_bf16 a[76:79],a[216:219],v[184:187],a[76:79]
ds_read_b64_tr_b16 a[200:201],v5 offset:33024
ds_read_b64_tr_b16 a[202:203],v5 offset:41216
v_mfma_f32_16x16x32_bf16 a[76:79],a[220:223],v[188:191],a[76:79]
v_mfma_f32_16x16x32_bf16 a[16:19],a[224:227],v[168:171],a[16:19]
ds_read_b64_tr_b16 a[204:205],v5 offset:49408
ds_read_b64_tr_b16 a[206:207],v5 offset:57600
v_mfma_f32_16x16x32_bf16 a[16:19],a[228:231],v[172:175],a[16:19]
v_exp_f32 v123,v123
v_mfma_f32_16x16x32_bf16 a[80:83],a[224:227],v[184:187],a[80:83]
ds_read_b64_tr_b16 a[208:209],v6 offset:33024
ds_read_b64_tr_b16 a[210:211],v6 offset:41216
v_cvt_pk_bf16_f32 v165,v122,v123
v_mfma_f32_16x16x32_bf16 a[80:83],a[228:231],v[188:191],a[80:83]
v_mfma_f32_16x16x32_bf16 a[20:23],a[232:235],v[168:171],a[20:23]
ds_read_b64_tr_b16 a[212:213],v6 offset:49408
ds_read_b64_tr_b16 a[214:215],v6 offset:57600
v_mfma_f32_16x16x32_bf16 a[20:23],a[236:239],v[172:175],a[20:23]
v_exp_f32 v136,v136
v_mfma_f32_16x16x32_bf16 a[84:87],a[232:235],v[184:187],a[84:87]
ds_read_b64_tr_b16 a[216:217],v7 offset:33024
ds_read_b64_tr_b16 a[218:219],v7 offset:41216
v_mfma_f32_16x16x32_bf16 a[84:87],a[236:239],v[188:191],a[84:87]
v_mfma_f32_16x16x32_bf16 a[24:27],a[240:243],v[168:171],a[24:27]
ds_read_b64_tr_b16 a[220:221],v7 offset:49408
ds_read_b64_tr_b16 a[222:223],v7 offset:57600
v_exp_f32 v137,v137
v_mfma_f32_16x16x32_bf16 a[24:27],a[244:247],v[172:175],a[24:27]
v_cvt_pk_bf16_f32 v180,v136,v137
v_mfma_f32_16x16x32_bf16 a[88:91],a[240:243],v[184:187],a[88:91]
ds_read_b64_tr_b16 a[224:225],v8 offset:33024
ds_read_b64_tr_b16 a[226:227],v8 offset:41216
v_mfma_f32_16x16x32_bf16 a[88:91],a[244:247],v[188:191],a[88:91]
s_waitcnt lgkmcnt(6)
v_mfma_f32_16x16x32_bf16 a[28:31],a[248:251],v[168:171],a[28:31]
ds_read_b64_tr_b16 a[228:229],v8 offset:49408
ds_read_b64_tr_b16 a[230:231],v8 offset:57600
v_exp_f32 v138,v138
v_mfma_f32_16x16x32_bf16 a[28:31],a[252:255],v[172:175],a[28:31]
v_mfma_f32_16x16x32_bf16 a[92:95],a[248:251],v[184:187],a[92:95]
ds_read_b64_tr_b16 a[232:233],v9 offset:33024
ds_read_b64_tr_b16 a[234:235],v9 offset:41216
v_mfma_f32_16x16x32_bf16 a[92:95],a[252:255],v[188:191],a[92:95]
v_exp_f32 v139,v139
v_mfma_f32_16x16x32_bf16 a[32:35],a[192:195],v[168:171],a[32:35]
ds_read_b64_tr_b16 a[236:237],v9 offset:49408
ds_read_b64_tr_b16 a[238:239],v9 offset:57600
v_cvt_pk_bf16_f32 v181,v138,v139
v_mfma_f32_16x16x32_bf16 a[32:35],a[196:199],v[172:175],a[32:35]
v_mfma_f32_16x16x32_bf16 a[96:99],a[192:195],v[184:187],a[96:99]
ds_read_b64_tr_b16 a[240:241],v10 offset:33024
ds_read_b64_tr_b16 a[242:243],v10 offset:41216
v_mfma_f32_16x16x32_bf16 a[96:99],a[196:199],v[188:191],a[96:99]
v_exp_f32 v124,v124
v_mfma_f32_16x16x32_bf16 a[36:39],a[200:203],v[168:171],a[36:39]
ds_read_b64_tr_b16 a[244:245],v10 offset:49408
ds_read_b64_tr_b16 a[246:247],v10 offset:57600
v_mfma_f32_16x16x32_bf16 a[36:39],a[204:207],v[172:175],a[36:39]
v_mfma_f32_16x16x32_bf16 a[100:103],a[200:203],v[184:187],a[100:103]
ds_read_b64_tr_b16 a[248:249],v11 offset:33024
ds_read_b64_tr_b16 a[250:251],v11 offset:41216
v_mfma_f32_16x16x32_bf16 a[100:103],a[204:207],v[188:191],a[100:103]
v_mfma_f32_16x16x32_bf16 a[40:43],a[208:211],v[168:171],a[40:43]
ds_read_b64_tr_b16 a[252:253],v11 offset:49408
ds_read_b64_tr_b16 a[254:255],v11 offset:57600
v_mfma_f32_16x16x32_bf16 a[40:43],a[212:215],v[172:175],a[40:43]
v_exp_f32 v125,v125
v_mfma_f32_16x16x32_bf16 a[104:107],a[208:211],v[184:187],a[104:107]
v_cvt_pk_bf16_f32 v166,v124,v125
v_mfma_f32_16x16x32_bf16 a[104:107],a[212:215],v[188:191],a[104:107]
s_waitcnt lgkmcnt(4)
v_mfma_f32_16x16x32_bf16 a[44:47],a[216:219],v[168:171],a[44:47]
v_mfma_f32_16x16x32_bf16 a[44:47],a[220:223],v[172:175],a[44:47]
v_exp_f32 v126,v126
v_exp_f32 v127,v127
v_mfma_f32_16x16x32_bf16 a[108:111],a[216:219],v[184:187],a[108:111]
v_cvt_pk_bf16_f32 v167,v126,v127
s_waitcnt lgkmcnt(0)
s_waitcnt vmcnt(16)
s_barrier
v_mfma_f32_16x16x32_bf16 a[108:111],a[220:223],v[188:191],a[108:111]
ds_read_b128 a[192:195],v0 offset:32768
s_mov_b32 m0,110592
s_add_u32 s28,s26,77824
v_mfma_f32_16x16x32_bf16 a[48:51],a[224:227],v[168:171],a[48:51]
buffer_load_dwordx4 v12,s[8:11],s28 offen nt lds
buffer_load_dwordx4 v13,s[8:11],s28 offen offset:1024 nt lds
v_mfma_f32_16x16x32_bf16 a[48:51],a[228:231],v[172:175],a[48:51]
ds_read_b128 a[196:199],v1 offset:32768
buffer_load_dwordx4 v14,s[8:11],s28 offen offset:2048 nt lds
v_mfma_f32_16x16x32_bf16 a[112:115],a[224:227],v[184:187],a[112:115]
buffer_load_dwordx4 v15,s[8:11],s28 offen offset:3072 nt lds
s_mov_b32 m0,114688
s_add_u32 s28,s26,81920
v_mfma_f32_16x16x32_bf16 a[112:115],a[228:231],v[188:191],a[112:115]
ds_read_b128 a[200:203],v2 offset:32768
buffer_load_dwordx4 v12,s[8:11],s28 offen nt lds
v_mfma_f32_16x16x32_bf16 a[52:55],a[232:235],v[168:171],a[52:55]
buffer_load_dwordx4 v13,s[8:11],s28 offen offset:1024 nt lds
buffer_load_dwordx4 v14,s[8:11],s28 offen offset:2048 nt lds
v_mfma_f32_16x16x32_bf16 a[52:55],a[236:239],v[172:175],a[52:55]
ds_read_b128 a[204:207],v3 offset:32768
buffer_load_dwordx4 v15,s[8:11],s28 offen offset:3072 nt lds
s_mov_b32 m0,118784
v_mfma_f32_16x16x32_bf16 a[116:119],a[232:235],v[184:187],a[116:119]
s_add_u32 s28,s26,86016
buffer_load_dwordx4 v12,s[8:11],s28 offen nt lds
v_mfma_f32_16x16x32_bf16 a[116:119],a[236:239],v[188:191],a[116:119]
buffer_load_dwordx4 v13,s[8:11],s28 offen offset:1024 nt lds
buffer_load_dwordx4 v14,s[8:11],s28 offen offset:2048 nt lds
v_mfma_f32_16x16x32_bf16 a[56:59],a[240:243],v[168:171],a[56:59]
ds_read_b128 a[208:211],v0 offset:33024
buffer_load_dwordx4 v15,s[8:11],s28 offen offset:3072 nt lds
s_mov_b32 m0,122880
v_mfma_f32_16x16x32_bf16 a[56:59],a[244:247],v[172:175],a[56:59]
s_add_u32 s28,s26,90112
buffer_load_dwordx4 v12,s[8:11],s28 offen nt lds
v_mfma_f32_16x16x32_bf16 a[120:123],a[240:243],v[184:187],a[120:123]
ds_read_b128 a[212:215],v1 offset:33024
buffer_load_dwordx4 v13,s[8:11],s28 offen offset:1024 nt lds
v_mfma_f32_16x16x32_bf16 a[120:123],a[244:247],v[188:191],a[120:123]
buffer_load_dwordx4 v14,s[8:11],s28 offen offset:2048 nt lds
s_waitcnt lgkmcnt(6)
v_mfma_f32_16x16x32_bf16 a[60:63],a[248:251],v[168:171],a[60:63]
ds_read_b128 a[216:219],v2 offset:33024
buffer_load_dwordx4 v15,s[8:11],s28 offen offset:3072 nt lds
s_mov_b32 m0,126976
v_mfma_f32_16x16x32_bf16 a[60:63],a[252:255],v[172:175],a[60:63]
s_add_u32 s28,s26,94208
buffer_load_dwordx4 v12,s[8:11],s28 offen nt lds
v_mfma_f32_16x16x32_bf16 a[124:127],a[248:251],v[184:187],a[124:127]
ds_read_b128 a[220:223],v3 offset:33024
buffer_load_dwordx4 v13,s[8:11],s28 offen offset:1024 nt lds
v_mfma_f32_16x16x32_bf16 a[124:127],a[252:255],v[188:191],a[124:127]
buffer_load_dwordx4 v14,s[8:11],s28 offen offset:2048 nt lds
buffer_load_dwordx4 v15,s[8:11],s28 offen offset:3072 nt lds
s_waitcnt lgkmcnt(3)
v_mfma_f32_16x16x32_bf16 v[112:115],a[192:195],v[16:19],v[208:211]
ds_read_b128 a[224:227],v0 offset:40960
v_exp_f32 v140,v140
v_mfma_f32_16x16x32_bf16 v[112:115],a[196:199],v[20:23],v[112:115]
ds_read_b128 a[228:231],v1 offset:40960
v_mfma_f32_16x16x32_bf16 v[112:115],a[200:203],v[24:27],v[112:115]
v_mfma_f32_16x16x32_bf16 v[112:115],a[204:207],v[28:31],v[112:115]
ds_read_b128 a[232:235],v2 offset:40960
v_exp_f32 v141,v141
v_mfma_f32_16x16x32_bf16 v[112:115],a[208:211],v[32:35],v[112:115]
v_cvt_pk_bf16_f32 v182,v140,v141
s_waitcnt lgkmcnt(4)
v_mfma_f32_16x16x32_bf16 v[112:115],a[212:215],v[36:39],v[112:115]
ds_read_b128 a[236:239],v3 offset:40960
v_mfma_f32_16x16x32_bf16 v[112:115],a[216:219],v[40:43],v[112:115]
v_exp_f32 v142,v142
s_waitcnt lgkmcnt(4)
v_mfma_f32_16x16x32_bf16 v[112:115],a[220:223],v[44:47],v[112:115]
ds_read_b128 a[240:243],v0 offset:41216
v_mfma_f32_16x16x32_bf16 v[128:131],a[192:195],v[48:51],v[212:215]
ds_read_b128 a[244:247],v1 offset:41216
v_mfma_f32_16x16x32_bf16 v[128:131],a[196:199],v[52:55],v[128:131]
v_exp_f32 v143,v143
v_mfma_f32_16x16x32_bf16 v[128:131],a[200:203],v[56:59],v[128:131]
ds_read_b128 a[248:251],v2 offset:41216
v_cvt_pk_bf16_f32 v183,v142,v143
v_mfma_f32_16x16x32_bf16 v[128:131],a[204:207],v[60:63],v[128:131]
v_mfma_f32_16x16x32_bf16 v[128:131],a[208:211],v[64:67],v[128:131]
ds_read_b128 a[252:255],v3 offset:41216
v_mfma_f32_16x16x32_bf16 v[128:131],a[212:215],v[68:71],v[128:131]
v_mfma_f32_16x16x32_bf16 v[128:131],a[216:219],v[72:75],v[128:131]
ds_read_b128 a[192:195],v0 offset:49152
v_exp_f32 v112,v112
v_mfma_f32_16x16x32_bf16 v[128:131],a[220:223],v[76:79],v[128:131]
ds_read_b128 a[196:199],v1 offset:49152
s_waitcnt lgkmcnt(4)
v_mfma_f32_16x16x32_bf16 v[116:119],a[224:227],v[16:19],v[208:211]
v_mfma_f32_16x16x32_bf16 v[116:119],a[228:231],v[20:23],v[116:119]
ds_read_b128 a[200:203],v2 offset:49152
v_exp_f32 v113,v113
v_mfma_f32_16x16x32_bf16 v[116:119],a[232:235],v[24:27],v[116:119]
v_cvt_pk_bf16_f32 v168,v112,v113
v_mfma_f32_16x16x32_bf16 v[116:119],a[236:239],v[28:31],v[116:119]
ds_read_b128 a[204:207],v3 offset:49152
v_mfma_f32_16x16x32_bf16 v[116:119],a[240:243],v[32:35],v[116:119]
v_exp_f32 v114,v114
v_mfma_f32_16x16x32_bf16 v[116:119],a[244:247],v[36:39],v[116:119]
ds_read_b128 a[208:211],v0 offset:49408
s_waitcnt lgkmcnt(4)
v_mfma_f32_16x16x32_bf16 v[116:119],a[248:251],v[40:43],v[116:119]
ds_read_b128 a[212:215],v1 offset:49408
v_mfma_f32_16x16x32_bf16 v[116:119],a[252:255],v[44:47],v[116:119]
v_exp_f32 v115,v115
v_mfma_f32_16x16x32_bf16 v[132:135],a[224:227],v[48:51],v[212:215]
ds_read_b128 a[216:219],v2 offset:49408
v_cvt_pk_bf16_f32 v169,v114,v115
v_mfma_f32_16x16x32_bf16 v[132:135],a[228:231],v[52:55],v[132:135]
v_mfma_f32_16x16x32_bf16 v[132:135],a[232:235],v[56:59],v[132:135]
ds_read_b128 a[220:223],v3 offset:49408
v_mfma_f32_16x16x32_bf16 v[132:135],a[236:239],v[60:63],v[132:135]
v_exp_f32 v128,v128
v_mfma_f32_16x16x32_bf16 v[132:135],a[240:243],v[64:67],v[132:135]
ds_read_b128 a[224:227],v0 offset:57344
v_mfma_f32_16x16x32_bf16 v[132:135],a[244:247],v[68:71],v[132:135]
ds_read_b128 a[228:231],v1 offset:57344
v_mfma_f32_16x16x32_bf16 v[132:135],a[248:251],v[72:75],v[132:135]
v_exp_f32 v129,v129
v_mfma_f32_16x16x32_bf16 v[132:135],a[252:255],v[76:79],v[132:135]
ds_read_b128 a[232:235],v2 offset:57344
v_cvt_pk_bf16_f32 v184,v128,v129
v_mfma_f32_16x16x32_bf16 v[120:123],a[192:195],v[16:19],v[208:211]
s_waitcnt lgkmcnt(4)
v_mfma_f32_16x16x32_bf16 v[120:123],a[196:199],v[20:23],v[120:123]
ds_read_b128 a[236:239],v3 offset:57344
v_exp_f32 v130,v130
v_mfma_f32_16x16x32_bf16 v[120:123],a[200:203],v[24:27],v[120:123]
v_mfma_f32_16x16x32_bf16 v[120:123],a[204:207],v[28:31],v[120:123]
ds_read_b128 a[240:243],v0 offset:57600
v_mfma_f32_16x16x32_bf16 v[120:123],a[208:211],v[32:35],v[120:123]
ds_read_b128 a[244:247],v1 offset:57600
v_exp_f32 v131,v131
v_mfma_f32_16x16x32_bf16 v[120:123],a[212:215],v[36:39],v[120:123]
v_cvt_pk_bf16_f32 v185,v130,v131
v_mfma_f32_16x16x32_bf16 v[120:123],a[216:219],v[40:43],v[120:123]
ds_read_b128 a[248:251],v2 offset:57600
s_waitcnt lgkmcnt(4)
v_mfma_f32_16x16x32_bf16 v[120:123],a[220:223],v[44:47],v[120:123]
v_exp_f32 v116,v116
v_mfma_f32_16x16x32_bf16 v[136:139],a[192:195],v[48:51],v[212:215]
ds_read_b128 a[252:255],v3 offset:57600
v_mfma_f32_16x16x32_bf16 v[136:139],a[196:199],v[52:55],v[136:139]
v_mfma_f32_16x16x32_bf16 v[136:139],a[200:203],v[56:59],v[136:139]
v_mfma_f32_16x16x32_bf16 v[136:139],a[204:207],v[60:63],v[136:139]
v_mfma_f32_16x16x32_bf16 v[136:139],a[208:211],v[64:67],v[136:139]
v_exp_f32 v117,v117
v_mfma_f32_16x16x32_bf16 v[136:139],a[212:215],v[68:71],v[136:139]
v_cvt_pk_bf16_f32 v170,v116,v117
v_exp_f32 v118,v118
v_mfma_f32_16x16x32_bf16 v[136:139],a[216:219],v[72:75],v[136:139]
s_waitcnt lgkmcnt(0)
s_waitcnt vmcnt(28)
s_barrier
v_mfma_f32_16x16x32_bf16 v[136:139],a[220:223],v[76:79],v[136:139]
ds_read_b64_tr_b16 a[192:193],v4 offset:0
ds_read_b64_tr_b16 a[194:195],v4 offset:8192
s_mov_b32 m0,45056
s_add_u32 s28,s26,143360
v_mfma_f32_16x16x32_bf16 v[124:127],a[224:227],v[16:19],v[208:211]
buffer_load_dwordx4 v12,s[4:7],s28 offen nt lds
buffer_load_dwordx4 v13,s[4:7],s28 offen offset:1024 nt lds
v_mfma_f32_16x16x32_bf16 v[124:127],a[228:231],v[20:23],v[124:127]
ds_read_b64_tr_b16 a[196:197],v4 offset:16384
ds_read_b64_tr_b16 a[198:199],v4 offset:24576
buffer_load_dwordx4 v14,s[4:7],s28 offen offset:2048 nt lds
v_mfma_f32_16x16x32_bf16 v[124:127],a[232:235],v[24:27],v[124:127]
buffer_load_dwordx4 v15,s[4:7],s28 offen offset:3072 nt lds
s_mov_b32 m0,61440
s_waitcnt lgkmcnt(4)
v_mfma_f32_16x16x32_bf16 v[124:127],a[236:239],v[28:31],v[124:127]
ds_read_b64_tr_b16 a[200:201],v5 offset:0
ds_read_b64_tr_b16 a[202:203],v5 offset:8192
s_add_u32 s28,s26,159744
v_mfma_f32_16x16x32_bf16 v[124:127],a[240:243],v[32:35],v[124:127]
buffer_load_dwordx4 v12,s[4:7],s28 offen nt lds
buffer_load_dwordx4 v13,s[4:7],s28 offen offset:1024 nt lds
v_mfma_f32_16x16x32_bf16 v[124:127],a[244:247],v[36:39],v[124:127]
ds_read_b64_tr_b16 a[204:205],v5 offset:16384
ds_read_b64_tr_b16 a[206:207],v5 offset:24576
buffer_load_dwordx4 v14,s[4:7],s28 offen offset:2048 nt lds
v_mfma_f32_16x16x32_bf16 v[124:127],a[248:251],v[40:43],v[124:127]
buffer_load_dwordx4 v15,s[4:7],s28 offen offset:3072 nt lds
v_exp_f32 v119,v119
v_mfma_f32_16x16x32_bf16 v[124:127],a[252:255],v[44:47],v[124:127]
ds_read_b64_tr_b16 a[208:209],v6 offset:0
ds_read_b64_tr_b16 a[210:211],v6 offset:8192
v_cvt_pk_bf16_f32 v171,v118,v119
v_mfma_f32_16x16x32_bf16 v[140:143],a[224:227],v[48:51],v[212:215]
v_mfma_f32_16x16x32_bf16 v[140:143],a[228:231],v[52:55],v[140:143]
ds_read_b64_tr_b16 a[212:213],v6 offset:16384
ds_read_b64_tr_b16 a[214:215],v6 offset:24576
v_mfma_f32_16x16x32_bf16 v[140:143],a[232:235],v[56:59],v[140:143]
v_mfma_f32_16x16x32_bf16 v[140:143],a[236:239],v[60:63],v[140:143]
ds_read_b64_tr_b16 a[216:217],v7 offset:0
ds_read_b64_tr_b16 a[218:219],v7 offset:8192
v_exp_f32 v132,v132
v_mfma_f32_16x16x32_bf16 v[140:143],a[240:243],v[64:67],v[140:143]
v_mfma_f32_16x16x32_bf16 v[140:143],a[244:247],v[68:71],v[140:143]
ds_read_b64_tr_b16 a[220:221],v7 offset:16384
ds_read_b64_tr_b16 a[222:223],v7 offset:24576
v_mfma_f32_16x16x32_bf16 v[140:143],a[248:251],v[72:75],v[140:143]
v_exp_f32 v133,v133
v_mfma_f32_16x16x32_bf16 v[140:143],a[252:255],v[76:79],v[140:143]
ds_read_b64_tr_b16 a[224:225],v8 offset:0
ds_read_b64_tr_b16 a[226:227],v8 offset:8192
v_cvt_pk_bf16_f32 v186,v132,v133
v_mfma_f32_16x16x32_bf16 v[220:223],v[232:235],v[160:163],v[220:223]
v_mfma_f32_16x16x32_bf16 v[220:223],v[232:235],v[164:167],v[220:223]
ds_read_b64_tr_b16 a[228:229],v8 offset:16384
ds_read_b64_tr_b16 a[230:231],v8 offset:24576
v_mfma_f32_16x16x32_bf16 v[224:227],v[232:235],v[176:179],v[224:227]
v_exp_f32 v134,v134
v_mfma_f32_16x16x32_bf16 v[224:227],v[232:235],v[180:183],v[224:227]
ds_read_b64_tr_b16 a[232:233],v9 offset:0
ds_read_b64_tr_b16 a[234:235],v9 offset:8192
s_waitcnt lgkmcnt(8)
v_mfma_f32_16x16x32_bf16 a[0:3],a[192:195],v[160:163],a[0:3]
v_mfma_f32_16x16x32_bf16 a[0:3],a[196:199],v[164:167],a[0:3]
ds_read_b64_tr_b16 a[236:237],v9 offset:16384
ds_read_b64_tr_b16 a[238:239],v9 offset:24576
v_mfma_f32_16x16x32_bf16 a[64:67],a[192:195],v[176:179],a[64:67]
v_exp_f32 v135,v135
v_mfma_f32_16x16x32_bf16 a[64:67],a[196:199],v[180:183],a[64:67]
ds_read_b64_tr_b16 a[240:241],v10 offset:0
ds_read_b64_tr_b16 a[242:243],v10 offset:8192
v_cvt_pk_bf16_f32 v187,v134,v135
v_mfma_f32_16x16x32_bf16 a[4:7],a[200:203],v[160:163],a[4:7]
v_mfma_f32_16x16x32_bf16 a[4:7],a[204:207],v[164:167],a[4:7]
ds_read_b64_tr_b16 a[244:245],v10 offset:16384
ds_read_b64_tr_b16 a[246:247],v10 offset:24576
v_mfma_f32_16x16x32_bf16 a[68:71],a[200:203],v[176:179],a[68:71]
v_exp_f32 v120,v120
v_mfma_f32_16x16x32_bf16 a[68:71],a[204:207],v[180:183],a[68:71]
ds_read_b64_tr_b16 a[248:249],v11 offset:0
ds_read_b64_tr_b16 a[250:251],v11 offset:8192
v_mfma_f32_16x16x32_bf16 a[8:11],a[208:211],v[160:163],a[8:11]
v_mfma_f32_16x16x32_bf16 a[8:11],a[212:215],v[164:167],a[8:11]
ds_read_b64_tr_b16 a[252:253],v11 offset:16384
ds_read_b64_tr_b16 a[254:255],v11 offset:24576
v_exp_f32 v121,v121
v_mfma_f32_16x16x32_bf16 a[72:75],a[208:211],v[176:179],a[72:75]
ds_read_b64_tr_b16 a[192:193],v4 offset:256
ds_read_b64_tr_b16 a[194:195],v4 offset:8448
v_cvt_pk_bf16_f32 v172,v120,v121
v_mfma_f32_16x16x32_bf16 a[72:75],a[212:215],v[180:183],a[72:75]
v_mfma_f32_16x16x32_bf16 a[12:15],a[216:219],v[160:163],a[12:15]
ds_read_b64_tr_b16 a[196:197],v4 offset:16640
ds_read_b64_tr_b16 a[198:199],v4 offset:24832
s_waitcnt lgkmcnt(8)
v_mfma_f32_16x16x32_bf16 a[12:15],a[220:223],v[164:167],a[12:15]
v_exp_f32 v122,v122
v_mfma_f32_16x16x32_bf16 a[76:79],a[216:219],v[176:179],a[76:79]
ds_read_b64_tr_b16 a[200:201],v5 offset:256
ds_read_b64_tr_b16 a[202:203],v5 offset:8448
v_mfma_f32_16x16x32_bf16 a[76:79],a[220:223],v[180:183],a[76:79]
v_mfma_f32_16x16x32_bf16 a[16:19],a[224:227],v[160:163],a[16:19]
ds_read_b64_tr_b16 a[204:205],v5 offset:16640
ds_read_b64_tr_b16 a[206:207],v5 offset:24832
v_mfma_f32_16x16x32_bf16 a[16:19],a[228:231],v[164:167],a[16:19]
v_exp_f32 v123,v123
v_mfma_f32_16x16x32_bf16 a[80:83],a[224:227],v[176:179],a[80:83]
ds_read_b64_tr_b16 a[208:209],v6 offset:256
ds_read_b64_tr_b16 a[210:211],v6 offset:8448
v_cvt_pk_bf16_f32 v173,v122,v123
v_mfma_f32_16x16x32_bf16 a[80:83],a[228:231],v[180:183],a[80:83]
v_mfma_f32_16x16x32_bf16 a[20:23],a[232:235],v[160:163],a[20:23]
ds_read_b64_tr_b16 a[212:213],v6 offset:16640
ds_read_b64_tr_b16 a[214:215],v6 offset:24832
v_mfma_f32_16x16x32_bf16 a[20:23],a[236:239],v[164:167],a[20:23]
v_exp_f32 v136,v136
v_mfma_f32_16x16x32_bf16 a[84:87],a[232:235],v[176:179],a[84:87]
ds_read_b64_tr_b16 a[216:217],v7 offset:256
ds_read_b64_tr_b16 a[218:219],v7 offset:8448
v_mfma_f32_16x16x32_bf16 a[84:87],a[236:239],v[180:183],a[84:87]
v_mfma_f32_16x16x32_bf16 a[24:27],a[240:243],v[160:163],a[24:27]
ds_read_b64_tr_b16 a[220:221],v7 offset:16640
ds_read_b64_tr_b16 a[222:223],v7 offset:24832
v_exp_f32 v137,v137
v_mfma_f32_16x16x32_bf16 a[24:27],a[244:247],v[164:167],a[24:27]
v_cvt_pk_bf16_f32 v188,v136,v137
v_mfma_f32_16x16x32_bf16 a[88:91],a[240:243],v[176:179],a[88:91]
ds_read_b64_tr_b16 a[224:225],v8 offset:256
ds_read_b64_tr_b16 a[226:227],v8 offset:8448
v_mfma_f32_16x16x32_bf16 a[88:91],a[244:247],v[180:183],a[88:91]
s_waitcnt lgkmcnt(6)
v_mfma_f32_16x16x32_bf16 a[28:31],a[248:251],v[160:163],a[28:31]
ds_read_b64_tr_b16 a[228:229],v8 offset:16640
ds_read_b64_tr_b16 a[230:231],v8 offset:24832
v_exp_f32 v138,v138
v_mfma_f32_16x16x32_bf16 a[28:31],a[252:255],v[164:167],a[28:31]
v_mfma_f32_16x16x32_bf16 a[92:95],a[248:251],v[176:179],a[92:95]
ds_read_b64_tr_b16 a[232:233],v9 offset:256
ds_read_b64_tr_b16 a[234:235],v9 offset:8448
v_mfma_f32_16x16x32_bf16 a[92:95],a[252:255],v[180:183],a[92:95]
v_exp_f32 v139,v139
v_mfma_f32_16x16x32_bf16 a[32:35],a[192:195],v[160:163],a[32:35]
ds_read_b64_tr_b16 a[236:237],v9 offset:16640
ds_read_b64_tr_b16 a[238:239],v9 offset:24832
v_cvt_pk_bf16_f32 v189,v138,v139
v_mfma_f32_16x16x32_bf16 a[32:35],a[196:199],v[164:167],a[32:35]
v_mfma_f32_16x16x32_bf16 a[96:99],a[192:195],v[176:179],a[96:99]
ds_read_b64_tr_b16 a[240:241],v10 offset:256
ds_read_b64_tr_b16 a[242:243],v10 offset:8448
v_mfma_f32_16x16x32_bf16 a[96:99],a[196:199],v[180:183],a[96:99]
v_exp_f32 v124,v124
v_mfma_f32_16x16x32_bf16 a[36:39],a[200:203],v[160:163],a[36:39]
ds_read_b64_tr_b16 a[244:245],v10 offset:16640
ds_read_b64_tr_b16 a[246:247],v10 offset:24832
v_mfma_f32_16x16x32_bf16 a[36:39],a[204:207],v[164:167],a[36:39]
v_mfma_f32_16x16x32_bf16 a[100:103],a[200:203],v[176:179],a[100:103]
ds_read_b64_tr_b16 a[248:249],v11 offset:256
ds_read_b64_tr_b16 a[250:251],v11 offset:8448
v_mfma_f32_16x16x32_bf16 a[100:103],a[204:207],v[180:183],a[100:103]
v_mfma_f32_16x16x32_bf16 a[40:43],a[208:211],v[160:163],a[40:43]
ds_read_b64_tr_b16 a[252:253],v11 offset:16640
ds_read_b64_tr_b16 a[254:255],v11 offset:24832
v_mfma_f32_16x16x32_bf16 a[40:43],a[212:215],v[164:167],a[40:43]
v_exp_f32 v125,v125
v_mfma_f32_16x16x32_bf16 a[104:107],a[208:211],v[176:179],a[104:107]
v_cvt_pk_bf16_f32 v174,v124,v125
v_mfma_f32_16x16x32_bf16 a[104:107],a[212:215],v[180:183],a[104:107]
s_waitcnt lgkmcnt(4)
v_mfma_f32_16x16x32_bf16 a[44:47],a[216:219],v[160:163],a[44:47]
v_mfma_f32_16x16x32_bf16 a[44:47],a[220:223],v[164:167],a[44:47]
v_exp_f32 v126,v126
v_exp_f32 v127,v127
v_mfma_f32_16x16x32_bf16 a[108:111],a[216:219],v[176:179],a[108:111]
v_cvt_pk_bf16_f32 v175,v126,v127
s_waitcnt lgkmcnt(0)
s_waitcnt vmcnt(28)
s_barrier
v_mfma_f32_16x16x32_bf16 a[108:111],a[220:223],v[180:183],a[108:111]
ds_read_b128 a[192:195],v0 offset:0
s_mov_b32 m0,77824
s_add_u32 s28,s26,110592
v_mfma_f32_16x16x32_bf16 a[48:51],a[224:227],v[160:163],a[48:51]
buffer_load_dwordx4 v12,s[8:11],s28 offen nt lds
buffer_load_dwordx4 v13,s[8:11],s28 offen offset:1024 nt lds
v_mfma_f32_16x16x32_bf16 a[48:51],a[228:231],v[164:167],a[48:51]
ds_read_b128 a[196:199],v1 offset:0
buffer_load_dwordx4 v14,s[8:11],s28 offen offset:2048 nt lds
v_mfma_f32_16x16x32_bf16 a[112:115],a[224:227],v[176:179],a[112:115]
buffer_load_dwordx4 v15,s[8:11],s28 offen offset:3072 nt lds
s_mov_b32 m0,81920
s_add_u32 s28,s26,114688
v_mfma_f32_16x16x32_bf16 a[112:115],a[228:231],v[180:183],a[112:115]
ds_read_b128 a[200:203],v2 offset:0
buffer_load_dwordx4 v12,s[8:11],s28 offen nt lds
v_mfma_f32_16x16x32_bf16 a[52:55],a[232:235],v[160:163],a[52:55]
buffer_load_dwordx4 v13,s[8:11],s28 offen offset:1024 nt lds
buffer_load_dwordx4 v14,s[8:11],s28 offen offset:2048 nt lds
v_mfma_f32_16x16x32_bf16 a[52:55],a[236:239],v[164:167],a[52:55]
ds_read_b128 a[204:207],v3 offset:0
buffer_load_dwordx4 v15,s[8:11],s28 offen offset:3072 nt lds
s_mov_b32 m0,86016
v_mfma_f32_16x16x32_bf16 a[116:119],a[232:235],v[176:179],a[116:119]
s_add_u32 s28,s26,118784
buffer_load_dwordx4 v12,s[8:11],s28 offen nt lds
v_mfma_f32_16x16x32_bf16 a[116:119],a[236:239],v[180:183],a[116:119]
buffer_load_dwordx4 v13,s[8:11],s28 offen offset:1024 nt lds
buffer_load_dwordx4 v14,s[8:11],s28 offen offset:2048 nt lds
v_mfma_f32_16x16x32_bf16 a[56:59],a[240:243],v[160:163],a[56:59]
ds_read_b128 a[208:211],v0 offset:256
buffer_load_dwordx4 v15,s[8:11],s28 offen offset:3072 nt lds
s_mov_b32 m0,90112
v_mfma_f32_16x16x32_bf16 a[56:59],a[244:247],v[164:167],a[56:59]
s_add_u32 s28,s26,122880
buffer_load_dwordx4 v12,s[8:11],s28 offen nt lds
v_mfma_f32_16x16x32_bf16 a[120:123],a[240:243],v[176:179],a[120:123]
ds_read_b128 a[212:215],v1 offset:256
buffer_load_dwordx4 v13,s[8:11],s28 offen offset:1024 nt lds
v_mfma_f32_16x16x32_bf16 a[120:123],a[244:247],v[180:183],a[120:123]
buffer_load_dwordx4 v14,s[8:11],s28 offen offset:2048 nt lds
s_waitcnt lgkmcnt(6)
v_mfma_f32_16x16x32_bf16 a[60:63],a[248:251],v[160:163],a[60:63]
ds_read_b128 a[216:219],v2 offset:256
buffer_load_dwordx4 v15,s[8:11],s28 offen offset:3072 nt lds
s_mov_b32 m0,94208
v_mfma_f32_16x16x32_bf16 a[60:63],a[252:255],v[164:167],a[60:63]
s_add_u32 s28,s26,126976
buffer_load_dwordx4 v12,s[8:11],s28 offen nt lds
v_mfma_f32_16x16x32_bf16 a[124:127],a[248:251],v[176:179],a[124:127]
ds_read_b128 a[220:223],v3 offset:256
buffer_load_dwordx4 v13,s[8:11],s28 offen offset:1024 nt lds
v_mfma_f32_16x16x32_bf16 a[124:127],a[252:255],v[180:183],a[124:127]
buffer_load_dwordx4 v14,s[8:11],s28 offen offset:2048 nt lds
buffer_load_dwordx4 v15,s[8:11],s28 offen offset:3072 nt lds
s_add_u32 s26,s26,65536
s_cmp_lt_u32 s26,950272
s_cbranch_scc1 LOOP_B2
M29_B2:
s_waitcnt lgkmcnt(3)
v_mfma_f32_16x16x32_bf16 v[112:115],a[192:195],v[16:19],v[208:211]
ds_read_b128 a[224:227],v0 offset:8192
v_lshrrev_b32 v254,3,v253
v_and_b32 v255,7,v253
v_and_b32 v251,6,v254
v_mfma_f32_16x16x32_bf16 v[112:115],a[196:199],v[20:23],v[112:115]
ds_read_b128 a[228:231],v1 offset:8192
v_xor_b32 v255,v255,v251
v_lshlrev_b32 v255,4,v255
v_mul_u32_u24 v254,0x380,v254
v_mfma_f32_16x16x32_bf16 v[112:115],a[200:203],v[24:27],v[112:115]
v_add_u32 v236,v254,v255
v_add_u32 v237,6144,v236
v_add_u32 v238,12288,v236
v_add_u32 v239,18432,v236
v_mfma_f32_16x16x32_bf16 v[112:115],a[204:207],v[28:31],v[112:115]
ds_read_b128 a[232:235],v2 offset:8192
v_lshrrev_b32 v254,2,v253
v_and_b32 v255,3,v253
v_bfe_u32 v251,v253,3,2
v_mfma_f32_16x16x32_bf16 v[112:115],a[208:211],v[32:35],v[112:115]
v_lshlrev_b32 v254,7,v254
v_lshl_add_u32 v254,v255,3,v254
v_xor_b32 v255,0,v251
s_waitcnt lgkmcnt(4)
v_mfma_f32_16x16x32_bf16 v[112:115],a[212:215],v[36:39],v[112:115]
ds_read_b128 a[236:239],v3 offset:8192
v_lshl_add_u32 v244,v255,5,v254
v_add_u32 v240,81920,v244
v_xor_b32 v255,1,v251
v_mfma_f32_16x16x32_bf16 v[112:115],a[216:219],v[40:43],v[112:115]
v_lshl_add_u32 v245,v255,5,v254
v_add_u32 v241,81920,v245
v_xor_b32 v255,2,v251
s_waitcnt lgkmcnt(4)
v_mfma_f32_16x16x32_bf16 v[112:115],a[220:223],v[44:47],v[112:115]
ds_read_b128 a[240:243],v0 offset:8448
v_lshl_add_u32 v246,v255,5,v254
v_add_u32 v242,81920,v246
v_xor_b32 v255,3,v251
v_mfma_f32_16x16x32_bf16 v[128:131],a[192:195],v[48:51],v[212:215]
ds_read_b128 a[244:247],v1 offset:8448
v_lshl_add_u32 v247,v255,5,v254
v_add_u32 v243,81920,v247
v_lshlrev_b32 v248,4,v253
v_mfma_f32_16x16x32_bf16 v[128:131],a[196:199],v[52:55],v[128:131]
v_add_u32 v249,16384,v248
s_mov_b32 s31,65536
v_lshl_add_u32 v252,v253,3,s31
v_mov_b32 v251,v252
v_mfma_f32_16x16x32_bf16 v[128:131],a[200:203],v[56:59],v[128:131]
ds_read_b128 a[248:251],v2 offset:8448
v_exp_f32 v140,v140
v_mfma_f32_16x16x32_bf16 v[128:131],a[204:207],v[60:63],v[128:131]
v_exp_f32 v141,v141
v_exp_f32 v142,v142
v_mfma_f32_16x16x32_bf16 v[128:131],a[208:211],v[64:67],v[128:131]
ds_read_b128 a[252:255],v3 offset:8448
v_cvt_pk_bf16_f32 v190,v140,v141
v_mfma_f32_16x16x32_bf16 v[128:131],a[212:215],v[68:71],v[128:131]
v_mfma_f32_16x16x32_bf16 v[128:131],a[216:219],v[72:75],v[128:131]
ds_read_b128 a[192:195],v0 offset:16384
v_mfma_f32_16x16x32_bf16 v[128:131],a[220:223],v[76:79],v[128:131]
ds_read_b128 a[196:199],v1 offset:16384
v_exp_f32 v143,v143
s_waitcnt lgkmcnt(4)
v_mfma_f32_16x16x32_bf16 v[116:119],a[224:227],v[16:19],v[208:211]
v_cvt_pk_bf16_f32 v191,v142,v143
v_mfma_f32_16x16x32_bf16 v[116:119],a[228:231],v[20:23],v[116:119]
ds_read_b128 a[200:203],v2 offset:16384
v_mfma_f32_16x16x32_bf16 v[116:119],a[232:235],v[24:27],v[116:119]
v_mfma_f32_16x16x32_bf16 v[116:119],a[236:239],v[28:31],v[116:119]
ds_read_b128 a[204:207],v3 offset:16384
v_mfma_f32_16x16x32_bf16 v[116:119],a[240:243],v[32:35],v[116:119]
v_mfma_f32_16x16x32_bf16 v[116:119],a[244:247],v[36:39],v[116:119]
ds_read_b128 a[208:211],v0 offset:16640
v_exp_f32 v112,v112
s_waitcnt lgkmcnt(4)
v_mfma_f32_16x16x32_bf16 v[116:119],a[248:251],v[40:43],v[116:119]
ds_read_b128 a[212:215],v1 offset:16640
v_mfma_f32_16x16x32_bf16 v[116:119],a[252:255],v[44:47],v[116:119]
v_exp_f32 v113,v113
v_mfma_f32_16x16x32_bf16 v[132:135],a[224:227],v[48:51],v[212:215]
ds_read_b128 a[216:219],v2 offset:16640
v_cvt_pk_bf16_f32 v160,v112,v113
v_mfma_f32_16x16x32_bf16 v[132:135],a[228:231],v[52:55],v[132:135]
v_mfma_f32_16x16x32_bf16 v[132:135],a[232:235],v[56:59],v[132:135]
ds_read_b128 a[220:223],v3 offset:16640
v_exp_f32 v114,v114
v_mfma_f32_16x16x32_bf16 v[132:135],a[236:239],v[60:63],v[132:135]
v_mfma_f32_16x16x32_bf16 v[132:135],a[240:243],v[64:67],v[132:135]
ds_read_b128 a[224:227],v0 offset:24576
v_mfma_f32_16x16x32_bf16 v[132:135],a[244:247],v[68:71],v[132:135]
ds_read_b128 a[228:231],v1 offset:24576
v_exp_f32 v115,v115
v_mfma_f32_16x16x32_bf16 v[132:135],a[248:251],v[72:75],v[132:135]
v_cvt_pk_bf16_f32 v161,v114,v115
v_mfma_f32_16x16x32_bf16 v[132:135],a[252:255],v[76:79],v[132:135]
ds_read_b128 a[232:235],v2 offset:24576
v_mfma_f32_16x16x32_bf16 v[120:123],a[192:195],v[16:19],v[208:211]
v_exp_f32 v128,v128
s_waitcnt lgkmcnt(4)
v_mfma_f32_16x16x32_bf16 v[120:123],a[196:199],v[20:23],v[120:123]
ds_read_b128 a[236:239],v3 offset:24576
v_mfma_f32_16x16x32_bf16 v[120:123],a[200:203],v[24:27],v[120:123]
v_exp_f32 v129,v129
v_mfma_f32_16x16x32_bf16 v[120:123],a[204:207],v[28:31],v[120:123]
ds_read_b128 a[240:243],v0 offset:24832
v_cvt_pk_bf16_f32 v176,v128,v129
v_mfma_f32_16x16x32_bf16 v[120:123],a[208:211],v[32:35],v[120:123]
ds_read_b128 a[244:247],v1 offset:24832
v_mfma_f32_16x16x32_bf16 v[120:123],a[212:215],v[36:39],v[120:123]
v_exp_f32 v130,v130
v_mfma_f32_16x16x32_bf16 v[120:123],a[216:219],v[40:43],v[120:123]
ds_read_b128 a[248:251],v2 offset:24832
s_waitcnt lgkmcnt(4)
v_mfma_f32_16x16x32_bf16 v[120:123],a[220:223],v[44:47],v[120:123]
v_mfma_f32_16x16x32_bf16 v[136:139],a[192:195],v[48:51],v[212:215]
ds_read_b128 a[252:255],v3 offset:24832
v_exp_f32 v131,v131
v_mfma_f32_16x16x32_bf16 v[136:139],a[196:199],v[52:55],v[136:139]
v_cvt_pk_bf16_f32 v177,v130,v131
v_mfma_f32_16x16x32_bf16 v[136:139],a[200:203],v[56:59],v[136:139]
v_mfma_f32_16x16x32_bf16 v[136:139],a[204:207],v[60:63],v[136:139]
v_exp_f32 v116,v116
v_mfma_f32_16x16x32_bf16 v[136:139],a[208:211],v[64:67],v[136:139]
v_mfma_f32_16x16x32_bf16 v[136:139],a[212:215],v[68:71],v[136:139]
v_exp_f32 v117,v117
v_mfma_f32_16x16x32_bf16 v[136:139],a[216:219],v[72:75],v[136:139]
v_cvt_pk_bf16_f32 v162,v116,v117
s_waitcnt lgkmcnt(0)
s_waitcnt vmcnt(28)
s_barrier
v_mfma_f32_16x16x32_bf16 v[136:139],a[220:223],v[76:79],v[136:139]
ds_read_b64_tr_b16 a[192:193],v4 offset:32768
ds_read_b64_tr_b16 a[194:195],v4 offset:40960
s_add_u32 m0,s25,131072
s_add_u32 s28,s67,0
v_mfma_f32_16x16x32_bf16 v[124:127],a[224:227],v[16:19],v[208:211]
buffer_load_dwordx4 v236,s[96:99],s28 offen lds
buffer_load_dwordx4 v237,s[96:99],s28 offen offset:1024 lds
v_mfma_f32_16x16x32_bf16 v[124:127],a[228:231],v[20:23],v[124:127]
ds_read_b64_tr_b16 a[196:197],v4 offset:49152
ds_read_b64_tr_b16 a[198:199],v4 offset:57344
buffer_load_dwordx4 v238,s[96:99],s28 offen offset:2048 lds
v_mfma_f32_16x16x32_bf16 v[124:127],a[232:235],v[24:27],v[124:127]
buffer_load_dwordx4 v239,s[96:99],s28 offen offset:3072 lds
s_add_u32 m0,s25,0
s_waitcnt lgkmcnt(4)
v_mfma_f32_16x16x32_bf16 v[124:127],a[236:239],v[28:31],v[124:127]
ds_read_b64_tr_b16 a[200:201],v5 offset:32768
ds_read_b64_tr_b16 a[202:203],v5 offset:40960
s_add_u32 s28,s67,128
v_mfma_f32_16x16x32_bf16 v[124:127],a[240:243],v[32:35],v[124:127]
buffer_load_dwordx4 v236,s[96:99],s28 offen lds
buffer_load_dwordx4 v237,s[96:99],s28 offen offset:1024 lds
v_mfma_f32_16x16x32_bf16 v[124:127],a[244:247],v[36:39],v[124:127]
ds_read_b64_tr_b16 a[204:205],v5 offset:49152
ds_read_b64_tr_b16 a[206:207],v5 offset:57344
buffer_load_dwordx4 v238,s[96:99],s28 offen offset:2048 lds
v_mfma_f32_16x16x32_bf16 v[124:127],a[248:251],v[40:43],v[124:127]
buffer_load_dwordx4 v239,s[96:99],s28 offen offset:3072 lds
s_add_u32 m0,s25,16384
s_add_u32 s28,s67,114688
v_mfma_f32_16x16x32_bf16 v[124:127],a[252:255],v[44:47],v[124:127]
ds_read_b64_tr_b16 a[208:209],v6 offset:32768
ds_read_b64_tr_b16 a[210:211],v6 offset:40960
buffer_load_dwordx4 v236,s[96:99],s28 offen lds
v_mfma_f32_16x16x32_bf16 v[140:143],a[224:227],v[48:51],v[212:215]
buffer_load_dwordx4 v237,s[96:99],s28 offen offset:1024 lds
buffer_load_dwordx4 v238,s[96:99],s28 offen offset:2048 lds
v_mfma_f32_16x16x32_bf16 v[140:143],a[228:231],v[52:55],v[140:143]
ds_read_b64_tr_b16 a[212:213],v6 offset:49152
ds_read_b64_tr_b16 a[214:215],v6 offset:57344
buffer_load_dwordx4 v239,s[96:99],s28 offen offset:3072 lds
v_mfma_f32_16x16x32_bf16 v[140:143],a[232:235],v[56:59],v[140:143]
v_exp_f32 v118,v118
v_mfma_f32_16x16x32_bf16 v[140:143],a[236:239],v[60:63],v[140:143]
ds_read_b64_tr_b16 a[216:217],v7 offset:32768
ds_read_b64_tr_b16 a[218:219],v7 offset:40960
v_mfma_f32_16x16x32_bf16 v[140:143],a[240:243],v[64:67],v[140:143]
v_exp_f32 v119,v119
v_mfma_f32_16x16x32_bf16 v[140:143],a[244:247],v[68:71],v[140:143]
ds_read_b64_tr_b16 a[220:221],v7 offset:49152
ds_read_b64_tr_b16 a[222:223],v7 offset:57344
v_cvt_pk_bf16_f32 v163,v118,v119
v_mfma_f32_16x16x32_bf16 v[140:143],a[248:251],v[72:75],v[140:143]
v_mfma_f32_16x16x32_bf16 v[140:143],a[252:255],v[76:79],v[140:143]
ds_read_b64_tr_b16 a[224:225],v8 offset:32768
ds_read_b64_tr_b16 a[226:227],v8 offset:40960
v_mfma_f32_16x16x32_bf16 v[220:223],v[232:235],v[168:171],v[220:223]
v_mfma_f32_16x16x32_bf16 v[220:223],v[232:235],v[172:175],v[220:223]
ds_read_b64_tr_b16 a[228:229],v8 offset:49152
ds_read_b64_tr_b16 a[230:231],v8 offset:57344
v_mfma_f32_16x16x32_bf16 v[224:227],v[232:235],v[184:187],v[224:227]
v_exp_f32 v132,v132
v_mfma_f32_16x16x32_bf16 v[224:227],v[232:235],v[188:191],v[224:227]
ds_read_b64_tr_b16 a[232:233],v9 offset:32768
ds_read_b64_tr_b16 a[234:235],v9 offset:40960
s_waitcnt lgkmcnt(8)
v_mfma_f32_16x16x32_bf16 a[0:3],a[192:195],v[168:171],a[0:3]
v_mfma_f32_16x16x32_bf16 a[0:3],a[196:199],v[172:175],a[0:3]
ds_read_b64_tr_b16 a[236:237],v9 offset:49152
ds_read_b64_tr_b16 a[238:239],v9 offset:57344
v_exp_f32 v133,v133
v_mfma_f32_16x16x32_bf16 a[64:67],a[192:195],v[184:187],a[64:67]
v_cvt_pk_bf16_f32 v178,v132,v133
v_mfma_f32_16x16x32_bf16 a[64:67],a[196:199],v[188:191],a[64:67]
ds_read_b64_tr_b16 a[240:241],v10 offset:32768
ds_read_b64_tr_b16 a[242:243],v10 offset:40960
v_mfma_f32_16x16x32_bf16 a[4:7],a[200:203],v[168:171],a[4:7]
v_exp_f32 v134,v134
v_mfma_f32_16x16x32_bf16 a[4:7],a[204:207],v[172:175],a[4:7]
ds_read_b64_tr_b16 a[244:245],v10 offset:49152
ds_read_b64_tr_b16 a[246:247],v10 offset:57344
v_mfma_f32_16x16x32_bf16 a[68:71],a[200:203],v[184:187],a[68:71]
v_mfma_f32_16x16x32_bf16 a[68:71],a[204:207],v[188:191],a[68:71]
ds_read_b64_tr_b16 a[248:249],v11 offset:32768
ds_read_b64_tr_b16 a[250:251],v11 offset:40960
v_exp_f32 v135,v135
v_mfma_f32_16x16x32_bf16 a[8:11],a[208:211],v[168:171],a[8:11]
v_cvt_pk_bf16_f32 v179,v134,v135
v_mfma_f32_16x16x32_bf16 a[8:11],a[212:215],v[172:175],a[8:11]
ds_read_b64_tr_b16 a[252:253],v11 offset:49152
ds_read_b64_tr_b16 a[254:255],v11 offset:57344
v_mfma_f32_16x16x32_bf16 a[72:75],a[208:211],v[184:187],a[72:75]
ds_read_b64_tr_b16 a[192:193],v4 offset:33024
ds_read_b64_tr_b16 a[194:195],v4 offset:41216
v_mfma_f32_16x16x32_bf16 a[72:75],a[212:215],v[188:191],a[72:75]
v_exp_f32 v120,v120
v_mfma_f32_16x16x32_bf16 a[12:15],a[216:219],v[168:171],a[12:15]
ds_read_b64_tr_b16 a[196:197],v4 offset:49408
ds_read_b64_tr_b16 a[198:199],v4 offset:57600
s_waitcnt lgkmcnt(8)
v_mfma_f32_16x16x32_bf16 a[12:15],a[220:223],v[172:175],a[12:15]
v_mfma_f32_16x16x32_bf16 a[76:79],a[216:219],v[184:187],a[76:79]
ds_read_b64_tr_b16 a[200:201],v5 offset:33024
ds_read_b64_tr_b16 a[202:203],v5 offset:41216
v_exp_f32 v121,v121
v_mfma_f32_16x16x32_bf16 a[76:79],a[220:223],v[188:191],a[76:79]
v_cvt_pk_bf16_f32 v164,v120,v121
v_mfma_f32_16x16x32_bf16 a[16:19],a[224:227],v[168:171],a[16:19]
ds_read_b64_tr_b16 a[204:205],v5 offset:49408
ds_read_b64_tr_b16 a[206:207],v5 offset:57600
v_mfma_f32_16x16x32_bf16 a[16:19],a[228:231],v[172:175],a[16:19]
v_exp_f32 v122,v122
v_mfma_f32_16x16x32_bf16 a[80:83],a[224:227],v[184:187],a[80:83]
ds_read_b64_tr_b16 a[208:209],v6 offset:33024
ds_read_b64_tr_b16 a[210:211],v6 offset:41216
v_mfma_f32_16x16x32_bf16 a[80:83],a[228:231],v[188:191],a[80:83]
v_mfma_f32_16x16x32_bf16 a[20:23],a[232:235],v[168:171],a[20:23]
ds_read_b64_tr_b16 a[212:213],v6 offset:49408
ds_read_b64_tr_b16 a[214:215],v6 offset:57600
v_exp_f32 v123,v123
v_mfma_f32_16x16x32_bf16 a[20:23],a[236:239],v[172:175],a[20:23]
v_cvt_pk_bf16_f32 v165,v122,v123
v_mfma_f32_16x16x32_bf16 a[84:87],a[232:235],v[184:187],a[84:87]
ds_read_b64_tr_b16 a[216:217],v7 offset:33024
ds_read_b64_tr_b16 a[218:219],v7 offset:41216
v_mfma_f32_16x16x32_bf16 a[84:87],a[236:239],v[188:191],a[84:87]
v_exp_f32 v136,v136
v_mfma_f32_16x16x32_bf16 a[24:27],a[240:243],v[168:171],a[24:27]
ds_read_b64_tr_b16 a[220:221],v7 offset:49408
ds_read_b64_tr_b16 a[222:223],v7 offset:57600
v_mfma_f32_16x16x32_bf16 a[24:27],a[244:247],v[172:175],a[24:27]
v_mfma_f32_16x16x32_bf16 a[88:91],a[240:243],v[184:187],a[88:91]
ds_read_b64_tr_b16 a[224:225],v8 offset:33024
ds_read_b64_tr_b16 a[226:227],v8 offset:41216
v_exp_f32 v137,v137
v_mfma_f32_16x16x32_bf16 a[88:91],a[244:247],v[188:191],a[88:91]
v_cvt_pk_bf16_f32 v180,v136,v137
s_waitcnt lgkmcnt(6)
v_mfma_f32_16x16x32_bf16 a[28:31],a[248:251],v[168:171],a[28:31]
ds_read_b64_tr_b16 a[228:229],v8 offset:49408
ds_read_b64_tr_b16 a[230:231],v8 offset:57600
v_mfma_f32_16x16x32_bf16 a[28:31],a[252:255],v[172:175],a[28:31]
v_exp_f32 v138,v138
v_mfma_f32_16x16x32_bf16 a[92:95],a[248:251],v[184:187],a[92:95]
ds_read_b64_tr_b16 a[232:233],v9 offset:33024
ds_read_b64_tr_b16 a[234:235],v9 offset:41216
v_mfma_f32_16x16x32_bf16 a[92:95],a[252:255],v[188:191],a[92:95]
v_mfma_f32_16x16x32_bf16 a[32:35],a[192:195],v[168:171],a[32:35]
ds_read_b64_tr_b16 a[236:237],v9 offset:49408
ds_read_b64_tr_b16 a[238:239],v9 offset:57600
v_exp_f32 v139,v139
v_mfma_f32_16x16x32_bf16 a[32:35],a[196:199],v[172:175],a[32:35]
v_cvt_pk_bf16_f32 v181,v138,v139
v_mfma_f32_16x16x32_bf16 a[96:99],a[192:195],v[184:187],a[96:99]
ds_read_b64_tr_b16 a[240:241],v10 offset:33024
ds_read_b64_tr_b16 a[242:243],v10 offset:41216
v_mfma_f32_16x16x32_bf16 a[96:99],a[196:199],v[188:191],a[96:99]
v_mfma_f32_16x16x32_bf16 a[36:39],a[200:203],v[168:171],a[36:39]
ds_read_b64_tr_b16 a[244:245],v10 offset:49408
ds_read_b64_tr_b16 a[246:247],v10 offset:57600
v_exp_f32 v124,v124
v_mfma_f32_16x16x32_bf16 a[36:39],a[204:207],v[172:175],a[36:39]
v_mfma_f32_16x16x32_bf16 a[100:103],a[200:203],v[184:187],a[100:103]
ds_read_b64_tr_b16 a[248:249],v11 offset:33024
ds_read_b64_tr_b16 a[250:251],v11 offset:41216
v_mfma_f32_16x16x32_bf16 a[100:103],a[204:207],v[188:191],a[100:103]
v_mfma_f32_16x16x32_bf16 a[40:43],a[208:211],v[168:171],a[40:43]
ds_read_b64_tr_b16 a[252:253],v11 offset:49408
ds_read_b64_tr_b16 a[254:255],v11 offset:57600
v_mfma_f32_16x16x32_bf16 a[40:43],a[212:215],v[172:175],a[40:43]
v_mfma_f32_16x16x32_bf16 a[104:107],a[208:211],v[184:187],a[104:107]
v_exp_f32 v125,v125
v_mfma_f32_16x16x32_bf16 a[104:107],a[212:215],v[188:191],a[104:107]
v_cvt_pk_bf16_f32 v166,v124,v125
s_waitcnt lgkmcnt(4)
v_mfma_f32_16x16x32_bf16 a[44:47],a[216:219],v[168:171],a[44:47]
v_mfma_f32_16x16x32_bf16 a[44:47],a[220:223],v[172:175],a[44:47]
v_exp_f32 v126,v126
v_exp_f32 v127,v127
v_mfma_f32_16x16x32_bf16 a[108:111],a[216:219],v[184:187],a[108:111]
v_cvt_pk_bf16_f32 v167,v126,v127
s_waitcnt lgkmcnt(0)
s_waitcnt vmcnt(32)
s_barrier
v_mfma_f32_16x16x32_bf16 a[108:111],a[220:223],v[188:191],a[108:111]
ds_read_b128 a[192:195],v0 offset:32768
s_mov_b32 m0,110592
s_mov_b32 s28,1028096
v_mfma_f32_16x16x32_bf16 a[48:51],a[224:227],v[168:171],a[48:51]
buffer_load_dwordx4 v12,s[8:11],s28 offen nt lds
buffer_load_dwordx4 v13,s[8:11],s28 offen offset:1024 nt lds
v_mfma_f32_16x16x32_bf16 a[48:51],a[228:231],v[172:175],a[48:51]
ds_read_b128 a[196:199],v1 offset:32768
buffer_load_dwordx4 v14,s[8:11],s28 offen offset:2048 nt lds
v_mfma_f32_16x16x32_bf16 a[112:115],a[224:227],v[184:187],a[112:115]
buffer_load_dwordx4 v15,s[8:11],s28 offen offset:3072 nt lds
s_mov_b32 m0,114688
s_mov_b32 s28,1032192
v_mfma_f32_16x16x32_bf16 a[112:115],a[228:231],v[188:191],a[112:115]
ds_read_b128 a[200:203],v2 offset:32768
buffer_load_dwordx4 v12,s[8:11],s28 offen nt lds
v_mfma_f32_16x16x32_bf16 a[52:55],a[232:235],v[168:171],a[52:55]
buffer_load_dwordx4 v13,s[8:11],s28 offen offset:1024 nt lds
buffer_load_dwordx4 v14,s[8:11],s28 offen offset:2048 nt lds
v_mfma_f32_16x16x32_bf16 a[52:55],a[236:239],v[172:175],a[52:55]
ds_read_b128 a[204:207],v3 offset:32768
buffer_load_dwordx4 v15,s[8:11],s28 offen offset:3072 nt lds
s_mov_b32 m0,118784
v_mfma_f32_16x16x32_bf16 a[116:119],a[232:235],v[184:187],a[116:119]
s_mov_b32 s28,1036288
buffer_load_dwordx4 v12,s[8:11],s28 offen nt lds
v_mfma_f32_16x16x32_bf16 a[116:119],a[236:239],v[188:191],a[116:119]
buffer_load_dwordx4 v13,s[8:11],s28 offen offset:1024 nt lds
buffer_load_dwordx4 v14,s[8:11],s28 offen offset:2048 nt lds
v_mfma_f32_16x16x32_bf16 a[56:59],a[240:243],v[168:171],a[56:59]
ds_read_b128 a[208:211],v0 offset:33024
buffer_load_dwordx4 v15,s[8:11],s28 offen offset:3072 nt lds
s_mov_b32 m0,122880
v_mfma_f32_16x16x32_bf16 a[56:59],a[244:247],v[172:175],a[56:59]
s_mov_b32 s28,1040384
buffer_load_dwordx4 v12,s[8:11],s28 offen nt lds
v_mfma_f32_16x16x32_bf16 a[120:123],a[240:243],v[184:187],a[120:123]
ds_read_b128 a[212:215],v1 offset:33024
buffer_load_dwordx4 v13,s[8:11],s28 offen offset:1024 nt lds
v_mfma_f32_16x16x32_bf16 a[120:123],a[244:247],v[188:191],a[120:123]
buffer_load_dwordx4 v14,s[8:11],s28 offen offset:2048 nt lds
s_waitcnt lgkmcnt(6)
v_mfma_f32_16x16x32_bf16 a[60:63],a[248:251],v[168:171],a[60:63]
ds_read_b128 a[216:219],v2 offset:33024
buffer_load_dwordx4 v15,s[8:11],s28 offen offset:3072 nt lds
s_mov_b32 m0,126976
v_mfma_f32_16x16x32_bf16 a[60:63],a[252:255],v[172:175],a[60:63]
s_mov_b32 s28,1044480
buffer_load_dwordx4 v12,s[8:11],s28 offen nt lds
v_mfma_f32_16x16x32_bf16 a[124:127],a[248:251],v[184:187],a[124:127]
ds_read_b128 a[220:223],v3 offset:33024
buffer_load_dwordx4 v13,s[8:11],s28 offen offset:1024 nt lds
v_mfma_f32_16x16x32_bf16 a[124:127],a[252:255],v[188:191],a[124:127]
buffer_load_dwordx4 v14,s[8:11],s28 offen offset:2048 nt lds
buffer_load_dwordx4 v15,s[8:11],s28 offen offset:3072 nt lds
s_waitcnt lgkmcnt(3)
v_mfma_f32_16x16x32_bf16 v[112:115],a[192:195],v[16:19],v[208:211]
ds_read_b128 a[224:227],v0 offset:40960
v_exp_f32 v140,v140
v_mfma_f32_16x16x32_bf16 v[112:115],a[196:199],v[20:23],v[112:115]
ds_read_b128 a[228:231],v1 offset:40960
v_mfma_f32_16x16x32_bf16 v[112:115],a[200:203],v[24:27],v[112:115]
v_mfma_f32_16x16x32_bf16 v[112:115],a[204:207],v[28:31],v[112:115]
ds_read_b128 a[232:235],v2 offset:40960
v_exp_f32 v141,v141
v_mfma_f32_16x16x32_bf16 v[112:115],a[208:211],v[32:35],v[112:115]
v_cvt_pk_bf16_f32 v182,v140,v141
s_waitcnt lgkmcnt(4)
v_mfma_f32_16x16x32_bf16 v[112:115],a[212:215],v[36:39],v[112:115]
ds_read_b128 a[236:239],v3 offset:40960
v_mfma_f32_16x16x32_bf16 v[112:115],a[216:219],v[40:43],v[112:115]
v_exp_f32 v142,v142
s_waitcnt lgkmcnt(4)
v_mfma_f32_16x16x32_bf16 v[112:115],a[220:223],v[44:47],v[112:115]
ds_read_b128 a[240:243],v0 offset:41216
v_mfma_f32_16x16x32_bf16 v[128:131],a[192:195],v[48:51],v[212:215]
ds_read_b128 a[244:247],v1 offset:41216
v_mfma_f32_16x16x32_bf16 v[128:131],a[196:199],v[52:55],v[128:131]
v_exp_f32 v143,v143
v_mfma_f32_16x16x32_bf16 v[128:131],a[200:203],v[56:59],v[128:131]
ds_read_b128 a[248:251],v2 offset:41216
v_cvt_pk_bf16_f32 v183,v142,v143
v_mfma_f32_16x16x32_bf16 v[128:131],a[204:207],v[60:63],v[128:131]
v_mfma_f32_16x16x32_bf16 v[128:131],a[208:211],v[64:67],v[128:131]
ds_read_b128 a[252:255],v3 offset:41216
v_mfma_f32_16x16x32_bf16 v[128:131],a[212:215],v[68:71],v[128:131]
v_mfma_f32_16x16x32_bf16 v[128:131],a[216:219],v[72:75],v[128:131]
ds_read_b128 a[192:195],v0 offset:49152
v_exp_f32 v112,v112
v_mfma_f32_16x16x32_bf16 v[128:131],a[220:223],v[76:79],v[128:131]
ds_read_b128 a[196:199],v1 offset:49152
s_waitcnt lgkmcnt(4)
v_mfma_f32_16x16x32_bf16 v[116:119],a[224:227],v[16:19],v[208:211]
v_mfma_f32_16x16x32_bf16 v[116:119],a[228:231],v[20:23],v[116:119]
ds_read_b128 a[200:203],v2 offset:49152
v_exp_f32 v113,v113
v_mfma_f32_16x16x32_bf16 v[116:119],a[232:235],v[24:27],v[116:119]
v_cvt_pk_bf16_f32 v168,v112,v113
v_mfma_f32_16x16x32_bf16 v[116:119],a[236:239],v[28:31],v[116:119]
ds_read_b128 a[204:207],v3 offset:49152
v_mfma_f32_16x16x32_bf16 v[116:119],a[240:243],v[32:35],v[116:119]
v_exp_f32 v114,v114
v_mfma_f32_16x16x32_bf16 v[116:119],a[244:247],v[36:39],v[116:119]
ds_read_b128 a[208:211],v0 offset:49408
s_waitcnt lgkmcnt(4)
v_mfma_f32_16x16x32_bf16 v[116:119],a[248:251],v[40:43],v[116:119]
ds_read_b128 a[212:215],v1 offset:49408
v_mfma_f32_16x16x32_bf16 v[116:119],a[252:255],v[44:47],v[116:119]
v_exp_f32 v115,v115
v_mfma_f32_16x16x32_bf16 v[132:135],a[224:227],v[48:51],v[212:215]
ds_read_b128 a[216:219],v2 offset:49408
v_cvt_pk_bf16_f32 v169,v114,v115
v_mfma_f32_16x16x32_bf16 v[132:135],a[228:231],v[52:55],v[132:135]
v_mfma_f32_16x16x32_bf16 v[132:135],a[232:235],v[56:59],v[132:135]
ds_read_b128 a[220:223],v3 offset:49408
v_exp_f32 v128,v128
v_mfma_f32_16x16x32_bf16 v[132:135],a[236:239],v[60:63],v[132:135]
v_mfma_f32_16x16x32_bf16 v[132:135],a[240:243],v[64:67],v[132:135]
ds_read_b128 a[224:227],v0 offset:57344
v_exp_f32 v129,v129
v_mfma_f32_16x16x32_bf16 v[132:135],a[244:247],v[68:71],v[132:135]
ds_read_b128 a[228:231],v1 offset:57344
v_cvt_pk_bf16_f32 v184,v128,v129
v_mfma_f32_16x16x32_bf16 v[132:135],a[248:251],v[72:75],v[132:135]
v_mfma_f32_16x16x32_bf16 v[132:135],a[252:255],v[76:79],v[132:135]
ds_read_b128 a[232:235],v2 offset:57344
v_exp_f32 v130,v130
v_mfma_f32_16x16x32_bf16 v[120:123],a[192:195],v[16:19],v[208:211]
s_waitcnt lgkmcnt(4)
v_mfma_f32_16x16x32_bf16 v[120:123],a[196:199],v[20:23],v[120:123]
ds_read_b128 a[236:239],v3 offset:57344
v_mfma_f32_16x16x32_bf16 v[120:123],a[200:203],v[24:27],v[120:123]
v_exp_f32 v131,v131
v_mfma_f32_16x16x32_bf16 v[120:123],a[204:207],v[28:31],v[120:123]
ds_read_b128 a[240:243],v0 offset:57600
v_cvt_pk_bf16_f32 v185,v130,v131
v_mfma_f32_16x16x32_bf16 v[120:123],a[208:211],v[32:35],v[120:123]
ds_read_b128 a[244:247],v1 offset:57600
v_mfma_f32_16x16x32_bf16 v[120:123],a[212:215],v[36:39],v[120:123]
v_exp_f32 v116,v116
v_mfma_f32_16x16x32_bf16 v[120:123],a[216:219],v[40:43],v[120:123]
ds_read_b128 a[248:251],v2 offset:57600
s_waitcnt lgkmcnt(4)
v_mfma_f32_16x16x32_bf16 v[120:123],a[220:223],v[44:47],v[120:123]
v_mfma_f32_16x16x32_bf16 v[136:139],a[192:195],v[48:51],v[212:215]
ds_read_b128 a[252:255],v3 offset:57600
v_mfma_f32_16x16x32_bf16 v[136:139],a[196:199],v[52:55],v[136:139]
v_exp_f32 v117,v117
v_mfma_f32_16x16x32_bf16 v[136:139],a[200:203],v[56:59],v[136:139]
v_cvt_pk_bf16_f32 v170,v116,v117
v_mfma_f32_16x16x32_bf16 v[136:139],a[204:207],v[60:63],v[136:139]
v_mfma_f32_16x16x32_bf16 v[136:139],a[208:211],v[64:67],v[136:139]
v_mfma_f32_16x16x32_bf16 v[136:139],a[212:215],v[68:71],v[136:139]
v_exp_f32 v118,v118
v_mfma_f32_16x16x32_bf16 v[136:139],a[216:219],v[72:75],v[136:139]
s_waitcnt lgkmcnt(0)
s_waitcnt vmcnt(32)
s_barrier
v_mfma_f32_16x16x32_bf16 v[136:139],a[220:223],v[76:79],v[136:139]
ds_read_b64_tr_b16 a[192:193],v4 offset:0
ds_read_b64_tr_b16 a[194:195],v4 offset:8192
s_add_u32 m0,s25,32768
s_add_u32 s28,s67,114816
v_mfma_f32_16x16x32_bf16 v[124:127],a[224:227],v[16:19],v[208:211]
buffer_load_dwordx4 v236,s[96:99],s28 offen lds
buffer_load_dwordx4 v237,s[96:99],s28 offen offset:1024 lds
v_mfma_f32_16x16x32_bf16 v[124:127],a[228:231],v[20:23],v[124:127]
ds_read_b64_tr_b16 a[196:197],v4 offset:16384
ds_read_b64_tr_b16 a[198:199],v4 offset:24576
buffer_load_dwordx4 v238,s[96:99],s28 offen offset:2048 lds
v_mfma_f32_16x16x32_bf16 v[124:127],a[232:235],v[24:27],v[124:127]
buffer_load_dwordx4 v239,s[96:99],s28 offen offset:3072 lds
s_add_u32 m0,s25,49152
s_waitcnt lgkmcnt(4)
v_mfma_f32_16x16x32_bf16 v[124:127],a[236:239],v[28:31],v[124:127]
ds_read_b64_tr_b16 a[200:201],v5 offset:0
ds_read_b64_tr_b16 a[202:203],v5 offset:8192
s_add_u32 s28,s67,256
v_mfma_f32_16x16x32_bf16 v[124:127],a[240:243],v[32:35],v[124:127]
buffer_load_dwordx4 v236,s[96:99],s28 offen lds
buffer_load_dwordx4 v237,s[96:99],s28 offen offset:1024 lds
v_mfma_f32_16x16x32_bf16 v[124:127],a[244:247],v[36:39],v[124:127]
ds_read_b64_tr_b16 a[204:205],v5 offset:16384
ds_read_b64_tr_b16 a[206:207],v5 offset:24576
buffer_load_dwordx4 v238,s[96:99],s28 offen offset:2048 lds
v_mfma_f32_16x16x32_bf16 v[124:127],a[248:251],v[40:43],v[124:127]
buffer_load_dwordx4 v239,s[96:99],s28 offen offset:3072 lds
v_exp_f32 v119,v119
v_mfma_f32_16x16x32_bf16 v[124:127],a[252:255],v[44:47],v[124:127]
ds_read_b64_tr_b16 a[208:209],v6 offset:0
ds_read_b64_tr_b16 a[210:211],v6 offset:8192
v_cvt_pk_bf16_f32 v171,v118,v119
v_mfma_f32_16x16x32_bf16 v[140:143],a[224:227],v[48:51],v[212:215]
v_exp_f32 v132,v132
v_mfma_f32_16x16x32_bf16 v[140:143],a[228:231],v[52:55],v[140:143]
ds_read_b64_tr_b16 a[212:213],v6 offset:16384
ds_read_b64_tr_b16 a[214:215],v6 offset:24576
v_mfma_f32_16x16x32_bf16 v[140:143],a[232:235],v[56:59],v[140:143]
v_mfma_f32_16x16x32_bf16 v[140:143],a[236:239],v[60:63],v[140:143]
ds_read_b64_tr_b16 a[216:217],v7 offset:0
ds_read_b64_tr_b16 a[218:219],v7 offset:8192
v_exp_f32 v133,v133
v_mfma_f32_16x16x32_bf16 v[140:143],a[240:243],v[64:67],v[140:143]
v_cvt_pk_bf16_f32 v186,v132,v133
v_mfma_f32_16x16x32_bf16 v[140:143],a[244:247],v[68:71],v[140:143]
ds_read_b64_tr_b16 a[220:221],v7 offset:16384
ds_read_b64_tr_b16 a[222:223],v7 offset:24576
v_mfma_f32_16x16x32_bf16 v[140:143],a[248:251],v[72:75],v[140:143]
v_exp_f32 v134,v134
v_mfma_f32_16x16x32_bf16 v[140:143],a[252:255],v[76:79],v[140:143]
ds_read_b64_tr_b16 a[224:225],v8 offset:0
ds_read_b64_tr_b16 a[226:227],v8 offset:8192
v_mfma_f32_16x16x32_bf16 v[220:223],v[232:235],v[160:163],v[220:223]
v_mfma_f32_16x16x32_bf16 v[220:223],v[232:235],v[164:167],v[220:223]
ds_read_b64_tr_b16 a[228:229],v8 offset:16384
ds_read_b64_tr_b16 a[230:231],v8 offset:24576
v_exp_f32 v135,v135
v_mfma_f32_16x16x32_bf16 v[224:227],v[232:235],v[176:179],v[224:227]
v_cvt_pk_bf16_f32 v187,v134,v135
v_mfma_f32_16x16x32_bf16 v[224:227],v[232:235],v[180:183],v[224:227]
ds_read_b64_tr_b16 a[232:233],v9 offset:0
ds_read_b64_tr_b16 a[234:235],v9 offset:8192
s_waitcnt lgkmcnt(8)
v_mfma_f32_16x16x32_bf16 a[0:3],a[192:195],v[160:163],a[0:3]
v_mfma_f32_16x16x32_bf16 a[0:3],a[196:199],v[164:167],a[0:3]
ds_read_b64_tr_b16 a[236:237],v9 offset:16384
ds_read_b64_tr_b16 a[238:239],v9 offset:24576
v_exp_f32 v120,v120
v_mfma_f32_16x16x32_bf16 a[64:67],a[192:195],v[176:179],a[64:67]
v_mfma_f32_16x16x32_bf16 a[64:67],a[196:199],v[180:183],a[64:67]
ds_read_b64_tr_b16 a[240:241],v10 offset:0
ds_read_b64_tr_b16 a[242:243],v10 offset:8192
v_mfma_f32_16x16x32_bf16 a[4:7],a[200:203],v[160:163],a[4:7]
v_exp_f32 v121,v121
v_mfma_f32_16x16x32_bf16 a[4:7],a[204:207],v[164:167],a[4:7]
ds_read_b64_tr_b16 a[244:245],v10 offset:16384
ds_read_b64_tr_b16 a[246:247],v10 offset:24576
v_cvt_pk_bf16_f32 v172,v120,v121
v_mfma_f32_16x16x32_bf16 a[68:71],a[200:203],v[176:179],a[68:71]
v_mfma_f32_16x16x32_bf16 a[68:71],a[204:207],v[180:183],a[68:71]
ds_read_b64_tr_b16 a[248:249],v11 offset:0
ds_read_b64_tr_b16 a[250:251],v11 offset:8192
v_mfma_f32_16x16x32_bf16 a[8:11],a[208:211],v[160:163],a[8:11]
v_exp_f32 v122,v122
v_mfma_f32_16x16x32_bf16 a[8:11],a[212:215],v[164:167],a[8:11]
ds_read_b64_tr_b16 a[252:253],v11 offset:16384
ds_read_b64_tr_b16 a[254:255],v11 offset:24576
v_mfma_f32_16x16x32_bf16 a[72:75],a[208:211],v[176:179],a[72:75]
ds_read_b64_tr_b16 a[192:193],v4 offset:256
ds_read_b64_tr_b16 a[194:195],v4 offset:8448
v_mfma_f32_16x16x32_bf16 a[72:75],a[212:215],v[180:183],a[72:75]
v_exp_f32 v123,v123
v_mfma_f32_16x16x32_bf16 a[12:15],a[216:219],v[160:163],a[12:15]
ds_read_b64_tr_b16 a[196:197],v4 offset:16640
ds_read_b64_tr_b16 a[198:199],v4 offset:24832
v_cvt_pk_bf16_f32 v173,v122,v123
s_waitcnt lgkmcnt(8)
v_mfma_f32_16x16x32_bf16 a[12:15],a[220:223],v[164:167],a[12:15]
v_mfma_f32_16x16x32_bf16 a[76:79],a[216:219],v[176:179],a[76:79]
ds_read_b64_tr_b16 a[200:201],v5 offset:256
ds_read_b64_tr_b16 a[202:203],v5 offset:8448
v_mfma_f32_16x16x32_bf16 a[76:79],a[220:223],v[180:183],a[76:79]
v_exp_f32 v136,v136
v_mfma_f32_16x16x32_bf16 a[16:19],a[224:227],v[160:163],a[16:19]
ds_read_b64_tr_b16 a[204:205],v5 offset:16640
ds_read_b64_tr_b16 a[206:207],v5 offset:24832
v_mfma_f32_16x16x32_bf16 a[16:19],a[228:231],v[164:167],a[16:19]
v_mfma_f32_16x16x32_bf16 a[80:83],a[224:227],v[176:179],a[80:83]
ds_read_b64_tr_b16 a[208:209],v6 offset:256
ds_read_b64_tr_b16 a[210:211],v6 offset:8448
v_exp_f32 v137,v137
v_mfma_f32_16x16x32_bf16 a[80:83],a[228:231],v[180:183],a[80:83]
v_cvt_pk_bf16_f32 v188,v136,v137
v_mfma_f32_16x16x32_bf16 a[20:23],a[232:235],v[160:163],a[20:23]
ds_read_b64_tr_b16 a[212:213],v6 offset:16640
ds_read_b64_tr_b16 a[214:215],v6 offset:24832
v_mfma_f32_16x16x32_bf16 a[20:23],a[236:239],v[164:167],a[20:23]
v_exp_f32 v138,v138
v_mfma_f32_16x16x32_bf16 a[84:87],a[232:235],v[176:179],a[84:87]
ds_read_b64_tr_b16 a[216:217],v7 offset:256
ds_read_b64_tr_b16 a[218:219],v7 offset:8448
v_mfma_f32_16x16x32_bf16 a[84:87],a[236:239],v[180:183],a[84:87]
v_mfma_f32_16x16x32_bf16 a[24:27],a[240:243],v[160:163],a[24:27]
ds_read_b64_tr_b16 a[220:221],v7 offset:16640
ds_read_b64_tr_b16 a[222:223],v7 offset:24832
v_exp_f32 v139,v139
v_mfma_f32_16x16x32_bf16 a[24:27],a[244:247],v[164:167],a[24:27]
v_cvt_pk_bf16_f32 v189,v138,v139
v_mfma_f32_16x16x32_bf16 a[88:91],a[240:243],v[176:179],a[88:91]
ds_read_b64_tr_b16 a[224:225],v8 offset:256
ds_read_b64_tr_b16 a[226:227],v8 offset:8448
v_mfma_f32_16x16x32_bf16 a[88:91],a[244:247],v[180:183],a[88:91]
s_waitcnt lgkmcnt(6)
v_mfma_f32_16x16x32_bf16 a[28:31],a[248:251],v[160:163],a[28:31]
ds_read_b64_tr_b16 a[228:229],v8 offset:16640
ds_read_b64_tr_b16 a[230:231],v8 offset:24832
v_exp_f32 v124,v124
v_mfma_f32_16x16x32_bf16 a[28:31],a[252:255],v[164:167],a[28:31]
v_mfma_f32_16x16x32_bf16 a[92:95],a[248:251],v[176:179],a[92:95]
ds_read_b64_tr_b16 a[232:233],v9 offset:256
ds_read_b64_tr_b16 a[234:235],v9 offset:8448
v_mfma_f32_16x16x32_bf16 a[92:95],a[252:255],v[180:183],a[92:95]
v_exp_f32 v125,v125
v_mfma_f32_16x16x32_bf16 a[32:35],a[192:195],v[160:163],a[32:35]
ds_read_b64_tr_b16 a[236:237],v9 offset:16640
ds_read_b64_tr_b16 a[238:239],v9 offset:24832
v_cvt_pk_bf16_f32 v174,v124,v125
v_mfma_f32_16x16x32_bf16 a[32:35],a[196:199],v[164:167],a[32:35]
v_mfma_f32_16x16x32_bf16 a[96:99],a[192:195],v[176:179],a[96:99]
ds_read_b64_tr_b16 a[240:241],v10 offset:256
ds_read_b64_tr_b16 a[242:243],v10 offset:8448
v_exp_f32 v126,v126
v_mfma_f32_16x16x32_bf16 a[96:99],a[196:199],v[180:183],a[96:99]
v_mfma_f32_16x16x32_bf16 a[36:39],a[200:203],v[160:163],a[36:39]
ds_read_b64_tr_b16 a[244:245],v10 offset:16640
ds_read_b64_tr_b16 a[246:247],v10 offset:24832
v_mfma_f32_16x16x32_bf16 a[36:39],a[204:207],v[164:167],a[36:39]
v_exp_f32 v127,v127
v_mfma_f32_16x16x32_bf16 a[100:103],a[200:203],v[176:179],a[100:103]
ds_read_b64_tr_b16 a[248:249],v11 offset:256
ds_read_b64_tr_b16 a[250:251],v11 offset:8448
v_cvt_pk_bf16_f32 v175,v126,v127
v_mfma_f32_16x16x32_bf16 a[100:103],a[204:207],v[180:183],a[100:103]
v_mfma_f32_16x16x32_bf16 a[40:43],a[208:211],v[160:163],a[40:43]
ds_read_b64_tr_b16 a[252:253],v11 offset:16640
ds_read_b64_tr_b16 a[254:255],v11 offset:24832
v_mfma_f32_16x16x32_bf16 a[40:43],a[212:215],v[164:167],a[40:43]
v_exp_f32 v140,v140
v_mfma_f32_16x16x32_bf16 a[104:107],a[208:211],v[176:179],a[104:107]
v_mfma_f32_16x16x32_bf16 a[104:107],a[212:215],v[180:183],a[104:107]
s_waitcnt lgkmcnt(4)
v_mfma_f32_16x16x32_bf16 a[44:47],a[216:219],v[160:163],a[44:47]
v_mfma_f32_16x16x32_bf16 a[44:47],a[220:223],v[164:167],a[44:47]
v_exp_f32 v141,v141
v_mfma_f32_16x16x32_bf16 a[108:111],a[216:219],v[176:179],a[108:111]
v_cvt_pk_bf16_f32 v190,v140,v141
s_waitcnt lgkmcnt(0)
s_waitcnt vmcnt(8)
s_barrier
v_mfma_f32_16x16x32_bf16 a[108:111],a[220:223],v[180:183],a[108:111]
ds_read_b64_tr_b16 a[192:193],v4 offset:32768
ds_read_b64_tr_b16 a[194:195],v4 offset:40960
s_add_u32 m0,s25,81920
s_add_u32 s28,s67,114944
v_mfma_f32_16x16x32_bf16 a[48:51],a[224:227],v[160:163],a[48:51]
buffer_load_dwordx4 v236,s[96:99],s28 offen lds
buffer_load_dwordx4 v237,s[96:99],s28 offen offset:1024 lds
v_mfma_f32_16x16x32_bf16 a[48:51],a[228:231],v[164:167],a[48:51]
ds_read_b64_tr_b16 a[196:197],v4 offset:49152
ds_read_b64_tr_b16 a[198:199],v4 offset:57344
buffer_load_dwordx4 v238,s[96:99],s28 offen offset:2048 lds
v_mfma_f32_16x16x32_bf16 a[112:115],a[224:227],v[176:179],a[112:115]
buffer_load_dwordx4 v239,s[96:99],s28 offen offset:3072 lds
v_mfma_f32_16x16x32_bf16 a[112:115],a[228:231],v[180:183],a[112:115]
ds_read_b64_tr_b16 a[200:201],v5 offset:32768
ds_read_b64_tr_b16 a[202:203],v5 offset:40960
v_exp_f32 v142,v142
v_mfma_f32_16x16x32_bf16 a[52:55],a[232:235],v[160:163],a[52:55]
s_lshl_b32 s38,s57,5
v_lshrrev_b32 v100,1,v253
v_add_u32 v100,s38,v100
v_mul_u32_u24 v100,0x380,v100
v_mfma_f32_16x16x32_bf16 a[52:55],a[236:239],v[164:167],a[52:55]
ds_read_b64_tr_b16 a[204:205],v5 offset:49152
ds_read_b64_tr_b16 a[206:207],v5 offset:57344
v_and_b32 v101,1,v253
v_lshl_add_u32 v100,v101,7,v100
v_mfma_f32_16x16x32_bf16 a[116:119],a[232:235],v[176:179],a[116:119]
buffer_load_dword v111,v100,s[96:99],0 offen offset:512
buffer_load_dword v111,v100,s[96:99],0 offen offset:640
v_mfma_f32_16x16x32_bf16 a[116:119],a[236:239],v[180:183],a[116:119]
v_mfma_f32_16x16x32_bf16 a[56:59],a[240:243],v[160:163],a[56:59]
ds_read_b64_tr_b16 a[208:209],v6 offset:32768
ds_read_b64_tr_b16 a[210:211],v6 offset:40960
v_exp_f32 v143,v143
v_mfma_f32_16x16x32_bf16 a[56:59],a[244:247],v[164:167],a[56:59]
v_cvt_pk_bf16_f32 v191,v142,v143
v_mfma_f32_16x16x32_bf16 a[120:123],a[240:243],v[176:179],a[120:123]
ds_read_b64_tr_b16 a[212:213],v6 offset:49152
ds_read_b64_tr_b16 a[214:215],v6 offset:57344
v_mfma_f32_16x16x32_bf16 a[120:123],a[244:247],v[180:183],a[120:123]
s_waitcnt lgkmcnt(12)
v_mfma_f32_16x16x32_bf16 a[60:63],a[248:251],v[160:163],a[60:63]
ds_read_b64_tr_b16 a[216:217],v7 offset:32768
ds_read_b64_tr_b16 a[218:219],v7 offset:40960
v_mfma_f32_16x16x32_bf16 a[60:63],a[252:255],v[164:167],a[60:63]
v_mfma_f32_16x16x32_bf16 a[124:127],a[248:251],v[176:179],a[124:127]
ds_read_b64_tr_b16 a[220:221],v7 offset:49152
ds_read_b64_tr_b16 a[222:223],v7 offset:57344
v_mfma_f32_16x16x32_bf16 a[124:127],a[252:255],v[180:183],a[124:127]
v_mfma_f32_16x16x32_bf16 v[220:223],v[232:235],v[168:171],v[220:223]
ds_read_b64_tr_b16 a[224:225],v8 offset:32768
ds_read_b64_tr_b16 a[226:227],v8 offset:40960
v_mfma_f32_16x16x32_bf16 v[220:223],v[232:235],v[172:175],v[220:223]
v_mfma_f32_16x16x32_bf16 v[224:227],v[232:235],v[184:187],v[224:227]
ds_read_b64_tr_b16 a[228:229],v8 offset:49152
ds_read_b64_tr_b16 a[230:231],v8 offset:57344
v_mfma_f32_16x16x32_bf16 v[224:227],v[232:235],v[188:191],v[224:227]
s_waitcnt lgkmcnt(6)
v_mfma_f32_16x16x32_bf16 a[0:3],a[192:195],v[168:171],a[0:3]
ds_read_b64_tr_b16 a[232:233],v9 offset:32768
ds_read_b64_tr_b16 a[234:235],v9 offset:40960
v_mfma_f32_16x16x32_bf16 a[0:3],a[196:199],v[172:175],a[0:3]
v_mfma_f32_16x16x32_bf16 a[64:67],a[192:195],v[184:187],a[64:67]
ds_read_b64_tr_b16 a[236:237],v9 offset:49152
ds_read_b64_tr_b16 a[238:239],v9 offset:57344
v_mfma_f32_16x16x32_bf16 a[64:67],a[196:199],v[188:191],a[64:67]
s_mov_b32 s28,0x4e800000
s_mov_b32 s66,0
v_cmp_ngt_f32 vcc,s28,v220
s_cmp_lg_u64 vcc,0
v_mfma_f32_16x16x32_bf16 a[4:7],a[200:203],v[168:171],a[4:7]
ds_read_b64_tr_b16 a[240:241],v10 offset:32768
ds_read_b64_tr_b16 a[242:243],v10 offset:40960
s_cselect_b32 s66,1,s66
v_cmp_ngt_f32 vcc,s28,v224
v_mfma_f32_16x16x32_bf16 a[4:7],a[204:207],v[172:175],a[4:7]
ds_read_b64_tr_b16 a[244:245],v10 offset:49152
ds_read_b64_tr_b16 a[246:247],v10 offset:57344
s_cmp_lg_u64 vcc,0
s_cselect_b32 s66,1,s66
v_mfma_f32_16x16x32_bf16 a[68:71],a[200:203],v[184:187],a[68:71]
s_lshl_b32 s28,s24,2
s_add_u32 s28,s28,155648
v_mov_b32 v221,s28
v_mov_b32 v222,s66
v_mfma_f32_16x16x32_bf16 a[68:71],a[204:207],v[188:191],a[68:71]
ds_read_b64_tr_b16 a[248:249],v11 offset:32768
ds_read_b64_tr_b16 a[250:251],v11 offset:40960
v_mov_b32 v223,155648
ds_write_b32 v221,v222
v_mfma_f32_16x16x32_bf16 a[8:11],a[208:211],v[168:171],a[8:11]
v_rcp_f32 v220,v220
v_rcp_f32 v224,v224
v_mfma_f32_16x16x32_bf16 a[8:11],a[212:215],v[172:175],a[8:11]
ds_read_b64_tr_b16 a[252:253],v11 offset:49152
ds_read_b64_tr_b16 a[254:255],v11 offset:57344
v_lshrrev_b32 v226,2,v248
v_and_b32 v226,60,v226
v_mfma_f32_16x16x32_bf16 a[72:75],a[208:211],v[184:187],a[72:75]
buffer_store_dword v220,v226,s[20:23],s68 offen offset:0
buffer_store_dword v224,v226,s[20:23],s68 offen offset:64
v_accvgpr_read_b32 v208,a0
v_accvgpr_read_b32 v209,a1
v_mfma_f32_16x16x32_bf16 a[72:75],a[212:215],v[188:191],a[72:75]
ds_read_b64_tr_b16 a[192:193],v4 offset:33024
ds_read_b64_tr_b16 a[194:195],v4 offset:41216
v_accvgpr_read_b32 v210,a2
v_accvgpr_read_b32 v211,a3
v_mfma_f32_16x16x32_bf16 a[12:15],a[216:219],v[168:171],a[12:15]
v_cvt_pk_bf16_f32 v112,v208,v209
v_cvt_pk_bf16_f32 v113,v210,v211
v_accvgpr_read_b32 v212,a64
s_waitcnt lgkmcnt(7)
v_mfma_f32_16x16x32_bf16 a[12:15],a[220:223],v[172:175],a[12:15]
ds_read_b64_tr_b16 a[196:197],v4 offset:49408
ds_read_b64_tr_b16 a[198:199],v4 offset:57600
v_accvgpr_read_b32 v213,a65
v_accvgpr_read_b32 v214,a66
v_mfma_f32_16x16x32_bf16 a[76:79],a[216:219],v[184:187],a[76:79]
v_accvgpr_read_b32 v215,a67
v_cvt_pk_bf16_f32 v128,v212,v213
v_cvt_pk_bf16_f32 v129,v214,v215
v_accvgpr_read_b32 v208,a4
v_mfma_f32_16x16x32_bf16 a[76:79],a[220:223],v[188:191],a[76:79]
ds_read_b64_tr_b16 a[200:201],v5 offset:33024
ds_read_b64_tr_b16 a[202:203],v5 offset:41216
v_accvgpr_read_b32 v209,a5
v_accvgpr_read_b32 v210,a6
v_mfma_f32_16x16x32_bf16 a[16:19],a[224:227],v[168:171],a[16:19]
v_accvgpr_read_b32 v211,a7
v_cvt_pk_bf16_f32 v114,v208,v209
v_cvt_pk_bf16_f32 v115,v210,v211
v_accvgpr_read_b32 v212,a68
v_mfma_f32_16x16x32_bf16 a[16:19],a[228:231],v[172:175],a[16:19]
ds_read_b64_tr_b16 a[204:205],v5 offset:49408
ds_read_b64_tr_b16 a[206:207],v5 offset:57600
v_accvgpr_read_b32 v213,a69
v_accvgpr_read_b32 v214,a70
v_mfma_f32_16x16x32_bf16 a[80:83],a[224:227],v[184:187],a[80:83]
v_accvgpr_read_b32 v215,a71
v_cvt_pk_bf16_f32 v130,v212,v213
v_cvt_pk_bf16_f32 v131,v214,v215
v_accvgpr_read_b32 v208,a8
v_mfma_f32_16x16x32_bf16 a[80:83],a[228:231],v[188:191],a[80:83]
ds_read_b64_tr_b16 a[208:209],v6 offset:33024
ds_read_b64_tr_b16 a[210:211],v6 offset:41216
v_accvgpr_read_b32 v209,a9
v_accvgpr_read_b32 v210,a10
v_mfma_f32_16x16x32_bf16 a[20:23],a[232:235],v[168:171],a[20:23]
v_accvgpr_read_b32 v211,a11
v_cvt_pk_bf16_f32 v116,v208,v209
v_cvt_pk_bf16_f32 v117,v210,v211
v_accvgpr_read_b32 v212,a72
v_mfma_f32_16x16x32_bf16 a[20:23],a[236:239],v[172:175],a[20:23]
ds_read_b64_tr_b16 a[212:213],v6 offset:49408
ds_read_b64_tr_b16 a[214:215],v6 offset:57600
v_accvgpr_read_b32 v213,a73
v_accvgpr_read_b32 v214,a74
v_mfma_f32_16x16x32_bf16 a[84:87],a[232:235],v[184:187],a[84:87]
v_accvgpr_read_b32 v215,a75
v_cvt_pk_bf16_f32 v132,v212,v213
v_cvt_pk_bf16_f32 v133,v214,v215
v_accvgpr_read_b32 v208,a12
v_mfma_f32_16x16x32_bf16 a[84:87],a[236:239],v[188:191],a[84:87]
ds_read_b64_tr_b16 a[216:217],v7 offset:33024
ds_read_b64_tr_b16 a[218:219],v7 offset:41216
v_accvgpr_read_b32 v209,a13
v_accvgpr_read_b32 v210,a14
v_mfma_f32_16x16x32_bf16 a[24:27],a[240:243],v[168:171],a[24:27]
v_accvgpr_read_b32 v211,a15
v_cvt_pk_bf16_f32 v118,v208,v209
v_cvt_pk_bf16_f32 v119,v210,v211
v_accvgpr_read_b32 v212,a76
v_mfma_f32_16x16x32_bf16 a[24:27],a[244:247],v[172:175],a[24:27]
ds_read_b64_tr_b16 a[220:221],v7 offset:49408
ds_read_b64_tr_b16 a[222:223],v7 offset:57600
v_accvgpr_read_b32 v213,a77
v_accvgpr_read_b32 v214,a78
v_mfma_f32_16x16x32_bf16 a[88:91],a[240:243],v[184:187],a[88:91]
v_accvgpr_read_b32 v215,a79
v_cvt_pk_bf16_f32 v134,v212,v213
v_cvt_pk_bf16_f32 v135,v214,v215
v_accvgpr_read_b32 v208,a16
v_mfma_f32_16x16x32_bf16 a[88:91],a[244:247],v[188:191],a[88:91]
ds_read_b64_tr_b16 a[224:225],v8 offset:33024
ds_read_b64_tr_b16 a[226:227],v8 offset:41216
v_accvgpr_read_b32 v209,a17
s_waitcnt lgkmcnt(8)
v_mfma_f32_16x16x32_bf16 a[28:31],a[248:251],v[168:171],a[28:31]
ds_read_b64_tr_b16 a[228:229],v8 offset:49408
ds_read_b64_tr_b16 a[230:231],v8 offset:57600
v_accvgpr_read_b32 v210,a18
v_accvgpr_read_b32 v211,a19
v_mfma_f32_16x16x32_bf16 a[28:31],a[252:255],v[172:175],a[28:31]
v_cvt_pk_bf16_f32 v120,v208,v209
v_cvt_pk_bf16_f32 v121,v210,v211
v_accvgpr_read_b32 v212,a80
v_accvgpr_read_b32 v213,a81
v_mfma_f32_16x16x32_bf16 a[92:95],a[248:251],v[184:187],a[92:95]
ds_read_b64_tr_b16 a[232:233],v9 offset:33024
ds_read_b64_tr_b16 a[234:235],v9 offset:41216
v_accvgpr_read_b32 v214,a82
v_accvgpr_read_b32 v215,a83
v_mfma_f32_16x16x32_bf16 a[92:95],a[252:255],v[188:191],a[92:95]
v_cvt_pk_bf16_f32 v136,v212,v213
v_cvt_pk_bf16_f32 v137,v214,v215
v_accvgpr_read_b32 v208,a20
v_accvgpr_read_b32 v209,a21
v_mfma_f32_16x16x32_bf16 a[32:35],a[192:195],v[168:171],a[32:35]
ds_read_b64_tr_b16 a[236:237],v9 offset:49408
ds_read_b64_tr_b16 a[238:239],v9 offset:57600
v_accvgpr_read_b32 v210,a22
v_accvgpr_read_b32 v211,a23
v_mfma_f32_16x16x32_bf16 a[32:35],a[196:199],v[172:175],a[32:35]
v_cvt_pk_bf16_f32 v122,v208,v209
v_cvt_pk_bf16_f32 v123,v210,v211
v_accvgpr_read_b32 v212,a84
v_accvgpr_read_b32 v213,a85
v_mfma_f32_16x16x32_bf16 a[96:99],a[192:195],v[184:187],a[96:99]
ds_read_b64_tr_b16 a[240:241],v10 offset:33024
ds_read_b64_tr_b16 a[242:243],v10 offset:41216
v_accvgpr_read_b32 v214,a86
v_accvgpr_read_b32 v215,a87
v_mfma_f32_16x16x32_bf16 a[96:99],a[196:199],v[188:191],a[96:99]
v_cvt_pk_bf16_f32 v138,v212,v213
v_cvt_pk_bf16_f32 v139,v214,v215
v_accvgpr_read_b32 v208,a24
v_accvgpr_read_b32 v209,a25
v_mfma_f32_16x16x32_bf16 a[36:39],a[200:203],v[168:171],a[36:39]
ds_read_b64_tr_b16 a[244:245],v10 offset:49408
ds_read_b64_tr_b16 a[246:247],v10 offset:57600
v_accvgpr_read_b32 v210,a26
v_accvgpr_read_b32 v211,a27
v_mfma_f32_16x16x32_bf16 a[36:39],a[204:207],v[172:175],a[36:39]
v_cvt_pk_bf16_f32 v124,v208,v209
v_cvt_pk_bf16_f32 v125,v210,v211
v_accvgpr_read_b32 v212,a88
v_accvgpr_read_b32 v213,a89
v_mfma_f32_16x16x32_bf16 a[100:103],a[200:203],v[184:187],a[100:103]
ds_read_b64_tr_b16 a[248:249],v11 offset:33024
ds_read_b64_tr_b16 a[250:251],v11 offset:41216
v_accvgpr_read_b32 v214,a90
v_accvgpr_read_b32 v215,a91
v_mfma_f32_16x16x32_bf16 a[100:103],a[204:207],v[188:191],a[100:103]
v_cvt_pk_bf16_f32 v140,v212,v213
v_cvt_pk_bf16_f32 v141,v214,v215
v_accvgpr_read_b32 v208,a28
v_accvgpr_read_b32 v209,a29
v_mfma_f32_16x16x32_bf16 a[40:43],a[208:211],v[168:171],a[40:43]
ds_read_b64_tr_b16 a[252:253],v11 offset:49408
ds_read_b64_tr_b16 a[254:255],v11 offset:57600
v_accvgpr_read_b32 v210,a30
s_waitcnt lgkmcnt(8)
v_mfma_f32_16x16x32_bf16 a[40:43],a[212:215],v[172:175],a[40:43]
v_accvgpr_read_b32 v211,a31
v_cvt_pk_bf16_f32 v126,v208,v209
v_cvt_pk_bf16_f32 v127,v210,v211
v_accvgpr_read_b32 v212,a92
v_mfma_f32_16x16x32_bf16 a[104:107],a[208:211],v[184:187],a[104:107]
v_accvgpr_read_b32 v213,a93
v_accvgpr_read_b32 v214,a94
v_accvgpr_read_b32 v215,a95
v_cvt_pk_bf16_f32 v142,v212,v213
v_mfma_f32_16x16x32_bf16 a[104:107],a[212:215],v[188:191],a[104:107]
v_cvt_pk_bf16_f32 v143,v214,v215
v_accvgpr_read_b32 v208,a32
v_accvgpr_read_b32 v209,a33
v_accvgpr_read_b32 v210,a34
v_mfma_f32_16x16x32_bf16 a[44:47],a[216:219],v[168:171],a[44:47]
v_accvgpr_read_b32 v211,a35
v_cvt_pk_bf16_f32 v160,v208,v209
v_cvt_pk_bf16_f32 v161,v210,v211
v_accvgpr_read_b32 v212,a96
v_mfma_f32_16x16x32_bf16 a[44:47],a[220:223],v[172:175],a[44:47]
v_accvgpr_read_b32 v213,a97
v_accvgpr_read_b32 v214,a98
v_accvgpr_read_b32 v215,a99
v_cvt_pk_bf16_f32 v176,v212,v213
v_mfma_f32_16x16x32_bf16 a[108:111],a[216:219],v[184:187],a[108:111]
v_cvt_pk_bf16_f32 v177,v214,v215
s_waitcnt lgkmcnt(0)
s_waitcnt vmcnt(40)
s_barrier
v_mfma_f32_16x16x32_bf16 a[108:111],a[220:223],v[188:191],a[108:111]
ds_read_b64_tr_b16 a[192:193],v240 offset:49152
ds_read_b64_tr_b16 a[194:195],v240 offset:51200
ds_read_b128 v[216:219],v223
v_accvgpr_read_b32 v208,a36
v_mfma_f32_16x16x32_bf16 a[48:51],a[224:227],v[168:171],a[48:51]
s_add_u32 m0,s25,98304
s_add_u32 s28,s67,384
v_accvgpr_read_b32 v209,a37
v_accvgpr_read_b32 v210,a38
v_mfma_f32_16x16x32_bf16 a[48:51],a[228:231],v[172:175],a[48:51]
ds_read_b64_tr_b16 a[196:197],v240 offset:53248
ds_read_b64_tr_b16 a[198:199],v240 offset:55296
v_accvgpr_read_b32 v211,a39
v_cvt_pk_bf16_f32 v162,v208,v209
v_mfma_f32_16x16x32_bf16 a[112:115],a[224:227],v[184:187],a[112:115]
buffer_load_dwordx4 v236,s[96:99],s28 offen lds
v_cvt_pk_bf16_f32 v163,v210,v211
v_accvgpr_read_b32 v212,a100
v_mfma_f32_16x16x32_bf16 a[112:115],a[228:231],v[188:191],a[112:115]
ds_read_b64_tr_b16 a[200:201],v240 offset:57344
ds_read_b64_tr_b16 a[202:203],v240 offset:59392
v_accvgpr_read_b32 v213,a101
v_accvgpr_read_b32 v214,a102
v_mfma_f32_16x16x32_bf16 a[52:55],a[232:235],v[168:171],a[52:55]
buffer_load_dwordx4 v237,s[96:99],s28 offen offset:1024 lds
v_accvgpr_read_b32 v215,a103
v_cvt_pk_bf16_f32 v178,v212,v213
v_mfma_f32_16x16x32_bf16 a[52:55],a[236:239],v[172:175],a[52:55]
ds_read_b64_tr_b16 a[204:205],v240 offset:61440
ds_read_b64_tr_b16 a[206:207],v240 offset:63488
v_cvt_pk_bf16_f32 v179,v214,v215
v_accvgpr_read_b32 v208,a40
v_mfma_f32_16x16x32_bf16 a[116:119],a[232:235],v[184:187],a[116:119]
buffer_load_dwordx4 v238,s[96:99],s28 offen offset:2048 lds
v_accvgpr_read_b32 v209,a41
v_accvgpr_read_b32 v210,a42
v_mfma_f32_16x16x32_bf16 a[116:119],a[236:239],v[188:191],a[116:119]
buffer_load_dwordx4 v239,s[96:99],s28 offen offset:3072 lds
v_accvgpr_read_b32 v211,a43
s_waitcnt lgkmcnt(9)
v_mfma_f32_16x16x32_bf16 a[56:59],a[240:243],v[168:171],a[56:59]
ds_read_b64_tr_b16 a[208:209],v241 offset:49152
ds_read_b64_tr_b16 a[210:211],v241 offset:51200
s_add_u32 m0,s25,114688
v_cvt_pk_bf16_f32 v164,v208,v209
v_mfma_f32_16x16x32_bf16 a[56:59],a[244:247],v[172:175],a[56:59]
s_add_u32 s28,s67,115072
buffer_load_dwordx4 v236,s[96:99],s28 offen lds
v_cvt_pk_bf16_f32 v165,v210,v211
v_mfma_f32_16x16x32_bf16 a[120:123],a[240:243],v[184:187],a[120:123]
ds_read_b64_tr_b16 a[212:213],v241 offset:53248
ds_read_b64_tr_b16 a[214:215],v241 offset:55296
v_accvgpr_read_b32 v212,a104
v_accvgpr_read_b32 v213,a105
v_mfma_f32_16x16x32_bf16 a[120:123],a[244:247],v[188:191],a[120:123]
buffer_load_dwordx4 v237,s[96:99],s28 offen offset:1024 lds
v_accvgpr_read_b32 v214,a106
v_accvgpr_read_b32 v215,a107
v_mfma_f32_16x16x32_bf16 a[60:63],a[248:251],v[168:171],a[60:63]
ds_read_b64_tr_b16 a[216:217],v241 offset:57344
ds_read_b64_tr_b16 a[218:219],v241 offset:59392
v_cvt_pk_bf16_f32 v180,v212,v213
v_cvt_pk_bf16_f32 v181,v214,v215
v_mfma_f32_16x16x32_bf16 a[60:63],a[252:255],v[172:175],a[60:63]
buffer_load_dwordx4 v238,s[96:99],s28 offen offset:2048 lds
s_waitcnt lgkmcnt(12)
v_or3_b32 v216,v216,v217,v218
v_or_b32 v216,v216,v219
v_mfma_f32_16x16x32_bf16 a[124:127],a[248:251],v[184:187],a[124:127]
ds_read_b64_tr_b16 a[220:221],v241 offset:61440
ds_read_b64_tr_b16 a[222:223],v241 offset:63488
v_mfma_f32_16x16x32_bf16 a[124:127],a[252:255],v[188:191],a[124:127]
buffer_load_dwordx4 v239,s[96:99],s28 offen offset:3072 lds
v_readfirstlane_b32 s66,v216
s_andn2_b32 s66,s66,s30
s_cbranch_scc1 FALLBACK_B2
s_waitcnt lgkmcnt(6)
v_mfma_f32_16x16x32_bf16 v[16:19],a[192:195],v[112:115],0
ds_read_b64_tr_b16 a[224:225],v242 offset:49152
ds_read_b64_tr_b16 a[226:227],v242 offset:51200
v_mfma_f32_16x16x32_bf16 v[16:19],a[196:199],v[116:119],v[16:19]
v_mfma_f32_16x16x32_bf16 v[16:19],a[200:203],v[120:123],v[16:19]
ds_read_b64_tr_b16 a[228:229],v242 offset:53248
ds_read_b64_tr_b16 a[230:231],v242 offset:55296
v_mfma_f32_16x16x32_bf16 v[16:19],a[204:207],v[124:127],v[16:19]
v_accvgpr_read_b32 v208,a44
v_accvgpr_read_b32 v209,a45
v_accvgpr_read_b32 v210,a46
v_accvgpr_read_b32 v211,a47
v_mfma_f32_16x16x32_bf16 v[20:23],a[192:195],v[128:131],0
ds_read_b64_tr_b16 a[232:233],v242 offset:57344
ds_read_b64_tr_b16 a[234:235],v242 offset:59392
v_cvt_pk_bf16_f32 v166,v208,v209
v_cvt_pk_bf16_f32 v167,v210,v211
v_mfma_f32_16x16x32_bf16 v[20:23],a[196:199],v[132:135],v[20:23]
v_accvgpr_read_b32 v212,a108
v_accvgpr_read_b32 v213,a109
v_accvgpr_read_b32 v214,a110
v_accvgpr_read_b32 v215,a111
v_mfma_f32_16x16x32_bf16 v[20:23],a[200:203],v[136:139],v[20:23]
ds_read_b64_tr_b16 a[236:237],v242 offset:61440
ds_read_b64_tr_b16 a[238:239],v242 offset:63488
v_cvt_pk_bf16_f32 v182,v212,v213
v_cvt_pk_bf16_f32 v183,v214,v215
v_mfma_f32_16x16x32_bf16 v[20:23],a[204:207],v[140:143],v[20:23]
v_accvgpr_read_b32 v208,a48
v_accvgpr_read_b32 v209,a49
v_accvgpr_read_b32 v210,a50
v_accvgpr_read_b32 v211,a51
v_mfma_f32_16x16x32_bf16 v[24:27],a[208:211],v[112:115],0
ds_read_b64_tr_b16 a[240:241],v243 offset:49152
ds_read_b64_tr_b16 a[242:243],v243 offset:51200
v_cvt_pk_bf16_f32 v168,v208,v209
s_waitcnt lgkmcnt(8)
v_mfma_f32_16x16x32_bf16 v[24:27],a[212:215],v[116:119],v[24:27]
v_cvt_pk_bf16_f32 v169,v210,v211
v_accvgpr_read_b32 v212,a112
v_accvgpr_read_b32 v213,a113
v_accvgpr_read_b32 v214,a114
v_mfma_f32_16x16x32_bf16 v[24:27],a[216:219],v[120:123],v[24:27]
ds_read_b64_tr_b16 a[244:245],v243 offset:53248
ds_read_b64_tr_b16 a[246:247],v243 offset:55296
v_accvgpr_read_b32 v215,a115
v_cvt_pk_bf16_f32 v184,v212,v213
v_mfma_f32_16x16x32_bf16 v[24:27],a[220:223],v[124:127],v[24:27]
v_cvt_pk_bf16_f32 v185,v214,v215
v_accvgpr_read_b32 v208,a52
v_accvgpr_read_b32 v209,a53
v_accvgpr_read_b32 v210,a54
v_mfma_f32_16x16x32_bf16 v[28:31],a[208:211],v[128:131],0
ds_read_b64_tr_b16 a[248:249],v243 offset:57344
ds_read_b64_tr_b16 a[250:251],v243 offset:59392
v_accvgpr_read_b32 v211,a55
v_cvt_pk_bf16_f32 v170,v208,v209
v_mfma_f32_16x16x32_bf16 v[28:31],a[212:215],v[132:135],v[28:31]
v_cvt_pk_bf16_f32 v171,v210,v211
v_mfma_f32_16x16x32_bf16 v[28:31],a[216:219],v[136:139],v[28:31]
ds_read_b64_tr_b16 a[252:253],v243 offset:61440
ds_read_b64_tr_b16 a[254:255],v243 offset:63488
v_mfma_f32_16x16x32_bf16 v[28:31],a[220:223],v[140:143],v[28:31]
v_mfma_f32_16x16x32_bf16 v[32:35],a[224:227],v[112:115],0
ds_read_b64_tr_b16 a[192:193],v244 offset:0
ds_read_b64_tr_b16 a[194:195],v244 offset:2048
s_waitcnt lgkmcnt(8)
v_mfma_f32_16x16x32_bf16 v[32:35],a[228:231],v[116:119],v[32:35]
v_mfma_f32_16x16x32_bf16 v[32:35],a[232:235],v[120:123],v[32:35]
ds_read_b64_tr_b16 a[196:197],v244 offset:4096
ds_read_b64_tr_b16 a[198:199],v244 offset:6144
v_mfma_f32_16x16x32_bf16 v[32:35],a[236:239],v[124:127],v[32:35]
v_mfma_f32_16x16x32_bf16 v[36:39],a[224:227],v[128:131],0
ds_read_b64_tr_b16 a[200:201],v244 offset:8192
ds_read_b64_tr_b16 a[202:203],v244 offset:10240
v_mfma_f32_16x16x32_bf16 v[36:39],a[228:231],v[132:135],v[36:39]
v_mfma_f32_16x16x32_bf16 v[36:39],a[232:235],v[136:139],v[36:39]
ds_read_b64_tr_b16 a[204:205],v244 offset:12288
ds_read_b64_tr_b16 a[206:207],v244 offset:14336
v_mfma_f32_16x16x32_bf16 v[36:39],a[236:239],v[140:143],v[36:39]
v_mfma_f32_16x16x32_bf16 v[40:43],a[240:243],v[112:115],0
ds_read_b64_tr_b16 a[208:209],v245 offset:0
ds_read_b64_tr_b16 a[210:211],v245 offset:2048
s_waitcnt lgkmcnt(10)
v_mfma_f32_16x16x32_bf16 v[40:43],a[244:247],v[116:119],v[40:43]
v_mfma_f32_16x16x32_bf16 v[40:43],a[248:251],v[120:123],v[40:43]
ds_read_b64_tr_b16 a[212:213],v245 offset:4096
ds_read_b64_tr_b16 a[214:215],v245 offset:6144
v_mfma_f32_16x16x32_bf16 v[40:43],a[252:255],v[124:127],v[40:43]
v_mfma_f32_16x16x32_bf16 v[44:47],a[240:243],v[128:131],0
ds_read_b64_tr_b16 a[216:217],v245 offset:8192
ds_read_b64_tr_b16 a[218:219],v245 offset:10240
v_mfma_f32_16x16x32_bf16 v[44:47],a[244:247],v[132:135],v[44:47]
v_mfma_f32_16x16x32_bf16 v[44:47],a[248:251],v[136:139],v[44:47]
ds_read_b64_tr_b16 a[220:221],v245 offset:12288
ds_read_b64_tr_b16 a[222:223],v245 offset:14336
v_mfma_f32_16x16x32_bf16 v[44:47],a[252:255],v[140:143],v[44:47]
s_waitcnt vmcnt(44)
s_barrier
s_waitcnt lgkmcnt(6)
v_mfma_f32_16x16x32_bf16 v[48:51],a[192:195],v[112:115],0
ds_read_b64_tr_b16 a[224:225],v246 offset:0
ds_read_b64_tr_b16 a[226:227],v246 offset:2048
s_add_u32 m0,s25,131072
s_add_u32 s28,s67,512
v_mfma_f32_16x16x32_bf16 v[48:51],a[196:199],v[116:119],v[48:51]
buffer_load_dwordx4 v236,s[96:99],s28 offen lds
buffer_load_dwordx4 v237,s[96:99],s28 offen offset:1024 lds
v_mfma_f32_16x16x32_bf16 v[48:51],a[200:203],v[120:123],v[48:51]
ds_read_b64_tr_b16 a[228:229],v246 offset:4096
ds_read_b64_tr_b16 a[230:231],v246 offset:6144
buffer_load_dwordx4 v238,s[96:99],s28 offen offset:2048 lds
v_mfma_f32_16x16x32_bf16 v[48:51],a[204:207],v[124:127],v[48:51]
buffer_load_dwordx4 v239,s[96:99],s28 offen offset:3072 lds
v_accvgpr_read_b32 v212,a116
v_accvgpr_read_b32 v213,a117
v_mfma_f32_16x16x32_bf16 v[52:55],a[192:195],v[128:131],0
ds_read_b64_tr_b16 a[232:233],v246 offset:8192
ds_read_b64_tr_b16 a[234:235],v246 offset:10240
v_accvgpr_read_b32 v214,a118
v_accvgpr_read_b32 v215,a119
v_mfma_f32_16x16x32_bf16 v[52:55],a[196:199],v[132:135],v[52:55]
v_cvt_pk_bf16_f32 v186,v212,v213
v_cvt_pk_bf16_f32 v187,v214,v215
v_accvgpr_read_b32 v208,a56
v_accvgpr_read_b32 v209,a57
v_mfma_f32_16x16x32_bf16 v[52:55],a[200:203],v[136:139],v[52:55]
ds_read_b64_tr_b16 a[236:237],v246 offset:12288
ds_read_b64_tr_b16 a[238:239],v246 offset:14336
v_accvgpr_read_b32 v210,a58
v_accvgpr_read_b32 v211,a59
v_mfma_f32_16x16x32_bf16 v[52:55],a[204:207],v[140:143],v[52:55]
v_cvt_pk_bf16_f32 v172,v208,v209
v_cvt_pk_bf16_f32 v173,v210,v211
v_accvgpr_read_b32 v212,a120
v_accvgpr_read_b32 v213,a121
v_mfma_f32_16x16x32_bf16 v[56:59],a[208:211],v[112:115],0
ds_read_b64_tr_b16 a[240:241],v247 offset:0
ds_read_b64_tr_b16 a[242:243],v247 offset:2048
v_accvgpr_read_b32 v214,a122
s_waitcnt lgkmcnt(8)
v_mfma_f32_16x16x32_bf16 v[56:59],a[212:215],v[116:119],v[56:59]
v_accvgpr_read_b32 v215,a123
v_cvt_pk_bf16_f32 v188,v212,v213
v_cvt_pk_bf16_f32 v189,v214,v215
v_accvgpr_read_b32 v208,a60
v_mfma_f32_16x16x32_bf16 v[56:59],a[216:219],v[120:123],v[56:59]
ds_read_b64_tr_b16 a[244:245],v247 offset:4096
ds_read_b64_tr_b16 a[246:247],v247 offset:6144
v_accvgpr_read_b32 v209,a61
v_accvgpr_read_b32 v210,a62
v_mfma_f32_16x16x32_bf16 v[56:59],a[220:223],v[124:127],v[56:59]
v_accvgpr_read_b32 v211,a63
v_cvt_pk_bf16_f32 v174,v208,v209
v_cvt_pk_bf16_f32 v175,v210,v211
v_accvgpr_read_b32 v212,a124
v_mfma_f32_16x16x32_bf16 v[60:63],a[208:211],v[128:131],0
ds_read_b64_tr_b16 a[248:249],v247 offset:8192
ds_read_b64_tr_b16 a[250:251],v247 offset:10240
v_accvgpr_read_b32 v213,a125
v_accvgpr_read_b32 v214,a126
v_mfma_f32_16x16x32_bf16 v[60:63],a[212:215],v[132:135],v[60:63]
v_accvgpr_read_b32 v215,a127
v_cvt_pk_bf16_f32 v190,v212,v213
v_cvt_pk_bf16_f32 v191,v214,v215
v_mfma_f32_16x16x32_bf16 v[60:63],a[216:219],v[136:139],v[60:63]
ds_read_b64_tr_b16 a[252:253],v247 offset:12288
ds_read_b64_tr_b16 a[254:255],v247 offset:14336
v_mfma_f32_16x16x32_bf16 v[60:63],a[220:223],v[140:143],v[60:63]
v_mfma_f32_16x16x32_bf16 v[64:67],a[224:227],v[112:115],0
ds_read_b64_tr_b16 a[192:193],v244 offset:16384
ds_read_b64_tr_b16 a[194:195],v244 offset:18432
s_waitcnt lgkmcnt(8)
v_mfma_f32_16x16x32_bf16 v[64:67],a[228:231],v[116:119],v[64:67]
v_mfma_f32_16x16x32_bf16 v[64:67],a[232:235],v[120:123],v[64:67]
ds_read_b64_tr_b16 a[196:197],v244 offset:20480
ds_read_b64_tr_b16 a[198:199],v244 offset:22528
v_mfma_f32_16x16x32_bf16 v[64:67],a[236:239],v[124:127],v[64:67]
v_mfma_f32_16x16x32_bf16 v[68:71],a[224:227],v[128:131],0
ds_read_b64_tr_b16 a[200:201],v244 offset:24576
ds_read_b64_tr_b16 a[202:203],v244 offset:26624
v_mfma_f32_16x16x32_bf16 v[68:71],a[228:231],v[132:135],v[68:71]
v_mfma_f32_16x16x32_bf16 v[68:71],a[232:235],v[136:139],v[68:71]
ds_read_b64_tr_b16 a[204:205],v244 offset:28672
ds_read_b64_tr_b16 a[206:207],v244 offset:30720
v_mfma_f32_16x16x32_bf16 v[68:71],a[236:239],v[140:143],v[68:71]
v_mfma_f32_16x16x32_bf16 v[72:75],a[240:243],v[112:115],0
ds_read_b64_tr_b16 a[208:209],v245 offset:16384
ds_read_b64_tr_b16 a[210:211],v245 offset:18432
s_waitcnt lgkmcnt(10)
v_mfma_f32_16x16x32_bf16 v[72:75],a[244:247],v[116:119],v[72:75]
v_mfma_f32_16x16x32_bf16 v[72:75],a[248:251],v[120:123],v[72:75]
ds_read_b64_tr_b16 a[212:213],v245 offset:20480
ds_read_b64_tr_b16 a[214:215],v245 offset:22528
v_mfma_f32_16x16x32_bf16 v[72:75],a[252:255],v[124:127],v[72:75]
v_mfma_f32_16x16x32_bf16 v[76:79],a[240:243],v[128:131],0
ds_read_b64_tr_b16 a[216:217],v245 offset:24576
ds_read_b64_tr_b16 a[218:219],v245 offset:26624
v_mfma_f32_16x16x32_bf16 v[76:79],a[244:247],v[132:135],v[76:79]
v_mfma_f32_16x16x32_bf16 v[76:79],a[248:251],v[136:139],v[76:79]
ds_read_b64_tr_b16 a[220:221],v245 offset:28672
ds_read_b64_tr_b16 a[222:223],v245 offset:30720
v_mfma_f32_16x16x32_bf16 v[76:79],a[252:255],v[140:143],v[76:79]
s_waitcnt vmcnt(24)
s_barrier
s_waitcnt lgkmcnt(6)
v_mfma_f32_16x16x32_bf16 v[16:19],a[192:195],v[160:163],v[16:19]
ds_read_b64_tr_b16 a[224:225],v246 offset:16384
ds_read_b64_tr_b16 a[226:227],v246 offset:18432
s_add_u32 m0,s25,0
s_add_u32 s28,s67,115200
v_mfma_f32_16x16x32_bf16 v[16:19],a[196:199],v[164:167],v[16:19]
buffer_load_dwordx4 v236,s[96:99],s28 offen lds
buffer_load_dwordx4 v237,s[96:99],s28 offen offset:1024 lds
v_mfma_f32_16x16x32_bf16 v[16:19],a[200:203],v[168:171],v[16:19]
ds_read_b64_tr_b16 a[228:229],v246 offset:20480
ds_read_b64_tr_b16 a[230:231],v246 offset:22528
buffer_load_dwordx4 v238,s[96:99],s28 offen offset:2048 lds
v_mfma_f32_16x16x32_bf16 v[16:19],a[204:207],v[172:175],v[16:19]
buffer_load_dwordx4 v239,s[96:99],s28 offen offset:3072 lds
v_mfma_f32_16x16x32_bf16 v[20:23],a[192:195],v[176:179],v[20:23]
ds_read_b64_tr_b16 a[232:233],v246 offset:24576
ds_read_b64_tr_b16 a[234:235],v246 offset:26624
v_mfma_f32_16x16x32_bf16 v[20:23],a[196:199],v[180:183],v[20:23]
v_mfma_f32_16x16x32_bf16 v[20:23],a[200:203],v[184:187],v[20:23]
ds_read_b64_tr_b16 a[236:237],v246 offset:28672
ds_read_b64_tr_b16 a[238:239],v246 offset:30720
v_mfma_f32_16x16x32_bf16 v[20:23],a[204:207],v[188:191],v[20:23]
v_mfma_f32_16x16x32_bf16 v[24:27],a[208:211],v[160:163],v[24:27]
ds_read_b64_tr_b16 a[240:241],v247 offset:16384
ds_read_b64_tr_b16 a[242:243],v247 offset:18432
s_waitcnt lgkmcnt(8)
v_mfma_f32_16x16x32_bf16 v[24:27],a[212:215],v[164:167],v[24:27]
v_mfma_f32_16x16x32_bf16 v[24:27],a[216:219],v[168:171],v[24:27]
ds_read_b64_tr_b16 a[244:245],v247 offset:20480
ds_read_b64_tr_b16 a[246:247],v247 offset:22528
v_mfma_f32_16x16x32_bf16 v[24:27],a[220:223],v[172:175],v[24:27]
v_mfma_f32_16x16x32_bf16 v[28:31],a[208:211],v[176:179],v[28:31]
ds_read_b64_tr_b16 a[248:249],v247 offset:24576
ds_read_b64_tr_b16 a[250:251],v247 offset:26624
v_mfma_f32_16x16x32_bf16 v[28:31],a[212:215],v[180:183],v[28:31]
v_mfma_f32_16x16x32_bf16 v[28:31],a[216:219],v[184:187],v[28:31]
ds_read_b64_tr_b16 a[252:253],v247 offset:28672
ds_read_b64_tr_b16 a[254:255],v247 offset:30720
v_mfma_f32_16x16x32_bf16 v[28:31],a[220:223],v[188:191],v[28:31]
v_mfma_f32_16x16x32_bf16 v[32:35],a[224:227],v[160:163],v[32:35]
ds_read_b64_tr_b16 a[192:193],v244 offset:32768
ds_read_b64_tr_b16 a[194:195],v244 offset:34816
s_waitcnt lgkmcnt(8)
v_mfma_f32_16x16x32_bf16 v[32:35],a[228:231],v[164:167],v[32:35]
v_mfma_f32_16x16x32_bf16 v[32:35],a[232:235],v[168:171],v[32:35]
ds_read_b64_tr_b16 a[196:197],v244 offset:36864
ds_read_b64_tr_b16 a[198:199],v244 offset:38912
v_mfma_f32_16x16x32_bf16 v[32:35],a[236:239],v[172:175],v[32:35]
v_mfma_f32_16x16x32_bf16 v[36:39],a[224:227],v[176:179],v[36:39]
ds_read_b64_tr_b16 a[200:201],v244 offset:40960
ds_read_b64_tr_b16 a[202:203],v244 offset:43008
v_mfma_f32_16x16x32_bf16 v[36:39],a[228:231],v[180:183],v[36:39]
v_mfma_f32_16x16x32_bf16 v[36:39],a[232:235],v[184:187],v[36:39]
ds_read_b64_tr_b16 a[204:205],v244 offset:45056
ds_read_b64_tr_b16 a[206:207],v244 offset:47104
v_mfma_f32_16x16x32_bf16 v[36:39],a[236:239],v[188:191],v[36:39]
v_mfma_f32_16x16x32_bf16 v[40:43],a[240:243],v[160:163],v[40:43]
ds_read_b64_tr_b16 a[208:209],v245 offset:32768
ds_read_b64_tr_b16 a[210:211],v245 offset:34816
s_waitcnt lgkmcnt(10)
v_mfma_f32_16x16x32_bf16 v[40:43],a[244:247],v[164:167],v[40:43]
v_mfma_f32_16x16x32_bf16 v[40:43],a[248:251],v[168:171],v[40:43]
ds_read_b64_tr_b16 a[212:213],v245 offset:36864
ds_read_b64_tr_b16 a[214:215],v245 offset:38912
v_mfma_f32_16x16x32_bf16 v[40:43],a[252:255],v[172:175],v[40:43]
v_mfma_f32_16x16x32_bf16 v[44:47],a[240:243],v[176:179],v[44:47]
ds_read_b64_tr_b16 a[216:217],v245 offset:40960
ds_read_b64_tr_b16 a[218:219],v245 offset:43008
v_mfma_f32_16x16x32_bf16 v[44:47],a[244:247],v[180:183],v[44:47]
v_mfma_f32_16x16x32_bf16 v[44:47],a[248:251],v[184:187],v[44:47]
ds_read_b64_tr_b16 a[220:221],v245 offset:45056
ds_read_b64_tr_b16 a[222:223],v245 offset:47104
v_mfma_f32_16x16x32_bf16 v[44:47],a[252:255],v[188:191],v[44:47]
s_waitcnt vmcnt(24)
s_barrier
s_waitcnt lgkmcnt(6)
v_mfma_f32_16x16x32_bf16 v[48:51],a[192:195],v[160:163],v[48:51]
ds_read_b64_tr_b16 a[224:225],v246 offset:32768
ds_read_b64_tr_b16 a[226:227],v246 offset:34816
s_add_u32 m0,s25,16384
s_add_u32 s28,s67,640
v_mfma_f32_16x16x32_bf16 v[48:51],a[196:199],v[164:167],v[48:51]
buffer_load_dwordx4 v236,s[96:99],s28 offen lds
buffer_load_dwordx4 v237,s[96:99],s28 offen offset:1024 lds
v_mfma_f32_16x16x32_bf16 v[48:51],a[200:203],v[168:171],v[48:51]
ds_read_b64_tr_b16 a[228:229],v246 offset:36864
ds_read_b64_tr_b16 a[230:231],v246 offset:38912
buffer_load_dwordx4 v238,s[96:99],s28 offen offset:2048 lds
v_mfma_f32_16x16x32_bf16 v[48:51],a[204:207],v[172:175],v[48:51]
buffer_load_dwordx4 v239,s[96:99],s28 offen offset:3072 lds
v_mfma_f32_16x16x32_bf16 v[52:55],a[192:195],v[176:179],v[52:55]
ds_read_b64_tr_b16 a[232:233],v246 offset:40960
ds_read_b64_tr_b16 a[234:235],v246 offset:43008
v_cvt_pk_bf16_f32 v16,v16,v17
v_cvt_pk_bf16_f32 v17,v18,v19
v_mfma_f32_16x16x32_bf16 v[52:55],a[196:199],v[180:183],v[52:55]
v_cvt_pk_bf16_f32 v18,v24,v25
v_cvt_pk_bf16_f32 v19,v26,v27
buffer_store_dwordx4 v[16:19],v248,s[20:23],s62 offen sc0 sc1
v_mfma_f32_16x16x32_bf16 v[52:55],a[200:203],v[184:187],v[52:55]
ds_read_b64_tr_b16 a[236:237],v246 offset:45056
ds_read_b64_tr_b16 a[238:239],v246 offset:47104
v_cvt_pk_bf16_f32 v20,v20,v21
v_cvt_pk_bf16_f32 v21,v22,v23
v_mfma_f32_16x16x32_bf16 v[52:55],a[204:207],v[188:191],v[52:55]
v_cvt_pk_bf16_f32 v22,v28,v29
v_cvt_pk_bf16_f32 v23,v30,v31
buffer_store_dwordx4 v[20:23],v248,s[20:23],s63 offen sc0 sc1
v_mfma_f32_16x16x32_bf16 v[56:59],a[208:211],v[160:163],v[56:59]
ds_read_b64_tr_b16 a[240:241],v247 offset:32768
ds_read_b64_tr_b16 a[242:243],v247 offset:34816
v_cvt_pk_bf16_f32 v32,v32,v33
s_waitcnt lgkmcnt(8)
v_mfma_f32_16x16x32_bf16 v[56:59],a[212:215],v[164:167],v[56:59]
v_cvt_pk_bf16_f32 v33,v34,v35
v_cvt_pk_bf16_f32 v34,v40,v41
v_cvt_pk_bf16_f32 v35,v42,v43
v_mfma_f32_16x16x32_bf16 v[56:59],a[216:219],v[168:171],v[56:59]
ds_read_b64_tr_b16 a[244:245],v247 offset:36864
ds_read_b64_tr_b16 a[246:247],v247 offset:38912
buffer_store_dwordx4 v[32:35],v249,s[20:23],s62 offen sc0 sc1
v_mfma_f32_16x16x32_bf16 v[56:59],a[220:223],v[172:175],v[56:59]
s_add_u32 s62,s62,32768
v_cvt_pk_bf16_f32 v36,v36,v37
v_cvt_pk_bf16_f32 v37,v38,v39
v_cvt_pk_bf16_f32 v38,v44,v45
v_mfma_f32_16x16x32_bf16 v[60:63],a[208:211],v[176:179],v[60:63]
ds_read_b64_tr_b16 a[248:249],v247 offset:40960
ds_read_b64_tr_b16 a[250:251],v247 offset:43008
v_cvt_pk_bf16_f32 v39,v46,v47
v_mfma_f32_16x16x32_bf16 v[60:63],a[212:215],v[180:183],v[60:63]
buffer_store_dwordx4 v[36:39],v249,s[20:23],s63 offen sc0 sc1
s_add_u32 s63,s63,32768
v_mfma_f32_16x16x32_bf16 v[60:63],a[216:219],v[184:187],v[60:63]
ds_read_b64_tr_b16 a[252:253],v247 offset:45056
ds_read_b64_tr_b16 a[254:255],v247 offset:47104
v_mfma_f32_16x16x32_bf16 v[60:63],a[220:223],v[188:191],v[60:63]
v_mfma_f32_16x16x32_bf16 v[64:67],a[224:227],v[160:163],v[64:67]
ds_read_b64_tr_b16 a[192:193],v244 offset:49152
ds_read_b64_tr_b16 a[194:195],v244 offset:51200
s_waitcnt lgkmcnt(8)
v_mfma_f32_16x16x32_bf16 v[64:67],a[228:231],v[164:167],v[64:67]
v_mfma_f32_16x16x32_bf16 v[64:67],a[232:235],v[168:171],v[64:67]
ds_read_b64_tr_b16 a[196:197],v244 offset:53248
ds_read_b64_tr_b16 a[198:199],v244 offset:55296
v_mfma_f32_16x16x32_bf16 v[64:67],a[236:239],v[172:175],v[64:67]
v_mfma_f32_16x16x32_bf16 v[68:71],a[224:227],v[176:179],v[68:71]
ds_read_b64_tr_b16 a[200:201],v244 offset:57344
ds_read_b64_tr_b16 a[202:203],v244 offset:59392
v_mfma_f32_16x16x32_bf16 v[68:71],a[228:231],v[180:183],v[68:71]
v_mfma_f32_16x16x32_bf16 v[68:71],a[232:235],v[184:187],v[68:71]
ds_read_b64_tr_b16 a[204:205],v244 offset:61440
ds_read_b64_tr_b16 a[206:207],v244 offset:63488
v_mfma_f32_16x16x32_bf16 v[68:71],a[236:239],v[188:191],v[68:71]
v_mfma_f32_16x16x32_bf16 v[72:75],a[240:243],v[160:163],v[72:75]
ds_read_b64_tr_b16 a[208:209],v245 offset:49152
ds_read_b64_tr_b16 a[210:211],v245 offset:51200
s_waitcnt lgkmcnt(10)
v_mfma_f32_16x16x32_bf16 v[72:75],a[244:247],v[164:167],v[72:75]
v_mfma_f32_16x16x32_bf16 v[72:75],a[248:251],v[168:171],v[72:75]
ds_read_b64_tr_b16 a[212:213],v245 offset:53248
ds_read_b64_tr_b16 a[214:215],v245 offset:55296
v_mfma_f32_16x16x32_bf16 v[72:75],a[252:255],v[172:175],v[72:75]
v_mfma_f32_16x16x32_bf16 v[76:79],a[240:243],v[176:179],v[76:79]
ds_read_b64_tr_b16 a[216:217],v245 offset:57344
ds_read_b64_tr_b16 a[218:219],v245 offset:59392
v_mfma_f32_16x16x32_bf16 v[76:79],a[244:247],v[180:183],v[76:79]
v_mfma_f32_16x16x32_bf16 v[76:79],a[248:251],v[184:187],v[76:79]
ds_read_b64_tr_b16 a[220:221],v245 offset:61440
ds_read_b64_tr_b16 a[222:223],v245 offset:63488
v_mfma_f32_16x16x32_bf16 v[76:79],a[252:255],v[188:191],v[76:79]
s_waitcnt vmcnt(28)
s_barrier
s_waitcnt lgkmcnt(6)
v_mfma_f32_16x16x32_bf16 v[16:19],a[192:195],v[112:115],0
ds_read_b64_tr_b16 a[224:225],v246 offset:49152
ds_read_b64_tr_b16 a[226:227],v246 offset:51200
s_add_u32 m0,s25,32768
s_add_u32 s28,s67,115328
v_mfma_f32_16x16x32_bf16 v[16:19],a[196:199],v[116:119],v[16:19]
buffer_load_dwordx4 v236,s[96:99],s28 offen lds
buffer_load_dwordx4 v237,s[96:99],s28 offen offset:1024 lds
v_mfma_f32_16x16x32_bf16 v[16:19],a[200:203],v[120:123],v[16:19]
ds_read_b64_tr_b16 a[228:229],v246 offset:53248
ds_read_b64_tr_b16 a[230:231],v246 offset:55296
buffer_load_dwordx4 v238,s[96:99],s28 offen offset:2048 lds
v_mfma_f32_16x16x32_bf16 v[16:19],a[204:207],v[124:127],v[16:19]
buffer_load_dwordx4 v239,s[96:99],s28 offen offset:3072 lds
v_mfma_f32_16x16x32_bf16 v[20:23],a[192:195],v[128:131],0
ds_read_b64_tr_b16 a[232:233],v246 offset:57344
ds_read_b64_tr_b16 a[234:235],v246 offset:59392
v_cvt_pk_bf16_f32 v48,v48,v49
v_cvt_pk_bf16_f32 v49,v50,v51
v_mfma_f32_16x16x32_bf16 v[20:23],a[196:199],v[132:135],v[20:23]
v_cvt_pk_bf16_f32 v50,v56,v57
v_cvt_pk_bf16_f32 v51,v58,v59
buffer_store_dwordx4 v[48:51],v248,s[20:23],s62 offen sc0 sc1
v_mfma_f32_16x16x32_bf16 v[20:23],a[200:203],v[136:139],v[20:23]
ds_read_b64_tr_b16 a[236:237],v246 offset:61440
ds_read_b64_tr_b16 a[238:239],v246 offset:63488
v_cvt_pk_bf16_f32 v52,v52,v53
v_cvt_pk_bf16_f32 v53,v54,v55
v_mfma_f32_16x16x32_bf16 v[20:23],a[204:207],v[140:143],v[20:23]
v_cvt_pk_bf16_f32 v54,v60,v61
v_cvt_pk_bf16_f32 v55,v62,v63
buffer_store_dwordx4 v[52:55],v248,s[20:23],s63 offen sc0 sc1
v_mfma_f32_16x16x32_bf16 v[24:27],a[208:211],v[112:115],0
ds_read_b64_tr_b16 a[240:241],v247 offset:49152
ds_read_b64_tr_b16 a[242:243],v247 offset:51200
s_waitcnt lgkmcnt(8)
v_mfma_f32_16x16x32_bf16 v[24:27],a[212:215],v[116:119],v[24:27]
v_mfma_f32_16x16x32_bf16 v[24:27],a[216:219],v[120:123],v[24:27]
ds_read_b64_tr_b16 a[244:245],v247 offset:53248
ds_read_b64_tr_b16 a[246:247],v247 offset:55296
v_mfma_f32_16x16x32_bf16 v[24:27],a[220:223],v[124:127],v[24:27]
v_mfma_f32_16x16x32_bf16 v[28:31],a[208:211],v[128:131],0
ds_read_b64_tr_b16 a[248:249],v247 offset:57344
ds_read_b64_tr_b16 a[250:251],v247 offset:59392
v_mfma_f32_16x16x32_bf16 v[28:31],a[212:215],v[132:135],v[28:31]
v_mfma_f32_16x16x32_bf16 v[28:31],a[216:219],v[136:139],v[28:31]
ds_read_b64_tr_b16 a[252:253],v247 offset:61440
ds_read_b64_tr_b16 a[254:255],v247 offset:63488
v_mfma_f32_16x16x32_bf16 v[28:31],a[220:223],v[140:143],v[28:31]
v_mfma_f32_16x16x32_bf16 v[32:35],a[224:227],v[112:115],0
ds_read_b64_tr_b16 a[192:193],v240 offset:0
ds_read_b64_tr_b16 a[194:195],v240 offset:2048
s_waitcnt lgkmcnt(8)
v_mfma_f32_16x16x32_bf16 v[32:35],a[228:231],v[116:119],v[32:35]
v_mfma_f32_16x16x32_bf16 v[32:35],a[232:235],v[120:123],v[32:35]
ds_read_b64_tr_b16 a[196:197],v240 offset:4096
ds_read_b64_tr_b16 a[198:199],v240 offset:6144
v_mfma_f32_16x16x32_bf16 v[32:35],a[236:239],v[124:127],v[32:35]
v_mfma_f32_16x16x32_bf16 v[36:39],a[224:227],v[128:131],0
ds_read_b64_tr_b16 a[200:201],v240 offset:8192
ds_read_b64_tr_b16 a[202:203],v240 offset:10240
v_mfma_f32_16x16x32_bf16 v[36:39],a[228:231],v[132:135],v[36:39]
v_mfma_f32_16x16x32_bf16 v[36:39],a[232:235],v[136:139],v[36:39]
ds_read_b64_tr_b16 a[204:205],v240 offset:12288
ds_read_b64_tr_b16 a[206:207],v240 offset:14336
v_mfma_f32_16x16x32_bf16 v[36:39],a[236:239],v[140:143],v[36:39]
v_mfma_f32_16x16x32_bf16 v[40:43],a[240:243],v[112:115],0
ds_read_b64_tr_b16 a[208:209],v241 offset:0
ds_read_b64_tr_b16 a[210:211],v241 offset:2048
s_waitcnt lgkmcnt(10)
v_mfma_f32_16x16x32_bf16 v[40:43],a[244:247],v[116:119],v[40:43]
v_mfma_f32_16x16x32_bf16 v[40:43],a[248:251],v[120:123],v[40:43]
ds_read_b64_tr_b16 a[212:213],v241 offset:4096
ds_read_b64_tr_b16 a[214:215],v241 offset:6144
v_mfma_f32_16x16x32_bf16 v[40:43],a[252:255],v[124:127],v[40:43]
v_mfma_f32_16x16x32_bf16 v[44:47],a[240:243],v[128:131],0
ds_read_b64_tr_b16 a[216:217],v241 offset:8192
ds_read_b64_tr_b16 a[218:219],v241 offset:10240
v_mfma_f32_16x16x32_bf16 v[44:47],a[244:247],v[132:135],v[44:47]
v_mfma_f32_16x16x32_bf16 v[44:47],a[248:251],v[136:139],v[44:47]
ds_read_b64_tr_b16 a[220:221],v241 offset:12288
ds_read_b64_tr_b16 a[222:223],v241 offset:14336
v_mfma_f32_16x16x32_bf16 v[44:47],a[252:255],v[140:143],v[44:47]
s_waitcnt vmcnt(26)
s_barrier
s_waitcnt lgkmcnt(6)
v_mfma_f32_16x16x32_bf16 v[16:19],a[192:195],v[160:163],v[16:19]
ds_read_b64_tr_b16 a[224:225],v242 offset:0
ds_read_b64_tr_b16 a[226:227],v242 offset:2048
s_add_u32 m0,s25,49152
s_add_u32 s28,s67,768
v_mfma_f32_16x16x32_bf16 v[16:19],a[196:199],v[164:167],v[16:19]
buffer_load_dwordx4 v236,s[96:99],s28 offen lds
buffer_load_dwordx4 v237,s[96:99],s28 offen offset:1024 lds
v_mfma_f32_16x16x32_bf16 v[16:19],a[200:203],v[168:171],v[16:19]
ds_read_b64_tr_b16 a[228:229],v242 offset:4096
ds_read_b64_tr_b16 a[230:231],v242 offset:6144
buffer_load_dwordx4 v238,s[96:99],s28 offen offset:2048 lds
v_mfma_f32_16x16x32_bf16 v[16:19],a[204:207],v[172:175],v[16:19]
buffer_load_dwordx4 v239,s[96:99],s28 offen offset:3072 lds
v_mfma_f32_16x16x32_bf16 v[20:23],a[192:195],v[176:179],v[20:23]
ds_read_b64_tr_b16 a[232:233],v242 offset:8192
ds_read_b64_tr_b16 a[234:235],v242 offset:10240
v_cvt_pk_bf16_f32 v64,v64,v65
v_cvt_pk_bf16_f32 v65,v66,v67
v_mfma_f32_16x16x32_bf16 v[20:23],a[196:199],v[180:183],v[20:23]
v_cvt_pk_bf16_f32 v66,v72,v73
v_cvt_pk_bf16_f32 v67,v74,v75
buffer_store_dwordx4 v[64:67],v249,s[20:23],s62 offen sc0 sc1
v_mfma_f32_16x16x32_bf16 v[20:23],a[200:203],v[184:187],v[20:23]
ds_read_b64_tr_b16 a[236:237],v242 offset:12288
ds_read_b64_tr_b16 a[238:239],v242 offset:14336
s_add_u32 s62,s62,32768
v_cvt_pk_bf16_f32 v68,v68,v69
v_mfma_f32_16x16x32_bf16 v[20:23],a[204:207],v[188:191],v[20:23]
v_cvt_pk_bf16_f32 v69,v70,v71
v_cvt_pk_bf16_f32 v70,v76,v77
v_cvt_pk_bf16_f32 v71,v78,v79
v_mfma_f32_16x16x32_bf16 v[24:27],a[208:211],v[160:163],v[24:27]
ds_read_b64_tr_b16 a[240:241],v243 offset:0
ds_read_b64_tr_b16 a[242:243],v243 offset:2048
s_waitcnt lgkmcnt(8)
v_mfma_f32_16x16x32_bf16 v[24:27],a[212:215],v[164:167],v[24:27]
buffer_store_dwordx4 v[68:71],v249,s[20:23],s63 offen sc0 sc1
s_add_u32 s63,s63,32768
v_mfma_f32_16x16x32_bf16 v[24:27],a[216:219],v[168:171],v[24:27]
ds_read_b64_tr_b16 a[244:245],v243 offset:4096
ds_read_b64_tr_b16 a[246:247],v243 offset:6144
v_mfma_f32_16x16x32_bf16 v[24:27],a[220:223],v[172:175],v[24:27]
v_mfma_f32_16x16x32_bf16 v[28:31],a[208:211],v[176:179],v[28:31]
ds_read_b64_tr_b16 a[248:249],v243 offset:8192
ds_read_b64_tr_b16 a[250:251],v243 offset:10240
v_mfma_f32_16x16x32_bf16 v[28:31],a[212:215],v[180:183],v[28:31]
v_mfma_f32_16x16x32_bf16 v[28:31],a[216:219],v[184:187],v[28:31]
ds_read_b64_tr_b16 a[252:253],v243 offset:12288
ds_read_b64_tr_b16 a[254:255],v243 offset:14336
v_mfma_f32_16x16x32_bf16 v[28:31],a[220:223],v[188:191],v[28:31]
v_mfma_f32_16x16x32_bf16 v[32:35],a[224:227],v[160:163],v[32:35]
ds_read_b64_tr_b16 a[192:193],v240 offset:16384
ds_read_b64_tr_b16 a[194:195],v240 offset:18432
s_waitcnt lgkmcnt(8)
v_mfma_f32_16x16x32_bf16 v[32:35],a[228:231],v[164:167],v[32:35]
v_mfma_f32_16x16x32_bf16 v[32:35],a[232:235],v[168:171],v[32:35]
ds_read_b64_tr_b16 a[196:197],v240 offset:20480
ds_read_b64_tr_b16 a[198:199],v240 offset:22528
v_mfma_f32_16x16x32_bf16 v[32:35],a[236:239],v[172:175],v[32:35]
v_mfma_f32_16x16x32_bf16 v[36:39],a[224:227],v[176:179],v[36:39]
ds_read_b64_tr_b16 a[200:201],v240 offset:24576
ds_read_b64_tr_b16 a[202:203],v240 offset:26624
v_mfma_f32_16x16x32_bf16 v[36:39],a[228:231],v[180:183],v[36:39]
v_mfma_f32_16x16x32_bf16 v[36:39],a[232:235],v[184:187],v[36:39]
ds_read_b64_tr_b16 a[204:205],v240 offset:28672
ds_read_b64_tr_b16 a[206:207],v240 offset:30720
v_mfma_f32_16x16x32_bf16 v[36:39],a[236:239],v[188:191],v[36:39]
v_mfma_f32_16x16x32_bf16 v[40:43],a[240:243],v[160:163],v[40:43]
ds_read_b64_tr_b16 a[208:209],v241 offset:16384
ds_read_b64_tr_b16 a[210:211],v241 offset:18432
s_waitcnt lgkmcnt(10)
v_mfma_f32_16x16x32_bf16 v[40:43],a[244:247],v[164:167],v[40:43]
v_mfma_f32_16x16x32_bf16 v[40:43],a[248:251],v[168:171],v[40:43]
ds_read_b64_tr_b16 a[212:213],v241 offset:20480
ds_read_b64_tr_b16 a[214:215],v241 offset:22528
v_mfma_f32_16x16x32_bf16 v[40:43],a[252:255],v[172:175],v[40:43]
v_mfma_f32_16x16x32_bf16 v[44:47],a[240:243],v[176:179],v[44:47]
ds_read_b64_tr_b16 a[216:217],v241 offset:24576
ds_read_b64_tr_b16 a[218:219],v241 offset:26624
v_mfma_f32_16x16x32_bf16 v[44:47],a[244:247],v[180:183],v[44:47]
v_mfma_f32_16x16x32_bf16 v[44:47],a[248:251],v[184:187],v[44:47]
ds_read_b64_tr_b16 a[220:221],v241 offset:28672
ds_read_b64_tr_b16 a[222:223],v241 offset:30720
v_mfma_f32_16x16x32_bf16 v[44:47],a[252:255],v[188:191],v[44:47]
s_waitcnt vmcnt(28)
s_barrier
s_waitcnt lgkmcnt(6)
v_mfma_f32_16x16x32_bf16 v[48:51],a[192:195],v[112:115],0
ds_read_b64_tr_b16 a[224:225],v242 offset:16384
ds_read_b64_tr_b16 a[226:227],v242 offset:18432
s_add_u32 m0,s25,81920
s_add_u32 s28,s67,115456
v_mfma_f32_16x16x32_bf16 v[48:51],a[196:199],v[116:119],v[48:51]
buffer_load_dwordx4 v236,s[96:99],s28 offen lds
buffer_load_dwordx4 v237,s[96:99],s28 offen offset:1024 lds
v_mfma_f32_16x16x32_bf16 v[48:51],a[200:203],v[120:123],v[48:51]
ds_read_b64_tr_b16 a[228:229],v242 offset:20480
ds_read_b64_tr_b16 a[230:231],v242 offset:22528
buffer_load_dwordx4 v238,s[96:99],s28 offen offset:2048 lds
v_mfma_f32_16x16x32_bf16 v[48:51],a[204:207],v[124:127],v[48:51]
buffer_load_dwordx4 v239,s[96:99],s28 offen offset:3072 lds
v_mfma_f32_16x16x32_bf16 v[52:55],a[192:195],v[128:131],0
ds_read_b64_tr_b16 a[232:233],v242 offset:24576
ds_read_b64_tr_b16 a[234:235],v242 offset:26624
v_cvt_pk_bf16_f32 v16,v16,v17
v_cvt_pk_bf16_f32 v17,v18,v19
v_mfma_f32_16x16x32_bf16 v[52:55],a[196:199],v[132:135],v[52:55]
v_cvt_pk_bf16_f32 v18,v24,v25
v_cvt_pk_bf16_f32 v19,v26,v27
buffer_store_dwordx4 v[16:19],v248,s[20:23],s62 offen sc0 sc1
v_mfma_f32_16x16x32_bf16 v[52:55],a[200:203],v[136:139],v[52:55]
ds_read_b64_tr_b16 a[236:237],v242 offset:28672
ds_read_b64_tr_b16 a[238:239],v242 offset:30720
v_cvt_pk_bf16_f32 v20,v20,v21
v_cvt_pk_bf16_f32 v21,v22,v23
v_mfma_f32_16x16x32_bf16 v[52:55],a[204:207],v[140:143],v[52:55]
v_cvt_pk_bf16_f32 v22,v28,v29
v_cvt_pk_bf16_f32 v23,v30,v31
buffer_store_dwordx4 v[20:23],v248,s[20:23],s63 offen sc0 sc1
v_mfma_f32_16x16x32_bf16 v[56:59],a[208:211],v[112:115],0
ds_read_b64_tr_b16 a[240:241],v243 offset:16384
ds_read_b64_tr_b16 a[242:243],v243 offset:18432
s_waitcnt lgkmcnt(8)
v_mfma_f32_16x16x32_bf16 v[56:59],a[212:215],v[116:119],v[56:59]
v_mfma_f32_16x16x32_bf16 v[56:59],a[216:219],v[120:123],v[56:59]
ds_read_b64_tr_b16 a[244:245],v243 offset:20480
ds_read_b64_tr_b16 a[246:247],v243 offset:22528
v_mfma_f32_16x16x32_bf16 v[56:59],a[220:223],v[124:127],v[56:59]
v_mfma_f32_16x16x32_bf16 v[60:63],a[208:211],v[128:131],0
ds_read_b64_tr_b16 a[248:249],v243 offset:24576
ds_read_b64_tr_b16 a[250:251],v243 offset:26624
v_mfma_f32_16x16x32_bf16 v[60:63],a[212:215],v[132:135],v[60:63]
v_mfma_f32_16x16x32_bf16 v[60:63],a[216:219],v[136:139],v[60:63]
ds_read_b64_tr_b16 a[252:253],v243 offset:28672
ds_read_b64_tr_b16 a[254:255],v243 offset:30720
v_mfma_f32_16x16x32_bf16 v[60:63],a[220:223],v[140:143],v[60:63]
v_mfma_f32_16x16x32_bf16 v[64:67],a[224:227],v[112:115],0
ds_read_b64_tr_b16 a[192:193],v240 offset:32768
ds_read_b64_tr_b16 a[194:195],v240 offset:34816
s_waitcnt lgkmcnt(8)
v_mfma_f32_16x16x32_bf16 v[64:67],a[228:231],v[116:119],v[64:67]
v_mfma_f32_16x16x32_bf16 v[64:67],a[232:235],v[120:123],v[64:67]
ds_read_b64_tr_b16 a[196:197],v240 offset:36864
ds_read_b64_tr_b16 a[198:199],v240 offset:38912
v_mfma_f32_16x16x32_bf16 v[64:67],a[236:239],v[124:127],v[64:67]
v_mfma_f32_16x16x32_bf16 v[68:71],a[224:227],v[128:131],0
ds_read_b64_tr_b16 a[200:201],v240 offset:40960
ds_read_b64_tr_b16 a[202:203],v240 offset:43008
v_mfma_f32_16x16x32_bf16 v[68:71],a[228:231],v[132:135],v[68:71]
v_mfma_f32_16x16x32_bf16 v[68:71],a[232:235],v[136:139],v[68:71]
ds_read_b64_tr_b16 a[204:205],v240 offset:45056
ds_read_b64_tr_b16 a[206:207],v240 offset:47104
v_mfma_f32_16x16x32_bf16 v[68:71],a[236:239],v[140:143],v[68:71]
v_mfma_f32_16x16x32_bf16 v[72:75],a[240:243],v[112:115],0
ds_read_b64_tr_b16 a[208:209],v241 offset:32768
ds_read_b64_tr_b16 a[210:211],v241 offset:34816
s_waitcnt lgkmcnt(10)
v_mfma_f32_16x16x32_bf16 v[72:75],a[244:247],v[116:119],v[72:75]
v_mfma_f32_16x16x32_bf16 v[72:75],a[248:251],v[120:123],v[72:75]
ds_read_b64_tr_b16 a[212:213],v241 offset:36864
ds_read_b64_tr_b16 a[214:215],v241 offset:38912
v_mfma_f32_16x16x32_bf16 v[72:75],a[252:255],v[124:127],v[72:75]
v_mfma_f32_16x16x32_bf16 v[76:79],a[240:243],v[128:131],0
ds_read_b64_tr_b16 a[216:217],v241 offset:40960
ds_read_b64_tr_b16 a[218:219],v241 offset:43008
v_mfma_f32_16x16x32_bf16 v[76:79],a[244:247],v[132:135],v[76:79]
v_mfma_f32_16x16x32_bf16 v[76:79],a[248:251],v[136:139],v[76:79]
ds_read_b64_tr_b16 a[220:221],v241 offset:45056
ds_read_b64_tr_b16 a[222:223],v241 offset:47104
v_mfma_f32_16x16x32_bf16 v[76:79],a[252:255],v[140:143],v[76:79]
s_waitcnt vmcnt(30)
s_barrier
s_waitcnt lgkmcnt(6)
v_mfma_f32_16x16x32_bf16 v[48:51],a[192:195],v[160:163],v[48:51]
ds_read_b64_tr_b16 a[224:225],v242 offset:32768
ds_read_b64_tr_b16 a[226:227],v242 offset:34816
v_mfma_f32_16x16x32_bf16 v[48:51],a[196:199],v[164:167],v[48:51]
v_mfma_f32_16x16x32_bf16 v[48:51],a[200:203],v[168:171],v[48:51]
ds_read_b64_tr_b16 a[228:229],v242 offset:36864
ds_read_b64_tr_b16 a[230:231],v242 offset:38912
v_mfma_f32_16x16x32_bf16 v[48:51],a[204:207],v[172:175],v[48:51]
v_mfma_f32_16x16x32_bf16 v[52:55],a[192:195],v[176:179],v[52:55]
ds_read_b64_tr_b16 a[232:233],v242 offset:40960
ds_read_b64_tr_b16 a[234:235],v242 offset:43008
v_cvt_pk_bf16_f32 v32,v32,v33
v_cvt_pk_bf16_f32 v33,v34,v35
v_mfma_f32_16x16x32_bf16 v[52:55],a[196:199],v[180:183],v[52:55]
v_cvt_pk_bf16_f32 v34,v40,v41
v_cvt_pk_bf16_f32 v35,v42,v43
buffer_store_dwordx4 v[32:35],v249,s[20:23],s62 offen sc0 sc1
v_mfma_f32_16x16x32_bf16 v[52:55],a[200:203],v[184:187],v[52:55]
ds_read_b64_tr_b16 a[236:237],v242 offset:45056
ds_read_b64_tr_b16 a[238:239],v242 offset:47104
s_add_u32 s62,s62,32768
v_cvt_pk_bf16_f32 v36,v36,v37
v_mfma_f32_16x16x32_bf16 v[52:55],a[204:207],v[188:191],v[52:55]
v_cvt_pk_bf16_f32 v37,v38,v39
v_cvt_pk_bf16_f32 v38,v44,v45
v_cvt_pk_bf16_f32 v39,v46,v47
v_mfma_f32_16x16x32_bf16 v[56:59],a[208:211],v[160:163],v[56:59]
ds_read_b64_tr_b16 a[240:241],v243 offset:32768
ds_read_b64_tr_b16 a[242:243],v243 offset:34816
s_waitcnt lgkmcnt(8)
v_mfma_f32_16x16x32_bf16 v[56:59],a[212:215],v[164:167],v[56:59]
buffer_store_dwordx4 v[36:39],v249,s[20:23],s63 offen sc0 sc1
s_add_u32 s63,s63,32768
v_mfma_f32_16x16x32_bf16 v[56:59],a[216:219],v[168:171],v[56:59]
ds_read_b64_tr_b16 a[244:245],v243 offset:36864
ds_read_b64_tr_b16 a[246:247],v243 offset:38912
v_mfma_f32_16x16x32_bf16 v[56:59],a[220:223],v[172:175],v[56:59]
v_mfma_f32_16x16x32_bf16 v[60:63],a[208:211],v[176:179],v[60:63]
ds_read_b64_tr_b16 a[248:249],v243 offset:40960
ds_read_b64_tr_b16 a[250:251],v243 offset:43008
v_mfma_f32_16x16x32_bf16 v[60:63],a[212:215],v[180:183],v[60:63]
v_mfma_f32_16x16x32_bf16 v[60:63],a[216:219],v[184:187],v[60:63]
ds_read_b64_tr_b16 a[252:253],v243 offset:45056
ds_read_b64_tr_b16 a[254:255],v243 offset:47104
v_mfma_f32_16x16x32_bf16 v[60:63],a[220:223],v[188:191],v[60:63]
v_mfma_f32_16x16x32_bf16 v[64:67],a[224:227],v[160:163],v[64:67]
ds_read_b64_tr_b16 a[192:193],v240 offset:49152
ds_read_b64_tr_b16 a[194:195],v240 offset:51200
s_waitcnt lgkmcnt(8)
v_mfma_f32_16x16x32_bf16 v[64:67],a[228:231],v[164:167],v[64:67]
v_mfma_f32_16x16x32_bf16 v[64:67],a[232:235],v[168:171],v[64:67]
ds_read_b64_tr_b16 a[196:197],v240 offset:53248
ds_read_b64_tr_b16 a[198:199],v240 offset:55296
v_mfma_f32_16x16x32_bf16 v[64:67],a[236:239],v[172:175],v[64:67]
v_mfma_f32_16x16x32_bf16 v[68:71],a[224:227],v[176:179],v[68:71]
ds_read_b64_tr_b16 a[200:201],v240 offset:57344
ds_read_b64_tr_b16 a[202:203],v240 offset:59392
v_mfma_f32_16x16x32_bf16 v[68:71],a[228:231],v[180:183],v[68:71]
v_mfma_f32_16x16x32_bf16 v[68:71],a[232:235],v[184:187],v[68:71]
ds_read_b64_tr_b16 a[204:205],v240 offset:61440
ds_read_b64_tr_b16 a[206:207],v240 offset:63488
v_mfma_f32_16x16x32_bf16 v[68:71],a[236:239],v[188:191],v[68:71]
v_mfma_f32_16x16x32_bf16 v[72:75],a[240:243],v[160:163],v[72:75]
ds_read_b64_tr_b16 a[208:209],v241 offset:49152
ds_read_b64_tr_b16 a[210:211],v241 offset:51200
s_waitcnt lgkmcnt(10)
v_mfma_f32_16x16x32_bf16 v[72:75],a[244:247],v[164:167],v[72:75]
v_mfma_f32_16x16x32_bf16 v[72:75],a[248:251],v[168:171],v[72:75]
ds_read_b64_tr_b16 a[212:213],v241 offset:53248
ds_read_b64_tr_b16 a[214:215],v241 offset:55296
v_mfma_f32_16x16x32_bf16 v[72:75],a[252:255],v[172:175],v[72:75]
v_mfma_f32_16x16x32_bf16 v[76:79],a[240:243],v[176:179],v[76:79]
ds_read_b64_tr_b16 a[216:217],v241 offset:57344
ds_read_b64_tr_b16 a[218:219],v241 offset:59392
v_mfma_f32_16x16x32_bf16 v[76:79],a[244:247],v[180:183],v[76:79]
v_mfma_f32_16x16x32_bf16 v[76:79],a[248:251],v[184:187],v[76:79]
ds_read_b64_tr_b16 a[220:221],v241 offset:61440
ds_read_b64_tr_b16 a[222:223],v241 offset:63488
v_mfma_f32_16x16x32_bf16 v[76:79],a[252:255],v[188:191],v[76:79]
s_waitcnt vmcnt(28)
s_barrier
s_waitcnt lgkmcnt(6)
v_mfma_f32_16x16x32_bf16 v[16:19],a[192:195],v[112:115],0
ds_read_b64_tr_b16 a[224:225],v242 offset:49152
ds_read_b64_tr_b16 a[226:227],v242 offset:51200
v_mfma_f32_16x16x32_bf16 v[16:19],a[196:199],v[116:119],v[16:19]
v_mfma_f32_16x16x32_bf16 v[16:19],a[200:203],v[120:123],v[16:19]
ds_read_b64_tr_b16 a[228:229],v242 offset:53248
ds_read_b64_tr_b16 a[230:231],v242 offset:55296
v_mfma_f32_16x16x32_bf16 v[16:19],a[204:207],v[124:127],v[16:19]
v_mfma_f32_16x16x32_bf16 v[20:23],a[192:195],v[128:131],0
ds_read_b64_tr_b16 a[232:233],v242 offset:57344
ds_read_b64_tr_b16 a[234:235],v242 offset:59392
v_cvt_pk_bf16_f32 v48,v48,v49
v_cvt_pk_bf16_f32 v49,v50,v51
v_mfma_f32_16x16x32_bf16 v[20:23],a[196:199],v[132:135],v[20:23]
v_cvt_pk_bf16_f32 v50,v56,v57
v_cvt_pk_bf16_f32 v51,v58,v59
buffer_store_dwordx4 v[48:51],v248,s[20:23],s62 offen sc0 sc1
v_mfma_f32_16x16x32_bf16 v[20:23],a[200:203],v[136:139],v[20:23]
ds_read_b64_tr_b16 a[236:237],v242 offset:61440
ds_read_b64_tr_b16 a[238:239],v242 offset:63488
v_cvt_pk_bf16_f32 v52,v52,v53
v_cvt_pk_bf16_f32 v53,v54,v55
v_mfma_f32_16x16x32_bf16 v[20:23],a[204:207],v[140:143],v[20:23]
v_cvt_pk_bf16_f32 v54,v60,v61
v_cvt_pk_bf16_f32 v55,v62,v63
buffer_store_dwordx4 v[52:55],v248,s[20:23],s63 offen sc0 sc1
v_mfma_f32_16x16x32_bf16 v[24:27],a[208:211],v[112:115],0
ds_read_b64_tr_b16 a[240:241],v243 offset:49152
ds_read_b64_tr_b16 a[242:243],v243 offset:51200
s_waitcnt lgkmcnt(8)
v_mfma_f32_16x16x32_bf16 v[24:27],a[212:215],v[116:119],v[24:27]
v_mfma_f32_16x16x32_bf16 v[24:27],a[216:219],v[120:123],v[24:27]
ds_read_b64_tr_b16 a[244:245],v243 offset:53248
ds_read_b64_tr_b16 a[246:247],v243 offset:55296
v_mfma_f32_16x16x32_bf16 v[24:27],a[220:223],v[124:127],v[24:27]
v_mfma_f32_16x16x32_bf16 v[28:31],a[208:211],v[128:131],0
ds_read_b64_tr_b16 a[248:249],v243 offset:57344
ds_read_b64_tr_b16 a[250:251],v243 offset:59392
v_mfma_f32_16x16x32_bf16 v[28:31],a[212:215],v[132:135],v[28:31]
v_mfma_f32_16x16x32_bf16 v[28:31],a[216:219],v[136:139],v[28:31]
ds_read_b64_tr_b16 a[252:253],v243 offset:61440
ds_read_b64_tr_b16 a[254:255],v243 offset:63488
v_mfma_f32_16x16x32_bf16 v[28:31],a[220:223],v[140:143],v[28:31]
v_mfma_f32_16x16x32_bf16 v[32:35],a[224:227],v[112:115],0
ds_read_b64_tr_b16 a[192:193],v244 offset:0
ds_read_b64_tr_b16 a[194:195],v244 offset:2048
s_waitcnt lgkmcnt(8)
v_mfma_f32_16x16x32_bf16 v[32:35],a[228:231],v[116:119],v[32:35]
v_mfma_f32_16x16x32_bf16 v[32:35],a[232:235],v[120:123],v[32:35]
ds_read_b64_tr_b16 a[196:197],v244 offset:4096
ds_read_b64_tr_b16 a[198:199],v244 offset:6144
v_mfma_f32_16x16x32_bf16 v[32:35],a[236:239],v[124:127],v[32:35]
v_mfma_f32_16x16x32_bf16 v[36:39],a[224:227],v[128:131],0
ds_read_b64_tr_b16 a[200:201],v244 offset:8192
ds_read_b64_tr_b16 a[202:203],v244 offset:10240
v_mfma_f32_16x16x32_bf16 v[36:39],a[228:231],v[132:135],v[36:39]
v_mfma_f32_16x16x32_bf16 v[36:39],a[232:235],v[136:139],v[36:39]
ds_read_b64_tr_b16 a[204:205],v244 offset:12288
ds_read_b64_tr_b16 a[206:207],v244 offset:14336
v_mfma_f32_16x16x32_bf16 v[36:39],a[236:239],v[140:143],v[36:39]
v_mfma_f32_16x16x32_bf16 v[40:43],a[240:243],v[112:115],0
ds_read_b64_tr_b16 a[208:209],v245 offset:0
ds_read_b64_tr_b16 a[210:211],v245 offset:2048
s_waitcnt lgkmcnt(10)
v_mfma_f32_16x16x32_bf16 v[40:43],a[244:247],v[116:119],v[40:43]
v_mfma_f32_16x16x32_bf16 v[40:43],a[248:251],v[120:123],v[40:43]
ds_read_b64_tr_b16 a[212:213],v245 offset:4096
ds_read_b64_tr_b16 a[214:215],v245 offset:6144
v_mfma_f32_16x16x32_bf16 v[40:43],a[252:255],v[124:127],v[40:43]
v_mfma_f32_16x16x32_bf16 v[44:47],a[240:243],v[128:131],0
ds_read_b64_tr_b16 a[216:217],v245 offset:8192
ds_read_b64_tr_b16 a[218:219],v245 offset:10240
v_mfma_f32_16x16x32_bf16 v[44:47],a[244:247],v[132:135],v[44:47]
v_mfma_f32_16x16x32_bf16 v[44:47],a[248:251],v[136:139],v[44:47]
ds_read_b64_tr_b16 a[220:221],v245 offset:12288
ds_read_b64_tr_b16 a[222:223],v245 offset:14336
v_mfma_f32_16x16x32_bf16 v[44:47],a[252:255],v[140:143],v[44:47]
s_waitcnt vmcnt(26)
s_barrier
s_waitcnt lgkmcnt(6)
v_mfma_f32_16x16x32_bf16 v[16:19],a[192:195],v[160:163],v[16:19]
ds_read_b64_tr_b16 a[224:225],v246 offset:0
ds_read_b64_tr_b16 a[226:227],v246 offset:2048
v_mfma_f32_16x16x32_bf16 v[16:19],a[196:199],v[164:167],v[16:19]
v_mfma_f32_16x16x32_bf16 v[16:19],a[200:203],v[168:171],v[16:19]
ds_read_b64_tr_b16 a[228:229],v246 offset:4096
ds_read_b64_tr_b16 a[230:231],v246 offset:6144
v_mfma_f32_16x16x32_bf16 v[16:19],a[204:207],v[172:175],v[16:19]
v_mfma_f32_16x16x32_bf16 v[20:23],a[192:195],v[176:179],v[20:23]
ds_read_b64_tr_b16 a[232:233],v246 offset:8192
ds_read_b64_tr_b16 a[234:235],v246 offset:10240
v_cvt_pk_bf16_f32 v64,v64,v65
v_cvt_pk_bf16_f32 v65,v66,v67
v_mfma_f32_16x16x32_bf16 v[20:23],a[196:199],v[180:183],v[20:23]
v_cvt_pk_bf16_f32 v66,v72,v73
v_cvt_pk_bf16_f32 v67,v74,v75
buffer_store_dwordx4 v[64:67],v249,s[20:23],s62 offen sc0 sc1
v_mfma_f32_16x16x32_bf16 v[20:23],a[200:203],v[184:187],v[20:23]
ds_read_b64_tr_b16 a[236:237],v246 offset:12288
ds_read_b64_tr_b16 a[238:239],v246 offset:14336
s_add_u32 s62,s62,32768
v_cvt_pk_bf16_f32 v68,v68,v69
v_mfma_f32_16x16x32_bf16 v[20:23],a[204:207],v[188:191],v[20:23]
v_cvt_pk_bf16_f32 v69,v70,v71
v_cvt_pk_bf16_f32 v70,v76,v77
v_cvt_pk_bf16_f32 v71,v78,v79
v_mfma_f32_16x16x32_bf16 v[24:27],a[208:211],v[160:163],v[24:27]
ds_read_b64_tr_b16 a[240:241],v247 offset:0
ds_read_b64_tr_b16 a[242:243],v247 offset:2048
s_waitcnt lgkmcnt(8)
v_mfma_f32_16x16x32_bf16 v[24:27],a[212:215],v[164:167],v[24:27]
buffer_store_dwordx4 v[68:71],v249,s[20:23],s63 offen sc0 sc1
s_add_u32 s63,s63,32768
v_mfma_f32_16x16x32_bf16 v[24:27],a[216:219],v[168:171],v[24:27]
ds_read_b64_tr_b16 a[244:245],v247 offset:4096
ds_read_b64_tr_b16 a[246:247],v247 offset:6144
v_mfma_f32_16x16x32_bf16 v[24:27],a[220:223],v[172:175],v[24:27]
v_mfma_f32_16x16x32_bf16 v[28:31],a[208:211],v[176:179],v[28:31]
ds_read_b64_tr_b16 a[248:249],v247 offset:8192
ds_read_b64_tr_b16 a[250:251],v247 offset:10240
v_mfma_f32_16x16x32_bf16 v[28:31],a[212:215],v[180:183],v[28:31]
v_mfma_f32_16x16x32_bf16 v[28:31],a[216:219],v[184:187],v[28:31]
ds_read_b64_tr_b16 a[252:253],v247 offset:12288
ds_read_b64_tr_b16 a[254:255],v247 offset:14336
v_mfma_f32_16x16x32_bf16 v[28:31],a[220:223],v[188:191],v[28:31]
v_mfma_f32_16x16x32_bf16 v[32:35],a[224:227],v[160:163],v[32:35]
ds_read_b64_tr_b16 a[192:193],v244 offset:16384
ds_read_b64_tr_b16 a[194:195],v244 offset:18432
s_waitcnt lgkmcnt(8)
v_mfma_f32_16x16x32_bf16 v[32:35],a[228:231],v[164:167],v[32:35]
v_mfma_f32_16x16x32_bf16 v[32:35],a[232:235],v[168:171],v[32:35]
ds_read_b64_tr_b16 a[196:197],v244 offset:20480
ds_read_b64_tr_b16 a[198:199],v244 offset:22528
v_mfma_f32_16x16x32_bf16 v[32:35],a[236:239],v[172:175],v[32:35]
v_mfma_f32_16x16x32_bf16 v[36:39],a[224:227],v[176:179],v[36:39]
ds_read_b64_tr_b16 a[200:201],v244 offset:24576
ds_read_b64_tr_b16 a[202:203],v244 offset:26624
v_mfma_f32_16x16x32_bf16 v[36:39],a[228:231],v[180:183],v[36:39]
v_mfma_f32_16x16x32_bf16 v[36:39],a[232:235],v[184:187],v[36:39]
ds_read_b64_tr_b16 a[204:205],v244 offset:28672
ds_read_b64_tr_b16 a[206:207],v244 offset:30720
v_mfma_f32_16x16x32_bf16 v[36:39],a[236:239],v[188:191],v[36:39]
v_mfma_f32_16x16x32_bf16 v[40:43],a[240:243],v[160:163],v[40:43]
ds_read_b64_tr_b16 a[208:209],v245 offset:16384
ds_read_b64_tr_b16 a[210:211],v245 offset:18432
s_waitcnt lgkmcnt(10)
v_mfma_f32_16x16x32_bf16 v[40:43],a[244:247],v[164:167],v[40:43]
v_mfma_f32_16x16x32_bf16 v[40:43],a[248:251],v[168:171],v[40:43]
ds_read_b64_tr_b16 a[212:213],v245 offset:20480
ds_read_b64_tr_b16 a[214:215],v245 offset:22528
v_mfma_f32_16x16x32_bf16 v[40:43],a[252:255],v[172:175],v[40:43]
v_mfma_f32_16x16x32_bf16 v[44:47],a[240:243],v[176:179],v[44:47]
ds_read_b64_tr_b16 a[216:217],v245 offset:24576
ds_read_b64_tr_b16 a[218:219],v245 offset:26624
v_mfma_f32_16x16x32_bf16 v[44:47],a[244:247],v[180:183],v[44:47]
v_mfma_f32_16x16x32_bf16 v[44:47],a[248:251],v[184:187],v[44:47]
ds_read_b64_tr_b16 a[220:221],v245 offset:28672
ds_read_b64_tr_b16 a[222:223],v245 offset:30720
v_mfma_f32_16x16x32_bf16 v[44:47],a[252:255],v[188:191],v[44:47]
s_waitcnt vmcnt(20)
s_barrier
s_waitcnt lgkmcnt(6)
v_mfma_f32_16x16x32_bf16 v[48:51],a[192:195],v[112:115],0
ds_read_b64_tr_b16 a[224:225],v246 offset:16384
ds_read_b64_tr_b16 a[226:227],v246 offset:18432
v_mfma_f32_16x16x32_bf16 v[48:51],a[196:199],v[116:119],v[48:51]
v_mfma_f32_16x16x32_bf16 v[48:51],a[200:203],v[120:123],v[48:51]
ds_read_b64_tr_b16 a[228:229],v246 offset:20480
ds_read_b64_tr_b16 a[230:231],v246 offset:22528
v_mfma_f32_16x16x32_bf16 v[48:51],a[204:207],v[124:127],v[48:51]
v_mfma_f32_16x16x32_bf16 v[52:55],a[192:195],v[128:131],0
ds_read_b64_tr_b16 a[232:233],v246 offset:24576
ds_read_b64_tr_b16 a[234:235],v246 offset:26624
v_cvt_pk_bf16_f32 v16,v16,v17
v_cvt_pk_bf16_f32 v17,v18,v19
v_mfma_f32_16x16x32_bf16 v[52:55],a[196:199],v[132:135],v[52:55]
v_cvt_pk_bf16_f32 v18,v24,v25
v_cvt_pk_bf16_f32 v19,v26,v27
buffer_store_dwordx4 v[16:19],v248,s[20:23],s62 offen sc0 sc1
v_mfma_f32_16x16x32_bf16 v[52:55],a[200:203],v[136:139],v[52:55]
ds_read_b64_tr_b16 a[236:237],v246 offset:28672
ds_read_b64_tr_b16 a[238:239],v246 offset:30720
v_cvt_pk_bf16_f32 v20,v20,v21
v_cvt_pk_bf16_f32 v21,v22,v23
v_mfma_f32_16x16x32_bf16 v[52:55],a[204:207],v[140:143],v[52:55]
v_cvt_pk_bf16_f32 v22,v28,v29
v_cvt_pk_bf16_f32 v23,v30,v31
buffer_store_dwordx4 v[20:23],v248,s[20:23],s63 offen sc0 sc1
v_mfma_f32_16x16x32_bf16 v[56:59],a[208:211],v[112:115],0
ds_read_b64_tr_b16 a[240:241],v247 offset:16384
ds_read_b64_tr_b16 a[242:243],v247 offset:18432
s_waitcnt lgkmcnt(8)
v_mfma_f32_16x16x32_bf16 v[56:59],a[212:215],v[116:119],v[56:59]
v_mfma_f32_16x16x32_bf16 v[56:59],a[216:219],v[120:123],v[56:59]
ds_read_b64_tr_b16 a[244:245],v247 offset:20480
ds_read_b64_tr_b16 a[246:247],v247 offset:22528
v_mfma_f32_16x16x32_bf16 v[56:59],a[220:223],v[124:127],v[56:59]
v_mfma_f32_16x16x32_bf16 v[60:63],a[208:211],v[128:131],0
ds_read_b64_tr_b16 a[248:249],v247 offset:24576
ds_read_b64_tr_b16 a[250:251],v247 offset:26624
v_mfma_f32_16x16x32_bf16 v[60:63],a[212:215],v[132:135],v[60:63]
v_mfma_f32_16x16x32_bf16 v[60:63],a[216:219],v[136:139],v[60:63]
ds_read_b64_tr_b16 a[252:253],v247 offset:28672
ds_read_b64_tr_b16 a[254:255],v247 offset:30720
v_mfma_f32_16x16x32_bf16 v[60:63],a[220:223],v[140:143],v[60:63]
v_mfma_f32_16x16x32_bf16 v[64:67],a[224:227],v[112:115],0
ds_read_b64_tr_b16 a[192:193],v244 offset:32768
ds_read_b64_tr_b16 a[194:195],v244 offset:34816
s_waitcnt lgkmcnt(8)
v_mfma_f32_16x16x32_bf16 v[64:67],a[228:231],v[116:119],v[64:67]
v_mfma_f32_16x16x32_bf16 v[64:67],a[232:235],v[120:123],v[64:67]
ds_read_b64_tr_b16 a[196:197],v244 offset:36864
ds_read_b64_tr_b16 a[198:199],v244 offset:38912
v_mfma_f32_16x16x32_bf16 v[64:67],a[236:239],v[124:127],v[64:67]
v_mfma_f32_16x16x32_bf16 v[68:71],a[224:227],v[128:131],0
ds_read_b64_tr_b16 a[200:201],v244 offset:40960
ds_read_b64_tr_b16 a[202:203],v244 offset:43008
v_mfma_f32_16x16x32_bf16 v[68:71],a[228:231],v[132:135],v[68:71]
v_mfma_f32_16x16x32_bf16 v[68:71],a[232:235],v[136:139],v[68:71]
ds_read_b64_tr_b16 a[204:205],v244 offset:45056
ds_read_b64_tr_b16 a[206:207],v244 offset:47104
v_mfma_f32_16x16x32_bf16 v[68:71],a[236:239],v[140:143],v[68:71]
v_mfma_f32_16x16x32_bf16 v[72:75],a[240:243],v[112:115],0
ds_read_b64_tr_b16 a[208:209],v245 offset:32768
ds_read_b64_tr_b16 a[210:211],v245 offset:34816
s_waitcnt lgkmcnt(10)
v_mfma_f32_16x16x32_bf16 v[72:75],a[244:247],v[116:119],v[72:75]
v_mfma_f32_16x16x32_bf16 v[72:75],a[248:251],v[120:123],v[72:75]
ds_read_b64_tr_b16 a[212:213],v245 offset:36864
ds_read_b64_tr_b16 a[214:215],v245 offset:38912
v_mfma_f32_16x16x32_bf16 v[72:75],a[252:255],v[124:127],v[72:75]
v_mfma_f32_16x16x32_bf16 v[76:79],a[240:243],v[128:131],0
ds_read_b64_tr_b16 a[216:217],v245 offset:40960
ds_read_b64_tr_b16 a[218:219],v245 offset:43008
v_mfma_f32_16x16x32_bf16 v[76:79],a[244:247],v[132:135],v[76:79]
v_mfma_f32_16x16x32_bf16 v[76:79],a[248:251],v[136:139],v[76:79]
ds_read_b64_tr_b16 a[220:221],v245 offset:45056
ds_read_b64_tr_b16 a[222:223],v245 offset:47104
v_mfma_f32_16x16x32_bf16 v[76:79],a[252:255],v[140:143],v[76:79]
s_waitcnt vmcnt(16)
s_barrier
s_waitcnt lgkmcnt(6)
v_mfma_f32_16x16x32_bf16 v[48:51],a[192:195],v[160:163],v[48:51]
ds_read_b64_tr_b16 a[224:225],v246 offset:32768
ds_read_b64_tr_b16 a[226:227],v246 offset:34816
v_mfma_f32_16x16x32_bf16 v[48:51],a[196:199],v[164:167],v[48:51]
v_mfma_f32_16x16x32_bf16 v[48:51],a[200:203],v[168:171],v[48:51]
ds_read_b64_tr_b16 a[228:229],v246 offset:36864
ds_read_b64_tr_b16 a[230:231],v246 offset:38912
v_mfma_f32_16x16x32_bf16 v[48:51],a[204:207],v[172:175],v[48:51]
v_mfma_f32_16x16x32_bf16 v[52:55],a[192:195],v[176:179],v[52:55]
ds_read_b64_tr_b16 a[232:233],v246 offset:40960
ds_read_b64_tr_b16 a[234:235],v246 offset:43008
v_cvt_pk_bf16_f32 v32,v32,v33
v_cvt_pk_bf16_f32 v33,v34,v35
v_mfma_f32_16x16x32_bf16 v[52:55],a[196:199],v[180:183],v[52:55]
v_cvt_pk_bf16_f32 v34,v40,v41
v_cvt_pk_bf16_f32 v35,v42,v43
buffer_store_dwordx4 v[32:35],v249,s[20:23],s62 offen sc0 sc1
v_mfma_f32_16x16x32_bf16 v[52:55],a[200:203],v[184:187],v[52:55]
ds_read_b64_tr_b16 a[236:237],v246 offset:45056
ds_read_b64_tr_b16 a[238:239],v246 offset:47104
s_add_u32 s62,s62,32768
v_cvt_pk_bf16_f32 v36,v36,v37
v_mfma_f32_16x16x32_bf16 v[52:55],a[204:207],v[188:191],v[52:55]
v_cvt_pk_bf16_f32 v37,v38,v39
v_cvt_pk_bf16_f32 v38,v44,v45
v_cvt_pk_bf16_f32 v39,v46,v47
v_mfma_f32_16x16x32_bf16 v[56:59],a[208:211],v[160:163],v[56:59]
ds_read_b64_tr_b16 a[240:241],v247 offset:32768
ds_read_b64_tr_b16 a[242:243],v247 offset:34816
s_waitcnt lgkmcnt(8)
v_mfma_f32_16x16x32_bf16 v[56:59],a[212:215],v[164:167],v[56:59]
buffer_store_dwordx4 v[36:39],v249,s[20:23],s63 offen sc0 sc1
s_add_u32 s63,s63,32768
v_mfma_f32_16x16x32_bf16 v[56:59],a[216:219],v[168:171],v[56:59]
ds_read_b64_tr_b16 a[244:245],v247 offset:36864
ds_read_b64_tr_b16 a[246:247],v247 offset:38912
v_mfma_f32_16x16x32_bf16 v[56:59],a[220:223],v[172:175],v[56:59]
v_mfma_f32_16x16x32_bf16 v[60:63],a[208:211],v[176:179],v[60:63]
ds_read_b64_tr_b16 a[248:249],v247 offset:40960
ds_read_b64_tr_b16 a[250:251],v247 offset:43008
v_mfma_f32_16x16x32_bf16 v[60:63],a[212:215],v[180:183],v[60:63]
v_mfma_f32_16x16x32_bf16 v[60:63],a[216:219],v[184:187],v[60:63]
ds_read_b64_tr_b16 a[252:253],v247 offset:45056
ds_read_b64_tr_b16 a[254:255],v247 offset:47104
v_mfma_f32_16x16x32_bf16 v[60:63],a[220:223],v[188:191],v[60:63]
v_mfma_f32_16x16x32_bf16 v[64:67],a[224:227],v[160:163],v[64:67]
ds_read_b64_tr_b16 a[192:193],v244 offset:49152
ds_read_b64_tr_b16 a[194:195],v244 offset:51200
s_waitcnt lgkmcnt(8)
v_mfma_f32_16x16x32_bf16 v[64:67],a[228:231],v[164:167],v[64:67]
v_mfma_f32_16x16x32_bf16 v[64:67],a[232:235],v[168:171],v[64:67]
ds_read_b64_tr_b16 a[196:197],v244 offset:53248
ds_read_b64_tr_b16 a[198:199],v244 offset:55296
v_mfma_f32_16x16x32_bf16 v[64:67],a[236:239],v[172:175],v[64:67]
v_mfma_f32_16x16x32_bf16 v[68:71],a[224:227],v[176:179],v[68:71]
ds_read_b64_tr_b16 a[200:201],v244 offset:57344
ds_read_b64_tr_b16 a[202:203],v244 offset:59392
v_mfma_f32_16x16x32_bf16 v[68:71],a[228:231],v[180:183],v[68:71]
v_mfma_f32_16x16x32_bf16 v[68:71],a[232:235],v[184:187],v[68:71]
ds_read_b64_tr_b16 a[204:205],v244 offset:61440
ds_read_b64_tr_b16 a[206:207],v244 offset:63488
v_mfma_f32_16x16x32_bf16 v[68:71],a[236:239],v[188:191],v[68:71]
v_mfma_f32_16x16x32_bf16 v[72:75],a[240:243],v[160:163],v[72:75]
ds_read_b64_tr_b16 a[208:209],v245 offset:49152
ds_read_b64_tr_b16 a[210:211],v245 offset:51200
s_waitcnt lgkmcnt(10)
v_mfma_f32_16x16x32_bf16 v[72:75],a[244:247],v[164:167],v[72:75]
v_mfma_f32_16x16x32_bf16 v[72:75],a[248:251],v[168:171],v[72:75]
ds_read_b64_tr_b16 a[212:213],v245 offset:53248
ds_read_b64_tr_b16 a[214:215],v245 offset:55296
v_mfma_f32_16x16x32_bf16 v[72:75],a[252:255],v[172:175],v[72:75]
v_mfma_f32_16x16x32_bf16 v[76:79],a[240:243],v[176:179],v[76:79]
ds_read_b64_tr_b16 a[216:217],v245 offset:57344
ds_read_b64_tr_b16 a[218:219],v245 offset:59392
v_mfma_f32_16x16x32_bf16 v[76:79],a[244:247],v[180:183],v[76:79]
v_mfma_f32_16x16x32_bf16 v[76:79],a[248:251],v[184:187],v[76:79]
ds_read_b64_tr_b16 a[220:221],v245 offset:61440
ds_read_b64_tr_b16 a[222:223],v245 offset:63488
v_mfma_f32_16x16x32_bf16 v[76:79],a[252:255],v[188:191],v[76:79]
s_waitcnt vmcnt(12)
s_barrier
s_waitcnt lgkmcnt(6)
v_mfma_f32_16x16x32_bf16 v[16:19],a[192:195],v[112:115],0
ds_read_b64_tr_b16 a[224:225],v246 offset:49152
ds_read_b64_tr_b16 a[226:227],v246 offset:51200
v_mfma_f32_16x16x32_bf16 v[16:19],a[196:199],v[116:119],v[16:19]
v_mfma_f32_16x16x32_bf16 v[16:19],a[200:203],v[120:123],v[16:19]
ds_read_b64_tr_b16 a[228:229],v246 offset:53248
ds_read_b64_tr_b16 a[230:231],v246 offset:55296
v_mfma_f32_16x16x32_bf16 v[16:19],a[204:207],v[124:127],v[16:19]
v_mfma_f32_16x16x32_bf16 v[20:23],a[192:195],v[128:131],0
ds_read_b64_tr_b16 a[232:233],v246 offset:57344
ds_read_b64_tr_b16 a[234:235],v246 offset:59392
v_cvt_pk_bf16_f32 v48,v48,v49
v_cvt_pk_bf16_f32 v49,v50,v51
v_mfma_f32_16x16x32_bf16 v[20:23],a[196:199],v[132:135],v[20:23]
v_cvt_pk_bf16_f32 v50,v56,v57
v_cvt_pk_bf16_f32 v51,v58,v59
buffer_store_dwordx4 v[48:51],v248,s[20:23],s62 offen sc0 sc1
v_mfma_f32_16x16x32_bf16 v[20:23],a[200:203],v[136:139],v[20:23]
ds_read_b64_tr_b16 a[236:237],v246 offset:61440
ds_read_b64_tr_b16 a[238:239],v246 offset:63488
v_cvt_pk_bf16_f32 v52,v52,v53
v_cvt_pk_bf16_f32 v53,v54,v55
v_mfma_f32_16x16x32_bf16 v[20:23],a[204:207],v[140:143],v[20:23]
v_cvt_pk_bf16_f32 v54,v60,v61
v_cvt_pk_bf16_f32 v55,v62,v63
buffer_store_dwordx4 v[52:55],v248,s[20:23],s63 offen sc0 sc1
v_mfma_f32_16x16x32_bf16 v[24:27],a[208:211],v[112:115],0
ds_read_b64_tr_b16 a[240:241],v247 offset:49152
ds_read_b64_tr_b16 a[242:243],v247 offset:51200
s_waitcnt lgkmcnt(8)
v_mfma_f32_16x16x32_bf16 v[24:27],a[212:215],v[116:119],v[24:27]
v_mfma_f32_16x16x32_bf16 v[24:27],a[216:219],v[120:123],v[24:27]
ds_read_b64_tr_b16 a[244:245],v247 offset:53248
ds_read_b64_tr_b16 a[246:247],v247 offset:55296
v_mfma_f32_16x16x32_bf16 v[24:27],a[220:223],v[124:127],v[24:27]
v_mfma_f32_16x16x32_bf16 v[28:31],a[208:211],v[128:131],0
ds_read_b64_tr_b16 a[248:249],v247 offset:57344
ds_read_b64_tr_b16 a[250:251],v247 offset:59392
v_mfma_f32_16x16x32_bf16 v[28:31],a[212:215],v[132:135],v[28:31]
v_mfma_f32_16x16x32_bf16 v[28:31],a[216:219],v[136:139],v[28:31]
ds_read_b64_tr_b16 a[252:253],v247 offset:61440
ds_read_b64_tr_b16 a[254:255],v247 offset:63488
v_mfma_f32_16x16x32_bf16 v[28:31],a[220:223],v[140:143],v[28:31]
v_mfma_f32_16x16x32_bf16 v[32:35],a[224:227],v[112:115],0
ds_read_b64_tr_b16 a[192:193],v240 offset:0
ds_read_b64_tr_b16 a[194:195],v240 offset:2048
s_waitcnt lgkmcnt(8)
v_mfma_f32_16x16x32_bf16 v[32:35],a[228:231],v[116:119],v[32:35]
v_mfma_f32_16x16x32_bf16 v[32:35],a[232:235],v[120:123],v[32:35]
ds_read_b64_tr_b16 a[196:197],v240 offset:4096
ds_read_b64_tr_b16 a[198:199],v240 offset:6144
v_mfma_f32_16x16x32_bf16 v[32:35],a[236:239],v[124:127],v[32:35]
v_mfma_f32_16x16x32_bf16 v[36:39],a[224:227],v[128:131],0
ds_read_b64_tr_b16 a[200:201],v240 offset:8192
ds_read_b64_tr_b16 a[202:203],v240 offset:10240
v_mfma_f32_16x16x32_bf16 v[36:39],a[228:231],v[132:135],v[36:39]
v_mfma_f32_16x16x32_bf16 v[36:39],a[232:235],v[136:139],v[36:39]
ds_read_b64_tr_b16 a[204:205],v240 offset:12288
ds_read_b64_tr_b16 a[206:207],v240 offset:14336
v_mfma_f32_16x16x32_bf16 v[36:39],a[236:239],v[140:143],v[36:39]
v_mfma_f32_16x16x32_bf16 v[40:43],a[240:243],v[112:115],0
ds_read_b64_tr_b16 a[208:209],v241 offset:0
ds_read_b64_tr_b16 a[210:211],v241 offset:2048
s_waitcnt lgkmcnt(10)
v_mfma_f32_16x16x32_bf16 v[40:43],a[244:247],v[116:119],v[40:43]
v_mfma_f32_16x16x32_bf16 v[40:43],a[248:251],v[120:123],v[40:43]
ds_read_b64_tr_b16 a[212:213],v241 offset:4096
ds_read_b64_tr_b16 a[214:215],v241 offset:6144
v_mfma_f32_16x16x32_bf16 v[40:43],a[252:255],v[124:127],v[40:43]
v_mfma_f32_16x16x32_bf16 v[44:47],a[240:243],v[128:131],0
ds_read_b64_tr_b16 a[216:217],v241 offset:8192
ds_read_b64_tr_b16 a[218:219],v241 offset:10240
v_mfma_f32_16x16x32_bf16 v[44:47],a[244:247],v[132:135],v[44:47]
v_mfma_f32_16x16x32_bf16 v[44:47],a[248:251],v[136:139],v[44:47]
ds_read_b64_tr_b16 a[220:221],v241 offset:12288
ds_read_b64_tr_b16 a[222:223],v241 offset:14336
v_mfma_f32_16x16x32_bf16 v[44:47],a[252:255],v[140:143],v[44:47]
s_waitcnt lgkmcnt(6)
v_mfma_f32_16x16x32_bf16 v[16:19],a[192:195],v[160:163],v[16:19]
ds_read_b64_tr_b16 a[224:225],v242 offset:0
ds_read_b64_tr_b16 a[226:227],v242 offset:2048
v_mfma_f32_16x16x32_bf16 v[16:19],a[196:199],v[164:167],v[16:19]
v_mfma_f32_16x16x32_bf16 v[16:19],a[200:203],v[168:171],v[16:19]
ds_read_b64_tr_b16 a[228:229],v242 offset:4096
ds_read_b64_tr_b16 a[230:231],v242 offset:6144
v_mfma_f32_16x16x32_bf16 v[16:19],a[204:207],v[172:175],v[16:19]
v_mfma_f32_16x16x32_bf16 v[20:23],a[192:195],v[176:179],v[20:23]
v_cvt_pk_bf16_f32 v64,v64,v65
v_cvt_pk_bf16_f32 v65,v66,v67
v_cvt_pk_bf16_f32 v66,v72,v73
v_cvt_pk_bf16_f32 v67,v74,v75
v_mfma_f32_16x16x32_bf16 v[20:23],a[196:199],v[180:183],v[20:23]
ds_read_b64_tr_b16 a[232:233],v242 offset:8192
ds_read_b64_tr_b16 a[234:235],v242 offset:10240
buffer_store_dwordx4 v[64:67],v249,s[20:23],s62 offen sc0 sc1
v_mfma_f32_16x16x32_bf16 v[20:23],a[200:203],v[184:187],v[20:23]
s_add_u32 s62,s62,32768
v_cvt_pk_bf16_f32 v68,v68,v69
v_cvt_pk_bf16_f32 v69,v70,v71
v_cvt_pk_bf16_f32 v70,v76,v77
v_mfma_f32_16x16x32_bf16 v[20:23],a[204:207],v[188:191],v[20:23]
v_cvt_pk_bf16_f32 v71,v78,v79
buffer_store_dwordx4 v[68:71],v249,s[20:23],s63 offen sc0 sc1
s_add_u32 s63,s63,32768
v_mfma_f32_16x16x32_bf16 v[24:27],a[208:211],v[160:163],v[24:27]
ds_read_b64_tr_b16 a[236:237],v242 offset:12288
ds_read_b64_tr_b16 a[238:239],v242 offset:14336
s_waitcnt lgkmcnt(6)
v_mfma_f32_16x16x32_bf16 v[24:27],a[212:215],v[164:167],v[24:27]
v_mfma_f32_16x16x32_bf16 v[24:27],a[216:219],v[168:171],v[24:27]
v_mfma_f32_16x16x32_bf16 v[24:27],a[220:223],v[172:175],v[24:27]
ds_read_b64_tr_b16 a[240:241],v243 offset:0
ds_read_b64_tr_b16 a[242:243],v243 offset:2048
v_mfma_f32_16x16x32_bf16 v[28:31],a[208:211],v[176:179],v[28:31]
v_mfma_f32_16x16x32_bf16 v[28:31],a[212:215],v[180:183],v[28:31]
ds_read_b64_tr_b16 a[244:245],v243 offset:4096
ds_read_b64_tr_b16 a[246:247],v243 offset:6144
v_mfma_f32_16x16x32_bf16 v[28:31],a[216:219],v[184:187],v[28:31]
v_mfma_f32_16x16x32_bf16 v[28:31],a[220:223],v[188:191],v[28:31]
v_mfma_f32_16x16x32_bf16 v[32:35],a[224:227],v[160:163],v[32:35]
ds_read_b64_tr_b16 a[248:249],v243 offset:8192
ds_read_b64_tr_b16 a[250:251],v243 offset:10240
s_waitcnt lgkmcnt(6)
v_mfma_f32_16x16x32_bf16 v[32:35],a[228:231],v[164:167],v[32:35]
v_mfma_f32_16x16x32_bf16 v[32:35],a[232:235],v[168:171],v[32:35]
v_mfma_f32_16x16x32_bf16 v[32:35],a[236:239],v[172:175],v[32:35]
ds_read_b64_tr_b16 a[252:253],v243 offset:12288
ds_read_b64_tr_b16 a[254:255],v243 offset:14336
v_mfma_f32_16x16x32_bf16 v[36:39],a[224:227],v[176:179],v[36:39]
v_mfma_f32_16x16x32_bf16 v[36:39],a[228:231],v[180:183],v[36:39]
v_mfma_f32_16x16x32_bf16 v[36:39],a[232:235],v[184:187],v[36:39]
v_mfma_f32_16x16x32_bf16 v[36:39],a[236:239],v[188:191],v[36:39]
s_waitcnt lgkmcnt(2)
v_mfma_f32_16x16x32_bf16 v[40:43],a[240:243],v[160:163],v[40:43]
v_mfma_f32_16x16x32_bf16 v[40:43],a[244:247],v[164:167],v[40:43]
v_mfma_f32_16x16x32_bf16 v[40:43],a[248:251],v[168:171],v[40:43]
s_waitcnt lgkmcnt(0)
v_mfma_f32_16x16x32_bf16 v[40:43],a[252:255],v[172:175],v[40:43]
v_mfma_f32_16x16x32_bf16 v[44:47],a[240:243],v[176:179],v[44:47]
v_mfma_f32_16x16x32_bf16 v[44:47],a[244:247],v[180:183],v[44:47]
v_mfma_f32_16x16x32_bf16 v[44:47],a[248:251],v[184:187],v[44:47]
v_mfma_f32_16x16x32_bf16 v[44:47],a[252:255],v[188:191],v[44:47]
s_nop 5
v_cvt_pk_bf16_f32 v16,v16,v17
v_cvt_pk_bf16_f32 v17,v18,v19
v_cvt_pk_bf16_f32 v18,v24,v25
v_cvt_pk_bf16_f32 v19,v26,v27
buffer_store_dwordx4 v[16:19],v248,s[20:23],s62 offen sc0 sc1
v_cvt_pk_bf16_f32 v20,v20,v21
v_cvt_pk_bf16_f32 v21,v22,v23
v_cvt_pk_bf16_f32 v22,v28,v29
v_cvt_pk_bf16_f32 v23,v30,v31
buffer_store_dwordx4 v[20:23],v248,s[20:23],s63 offen sc0 sc1
v_cvt_pk_bf16_f32 v32,v32,v33
v_cvt_pk_bf16_f32 v33,v34,v35
v_cvt_pk_bf16_f32 v34,v40,v41
v_cvt_pk_bf16_f32 v35,v42,v43
buffer_store_dwordx4 v[32:35],v249,s[20:23],s62 offen sc0 sc1
s_add_u32 s62,s62,32768
v_cvt_pk_bf16_f32 v36,v36,v37
v_cvt_pk_bf16_f32 v37,v38,v39
v_cvt_pk_bf16_f32 v38,v44,v45
v_cvt_pk_bf16_f32 v39,v46,v47
buffer_store_dwordx4 v[36:39],v249,s[20:23],s63 offen sc0 sc1
s_add_u32 s63,s63,32768
s_endpgm
FALLBACK_B2:
s_waitcnt vmcnt(0) lgkmcnt(0)
s_mov_b32 s30,1
s_mov_b32 s65,0
v_mov_b32 v168,0xff800000
v_mov_b32 v169,0xff800000
FBLOOP_B2:
s_barrier
s_mov_b32 m0,s25
s_add_u32 s28,s25,s65
buffer_load_dwordx4 v12,s[4:7],s28 offen lds
buffer_load_dwordx4 v13,s[4:7],s28 offen offset:1024 lds
buffer_load_dwordx4 v14,s[4:7],s28 offen offset:2048 lds
buffer_load_dwordx4 v15,s[4:7],s28 offen offset:3072 lds
s_waitcnt vmcnt(0)
s_barrier
ds_read_b128 a[192:195],v0 offset:0
ds_read_b128 a[196:199],v1 offset:0
ds_read_b128 a[200:203],v2 offset:0
ds_read_b128 a[204:207],v3 offset:0
ds_read_b128 a[208:211],v0 offset:256
ds_read_b128 a[212:215],v1 offset:256
ds_read_b128 a[216:219],v2 offset:256
ds_read_b128 a[220:223],v3 offset:256
ds_read_b128 a[224:227],v0 offset:8192
ds_read_b128 a[228:231],v1 offset:8192
ds_read_b128 a[232:235],v2 offset:8192
ds_read_b128 a[236:239],v3 offset:8192
ds_read_b128 a[240:243],v0 offset:8448
ds_read_b128 a[244:247],v1 offset:8448
ds_read_b128 a[248:251],v2 offset:8448
ds_read_b128 a[252:255],v3 offset:8448
s_waitcnt lgkmcnt(0)
v_mfma_f32_16x16x32_bf16 v[112:115],a[192:195],v[16:19],0
v_mfma_f32_16x16x32_bf16 v[112:115],a[196:199],v[20:23],v[112:115]
v_mfma_f32_16x16x32_bf16 v[112:115],a[200:203],v[24:27],v[112:115]
v_mfma_f32_16x16x32_bf16 v[112:115],a[204:207],v[28:31],v[112:115]
v_mfma_f32_16x16x32_bf16 v[112:115],a[208:211],v[32:35],v[112:115]
v_mfma_f32_16x16x32_bf16 v[112:115],a[212:215],v[36:39],v[112:115]
v_mfma_f32_16x16x32_bf16 v[112:115],a[216:219],v[40:43],v[112:115]
v_mfma_f32_16x16x32_bf16 v[112:115],a[220:223],v[44:47],v[112:115]
v_mfma_f32_16x16x32_bf16 v[128:131],a[192:195],v[48:51],0
v_mfma_f32_16x16x32_bf16 v[128:131],a[196:199],v[52:55],v[128:131]
v_mfma_f32_16x16x32_bf16 v[128:131],a[200:203],v[56:59],v[128:131]
v_mfma_f32_16x16x32_bf16 v[128:131],a[204:207],v[60:63],v[128:131]
v_mfma_f32_16x16x32_bf16 v[128:131],a[208:211],v[64:67],v[128:131]
v_mfma_f32_16x16x32_bf16 v[128:131],a[212:215],v[68:71],v[128:131]
v_mfma_f32_16x16x32_bf16 v[128:131],a[216:219],v[72:75],v[128:131]
v_mfma_f32_16x16x32_bf16 v[128:131],a[220:223],v[76:79],v[128:131]
v_mfma_f32_16x16x32_bf16 v[116:119],a[224:227],v[16:19],0
v_mfma_f32_16x16x32_bf16 v[116:119],a[228:231],v[20:23],v[116:119]
v_mfma_f32_16x16x32_bf16 v[116:119],a[232:235],v[24:27],v[116:119]
v_mfma_f32_16x16x32_bf16 v[116:119],a[236:239],v[28:31],v[116:119]
v_mfma_f32_16x16x32_bf16 v[116:119],a[240:243],v[32:35],v[116:119]
v_mfma_f32_16x16x32_bf16 v[116:119],a[244:247],v[36:39],v[116:119]
v_mfma_f32_16x16x32_bf16 v[116:119],a[248:251],v[40:43],v[116:119]
v_mfma_f32_16x16x32_bf16 v[116:119],a[252:255],v[44:47],v[116:119]
v_mfma_f32_16x16x32_bf16 v[132:135],a[224:227],v[48:51],0
v_mfma_f32_16x16x32_bf16 v[132:135],a[228:231],v[52:55],v[132:135]
v_mfma_f32_16x16x32_bf16 v[132:135],a[232:235],v[56:59],v[132:135]
v_mfma_f32_16x16x32_bf16 v[132:135],a[236:239],v[60:63],v[132:135]
v_mfma_f32_16x16x32_bf16 v[132:135],a[240:243],v[64:67],v[132:135]
v_mfma_f32_16x16x32_bf16 v[132:135],a[244:247],v[68:71],v[132:135]
v_mfma_f32_16x16x32_bf16 v[132:135],a[248:251],v[72:75],v[132:135]
v_mfma_f32_16x16x32_bf16 v[132:135],a[252:255],v[76:79],v[132:135]
s_nop 7
v_max3_f32 v168,v168,v112,v113
v_max3_f32 v168,v168,v114,v115
v_max3_f32 v168,v168,v116,v117
v_max3_f32 v168,v168,v118,v119
v_max3_f32 v169,v169,v128,v129
v_max3_f32 v169,v169,v130,v131
v_max3_f32 v169,v169,v132,v133
v_max3_f32 v169,v169,v134,v135
s_add_u32 s65,s65,16384
s_cmp_lt_u32 s65,1048576
s_cbranch_scc1 FBLOOP_B2
v_mov_b32 v172,v168
v_mov_b32 v173,v169
s_nop 1
v_permlane32_swap_b32 v168,v172
v_permlane32_swap_b32 v169,v173
s_nop 1
v_max_f32 v168,v168,v172
v_max_f32 v169,v169,v173
v_mov_b32 v172,v168
v_mov_b32 v173,v169
s_nop 1
v_permlane16_swap_b32 v168,v172
v_permlane16_swap_b32 v169,v173
s_nop 1
v_max_f32 v168,v168,v172
v_max_f32 v169,v169,v173
v_sub_f32 v208,0,v168
v_sub_f32 v212,0,v169
s_barrier
s_mov_b32 m0,12288
s_mov_b32 s28,12288
buffer_load_dwordx4 v12,s[4:7],s28 offen nt lds
buffer_load_dwordx4 v13,s[4:7],s28 offen offset:1024 nt lds
buffer_load_dwordx4 v14,s[4:7],s28 offen offset:2048 nt lds
buffer_load_dwordx4 v15,s[4:7],s28 offen offset:3072 nt lds
s_mov_b32 m0,28672
s_mov_b32 s28,28672
buffer_load_dwordx4 v12,s[4:7],s28 offen nt lds
buffer_load_dwordx4 v13,s[4:7],s28 offen offset:1024 nt lds
buffer_load_dwordx4 v14,s[4:7],s28 offen offset:2048 nt lds
buffer_load_dwordx4 v15,s[4:7],s28 offen offset:3072 nt lds
s_mov_b32 m0,45056
s_mov_b32 s28,45056
buffer_load_dwordx4 v12,s[4:7],s28 offen nt lds
buffer_load_dwordx4 v13,s[4:7],s28 offen offset:1024 nt lds
buffer_load_dwordx4 v14,s[4:7],s28 offen offset:2048 nt lds
buffer_load_dwordx4 v15,s[4:7],s28 offen offset:3072 nt lds
s_mov_b32 m0,61440
s_mov_b32 s28,61440
buffer_load_dwordx4 v12,s[4:7],s28 offen nt lds
buffer_load_dwordx4 v13,s[4:7],s28 offen offset:1024 nt lds
buffer_load_dwordx4 v14,s[4:7],s28 offen offset:2048 nt lds
buffer_load_dwordx4 v15,s[4:7],s28 offen offset:3072 nt lds
s_mov_b32 m0,77824
s_mov_b32 s28,12288
buffer_load_dwordx4 v12,s[8:11],s28 offen nt lds
buffer_load_dwordx4 v13,s[8:11],s28 offen offset:1024 nt lds
buffer_load_dwordx4 v14,s[8:11],s28 offen offset:2048 nt lds
buffer_load_dwordx4 v15,s[8:11],s28 offen offset:3072 nt lds
s_mov_b32 m0,81920
s_mov_b32 s28,16384
buffer_load_dwordx4 v12,s[8:11],s28 offen nt lds
buffer_load_dwordx4 v13,s[8:11],s28 offen offset:1024 nt lds
buffer_load_dwordx4 v14,s[8:11],s28 offen offset:2048 nt lds
buffer_load_dwordx4 v15,s[8:11],s28 offen offset:3072 nt lds
s_mov_b32 m0,86016
s_mov_b32 s28,20480
buffer_load_dwordx4 v12,s[8:11],s28 offen nt lds
buffer_load_dwordx4 v13,s[8:11],s28 offen offset:1024 nt lds
buffer_load_dwordx4 v14,s[8:11],s28 offen offset:2048 nt lds
buffer_load_dwordx4 v15,s[8:11],s28 offen offset:3072 nt lds
s_mov_b32 m0,90112
s_mov_b32 s28,24576
buffer_load_dwordx4 v12,s[8:11],s28 offen nt lds
buffer_load_dwordx4 v13,s[8:11],s28 offen offset:1024 nt lds
buffer_load_dwordx4 v14,s[8:11],s28 offen offset:2048 nt lds
buffer_load_dwordx4 v15,s[8:11],s28 offen offset:3072 nt lds
s_mov_b32 m0,94208
s_mov_b32 s28,28672
buffer_load_dwordx4 v12,s[8:11],s28 offen nt lds
buffer_load_dwordx4 v13,s[8:11],s28 offen offset:1024 nt lds
buffer_load_dwordx4 v14,s[8:11],s28 offen offset:2048 nt lds
buffer_load_dwordx4 v15,s[8:11],s28 offen offset:3072 nt lds
s_waitcnt vmcnt(0)
s_barrier
ds_read_b128 a[192:195],v0 offset:0
ds_read_b128 a[196:199],v1 offset:0
ds_read_b128 a[200:203],v2 offset:0
ds_read_b128 a[204:207],v3 offset:0
ds_read_b128 a[208:211],v0 offset:256
ds_read_b128 a[212:215],v1 offset:256
ds_read_b128 a[216:219],v2 offset:256
ds_read_b128 a[220:223],v3 offset:256
s_branch PRE_B2
.globl oproj_kernel
.p2align 8
.type oproj_kernel,@function
oproj_kernel:
s_cmp_ge_u32 s2,247
s_cbranch_scc1 K2_END
s_load_dwordx2 s[38:39],s[0:1],80
s_load_dwordx2 s[40:41],s[0:1],96
v_lshrrev_b32 v1,6,v0
v_and_b32 v0,63,v0
v_readfirstlane_b32 s24,v1
v_lshlrev_b32 v2,4,v0
v_add_u32 v3,4096,v2
v_add_u32 v4,8192,v2
v_add_u32 v5,12288,v2
v_and_b32 v6,15,v0
v_lshrrev_b32 v7,4,v0
v_lshlrev_b32 v8,2,v6
v_add_u32 v9,4096,v8
v_add_u32 v10,8192,v8
v_add_u32 v11,12288,v8
v_mul_u32_u24 v12,0x700,v6
v_lshl_add_u32 v12,v7,3,v12
s_mul_i32 s25,s2,10
s_add_u32 s25,s25,s24
s_cmp_ge_u32 s25,2464
s_cbranch_scc1 K2_END
s_mul_i32 s26,s25,6809
s_lshr_b32 s26,s26,20
s_mul_i32 s27,s26,154
s_sub_u32 s27,s25,s27
s_mul_i32 s28,s27,147
s_lshr_b32 s28,s28,11
s_mul_i32 s29,s28,14
s_sub_u32 s29,s27,s29
s_mul_i32 s30,s26,2523136
s_mul_i32 s31,s28,229376
s_add_u32 s30,s30,s31
s_mul_i32 s31,s29,16384
s_add_u32 s30,s30,s31
s_mov_b32 s44,0
s_mov_b32 s45,1024
s_mov_b32 s46,2048
s_mov_b32 s47,3072
s_mov_b32 s48,4096
s_mov_b32 s49,5120
s_mov_b32 s50,6144
s_mov_b32 s51,7168
s_mov_b32 s52,8192
s_mov_b32 s53,9216
s_mov_b32 s54,10240
s_mov_b32 s55,11264
s_mov_b32 s56,12288
s_mov_b32 s57,13312
s_mov_b32 s58,14336
s_mov_b32 s59,15360
s_lshl_b32 s31,s26,14
s_lshl_b32 s32,s28,6
s_add_u32 s31,s31,s32
s_add_u32 s31,s31,50331648
s_and_b32 s33,s26,7
s_mul_i32 s33,s33,11
s_add_u32 s33,s33,s28
s_mul_i32 s33,s33,28672
s_lshr_b32 s34,s26,3
s_mul_i32 s34,s34,896
s_add_u32 s33,s33,s34
s_lshl_b32 s34,s29,6
s_add_u32 s33,s33,s34
s_mov_b32 s6,16384
s_mov_b32 s7,0x20000
s_mov_b32 s10,16384
s_mov_b32 s11,0x20000
s_sub_u32 s14,2523136,s33
s_mov_b32 s15,0x20000
s_waitcnt lgkmcnt(0)
s_add_u32 s4,s40,s30
s_addc_u32 s5,s41,0
s_add_u32 s8,s40,s31
s_addc_u32 s9,s41,0
s_add_u32 s12,s38,s33
s_addc_u32 s13,s39,0
buffer_load_dwordx4 v[48:51],v2,s[4:7],s44 offen
buffer_load_dword v16,v8,s[8:11],0 offen offset:0
buffer_load_dwordx4 v[52:55],v2,s[4:7],s45 offen
buffer_load_dword v17,v8,s[8:11],0 offen offset:1024
buffer_load_dwordx4 v[56:59],v2,s[4:7],s46 offen
buffer_load_dword v18,v8,s[8:11],0 offen offset:2048
buffer_load_dwordx4 v[60:63],v2,s[4:7],s47 offen
buffer_load_dword v19,v8,s[8:11],0 offen offset:3072
buffer_load_dwordx4 v[64:67],v2,s[4:7],s48 offen
buffer_load_dword v20,v9,s[8:11],0 offen offset:0
buffer_load_dwordx4 v[68:71],v2,s[4:7],s49 offen
buffer_load_dword v21,v9,s[8:11],0 offen offset:1024
buffer_load_dwordx4 v[72:75],v2,s[4:7],s50 offen
buffer_load_dword v22,v9,s[8:11],0 offen offset:2048
buffer_load_dwordx4 v[76:79],v2,s[4:7],s51 offen
buffer_load_dword v23,v9,s[8:11],0 offen offset:3072
buffer_load_dwordx4 v[80:83],v2,s[4:7],s52 offen
buffer_load_dword v24,v10,s[8:11],0 offen offset:0
buffer_load_dwordx4 v[84:87],v2,s[4:7],s53 offen
buffer_load_dword v25,v10,s[8:11],0 offen offset:1024
buffer_load_dwordx4 v[88:91],v2,s[4:7],s54 offen
buffer_load_dword v26,v10,s[8:11],0 offen offset:2048
buffer_load_dwordx4 v[92:95],v2,s[4:7],s55 offen
buffer_load_dword v27,v10,s[8:11],0 offen offset:3072
buffer_load_dwordx4 v[96:99],v2,s[4:7],s56 offen
buffer_load_dword v28,v11,s[8:11],0 offen offset:0
buffer_load_dwordx4 v[100:103],v2,s[4:7],s57 offen
buffer_load_dword v29,v11,s[8:11],0 offen offset:1024
buffer_load_dwordx4 v[104:107],v2,s[4:7],s58 offen
buffer_load_dword v30,v11,s[8:11],0 offen offset:2048
buffer_load_dwordx4 v[108:111],v2,s[4:7],s59 offen
buffer_load_dword v31,v11,s[8:11],0 offen offset:3072
s_mov_b32 s35,0xffff0000
s_waitcnt vmcnt(30)
v_lshlrev_b32 v40,16,v48
v_and_b32 v48,s35,v48
v_lshlrev_b32 v41,16,v49
v_and_b32 v49,s35,v49
v_lshlrev_b32 v42,16,v50
v_and_b32 v50,s35,v50
v_lshlrev_b32 v43,16,v51
v_and_b32 v51,s35,v51
v_mul_f32 v32,v40,v16
v_mul_f32 v33,v48,v16
v_mul_f32 v34,v41,v16
v_mul_f32 v35,v49,v16
v_mul_f32 v36,v42,v16
v_mul_f32 v37,v50,v16
v_mul_f32 v38,v43,v16
v_mul_f32 v39,v51,v16
s_waitcnt vmcnt(28)
v_lshlrev_b32 v40,16,v52
v_and_b32 v52,s35,v52
v_lshlrev_b32 v41,16,v53
v_and_b32 v53,s35,v53
v_lshlrev_b32 v42,16,v54
v_and_b32 v54,s35,v54
v_lshlrev_b32 v43,16,v55
v_and_b32 v55,s35,v55
v_fmac_f32 v32,v40,v17
v_fmac_f32 v33,v52,v17
v_fmac_f32 v34,v41,v17
v_fmac_f32 v35,v53,v17
v_fmac_f32 v36,v42,v17
v_fmac_f32 v37,v54,v17
v_fmac_f32 v38,v43,v17
v_fmac_f32 v39,v55,v17
s_waitcnt vmcnt(26)
v_lshlrev_b32 v40,16,v56
v_and_b32 v56,s35,v56
v_lshlrev_b32 v41,16,v57
v_and_b32 v57,s35,v57
v_lshlrev_b32 v42,16,v58
v_and_b32 v58,s35,v58
v_lshlrev_b32 v43,16,v59
v_and_b32 v59,s35,v59
v_fmac_f32 v32,v40,v18
v_fmac_f32 v33,v56,v18
v_fmac_f32 v34,v41,v18
v_fmac_f32 v35,v57,v18
v_fmac_f32 v36,v42,v18
v_fmac_f32 v37,v58,v18
v_fmac_f32 v38,v43,v18
v_fmac_f32 v39,v59,v18
s_waitcnt vmcnt(24)
v_lshlrev_b32 v40,16,v60
v_and_b32 v60,s35,v60
v_lshlrev_b32 v41,16,v61
v_and_b32 v61,s35,v61
v_lshlrev_b32 v42,16,v62
v_and_b32 v62,s35,v62
v_lshlrev_b32 v43,16,v63
v_and_b32 v63,s35,v63
v_fmac_f32 v32,v40,v19
v_fmac_f32 v33,v60,v19
v_fmac_f32 v34,v41,v19
v_fmac_f32 v35,v61,v19
v_fmac_f32 v36,v42,v19
v_fmac_f32 v37,v62,v19
v_fmac_f32 v38,v43,v19
v_fmac_f32 v39,v63,v19
s_waitcnt vmcnt(22)
v_lshlrev_b32 v40,16,v64
v_and_b32 v64,s35,v64
v_lshlrev_b32 v41,16,v65
v_and_b32 v65,s35,v65
v_lshlrev_b32 v42,16,v66
v_and_b32 v66,s35,v66
v_lshlrev_b32 v43,16,v67
v_and_b32 v67,s35,v67
v_fmac_f32 v32,v40,v20
v_fmac_f32 v33,v64,v20
v_fmac_f32 v34,v41,v20
v_fmac_f32 v35,v65,v20
v_fmac_f32 v36,v42,v20
v_fmac_f32 v37,v66,v20
v_fmac_f32 v38,v43,v20
v_fmac_f32 v39,v67,v20
s_waitcnt vmcnt(20)
v_lshlrev_b32 v40,16,v68
v_and_b32 v68,s35,v68
v_lshlrev_b32 v41,16,v69
v_and_b32 v69,s35,v69
v_lshlrev_b32 v42,16,v70
v_and_b32 v70,s35,v70
v_lshlrev_b32 v43,16,v71
v_and_b32 v71,s35,v71
v_fmac_f32 v32,v40,v21
v_fmac_f32 v33,v68,v21
v_fmac_f32 v34,v41,v21
v_fmac_f32 v35,v69,v21
v_fmac_f32 v36,v42,v21
v_fmac_f32 v37,v70,v21
v_fmac_f32 v38,v43,v21
v_fmac_f32 v39,v71,v21
s_waitcnt vmcnt(18)
v_lshlrev_b32 v40,16,v72
v_and_b32 v72,s35,v72
v_lshlrev_b32 v41,16,v73
v_and_b32 v73,s35,v73
v_lshlrev_b32 v42,16,v74
v_and_b32 v74,s35,v74
v_lshlrev_b32 v43,16,v75
v_and_b32 v75,s35,v75
v_fmac_f32 v32,v40,v22
v_fmac_f32 v33,v72,v22
v_fmac_f32 v34,v41,v22
v_fmac_f32 v35,v73,v22
v_fmac_f32 v36,v42,v22
v_fmac_f32 v37,v74,v22
v_fmac_f32 v38,v43,v22
v_fmac_f32 v39,v75,v22
s_waitcnt vmcnt(16)
v_lshlrev_b32 v40,16,v76
v_and_b32 v76,s35,v76
v_lshlrev_b32 v41,16,v77
v_and_b32 v77,s35,v77
v_lshlrev_b32 v42,16,v78
v_and_b32 v78,s35,v78
v_lshlrev_b32 v43,16,v79
v_and_b32 v79,s35,v79
v_fmac_f32 v32,v40,v23
v_fmac_f32 v33,v76,v23
v_fmac_f32 v34,v41,v23
v_fmac_f32 v35,v77,v23
v_fmac_f32 v36,v42,v23
v_fmac_f32 v37,v78,v23
v_fmac_f32 v38,v43,v23
v_fmac_f32 v39,v79,v23
s_waitcnt vmcnt(14)
v_lshlrev_b32 v40,16,v80
v_and_b32 v80,s35,v80
v_lshlrev_b32 v41,16,v81
v_and_b32 v81,s35,v81
v_lshlrev_b32 v42,16,v82
v_and_b32 v82,s35,v82
v_lshlrev_b32 v43,16,v83
v_and_b32 v83,s35,v83
v_fmac_f32 v32,v40,v24
v_fmac_f32 v33,v80,v24
v_fmac_f32 v34,v41,v24
v_fmac_f32 v35,v81,v24
v_fmac_f32 v36,v42,v24
v_fmac_f32 v37,v82,v24
v_fmac_f32 v38,v43,v24
v_fmac_f32 v39,v83,v24
s_waitcnt vmcnt(12)
v_lshlrev_b32 v40,16,v84
v_and_b32 v84,s35,v84
v_lshlrev_b32 v41,16,v85
v_and_b32 v85,s35,v85
v_lshlrev_b32 v42,16,v86
v_and_b32 v86,s35,v86
v_lshlrev_b32 v43,16,v87
v_and_b32 v87,s35,v87
v_fmac_f32 v32,v40,v25
v_fmac_f32 v33,v84,v25
v_fmac_f32 v34,v41,v25
v_fmac_f32 v35,v85,v25
v_fmac_f32 v36,v42,v25
v_fmac_f32 v37,v86,v25
v_fmac_f32 v38,v43,v25
v_fmac_f32 v39,v87,v25
s_waitcnt vmcnt(10)
v_lshlrev_b32 v40,16,v88
v_and_b32 v88,s35,v88
v_lshlrev_b32 v41,16,v89
v_and_b32 v89,s35,v89
v_lshlrev_b32 v42,16,v90
v_and_b32 v90,s35,v90
v_lshlrev_b32 v43,16,v91
v_and_b32 v91,s35,v91
v_fmac_f32 v32,v40,v26
v_fmac_f32 v33,v88,v26
v_fmac_f32 v34,v41,v26
v_fmac_f32 v35,v89,v26
v_fmac_f32 v36,v42,v26
v_fmac_f32 v37,v90,v26
v_fmac_f32 v38,v43,v26
v_fmac_f32 v39,v91,v26
s_waitcnt vmcnt(8)
v_lshlrev_b32 v40,16,v92
v_and_b32 v92,s35,v92
v_lshlrev_b32 v41,16,v93
v_and_b32 v93,s35,v93
v_lshlrev_b32 v42,16,v94
v_and_b32 v94,s35,v94
v_lshlrev_b32 v43,16,v95
v_and_b32 v95,s35,v95
v_fmac_f32 v32,v40,v27
v_fmac_f32 v33,v92,v27
v_fmac_f32 v34,v41,v27
v_fmac_f32 v35,v93,v27
v_fmac_f32 v36,v42,v27
v_fmac_f32 v37,v94,v27
v_fmac_f32 v38,v43,v27
v_fmac_f32 v39,v95,v27
s_waitcnt vmcnt(6)
v_lshlrev_b32 v40,16,v96
v_and_b32 v96,s35,v96
v_lshlrev_b32 v41,16,v97
v_and_b32 v97,s35,v97
v_lshlrev_b32 v42,16,v98
v_and_b32 v98,s35,v98
v_lshlrev_b32 v43,16,v99
v_and_b32 v99,s35,v99
v_fmac_f32 v32,v40,v28
v_fmac_f32 v33,v96,v28
v_fmac_f32 v34,v41,v28
v_fmac_f32 v35,v97,v28
v_fmac_f32 v36,v42,v28
v_fmac_f32 v37,v98,v28
v_fmac_f32 v38,v43,v28
v_fmac_f32 v39,v99,v28
s_waitcnt vmcnt(4)
v_lshlrev_b32 v40,16,v100
v_and_b32 v100,s35,v100
v_lshlrev_b32 v41,16,v101
v_and_b32 v101,s35,v101
v_lshlrev_b32 v42,16,v102
v_and_b32 v102,s35,v102
v_lshlrev_b32 v43,16,v103
v_and_b32 v103,s35,v103
v_fmac_f32 v32,v40,v29
v_fmac_f32 v33,v100,v29
v_fmac_f32 v34,v41,v29
v_fmac_f32 v35,v101,v29
v_fmac_f32 v36,v42,v29
v_fmac_f32 v37,v102,v29
v_fmac_f32 v38,v43,v29
v_fmac_f32 v39,v103,v29
s_waitcnt vmcnt(2)
v_lshlrev_b32 v40,16,v104
v_and_b32 v104,s35,v104
v_lshlrev_b32 v41,16,v105
v_and_b32 v105,s35,v105
v_lshlrev_b32 v42,16,v106
v_and_b32 v106,s35,v106
v_lshlrev_b32 v43,16,v107
v_and_b32 v107,s35,v107
v_fmac_f32 v32,v40,v30
v_fmac_f32 v33,v104,v30
v_fmac_f32 v34,v41,v30
v_fmac_f32 v35,v105,v30
v_fmac_f32 v36,v42,v30
v_fmac_f32 v37,v106,v30
v_fmac_f32 v38,v43,v30
v_fmac_f32 v39,v107,v30
s_waitcnt vmcnt(0)
v_lshlrev_b32 v40,16,v108
v_and_b32 v108,s35,v108
v_lshlrev_b32 v41,16,v109
v_and_b32 v109,s35,v109
v_lshlrev_b32 v42,16,v110
v_and_b32 v110,s35,v110
v_lshlrev_b32 v43,16,v111
v_and_b32 v111,s35,v111
v_fmac_f32 v32,v40,v31
v_fmac_f32 v33,v108,v31
v_fmac_f32 v34,v41,v31
v_fmac_f32 v35,v109,v31
v_fmac_f32 v36,v42,v31
v_fmac_f32 v37,v110,v31
v_fmac_f32 v38,v43,v31
v_fmac_f32 v39,v111,v31
v_cvt_pk_bf16_f32 v40,v32,v33
v_cvt_pk_bf16_f32 v41,v34,v35
v_cvt_pk_bf16_f32 v42,v36,v37
v_cvt_pk_bf16_f32 v43,v38,v39
buffer_store_dwordx2 v[40:41],v12,s[12:15],0 offen
buffer_store_dwordx2 v[42:43],v12,s[12:15],0 offen offset:32
K2_END:
s_endpgm
.section .rodata,"a"
.p2align 6
.amdhsa_kernel concat_heads__gqa_block_cached__mha_block_cached__near_ridge_kernel
  .amdhsa_next_free_vgpr 512
  .amdhsa_next_free_sgpr 102
  .amdhsa_accum_offset 256
  .amdhsa_group_segment_fixed_size 0
  .amdhsa_kernarg_size 104
  .amdhsa_user_sgpr_count 2
  .amdhsa_user_sgpr_kernarg_segment_ptr 1
  .amdhsa_system_sgpr_workgroup_id_x 1
.end_amdhsa_kernel
.p2align 6
.amdhsa_kernel oproj_kernel
  .amdhsa_next_free_vgpr 112
  .amdhsa_next_free_sgpr 102
  .amdhsa_accum_offset 112
  .amdhsa_group_segment_fixed_size 0
  .amdhsa_kernarg_size 104
  .amdhsa_user_sgpr_count 2
  .amdhsa_user_sgpr_kernarg_segment_ptr 1
  .amdhsa_system_sgpr_workgroup_id_x 1
.end_amdhsa_kernel
```
